```python
import torch

def _softmax(x, axis=-1):
    return torch.softmax(x, dim=axis)

def _gelu(x):
    return torch.nn.functional.gelu(x, approximate='tanh')

def _silu(x):
    return torch.nn.functional.silu(x)

def _sigmoid(x):
    return torch.sigmoid(x)

def _layernorm(x, axis=-1, eps=1e-05):
    m = x.mean(dim=axis, keepdim=True)
    v = x.var(dim=axis, keepdim=True, unbiased=False)
    return (x - m) / torch.sqrt(v + eps)

def _scatter_add(tgt, idx, src, axis=0):
    return tgt.clone().index_add_(axis, idx, src)

def _segment_sum(src, seg, n):
    out = torch.zeros((n,) + src.shape[1:], dtype=src.dtype)
    return out.index_add_(0, seg, src)

def _pad(x, pw):
    flat = tuple((v for pair in reversed(pw) for v in pair))
    return torch.nn.functional.pad(x, flat)
kernel_name = 'adaLN_cond__memory_aug_recurrent_mem_tr__moe_arch_mod__prompt'

def setup_inputs():

    _w = lambda a: (lambda t: t.to(torch.bfloat16) if t.is_floating_point() else t)(torch.as_tensor(a))

    def _A_setup():
        B, S, Dm = (1, 2048, 640)
        H, Dh = (32, 192)
        M, seg = (8, 32)
        seg = min(seg, S)
        S = S // seg * seg
        return {'x': _w((lambda *s: torch.randn(*s, dtype=torch.bfloat16) * 0.05)(B, S, Dm)), 'mem0': _w((lambda *s: torch.randn(*s, dtype=torch.bfloat16) * 0.4)(B, M, Dm)), 'Wq': _w((lambda *s: torch.randn(*s, dtype=torch.bfloat16) * 3.2)(Dm, H, Dh) * Dm ** (-0.5)), 'Wk': _w((lambda *s: torch.randn(*s, dtype=torch.bfloat16) * 3.2)(Dm, H, Dh) * Dm ** (-0.5)), 'Wv': _w((lambda *s: torch.randn(*s, dtype=torch.bfloat16) * 0.4)(Dm, H, Dh) * Dm ** (-0.5)), 'Wo': _w((lambda *s: torch.randn(*s, dtype=torch.bfloat16) * 0.4)(H, Dh, Dm) * (H * Dh) ** (-0.5)), 'seg_len': seg}
    _A_in = _A_setup()

    def _B_setup():
        B, S, D, F, C = (1, 2048, 640, 1536, 8)
        return {'x': _w((lambda *s: torch.randn(*s, dtype=torch.bfloat16) * 0.05)(B, S, D)), 'w_r': _w((lambda *s: torch.randn(*s, dtype=torch.bfloat16) * 0.05)(D)), 'w_gate': _w((lambda *s: torch.randn(*s, dtype=torch.bfloat16) * 0.05)(D, F)), 'w_up': _w((lambda *s: torch.randn(*s, dtype=torch.bfloat16) * 0.05)(D, F)), 'w_down': _w((lambda *s: torch.randn(*s, dtype=torch.bfloat16) * 0.05)(F, D))}
    _B_in = _B_setup()
    return {'A_x': _A_in['x'], 'A_mem0': _A_in['mem0'], 'A_Wq': _A_in['Wq'], 'A_Wk': _A_in['Wk'], 'A_Wv': _A_in['Wv'], 'A_Wo': _A_in['Wo'], 'A_seg_len': _A_in['seg_len'], 'B_x': _B_in['x'], 'B_w_r': _B_in['w_r'], 'B_w_gate': _B_in['w_gate'], 'B_w_up': _B_in['w_up'], 'B_w_down': _B_in['w_down'], 'c': _w((lambda *s: torch.randn(*s, dtype=torch.bfloat16) * 0.05)(1, 640) * 8.0), 'w_mod': _w((lambda *s: torch.randn(*s, dtype=torch.bfloat16) * 0.05)(640, 6 * 640) * 640 ** (-0.5) * 8.0)}

def reference(A_x, A_mem0, A_Wq, A_Wk, A_Wv, A_Wo, A_seg_len, B_x, B_w_r, B_w_gate, B_w_up, B_w_down, c, w_mod):

    def _A_ref(x, mem0, Wq, Wk, Wv, Wo, seg_len):
        B, S, Dm = x.shape
        H, Dh = (Wq.shape[1], Wq.shape[2])
        M = mem0.shape[1]
        scale = Dh ** (-0.5)
        n_seg = S // seg_len
        L = M + seg_len
        idx = torch.arange(L)
        mask = (idx[:, None] < M) | (idx[:, None] >= idx[None, :])
        mem = mem0
        outs = []
        for s in range(n_seg):
            xs = x[:, s * seg_len:(s + 1) * seg_len, :].clone()
            h = torch.concatenate([mem, xs], axis=1)
            q = torch.einsum('btd,dhe->bhte', h, Wq)
            k = torch.einsum('btd,dhe->bhte', h, Wk)
            v = torch.einsum('btd,dhe->bhte', h, Wv)
            scores = torch.einsum('bhqe,bhke->bhqk', q, k) * scale
            scores = torch.where(mask[None, None], scores, -1000000000.0)
            p = _softmax(scores, axis=-1)
            o = torch.einsum('bhqk,bhke->bhqe', p, v)
            o = torch.einsum('bhte,hed->btd', o, Wo)
            mem = o[:, :M, :].clone()
            outs.append(o[:, M:, :])
        return torch.concatenate(outs, axis=1)

    def _B_ref(x, w_r, w_gate, w_up, w_down):
        B, S, D = x.shape
        C = 8
        r = x @ w_r
        idx = torch.argsort(-r, axis=-1)[:, :C]
        idx_e = (lambda x, n, axis: torch.repeat_interleave(x, n, dim=axis))(idx.reshape(B, C, 1), D, axis=2)
        x_sel = (lambda x, i, axis: torch.take_along_dim(x, i, dim=axis))(x, idx_e, axis=1)
        g = _silu(x_sel @ w_gate)
        u = x_sel @ w_up
        y = g * u @ w_down
        r_sel = _sigmoid((lambda x, i, axis: torch.take_along_dim(x, i, dim=axis))(r, idx, axis=1))
        y = y * r_sel.reshape(B, C, 1)
        b_off = (torch.arange(B) * S).reshape(B, 1)
        flat_idx = (idx + b_off).reshape(B * C)
        zero = (x * 0.0).reshape(B * S, D)
        upd = _scatter_add(zero, flat_idx, y.reshape(B * C, D), axis=0)
        return x + upd.reshape(B, S, D)
    x = A_x
    mod = (_silu(c) @ w_mod).reshape(c.shape[0], 6, 1, -1)
    sa, ca, ga, sb, cb, gb = (mod[:, 0].clone(), mod[:, 1].clone(), mod[:, 2].clone(), mod[:, 3].clone(), mod[:, 4].clone(), mod[:, 5].clone())
    h = _layernorm(x, axis=-1) * (1 + ca) + sa
    x = x + ga * _A_ref(h, A_mem0, A_Wq, A_Wk, A_Wv, A_Wo, A_seg_len)
    h = _layernorm(x, axis=-1) * (1 + cb) + sb
    x = x + gb * _B_ref(h, B_w_r, B_w_gate, B_w_up, B_w_down)
    return x
```

```asm
; @launch kernel=init_kernel grid=(64,1,1) block=(256,1,1) lds=8192
; @launch kernel=main_kernel grid=(256,1,1) block=(256,1,1) lds=163840
.amdgcn_target "amdgcn-amd-amdhsa--gfx950"
.text
.globl init_kernel
.p2align 8
.type init_kernel,@function
init_kernel:
  s_load_dwordx2 s[8:9], s[0:1], 128
  s_mov_b32 s10, 268435456
  s_mov_b32 s11, 0x00020000
  s_load_dwordx2 s[12:13], s[0:1], 8
  s_mov_b32 s14, 10240
  s_mov_b32 s15, 0x00020000
  s_load_dwordx2 s[16:17], s[0:1], 96
  s_mov_b32 s18, 1280
  s_mov_b32 s19, 0x00020000
  s_load_dwordx2 s[20:21], s[0:1], 104
  s_mov_b32 s22, 4915200
  s_mov_b32 s23, 0x00020000
  s_cmp_ge_u32 s2, 64
  s_cbranch_scc1 init_end
  s_lshl_b32 s3, s2, 8
  v_add_u32 v1, s3, v0
  v_lshlrev_b32 v2, 4, v1
  v_mov_b32 v4, -1
  v_mov_b32 v5, -1
  v_mov_b32 v6, -1
  v_mov_b32 v7, -1
  v_mov_b32 v8, 0
  v_mov_b32 v9, 0
  v_mov_b32 v10, 0
  v_mov_b32 v11, 0
  s_waitcnt lgkmcnt(0)
  s_mov_b32 s4, 212992
  buffer_store_dwordx4 v[4:7], v2, s[8:11], s4 offen
  s_mov_b32 s4, 475136
  buffer_store_dwordx4 v[4:7], v2, s[8:11], s4 offen
  s_mov_b32 s4, 737280
  buffer_store_dwordx4 v[4:7], v2, s[8:11], s4 offen
  s_mov_b32 s4, 999424
  buffer_store_dwordx4 v[4:7], v2, s[8:11], s4 offen
  s_mov_b32 s4, 1261568
  buffer_store_dwordx4 v[4:7], v2, s[8:11], s4 offen
  s_mov_b32 s4, 1523712
  buffer_store_dwordx4 v[4:7], v2, s[8:11], s4 offen
  s_mov_b32 s4, 1785856
  buffer_store_dwordx4 v[4:7], v2, s[8:11], s4 offen
  s_mov_b32 s4, 2048000
  buffer_store_dwordx4 v[4:7], v2, s[8:11], s4 offen
  s_mov_b32 s4, 2310144
  buffer_store_dwordx4 v[4:7], v2, s[8:11], s4 offen
  s_mov_b32 s4, 2572288
  buffer_store_dwordx4 v[4:7], v2, s[8:11], s4 offen
  s_cmp_ge_u32 s2, 16
  s_cbranch_scc1 init_nf
  buffer_store_dwordx4 v[8:11], v2, s[8:11], 0 offen
init_nf:
  s_cmp_ge_u32 s2, 60
  s_cbranch_scc0 init_mod
  s_sub_u32 s5, s2, 60
  s_lshl_b32 s5, s5, 8
  v_add_u32 v1, s5, v0
  v_cmp_gt_u32 vcc, 640, v1
  s_nop 0
  s_and_b64 exec, exec, vcc
  s_cbranch_execz init_end
  v_lshrrev_b32 v12, 6, v1
  v_lshlrev_b32 v12, 7, v12
  v_bfe_u32 v13, v1, 5, 1
  v_lshlrev_b32 v13, 6, v13
  v_add_u32 v12, v12, v13
  v_bfe_u32 v13, v1, 4, 1
  v_lshlrev_b32 v13, 4, v13
  v_add_u32 v12, v12, v13
  v_bfe_u32 v13, v1, 1, 1
  v_lshlrev_b32 v13, 2, v13
  v_add_u32 v12, v12, v13
  v_bfe_u32 v13, v1, 2, 2
  v_lshlrev_b32 v13, 1, v13
  v_and_b32 v18, 1, v1
  v_add_u32 v13, v13, v18
  v_mul_u32_u24 v13, 1280, v13
  v_add_u32 v12, v12, v13
  buffer_load_dword v14, v12, s[12:15], 0 offen
  buffer_load_dword v15, v12, s[12:15], 0 offen offset:32
  buffer_load_dword v16, v12, s[12:15], 0 offen offset:8
  buffer_load_dword v17, v12, s[12:15], 0 offen offset:40
  v_lshlrev_b32 v2, 4, v1
  s_waitcnt vmcnt(0)
  s_mov_b32 s4, 131072
  buffer_store_dwordx4 v[14:17], v2, s[8:11], s4 offen
  s_mov_b32 s4, 141312
  buffer_store_dwordx4 v[14:17], v2, s[8:11], s4 offen
  s_mov_b32 s4, 151552
  buffer_store_dwordx4 v[14:17], v2, s[8:11], s4 offen
  s_mov_b32 s4, 161792
  buffer_store_dwordx4 v[14:17], v2, s[8:11], s4 offen
  s_mov_b32 s4, 172032
  buffer_store_dwordx4 v[14:17], v2, s[8:11], s4 offen
  s_mov_b32 s4, 182272
  buffer_store_dwordx4 v[14:17], v2, s[8:11], s4 offen
  s_mov_b32 s4, 192512
  buffer_store_dwordx4 v[14:17], v2, s[8:11], s4 offen
  s_mov_b32 s4, 202752
  buffer_store_dwordx4 v[14:17], v2, s[8:11], s4 offen
  s_branch init_end
init_mod:
  v_lshlrev_b32 v12, 2, v0
  buffer_load_dword v13, v12, s[16:19], 0 offen
  buffer_load_dword v14, v12, s[16:19], 0 offen offset:1024
  v_lshrrev_b32 v20, 5, v0
  v_and_b32 v21, 31, v0
  v_mul_u32_u24 v22, 614400, v20
  v_lshlrev_b32 v23, 2, v21
  v_add_u32 v22, v22, v23
  s_lshl_b32 s6, s2, 7
  buffer_load_dword v40, v22, s[20:23], s6 offen
  s_add_u32 s6, s6, 7680
  buffer_load_dword v41, v22, s[20:23], s6 offen
  s_add_u32 s6, s6, 7680
  buffer_load_dword v42, v22, s[20:23], s6 offen
  s_add_u32 s6, s6, 7680
  buffer_load_dword v43, v22, s[20:23], s6 offen
  s_add_u32 s6, s6, 7680
  buffer_load_dword v44, v22, s[20:23], s6 offen
  s_add_u32 s6, s6, 7680
  buffer_load_dword v45, v22, s[20:23], s6 offen
  s_add_u32 s6, s6, 7680
  buffer_load_dword v46, v22, s[20:23], s6 offen
  s_add_u32 s6, s6, 7680
  buffer_load_dword v47, v22, s[20:23], s6 offen
  s_add_u32 s6, s6, 7680
  buffer_load_dword v48, v22, s[20:23], s6 offen
  s_add_u32 s6, s6, 7680
  buffer_load_dword v49, v22, s[20:23], s6 offen
  s_add_u32 s6, s6, 7680
  buffer_load_dword v50, v22, s[20:23], s6 offen
  s_add_u32 s6, s6, 7680
  buffer_load_dword v51, v22, s[20:23], s6 offen
  s_add_u32 s6, s6, 7680
  buffer_load_dword v52, v22, s[20:23], s6 offen
  s_add_u32 s6, s6, 7680
  buffer_load_dword v53, v22, s[20:23], s6 offen
  s_add_u32 s6, s6, 7680
  buffer_load_dword v54, v22, s[20:23], s6 offen
  s_add_u32 s6, s6, 7680
  buffer_load_dword v55, v22, s[20:23], s6 offen
  s_add_u32 s6, s6, 7680
  buffer_load_dword v56, v22, s[20:23], s6 offen
  s_add_u32 s6, s6, 7680
  buffer_load_dword v57, v22, s[20:23], s6 offen
  s_add_u32 s6, s6, 7680
  buffer_load_dword v58, v22, s[20:23], s6 offen
  s_add_u32 s6, s6, 7680
  buffer_load_dword v59, v22, s[20:23], s6 offen
  s_add_u32 s6, s6, 7680
  buffer_load_dword v60, v22, s[20:23], s6 offen
  s_add_u32 s6, s6, 7680
  buffer_load_dword v61, v22, s[20:23], s6 offen
  s_add_u32 s6, s6, 7680
  buffer_load_dword v62, v22, s[20:23], s6 offen
  s_add_u32 s6, s6, 7680
  buffer_load_dword v63, v22, s[20:23], s6 offen
  s_add_u32 s6, s6, 7680
  buffer_load_dword v64, v22, s[20:23], s6 offen
  s_add_u32 s6, s6, 7680
  buffer_load_dword v65, v22, s[20:23], s6 offen
  s_add_u32 s6, s6, 7680
  buffer_load_dword v66, v22, s[20:23], s6 offen
  s_add_u32 s6, s6, 7680
  buffer_load_dword v67, v22, s[20:23], s6 offen
  s_add_u32 s6, s6, 7680
  buffer_load_dword v68, v22, s[20:23], s6 offen
  s_add_u32 s6, s6, 7680
  buffer_load_dword v69, v22, s[20:23], s6 offen
  s_add_u32 s6, s6, 7680
  buffer_load_dword v70, v22, s[20:23], s6 offen
  s_add_u32 s6, s6, 7680
  buffer_load_dword v71, v22, s[20:23], s6 offen
  s_add_u32 s6, s6, 7680
  buffer_load_dword v72, v22, s[20:23], s6 offen
  s_add_u32 s6, s6, 7680
  buffer_load_dword v73, v22, s[20:23], s6 offen
  s_add_u32 s6, s6, 7680
  buffer_load_dword v74, v22, s[20:23], s6 offen
  s_add_u32 s6, s6, 7680
  buffer_load_dword v75, v22, s[20:23], s6 offen
  s_add_u32 s6, s6, 7680
  buffer_load_dword v76, v22, s[20:23], s6 offen
  s_add_u32 s6, s6, 7680
  buffer_load_dword v77, v22, s[20:23], s6 offen
  s_add_u32 s6, s6, 7680
  buffer_load_dword v78, v22, s[20:23], s6 offen
  s_add_u32 s6, s6, 7680
  buffer_load_dword v79, v22, s[20:23], s6 offen
  s_add_u32 s6, s6, 7680
  buffer_load_dword v80, v22, s[20:23], s6 offen
  s_add_u32 s6, s6, 7680
  buffer_load_dword v81, v22, s[20:23], s6 offen
  s_add_u32 s6, s6, 7680
  buffer_load_dword v82, v22, s[20:23], s6 offen
  s_add_u32 s6, s6, 7680
  buffer_load_dword v83, v22, s[20:23], s6 offen
  s_add_u32 s6, s6, 7680
  buffer_load_dword v84, v22, s[20:23], s6 offen
  s_add_u32 s6, s6, 7680
  buffer_load_dword v85, v22, s[20:23], s6 offen
  s_add_u32 s6, s6, 7680
  buffer_load_dword v86, v22, s[20:23], s6 offen
  s_add_u32 s6, s6, 7680
  buffer_load_dword v87, v22, s[20:23], s6 offen
  s_add_u32 s6, s6, 7680
  buffer_load_dword v88, v22, s[20:23], s6 offen
  s_add_u32 s6, s6, 7680
  buffer_load_dword v89, v22, s[20:23], s6 offen
  s_add_u32 s6, s6, 7680
  buffer_load_dword v90, v22, s[20:23], s6 offen
  s_add_u32 s6, s6, 7680
  buffer_load_dword v91, v22, s[20:23], s6 offen
  s_add_u32 s6, s6, 7680
  buffer_load_dword v92, v22, s[20:23], s6 offen
  s_add_u32 s6, s6, 7680
  buffer_load_dword v93, v22, s[20:23], s6 offen
  s_add_u32 s6, s6, 7680
  buffer_load_dword v94, v22, s[20:23], s6 offen
  s_add_u32 s6, s6, 7680
  buffer_load_dword v95, v22, s[20:23], s6 offen
  s_add_u32 s6, s6, 7680
  buffer_load_dword v96, v22, s[20:23], s6 offen
  s_add_u32 s6, s6, 7680
  buffer_load_dword v97, v22, s[20:23], s6 offen
  s_add_u32 s6, s6, 7680
  buffer_load_dword v98, v22, s[20:23], s6 offen
  s_add_u32 s6, s6, 7680
  buffer_load_dword v99, v22, s[20:23], s6 offen
  s_add_u32 s6, s6, 7680
  buffer_load_dword v100, v22, s[20:23], s6 offen
  s_add_u32 s6, s6, 7680
  buffer_load_dword v101, v22, s[20:23], s6 offen
  s_add_u32 s6, s6, 7680
  buffer_load_dword v102, v22, s[20:23], s6 offen
  s_add_u32 s6, s6, 7680
  buffer_load_dword v103, v22, s[20:23], s6 offen
  s_add_u32 s6, s6, 7680
  buffer_load_dword v104, v22, s[20:23], s6 offen
  s_add_u32 s6, s6, 7680
  buffer_load_dword v105, v22, s[20:23], s6 offen
  s_add_u32 s6, s6, 7680
  buffer_load_dword v106, v22, s[20:23], s6 offen
  s_add_u32 s6, s6, 7680
  buffer_load_dword v107, v22, s[20:23], s6 offen
  s_add_u32 s6, s6, 7680
  buffer_load_dword v108, v22, s[20:23], s6 offen
  s_add_u32 s6, s6, 7680
  buffer_load_dword v109, v22, s[20:23], s6 offen
  s_add_u32 s6, s6, 7680
  buffer_load_dword v110, v22, s[20:23], s6 offen
  s_add_u32 s6, s6, 7680
  buffer_load_dword v111, v22, s[20:23], s6 offen
  s_add_u32 s6, s6, 7680
  buffer_load_dword v112, v22, s[20:23], s6 offen
  s_add_u32 s6, s6, 7680
  buffer_load_dword v113, v22, s[20:23], s6 offen
  s_add_u32 s6, s6, 7680
  buffer_load_dword v114, v22, s[20:23], s6 offen
  s_add_u32 s6, s6, 7680
  buffer_load_dword v115, v22, s[20:23], s6 offen
  s_add_u32 s6, s6, 7680
  buffer_load_dword v116, v22, s[20:23], s6 offen
  s_add_u32 s6, s6, 7680
  buffer_load_dword v117, v22, s[20:23], s6 offen
  s_add_u32 s6, s6, 7680
  buffer_load_dword v118, v22, s[20:23], s6 offen
  s_add_u32 s6, s6, 7680
  buffer_load_dword v119, v22, s[20:23], s6 offen
  s_add_u32 s6, s6, 7680
  s_waitcnt vmcnt(63)
  s_waitcnt vmcnt(63)
  v_lshlrev_b32 v24, 16, v13
  v_and_b32 v25, 0xffff0000, v13
  v_mul_f32 v30, 0xbfb8aa3b, v24
  v_mul_f32 v31, 0xbfb8aa3b, v25
  v_exp_f32 v30, v30
  v_exp_f32 v31, v31
  v_add_f32 v30, 1.0, v30
  v_add_f32 v31, 1.0, v31
  v_rcp_f32 v30, v30
  v_rcp_f32 v31, v31
  v_mul_f32 v24, v24, v30
  v_mul_f32 v25, v25, v31
  v_cvt_pk_bf16_f32 v30, v24, v25
  v_lshlrev_b32 v24, 16, v30
  v_and_b32 v25, 0xffff0000, v30
  v_lshlrev_b32 v26, 16, v14
  v_and_b32 v27, 0xffff0000, v14
  v_mul_f32 v30, 0xbfb8aa3b, v26
  v_mul_f32 v31, 0xbfb8aa3b, v27
  v_exp_f32 v30, v30
  v_exp_f32 v31, v31
  v_add_f32 v30, 1.0, v30
  v_add_f32 v31, 1.0, v31
  v_rcp_f32 v30, v30
  v_rcp_f32 v31, v31
  v_mul_f32 v26, v26, v30
  v_mul_f32 v27, v27, v31
  v_cvt_pk_bf16_f32 v30, v26, v27
  v_lshlrev_b32 v26, 16, v30
  v_and_b32 v27, 0xffff0000, v30
  v_lshlrev_b32 v12, 3, v0
  ds_write_b64 v12, v[24:25]
  ds_write_b64 v12, v[26:27] offset:2048
  s_waitcnt lgkmcnt(0)
  s_barrier
  v_mul_u32_u24 v12, 320, v20
  v_mov_b32 v24, 0
  v_mov_b32 v25, 0
  ds_read_b128 v[124:127], v12 offset:0
  ds_read_b128 v[128:131], v12 offset:16
  ds_read_b128 v[132:135], v12 offset:32
  ds_read_b128 v[136:139], v12 offset:48
  ds_read_b128 v[140:143], v12 offset:64
  ds_read_b128 v[144:147], v12 offset:80
  ds_read_b128 v[148:151], v12 offset:96
  ds_read_b128 v[152:155], v12 offset:112
  ds_read_b128 v[156:159], v12 offset:128
  ds_read_b128 v[160:163], v12 offset:144
  ds_read_b128 v[164:167], v12 offset:160
  ds_read_b128 v[168:171], v12 offset:176
  ds_read_b128 v[172:175], v12 offset:192
  ds_read_b128 v[176:179], v12 offset:208
  ds_read_b128 v[180:183], v12 offset:224
  ds_read_b128 v[184:187], v12 offset:240
  ds_read_b128 v[188:191], v12 offset:256
  ds_read_b128 v[192:195], v12 offset:272
  ds_read_b128 v[196:199], v12 offset:288
  ds_read_b128 v[200:203], v12 offset:304
  s_waitcnt vmcnt(0) lgkmcnt(0)
  v_lshlrev_b32 v26, 16, v40
  v_and_b32 v27, 0xffff0000, v40
  v_fmac_f32 v24, v26, v124
  v_fmac_f32 v25, v27, v124
  v_lshlrev_b32 v26, 16, v41
  v_and_b32 v27, 0xffff0000, v41
  v_fmac_f32 v24, v26, v125
  v_fmac_f32 v25, v27, v125
  v_lshlrev_b32 v26, 16, v42
  v_and_b32 v27, 0xffff0000, v42
  v_fmac_f32 v24, v26, v126
  v_fmac_f32 v25, v27, v126
  v_lshlrev_b32 v26, 16, v43
  v_and_b32 v27, 0xffff0000, v43
  v_fmac_f32 v24, v26, v127
  v_fmac_f32 v25, v27, v127
  v_lshlrev_b32 v26, 16, v44
  v_and_b32 v27, 0xffff0000, v44
  v_fmac_f32 v24, v26, v128
  v_fmac_f32 v25, v27, v128
  v_lshlrev_b32 v26, 16, v45
  v_and_b32 v27, 0xffff0000, v45
  v_fmac_f32 v24, v26, v129
  v_fmac_f32 v25, v27, v129
  v_lshlrev_b32 v26, 16, v46
  v_and_b32 v27, 0xffff0000, v46
  v_fmac_f32 v24, v26, v130
  v_fmac_f32 v25, v27, v130
  v_lshlrev_b32 v26, 16, v47
  v_and_b32 v27, 0xffff0000, v47
  v_fmac_f32 v24, v26, v131
  v_fmac_f32 v25, v27, v131
  v_lshlrev_b32 v26, 16, v48
  v_and_b32 v27, 0xffff0000, v48
  v_fmac_f32 v24, v26, v132
  v_fmac_f32 v25, v27, v132
  v_lshlrev_b32 v26, 16, v49
  v_and_b32 v27, 0xffff0000, v49
  v_fmac_f32 v24, v26, v133
  v_fmac_f32 v25, v27, v133
  v_lshlrev_b32 v26, 16, v50
  v_and_b32 v27, 0xffff0000, v50
  v_fmac_f32 v24, v26, v134
  v_fmac_f32 v25, v27, v134
  v_lshlrev_b32 v26, 16, v51
  v_and_b32 v27, 0xffff0000, v51
  v_fmac_f32 v24, v26, v135
  v_fmac_f32 v25, v27, v135
  v_lshlrev_b32 v26, 16, v52
  v_and_b32 v27, 0xffff0000, v52
  v_fmac_f32 v24, v26, v136
  v_fmac_f32 v25, v27, v136
  v_lshlrev_b32 v26, 16, v53
  v_and_b32 v27, 0xffff0000, v53
  v_fmac_f32 v24, v26, v137
  v_fmac_f32 v25, v27, v137
  v_lshlrev_b32 v26, 16, v54
  v_and_b32 v27, 0xffff0000, v54
  v_fmac_f32 v24, v26, v138
  v_fmac_f32 v25, v27, v138
  v_lshlrev_b32 v26, 16, v55
  v_and_b32 v27, 0xffff0000, v55
  v_fmac_f32 v24, v26, v139
  v_fmac_f32 v25, v27, v139
  v_lshlrev_b32 v26, 16, v56
  v_and_b32 v27, 0xffff0000, v56
  v_fmac_f32 v24, v26, v140
  v_fmac_f32 v25, v27, v140
  v_lshlrev_b32 v26, 16, v57
  v_and_b32 v27, 0xffff0000, v57
  v_fmac_f32 v24, v26, v141
  v_fmac_f32 v25, v27, v141
  v_lshlrev_b32 v26, 16, v58
  v_and_b32 v27, 0xffff0000, v58
  v_fmac_f32 v24, v26, v142
  v_fmac_f32 v25, v27, v142
  v_lshlrev_b32 v26, 16, v59
  v_and_b32 v27, 0xffff0000, v59
  v_fmac_f32 v24, v26, v143
  v_fmac_f32 v25, v27, v143
  v_lshlrev_b32 v26, 16, v60
  v_and_b32 v27, 0xffff0000, v60
  v_fmac_f32 v24, v26, v144
  v_fmac_f32 v25, v27, v144
  v_lshlrev_b32 v26, 16, v61
  v_and_b32 v27, 0xffff0000, v61
  v_fmac_f32 v24, v26, v145
  v_fmac_f32 v25, v27, v145
  v_lshlrev_b32 v26, 16, v62
  v_and_b32 v27, 0xffff0000, v62
  v_fmac_f32 v24, v26, v146
  v_fmac_f32 v25, v27, v146
  v_lshlrev_b32 v26, 16, v63
  v_and_b32 v27, 0xffff0000, v63
  v_fmac_f32 v24, v26, v147
  v_fmac_f32 v25, v27, v147
  v_lshlrev_b32 v26, 16, v64
  v_and_b32 v27, 0xffff0000, v64
  v_fmac_f32 v24, v26, v148
  v_fmac_f32 v25, v27, v148
  v_lshlrev_b32 v26, 16, v65
  v_and_b32 v27, 0xffff0000, v65
  v_fmac_f32 v24, v26, v149
  v_fmac_f32 v25, v27, v149
  v_lshlrev_b32 v26, 16, v66
  v_and_b32 v27, 0xffff0000, v66
  v_fmac_f32 v24, v26, v150
  v_fmac_f32 v25, v27, v150
  v_lshlrev_b32 v26, 16, v67
  v_and_b32 v27, 0xffff0000, v67
  v_fmac_f32 v24, v26, v151
  v_fmac_f32 v25, v27, v151
  v_lshlrev_b32 v26, 16, v68
  v_and_b32 v27, 0xffff0000, v68
  v_fmac_f32 v24, v26, v152
  v_fmac_f32 v25, v27, v152
  v_lshlrev_b32 v26, 16, v69
  v_and_b32 v27, 0xffff0000, v69
  v_fmac_f32 v24, v26, v153
  v_fmac_f32 v25, v27, v153
  v_lshlrev_b32 v26, 16, v70
  v_and_b32 v27, 0xffff0000, v70
  v_fmac_f32 v24, v26, v154
  v_fmac_f32 v25, v27, v154
  v_lshlrev_b32 v26, 16, v71
  v_and_b32 v27, 0xffff0000, v71
  v_fmac_f32 v24, v26, v155
  v_fmac_f32 v25, v27, v155
  v_lshlrev_b32 v26, 16, v72
  v_and_b32 v27, 0xffff0000, v72
  v_fmac_f32 v24, v26, v156
  v_fmac_f32 v25, v27, v156
  v_lshlrev_b32 v26, 16, v73
  v_and_b32 v27, 0xffff0000, v73
  v_fmac_f32 v24, v26, v157
  v_fmac_f32 v25, v27, v157
  v_lshlrev_b32 v26, 16, v74
  v_and_b32 v27, 0xffff0000, v74
  v_fmac_f32 v24, v26, v158
  v_fmac_f32 v25, v27, v158
  v_lshlrev_b32 v26, 16, v75
  v_and_b32 v27, 0xffff0000, v75
  v_fmac_f32 v24, v26, v159
  v_fmac_f32 v25, v27, v159
  v_lshlrev_b32 v26, 16, v76
  v_and_b32 v27, 0xffff0000, v76
  v_fmac_f32 v24, v26, v160
  v_fmac_f32 v25, v27, v160
  v_lshlrev_b32 v26, 16, v77
  v_and_b32 v27, 0xffff0000, v77
  v_fmac_f32 v24, v26, v161
  v_fmac_f32 v25, v27, v161
  v_lshlrev_b32 v26, 16, v78
  v_and_b32 v27, 0xffff0000, v78
  v_fmac_f32 v24, v26, v162
  v_fmac_f32 v25, v27, v162
  v_lshlrev_b32 v26, 16, v79
  v_and_b32 v27, 0xffff0000, v79
  v_fmac_f32 v24, v26, v163
  v_fmac_f32 v25, v27, v163
  v_lshlrev_b32 v26, 16, v80
  v_and_b32 v27, 0xffff0000, v80
  v_fmac_f32 v24, v26, v164
  v_fmac_f32 v25, v27, v164
  v_lshlrev_b32 v26, 16, v81
  v_and_b32 v27, 0xffff0000, v81
  v_fmac_f32 v24, v26, v165
  v_fmac_f32 v25, v27, v165
  v_lshlrev_b32 v26, 16, v82
  v_and_b32 v27, 0xffff0000, v82
  v_fmac_f32 v24, v26, v166
  v_fmac_f32 v25, v27, v166
  v_lshlrev_b32 v26, 16, v83
  v_and_b32 v27, 0xffff0000, v83
  v_fmac_f32 v24, v26, v167
  v_fmac_f32 v25, v27, v167
  v_lshlrev_b32 v26, 16, v84
  v_and_b32 v27, 0xffff0000, v84
  v_fmac_f32 v24, v26, v168
  v_fmac_f32 v25, v27, v168
  v_lshlrev_b32 v26, 16, v85
  v_and_b32 v27, 0xffff0000, v85
  v_fmac_f32 v24, v26, v169
  v_fmac_f32 v25, v27, v169
  v_lshlrev_b32 v26, 16, v86
  v_and_b32 v27, 0xffff0000, v86
  v_fmac_f32 v24, v26, v170
  v_fmac_f32 v25, v27, v170
  v_lshlrev_b32 v26, 16, v87
  v_and_b32 v27, 0xffff0000, v87
  v_fmac_f32 v24, v26, v171
  v_fmac_f32 v25, v27, v171
  v_lshlrev_b32 v26, 16, v88
  v_and_b32 v27, 0xffff0000, v88
  v_fmac_f32 v24, v26, v172
  v_fmac_f32 v25, v27, v172
  v_lshlrev_b32 v26, 16, v89
  v_and_b32 v27, 0xffff0000, v89
  v_fmac_f32 v24, v26, v173
  v_fmac_f32 v25, v27, v173
  v_lshlrev_b32 v26, 16, v90
  v_and_b32 v27, 0xffff0000, v90
  v_fmac_f32 v24, v26, v174
  v_fmac_f32 v25, v27, v174
  v_lshlrev_b32 v26, 16, v91
  v_and_b32 v27, 0xffff0000, v91
  v_fmac_f32 v24, v26, v175
  v_fmac_f32 v25, v27, v175
  v_lshlrev_b32 v26, 16, v92
  v_and_b32 v27, 0xffff0000, v92
  v_fmac_f32 v24, v26, v176
  v_fmac_f32 v25, v27, v176
  v_lshlrev_b32 v26, 16, v93
  v_and_b32 v27, 0xffff0000, v93
  v_fmac_f32 v24, v26, v177
  v_fmac_f32 v25, v27, v177
  v_lshlrev_b32 v26, 16, v94
  v_and_b32 v27, 0xffff0000, v94
  v_fmac_f32 v24, v26, v178
  v_fmac_f32 v25, v27, v178
  v_lshlrev_b32 v26, 16, v95
  v_and_b32 v27, 0xffff0000, v95
  v_fmac_f32 v24, v26, v179
  v_fmac_f32 v25, v27, v179
  v_lshlrev_b32 v26, 16, v96
  v_and_b32 v27, 0xffff0000, v96
  v_fmac_f32 v24, v26, v180
  v_fmac_f32 v25, v27, v180
  v_lshlrev_b32 v26, 16, v97
  v_and_b32 v27, 0xffff0000, v97
  v_fmac_f32 v24, v26, v181
  v_fmac_f32 v25, v27, v181
  v_lshlrev_b32 v26, 16, v98
  v_and_b32 v27, 0xffff0000, v98
  v_fmac_f32 v24, v26, v182
  v_fmac_f32 v25, v27, v182
  v_lshlrev_b32 v26, 16, v99
  v_and_b32 v27, 0xffff0000, v99
  v_fmac_f32 v24, v26, v183
  v_fmac_f32 v25, v27, v183
  v_lshlrev_b32 v26, 16, v100
  v_and_b32 v27, 0xffff0000, v100
  v_fmac_f32 v24, v26, v184
  v_fmac_f32 v25, v27, v184
  v_lshlrev_b32 v26, 16, v101
  v_and_b32 v27, 0xffff0000, v101
  v_fmac_f32 v24, v26, v185
  v_fmac_f32 v25, v27, v185
  v_lshlrev_b32 v26, 16, v102
  v_and_b32 v27, 0xffff0000, v102
  v_fmac_f32 v24, v26, v186
  v_fmac_f32 v25, v27, v186
  v_lshlrev_b32 v26, 16, v103
  v_and_b32 v27, 0xffff0000, v103
  v_fmac_f32 v24, v26, v187
  v_fmac_f32 v25, v27, v187
  v_lshlrev_b32 v26, 16, v104
  v_and_b32 v27, 0xffff0000, v104
  v_fmac_f32 v24, v26, v188
  v_fmac_f32 v25, v27, v188
  v_lshlrev_b32 v26, 16, v105
  v_and_b32 v27, 0xffff0000, v105
  v_fmac_f32 v24, v26, v189
  v_fmac_f32 v25, v27, v189
  v_lshlrev_b32 v26, 16, v106
  v_and_b32 v27, 0xffff0000, v106
  v_fmac_f32 v24, v26, v190
  v_fmac_f32 v25, v27, v190
  v_lshlrev_b32 v26, 16, v107
  v_and_b32 v27, 0xffff0000, v107
  v_fmac_f32 v24, v26, v191
  v_fmac_f32 v25, v27, v191
  v_lshlrev_b32 v26, 16, v108
  v_and_b32 v27, 0xffff0000, v108
  v_fmac_f32 v24, v26, v192
  v_fmac_f32 v25, v27, v192
  v_lshlrev_b32 v26, 16, v109
  v_and_b32 v27, 0xffff0000, v109
  v_fmac_f32 v24, v26, v193
  v_fmac_f32 v25, v27, v193
  v_lshlrev_b32 v26, 16, v110
  v_and_b32 v27, 0xffff0000, v110
  v_fmac_f32 v24, v26, v194
  v_fmac_f32 v25, v27, v194
  v_lshlrev_b32 v26, 16, v111
  v_and_b32 v27, 0xffff0000, v111
  v_fmac_f32 v24, v26, v195
  v_fmac_f32 v25, v27, v195
  v_lshlrev_b32 v26, 16, v112
  v_and_b32 v27, 0xffff0000, v112
  v_fmac_f32 v24, v26, v196
  v_fmac_f32 v25, v27, v196
  v_lshlrev_b32 v26, 16, v113
  v_and_b32 v27, 0xffff0000, v113
  v_fmac_f32 v24, v26, v197
  v_fmac_f32 v25, v27, v197
  v_lshlrev_b32 v26, 16, v114
  v_and_b32 v27, 0xffff0000, v114
  v_fmac_f32 v24, v26, v198
  v_fmac_f32 v25, v27, v198
  v_lshlrev_b32 v26, 16, v115
  v_and_b32 v27, 0xffff0000, v115
  v_fmac_f32 v24, v26, v199
  v_fmac_f32 v25, v27, v199
  v_lshlrev_b32 v26, 16, v116
  v_and_b32 v27, 0xffff0000, v116
  v_fmac_f32 v24, v26, v200
  v_fmac_f32 v25, v27, v200
  v_lshlrev_b32 v26, 16, v117
  v_and_b32 v27, 0xffff0000, v117
  v_fmac_f32 v24, v26, v201
  v_fmac_f32 v25, v27, v201
  v_lshlrev_b32 v26, 16, v118
  v_and_b32 v27, 0xffff0000, v118
  v_fmac_f32 v24, v26, v202
  v_fmac_f32 v25, v27, v202
  v_lshlrev_b32 v26, 16, v119
  v_and_b32 v27, 0xffff0000, v119
  v_fmac_f32 v24, v26, v203
  v_fmac_f32 v25, v27, v203
  v_lshlrev_b32 v12, 3, v0
  ds_write_b64 v12, v[24:25] offset:4096
  s_waitcnt lgkmcnt(0)
  s_barrier
  v_cmp_gt_u32 vcc, 32, v0
  s_nop 0
  s_and_b64 exec, exec, vcc
  s_cbranch_execz init_end
  ds_read_b64 v[40:41], v12 offset:4096
  ds_read_b64 v[42:43], v12 offset:4352
  ds_read_b64 v[44:45], v12 offset:4608
  ds_read_b64 v[46:47], v12 offset:4864
  ds_read_b64 v[48:49], v12 offset:5120
  ds_read_b64 v[50:51], v12 offset:5376
  ds_read_b64 v[52:53], v12 offset:5632
  ds_read_b64 v[54:55], v12 offset:5888
  s_waitcnt lgkmcnt(0)
  v_add_f32 v40, v40, v42
  v_add_f32 v41, v41, v43
  v_add_f32 v40, v40, v44
  v_add_f32 v41, v41, v45
  v_add_f32 v40, v40, v46
  v_add_f32 v41, v41, v47
  v_add_f32 v40, v40, v48
  v_add_f32 v41, v41, v49
  v_add_f32 v40, v40, v50
  v_add_f32 v41, v41, v51
  v_add_f32 v40, v40, v52
  v_add_f32 v41, v41, v53
  v_add_f32 v40, v40, v54
  v_add_f32 v41, v41, v55
  v_cvt_pk_bf16_f32 v30, v40, v41
  v_lshlrev_b32 v40, 16, v30
  v_and_b32 v41, 0xffff0000, v30
  s_lshl_b32 s6, s2, 8
  s_add_u32 s6, s6, 65536
  buffer_store_dwordx2 v[40:41], v12, s[8:11], s6 offen
init_end:
  s_endpgm
.globl main_kernel
.p2align 8
.type main_kernel,@function
main_kernel:
  s_load_dwordx2 s[8:9], s[0:1], 128
  s_mov_b32 s10, 268435456
  s_mov_b32 s11, 0x00020000
  s_load_dwordx2 s[12:13], s[0:1], 120
  s_mov_b32 s14, 256
  s_mov_b32 s15, 0x00020000
  s_getreg_b32 s16, hwreg(HW_REG_XCC_ID)
  s_and_b32 s16, s16, 7
  v_and_b32 v1, 63, v0
  v_lshrrev_b32 v2, 6, v0
  s_nop 0
  v_readfirstlane_b32 s17, v2
  v_mov_b32 v3, 1
  s_lshl_b32 s3, s16, 2
  v_mov_b32 v4, s3
  v_mov_b32 v5, 0
  s_waitcnt lgkmcnt(0)
  v_cmp_eq_u32 vcc, 0, v0
  s_nop 0
  s_and_b64 exec, exec, vcc
  s_cbranch_execz main_tk
  buffer_atomic_add v3, v4, s[12:15], 0 offen sc0
  s_waitcnt vmcnt(0)
  ds_write_b32 v5, v3
  s_waitcnt lgkmcnt(0)
main_tk:
  s_mov_b64 exec, -1
  s_barrier
  ds_read_b32 v3, v5
  s_waitcnt lgkmcnt(0)
  v_readfirstlane_b32 s18, v3
  s_barrier
  s_cmp_lt_u32 s18, 12
  s_cbranch_scc1 role_chain
  s_cmp_lt_u32 s18, 21
  s_cbranch_scc1 role_p
  s_cmp_lt_u32 s18, 26
  s_cbranch_scc1 role_ua
  s_cmp_lt_u32 s18, 28
  s_cbranch_scc1 role_sm
  s_cmp_lt_u32 s18, 32
  s_cbranch_scc1 role_r
role_none:
  s_endpgm
role_abort:
  v_mov_b32 v2, 132
  v_mov_b32 v3, 1
  s_mov_b64 exec, 1
  buffer_atomic_add v3, v2, s[12:15], 0 offen
  s_endpgm
role_p:
  s_sub_u32 s24, s18, 12
  s_lshl_b32 s24, s24, 2
  s_add_u32 s24, s24, s17
  s_mul_i32 s25, s24, 43
  s_lshr_b32 s25, s25, 9
  s_mul_i32 s30, s25, 12
  s_sub_u32 s30, s24, s30
  s_mul_i32 s26, s30, 43
  s_lshr_b32 s26, s26, 7
  s_mul_i32 s31, s26, 3
  s_sub_u32 s27, s30, s31
  s_load_dwordx2 s[20:21], s[0:1], 16
  s_load_dwordx2 s[4:5], s[0:1], 24
  s_load_dwordx2 s[6:7], s[0:1], 32
  s_mov_b32 s22, 7864320
  s_mov_b32 s23, 0x00020000
  s_waitcnt lgkmcnt(0)
  s_cmp_eq_u32 s25, 1
  s_cselect_b64 s[20:21], s[4:5], s[20:21]
  s_cmp_eq_u32 s25, 2
  s_cselect_b64 s[20:21], s[6:7], s[20:21]
  v_lshrrev_b32 v107, 4, v1
  v_and_b32 v107, 3, v107
  v_lshlrev_b32 v107, 1, v107
  v_and_b32 v52, 7, v1
  v_xor_b32 v52, v52, v107
  v_lshlrev_b32 v52, 4, v52
  v_lshrrev_b32 v107, 3, v1
  v_mul_u32_u24 v107, 0, v107
  v_add_u32 v52, v52, v107
  v_bfe_u32 v107, v1, 3, 2
  v_bfe_u32 v108, v1, 5, 1
  v_lshl_add_u32 v107, v108, 3, v107
  v_mul_u32_u24 v107, 12288, v107
  v_add_u32 v52, v52, v107
  s_mul_i32 s33, s17, 40960
  v_lshrrev_b32 v107, 2, v1
  v_lshrrev_b32 v108, 1, v107
  v_and_b32 v108, 3, v108
  v_lshlrev_b32 v108, 1, v108
  v_bfe_u32 v110, v1, 1, 1
  v_add_u32 v110, 0, v110
  v_xor_b32 v110, v110, v108
  v_lshlrev_b32 v110, 4, v110
  v_lshlrev_b32 v107, 7, v107
  v_add_u32 v110, v110, v107
  v_and_b32 v107, 1, v1
  v_lshlrev_b32 v107, 3, v107
  v_add_u32 v110, v110, v107
  v_add_u32 v110, s33, v110
  v_lshrrev_b32 v107, 2, v1
  v_lshrrev_b32 v108, 1, v107
  v_and_b32 v108, 3, v108
  v_lshlrev_b32 v108, 1, v108
  v_bfe_u32 v111, v1, 1, 1
  v_add_u32 v111, 2, v111
  v_xor_b32 v111, v111, v108
  v_lshlrev_b32 v111, 4, v111
  v_lshlrev_b32 v107, 7, v107
  v_add_u32 v111, v111, v107
  v_and_b32 v107, 1, v1
  v_lshlrev_b32 v107, 3, v107
  v_add_u32 v111, v111, v107
  v_add_u32 v111, s33, v111
  v_lshrrev_b32 v107, 2, v1
  v_lshrrev_b32 v108, 1, v107
  v_and_b32 v108, 3, v108
  v_lshlrev_b32 v108, 1, v108
  v_bfe_u32 v112, v1, 1, 1
  v_add_u32 v112, 4, v112
  v_xor_b32 v112, v112, v108
  v_lshlrev_b32 v112, 4, v112
  v_lshlrev_b32 v107, 7, v107
  v_add_u32 v112, v112, v107
  v_and_b32 v107, 1, v1
  v_lshlrev_b32 v107, 3, v107
  v_add_u32 v112, v112, v107
  v_add_u32 v112, s33, v112
  v_lshrrev_b32 v107, 2, v1
  v_lshrrev_b32 v108, 1, v107
  v_and_b32 v108, 3, v108
  v_lshlrev_b32 v108, 1, v108
  v_bfe_u32 v113, v1, 1, 1
  v_add_u32 v113, 6, v113
  v_xor_b32 v113, v113, v108
  v_lshlrev_b32 v113, 4, v113
  v_lshlrev_b32 v107, 7, v107
  v_add_u32 v113, v113, v107
  v_and_b32 v107, 1, v1
  v_lshlrev_b32 v107, 3, v107
  v_add_u32 v113, v113, v107
  v_add_u32 v113, s33, v113
  s_lshl_b32 s30, s16, 2
  s_add_u32 s30, s30, s26
  s_mul_i32 s32, s30, 384
  s_lshl_b32 s31, s27, 7
  s_add_u32 s32, s32, s31
  s_mul_i32 s35, s30, 786432
  s_mul_i32 s30, s25, 25165824
  s_add_u32 s35, s35, s30
  s_lshl_b32 s31, s27, 11
  s_add_u32 s35, s35, s31
  s_add_u32 s35, s35, 67108864
  s_mov_b32 s31, s33
  s_mov_b32 m0, s31
  s_add_u32 s30, s32, 0
  s_add_u32 s31, s31, 1024
  buffer_load_dwordx4 v52, s[20:23], s30 offen lds
  s_mov_b32 m0, s31
  s_add_u32 s30, s32, 196608
  s_add_u32 s31, s31, 1024
  buffer_load_dwordx4 v52, s[20:23], s30 offen lds
  s_mov_b32 m0, s31
  s_add_u32 s30, s32, 49152
  s_add_u32 s31, s31, 1024
  buffer_load_dwordx4 v52, s[20:23], s30 offen lds
  s_mov_b32 m0, s31
  s_add_u32 s30, s32, 245760
  s_add_u32 s31, s31, 1024
  buffer_load_dwordx4 v52, s[20:23], s30 offen lds
  s_mov_b32 m0, s31
  s_add_u32 s30, s32, 393216
  s_add_u32 s31, s31, 1024
  buffer_load_dwordx4 v52, s[20:23], s30 offen lds
  s_mov_b32 m0, s31
  s_add_u32 s30, s32, 589824
  s_add_u32 s31, s31, 1024
  buffer_load_dwordx4 v52, s[20:23], s30 offen lds
  s_mov_b32 m0, s31
  s_add_u32 s30, s32, 442368
  s_add_u32 s31, s31, 1024
  buffer_load_dwordx4 v52, s[20:23], s30 offen lds
  s_mov_b32 m0, s31
  s_add_u32 s30, s32, 638976
  s_add_u32 s31, s31, 1024
  buffer_load_dwordx4 v52, s[20:23], s30 offen lds
  s_mov_b32 m0, s31
  s_add_u32 s30, s32, 786432
  s_add_u32 s31, s31, 1024
  buffer_load_dwordx4 v52, s[20:23], s30 offen lds
  s_mov_b32 m0, s31
  s_add_u32 s30, s32, 983040
  s_add_u32 s31, s31, 1024
  buffer_load_dwordx4 v52, s[20:23], s30 offen lds
  s_mov_b32 m0, s31
  s_add_u32 s30, s32, 835584
  s_add_u32 s31, s31, 1024
  buffer_load_dwordx4 v52, s[20:23], s30 offen lds
  s_mov_b32 m0, s31
  s_add_u32 s30, s32, 1032192
  s_add_u32 s31, s31, 1024
  buffer_load_dwordx4 v52, s[20:23], s30 offen lds
  s_mov_b32 m0, s31
  s_add_u32 s30, s32, 1179648
  s_add_u32 s31, s31, 1024
  buffer_load_dwordx4 v52, s[20:23], s30 offen lds
  s_mov_b32 m0, s31
  s_add_u32 s30, s32, 1376256
  s_add_u32 s31, s31, 1024
  buffer_load_dwordx4 v52, s[20:23], s30 offen lds
  s_mov_b32 m0, s31
  s_add_u32 s30, s32, 1228800
  s_add_u32 s31, s31, 1024
  buffer_load_dwordx4 v52, s[20:23], s30 offen lds
  s_mov_b32 m0, s31
  s_add_u32 s30, s32, 1425408
  s_add_u32 s31, s31, 1024
  buffer_load_dwordx4 v52, s[20:23], s30 offen lds
  s_mov_b32 m0, s31
  s_add_u32 s30, s32, 1572864
  s_add_u32 s31, s31, 1024
  buffer_load_dwordx4 v52, s[20:23], s30 offen lds
  s_mov_b32 m0, s31
  s_add_u32 s30, s32, 1769472
  s_add_u32 s31, s31, 1024
  buffer_load_dwordx4 v52, s[20:23], s30 offen lds
  s_mov_b32 m0, s31
  s_add_u32 s30, s32, 1622016
  s_add_u32 s31, s31, 1024
  buffer_load_dwordx4 v52, s[20:23], s30 offen lds
  s_mov_b32 m0, s31
  s_add_u32 s30, s32, 1818624
  s_add_u32 s31, s31, 1024
  buffer_load_dwordx4 v52, s[20:23], s30 offen lds
  s_mov_b32 m0, s31
  s_add_u32 s30, s32, 1966080
  s_add_u32 s31, s31, 1024
  buffer_load_dwordx4 v52, s[20:23], s30 offen lds
  s_mov_b32 m0, s31
  s_add_u32 s30, s32, 2162688
  s_add_u32 s31, s31, 1024
  buffer_load_dwordx4 v52, s[20:23], s30 offen lds
  s_mov_b32 m0, s31
  s_add_u32 s30, s32, 2015232
  s_add_u32 s31, s31, 1024
  buffer_load_dwordx4 v52, s[20:23], s30 offen lds
  s_mov_b32 m0, s31
  s_add_u32 s30, s32, 2211840
  s_add_u32 s31, s31, 1024
  buffer_load_dwordx4 v52, s[20:23], s30 offen lds
  s_mov_b32 m0, s31
  s_add_u32 s30, s32, 2359296
  s_add_u32 s31, s31, 1024
  buffer_load_dwordx4 v52, s[20:23], s30 offen lds
  s_mov_b32 m0, s31
  s_add_u32 s30, s32, 2555904
  s_add_u32 s31, s31, 1024
  buffer_load_dwordx4 v52, s[20:23], s30 offen lds
  s_mov_b32 m0, s31
  s_add_u32 s30, s32, 2408448
  s_add_u32 s31, s31, 1024
  buffer_load_dwordx4 v52, s[20:23], s30 offen lds
  s_mov_b32 m0, s31
  s_add_u32 s30, s32, 2605056
  s_add_u32 s31, s31, 1024
  buffer_load_dwordx4 v52, s[20:23], s30 offen lds
  s_mov_b32 m0, s31
  s_add_u32 s30, s32, 2752512
  s_add_u32 s31, s31, 1024
  buffer_load_dwordx4 v52, s[20:23], s30 offen lds
  s_mov_b32 m0, s31
  s_add_u32 s30, s32, 2949120
  s_add_u32 s31, s31, 1024
  buffer_load_dwordx4 v52, s[20:23], s30 offen lds
  s_mov_b32 m0, s31
  s_add_u32 s30, s32, 2801664
  s_add_u32 s31, s31, 1024
  buffer_load_dwordx4 v52, s[20:23], s30 offen lds
  s_mov_b32 m0, s31
  s_add_u32 s30, s32, 2998272
  s_add_u32 s31, s31, 1024
  buffer_load_dwordx4 v52, s[20:23], s30 offen lds
  s_mov_b32 m0, s31
  s_add_u32 s30, s32, 3145728
  s_add_u32 s31, s31, 1024
  buffer_load_dwordx4 v52, s[20:23], s30 offen lds
  s_mov_b32 m0, s31
  s_add_u32 s30, s32, 3342336
  s_add_u32 s31, s31, 1024
  buffer_load_dwordx4 v52, s[20:23], s30 offen lds
  s_mov_b32 m0, s31
  s_add_u32 s30, s32, 3194880
  s_add_u32 s31, s31, 1024
  buffer_load_dwordx4 v52, s[20:23], s30 offen lds
  s_mov_b32 m0, s31
  s_add_u32 s30, s32, 3391488
  s_add_u32 s31, s31, 1024
  buffer_load_dwordx4 v52, s[20:23], s30 offen lds
  s_mov_b32 m0, s31
  s_add_u32 s30, s32, 3538944
  s_add_u32 s31, s31, 1024
  buffer_load_dwordx4 v52, s[20:23], s30 offen lds
  s_mov_b32 m0, s31
  s_add_u32 s30, s32, 3735552
  s_add_u32 s31, s31, 1024
  buffer_load_dwordx4 v52, s[20:23], s30 offen lds
  s_mov_b32 m0, s31
  s_add_u32 s30, s32, 3588096
  s_add_u32 s31, s31, 1024
  buffer_load_dwordx4 v52, s[20:23], s30 offen lds
  s_mov_b32 m0, s31
  s_add_u32 s30, s32, 3784704
  s_add_u32 s31, s31, 1024
  buffer_load_dwordx4 v52, s[20:23], s30 offen lds
  s_waitcnt vmcnt(36)
  ds_read_b64_tr_b16 v[192:193], v110 offset:0
  ds_read_b64_tr_b16 v[194:195], v110 offset:2048
  ds_read_b64_tr_b16 a[16:17], v111 offset:0
  ds_read_b64_tr_b16 a[18:19], v111 offset:2048
  ds_read_b64_tr_b16 a[96:97], v112 offset:0
  ds_read_b64_tr_b16 a[98:99], v112 offset:2048
  ds_read_b64_tr_b16 a[176:177], v113 offset:0
  ds_read_b64_tr_b16 a[178:179], v113 offset:2048
  s_waitcnt vmcnt(32)
  ds_read_b64_tr_b16 v[196:197], v110 offset:4096
  ds_read_b64_tr_b16 v[198:199], v110 offset:6144
  ds_read_b64_tr_b16 a[20:21], v111 offset:4096
  ds_read_b64_tr_b16 a[22:23], v111 offset:6144
  ds_read_b64_tr_b16 a[100:101], v112 offset:4096
  ds_read_b64_tr_b16 a[102:103], v112 offset:6144
  ds_read_b64_tr_b16 a[180:181], v113 offset:4096
  ds_read_b64_tr_b16 a[182:183], v113 offset:6144
  s_waitcnt lgkmcnt(0)
  s_waitcnt vmcnt(28)
  ds_read_b64_tr_b16 v[200:201], v110 offset:8192
  ds_read_b64_tr_b16 v[202:203], v110 offset:10240
  ds_read_b64_tr_b16 a[24:25], v111 offset:8192
  ds_read_b64_tr_b16 a[26:27], v111 offset:10240
  ds_read_b64_tr_b16 a[104:105], v112 offset:8192
  ds_read_b64_tr_b16 a[106:107], v112 offset:10240
  ds_read_b64_tr_b16 a[184:185], v113 offset:8192
  ds_read_b64_tr_b16 a[186:187], v113 offset:10240
  s_waitcnt vmcnt(24)
  ds_read_b64_tr_b16 v[204:205], v110 offset:12288
  ds_read_b64_tr_b16 v[206:207], v110 offset:14336
  ds_read_b64_tr_b16 a[28:29], v111 offset:12288
  ds_read_b64_tr_b16 a[30:31], v111 offset:14336
  ds_read_b64_tr_b16 a[108:109], v112 offset:12288
  ds_read_b64_tr_b16 a[110:111], v112 offset:14336
  ds_read_b64_tr_b16 a[188:189], v113 offset:12288
  ds_read_b64_tr_b16 a[190:191], v113 offset:14336
  s_waitcnt lgkmcnt(0)
  s_waitcnt vmcnt(20)
  ds_read_b64_tr_b16 v[208:209], v110 offset:16384
  ds_read_b64_tr_b16 v[210:211], v110 offset:18432
  ds_read_b64_tr_b16 a[32:33], v111 offset:16384
  ds_read_b64_tr_b16 a[34:35], v111 offset:18432
  ds_read_b64_tr_b16 a[112:113], v112 offset:16384
  ds_read_b64_tr_b16 a[114:115], v112 offset:18432
  ds_read_b64_tr_b16 a[192:193], v113 offset:16384
  ds_read_b64_tr_b16 a[194:195], v113 offset:18432
  s_waitcnt vmcnt(16)
  ds_read_b64_tr_b16 v[212:213], v110 offset:20480
  ds_read_b64_tr_b16 v[214:215], v110 offset:22528
  ds_read_b64_tr_b16 a[36:37], v111 offset:20480
  ds_read_b64_tr_b16 a[38:39], v111 offset:22528
  ds_read_b64_tr_b16 a[116:117], v112 offset:20480
  ds_read_b64_tr_b16 a[118:119], v112 offset:22528
  ds_read_b64_tr_b16 a[196:197], v113 offset:20480
  ds_read_b64_tr_b16 a[198:199], v113 offset:22528
  s_waitcnt lgkmcnt(0)
  s_waitcnt vmcnt(12)
  ds_read_b64_tr_b16 v[216:217], v110 offset:24576
  ds_read_b64_tr_b16 v[218:219], v110 offset:26624
  ds_read_b64_tr_b16 a[40:41], v111 offset:24576
  ds_read_b64_tr_b16 a[42:43], v111 offset:26624
  ds_read_b64_tr_b16 a[120:121], v112 offset:24576
  ds_read_b64_tr_b16 a[122:123], v112 offset:26624
  ds_read_b64_tr_b16 a[200:201], v113 offset:24576
  ds_read_b64_tr_b16 a[202:203], v113 offset:26624
  s_waitcnt vmcnt(8)
  ds_read_b64_tr_b16 v[220:221], v110 offset:28672
  ds_read_b64_tr_b16 v[222:223], v110 offset:30720
  ds_read_b64_tr_b16 a[44:45], v111 offset:28672
  ds_read_b64_tr_b16 a[46:47], v111 offset:30720
  ds_read_b64_tr_b16 a[124:125], v112 offset:28672
  ds_read_b64_tr_b16 a[126:127], v112 offset:30720
  ds_read_b64_tr_b16 a[204:205], v113 offset:28672
  ds_read_b64_tr_b16 a[206:207], v113 offset:30720
  s_waitcnt lgkmcnt(0)
  s_waitcnt vmcnt(4)
  ds_read_b64_tr_b16 v[224:225], v110 offset:32768
  ds_read_b64_tr_b16 v[226:227], v110 offset:34816
  ds_read_b64_tr_b16 a[48:49], v111 offset:32768
  ds_read_b64_tr_b16 a[50:51], v111 offset:34816
  ds_read_b64_tr_b16 a[128:129], v112 offset:32768
  ds_read_b64_tr_b16 a[130:131], v112 offset:34816
  ds_read_b64_tr_b16 a[208:209], v113 offset:32768
  ds_read_b64_tr_b16 a[210:211], v113 offset:34816
  s_waitcnt vmcnt(0)
  ds_read_b64_tr_b16 v[228:229], v110 offset:36864
  ds_read_b64_tr_b16 v[230:231], v110 offset:38912
  ds_read_b64_tr_b16 a[52:53], v111 offset:36864
  ds_read_b64_tr_b16 a[54:55], v111 offset:38912
  ds_read_b64_tr_b16 a[132:133], v112 offset:36864
  ds_read_b64_tr_b16 a[134:135], v112 offset:38912
  ds_read_b64_tr_b16 a[212:213], v113 offset:36864
  ds_read_b64_tr_b16 a[214:215], v113 offset:38912
  s_waitcnt lgkmcnt(0)
  s_mov_b32 s31, s33
  s_mov_b32 m0, s31
  s_add_u32 s30, s32, 3932160
  s_add_u32 s31, s31, 1024
  buffer_load_dwordx4 v52, s[20:23], s30 offen lds
  s_mov_b32 m0, s31
  s_add_u32 s30, s32, 4128768
  s_add_u32 s31, s31, 1024
  buffer_load_dwordx4 v52, s[20:23], s30 offen lds
  s_mov_b32 m0, s31
  s_add_u32 s30, s32, 3981312
  s_add_u32 s31, s31, 1024
  buffer_load_dwordx4 v52, s[20:23], s30 offen lds
  s_mov_b32 m0, s31
  s_add_u32 s30, s32, 4177920
  s_add_u32 s31, s31, 1024
  buffer_load_dwordx4 v52, s[20:23], s30 offen lds
  s_mov_b32 m0, s31
  s_add_u32 s30, s32, 4325376
  s_add_u32 s31, s31, 1024
  buffer_load_dwordx4 v52, s[20:23], s30 offen lds
  s_mov_b32 m0, s31
  s_add_u32 s30, s32, 4521984
  s_add_u32 s31, s31, 1024
  buffer_load_dwordx4 v52, s[20:23], s30 offen lds
  s_mov_b32 m0, s31
  s_add_u32 s30, s32, 4374528
  s_add_u32 s31, s31, 1024
  buffer_load_dwordx4 v52, s[20:23], s30 offen lds
  s_mov_b32 m0, s31
  s_add_u32 s30, s32, 4571136
  s_add_u32 s31, s31, 1024
  buffer_load_dwordx4 v52, s[20:23], s30 offen lds
  s_mov_b32 m0, s31
  s_add_u32 s30, s32, 4718592
  s_add_u32 s31, s31, 1024
  buffer_load_dwordx4 v52, s[20:23], s30 offen lds
  s_mov_b32 m0, s31
  s_add_u32 s30, s32, 4915200
  s_add_u32 s31, s31, 1024
  buffer_load_dwordx4 v52, s[20:23], s30 offen lds
  s_mov_b32 m0, s31
  s_add_u32 s30, s32, 4767744
  s_add_u32 s31, s31, 1024
  buffer_load_dwordx4 v52, s[20:23], s30 offen lds
  s_mov_b32 m0, s31
  s_add_u32 s30, s32, 4964352
  s_add_u32 s31, s31, 1024
  buffer_load_dwordx4 v52, s[20:23], s30 offen lds
  s_mov_b32 m0, s31
  s_add_u32 s30, s32, 5111808
  s_add_u32 s31, s31, 1024
  buffer_load_dwordx4 v52, s[20:23], s30 offen lds
  s_mov_b32 m0, s31
  s_add_u32 s30, s32, 5308416
  s_add_u32 s31, s31, 1024
  buffer_load_dwordx4 v52, s[20:23], s30 offen lds
  s_mov_b32 m0, s31
  s_add_u32 s30, s32, 5160960
  s_add_u32 s31, s31, 1024
  buffer_load_dwordx4 v52, s[20:23], s30 offen lds
  s_mov_b32 m0, s31
  s_add_u32 s30, s32, 5357568
  s_add_u32 s31, s31, 1024
  buffer_load_dwordx4 v52, s[20:23], s30 offen lds
  s_mov_b32 m0, s31
  s_add_u32 s30, s32, 5505024
  s_add_u32 s31, s31, 1024
  buffer_load_dwordx4 v52, s[20:23], s30 offen lds
  s_mov_b32 m0, s31
  s_add_u32 s30, s32, 5701632
  s_add_u32 s31, s31, 1024
  buffer_load_dwordx4 v52, s[20:23], s30 offen lds
  s_mov_b32 m0, s31
  s_add_u32 s30, s32, 5554176
  s_add_u32 s31, s31, 1024
  buffer_load_dwordx4 v52, s[20:23], s30 offen lds
  s_mov_b32 m0, s31
  s_add_u32 s30, s32, 5750784
  s_add_u32 s31, s31, 1024
  buffer_load_dwordx4 v52, s[20:23], s30 offen lds
  s_mov_b32 m0, s31
  s_add_u32 s30, s32, 5898240
  s_add_u32 s31, s31, 1024
  buffer_load_dwordx4 v52, s[20:23], s30 offen lds
  s_mov_b32 m0, s31
  s_add_u32 s30, s32, 6094848
  s_add_u32 s31, s31, 1024
  buffer_load_dwordx4 v52, s[20:23], s30 offen lds
  s_mov_b32 m0, s31
  s_add_u32 s30, s32, 5947392
  s_add_u32 s31, s31, 1024
  buffer_load_dwordx4 v52, s[20:23], s30 offen lds
  s_mov_b32 m0, s31
  s_add_u32 s30, s32, 6144000
  s_add_u32 s31, s31, 1024
  buffer_load_dwordx4 v52, s[20:23], s30 offen lds
  s_mov_b32 m0, s31
  s_add_u32 s30, s32, 6291456
  s_add_u32 s31, s31, 1024
  buffer_load_dwordx4 v52, s[20:23], s30 offen lds
  s_mov_b32 m0, s31
  s_add_u32 s30, s32, 6488064
  s_add_u32 s31, s31, 1024
  buffer_load_dwordx4 v52, s[20:23], s30 offen lds
  s_mov_b32 m0, s31
  s_add_u32 s30, s32, 6340608
  s_add_u32 s31, s31, 1024
  buffer_load_dwordx4 v52, s[20:23], s30 offen lds
  s_mov_b32 m0, s31
  s_add_u32 s30, s32, 6537216
  s_add_u32 s31, s31, 1024
  buffer_load_dwordx4 v52, s[20:23], s30 offen lds
  s_mov_b32 m0, s31
  s_add_u32 s30, s32, 6684672
  s_add_u32 s31, s31, 1024
  buffer_load_dwordx4 v52, s[20:23], s30 offen lds
  s_mov_b32 m0, s31
  s_add_u32 s30, s32, 6881280
  s_add_u32 s31, s31, 1024
  buffer_load_dwordx4 v52, s[20:23], s30 offen lds
  s_mov_b32 m0, s31
  s_add_u32 s30, s32, 6733824
  s_add_u32 s31, s31, 1024
  buffer_load_dwordx4 v52, s[20:23], s30 offen lds
  s_mov_b32 m0, s31
  s_add_u32 s30, s32, 6930432
  s_add_u32 s31, s31, 1024
  buffer_load_dwordx4 v52, s[20:23], s30 offen lds
  s_mov_b32 m0, s31
  s_add_u32 s30, s32, 7077888
  s_add_u32 s31, s31, 1024
  buffer_load_dwordx4 v52, s[20:23], s30 offen lds
  s_mov_b32 m0, s31
  s_add_u32 s30, s32, 7274496
  s_add_u32 s31, s31, 1024
  buffer_load_dwordx4 v52, s[20:23], s30 offen lds
  s_mov_b32 m0, s31
  s_add_u32 s30, s32, 7127040
  s_add_u32 s31, s31, 1024
  buffer_load_dwordx4 v52, s[20:23], s30 offen lds
  s_mov_b32 m0, s31
  s_add_u32 s30, s32, 7323648
  s_add_u32 s31, s31, 1024
  buffer_load_dwordx4 v52, s[20:23], s30 offen lds
  s_mov_b32 m0, s31
  s_add_u32 s30, s32, 7471104
  s_add_u32 s31, s31, 1024
  buffer_load_dwordx4 v52, s[20:23], s30 offen lds
  s_mov_b32 m0, s31
  s_add_u32 s30, s32, 7667712
  s_add_u32 s31, s31, 1024
  buffer_load_dwordx4 v52, s[20:23], s30 offen lds
  s_mov_b32 m0, s31
  s_add_u32 s30, s32, 7520256
  s_add_u32 s31, s31, 1024
  buffer_load_dwordx4 v52, s[20:23], s30 offen lds
  s_mov_b32 m0, s31
  s_add_u32 s30, s32, 7716864
  s_add_u32 s31, s31, 1024
  buffer_load_dwordx4 v52, s[20:23], s30 offen lds
  s_waitcnt vmcnt(36)
  ds_read_b64_tr_b16 v[232:233], v110 offset:0
  ds_read_b64_tr_b16 v[234:235], v110 offset:2048
  ds_read_b64_tr_b16 a[56:57], v111 offset:0
  ds_read_b64_tr_b16 a[58:59], v111 offset:2048
  ds_read_b64_tr_b16 a[136:137], v112 offset:0
  ds_read_b64_tr_b16 a[138:139], v112 offset:2048
  ds_read_b64_tr_b16 a[216:217], v113 offset:0
  ds_read_b64_tr_b16 a[218:219], v113 offset:2048
  s_waitcnt vmcnt(32)
  ds_read_b64_tr_b16 v[236:237], v110 offset:4096
  ds_read_b64_tr_b16 v[238:239], v110 offset:6144
  ds_read_b64_tr_b16 a[60:61], v111 offset:4096
  ds_read_b64_tr_b16 a[62:63], v111 offset:6144
  ds_read_b64_tr_b16 a[140:141], v112 offset:4096
  ds_read_b64_tr_b16 a[142:143], v112 offset:6144
  ds_read_b64_tr_b16 a[220:221], v113 offset:4096
  ds_read_b64_tr_b16 a[222:223], v113 offset:6144
  s_waitcnt lgkmcnt(0)
  s_waitcnt vmcnt(28)
  ds_read_b64_tr_b16 v[240:241], v110 offset:8192
  ds_read_b64_tr_b16 v[242:243], v110 offset:10240
  ds_read_b64_tr_b16 a[64:65], v111 offset:8192
  ds_read_b64_tr_b16 a[66:67], v111 offset:10240
  ds_read_b64_tr_b16 a[144:145], v112 offset:8192
  ds_read_b64_tr_b16 a[146:147], v112 offset:10240
  ds_read_b64_tr_b16 a[224:225], v113 offset:8192
  ds_read_b64_tr_b16 a[226:227], v113 offset:10240
  s_waitcnt vmcnt(24)
  ds_read_b64_tr_b16 v[244:245], v110 offset:12288
  ds_read_b64_tr_b16 v[246:247], v110 offset:14336
  ds_read_b64_tr_b16 a[68:69], v111 offset:12288
  ds_read_b64_tr_b16 a[70:71], v111 offset:14336
  ds_read_b64_tr_b16 a[148:149], v112 offset:12288
  ds_read_b64_tr_b16 a[150:151], v112 offset:14336
  ds_read_b64_tr_b16 a[228:229], v113 offset:12288
  ds_read_b64_tr_b16 a[230:231], v113 offset:14336
  s_waitcnt lgkmcnt(0)
  s_waitcnt vmcnt(20)
  ds_read_b64_tr_b16 v[248:249], v110 offset:16384
  ds_read_b64_tr_b16 v[250:251], v110 offset:18432
  ds_read_b64_tr_b16 a[72:73], v111 offset:16384
  ds_read_b64_tr_b16 a[74:75], v111 offset:18432
  ds_read_b64_tr_b16 a[152:153], v112 offset:16384
  ds_read_b64_tr_b16 a[154:155], v112 offset:18432
  ds_read_b64_tr_b16 a[232:233], v113 offset:16384
  ds_read_b64_tr_b16 a[234:235], v113 offset:18432
  s_waitcnt vmcnt(16)
  ds_read_b64_tr_b16 v[252:253], v110 offset:20480
  ds_read_b64_tr_b16 v[254:255], v110 offset:22528
  ds_read_b64_tr_b16 a[76:77], v111 offset:20480
  ds_read_b64_tr_b16 a[78:79], v111 offset:22528
  ds_read_b64_tr_b16 a[156:157], v112 offset:20480
  ds_read_b64_tr_b16 a[158:159], v112 offset:22528
  ds_read_b64_tr_b16 a[236:237], v113 offset:20480
  ds_read_b64_tr_b16 a[238:239], v113 offset:22528
  s_waitcnt lgkmcnt(0)
  s_waitcnt vmcnt(12)
  ds_read_b64_tr_b16 a[0:1], v110 offset:24576
  ds_read_b64_tr_b16 a[2:3], v110 offset:26624
  ds_read_b64_tr_b16 a[80:81], v111 offset:24576
  ds_read_b64_tr_b16 a[82:83], v111 offset:26624
  ds_read_b64_tr_b16 a[160:161], v112 offset:24576
  ds_read_b64_tr_b16 a[162:163], v112 offset:26624
  ds_read_b64_tr_b16 a[240:241], v113 offset:24576
  ds_read_b64_tr_b16 a[242:243], v113 offset:26624
  s_waitcnt vmcnt(8)
  ds_read_b64_tr_b16 a[4:5], v110 offset:28672
  ds_read_b64_tr_b16 a[6:7], v110 offset:30720
  ds_read_b64_tr_b16 a[84:85], v111 offset:28672
  ds_read_b64_tr_b16 a[86:87], v111 offset:30720
  ds_read_b64_tr_b16 a[164:165], v112 offset:28672
  ds_read_b64_tr_b16 a[166:167], v112 offset:30720
  ds_read_b64_tr_b16 a[244:245], v113 offset:28672
  ds_read_b64_tr_b16 a[246:247], v113 offset:30720
  s_waitcnt lgkmcnt(0)
  s_waitcnt vmcnt(4)
  ds_read_b64_tr_b16 a[8:9], v110 offset:32768
  ds_read_b64_tr_b16 a[10:11], v110 offset:34816
  ds_read_b64_tr_b16 a[88:89], v111 offset:32768
  ds_read_b64_tr_b16 a[90:91], v111 offset:34816
  ds_read_b64_tr_b16 a[168:169], v112 offset:32768
  ds_read_b64_tr_b16 a[170:171], v112 offset:34816
  ds_read_b64_tr_b16 a[248:249], v113 offset:32768
  ds_read_b64_tr_b16 a[250:251], v113 offset:34816
  s_waitcnt vmcnt(0)
  ds_read_b64_tr_b16 a[12:13], v110 offset:36864
  ds_read_b64_tr_b16 a[14:15], v110 offset:38912
  ds_read_b64_tr_b16 a[92:93], v111 offset:36864
  ds_read_b64_tr_b16 a[94:95], v111 offset:38912
  ds_read_b64_tr_b16 a[172:173], v112 offset:36864
  ds_read_b64_tr_b16 a[174:175], v112 offset:38912
  ds_read_b64_tr_b16 a[252:253], v113 offset:36864
  ds_read_b64_tr_b16 a[254:255], v113 offset:38912
  s_waitcnt lgkmcnt(0)
  v_lshlrev_b32 v100, 4, v1
  v_and_b32 v107, 15, v1
  v_mul_u32_u24 v107, 1280, v107
  v_lshrrev_b32 v108, 4, v1
  v_lshl_add_u32 v107, v108, 4, v107
  s_lshr_b32 s30, s17, 1
  s_mul_i32 s30, s30, 20480
  s_and_b32 s31, s17, 1
  s_mul_i32 s31, s31, 640
  s_add_u32 s30, s30, s31
  v_add_u32 v101, s30, v107
  s_mul_i32 s30, s17, 10240
  v_add_u32 v102, s30, v100
  v_mov_b32 v103, v100
  s_mul_i32 s34, s16, 2621440
  s_add_u32 s34, s34, 247463936
  s_lshl_b32 s30, s16, 8
  v_lshl_add_u32 v105, v1, 2, s30
  v_add_u32 v105, 12288, v105
  s_lshl_b32 s31, s24, 2
  s_add_u32 s30, s30, s31
  s_add_u32 s30, s30, 0
  v_mov_b32 v104, s30
  s_mov_b32 s28, 0
  s_mov_b32 s36, 2
  s_barrier
  s_mov_b32 s29, 0
pw_1:
  buffer_load_dword v106, v105, s[8:11], 0 offen sc1
  s_add_u32 s29, s29, 1
  s_cmp_gt_u32 s29, 65536
  s_cbranch_scc1 role_abort
  s_waitcnt vmcnt(0)
pc_3:
  v_cmp_gt_u32 vcc, s36, v106
  s_nop 0
  s_and_b32 vcc_lo, vcc_lo, 0xffff
  s_and_b32 vcc_hi, vcc_hi, 0x0
  s_cmp_eq_u64 vcc, 0
  s_cbranch_scc1 po_2
  s_sleep 2
  s_branch pw_1
po_2:
  buffer_load_dwordx4 v[52:55], v101, s[8:11], s34 offen offset:0 sc1
  buffer_load_dwordx4 v[56:59], v101, s[8:11], s34 offen offset:64 sc1
  buffer_load_dwordx4 v[60:63], v101, s[8:11], s34 offen offset:128 sc1
  buffer_load_dwordx4 v[64:67], v101, s[8:11], s34 offen offset:192 sc1
  buffer_load_dwordx4 v[68:71], v101, s[8:11], s34 offen offset:256 sc1
  buffer_load_dwordx4 v[72:75], v101, s[8:11], s34 offen offset:320 sc1
  buffer_load_dwordx4 v[76:79], v101, s[8:11], s34 offen offset:384 sc1
  buffer_load_dwordx4 v[80:83], v101, s[8:11], s34 offen offset:448 sc1
  buffer_load_dwordx4 v[84:87], v101, s[8:11], s34 offen offset:512 sc1
  buffer_load_dwordx4 v[88:91], v101, s[8:11], s34 offen offset:576 sc1
  s_waitcnt vmcnt(0)
  ds_write_b128 v102, v[52:55] offset:0
  ds_write_b128 v102, v[56:59] offset:1024
  ds_write_b128 v102, v[60:63] offset:2048
  ds_write_b128 v102, v[64:67] offset:3072
  ds_write_b128 v102, v[68:71] offset:4096
  ds_write_b128 v102, v[72:75] offset:5120
  ds_write_b128 v102, v[76:79] offset:6144
  ds_write_b128 v102, v[80:83] offset:7168
  ds_write_b128 v102, v[84:87] offset:8192
  ds_write_b128 v102, v[88:91] offset:9216
  v_xor_b32 v102, 0x10000, v102
  s_waitcnt lgkmcnt(0)
  s_barrier
p_loop:
  s_add_u32 s36, s36, 2
  s_min_u32 s36, s36, 128
  ds_read_b128 v[36:39], v103 offset:0
  ds_read_b128 v[40:43], v103 offset:1024
  ds_read_b128 v[44:47], v103 offset:2048
  s_waitcnt vmcnt(2)
  s_mov_b32 s29, 0
  s_branch pc_6
pw_4:
  buffer_load_dword v106, v105, s[8:11], 0 offen sc1
  s_add_u32 s29, s29, 1
  s_cmp_gt_u32 s29, 65536
  s_cbranch_scc1 role_abort
  s_waitcnt vmcnt(0)
pc_6:
  v_cmp_gt_u32 vcc, s36, v106
  s_nop 0
  s_and_b32 vcc_lo, vcc_lo, 0xffff
  s_and_b32 vcc_hi, vcc_hi, 0x0
  s_cmp_eq_u64 vcc, 0
  s_cbranch_scc1 po_5
  s_sleep 2
  s_branch pw_4
po_5:
  s_cmp_lt_u32 s28, 63
  s_cselect_b32 s30, 40960, 0
  s_add_u32 s34, s34, s30
  s_sub_u32 s32, s35, 6144
  s_cmp_eq_u32 s28, 0
  s_cselect_b32 s32, s35, s32
  v_mov_b32 v109, s28
  s_waitcnt lgkmcnt(2)
  v_mfma_f32_16x16x32_bf16 v[4:7], v[192:195], v[36:39], 0
  ds_read_b128 v[48:51], v103 offset:3072
  v_mfma_f32_16x16x32_bf16 v[8:11], a[16:19], v[36:39], 0
  v_mfma_f32_16x16x32_bf16 v[12:15], a[96:99], v[36:39], 0
  v_mfma_f32_16x16x32_bf16 v[16:19], a[176:179], v[36:39], 0
  s_waitcnt lgkmcnt(2)
  v_mfma_f32_16x16x32_bf16 v[4:7], v[196:199], v[40:43], v[4:7]
  ds_read_b128 v[36:39], v103 offset:4096
  v_mfma_f32_16x16x32_bf16 v[8:11], a[20:23], v[40:43], v[8:11]
  v_cvt_pk_bf16_f32 v92, v20, v21
  v_mfma_f32_16x16x32_bf16 v[12:15], a[100:103], v[40:43], v[12:15]
  v_cvt_pk_bf16_f32 v93, v22, v23
  v_mfma_f32_16x16x32_bf16 v[16:19], a[180:183], v[40:43], v[16:19]
  s_waitcnt lgkmcnt(2)
  v_mfma_f32_16x16x32_bf16 v[4:7], v[200:203], v[44:47], v[4:7]
  ds_read_b128 v[40:43], v103 offset:5120
  v_mfma_f32_16x16x32_bf16 v[8:11], a[24:27], v[44:47], v[8:11]
  v_cvt_pk_bf16_f32 v94, v24, v25
  v_mfma_f32_16x16x32_bf16 v[12:15], a[104:107], v[44:47], v[12:15]
  v_cvt_pk_bf16_f32 v95, v26, v27
  v_mfma_f32_16x16x32_bf16 v[16:19], a[184:187], v[44:47], v[16:19]
  s_waitcnt lgkmcnt(2)
  v_mfma_f32_16x16x32_bf16 v[4:7], v[204:207], v[48:51], v[4:7]
  ds_read_b128 v[44:47], v103 offset:6144
  v_mfma_f32_16x16x32_bf16 v[8:11], a[28:31], v[48:51], v[8:11]
  buffer_store_dwordx4 v[92:95], v100, s[8:11], s32 offen offset:0
  v_mfma_f32_16x16x32_bf16 v[12:15], a[108:111], v[48:51], v[12:15]
  v_cvt_pk_bf16_f32 v96, v28, v29
  v_mfma_f32_16x16x32_bf16 v[16:19], a[188:191], v[48:51], v[16:19]
  s_waitcnt lgkmcnt(2)
  v_mfma_f32_16x16x32_bf16 v[4:7], v[208:211], v[36:39], v[4:7]
  ds_read_b128 v[48:51], v103 offset:7168
  v_mfma_f32_16x16x32_bf16 v[8:11], a[32:35], v[36:39], v[8:11]
  v_cvt_pk_bf16_f32 v97, v30, v31
  v_mfma_f32_16x16x32_bf16 v[12:15], a[112:115], v[36:39], v[12:15]
  v_cvt_pk_bf16_f32 v98, v32, v33
  v_mfma_f32_16x16x32_bf16 v[16:19], a[192:195], v[36:39], v[16:19]
  s_waitcnt lgkmcnt(2)
  v_mfma_f32_16x16x32_bf16 v[4:7], v[212:215], v[40:43], v[4:7]
  ds_read_b128 v[36:39], v103 offset:8192
  v_mfma_f32_16x16x32_bf16 v[8:11], a[36:39], v[40:43], v[8:11]
  v_cvt_pk_bf16_f32 v99, v34, v35
  v_mfma_f32_16x16x32_bf16 v[12:15], a[116:119], v[40:43], v[12:15]
  buffer_store_dwordx4 v[96:99], v100, s[8:11], s32 offen offset:1024
  v_mfma_f32_16x16x32_bf16 v[16:19], a[196:199], v[40:43], v[16:19]
  s_waitcnt lgkmcnt(2)
  v_mfma_f32_16x16x32_bf16 v[4:7], v[216:219], v[44:47], v[4:7]
  ds_read_b128 v[40:43], v103 offset:9216
  v_mfma_f32_16x16x32_bf16 v[8:11], a[40:43], v[44:47], v[8:11]
  buffer_load_dwordx4 v[52:55], v101, s[8:11], s34 offen offset:0 sc1
  v_mfma_f32_16x16x32_bf16 v[12:15], a[120:123], v[44:47], v[12:15]
  buffer_load_dwordx4 v[56:59], v101, s[8:11], s34 offen offset:64 sc1
  v_mfma_f32_16x16x32_bf16 v[16:19], a[200:203], v[44:47], v[16:19]
  s_waitcnt lgkmcnt(2)
  v_mfma_f32_16x16x32_bf16 v[4:7], v[220:223], v[48:51], v[4:7]
  ds_read_b128 v[44:47], v103 offset:10240
  v_mfma_f32_16x16x32_bf16 v[8:11], a[44:47], v[48:51], v[8:11]
  buffer_load_dwordx4 v[60:63], v101, s[8:11], s34 offen offset:128 sc1
  v_mfma_f32_16x16x32_bf16 v[12:15], a[124:127], v[48:51], v[12:15]
  buffer_load_dwordx4 v[64:67], v101, s[8:11], s34 offen offset:192 sc1
  v_mfma_f32_16x16x32_bf16 v[16:19], a[204:207], v[48:51], v[16:19]
  s_waitcnt lgkmcnt(2)
  v_mfma_f32_16x16x32_bf16 v[4:7], v[224:227], v[36:39], v[4:7]
  ds_read_b128 v[48:51], v103 offset:11264
  v_mfma_f32_16x16x32_bf16 v[8:11], a[48:51], v[36:39], v[8:11]
  buffer_load_dwordx4 v[68:71], v101, s[8:11], s34 offen offset:256 sc1
  v_mfma_f32_16x16x32_bf16 v[12:15], a[128:131], v[36:39], v[12:15]
  buffer_load_dwordx4 v[72:75], v101, s[8:11], s34 offen offset:320 sc1
  v_mfma_f32_16x16x32_bf16 v[16:19], a[208:211], v[36:39], v[16:19]
  s_waitcnt lgkmcnt(2)
  v_mfma_f32_16x16x32_bf16 v[4:7], v[228:231], v[40:43], v[4:7]
  ds_read_b128 v[36:39], v103 offset:12288
  v_mfma_f32_16x16x32_bf16 v[8:11], a[52:55], v[40:43], v[8:11]
  buffer_load_dwordx4 v[76:79], v101, s[8:11], s34 offen offset:384 sc1
  v_mfma_f32_16x16x32_bf16 v[12:15], a[132:135], v[40:43], v[12:15]
  buffer_load_dwordx4 v[80:83], v101, s[8:11], s34 offen offset:448 sc1
  v_mfma_f32_16x16x32_bf16 v[16:19], a[212:215], v[40:43], v[16:19]
  s_waitcnt lgkmcnt(2)
  v_mfma_f32_16x16x32_bf16 v[4:7], v[232:235], v[44:47], v[4:7]
  ds_read_b128 v[40:43], v103 offset:13312
  v_mfma_f32_16x16x32_bf16 v[8:11], a[56:59], v[44:47], v[8:11]
  buffer_load_dwordx4 v[84:87], v101, s[8:11], s34 offen offset:512 sc1
  v_mfma_f32_16x16x32_bf16 v[12:15], a[136:139], v[44:47], v[12:15]
  buffer_load_dwordx4 v[88:91], v101, s[8:11], s34 offen offset:576 sc1
  v_mfma_f32_16x16x32_bf16 v[16:19], a[216:219], v[44:47], v[16:19]
  s_waitcnt lgkmcnt(2)
  v_mfma_f32_16x16x32_bf16 v[4:7], v[236:239], v[48:51], v[4:7]
  ds_read_b128 v[44:47], v103 offset:14336
  v_mfma_f32_16x16x32_bf16 v[8:11], a[60:63], v[48:51], v[8:11]
  v_mfma_f32_16x16x32_bf16 v[12:15], a[140:143], v[48:51], v[12:15]
  v_mfma_f32_16x16x32_bf16 v[16:19], a[220:223], v[48:51], v[16:19]
  s_waitcnt lgkmcnt(2)
  v_mfma_f32_16x16x32_bf16 v[4:7], v[240:243], v[36:39], v[4:7]
  ds_read_b128 v[48:51], v103 offset:15360
  v_mfma_f32_16x16x32_bf16 v[8:11], a[64:67], v[36:39], v[8:11]
  v_mfma_f32_16x16x32_bf16 v[12:15], a[144:147], v[36:39], v[12:15]
  v_mfma_f32_16x16x32_bf16 v[16:19], a[224:227], v[36:39], v[16:19]
  s_waitcnt lgkmcnt(2)
  v_mfma_f32_16x16x32_bf16 v[4:7], v[244:247], v[40:43], v[4:7]
  ds_read_b128 v[36:39], v103 offset:16384
  v_mfma_f32_16x16x32_bf16 v[8:11], a[68:71], v[40:43], v[8:11]
  v_mfma_f32_16x16x32_bf16 v[12:15], a[148:151], v[40:43], v[12:15]
  v_mfma_f32_16x16x32_bf16 v[16:19], a[228:231], v[40:43], v[16:19]
  s_waitcnt lgkmcnt(2)
  v_mfma_f32_16x16x32_bf16 v[4:7], v[248:251], v[44:47], v[4:7]
  ds_read_b128 v[40:43], v103 offset:17408
  v_mfma_f32_16x16x32_bf16 v[8:11], a[72:75], v[44:47], v[8:11]
  v_mfma_f32_16x16x32_bf16 v[12:15], a[152:155], v[44:47], v[12:15]
  v_mfma_f32_16x16x32_bf16 v[16:19], a[232:235], v[44:47], v[16:19]
  s_waitcnt lgkmcnt(2)
  v_mfma_f32_16x16x32_bf16 v[4:7], v[252:255], v[48:51], v[4:7]
  ds_read_b128 v[44:47], v103 offset:18432
  v_mfma_f32_16x16x32_bf16 v[8:11], a[76:79], v[48:51], v[8:11]
  s_waitcnt vmcnt(10)
  v_mfma_f32_16x16x32_bf16 v[12:15], a[156:159], v[48:51], v[12:15]
  buffer_store_dword v109, v104, s[8:11], 0 offen
  v_mfma_f32_16x16x32_bf16 v[16:19], a[236:239], v[48:51], v[16:19]
  s_waitcnt lgkmcnt(2)
  v_mfma_f32_16x16x32_bf16 v[4:7], a[0:3], v[36:39], v[4:7]
  ds_read_b128 v[48:51], v103 offset:19456
  v_mfma_f32_16x16x32_bf16 v[8:11], a[80:83], v[36:39], v[8:11]
  buffer_load_dword v106, v105, s[8:11], 0 offen sc1
  v_mfma_f32_16x16x32_bf16 v[12:15], a[160:163], v[36:39], v[12:15]
  v_mfma_f32_16x16x32_bf16 v[16:19], a[240:243], v[36:39], v[16:19]
  s_waitcnt lgkmcnt(2)
  v_mfma_f32_16x16x32_bf16 v[4:7], a[4:7], v[40:43], v[4:7]
  ds_read_b128 v[36:39], v103 offset:20480
  v_mfma_f32_16x16x32_bf16 v[8:11], a[84:87], v[40:43], v[8:11]
  v_mfma_f32_16x16x32_bf16 v[12:15], a[164:167], v[40:43], v[12:15]
  v_mfma_f32_16x16x32_bf16 v[16:19], a[244:247], v[40:43], v[16:19]
  s_waitcnt lgkmcnt(2)
  v_mfma_f32_16x16x32_bf16 v[4:7], a[8:11], v[44:47], v[4:7]
  ds_read_b128 v[40:43], v103 offset:21504
  v_mfma_f32_16x16x32_bf16 v[8:11], a[88:91], v[44:47], v[8:11]
  v_mfma_f32_16x16x32_bf16 v[12:15], a[168:171], v[44:47], v[12:15]
  v_mfma_f32_16x16x32_bf16 v[16:19], a[248:251], v[44:47], v[16:19]
  s_waitcnt lgkmcnt(2)
  v_mfma_f32_16x16x32_bf16 v[4:7], a[12:15], v[48:51], v[4:7]
  ds_read_b128 v[44:47], v103 offset:22528
  v_mfma_f32_16x16x32_bf16 v[8:11], a[92:95], v[48:51], v[8:11]
  v_mfma_f32_16x16x32_bf16 v[12:15], a[172:175], v[48:51], v[12:15]
  v_mfma_f32_16x16x32_bf16 v[16:19], a[252:255], v[48:51], v[16:19]
  s_waitcnt lgkmcnt(2)
  v_mfma_f32_16x16x32_bf16 v[20:23], v[192:195], v[36:39], 0
  ds_read_b128 v[48:51], v103 offset:23552
  v_mfma_f32_16x16x32_bf16 v[24:27], a[16:19], v[36:39], 0
  v_mfma_f32_16x16x32_bf16 v[28:31], a[96:99], v[36:39], 0
  v_mfma_f32_16x16x32_bf16 v[32:35], a[176:179], v[36:39], 0
  s_waitcnt lgkmcnt(2)
  v_mfma_f32_16x16x32_bf16 v[20:23], v[196:199], v[40:43], v[20:23]
  ds_read_b128 v[36:39], v103 offset:24576
  v_mfma_f32_16x16x32_bf16 v[24:27], a[20:23], v[40:43], v[24:27]
  v_cvt_pk_bf16_f32 v92, v4, v5
  v_mfma_f32_16x16x32_bf16 v[28:31], a[100:103], v[40:43], v[28:31]
  v_cvt_pk_bf16_f32 v93, v6, v7
  v_mfma_f32_16x16x32_bf16 v[32:35], a[180:183], v[40:43], v[32:35]
  s_waitcnt lgkmcnt(2)
  v_mfma_f32_16x16x32_bf16 v[20:23], v[200:203], v[44:47], v[20:23]
  ds_read_b128 v[40:43], v103 offset:25600
  v_mfma_f32_16x16x32_bf16 v[24:27], a[24:27], v[44:47], v[24:27]
  v_cvt_pk_bf16_f32 v94, v8, v9
  v_mfma_f32_16x16x32_bf16 v[28:31], a[104:107], v[44:47], v[28:31]
  v_cvt_pk_bf16_f32 v95, v10, v11
  v_mfma_f32_16x16x32_bf16 v[32:35], a[184:187], v[44:47], v[32:35]
  s_waitcnt lgkmcnt(2)
  v_mfma_f32_16x16x32_bf16 v[20:23], v[204:207], v[48:51], v[20:23]
  ds_read_b128 v[44:47], v103 offset:26624
  v_mfma_f32_16x16x32_bf16 v[24:27], a[28:31], v[48:51], v[24:27]
  buffer_store_dwordx4 v[92:95], v100, s[8:11], s35 offen offset:0
  v_mfma_f32_16x16x32_bf16 v[28:31], a[108:111], v[48:51], v[28:31]
  v_cvt_pk_bf16_f32 v96, v12, v13
  v_mfma_f32_16x16x32_bf16 v[32:35], a[188:191], v[48:51], v[32:35]
  s_waitcnt lgkmcnt(2)
  v_mfma_f32_16x16x32_bf16 v[20:23], v[208:211], v[36:39], v[20:23]
  ds_read_b128 v[48:51], v103 offset:27648
  v_mfma_f32_16x16x32_bf16 v[24:27], a[32:35], v[36:39], v[24:27]
  v_cvt_pk_bf16_f32 v97, v14, v15
  v_mfma_f32_16x16x32_bf16 v[28:31], a[112:115], v[36:39], v[28:31]
  v_cvt_pk_bf16_f32 v98, v16, v17
  v_mfma_f32_16x16x32_bf16 v[32:35], a[192:195], v[36:39], v[32:35]
  s_waitcnt lgkmcnt(2)
  v_mfma_f32_16x16x32_bf16 v[20:23], v[212:215], v[40:43], v[20:23]
  ds_read_b128 v[36:39], v103 offset:28672
  v_mfma_f32_16x16x32_bf16 v[24:27], a[36:39], v[40:43], v[24:27]
  v_cvt_pk_bf16_f32 v99, v18, v19
  v_mfma_f32_16x16x32_bf16 v[28:31], a[116:119], v[40:43], v[28:31]
  buffer_store_dwordx4 v[96:99], v100, s[8:11], s35 offen offset:1024
  v_mfma_f32_16x16x32_bf16 v[32:35], a[196:199], v[40:43], v[32:35]
  s_waitcnt lgkmcnt(2)
  v_mfma_f32_16x16x32_bf16 v[20:23], v[216:219], v[44:47], v[20:23]
  ds_read_b128 v[40:43], v103 offset:29696
  v_mfma_f32_16x16x32_bf16 v[24:27], a[40:43], v[44:47], v[24:27]
  s_waitcnt vmcnt(4)
  v_mfma_f32_16x16x32_bf16 v[28:31], a[120:123], v[44:47], v[28:31]
  ds_write_b128 v102, v[52:55] offset:0
  v_mfma_f32_16x16x32_bf16 v[32:35], a[200:203], v[44:47], v[32:35]
  s_waitcnt lgkmcnt(3)
  v_mfma_f32_16x16x32_bf16 v[20:23], v[220:223], v[48:51], v[20:23]
  ds_read_b128 v[44:47], v103 offset:30720
  v_mfma_f32_16x16x32_bf16 v[24:27], a[44:47], v[48:51], v[24:27]
  ds_write_b128 v102, v[56:59] offset:1024
  v_mfma_f32_16x16x32_bf16 v[28:31], a[124:127], v[48:51], v[28:31]
  ds_write_b128 v102, v[60:63] offset:2048
  v_mfma_f32_16x16x32_bf16 v[32:35], a[204:207], v[48:51], v[32:35]
  s_waitcnt lgkmcnt(5)
  v_mfma_f32_16x16x32_bf16 v[20:23], v[224:227], v[36:39], v[20:23]
  ds_read_b128 v[48:51], v103 offset:31744
  v_mfma_f32_16x16x32_bf16 v[24:27], a[48:51], v[36:39], v[24:27]
  ds_write_b128 v102, v[64:67] offset:3072
  v_mfma_f32_16x16x32_bf16 v[28:31], a[128:131], v[36:39], v[28:31]
  ds_write_b128 v102, v[68:71] offset:4096
  v_mfma_f32_16x16x32_bf16 v[32:35], a[208:211], v[36:39], v[32:35]
  s_waitcnt lgkmcnt(7)
  v_mfma_f32_16x16x32_bf16 v[20:23], v[228:231], v[40:43], v[20:23]
  ds_read_b128 v[36:39], v103 offset:32768
  v_mfma_f32_16x16x32_bf16 v[24:27], a[52:55], v[40:43], v[24:27]
  ds_write_b128 v102, v[72:75] offset:5120
  v_mfma_f32_16x16x32_bf16 v[28:31], a[132:135], v[40:43], v[28:31]
  ds_write_b128 v102, v[76:79] offset:6144
  v_mfma_f32_16x16x32_bf16 v[32:35], a[212:215], v[40:43], v[32:35]
  s_waitcnt lgkmcnt(8)
  v_mfma_f32_16x16x32_bf16 v[20:23], v[232:235], v[44:47], v[20:23]
  ds_read_b128 v[40:43], v103 offset:33792
  v_mfma_f32_16x16x32_bf16 v[24:27], a[56:59], v[44:47], v[24:27]
  ds_write_b128 v102, v[80:83] offset:7168
  v_mfma_f32_16x16x32_bf16 v[28:31], a[136:139], v[44:47], v[28:31]
  ds_write_b128 v102, v[84:87] offset:8192
  v_mfma_f32_16x16x32_bf16 v[32:35], a[216:219], v[44:47], v[32:35]
  s_waitcnt lgkmcnt(8)
  v_mfma_f32_16x16x32_bf16 v[20:23], v[236:239], v[48:51], v[20:23]
  ds_read_b128 v[44:47], v103 offset:34816
  v_mfma_f32_16x16x32_bf16 v[24:27], a[60:63], v[48:51], v[24:27]
  ds_write_b128 v102, v[88:91] offset:9216
  v_mfma_f32_16x16x32_bf16 v[28:31], a[140:143], v[48:51], v[28:31]
  v_mfma_f32_16x16x32_bf16 v[32:35], a[220:223], v[48:51], v[32:35]
  s_waitcnt lgkmcnt(7)
  v_mfma_f32_16x16x32_bf16 v[20:23], v[240:243], v[36:39], v[20:23]
  ds_read_b128 v[48:51], v103 offset:35840
  v_mfma_f32_16x16x32_bf16 v[24:27], a[64:67], v[36:39], v[24:27]
  v_mfma_f32_16x16x32_bf16 v[28:31], a[144:147], v[36:39], v[28:31]
  v_mfma_f32_16x16x32_bf16 v[32:35], a[224:227], v[36:39], v[32:35]
  s_waitcnt lgkmcnt(5)
  v_mfma_f32_16x16x32_bf16 v[20:23], v[244:247], v[40:43], v[20:23]
  ds_read_b128 v[36:39], v103 offset:36864
  v_mfma_f32_16x16x32_bf16 v[24:27], a[68:71], v[40:43], v[24:27]
  v_mfma_f32_16x16x32_bf16 v[28:31], a[148:151], v[40:43], v[28:31]
  v_mfma_f32_16x16x32_bf16 v[32:35], a[228:231], v[40:43], v[32:35]
  s_waitcnt lgkmcnt(3)
  v_mfma_f32_16x16x32_bf16 v[20:23], v[248:251], v[44:47], v[20:23]
  ds_read_b128 v[40:43], v103 offset:37888
  v_mfma_f32_16x16x32_bf16 v[24:27], a[72:75], v[44:47], v[24:27]
  v_mfma_f32_16x16x32_bf16 v[28:31], a[152:155], v[44:47], v[28:31]
  v_mfma_f32_16x16x32_bf16 v[32:35], a[232:235], v[44:47], v[32:35]
  s_waitcnt lgkmcnt(2)
  v_mfma_f32_16x16x32_bf16 v[20:23], v[252:255], v[48:51], v[20:23]
  ds_read_b128 v[44:47], v103 offset:38912
  v_mfma_f32_16x16x32_bf16 v[24:27], a[76:79], v[48:51], v[24:27]
  v_mfma_f32_16x16x32_bf16 v[28:31], a[156:159], v[48:51], v[28:31]
  v_mfma_f32_16x16x32_bf16 v[32:35], a[236:239], v[48:51], v[32:35]
  s_waitcnt lgkmcnt(2)
  v_mfma_f32_16x16x32_bf16 v[20:23], a[0:3], v[36:39], v[20:23]
  ds_read_b128 v[48:51], v103 offset:39936
  v_mfma_f32_16x16x32_bf16 v[24:27], a[80:83], v[36:39], v[24:27]
  v_mfma_f32_16x16x32_bf16 v[28:31], a[160:163], v[36:39], v[28:31]
  v_mfma_f32_16x16x32_bf16 v[32:35], a[240:243], v[36:39], v[32:35]
  s_waitcnt lgkmcnt(2)
  v_mfma_f32_16x16x32_bf16 v[20:23], a[4:7], v[40:43], v[20:23]
  v_mfma_f32_16x16x32_bf16 v[24:27], a[84:87], v[40:43], v[24:27]
  v_mfma_f32_16x16x32_bf16 v[28:31], a[164:167], v[40:43], v[28:31]
  v_mfma_f32_16x16x32_bf16 v[32:35], a[244:247], v[40:43], v[32:35]
  s_waitcnt lgkmcnt(1)
  v_mfma_f32_16x16x32_bf16 v[20:23], a[8:11], v[44:47], v[20:23]
  v_mfma_f32_16x16x32_bf16 v[24:27], a[88:91], v[44:47], v[24:27]
  v_mfma_f32_16x16x32_bf16 v[28:31], a[168:171], v[44:47], v[28:31]
  v_mfma_f32_16x16x32_bf16 v[32:35], a[248:251], v[44:47], v[32:35]
  s_waitcnt lgkmcnt(0)
  v_mfma_f32_16x16x32_bf16 v[20:23], a[12:15], v[48:51], v[20:23]
  v_mfma_f32_16x16x32_bf16 v[24:27], a[92:95], v[48:51], v[24:27]
  v_mfma_f32_16x16x32_bf16 v[28:31], a[172:175], v[48:51], v[28:31]
  v_mfma_f32_16x16x32_bf16 v[32:35], a[252:255], v[48:51], v[32:35]
  s_add_u32 s35, s35, 12288
  v_xor_b32 v102, 0x10000, v102
  v_xor_b32 v103, 0x10000, v103
  s_add_u32 s28, s28, 1
  s_cmp_lt_u32 s28, 64
  s_waitcnt lgkmcnt(0)
  s_barrier
  s_cbranch_scc1 p_loop
  s_sub_u32 s32, s35, 6144
  v_cvt_pk_bf16_f32 v92, v20, v21
  v_cvt_pk_bf16_f32 v93, v22, v23
  v_cvt_pk_bf16_f32 v94, v24, v25
  v_cvt_pk_bf16_f32 v95, v26, v27
  buffer_store_dwordx4 v[92:95], v100, s[8:11], s32 offen offset:0
  v_cvt_pk_bf16_f32 v96, v28, v29
  v_cvt_pk_bf16_f32 v97, v30, v31
  v_cvt_pk_bf16_f32 v98, v32, v33
  v_cvt_pk_bf16_f32 v99, v34, v35
  buffer_store_dwordx4 v[96:99], v100, s[8:11], s32 offen offset:1024
  v_mov_b32 v109, s28
  s_waitcnt vmcnt(0)
  buffer_store_dword v109, v104, s[8:11], 0 offen
  s_branch role_moe
role_moe:
  s_cmp_gt_u32 s18, 14
  s_cbranch_scc1 moe_end
  s_load_dwordx2 s[20:21], s[0:1], 72
  s_mov_b32 s22, 1966080
  s_mov_b32 s23, 0x00020000
  s_load_dwordx2 s[24:25], s[0:1], 80
  s_mov_b32 s26, 1966080
  s_mov_b32 s27, 0x00020000
  s_load_dwordx2 s[28:29], s[0:1], 88
  s_mov_b32 s30, 1966080
  s_mov_b32 s31, 0x00020000
  s_load_dwordx2 s[32:33], s[0:1], 112
  s_mov_b32 s34, 2621440
  s_mov_b32 s35, 0x00020000
  s_mul_i32 s36, s16, 3
  s_add_u32 s36, s36, s18
  s_sub_u32 s36, s36, 12
  s_mul_i32 s41, s17, 40960
  v_lshrrev_b32 v131, 4, v1
  v_and_b32 v131, 3, v131
  v_lshlrev_b32 v131, 1, v131
  v_and_b32 v4, 7, v1
  v_xor_b32 v4, v4, v131
  v_lshlrev_b32 v4, 4, v4
  v_lshrrev_b32 v131, 3, v1
  v_mul_u32_u24 v131, 0, v131
  v_add_u32 v4, v4, v131
  v_lshrrev_b32 v131, 4, v1
  v_and_b32 v131, 3, v131
  v_lshlrev_b32 v131, 1, v131
  v_and_b32 v5, 7, v1
  v_xor_b32 v5, v5, v131
  v_lshlrev_b32 v5, 4, v5
  v_lshrrev_b32 v131, 3, v1
  v_mul_u32_u24 v131, 1280, v131
  v_add_u32 v5, v5, v131
  v_bfe_u32 v131, v1, 3, 2
  v_bfe_u32 v132, v1, 5, 1
  v_lshl_add_u32 v131, v132, 3, v131
  v_mul_u32_u24 v131, 3072, v131
  v_add_u32 v4, v4, v131
  v_lshrrev_b32 v131, 2, v1
  v_lshrrev_b32 v132, 1, v131
  v_and_b32 v132, 3, v132
  v_lshlrev_b32 v132, 1, v132
  v_bfe_u32 v152, v1, 1, 1
  v_add_u32 v152, 0, v152
  v_xor_b32 v152, v152, v132
  v_lshlrev_b32 v152, 4, v152
  v_lshlrev_b32 v131, 7, v131
  v_add_u32 v152, v152, v131
  v_and_b32 v131, 1, v1
  v_lshlrev_b32 v131, 3, v131
  v_add_u32 v152, v152, v131
  v_add_u32 v152, s41, v152
  v_lshrrev_b32 v131, 2, v1
  v_lshrrev_b32 v132, 1, v131
  v_and_b32 v132, 3, v132
  v_lshlrev_b32 v132, 1, v132
  v_bfe_u32 v153, v1, 1, 1
  v_add_u32 v153, 2, v153
  v_xor_b32 v153, v153, v132
  v_lshlrev_b32 v153, 4, v153
  v_lshlrev_b32 v131, 7, v131
  v_add_u32 v153, v153, v131
  v_and_b32 v131, 1, v1
  v_lshlrev_b32 v131, 3, v131
  v_add_u32 v153, v153, v131
  v_add_u32 v153, s41, v153
  v_lshrrev_b32 v131, 2, v1
  v_lshrrev_b32 v132, 1, v131
  v_and_b32 v132, 3, v132
  v_lshlrev_b32 v132, 1, v132
  v_bfe_u32 v154, v1, 1, 1
  v_add_u32 v154, 4, v154
  v_xor_b32 v154, v154, v132
  v_lshlrev_b32 v154, 4, v154
  v_lshlrev_b32 v131, 7, v131
  v_add_u32 v154, v154, v131
  v_and_b32 v131, 1, v1
  v_lshlrev_b32 v131, 3, v131
  v_add_u32 v154, v154, v131
  v_add_u32 v154, s41, v154
  v_lshrrev_b32 v131, 2, v1
  v_lshrrev_b32 v132, 1, v131
  v_and_b32 v132, 3, v132
  v_lshlrev_b32 v132, 1, v132
  v_bfe_u32 v155, v1, 1, 1
  v_add_u32 v155, 6, v155
  v_xor_b32 v155, v155, v132
  v_lshlrev_b32 v155, 4, v155
  v_lshlrev_b32 v131, 7, v131
  v_add_u32 v155, v155, v131
  v_and_b32 v131, 1, v1
  v_lshlrev_b32 v131, 3, v131
  v_add_u32 v155, v155, v131
  v_add_u32 v155, s41, v155
  s_mul_i32 s40, s17, 491520
  s_lshl_b32 s38, s36, 7
  s_add_u32 s40, s40, s38
  s_waitcnt lgkmcnt(0)
  s_barrier
  s_add_u32 m0, s41, 0
  s_add_u32 s38, s40, 0
  buffer_load_dwordx4 v4, s[20:23], s38 offen lds
  s_add_u32 m0, s41, 1024
  s_add_u32 s38, s40, 49152
  buffer_load_dwordx4 v4, s[20:23], s38 offen lds
  s_add_u32 m0, s41, 2048
  s_add_u32 s38, s40, 12288
  buffer_load_dwordx4 v4, s[20:23], s38 offen lds
  s_add_u32 m0, s41, 3072
  s_add_u32 s38, s40, 61440
  buffer_load_dwordx4 v4, s[20:23], s38 offen lds
  s_add_u32 m0, s41, 4096
  s_add_u32 s38, s40, 98304
  buffer_load_dwordx4 v4, s[20:23], s38 offen lds
  s_add_u32 m0, s41, 5120
  s_add_u32 s38, s40, 147456
  buffer_load_dwordx4 v4, s[20:23], s38 offen lds
  s_add_u32 m0, s41, 6144
  s_add_u32 s38, s40, 110592
  buffer_load_dwordx4 v4, s[20:23], s38 offen lds
  s_add_u32 m0, s41, 7168
  s_add_u32 s38, s40, 159744
  buffer_load_dwordx4 v4, s[20:23], s38 offen lds
  s_add_u32 m0, s41, 8192
  s_add_u32 s38, s40, 196608
  buffer_load_dwordx4 v4, s[20:23], s38 offen lds
  s_add_u32 m0, s41, 9216
  s_add_u32 s38, s40, 245760
  buffer_load_dwordx4 v4, s[20:23], s38 offen lds
  s_add_u32 m0, s41, 10240
  s_add_u32 s38, s40, 208896
  buffer_load_dwordx4 v4, s[20:23], s38 offen lds
  s_add_u32 m0, s41, 11264
  s_add_u32 s38, s40, 258048
  buffer_load_dwordx4 v4, s[20:23], s38 offen lds
  s_add_u32 m0, s41, 12288
  s_add_u32 s38, s40, 294912
  buffer_load_dwordx4 v4, s[20:23], s38 offen lds
  s_add_u32 m0, s41, 13312
  s_add_u32 s38, s40, 344064
  buffer_load_dwordx4 v4, s[20:23], s38 offen lds
  s_add_u32 m0, s41, 14336
  s_add_u32 s38, s40, 307200
  buffer_load_dwordx4 v4, s[20:23], s38 offen lds
  s_add_u32 m0, s41, 15360
  s_add_u32 s38, s40, 356352
  buffer_load_dwordx4 v4, s[20:23], s38 offen lds
  s_add_u32 m0, s41, 16384
  s_add_u32 s38, s40, 393216
  buffer_load_dwordx4 v4, s[20:23], s38 offen lds
  s_add_u32 m0, s41, 17408
  s_add_u32 s38, s40, 442368
  buffer_load_dwordx4 v4, s[20:23], s38 offen lds
  s_add_u32 m0, s41, 18432
  s_add_u32 s38, s40, 405504
  buffer_load_dwordx4 v4, s[20:23], s38 offen lds
  s_add_u32 m0, s41, 19456
  s_add_u32 s38, s40, 454656
  buffer_load_dwordx4 v4, s[20:23], s38 offen lds
  s_add_u32 m0, s41, 20480
  s_add_u32 s38, s40, 0
  buffer_load_dwordx4 v4, s[24:27], s38 offen lds
  s_add_u32 m0, s41, 21504
  s_add_u32 s38, s40, 49152
  buffer_load_dwordx4 v4, s[24:27], s38 offen lds
  s_add_u32 m0, s41, 22528
  s_add_u32 s38, s40, 12288
  buffer_load_dwordx4 v4, s[24:27], s38 offen lds
  s_add_u32 m0, s41, 23552
  s_add_u32 s38, s40, 61440
  buffer_load_dwordx4 v4, s[24:27], s38 offen lds
  s_add_u32 m0, s41, 24576
  s_add_u32 s38, s40, 98304
  buffer_load_dwordx4 v4, s[24:27], s38 offen lds
  s_add_u32 m0, s41, 25600
  s_add_u32 s38, s40, 147456
  buffer_load_dwordx4 v4, s[24:27], s38 offen lds
  s_add_u32 m0, s41, 26624
  s_add_u32 s38, s40, 110592
  buffer_load_dwordx4 v4, s[24:27], s38 offen lds
  s_add_u32 m0, s41, 27648
  s_add_u32 s38, s40, 159744
  buffer_load_dwordx4 v4, s[24:27], s38 offen lds
  s_add_u32 m0, s41, 28672
  s_add_u32 s38, s40, 196608
  buffer_load_dwordx4 v4, s[24:27], s38 offen lds
  s_add_u32 m0, s41, 29696
  s_add_u32 s38, s40, 245760
  buffer_load_dwordx4 v4, s[24:27], s38 offen lds
  s_add_u32 m0, s41, 30720
  s_add_u32 s38, s40, 208896
  buffer_load_dwordx4 v4, s[24:27], s38 offen lds
  s_add_u32 m0, s41, 31744
  s_add_u32 s38, s40, 258048
  buffer_load_dwordx4 v4, s[24:27], s38 offen lds
  s_add_u32 m0, s41, 32768
  s_add_u32 s38, s40, 294912
  buffer_load_dwordx4 v4, s[24:27], s38 offen lds
  s_add_u32 m0, s41, 33792
  s_add_u32 s38, s40, 344064
  buffer_load_dwordx4 v4, s[24:27], s38 offen lds
  s_add_u32 m0, s41, 34816
  s_add_u32 s38, s40, 307200
  buffer_load_dwordx4 v4, s[24:27], s38 offen lds
  s_add_u32 m0, s41, 35840
  s_add_u32 s38, s40, 356352
  buffer_load_dwordx4 v4, s[24:27], s38 offen lds
  s_add_u32 m0, s41, 36864
  s_add_u32 s38, s40, 393216
  buffer_load_dwordx4 v4, s[24:27], s38 offen lds
  s_add_u32 m0, s41, 37888
  s_add_u32 s38, s40, 442368
  buffer_load_dwordx4 v4, s[24:27], s38 offen lds
  s_add_u32 m0, s41, 38912
  s_add_u32 s38, s40, 405504
  buffer_load_dwordx4 v4, s[24:27], s38 offen lds
  s_add_u32 m0, s41, 39936
  s_add_u32 s38, s40, 454656
  buffer_load_dwordx4 v4, s[24:27], s38 offen lds
  s_waitcnt vmcnt(36)
  ds_read_b64_tr_b16 a[0:1], v152 offset:0
  ds_read_b64_tr_b16 a[2:3], v152 offset:2048
  ds_read_b64_tr_b16 a[20:21], v153 offset:0
  ds_read_b64_tr_b16 a[22:23], v153 offset:2048
  ds_read_b64_tr_b16 a[40:41], v154 offset:0
  ds_read_b64_tr_b16 a[42:43], v154 offset:2048
  ds_read_b64_tr_b16 a[60:61], v155 offset:0
  ds_read_b64_tr_b16 a[62:63], v155 offset:2048
  s_waitcnt vmcnt(32)
  ds_read_b64_tr_b16 a[4:5], v152 offset:4096
  ds_read_b64_tr_b16 a[6:7], v152 offset:6144
  ds_read_b64_tr_b16 a[24:25], v153 offset:4096
  ds_read_b64_tr_b16 a[26:27], v153 offset:6144
  ds_read_b64_tr_b16 a[44:45], v154 offset:4096
  ds_read_b64_tr_b16 a[46:47], v154 offset:6144
  ds_read_b64_tr_b16 a[64:65], v155 offset:4096
  ds_read_b64_tr_b16 a[66:67], v155 offset:6144
  s_waitcnt lgkmcnt(0)
  s_waitcnt vmcnt(28)
  ds_read_b64_tr_b16 a[8:9], v152 offset:8192
  ds_read_b64_tr_b16 a[10:11], v152 offset:10240
  ds_read_b64_tr_b16 a[28:29], v153 offset:8192
  ds_read_b64_tr_b16 a[30:31], v153 offset:10240
  ds_read_b64_tr_b16 a[48:49], v154 offset:8192
  ds_read_b64_tr_b16 a[50:51], v154 offset:10240
  ds_read_b64_tr_b16 a[68:69], v155 offset:8192
  ds_read_b64_tr_b16 a[70:71], v155 offset:10240
  s_waitcnt vmcnt(24)
  ds_read_b64_tr_b16 a[12:13], v152 offset:12288
  ds_read_b64_tr_b16 a[14:15], v152 offset:14336
  ds_read_b64_tr_b16 a[32:33], v153 offset:12288
  ds_read_b64_tr_b16 a[34:35], v153 offset:14336
  ds_read_b64_tr_b16 a[52:53], v154 offset:12288
  ds_read_b64_tr_b16 a[54:55], v154 offset:14336
  ds_read_b64_tr_b16 a[72:73], v155 offset:12288
  ds_read_b64_tr_b16 a[74:75], v155 offset:14336
  s_waitcnt lgkmcnt(0)
  s_waitcnt vmcnt(20)
  ds_read_b64_tr_b16 a[16:17], v152 offset:16384
  ds_read_b64_tr_b16 a[18:19], v152 offset:18432
  ds_read_b64_tr_b16 a[36:37], v153 offset:16384
  ds_read_b64_tr_b16 a[38:39], v153 offset:18432
  ds_read_b64_tr_b16 a[56:57], v154 offset:16384
  ds_read_b64_tr_b16 a[58:59], v154 offset:18432
  ds_read_b64_tr_b16 a[76:77], v155 offset:16384
  ds_read_b64_tr_b16 a[78:79], v155 offset:18432
  s_waitcnt vmcnt(16)
  ds_read_b64_tr_b16 a[80:81], v152 offset:20480
  ds_read_b64_tr_b16 a[82:83], v152 offset:22528
  ds_read_b64_tr_b16 a[100:101], v153 offset:20480
  ds_read_b64_tr_b16 a[102:103], v153 offset:22528
  ds_read_b64_tr_b16 a[120:121], v154 offset:20480
  ds_read_b64_tr_b16 a[122:123], v154 offset:22528
  ds_read_b64_tr_b16 a[140:141], v155 offset:20480
  ds_read_b64_tr_b16 a[142:143], v155 offset:22528
  s_waitcnt lgkmcnt(0)
  s_waitcnt vmcnt(12)
  ds_read_b64_tr_b16 a[84:85], v152 offset:24576
  ds_read_b64_tr_b16 a[86:87], v152 offset:26624
  ds_read_b64_tr_b16 a[104:105], v153 offset:24576
  ds_read_b64_tr_b16 a[106:107], v153 offset:26624
  ds_read_b64_tr_b16 a[124:125], v154 offset:24576
  ds_read_b64_tr_b16 a[126:127], v154 offset:26624
  ds_read_b64_tr_b16 a[144:145], v155 offset:24576
  ds_read_b64_tr_b16 a[146:147], v155 offset:26624
  s_waitcnt vmcnt(8)
  ds_read_b64_tr_b16 a[88:89], v152 offset:28672
  ds_read_b64_tr_b16 a[90:91], v152 offset:30720
  ds_read_b64_tr_b16 a[108:109], v153 offset:28672
  ds_read_b64_tr_b16 a[110:111], v153 offset:30720
  ds_read_b64_tr_b16 a[128:129], v154 offset:28672
  ds_read_b64_tr_b16 a[130:131], v154 offset:30720
  ds_read_b64_tr_b16 a[148:149], v155 offset:28672
  ds_read_b64_tr_b16 a[150:151], v155 offset:30720
  s_waitcnt lgkmcnt(0)
  s_waitcnt vmcnt(4)
  ds_read_b64_tr_b16 a[92:93], v152 offset:32768
  ds_read_b64_tr_b16 a[94:95], v152 offset:34816
  ds_read_b64_tr_b16 a[112:113], v153 offset:32768
  ds_read_b64_tr_b16 a[114:115], v153 offset:34816
  ds_read_b64_tr_b16 a[132:133], v154 offset:32768
  ds_read_b64_tr_b16 a[134:135], v154 offset:34816
  ds_read_b64_tr_b16 a[152:153], v155 offset:32768
  ds_read_b64_tr_b16 a[154:155], v155 offset:34816
  s_waitcnt vmcnt(0)
  ds_read_b64_tr_b16 a[96:97], v152 offset:36864
  ds_read_b64_tr_b16 a[98:99], v152 offset:38912
  ds_read_b64_tr_b16 a[116:117], v153 offset:36864
  ds_read_b64_tr_b16 a[118:119], v153 offset:38912
  ds_read_b64_tr_b16 a[136:137], v154 offset:36864
  ds_read_b64_tr_b16 a[138:139], v154 offset:38912
  ds_read_b64_tr_b16 a[156:157], v155 offset:36864
  ds_read_b64_tr_b16 a[158:159], v155 offset:38912
  s_waitcnt lgkmcnt(0)
  s_mul_i32 s40, s36, 81920
  s_mul_i32 s38, s17, 320
  s_add_u32 s40, s40, s38
  s_add_u32 m0, s41, 0
  s_add_u32 s38, s40, 0
  buffer_load_dwordx4 v5, s[28:31], s38 offen lds
  s_add_u32 m0, s41, 1024
  s_add_u32 s38, s40, 10240
  buffer_load_dwordx4 v5, s[28:31], s38 offen lds
  s_add_u32 m0, s41, 2048
  s_add_u32 s38, s40, 20480
  buffer_load_dwordx4 v5, s[28:31], s38 offen lds
  s_add_u32 m0, s41, 3072
  s_add_u32 s38, s40, 30720
  buffer_load_dwordx4 v5, s[28:31], s38 offen lds
  s_add_u32 m0, s41, 4096
  s_add_u32 s38, s40, 40960
  buffer_load_dwordx4 v5, s[28:31], s38 offen lds
  s_add_u32 m0, s41, 5120
  s_add_u32 s38, s40, 51200
  buffer_load_dwordx4 v5, s[28:31], s38 offen lds
  s_add_u32 m0, s41, 6144
  s_add_u32 s38, s40, 61440
  buffer_load_dwordx4 v5, s[28:31], s38 offen lds
  s_add_u32 m0, s41, 7168
  s_add_u32 s38, s40, 71680
  buffer_load_dwordx4 v5, s[28:31], s38 offen lds
  s_add_u32 m0, s41, 8192
  s_add_u32 s38, s40, 128
  buffer_load_dwordx4 v5, s[28:31], s38 offen lds
  s_add_u32 m0, s41, 9216
  s_add_u32 s38, s40, 10368
  buffer_load_dwordx4 v5, s[28:31], s38 offen lds
  s_add_u32 m0, s41, 10240
  s_add_u32 s38, s40, 20608
  buffer_load_dwordx4 v5, s[28:31], s38 offen lds
  s_add_u32 m0, s41, 11264
  s_add_u32 s38, s40, 30848
  buffer_load_dwordx4 v5, s[28:31], s38 offen lds
  s_add_u32 m0, s41, 12288
  s_add_u32 s38, s40, 41088
  buffer_load_dwordx4 v5, s[28:31], s38 offen lds
  s_add_u32 m0, s41, 13312
  s_add_u32 s38, s40, 51328
  buffer_load_dwordx4 v5, s[28:31], s38 offen lds
  s_add_u32 m0, s41, 14336
  s_add_u32 s38, s40, 61568
  buffer_load_dwordx4 v5, s[28:31], s38 offen lds
  s_add_u32 m0, s41, 15360
  s_add_u32 s38, s40, 71808
  buffer_load_dwordx4 v5, s[28:31], s38 offen lds
  s_add_u32 m0, s41, 16384
  s_add_u32 s38, s40, 256
  buffer_load_dwordx4 v5, s[28:31], s38 offen lds
  s_add_u32 m0, s41, 17408
  s_add_u32 s38, s40, 10496
  buffer_load_dwordx4 v5, s[28:31], s38 offen lds
  s_add_u32 m0, s41, 18432
  s_add_u32 s38, s40, 20736
  buffer_load_dwordx4 v5, s[28:31], s38 offen lds
  s_add_u32 m0, s41, 19456
  s_add_u32 s38, s40, 30976
  buffer_load_dwordx4 v5, s[28:31], s38 offen lds
  s_add_u32 m0, s41, 20480
  s_add_u32 s38, s40, 41216
  buffer_load_dwordx4 v5, s[28:31], s38 offen lds
  s_add_u32 m0, s41, 21504
  s_add_u32 s38, s40, 51456
  buffer_load_dwordx4 v5, s[28:31], s38 offen lds
  s_add_u32 m0, s41, 22528
  s_add_u32 s38, s40, 61696
  buffer_load_dwordx4 v5, s[28:31], s38 offen lds
  s_add_u32 m0, s41, 23552
  s_add_u32 s38, s40, 71936
  buffer_load_dwordx4 v5, s[28:31], s38 offen lds
  s_waitcnt vmcnt(0)
  ds_read_b64_tr_b16 a[160:161], v152 offset:0
  ds_read_b64_tr_b16 a[162:163], v152 offset:2048
  ds_read_b64_tr_b16 a[164:165], v152 offset:4096
  ds_read_b64_tr_b16 a[166:167], v152 offset:6144
  ds_read_b64_tr_b16 a[168:169], v153 offset:0
  ds_read_b64_tr_b16 a[170:171], v153 offset:2048
  ds_read_b64_tr_b16 a[172:173], v153 offset:4096
  ds_read_b64_tr_b16 a[174:175], v153 offset:6144
  ds_read_b64_tr_b16 a[176:177], v154 offset:0
  ds_read_b64_tr_b16 a[178:179], v154 offset:2048
  ds_read_b64_tr_b16 a[180:181], v154 offset:4096
  ds_read_b64_tr_b16 a[182:183], v154 offset:6144
  s_waitcnt lgkmcnt(0)
  ds_read_b64_tr_b16 a[184:185], v155 offset:0
  ds_read_b64_tr_b16 a[186:187], v155 offset:2048
  ds_read_b64_tr_b16 a[188:189], v155 offset:4096
  ds_read_b64_tr_b16 a[190:191], v155 offset:6144
  ds_read_b64_tr_b16 a[192:193], v152 offset:8192
  ds_read_b64_tr_b16 a[194:195], v152 offset:10240
  ds_read_b64_tr_b16 a[196:197], v152 offset:12288
  ds_read_b64_tr_b16 a[198:199], v152 offset:14336
  ds_read_b64_tr_b16 a[200:201], v153 offset:8192
  ds_read_b64_tr_b16 a[202:203], v153 offset:10240
  ds_read_b64_tr_b16 a[204:205], v153 offset:12288
  ds_read_b64_tr_b16 a[206:207], v153 offset:14336
  s_waitcnt lgkmcnt(0)
  ds_read_b64_tr_b16 a[208:209], v154 offset:8192
  ds_read_b64_tr_b16 a[210:211], v154 offset:10240
  ds_read_b64_tr_b16 a[212:213], v154 offset:12288
  ds_read_b64_tr_b16 a[214:215], v154 offset:14336
  ds_read_b64_tr_b16 a[216:217], v155 offset:8192
  ds_read_b64_tr_b16 a[218:219], v155 offset:10240
  ds_read_b64_tr_b16 a[220:221], v155 offset:12288
  ds_read_b64_tr_b16 a[222:223], v155 offset:14336
  ds_read_b64_tr_b16 a[224:225], v152 offset:16384
  ds_read_b64_tr_b16 a[226:227], v152 offset:18432
  ds_read_b64_tr_b16 a[228:229], v152 offset:20480
  ds_read_b64_tr_b16 a[230:231], v152 offset:22528
  s_waitcnt lgkmcnt(0)
  ds_read_b64_tr_b16 a[232:233], v153 offset:16384
  ds_read_b64_tr_b16 a[234:235], v153 offset:18432
  ds_read_b64_tr_b16 a[236:237], v153 offset:20480
  ds_read_b64_tr_b16 a[238:239], v153 offset:22528
  v_lshlrev_b32 v120, 4, v1
  v_lshrrev_b32 v131, 2, v1
  v_and_b32 v132, 3, v1
  v_lshlrev_b32 v132, 2, v132
  v_lshl_add_u32 v121, v131, 7, v132
  s_lshl_b32 s38, s16, 7
  s_add_u32 s38, s38, 8192
  v_mov_b32 v123, s38
  v_mov_b32 v124, 0
  v_lshrrev_b32 v131, 4, v1
  v_and_b32 v132, 7, v1
  v_lshlrev_b32 v132, 4, v132
  v_lshl_add_u32 v127, v131, 7, v132
  v_lshrrev_b32 v131, 5, v1
  v_mul_u32_u24 v131, 20480, v131
  v_and_b32 v132, 31, v1
  v_lshl_add_u32 v128, v132, 4, v131
  s_mul_i32 s47, s17, 24
  s_add_u32 s47, s47, s36
  s_mov_b32 s42, 0
  s_mov_b32 s44, 2097152
  s_waitcnt lgkmcnt(0)
  s_barrier
  s_mov_b32 s48, 0
  s_mov_b32 s49, 0
  s_mov_b32 s50, 0
  s_mov_b32 s51, 0
  s_mov_b32 s52, 0
  s_mov_b32 s53, 0
  s_mov_b32 s54, 0
  s_mov_b32 s55, 0
moe_chunk:
  s_lshl_b32 s43, s42, 1
  s_add_u32 s43, s43, 3
  s_min_u32 s43, s43, 64
  s_mov_b32 s37, 0
  s_branch pc_9
pw_7:
  buffer_load_dword v124, v123, s[8:11], 0 offen sc1
  s_add_u32 s37, s37, 1
  s_cmp_gt_u32 s37, 65536
  s_cbranch_scc1 role_abort
  s_waitcnt vmcnt(0)
pc_9:
  v_cmp_gt_u32 vcc, s43, v124
  s_nop 0
  s_and_b32 vcc_lo, vcc_lo, 0x1
  s_and_b32 vcc_hi, vcc_hi, 0x0
  s_cmp_eq_u64 vcc, 0
  s_cbranch_scc1 po_8
  s_sleep 8
  s_branch pw_7
po_8:
  s_cmp_lt_u32 s42, 31
  s_cbranch_scc1 moe_kp0
  s_sleep 24
moe_kp0:
  s_mov_b32 s37, 0
moe_kp:
  buffer_load_dword v122, v121, s[8:11], s44 offen sc1
  s_add_u32 s37, s37, 1
  s_cmp_gt_u32 s37, 65536
  s_cbranch_scc1 role_abort
  s_waitcnt vmcnt(0)
  v_cmp_eq_u32 vcc, -1, v122
  s_cbranch_vccz moe_ins
  s_sleep 4
  s_branch moe_kp
moe_ins:
  v_cmp_lt_u32 vcc, s55, v122
  s_cbranch_vccz moe_nx
  s_ff1_i32_b64 s38, vcc
  v_readlane_b32 s45, v122, s38
  v_writelane_b32 v122, 0, s38
  s_min_u32 s46, s48, s45
  s_max_u32 s48, s48, s45
  s_min_u32 s45, s49, s46
  s_max_u32 s49, s49, s46
  s_min_u32 s46, s50, s45
  s_max_u32 s50, s50, s45
  s_min_u32 s45, s51, s46
  s_max_u32 s51, s51, s46
  s_min_u32 s46, s52, s45
  s_max_u32 s52, s52, s45
  s_min_u32 s45, s53, s46
  s_max_u32 s53, s53, s46
  s_min_u32 s46, s54, s45
  s_max_u32 s54, s54, s45
  s_min_u32 s45, s55, s46
  s_max_u32 s55, s55, s46
  s_branch moe_ins
moe_nx:
  s_add_u32 s44, s44, 2048
  s_add_u32 s42, s42, 1
  s_cmp_lt_u32 s42, 32
  s_cbranch_scc1 moe_chunk
  s_mov_b32 exec_lo, 0x1010101
  s_mov_b32 exec_hi, 0x1010101
  v_mov_b32 v125, s48
  s_mov_b32 exec_lo, 0x2020202
  s_mov_b32 exec_hi, 0x2020202
  v_mov_b32 v125, s49
  s_mov_b32 exec_lo, 0x4040404
  s_mov_b32 exec_hi, 0x4040404
  v_mov_b32 v125, s50
  s_mov_b32 exec_lo, 0x8080808
  s_mov_b32 exec_hi, 0x8080808
  v_mov_b32 v125, s51
  s_mov_b32 exec_lo, 0x10101010
  s_mov_b32 exec_hi, 0x10101010
  v_mov_b32 v125, s52
  s_mov_b32 exec_lo, 0x20202020
  s_mov_b32 exec_hi, 0x20202020
  v_mov_b32 v125, s53
  s_mov_b32 exec_lo, 0x40404040
  s_mov_b32 exec_hi, 0x40404040
  v_mov_b32 v125, s54
  s_mov_b32 exec_lo, 0x80808080
  s_mov_b32 exec_hi, 0x80808080
  v_mov_b32 v125, s55
  s_mov_b64 exec, -1
  v_and_b32 v131, 0x7ff, v125
  v_sub_u32 v131, 2047, v131
  v_mul_u32_u24 v129, 1280, v131
  v_lshrrev_b32 v132, 4, v1
  v_lshl_add_u32 v126, v132, 4, v129
  s_mul_i32 s38, s17, 320
  s_add_u32 s38, s38, 8388608
  buffer_load_dwordx4 v[4:7], v126, s[8:11], s38 offen offset:0 sc1
  buffer_load_dwordx4 v[8:11], v126, s[8:11], s38 offen offset:64 sc1
  buffer_load_dwordx4 v[12:15], v126, s[8:11], s38 offen offset:128 sc1
  buffer_load_dwordx4 v[16:19], v126, s[8:11], s38 offen offset:192 sc1
  buffer_load_dwordx4 v[20:23], v126, s[8:11], s38 offen offset:256 sc1
  v_bfe_u32 v132, v1, 3, 2
  s_min_u32 s40, s47, 39
  s_lshl_b32 s39, s40, 5
  v_lshl_add_u32 v133, v132, 3, s39
  v_add_u32 v129, v129, v133
  v_lshlrev_b32 v133, 1, v133
  s_mov_b32 s38, 5242880
  s_mov_b32 s39, 8388608
  s_mov_b32 s45, 78336
  buffer_load_dwordx2 v[136:137], v129, s[8:11], s38 offen sc1
  buffer_load_dwordx2 v[138:139], v129, s[8:11], s39 offen sc1
  buffer_load_dwordx4 v[140:143], v133, s[8:11], s45 offen
  v_and_b32 v131, 0xffff0000, v125
  v_ashrrev_i32 v132, 31, v131
  v_not_b32 v132, v132
  v_or_b32 v132, 0x80000000, v132
  v_and_b32 v132, 0xffff0000, v132
  v_xor_b32 v131, v131, v132
  v_mul_f32 v131, 0xbfb8aa3b, v131
  v_exp_f32 v131, v131
  s_nop 0
  v_add_f32 v131, 1.0, v131
  v_rcp_f32 v131, v131
  s_nop 0
  v_cvt_pk_bf16_f32 v131, v131, v131
  v_lshlrev_b32 v130, 16, v131
  s_lshl_b32 s38, s17, 13
  v_add_u32 v133, s38, v120
  s_lshl_b32 s38, s17, 10
  v_add_u32 v134, s38, v120
  s_waitcnt vmcnt(7)
  v_mfma_f32_16x16x32_bf16 v[24:27], a[0:3], v[4:7], 0
  v_mfma_f32_16x16x32_bf16 v[28:31], a[20:23], v[4:7], 0
  v_mfma_f32_16x16x32_bf16 v[32:35], a[40:43], v[4:7], 0
  v_mfma_f32_16x16x32_bf16 v[36:39], a[60:63], v[4:7], 0
  v_mfma_f32_16x16x32_bf16 v[40:43], a[80:83], v[4:7], 0
  v_mfma_f32_16x16x32_bf16 v[44:47], a[100:103], v[4:7], 0
  v_mfma_f32_16x16x32_bf16 v[48:51], a[120:123], v[4:7], 0
  v_mfma_f32_16x16x32_bf16 v[52:55], a[140:143], v[4:7], 0
  s_waitcnt vmcnt(6)
  v_mfma_f32_16x16x32_bf16 v[24:27], a[4:7], v[8:11], v[24:27]
  v_mfma_f32_16x16x32_bf16 v[28:31], a[24:27], v[8:11], v[28:31]
  v_mfma_f32_16x16x32_bf16 v[32:35], a[44:47], v[8:11], v[32:35]
  v_mfma_f32_16x16x32_bf16 v[36:39], a[64:67], v[8:11], v[36:39]
  v_mfma_f32_16x16x32_bf16 v[40:43], a[84:87], v[8:11], v[40:43]
  v_mfma_f32_16x16x32_bf16 v[44:47], a[104:107], v[8:11], v[44:47]
  v_mfma_f32_16x16x32_bf16 v[48:51], a[124:127], v[8:11], v[48:51]
  v_mfma_f32_16x16x32_bf16 v[52:55], a[144:147], v[8:11], v[52:55]
  s_waitcnt vmcnt(5)
  v_mfma_f32_16x16x32_bf16 v[24:27], a[8:11], v[12:15], v[24:27]
  v_mfma_f32_16x16x32_bf16 v[28:31], a[28:31], v[12:15], v[28:31]
  v_mfma_f32_16x16x32_bf16 v[32:35], a[48:51], v[12:15], v[32:35]
  v_mfma_f32_16x16x32_bf16 v[36:39], a[68:71], v[12:15], v[36:39]
  v_mfma_f32_16x16x32_bf16 v[40:43], a[88:91], v[12:15], v[40:43]
  v_mfma_f32_16x16x32_bf16 v[44:47], a[108:111], v[12:15], v[44:47]
  v_mfma_f32_16x16x32_bf16 v[48:51], a[128:131], v[12:15], v[48:51]
  v_mfma_f32_16x16x32_bf16 v[52:55], a[148:151], v[12:15], v[52:55]
  s_waitcnt vmcnt(4)
  v_mfma_f32_16x16x32_bf16 v[24:27], a[12:15], v[16:19], v[24:27]
  v_mfma_f32_16x16x32_bf16 v[28:31], a[32:35], v[16:19], v[28:31]
  v_mfma_f32_16x16x32_bf16 v[32:35], a[52:55], v[16:19], v[32:35]
  v_mfma_f32_16x16x32_bf16 v[36:39], a[72:75], v[16:19], v[36:39]
  v_mfma_f32_16x16x32_bf16 v[40:43], a[92:95], v[16:19], v[40:43]
  v_mfma_f32_16x16x32_bf16 v[44:47], a[112:115], v[16:19], v[44:47]
  v_mfma_f32_16x16x32_bf16 v[48:51], a[132:135], v[16:19], v[48:51]
  v_mfma_f32_16x16x32_bf16 v[52:55], a[152:155], v[16:19], v[52:55]
  s_waitcnt vmcnt(3)
  v_mfma_f32_16x16x32_bf16 v[24:27], a[16:19], v[20:23], v[24:27]
  v_mfma_f32_16x16x32_bf16 v[28:31], a[36:39], v[20:23], v[28:31]
  v_mfma_f32_16x16x32_bf16 v[32:35], a[56:59], v[20:23], v[32:35]
  v_mfma_f32_16x16x32_bf16 v[36:39], a[76:79], v[20:23], v[36:39]
  v_mfma_f32_16x16x32_bf16 v[40:43], a[96:99], v[20:23], v[40:43]
  v_mfma_f32_16x16x32_bf16 v[44:47], a[116:119], v[20:23], v[44:47]
  v_mfma_f32_16x16x32_bf16 v[48:51], a[136:139], v[20:23], v[48:51]
  v_mfma_f32_16x16x32_bf16 v[52:55], a[156:159], v[20:23], v[52:55]
  s_nop 0
  ds_write_b128 v133, v[24:27] offset:0
  ds_write_b128 v133, v[28:31] offset:1024
  ds_write_b128 v133, v[32:35] offset:2048
  ds_write_b128 v133, v[36:39] offset:3072
  ds_write_b128 v133, v[40:43] offset:4096
  ds_write_b128 v133, v[44:47] offset:5120
  ds_write_b128 v133, v[48:51] offset:6144
  ds_write_b128 v133, v[52:55] offset:7168
  s_waitcnt lgkmcnt(0)
  s_barrier
  ds_read_b128 v[64:67], v134 offset:0
  ds_read_b128 v[80:83], v134 offset:4096
  ds_read_b128 v[68:71], v134 offset:8192
  ds_read_b128 v[84:87], v134 offset:12288
  ds_read_b128 v[72:75], v134 offset:16384
  ds_read_b128 v[88:91], v134 offset:20480
  ds_read_b128 v[76:79], v134 offset:24576
  ds_read_b128 v[92:95], v134 offset:28672
  s_waitcnt lgkmcnt(0)
  v_pk_add_f32 v[64:65], v[64:65], v[68:69]
  v_pk_add_f32 v[72:73], v[72:73], v[76:77]
  v_pk_add_f32 v[66:67], v[66:67], v[70:71]
  v_pk_add_f32 v[74:75], v[74:75], v[78:79]
  v_pk_add_f32 v[64:65], v[64:65], v[72:73]
  v_cvt_pk_bf16_f32 v131, v64, v65
  v_lshlrev_b32 v64, 16, v131
  v_and_b32 v65, 0xffff0000, v131
  v_pk_add_f32 v[66:67], v[66:67], v[74:75]
  v_cvt_pk_bf16_f32 v131, v66, v67
  v_lshlrev_b32 v66, 16, v131
  v_and_b32 v67, 0xffff0000, v131
  v_pk_add_f32 v[80:81], v[80:81], v[84:85]
  v_pk_add_f32 v[88:89], v[88:89], v[92:93]
  v_pk_add_f32 v[82:83], v[82:83], v[86:87]
  v_pk_add_f32 v[90:91], v[90:91], v[94:95]
  v_pk_add_f32 v[80:81], v[80:81], v[88:89]
  v_cvt_pk_bf16_f32 v131, v80, v81
  v_lshlrev_b32 v80, 16, v131
  v_and_b32 v81, 0xffff0000, v131
  v_pk_add_f32 v[82:83], v[82:83], v[90:91]
  v_cvt_pk_bf16_f32 v131, v82, v83
  v_lshlrev_b32 v82, 16, v131
  v_and_b32 v83, 0xffff0000, v131
  v_mul_f32 v148, 0xbfb8aa3b, v64
  v_mul_f32 v149, 0xbfb8aa3b, v65
  v_mul_f32 v150, 0xbfb8aa3b, v66
  v_mul_f32 v151, 0xbfb8aa3b, v67
  v_exp_f32 v148, v148
  v_exp_f32 v149, v149
  v_exp_f32 v150, v150
  v_exp_f32 v151, v151
  v_add_f32 v148, 1.0, v148
  v_add_f32 v149, 1.0, v149
  v_add_f32 v150, 1.0, v150
  v_add_f32 v151, 1.0, v151
  v_rcp_f32 v148, v148
  v_rcp_f32 v149, v149
  v_rcp_f32 v150, v150
  v_rcp_f32 v151, v151
  v_pk_mul_f32 v[64:65], v[64:65], v[148:149]
  v_cvt_pk_bf16_f32 v131, v64, v65
  v_lshlrev_b32 v64, 16, v131
  v_and_b32 v65, 0xffff0000, v131
  v_pk_mul_f32 v[64:65], v[64:65], v[80:81]
  v_cvt_pk_bf16_f32 v148, v64, v65
  v_pk_mul_f32 v[66:67], v[66:67], v[150:151]
  v_cvt_pk_bf16_f32 v131, v66, v67
  v_lshlrev_b32 v66, 16, v131
  v_and_b32 v67, 0xffff0000, v131
  v_pk_mul_f32 v[66:67], v[66:67], v[82:83]
  v_cvt_pk_bf16_f32 v149, v66, v67
  s_lshr_b32 s38, s17, 1
  s_lshl_b32 s38, s38, 10
  s_and_b32 s39, s17, 1
  s_lshl_b32 s39, s39, 3
  s_add_u32 s38, s38, s39
  v_add_u32 v133, s38, v120
  ds_write_b64 v133, v[148:149] offset:32768
  s_waitcnt lgkmcnt(0)
  s_barrier
  ds_read_b128 v[112:115], v120 offset:32768
  ds_read_b128 v[116:119], v120 offset:33792
  s_mul_i32 s38, s36, 20480
  s_mul_i32 s39, s17, 5120
  s_add_u32 s38, s38, s39
  s_add_u32 s38, s38, 2326528
  s_add_u32 s39, s38, 4096
  s_waitcnt lgkmcnt(0)
  v_mfma_f32_16x16x32_bf16 v[24:27], a[160:163], v[112:115], 0
  v_mfma_f32_16x16x32_bf16 v[28:31], a[168:171], v[112:115], 0
  v_mfma_f32_16x16x32_bf16 v[32:35], a[176:179], v[112:115], 0
  v_mfma_f32_16x16x32_bf16 v[36:39], a[184:187], v[112:115], 0
  v_mfma_f32_16x16x32_bf16 v[40:43], a[192:195], v[112:115], 0
  v_mfma_f32_16x16x32_bf16 v[44:47], a[200:203], v[112:115], 0
  v_mfma_f32_16x16x32_bf16 v[48:51], a[208:211], v[112:115], 0
  v_mfma_f32_16x16x32_bf16 v[52:55], a[216:219], v[112:115], 0
  v_mfma_f32_16x16x32_bf16 v[56:59], a[224:227], v[112:115], 0
  v_mfma_f32_16x16x32_bf16 v[60:63], a[232:235], v[112:115], 0
  v_mfma_f32_16x16x32_bf16 v[24:27], a[164:167], v[116:119], v[24:27]
  v_mfma_f32_16x16x32_bf16 v[28:31], a[172:175], v[116:119], v[28:31]
  v_mfma_f32_16x16x32_bf16 v[32:35], a[180:183], v[116:119], v[32:35]
  v_mfma_f32_16x16x32_bf16 v[36:39], a[188:191], v[116:119], v[36:39]
  v_mfma_f32_16x16x32_bf16 v[40:43], a[196:199], v[116:119], v[40:43]
  v_mfma_f32_16x16x32_bf16 v[44:47], a[204:207], v[116:119], v[44:47]
  v_mfma_f32_16x16x32_bf16 v[48:51], a[212:215], v[116:119], v[48:51]
  v_mfma_f32_16x16x32_bf16 v[52:55], a[220:223], v[116:119], v[52:55]
  v_mfma_f32_16x16x32_bf16 v[56:59], a[228:231], v[116:119], v[56:59]
  v_mfma_f32_16x16x32_bf16 v[60:63], a[236:239], v[116:119], v[60:63]
  s_mov_b32 exec_lo, 0x00ff00ff
  s_mov_b32 exec_hi, 0x00ff00ff
  buffer_store_dwordx4 v[24:27], v127, s[8:11], s38 offen offset:0 sc1
  buffer_store_dwordx4 v[28:31], v127, s[8:11], s38 offen offset:512 sc1
  buffer_store_dwordx4 v[32:35], v127, s[8:11], s38 offen offset:1024 sc1
  buffer_store_dwordx4 v[36:39], v127, s[8:11], s38 offen offset:1536 sc1
  buffer_store_dwordx4 v[40:43], v127, s[8:11], s38 offen offset:2048 sc1
  buffer_store_dwordx4 v[44:47], v127, s[8:11], s38 offen offset:2560 sc1
  buffer_store_dwordx4 v[48:51], v127, s[8:11], s38 offen offset:3072 sc1
  buffer_store_dwordx4 v[52:55], v127, s[8:11], s38 offen offset:3584 sc1
  buffer_store_dwordx4 v[56:59], v127, s[8:11], s39 offen offset:0 sc1
  buffer_store_dwordx4 v[60:63], v127, s[8:11], s39 offen offset:512 sc1
  s_mov_b64 exec, -1
  s_cmp_ge_u32 s47, 40
  s_cbranch_scc1 moe_end
  s_lshl_b32 s40, s47, 9
  s_add_u32 s40, s40, 2326528
  s_sleep 8
  s_mov_b32 s37, 0
moe_yp:
  s_mov_b32 s38, s40
  buffer_load_dwordx4 v[64:67], v128, s[8:11], s38 offen sc1
  s_add_u32 s38, s38, 40960
  buffer_load_dwordx4 v[68:71], v128, s[8:11], s38 offen sc1
  s_add_u32 s38, s38, 40960
  buffer_load_dwordx4 v[72:75], v128, s[8:11], s38 offen sc1
  s_add_u32 s38, s38, 40960
  buffer_load_dwordx4 v[76:79], v128, s[8:11], s38 offen sc1
  s_add_u32 s38, s38, 40960
  buffer_load_dwordx4 v[80:83], v128, s[8:11], s38 offen sc1
  s_add_u32 s38, s38, 40960
  buffer_load_dwordx4 v[84:87], v128, s[8:11], s38 offen sc1
  s_add_u32 s38, s38, 40960
  buffer_load_dwordx4 v[88:91], v128, s[8:11], s38 offen sc1
  s_add_u32 s38, s38, 40960
  buffer_load_dwordx4 v[92:95], v128, s[8:11], s38 offen sc1
  s_add_u32 s38, s38, 40960
  buffer_load_dwordx4 v[96:99], v128, s[8:11], s38 offen sc1
  s_add_u32 s38, s38, 40960
  buffer_load_dwordx4 v[100:103], v128, s[8:11], s38 offen sc1
  s_add_u32 s38, s38, 40960
  buffer_load_dwordx4 v[104:107], v128, s[8:11], s38 offen sc1
  s_add_u32 s38, s38, 40960
  buffer_load_dwordx4 v[108:111], v128, s[8:11], s38 offen sc1
  s_add_u32 s38, s38, 40960
  s_add_u32 s37, s37, 1
  s_cmp_gt_u32 s37, 65536
  s_cbranch_scc1 role_abort
  s_waitcnt vmcnt(10)
  v_pk_add_f32 v[144:145], v[64:65], v[68:69]
  v_pk_add_f32 v[146:147], v[66:67], v[70:71]
  s_waitcnt vmcnt(9)
  v_pk_add_f32 v[144:145], v[144:145], v[72:73]
  v_pk_add_f32 v[146:147], v[146:147], v[74:75]
  s_waitcnt vmcnt(8)
  v_pk_add_f32 v[144:145], v[144:145], v[76:77]
  v_pk_add_f32 v[146:147], v[146:147], v[78:79]
  s_waitcnt vmcnt(7)
  v_pk_add_f32 v[144:145], v[144:145], v[80:81]
  v_pk_add_f32 v[146:147], v[146:147], v[82:83]
  s_waitcnt vmcnt(6)
  v_pk_add_f32 v[144:145], v[144:145], v[84:85]
  v_pk_add_f32 v[146:147], v[146:147], v[86:87]
  s_waitcnt vmcnt(5)
  v_pk_add_f32 v[144:145], v[144:145], v[88:89]
  v_pk_add_f32 v[146:147], v[146:147], v[90:91]
  s_waitcnt vmcnt(4)
  v_pk_add_f32 v[144:145], v[144:145], v[92:93]
  v_pk_add_f32 v[146:147], v[146:147], v[94:95]
  s_waitcnt vmcnt(3)
  v_pk_add_f32 v[144:145], v[144:145], v[96:97]
  v_pk_add_f32 v[146:147], v[146:147], v[98:99]
  s_waitcnt vmcnt(2)
  v_pk_add_f32 v[144:145], v[144:145], v[100:101]
  v_pk_add_f32 v[146:147], v[146:147], v[102:103]
  s_waitcnt vmcnt(1)
  v_pk_add_f32 v[144:145], v[144:145], v[104:105]
  v_pk_add_f32 v[146:147], v[146:147], v[106:107]
  s_waitcnt vmcnt(0)
  v_pk_add_f32 v[144:145], v[144:145], v[108:109]
  v_pk_add_f32 v[146:147], v[146:147], v[110:111]
  v_add_f32 v131, v144, v145
  v_add_f32 v132, v146, v147
  v_cmp_u_f32 vcc, v131, v132
  s_cbranch_vccz moe_yok
  s_sleep 2
  s_branch moe_yp
moe_yok:
  v_mov_b32 v148, v144
  v_mov_b32 v149, v145
  v_mov_b32 v150, v146
  v_mov_b32 v151, v147
  v_permlane32_swap_b32 v144, v148
  v_permlane32_swap_b32 v145, v149
  v_permlane32_swap_b32 v146, v150
  v_permlane32_swap_b32 v147, v151
  v_lshlrev_b32 v64, 16, v136
  v_and_b32 v65, 0xffff0000, v136
  v_lshlrev_b32 v68, 16, v138
  v_and_b32 v69, 0xffff0000, v138
  v_lshlrev_b32 v66, 16, v137
  v_and_b32 v67, 0xffff0000, v137
  v_lshlrev_b32 v70, 16, v139
  v_and_b32 v71, 0xffff0000, v139
  v_pk_add_f32 v[144:145], v[144:145], v[148:149]
  v_cvt_pk_bf16_f32 v131, v144, v145
  v_lshlrev_b32 v144, 16, v131
  v_and_b32 v145, 0xffff0000, v131
  v_mul_f32 v144, v144, v130
  v_mul_f32 v145, v145, v130
  v_cvt_pk_bf16_f32 v131, v144, v145
  v_lshlrev_b32 v144, 16, v131
  v_and_b32 v145, 0xffff0000, v131
  v_pk_add_f32 v[144:145], v[144:145], v[68:69]
  v_cvt_pk_bf16_f32 v131, v144, v145
  v_lshlrev_b32 v144, 16, v131
  v_and_b32 v145, 0xffff0000, v131
  v_pk_mul_f32 v[144:145], v[144:145], v[140:141]
  v_cvt_pk_bf16_f32 v131, v144, v145
  v_lshlrev_b32 v144, 16, v131
  v_and_b32 v145, 0xffff0000, v131
  v_pk_add_f32 v[144:145], v[144:145], v[64:65]
  v_cvt_pk_bf16_f32 v148, v144, v145
  v_pk_add_f32 v[146:147], v[146:147], v[150:151]
  v_cvt_pk_bf16_f32 v131, v146, v147
  v_lshlrev_b32 v146, 16, v131
  v_and_b32 v147, 0xffff0000, v131
  v_mul_f32 v146, v146, v130
  v_mul_f32 v147, v147, v130
  v_cvt_pk_bf16_f32 v131, v146, v147
  v_lshlrev_b32 v146, 16, v131
  v_and_b32 v147, 0xffff0000, v131
  v_pk_add_f32 v[146:147], v[146:147], v[70:71]
  v_cvt_pk_bf16_f32 v131, v146, v147
  v_lshlrev_b32 v146, 16, v131
  v_and_b32 v147, 0xffff0000, v131
  v_pk_mul_f32 v[146:147], v[146:147], v[142:143]
  v_cvt_pk_bf16_f32 v131, v146, v147
  v_lshlrev_b32 v146, 16, v131
  v_and_b32 v147, 0xffff0000, v131
  v_pk_add_f32 v[146:147], v[146:147], v[66:67]
  v_cvt_pk_bf16_f32 v149, v146, v147
  s_mov_b32 exec_hi, 0
  buffer_store_dwordx2 v[148:149], v129, s[32:35], 0 offen sc1
moe_end:
  s_endpgm
role_ua:
  s_load_dwordx2 s[20:21], s[0:1], 40
  s_mov_b32 s22, 7864320
  s_mov_b32 s23, 0x00020000
  s_sub_u32 s24, s18, 21
  s_lshl_b32 s25, s16, 2
  s_add_u32 s25, s25, s17
  s_lshl_b32 s35, s24, 2
  s_add_u32 s35, s35, s17
  v_lshrrev_b32 v222, 4, v1
  v_and_b32 v222, 3, v222
  v_lshlrev_b32 v222, 1, v222
  v_and_b32 v4, 7, v1
  v_xor_b32 v4, v4, v222
  v_lshlrev_b32 v4, 4, v4
  v_lshrrev_b32 v222, 3, v1
  v_mul_u32_u24 v222, 1280, v222
  v_add_u32 v4, v4, v222
  s_mul_i32 s31, s17, 40960
  v_lshrrev_b32 v222, 2, v1
  v_lshrrev_b32 v223, 1, v222
  v_and_b32 v223, 3, v223
  v_lshlrev_b32 v223, 1, v223
  v_bfe_u32 v226, v1, 1, 1
  v_add_u32 v226, 0, v226
  v_xor_b32 v226, v226, v223
  v_lshlrev_b32 v226, 4, v226
  v_lshlrev_b32 v222, 7, v222
  v_add_u32 v226, v226, v222
  v_and_b32 v222, 1, v1
  v_lshlrev_b32 v222, 3, v222
  v_add_u32 v226, v226, v222
  v_add_u32 v226, s31, v226
  v_lshrrev_b32 v222, 2, v1
  v_lshrrev_b32 v223, 1, v222
  v_and_b32 v223, 3, v223
  v_lshlrev_b32 v223, 1, v223
  v_bfe_u32 v227, v1, 1, 1
  v_add_u32 v227, 2, v227
  v_xor_b32 v227, v227, v223
  v_lshlrev_b32 v227, 4, v227
  v_lshlrev_b32 v222, 7, v222
  v_add_u32 v227, v227, v222
  v_and_b32 v222, 1, v1
  v_lshlrev_b32 v222, 3, v222
  v_add_u32 v227, v227, v222
  v_add_u32 v227, s31, v227
  v_lshrrev_b32 v222, 2, v1
  v_lshrrev_b32 v223, 1, v222
  v_and_b32 v223, 3, v223
  v_lshlrev_b32 v223, 1, v223
  v_bfe_u32 v228, v1, 1, 1
  v_add_u32 v228, 4, v228
  v_xor_b32 v228, v228, v223
  v_lshlrev_b32 v228, 4, v228
  v_lshlrev_b32 v222, 7, v222
  v_add_u32 v228, v228, v222
  v_and_b32 v222, 1, v1
  v_lshlrev_b32 v222, 3, v222
  v_add_u32 v228, v228, v222
  v_add_u32 v228, s31, v228
  v_lshrrev_b32 v222, 2, v1
  v_lshrrev_b32 v223, 1, v222
  v_and_b32 v223, 3, v223
  v_lshlrev_b32 v223, 1, v223
  v_bfe_u32 v229, v1, 1, 1
  v_add_u32 v229, 6, v229
  v_xor_b32 v229, v229, v223
  v_lshlrev_b32 v229, 4, v229
  v_lshlrev_b32 v222, 7, v222
  v_add_u32 v229, v229, v222
  v_and_b32 v222, 1, v1
  v_lshlrev_b32 v222, 3, v222
  v_add_u32 v229, v229, v222
  v_add_u32 v229, s31, v229
  s_mul_i32 s30, s25, 245760
  s_lshl_b32 s28, s24, 8
  s_add_u32 s30, s30, s28
  s_waitcnt lgkmcnt(0)
  s_add_u32 m0, s31, 0
  s_add_u32 s28, s30, 0
  buffer_load_dwordx4 v4, s[20:23], s28 offen lds
  s_add_u32 m0, s31, 1024
  s_add_u32 s28, s30, 10240
  buffer_load_dwordx4 v4, s[20:23], s28 offen lds
  s_add_u32 m0, s31, 2048
  s_add_u32 s28, s30, 20480
  buffer_load_dwordx4 v4, s[20:23], s28 offen lds
  s_add_u32 m0, s31, 3072
  s_add_u32 s28, s30, 30720
  buffer_load_dwordx4 v4, s[20:23], s28 offen lds
  s_add_u32 m0, s31, 4096
  s_add_u32 s28, s30, 40960
  buffer_load_dwordx4 v4, s[20:23], s28 offen lds
  s_add_u32 m0, s31, 5120
  s_add_u32 s28, s30, 51200
  buffer_load_dwordx4 v4, s[20:23], s28 offen lds
  s_add_u32 m0, s31, 6144
  s_add_u32 s28, s30, 61440
  buffer_load_dwordx4 v4, s[20:23], s28 offen lds
  s_add_u32 m0, s31, 7168
  s_add_u32 s28, s30, 71680
  buffer_load_dwordx4 v4, s[20:23], s28 offen lds
  s_add_u32 m0, s31, 8192
  s_add_u32 s28, s30, 81920
  buffer_load_dwordx4 v4, s[20:23], s28 offen lds
  s_add_u32 m0, s31, 9216
  s_add_u32 s28, s30, 92160
  buffer_load_dwordx4 v4, s[20:23], s28 offen lds
  s_add_u32 m0, s31, 10240
  s_add_u32 s28, s30, 102400
  buffer_load_dwordx4 v4, s[20:23], s28 offen lds
  s_add_u32 m0, s31, 11264
  s_add_u32 s28, s30, 112640
  buffer_load_dwordx4 v4, s[20:23], s28 offen lds
  s_add_u32 m0, s31, 12288
  s_add_u32 s28, s30, 122880
  buffer_load_dwordx4 v4, s[20:23], s28 offen lds
  s_add_u32 m0, s31, 13312
  s_add_u32 s28, s30, 133120
  buffer_load_dwordx4 v4, s[20:23], s28 offen lds
  s_add_u32 m0, s31, 14336
  s_add_u32 s28, s30, 143360
  buffer_load_dwordx4 v4, s[20:23], s28 offen lds
  s_add_u32 m0, s31, 15360
  s_add_u32 s28, s30, 153600
  buffer_load_dwordx4 v4, s[20:23], s28 offen lds
  s_add_u32 m0, s31, 16384
  s_add_u32 s28, s30, 163840
  buffer_load_dwordx4 v4, s[20:23], s28 offen lds
  s_add_u32 m0, s31, 17408
  s_add_u32 s28, s30, 174080
  buffer_load_dwordx4 v4, s[20:23], s28 offen lds
  s_add_u32 m0, s31, 18432
  s_add_u32 s28, s30, 184320
  buffer_load_dwordx4 v4, s[20:23], s28 offen lds
  s_add_u32 m0, s31, 19456
  s_add_u32 s28, s30, 194560
  buffer_load_dwordx4 v4, s[20:23], s28 offen lds
  s_add_u32 m0, s31, 20480
  s_add_u32 s28, s30, 204800
  buffer_load_dwordx4 v4, s[20:23], s28 offen lds
  s_add_u32 m0, s31, 21504
  s_add_u32 s28, s30, 215040
  buffer_load_dwordx4 v4, s[20:23], s28 offen lds
  s_add_u32 m0, s31, 22528
  s_add_u32 s28, s30, 225280
  buffer_load_dwordx4 v4, s[20:23], s28 offen lds
  s_add_u32 m0, s31, 23552
  s_add_u32 s28, s30, 235520
  buffer_load_dwordx4 v4, s[20:23], s28 offen lds
  s_add_u32 m0, s31, 24576
  s_add_u32 s28, s30, 128
  buffer_load_dwordx4 v4, s[20:23], s28 offen lds
  s_add_u32 m0, s31, 25600
  s_add_u32 s28, s30, 10368
  buffer_load_dwordx4 v4, s[20:23], s28 offen lds
  s_add_u32 m0, s31, 26624
  s_add_u32 s28, s30, 20608
  buffer_load_dwordx4 v4, s[20:23], s28 offen lds
  s_add_u32 m0, s31, 27648
  s_add_u32 s28, s30, 30848
  buffer_load_dwordx4 v4, s[20:23], s28 offen lds
  s_add_u32 m0, s31, 28672
  s_add_u32 s28, s30, 41088
  buffer_load_dwordx4 v4, s[20:23], s28 offen lds
  s_add_u32 m0, s31, 29696
  s_add_u32 s28, s30, 51328
  buffer_load_dwordx4 v4, s[20:23], s28 offen lds
  s_add_u32 m0, s31, 30720
  s_add_u32 s28, s30, 61568
  buffer_load_dwordx4 v4, s[20:23], s28 offen lds
  s_add_u32 m0, s31, 31744
  s_add_u32 s28, s30, 71808
  buffer_load_dwordx4 v4, s[20:23], s28 offen lds
  s_add_u32 m0, s31, 32768
  s_add_u32 s28, s30, 82048
  buffer_load_dwordx4 v4, s[20:23], s28 offen lds
  s_add_u32 m0, s31, 33792
  s_add_u32 s28, s30, 92288
  buffer_load_dwordx4 v4, s[20:23], s28 offen lds
  s_add_u32 m0, s31, 34816
  s_add_u32 s28, s30, 102528
  buffer_load_dwordx4 v4, s[20:23], s28 offen lds
  s_add_u32 m0, s31, 35840
  s_add_u32 s28, s30, 112768
  buffer_load_dwordx4 v4, s[20:23], s28 offen lds
  s_add_u32 m0, s31, 36864
  s_add_u32 s28, s30, 123008
  buffer_load_dwordx4 v4, s[20:23], s28 offen lds
  s_add_u32 m0, s31, 37888
  s_add_u32 s28, s30, 133248
  buffer_load_dwordx4 v4, s[20:23], s28 offen lds
  s_add_u32 m0, s31, 38912
  s_add_u32 s28, s30, 143488
  buffer_load_dwordx4 v4, s[20:23], s28 offen lds
  s_add_u32 m0, s31, 39936
  s_add_u32 s28, s30, 153728
  buffer_load_dwordx4 v4, s[20:23], s28 offen lds
  s_waitcnt vmcnt(36)
  ds_read_b64_tr_b16 a[0:1], v226 offset:0
  ds_read_b64_tr_b16 a[2:3], v226 offset:2048
  ds_read_b64_tr_b16 a[24:25], v227 offset:0
  ds_read_b64_tr_b16 a[26:27], v227 offset:2048
  ds_read_b64_tr_b16 a[48:49], v228 offset:0
  ds_read_b64_tr_b16 a[50:51], v228 offset:2048
  ds_read_b64_tr_b16 a[72:73], v229 offset:0
  ds_read_b64_tr_b16 a[74:75], v229 offset:2048
  s_waitcnt vmcnt(32)
  ds_read_b64_tr_b16 a[4:5], v226 offset:4096
  ds_read_b64_tr_b16 a[6:7], v226 offset:6144
  ds_read_b64_tr_b16 a[28:29], v227 offset:4096
  ds_read_b64_tr_b16 a[30:31], v227 offset:6144
  ds_read_b64_tr_b16 a[52:53], v228 offset:4096
  ds_read_b64_tr_b16 a[54:55], v228 offset:6144
  ds_read_b64_tr_b16 a[76:77], v229 offset:4096
  ds_read_b64_tr_b16 a[78:79], v229 offset:6144
  s_waitcnt lgkmcnt(0)
  s_waitcnt vmcnt(28)
  ds_read_b64_tr_b16 a[8:9], v226 offset:8192
  ds_read_b64_tr_b16 a[10:11], v226 offset:10240
  ds_read_b64_tr_b16 a[32:33], v227 offset:8192
  ds_read_b64_tr_b16 a[34:35], v227 offset:10240
  ds_read_b64_tr_b16 a[56:57], v228 offset:8192
  ds_read_b64_tr_b16 a[58:59], v228 offset:10240
  ds_read_b64_tr_b16 a[80:81], v229 offset:8192
  ds_read_b64_tr_b16 a[82:83], v229 offset:10240
  s_waitcnt vmcnt(24)
  ds_read_b64_tr_b16 a[12:13], v226 offset:12288
  ds_read_b64_tr_b16 a[14:15], v226 offset:14336
  ds_read_b64_tr_b16 a[36:37], v227 offset:12288
  ds_read_b64_tr_b16 a[38:39], v227 offset:14336
  ds_read_b64_tr_b16 a[60:61], v228 offset:12288
  ds_read_b64_tr_b16 a[62:63], v228 offset:14336
  ds_read_b64_tr_b16 a[84:85], v229 offset:12288
  ds_read_b64_tr_b16 a[86:87], v229 offset:14336
  s_waitcnt vmcnt(20)
  ds_read_b64_tr_b16 a[16:17], v226 offset:16384
  ds_read_b64_tr_b16 a[18:19], v226 offset:18432
  ds_read_b64_tr_b16 a[40:41], v227 offset:16384
  ds_read_b64_tr_b16 a[42:43], v227 offset:18432
  ds_read_b64_tr_b16 a[64:65], v228 offset:16384
  ds_read_b64_tr_b16 a[66:67], v228 offset:18432
  ds_read_b64_tr_b16 a[88:89], v229 offset:16384
  ds_read_b64_tr_b16 a[90:91], v229 offset:18432
  s_waitcnt vmcnt(16)
  ds_read_b64_tr_b16 a[20:21], v226 offset:20480
  ds_read_b64_tr_b16 a[22:23], v226 offset:22528
  ds_read_b64_tr_b16 a[44:45], v227 offset:20480
  ds_read_b64_tr_b16 a[46:47], v227 offset:22528
  ds_read_b64_tr_b16 a[68:69], v228 offset:20480
  ds_read_b64_tr_b16 a[70:71], v228 offset:22528
  ds_read_b64_tr_b16 a[92:93], v229 offset:20480
  ds_read_b64_tr_b16 a[94:95], v229 offset:22528
  s_waitcnt lgkmcnt(0)
  s_add_u32 m0, s31, 0
  s_add_u32 s28, s30, 163968
  buffer_load_dwordx4 v4, s[20:23], s28 offen lds
  s_add_u32 m0, s31, 1024
  s_add_u32 s28, s30, 174208
  buffer_load_dwordx4 v4, s[20:23], s28 offen lds
  s_add_u32 m0, s31, 2048
  s_add_u32 s28, s30, 184448
  buffer_load_dwordx4 v4, s[20:23], s28 offen lds
  s_add_u32 m0, s31, 3072
  s_add_u32 s28, s30, 194688
  buffer_load_dwordx4 v4, s[20:23], s28 offen lds
  s_add_u32 m0, s31, 4096
  s_add_u32 s28, s30, 204928
  buffer_load_dwordx4 v4, s[20:23], s28 offen lds
  s_add_u32 m0, s31, 5120
  s_add_u32 s28, s30, 215168
  buffer_load_dwordx4 v4, s[20:23], s28 offen lds
  s_add_u32 m0, s31, 6144
  s_add_u32 s28, s30, 225408
  buffer_load_dwordx4 v4, s[20:23], s28 offen lds
  s_add_u32 m0, s31, 7168
  s_add_u32 s28, s30, 235648
  buffer_load_dwordx4 v4, s[20:23], s28 offen lds
  s_waitcnt vmcnt(20)
  ds_read_b64_tr_b16 a[96:97], v226 offset:24576
  ds_read_b64_tr_b16 a[98:99], v226 offset:26624
  ds_read_b64_tr_b16 a[120:121], v227 offset:24576
  ds_read_b64_tr_b16 a[122:123], v227 offset:26624
  ds_read_b64_tr_b16 a[144:145], v228 offset:24576
  ds_read_b64_tr_b16 a[146:147], v228 offset:26624
  ds_read_b64_tr_b16 a[168:169], v229 offset:24576
  ds_read_b64_tr_b16 a[170:171], v229 offset:26624
  s_waitcnt vmcnt(16)
  ds_read_b64_tr_b16 a[100:101], v226 offset:28672
  ds_read_b64_tr_b16 a[102:103], v226 offset:30720
  ds_read_b64_tr_b16 a[124:125], v227 offset:28672
  ds_read_b64_tr_b16 a[126:127], v227 offset:30720
  ds_read_b64_tr_b16 a[148:149], v228 offset:28672
  ds_read_b64_tr_b16 a[150:151], v228 offset:30720
  ds_read_b64_tr_b16 a[172:173], v229 offset:28672
  ds_read_b64_tr_b16 a[174:175], v229 offset:30720
  s_waitcnt lgkmcnt(0)
  s_waitcnt vmcnt(12)
  ds_read_b64_tr_b16 a[104:105], v226 offset:32768
  ds_read_b64_tr_b16 a[106:107], v226 offset:34816
  ds_read_b64_tr_b16 a[128:129], v227 offset:32768
  ds_read_b64_tr_b16 a[130:131], v227 offset:34816
  ds_read_b64_tr_b16 a[152:153], v228 offset:32768
  ds_read_b64_tr_b16 a[154:155], v228 offset:34816
  ds_read_b64_tr_b16 a[176:177], v229 offset:32768
  ds_read_b64_tr_b16 a[178:179], v229 offset:34816
  s_waitcnt vmcnt(8)
  ds_read_b64_tr_b16 a[108:109], v226 offset:36864
  ds_read_b64_tr_b16 a[110:111], v226 offset:38912
  ds_read_b64_tr_b16 a[132:133], v227 offset:36864
  ds_read_b64_tr_b16 a[134:135], v227 offset:38912
  ds_read_b64_tr_b16 a[156:157], v228 offset:36864
  ds_read_b64_tr_b16 a[158:159], v228 offset:38912
  ds_read_b64_tr_b16 a[180:181], v229 offset:36864
  ds_read_b64_tr_b16 a[182:183], v229 offset:38912
  s_waitcnt lgkmcnt(0)
  s_waitcnt vmcnt(4)
  ds_read_b64_tr_b16 a[112:113], v226 offset:0
  ds_read_b64_tr_b16 a[114:115], v226 offset:2048
  ds_read_b64_tr_b16 a[136:137], v227 offset:0
  ds_read_b64_tr_b16 a[138:139], v227 offset:2048
  ds_read_b64_tr_b16 a[160:161], v228 offset:0
  ds_read_b64_tr_b16 a[162:163], v228 offset:2048
  ds_read_b64_tr_b16 a[184:185], v229 offset:0
  ds_read_b64_tr_b16 a[186:187], v229 offset:2048
  s_waitcnt vmcnt(0)
  ds_read_b64_tr_b16 a[116:117], v226 offset:4096
  ds_read_b64_tr_b16 a[118:119], v226 offset:6144
  ds_read_b64_tr_b16 a[140:141], v227 offset:4096
  ds_read_b64_tr_b16 a[142:143], v227 offset:6144
  ds_read_b64_tr_b16 a[164:165], v228 offset:4096
  ds_read_b64_tr_b16 a[166:167], v228 offset:6144
  ds_read_b64_tr_b16 a[188:189], v229 offset:4096
  ds_read_b64_tr_b16 a[190:191], v229 offset:6144
  s_waitcnt lgkmcnt(0)
  v_lshlrev_b32 v212, 4, v1
  v_bfe_u32 v222, v1, 2, 1
  v_and_b32 v223, 3, v1
  v_lshl_add_u32 v222, v222, 3, v223
  v_lshrrev_b32 v223, 4, v1
  v_lshl_add_u32 v222, v223, 4, v222
  v_lshlrev_b32 v214, 4, v222
  v_bfe_u32 v223, v1, 3, 1
  v_lshl_add_u32 v213, v223, 10, v214
  v_cmp_eq_u32 s[42:43], 1, v223
  v_and_b32 v222, 15, v1
  v_mul_u32_u24 v222, 1280, v222
  v_lshrrev_b32 v223, 4, v1
  v_lshl_add_u32 v215, v223, 4, v222
  s_lshl_b32 s28, s16, 8
  v_lshl_add_u32 v218, v1, 2, s28
  v_add_u32 v219, 16384, v218
  s_mul_i32 s29, s17, 12
  s_add_u32 s29, s29, 96
  v_add_u32 v218, s29, v218
  s_lshl_b32 s29, s35, 2
  s_add_u32 s28, s28, s29
  s_add_u32 s28, s28, 144
  v_mov_b32 v216, s28
  s_lshl_b32 s28, s16, 7
  s_add_u32 s28, s28, s29
  s_add_u32 s28, s28, 8192
  v_mov_b32 v217, s28
  s_mul_i32 s32, s25, 786432
  s_add_u32 s32, s32, 117440512
  s_mul_i32 s33, s25, 2621440
  s_lshl_b32 s28, s24, 13
  s_add_u32 s33, s33, s28
  s_add_u32 s33, s33, 142606336
  s_mul_i32 s36, s16, 10485760
  s_lshl_b32 s28, s35, 11
  s_add_u32 s36, s36, s28
  s_add_u32 s36, s36, 142606336
  s_mul_i32 s37, s16, 524288
  s_add_u32 s37, s37, 47185920
  s_mul_i32 s38, s16, 2621440
  s_lshr_b32 s28, s35, 1
  s_lshl_b32 s28, s28, 10
  s_add_u32 s38, s38, s28
  s_and_b32 s28, s35, 1
  s_lshl_b32 s28, s28, 3
  s_add_u32 s38, s38, s28
  s_add_u32 s38, s38, 25165824
  s_mul_i32 s39, s16, 131072
  s_add_u32 s39, s39, 54525952
  s_mul_i32 s40, s16, 40960
  s_lshl_b32 s28, s35, 6
  s_add_u32 s40, s40, s28
  s_add_u32 s40, s40, 226492416
  s_mov_b32 s26, 0
  v_mov_b32 v220, 0
  v_mov_b32 v221, 0
ua_loop:
  s_cmp_ge_u32 s26, 64
  s_cbranch_scc1 ua_ao
  s_add_u32 s34, s26, 1
  s_mov_b32 s27, 0
  s_branch pc_12
pw_10:
  buffer_load_dword v220, v218, s[8:11], 0 offen sc1
  s_add_u32 s27, s27, 1
  s_cmp_gt_u32 s27, 65536
  s_cbranch_scc1 role_abort
  s_waitcnt vmcnt(0)
pc_12:
  v_cmp_gt_u32 vcc, s34, v220
  s_nop 0
  s_and_b32 vcc_lo, vcc_lo, 0x7
  s_and_b32 vcc_hi, vcc_hi, 0x0
  s_cmp_eq_u64 vcc, 0
  s_cbranch_scc1 po_11
  s_sleep 4
  s_branch pw_10
po_11:
  s_add_u32 s28, s32, 4096
  s_add_u32 s29, s32, 8192
  buffer_load_dwordx4 v[4:7], v212, s[8:11], s32 offen offset:0 sc1
  buffer_load_dwordx4 v[28:31], v212, s[8:11], s28 offen offset:2048 sc1
  buffer_load_dwordx4 v[8:11], v212, s[8:11], s32 offen offset:1024 sc1
  buffer_load_dwordx4 v[32:35], v212, s[8:11], s28 offen offset:3072 sc1
  buffer_load_dwordx4 v[12:15], v212, s[8:11], s32 offen offset:2048 sc1
  buffer_load_dwordx4 v[36:39], v212, s[8:11], s29 offen offset:0 sc1
  buffer_load_dwordx4 v[16:19], v212, s[8:11], s32 offen offset:3072 sc1
  buffer_load_dwordx4 v[40:43], v212, s[8:11], s29 offen offset:1024 sc1
  buffer_load_dwordx4 v[20:23], v212, s[8:11], s28 offen offset:0 sc1
  buffer_load_dwordx4 v[44:47], v212, s[8:11], s29 offen offset:2048 sc1
  buffer_load_dwordx4 v[24:27], v212, s[8:11], s28 offen offset:1024 sc1
  buffer_load_dwordx4 v[48:51], v212, s[8:11], s29 offen offset:3072 sc1
  s_add_u32 s32, s32, 12288
  s_add_u32 s30, s33, 4096
  s_waitcnt vmcnt(10)
  v_mfma_f32_16x16x32_bf16 v[52:55], v[4:7], a[0:3], 0
  v_mfma_f32_16x16x32_bf16 v[56:59], v[28:31], a[0:3], 0
  v_mfma_f32_16x16x32_bf16 v[60:63], v[4:7], a[24:27], 0
  v_mfma_f32_16x16x32_bf16 v[64:67], v[28:31], a[24:27], 0
  s_waitcnt vmcnt(8)
  v_mfma_f32_16x16x32_bf16 v[52:55], v[8:11], a[4:7], v[52:55]
  v_mfma_f32_16x16x32_bf16 v[56:59], v[32:35], a[4:7], v[56:59]
  v_mfma_f32_16x16x32_bf16 v[60:63], v[8:11], a[28:31], v[60:63]
  v_mfma_f32_16x16x32_bf16 v[64:67], v[32:35], a[28:31], v[64:67]
  s_waitcnt vmcnt(6)
  v_mfma_f32_16x16x32_bf16 v[52:55], v[12:15], a[8:11], v[52:55]
  v_mfma_f32_16x16x32_bf16 v[56:59], v[36:39], a[8:11], v[56:59]
  v_mfma_f32_16x16x32_bf16 v[60:63], v[12:15], a[32:35], v[60:63]
  v_mfma_f32_16x16x32_bf16 v[64:67], v[36:39], a[32:35], v[64:67]
  s_waitcnt vmcnt(4)
  v_mfma_f32_16x16x32_bf16 v[52:55], v[16:19], a[12:15], v[52:55]
  v_mfma_f32_16x16x32_bf16 v[56:59], v[40:43], a[12:15], v[56:59]
  v_mfma_f32_16x16x32_bf16 v[60:63], v[16:19], a[36:39], v[60:63]
  v_mfma_f32_16x16x32_bf16 v[64:67], v[40:43], a[36:39], v[64:67]
  s_waitcnt vmcnt(2)
  v_mfma_f32_16x16x32_bf16 v[52:55], v[20:23], a[16:19], v[52:55]
  v_mfma_f32_16x16x32_bf16 v[56:59], v[44:47], a[16:19], v[56:59]
  v_mfma_f32_16x16x32_bf16 v[60:63], v[20:23], a[40:43], v[60:63]
  v_mfma_f32_16x16x32_bf16 v[64:67], v[44:47], a[40:43], v[64:67]
  s_waitcnt vmcnt(0)
  v_mfma_f32_16x16x32_bf16 v[52:55], v[24:27], a[20:23], v[52:55]
  v_mfma_f32_16x16x32_bf16 v[56:59], v[48:51], a[20:23], v[56:59]
  v_mfma_f32_16x16x32_bf16 v[60:63], v[24:27], a[44:47], v[60:63]
  v_mfma_f32_16x16x32_bf16 v[64:67], v[48:51], a[44:47], v[64:67]
  v_mfma_f32_16x16x32_bf16 v[68:71], v[4:7], a[48:51], 0
  v_mfma_f32_16x16x32_bf16 v[72:75], v[28:31], a[48:51], 0
  v_mfma_f32_16x16x32_bf16 v[76:79], v[4:7], a[72:75], 0
  v_mfma_f32_16x16x32_bf16 v[80:83], v[28:31], a[72:75], 0
  v_mfma_f32_16x16x32_bf16 v[68:71], v[8:11], a[52:55], v[68:71]
  v_cvt_pk_bf16_f32 v84, v52, v53
  v_mfma_f32_16x16x32_bf16 v[72:75], v[32:35], a[52:55], v[72:75]
  v_cvt_pk_bf16_f32 v85, v54, v55
  v_mfma_f32_16x16x32_bf16 v[76:79], v[8:11], a[76:79], v[76:79]
  v_cvt_pk_bf16_f32 v86, v56, v57
  v_mfma_f32_16x16x32_bf16 v[80:83], v[32:35], a[76:79], v[80:83]
  v_cvt_pk_bf16_f32 v87, v58, v59
  v_mfma_f32_16x16x32_bf16 v[68:71], v[12:15], a[56:59], v[68:71]
  buffer_store_dwordx4 v[84:87], v212, s[8:11], s33 offen offset:0
  v_mfma_f32_16x16x32_bf16 v[72:75], v[36:39], a[56:59], v[72:75]
  v_cvt_pk_bf16_f32 v88, v60, v61
  v_mfma_f32_16x16x32_bf16 v[76:79], v[12:15], a[80:83], v[76:79]
  v_cvt_pk_bf16_f32 v89, v62, v63
  v_mfma_f32_16x16x32_bf16 v[80:83], v[36:39], a[80:83], v[80:83]
  v_cvt_pk_bf16_f32 v90, v64, v65
  v_mfma_f32_16x16x32_bf16 v[68:71], v[16:19], a[60:63], v[68:71]
  v_cvt_pk_bf16_f32 v91, v66, v67
  v_mfma_f32_16x16x32_bf16 v[72:75], v[40:43], a[60:63], v[72:75]
  buffer_store_dwordx4 v[88:91], v212, s[8:11], s33 offen offset:1024
  v_mfma_f32_16x16x32_bf16 v[76:79], v[16:19], a[84:87], v[76:79]
  v_mfma_f32_16x16x32_bf16 v[80:83], v[40:43], a[84:87], v[80:83]
  v_mfma_f32_16x16x32_bf16 v[68:71], v[20:23], a[64:67], v[68:71]
  v_mfma_f32_16x16x32_bf16 v[72:75], v[44:47], a[64:67], v[72:75]
  v_mfma_f32_16x16x32_bf16 v[76:79], v[20:23], a[88:91], v[76:79]
  v_mfma_f32_16x16x32_bf16 v[80:83], v[44:47], a[88:91], v[80:83]
  v_mfma_f32_16x16x32_bf16 v[68:71], v[24:27], a[68:71], v[68:71]
  v_mfma_f32_16x16x32_bf16 v[72:75], v[48:51], a[68:71], v[72:75]
  v_mfma_f32_16x16x32_bf16 v[76:79], v[24:27], a[92:95], v[76:79]
  v_mfma_f32_16x16x32_bf16 v[80:83], v[48:51], a[92:95], v[80:83]
  v_mfma_f32_16x16x32_bf16 v[52:55], v[4:7], a[96:99], 0
  v_mfma_f32_16x16x32_bf16 v[56:59], v[28:31], a[96:99], 0
  v_mfma_f32_16x16x32_bf16 v[60:63], v[4:7], a[120:123], 0
  v_mfma_f32_16x16x32_bf16 v[64:67], v[28:31], a[120:123], 0
  v_mfma_f32_16x16x32_bf16 v[52:55], v[8:11], a[100:103], v[52:55]
  v_cvt_pk_bf16_f32 v84, v68, v69
  v_mfma_f32_16x16x32_bf16 v[56:59], v[32:35], a[100:103], v[56:59]
  v_cvt_pk_bf16_f32 v85, v70, v71
  v_mfma_f32_16x16x32_bf16 v[60:63], v[8:11], a[124:127], v[60:63]
  v_cvt_pk_bf16_f32 v86, v72, v73
  v_mfma_f32_16x16x32_bf16 v[64:67], v[32:35], a[124:127], v[64:67]
  v_cvt_pk_bf16_f32 v87, v74, v75
  v_mfma_f32_16x16x32_bf16 v[52:55], v[12:15], a[104:107], v[52:55]
  buffer_store_dwordx4 v[84:87], v212, s[8:11], s33 offen offset:2048
  v_mfma_f32_16x16x32_bf16 v[56:59], v[36:39], a[104:107], v[56:59]
  v_cvt_pk_bf16_f32 v88, v76, v77
  v_mfma_f32_16x16x32_bf16 v[60:63], v[12:15], a[128:131], v[60:63]
  v_cvt_pk_bf16_f32 v89, v78, v79
  v_mfma_f32_16x16x32_bf16 v[64:67], v[36:39], a[128:131], v[64:67]
  v_cvt_pk_bf16_f32 v90, v80, v81
  v_mfma_f32_16x16x32_bf16 v[52:55], v[16:19], a[108:111], v[52:55]
  v_cvt_pk_bf16_f32 v91, v82, v83
  v_mfma_f32_16x16x32_bf16 v[56:59], v[40:43], a[108:111], v[56:59]
  buffer_store_dwordx4 v[88:91], v212, s[8:11], s33 offen offset:3072
  v_mfma_f32_16x16x32_bf16 v[60:63], v[16:19], a[132:135], v[60:63]
  v_mfma_f32_16x16x32_bf16 v[64:67], v[40:43], a[132:135], v[64:67]
  v_mfma_f32_16x16x32_bf16 v[52:55], v[20:23], a[112:115], v[52:55]
  v_mfma_f32_16x16x32_bf16 v[56:59], v[44:47], a[112:115], v[56:59]
  v_mfma_f32_16x16x32_bf16 v[60:63], v[20:23], a[136:139], v[60:63]
  v_mfma_f32_16x16x32_bf16 v[64:67], v[44:47], a[136:139], v[64:67]
  v_mfma_f32_16x16x32_bf16 v[52:55], v[24:27], a[116:119], v[52:55]
  v_mfma_f32_16x16x32_bf16 v[56:59], v[48:51], a[116:119], v[56:59]
  v_mfma_f32_16x16x32_bf16 v[60:63], v[24:27], a[140:143], v[60:63]
  v_mfma_f32_16x16x32_bf16 v[64:67], v[48:51], a[140:143], v[64:67]
  v_mfma_f32_16x16x32_bf16 v[68:71], v[4:7], a[144:147], 0
  v_mfma_f32_16x16x32_bf16 v[72:75], v[28:31], a[144:147], 0
  v_mfma_f32_16x16x32_bf16 v[76:79], v[4:7], a[168:171], 0
  v_mfma_f32_16x16x32_bf16 v[80:83], v[28:31], a[168:171], 0
  v_mfma_f32_16x16x32_bf16 v[68:71], v[8:11], a[148:151], v[68:71]
  v_cvt_pk_bf16_f32 v84, v52, v53
  v_mfma_f32_16x16x32_bf16 v[72:75], v[32:35], a[148:151], v[72:75]
  v_cvt_pk_bf16_f32 v85, v54, v55
  v_mfma_f32_16x16x32_bf16 v[76:79], v[8:11], a[172:175], v[76:79]
  v_cvt_pk_bf16_f32 v86, v56, v57
  v_mfma_f32_16x16x32_bf16 v[80:83], v[32:35], a[172:175], v[80:83]
  v_cvt_pk_bf16_f32 v87, v58, v59
  v_mfma_f32_16x16x32_bf16 v[68:71], v[12:15], a[152:155], v[68:71]
  buffer_store_dwordx4 v[84:87], v212, s[8:11], s30 offen offset:0
  v_mfma_f32_16x16x32_bf16 v[72:75], v[36:39], a[152:155], v[72:75]
  v_cvt_pk_bf16_f32 v88, v60, v61
  v_mfma_f32_16x16x32_bf16 v[76:79], v[12:15], a[176:179], v[76:79]
  v_cvt_pk_bf16_f32 v89, v62, v63
  v_mfma_f32_16x16x32_bf16 v[80:83], v[36:39], a[176:179], v[80:83]
  v_cvt_pk_bf16_f32 v90, v64, v65
  v_mfma_f32_16x16x32_bf16 v[68:71], v[16:19], a[156:159], v[68:71]
  v_cvt_pk_bf16_f32 v91, v66, v67
  v_mfma_f32_16x16x32_bf16 v[72:75], v[40:43], a[156:159], v[72:75]
  buffer_store_dwordx4 v[88:91], v212, s[8:11], s30 offen offset:1024
  v_mfma_f32_16x16x32_bf16 v[76:79], v[16:19], a[180:183], v[76:79]
  v_mfma_f32_16x16x32_bf16 v[80:83], v[40:43], a[180:183], v[80:83]
  v_mfma_f32_16x16x32_bf16 v[68:71], v[20:23], a[160:163], v[68:71]
  v_mfma_f32_16x16x32_bf16 v[72:75], v[44:47], a[160:163], v[72:75]
  v_mfma_f32_16x16x32_bf16 v[76:79], v[20:23], a[184:187], v[76:79]
  v_mfma_f32_16x16x32_bf16 v[80:83], v[44:47], a[184:187], v[80:83]
  v_mfma_f32_16x16x32_bf16 v[68:71], v[24:27], a[164:167], v[68:71]
  v_mfma_f32_16x16x32_bf16 v[72:75], v[48:51], a[164:167], v[72:75]
  v_mfma_f32_16x16x32_bf16 v[76:79], v[24:27], a[188:191], v[76:79]
  v_mfma_f32_16x16x32_bf16 v[80:83], v[48:51], a[188:191], v[80:83]
  s_nop 4
  v_cvt_pk_bf16_f32 v84, v68, v69
  v_cvt_pk_bf16_f32 v85, v70, v71
  v_cvt_pk_bf16_f32 v86, v72, v73
  v_cvt_pk_bf16_f32 v87, v74, v75
  buffer_store_dwordx4 v[84:87], v212, s[8:11], s30 offen offset:2048
  v_cvt_pk_bf16_f32 v88, v76, v77
  v_cvt_pk_bf16_f32 v89, v78, v79
  v_cvt_pk_bf16_f32 v90, v80, v81
  v_cvt_pk_bf16_f32 v91, v82, v83
  buffer_store_dwordx4 v[88:91], v212, s[8:11], s30 offen offset:3072
  s_add_u32 s33, s33, 40960
  buffer_load_dword v220, v218, s[8:11], 0 offen sc1
  buffer_load_dword v221, v219, s[8:11], 0 offen sc1
  v_mov_b32 v224, s34
  s_waitcnt vmcnt(0)
  buffer_store_dword v224, v216, s[8:11], 0 offen
  s_cmp_lt_u32 s26, 4
  s_cbranch_scc1 ua_next
  s_cmp_eq_u32 s26, 4
  s_cbranch_scc0 ua_ao
  s_barrier
ua_ao:
  s_sub_u32 s34, s26, 3
  buffer_load_dwordx4 v[92:95], v213, s[8:11], s36 offen offset:0 sc1
  buffer_load_dwordx4 v[96:99], v213, s[8:11], s36 offen offset:64 sc1
  s_add_u32 s28, s36, 2621440
  buffer_load_dwordx4 v[100:103], v213, s[8:11], s28 offen offset:0 sc1
  buffer_load_dwordx4 v[104:107], v213, s[8:11], s28 offen offset:64 sc1
  s_add_u32 s28, s36, 5242880
  buffer_load_dwordx4 v[108:111], v213, s[8:11], s28 offen offset:0 sc1
  buffer_load_dwordx4 v[112:115], v213, s[8:11], s28 offen offset:64 sc1
  s_add_u32 s28, s36, 7864320
  buffer_load_dwordx4 v[116:119], v213, s[8:11], s28 offen offset:0 sc1
  buffer_load_dwordx4 v[120:123], v213, s[8:11], s28 offen offset:64 sc1
  s_mov_b32 s27, 0
  s_branch pc_15
pw_13:
  buffer_load_dword v221, v219, s[8:11], 0 offen sc1
  s_add_u32 s27, s27, 1
  s_cmp_gt_u32 s27, 65536
  s_cbranch_scc1 role_abort
  s_waitcnt vmcnt(0)
pc_15:
  v_cmp_gt_u32 vcc, s34, v221
  s_nop 0
  s_and_b32 vcc_lo, vcc_lo, 0xff
  s_and_b32 vcc_hi, vcc_hi, 0x0
  s_cmp_eq_u64 vcc, 0
  s_cbranch_scc1 po_14
  s_sleep 2
  s_branch pw_13
po_14:
  buffer_load_dwordx4 v[124:127], v212, s[8:11], s37 offen offset:0 sc1
  buffer_load_dwordx4 v[128:131], v212, s[8:11], s37 offen offset:1024 sc1
  s_add_u32 s28, s37, 131072
  buffer_load_dwordx4 v[132:135], v212, s[8:11], s28 offen offset:0 sc1
  buffer_load_dwordx4 v[136:139], v212, s[8:11], s28 offen offset:1024 sc1
  s_add_u32 s28, s37, 262144
  buffer_load_dwordx4 v[140:143], v212, s[8:11], s28 offen offset:0 sc1
  buffer_load_dwordx4 v[144:147], v212, s[8:11], s28 offen offset:1024 sc1
  s_add_u32 s28, s37, 393216
  buffer_load_dwordx4 v[148:151], v212, s[8:11], s28 offen offset:0 sc1
  buffer_load_dwordx4 v[152:155], v212, s[8:11], s28 offen offset:1024 sc1
  buffer_load_dwordx2 v[156:157], v214, s[8:11], s38 offen offset:0 sc1
  buffer_load_dwordx2 v[158:159], v214, s[8:11], s38 offen offset:64 sc1
  s_add_u32 s28, s38, 655360
  buffer_load_dwordx2 v[160:161], v214, s[8:11], s28 offen offset:0 sc1
  buffer_load_dwordx2 v[162:163], v214, s[8:11], s28 offen offset:64 sc1
  s_add_u32 s28, s38, 1310720
  buffer_load_dwordx2 v[164:165], v214, s[8:11], s28 offen offset:0 sc1
  buffer_load_dwordx2 v[166:167], v214, s[8:11], s28 offen offset:64 sc1
  s_add_u32 s28, s38, 1966080
  buffer_load_dwordx2 v[168:169], v214, s[8:11], s28 offen offset:0 sc1
  buffer_load_dwordx2 v[170:171], v214, s[8:11], s28 offen offset:64 sc1
  buffer_load_dwordx4 v[180:183], v212, s[8:11], s39 offen offset:0 sc1
  buffer_load_dwordx4 v[184:187], v212, s[8:11], s39 offen offset:1024 sc1
  s_add_u32 s36, s36, 40960
  s_add_u32 s37, s37, 2048
  s_add_u32 s38, s38, 10240
  s_add_u32 s39, s39, 2048
  s_waitcnt vmcnt(16)
  v_mfma_f32_16x16x32_bf16 v[188:191], v[92:95], v[124:127], 0
  v_mfma_f32_16x16x32_bf16 v[192:195], v[96:99], v[124:127], 0
  v_mfma_f32_16x16x32_bf16 v[196:199], v[92:95], v[128:131], 0
  v_mfma_f32_16x16x32_bf16 v[200:203], v[96:99], v[128:131], 0
  s_waitcnt vmcnt(14)
  v_mfma_f32_16x16x32_bf16 v[188:191], v[100:103], v[132:135], v[188:191]
  v_mfma_f32_16x16x32_bf16 v[192:195], v[104:107], v[132:135], v[192:195]
  v_mfma_f32_16x16x32_bf16 v[196:199], v[100:103], v[136:139], v[196:199]
  v_mfma_f32_16x16x32_bf16 v[200:203], v[104:107], v[136:139], v[200:203]
  s_waitcnt vmcnt(12)
  v_mfma_f32_16x16x32_bf16 v[188:191], v[108:111], v[140:143], v[188:191]
  v_mfma_f32_16x16x32_bf16 v[192:195], v[112:115], v[140:143], v[192:195]
  v_mfma_f32_16x16x32_bf16 v[196:199], v[108:111], v[144:147], v[196:199]
  v_mfma_f32_16x16x32_bf16 v[200:203], v[112:115], v[144:147], v[200:203]
  s_waitcnt vmcnt(10)
  v_mfma_f32_16x16x32_bf16 v[188:191], v[116:119], v[148:151], v[188:191]
  v_mfma_f32_16x16x32_bf16 v[192:195], v[120:123], v[148:151], v[192:195]
  v_mfma_f32_16x16x32_bf16 v[196:199], v[116:119], v[152:155], v[196:199]
  v_mfma_f32_16x16x32_bf16 v[200:203], v[120:123], v[152:155], v[200:203]
  s_waitcnt vmcnt(2)
  v_cndmask_b32 v172, v156, v157, s[42:43]
  v_cndmask_b32 v173, v160, v161, s[42:43]
  v_cndmask_b32 v174, v164, v165, s[42:43]
  v_cndmask_b32 v175, v168, v169, s[42:43]
  v_cndmask_b32 v176, v158, v159, s[42:43]
  v_cndmask_b32 v177, v162, v163, s[42:43]
  v_cndmask_b32 v178, v166, v167, s[42:43]
  v_cndmask_b32 v179, v170, v171, s[42:43]
  s_waitcnt vmcnt(0)
  v_mfma_f32_16x16x32_bf16 v[188:191], v[172:175], v[180:183], v[188:191]
  v_mfma_f32_16x16x32_bf16 v[192:195], v[176:179], v[180:183], v[192:195]
  v_mfma_f32_16x16x32_bf16 v[196:199], v[172:175], v[184:187], v[196:199]
  v_mfma_f32_16x16x32_bf16 v[200:203], v[176:179], v[184:187], v[200:203]
  s_add_u32 s28, s40, 20480
  s_nop 3
  v_cvt_pk_bf16_f32 v204, v188, v189
  v_cvt_pk_bf16_f32 v205, v190, v191
  v_cvt_pk_bf16_f32 v206, v192, v193
  v_cvt_pk_bf16_f32 v207, v194, v195
  buffer_store_dwordx4 v[204:207], v215, s[8:11], s40 offen sc1
  v_cvt_pk_bf16_f32 v208, v196, v197
  v_cvt_pk_bf16_f32 v209, v198, v199
  v_cvt_pk_bf16_f32 v210, v200, v201
  v_cvt_pk_bf16_f32 v211, v202, v203
  buffer_store_dwordx4 v[208:211], v215, s[8:11], s28 offen sc1
  s_add_u32 s40, s40, 327680
  v_mov_b32 v224, s34
  s_waitcnt vmcnt(0)
  s_mov_b64 exec, 1
  buffer_store_dword v224, v217, s[8:11], 0 offen sc1
  s_mov_b64 exec, -1
ua_next:
  s_add_u32 s26, s26, 1
  s_cmp_lt_u32 s26, 68
  s_cbranch_scc1 ua_loop
  s_endpgm
role_sm:
  s_sub_u32 s20, s18, 26
  s_lshl_b32 s20, s20, 2
  s_add_u32 s20, s20, s17
  s_lshr_b32 s21, s20, 1
  s_and_b32 s22, s20, 1
  s_lshl_b32 s23, s16, 2
  s_add_u32 s23, s23, s21
  v_lshlrev_b32 v128, 4, v1
  v_bfe_u32 v135, v1, 2, 2
  v_and_b32 v136, 1, v1
  v_lshl_add_u32 v135, v135, 1, v136
  v_lshrrev_b32 v136, 4, v1
  v_lshl_add_u32 v135, v136, 3, v135
  v_lshlrev_b32 v129, 4, v135
  v_and_b32 v135, 15, v1
  s_lshl_b32 s26, s22, 4
  v_add_u32 v135, s26, v135
  v_lshlrev_b32 v136, 2, v136
  v_sub_u32 v135, v135, v136
  v_mov_b32 v136, 0
  v_mov_b32 v137, 0xf149f2ca
  v_cmp_le_i32 vcc, 0, v135
  s_nop 1
  v_cndmask_b32 v112, v137, v136, vcc
  v_cmp_le_i32 vcc, 1, v135
  s_nop 1
  v_cndmask_b32 v113, v137, v136, vcc
  v_cmp_le_i32 vcc, 2, v135
  s_nop 1
  v_cndmask_b32 v114, v137, v136, vcc
  v_cmp_le_i32 vcc, 3, v135
  s_nop 1
  v_cndmask_b32 v115, v137, v136, vcc
  v_cmp_le_i32 vcc, 16, v135
  s_nop 1
  v_cndmask_b32 v116, v137, v136, vcc
  v_cmp_le_i32 vcc, 17, v135
  s_nop 1
  v_cndmask_b32 v117, v137, v136, vcc
  v_cmp_le_i32 vcc, 18, v135
  s_nop 1
  v_cndmask_b32 v118, v137, v136, vcc
  v_cmp_le_i32 vcc, 19, v135
  s_nop 1
  v_cndmask_b32 v119, v137, v136, vcc
  v_mov_b32 v124, 0x3d93cd3a
  v_mov_b32 v125, 0x3d93cd3a
  s_lshl_b32 s26, s16, 8
  v_lshl_add_u32 v130, v1, 2, s26
  v_add_u32 v131, 4096, v130
  s_mul_i32 s27, s21, 12
  v_add_u32 v130, s27, v130
  s_lshl_b32 s27, s20, 2
  s_add_u32 s26, s26, s27
  s_add_u32 s26, s26, 16384
  v_mov_b32 v132, s26
  s_mul_i32 s30, s23, 786432
  s_add_u32 s30, s30, 67108864
  s_mul_i32 s26, s22, 6144
  s_add_u32 s29, s30, s26
  s_add_u32 s30, s30, 25165824
  s_mul_i32 s31, s23, 196608
  s_add_u32 s31, s31, 16777216
  s_lshl_b32 s26, s22, 10
  s_mul_i32 s32, s23, 131072
  s_add_u32 s32, s32, s26
  s_add_u32 s32, s32, 47185920
  s_mul_i32 s33, s16, 131072
  s_add_u32 s33, s33, s26
  s_lshl_b32 s26, s21, 2
  s_add_u32 s33, s33, s26
  s_add_u32 s33, s33, 54525952
  s_mov_b32 s34, 1
  v_mov_b32 v133, 0
sm_loop:
  s_mov_b32 s25, 0
  s_branch pc_18
pw_16:
  buffer_load_dword v133, v130, s[8:11], 0 offen sc1
  s_add_u32 s25, s25, 1
  s_cmp_gt_u32 s25, 65536
  s_cbranch_scc1 role_abort
  s_waitcnt vmcnt(0)
pc_18:
  v_cmp_gt_u32 vcc, s34, v133
  s_nop 0
  s_and_b32 vcc_lo, vcc_lo, 0x7007
  s_and_b32 vcc_hi, vcc_hi, 0x0
  s_cmp_eq_u64 vcc, 0
  s_cbranch_scc1 po_17
  s_sleep 4
  s_branch pw_16
po_17:
  s_add_u32 s26, s30, 4096
  s_add_u32 s27, s30, 8192
  s_add_u32 s28, s29, 4096
  buffer_load_dwordx4 v[4:7], v128, s[8:11], s29 offen offset:0 sc1
  buffer_load_dwordx4 v[28:31], v128, s[8:11], s30 offen offset:0 sc1
  buffer_load_dwordx4 v[52:55], v128, s[8:11], s26 offen offset:2048 sc1
  buffer_load_dwordx4 v[8:11], v128, s[8:11], s29 offen offset:1024 sc1
  buffer_load_dwordx4 v[32:35], v128, s[8:11], s30 offen offset:1024 sc1
  buffer_load_dwordx4 v[56:59], v128, s[8:11], s26 offen offset:3072 sc1
  buffer_load_dwordx4 v[12:15], v128, s[8:11], s29 offen offset:2048 sc1
  buffer_load_dwordx4 v[36:39], v128, s[8:11], s30 offen offset:2048 sc1
  buffer_load_dwordx4 v[60:63], v128, s[8:11], s27 offen offset:0 sc1
  buffer_load_dwordx4 v[16:19], v128, s[8:11], s29 offen offset:3072 sc1
  buffer_load_dwordx4 v[40:43], v128, s[8:11], s30 offen offset:3072 sc1
  buffer_load_dwordx4 v[64:67], v128, s[8:11], s27 offen offset:1024 sc1
  buffer_load_dwordx4 v[20:23], v128, s[8:11], s28 offen offset:0 sc1
  buffer_load_dwordx4 v[44:47], v128, s[8:11], s26 offen offset:0 sc1
  buffer_load_dwordx4 v[68:71], v128, s[8:11], s27 offen offset:2048 sc1
  buffer_load_dwordx4 v[24:27], v128, s[8:11], s28 offen offset:1024 sc1
  buffer_load_dwordx4 v[48:51], v128, s[8:11], s26 offen offset:1024 sc1
  buffer_load_dwordx4 v[72:75], v128, s[8:11], s27 offen offset:3072 sc1
  buffer_load_dword v133, v130, s[8:11], 0 offen sc1
  s_add_u32 s30, s30, 12288
  s_add_u32 s29, s29, 12288
  s_waitcnt vmcnt(16)
  v_mfma_f32_16x16x32_bf16 v[100:103], v[28:31], v[4:7], 0
  v_mfma_f32_16x16x32_bf16 v[104:107], v[52:55], v[4:7], 0
  s_waitcnt vmcnt(13)
  v_mfma_f32_16x16x32_bf16 v[100:103], v[32:35], v[8:11], v[100:103]
  v_mfma_f32_16x16x32_bf16 v[104:107], v[56:59], v[8:11], v[104:107]
  s_waitcnt vmcnt(10)
  v_mfma_f32_16x16x32_bf16 v[100:103], v[36:39], v[12:15], v[100:103]
  v_mfma_f32_16x16x32_bf16 v[104:107], v[60:63], v[12:15], v[104:107]
  s_waitcnt vmcnt(7)
  v_mfma_f32_16x16x32_bf16 v[100:103], v[40:43], v[16:19], v[100:103]
  v_mfma_f32_16x16x32_bf16 v[104:107], v[64:67], v[16:19], v[104:107]
  s_waitcnt vmcnt(4)
  v_mfma_f32_16x16x32_bf16 v[100:103], v[44:47], v[20:23], v[100:103]
  v_mfma_f32_16x16x32_bf16 v[104:107], v[68:71], v[20:23], v[104:107]
  s_waitcnt vmcnt(1)
  v_mfma_f32_16x16x32_bf16 v[100:103], v[48:51], v[24:27], v[100:103]
  v_mfma_f32_16x16x32_bf16 v[104:107], v[72:75], v[24:27], v[104:107]
  s_nop 6
  v_cvt_pk_bf16_f32 v135, v100, v101
  v_lshlrev_b32 v100, 16, v135
  v_and_b32 v101, 0xffff0000, v135
  v_cvt_pk_bf16_f32 v135, v102, v103
  v_lshlrev_b32 v102, 16, v135
  v_and_b32 v103, 0xffff0000, v135
  v_cvt_pk_bf16_f32 v135, v104, v105
  v_lshlrev_b32 v104, 16, v135
  v_and_b32 v105, 0xffff0000, v135
  v_cvt_pk_bf16_f32 v135, v106, v107
  v_lshlrev_b32 v106, 16, v135
  v_and_b32 v107, 0xffff0000, v135
  v_pk_fma_f32 v[100:101], v[100:101], v[124:125], v[112:113]
  v_cvt_pk_bf16_f32 v135, v100, v101
  v_lshlrev_b32 v100, 16, v135
  v_and_b32 v101, 0xffff0000, v135
  v_pk_fma_f32 v[102:103], v[102:103], v[124:125], v[114:115]
  v_cvt_pk_bf16_f32 v135, v102, v103
  v_lshlrev_b32 v102, 16, v135
  v_and_b32 v103, 0xffff0000, v135
  v_pk_fma_f32 v[104:105], v[104:105], v[124:125], v[116:117]
  v_cvt_pk_bf16_f32 v135, v104, v105
  v_lshlrev_b32 v104, 16, v135
  v_and_b32 v105, 0xffff0000, v135
  v_pk_fma_f32 v[106:107], v[106:107], v[124:125], v[118:119]
  v_cvt_pk_bf16_f32 v135, v106, v107
  v_lshlrev_b32 v106, 16, v135
  v_and_b32 v107, 0xffff0000, v135
  v_max3_f32 v137, v100, v101, v102
  v_max3_f32 v137, v137, v103, v104
  v_max3_f32 v137, v137, v105, v106
  v_max_f32 v137, v137, v107
  s_mov_b32 s25, 0
pw_19:
  buffer_load_dword v134, v131, s[8:11], 0 offen sc1
  s_add_u32 s25, s25, 1
  s_cmp_gt_u32 s25, 65536
  s_cbranch_scc1 role_abort
  s_waitcnt vmcnt(0)
pc_21:
  v_cmp_gt_u32 vcc, s34, v134
  s_nop 0
  s_and_b32 vcc_lo, vcc_lo, 0xffffffff
  s_and_b32 vcc_hi, vcc_hi, 0xffff
  s_cmp_eq_u64 vcc, 0
  s_cbranch_scc1 po_20
  s_sleep 2
  s_branch pw_19
po_20:
  buffer_load_dwordx4 v[76:79], v129, s[8:11], s31 offen offset:0 sc1
  buffer_load_dwordx4 v[80:83], v129, s[8:11], s31 offen offset:512 sc1
  buffer_load_dwordx4 v[84:87], v129, s[8:11], s31 offen offset:1024 sc1
  buffer_load_dwordx4 v[88:91], v129, s[8:11], s31 offen offset:1536 sc1
  buffer_load_dwordx4 v[92:95], v129, s[8:11], s31 offen offset:2048 sc1
  buffer_load_dwordx4 v[96:99], v129, s[8:11], s31 offen offset:2560 sc1
  s_add_u32 s31, s31, 3072
  s_waitcnt vmcnt(5)
  v_mfma_f32_16x16x32_bf16 v[108:111], v[76:79], v[4:7], 0
  s_waitcnt vmcnt(4)
  v_mfma_f32_16x16x32_bf16 v[108:111], v[80:83], v[8:11], v[108:111]
  s_waitcnt vmcnt(3)
  v_mfma_f32_16x16x32_bf16 v[108:111], v[84:87], v[12:15], v[108:111]
  s_waitcnt vmcnt(2)
  v_mfma_f32_16x16x32_bf16 v[108:111], v[88:91], v[16:19], v[108:111]
  s_waitcnt vmcnt(1)
  v_mfma_f32_16x16x32_bf16 v[108:111], v[92:95], v[20:23], v[108:111]
  s_waitcnt vmcnt(0)
  v_mfma_f32_16x16x32_bf16 v[108:111], v[96:99], v[24:27], v[108:111]
  s_nop 7
  v_cvt_pk_bf16_f32 v135, v108, v109
  v_lshlrev_b32 v108, 16, v135
  v_and_b32 v109, 0xffff0000, v135
  v_pk_mul_f32 v[108:109], v[108:109], v[124:125]
  v_cvt_pk_bf16_f32 v135, v108, v109
  v_lshlrev_b32 v108, 16, v135
  v_and_b32 v109, 0xffff0000, v135
  v_max3_f32 v137, v137, v108, v109
  v_mov_b32 v136, v137
  s_nop 1
  v_permlane16_swap_b32 v137, v136
  v_max_f32 v137, v137, v136
  v_mov_b32 v136, v137
  s_nop 1
  v_permlane32_swap_b32 v137, v136
  v_max_f32 v137, v137, v136
  v_sub_f32 v100, v100, v137
  v_sub_f32 v101, v101, v137
  v_sub_f32 v102, v102, v137
  v_sub_f32 v103, v103, v137
  v_sub_f32 v104, v104, v137
  v_sub_f32 v105, v105, v137
  v_sub_f32 v106, v106, v137
  v_sub_f32 v107, v107, v137
  v_sub_f32 v108, v108, v137
  v_sub_f32 v109, v109, v137
  v_mul_f32 v100, 0x3fb8aa3b, v100
  v_mul_f32 v101, 0x3fb8aa3b, v101
  v_mul_f32 v102, 0x3fb8aa3b, v102
  v_mul_f32 v103, 0x3fb8aa3b, v103
  v_mul_f32 v104, 0x3fb8aa3b, v104
  v_mul_f32 v105, 0x3fb8aa3b, v105
  v_mul_f32 v106, 0x3fb8aa3b, v106
  v_mul_f32 v107, 0x3fb8aa3b, v107
  v_mul_f32 v108, 0x3fb8aa3b, v108
  v_mul_f32 v109, 0x3fb8aa3b, v109
  v_exp_f32 v100, v100
  v_exp_f32 v101, v101
  v_exp_f32 v102, v102
  v_exp_f32 v103, v103
  v_exp_f32 v104, v104
  v_exp_f32 v105, v105
  v_exp_f32 v106, v106
  v_exp_f32 v107, v107
  v_exp_f32 v108, v108
  v_exp_f32 v109, v109
  v_pk_add_f32 v[126:127], v[100:101], v[102:103]
  v_pk_add_f32 v[110:111], v[104:105], v[106:107]
  v_pk_add_f32 v[126:127], v[126:127], v[108:109]
  v_pk_add_f32 v[126:127], v[126:127], v[110:111]
  v_add_f32 v137, v126, v127
  v_mov_b32 v136, v137
  s_nop 1
  v_permlane16_swap_b32 v137, v136
  v_add_f32 v137, v137, v136
  v_mov_b32 v136, v137
  s_nop 1
  v_permlane32_swap_b32 v137, v136
  v_add_f32 v137, v137, v136
  v_rcp_f32 v126, v137
  s_nop 0
  v_mov_b32 v127, v126
  v_pk_mul_f32 v[100:101], v[100:101], v[126:127]
  v_cvt_pk_bf16_f32 v120, v100, v101
  v_pk_mul_f32 v[102:103], v[102:103], v[126:127]
  v_cvt_pk_bf16_f32 v121, v102, v103
  v_pk_mul_f32 v[104:105], v[104:105], v[126:127]
  v_cvt_pk_bf16_f32 v122, v104, v105
  v_pk_mul_f32 v[106:107], v[106:107], v[126:127]
  v_cvt_pk_bf16_f32 v123, v106, v107
  v_pk_mul_f32 v[108:109], v[108:109], v[126:127]
  buffer_store_dwordx4 v[120:123], v128, s[8:11], s32 offen
  v_cvt_pk_bf16_f32 v138, v108, v109
  buffer_store_dword v138, v128, s[8:11], s33 offen
  v_mov_b32 v137, s34
  s_add_u32 s32, s32, 2048
  s_add_u32 s33, s33, 2048
  s_add_u32 s34, s34, 1
  s_cmp_le_u32 s34, 64
  s_waitcnt vmcnt(0)
  buffer_store_dword v137, v132, s[8:11], 0 offen
  s_cbranch_scc1 sm_loop
  s_endpgm
role_r:
  s_load_dwordx2 s[20:21], s[0:1], 0
  s_mov_b32 s22, 2621440
  s_mov_b32 s23, 0x00020000
  s_load_dwordx2 s[24:25], s[0:1], 112
  s_mov_b32 s26, 2621440
  s_mov_b32 s27, 0x00020000
  s_load_dwordx2 s[28:29], s[0:1], 64
  s_mov_b32 s30, 1280
  s_mov_b32 s31, 0x00020000
  s_sub_u32 s32, s18, 28
  s_lshl_b32 s32, s32, 2
  s_add_u32 s32, s32, s17
  v_lshlrev_b32 v143, 2, v1
  v_lshlrev_b32 v144, 3, v1
  s_lshl_b32 s35, s16, 8
  s_lshl_b32 s36, s32, 2
  s_add_u32 s35, s35, s36
  s_add_u32 s35, s35, 12288
  v_mov_b32 v145, s35
  v_mov_b32 v148, 0x00003f80
  v_mov_b32 v149, 0x3f800000
  s_mul_i32 s37, s32, 1280
  s_mul_i32 s38, s16, 2621440
  s_add_u32 s38, s38, 247463936
  s_add_u32 s38, s38, s37
  s_waitcnt lgkmcnt(0)
  s_mov_b32 s35, 65536
  buffer_load_dwordx2 v[56:57], v144, s[8:11], s35 offen offset:0
  buffer_load_dwordx2 v[58:59], v144, s[8:11], s35 offen offset:512
  buffer_load_dwordx2 v[60:61], v144, s[8:11], s35 offen offset:1024
  buffer_load_dwordx2 v[62:63], v144, s[8:11], s35 offen offset:1536
  buffer_load_dwordx2 v[64:65], v144, s[8:11], s35 offen offset:2048
  s_mov_b32 s35, 68096
  buffer_load_dwordx2 v[46:47], v144, s[8:11], s35 offen offset:0
  buffer_load_dwordx2 v[48:49], v144, s[8:11], s35 offen offset:512
  buffer_load_dwordx2 v[50:51], v144, s[8:11], s35 offen offset:1024
  buffer_load_dwordx2 v[52:53], v144, s[8:11], s35 offen offset:1536
  buffer_load_dwordx2 v[54:55], v144, s[8:11], s35 offen offset:2048
  buffer_load_dword v22, v143, s[20:23], s37 offen offset:0
  buffer_load_dword v23, v143, s[20:23], s37 offen offset:256
  buffer_load_dword v24, v143, s[20:23], s37 offen offset:512
  buffer_load_dword v25, v143, s[20:23], s37 offen offset:768
  buffer_load_dword v26, v143, s[20:23], s37 offen offset:1024
  s_waitcnt vmcnt(5)
  v_add_f32 v46, 1.0, v46
  v_add_f32 v47, 1.0, v47
  v_cvt_pk_bf16_f32 v140, v46, v47
  v_lshlrev_b32 v46, 16, v140
  v_and_b32 v47, 0xffff0000, v140
  v_add_f32 v48, 1.0, v48
  v_add_f32 v49, 1.0, v49
  v_cvt_pk_bf16_f32 v140, v48, v49
  v_lshlrev_b32 v48, 16, v140
  v_and_b32 v49, 0xffff0000, v140
  v_add_f32 v50, 1.0, v50
  v_add_f32 v51, 1.0, v51
  v_cvt_pk_bf16_f32 v140, v50, v51
  v_lshlrev_b32 v50, 16, v140
  v_and_b32 v51, 0xffff0000, v140
  v_add_f32 v52, 1.0, v52
  v_add_f32 v53, 1.0, v53
  v_cvt_pk_bf16_f32 v140, v52, v53
  v_lshlrev_b32 v52, 16, v140
  v_and_b32 v53, 0xffff0000, v140
  v_add_f32 v54, 1.0, v54
  v_add_f32 v55, 1.0, v55
  v_cvt_pk_bf16_f32 v140, v54, v55
  v_lshlrev_b32 v54, 16, v140
  v_and_b32 v55, 0xffff0000, v140
  s_mov_b32 s33, 0
  s_waitcnt vmcnt(0)
r_ln1:
  s_waitcnt vmcnt(6)
  v_lshlrev_b32 v2, 16, v22
  v_and_b32 v3, 0xffff0000, v22
  v_lshlrev_b32 v4, 16, v23
  v_and_b32 v5, 0xffff0000, v23
  v_lshlrev_b32 v6, 16, v24
  v_and_b32 v7, 0xffff0000, v24
  v_lshlrev_b32 v8, 16, v25
  v_and_b32 v9, 0xffff0000, v25
  v_lshlrev_b32 v10, 16, v26
  v_and_b32 v11, 0xffff0000, v26
  s_add_u32 s37, s37, 20480
  s_min_u32 s37, s37, 2620160
  buffer_load_dword v22, v143, s[20:23], s37 offen offset:0
  buffer_load_dword v23, v143, s[20:23], s37 offen offset:256
  buffer_load_dword v24, v143, s[20:23], s37 offen offset:512
  buffer_load_dword v25, v143, s[20:23], s37 offen offset:768
  buffer_load_dword v26, v143, s[20:23], s37 offen offset:1024
  v_pk_add_f32 v[136:137], v[2:3], v[4:5]
  v_pk_add_f32 v[138:139], v[6:7], v[8:9]
  v_pk_add_f32 v[136:137], v[136:137], v[10:11]
  v_pk_add_f32 v[136:137], v[136:137], v[138:139]
  v_add_f32 v136, v136, v137
  s_nop 1
  v_add_f32_dpp v136, v136, v136 row_ror:8 row_mask:0xf bank_mask:0xf
  s_nop 1
  v_add_f32_dpp v136, v136, v136 row_ror:4 row_mask:0xf bank_mask:0xf
  s_nop 1
  v_add_f32_dpp v136, v136, v136 row_ror:2 row_mask:0xf bank_mask:0xf
  s_nop 1
  v_add_f32_dpp v136, v136, v136 row_ror:1 row_mask:0xf bank_mask:0xf
  v_mov_b32 v140, v136
  s_nop 1
  v_permlane16_swap_b32 v136, v140
  v_add_f32 v136, v136, v140
  v_mov_b32 v140, v136
  s_nop 1
  v_permlane32_swap_b32 v136, v140
  v_add_f32 v136, v136, v140
  v_mul_f32 v138, 0xbacccccd, v136
  v_mul_f32 v139, 0xbacccccd, v136
  v_pk_add_f32 v[12:13], v[2:3], v[138:139]
  v_pk_add_f32 v[14:15], v[4:5], v[138:139]
  v_pk_add_f32 v[16:17], v[6:7], v[138:139]
  v_pk_add_f32 v[18:19], v[8:9], v[138:139]
  v_pk_add_f32 v[20:21], v[10:11], v[138:139]
  v_pk_mul_f32 v[136:137], v[12:13], v[12:13]
  v_pk_fma_f32 v[136:137], v[14:15], v[14:15], v[136:137]
  v_pk_fma_f32 v[136:137], v[16:17], v[16:17], v[136:137]
  v_pk_fma_f32 v[136:137], v[18:19], v[18:19], v[136:137]
  v_pk_fma_f32 v[136:137], v[20:21], v[20:21], v[136:137]
  v_add_f32 v136, v136, v137
  v_cvt_pk_bf16_f32 v141, v138, v139
  v_lshlrev_b32 v138, 16, v141
  v_and_b32 v139, 0xffff0000, v141
  v_add_f32_dpp v136, v136, v136 row_ror:8 row_mask:0xf bank_mask:0xf
  s_nop 1
  v_add_f32_dpp v136, v136, v136 row_ror:4 row_mask:0xf bank_mask:0xf
  s_nop 1
  v_add_f32_dpp v136, v136, v136 row_ror:2 row_mask:0xf bank_mask:0xf
  s_nop 1
  v_add_f32_dpp v136, v136, v136 row_ror:1 row_mask:0xf bank_mask:0xf
  v_mov_b32 v140, v136
  s_nop 1
  v_permlane16_swap_b32 v136, v140
  v_add_f32 v136, v136, v140
  v_mov_b32 v140, v136
  s_nop 1
  v_permlane32_swap_b32 v136, v140
  v_add_f32 v136, v136, v140
  v_pk_add_f32 v[12:13], v[2:3], v[138:139]
  v_pk_add_f32 v[14:15], v[4:5], v[138:139]
  v_pk_add_f32 v[16:17], v[6:7], v[138:139]
  v_pk_add_f32 v[18:19], v[8:9], v[138:139]
  v_pk_add_f32 v[20:21], v[10:11], v[138:139]
  v_mul_f32 v136, 0x3acccccd, v136
  v_cvt_pk_bf16_f32 v136, v136, v136
  v_lshlrev_b32 v136, 16, v136
  v_add_f32 v136, 0x3727c5ac, v136
  v_cvt_pk_bf16_f32 v136, v136, v136
  v_lshlrev_b32 v136, 16, v136
  v_sqrt_f32 v136, v136
  v_cvt_pk_bf16_f32 v140, v12, v13
  v_lshlrev_b32 v12, 16, v140
  v_and_b32 v13, 0xffff0000, v140
  v_cvt_pk_bf16_f32 v136, v136, v136
  v_lshlrev_b32 v136, 16, v136
  v_rcp_f32 v136, v136
  v_cvt_pk_bf16_f32 v140, v14, v15
  v_lshlrev_b32 v14, 16, v140
  v_and_b32 v15, 0xffff0000, v140
  v_cvt_pk_bf16_f32 v140, v16, v17
  v_lshlrev_b32 v16, 16, v140
  v_and_b32 v17, 0xffff0000, v140
  v_cvt_pk_bf16_f32 v140, v18, v19
  v_lshlrev_b32 v18, 16, v140
  v_and_b32 v19, 0xffff0000, v140
  v_cvt_pk_bf16_f32 v140, v20, v21
  v_lshlrev_b32 v20, 16, v140
  v_and_b32 v21, 0xffff0000, v140
  v_mov_b32 v137, v136
  v_pk_mul_f32 v[12:13], v[12:13], v[136:137]
  v_cvt_pk_bf16_f32 v140, v12, v13
  v_lshlrev_b32 v12, 16, v140
  v_and_b32 v13, 0xffff0000, v140
  v_pk_mul_f32 v[14:15], v[14:15], v[136:137]
  v_cvt_pk_bf16_f32 v140, v14, v15
  v_lshlrev_b32 v14, 16, v140
  v_and_b32 v15, 0xffff0000, v140
  v_pk_mul_f32 v[16:17], v[16:17], v[136:137]
  v_cvt_pk_bf16_f32 v140, v16, v17
  v_lshlrev_b32 v16, 16, v140
  v_and_b32 v17, 0xffff0000, v140
  v_pk_mul_f32 v[18:19], v[18:19], v[136:137]
  v_cvt_pk_bf16_f32 v140, v18, v19
  v_lshlrev_b32 v18, 16, v140
  v_and_b32 v19, 0xffff0000, v140
  v_pk_mul_f32 v[20:21], v[20:21], v[136:137]
  v_cvt_pk_bf16_f32 v140, v20, v21
  v_lshlrev_b32 v20, 16, v140
  v_and_b32 v21, 0xffff0000, v140
  v_pk_mul_f32 v[12:13], v[12:13], v[46:47]
  v_cvt_pk_bf16_f32 v140, v12, v13
  v_lshlrev_b32 v12, 16, v140
  v_and_b32 v13, 0xffff0000, v140
  v_pk_mul_f32 v[14:15], v[14:15], v[48:49]
  v_cvt_pk_bf16_f32 v140, v14, v15
  v_lshlrev_b32 v14, 16, v140
  v_and_b32 v15, 0xffff0000, v140
  v_pk_mul_f32 v[16:17], v[16:17], v[50:51]
  v_cvt_pk_bf16_f32 v140, v16, v17
  v_lshlrev_b32 v16, 16, v140
  v_and_b32 v17, 0xffff0000, v140
  v_pk_mul_f32 v[18:19], v[18:19], v[52:53]
  v_cvt_pk_bf16_f32 v140, v18, v19
  v_lshlrev_b32 v18, 16, v140
  v_and_b32 v19, 0xffff0000, v140
  v_pk_mul_f32 v[20:21], v[20:21], v[54:55]
  v_cvt_pk_bf16_f32 v140, v20, v21
  v_lshlrev_b32 v20, 16, v140
  v_and_b32 v21, 0xffff0000, v140
  v_pk_add_f32 v[12:13], v[12:13], v[56:57]
  v_cvt_pk_bf16_f32 v28, v12, v13
  v_pk_add_f32 v[14:15], v[14:15], v[58:59]
  v_cvt_pk_bf16_f32 v29, v14, v15
  v_pk_add_f32 v[16:17], v[16:17], v[60:61]
  v_cvt_pk_bf16_f32 v30, v16, v17
  v_pk_add_f32 v[18:19], v[18:19], v[62:63]
  v_cvt_pk_bf16_f32 v31, v18, v19
  v_pk_add_f32 v[20:21], v[20:21], v[64:65]
  v_cvt_pk_bf16_f32 v32, v20, v21
  v_mov_b32 v142, s33
  s_waitcnt vmcnt(5)
  buffer_store_dword v142, v145, s[8:11], 0 offen
  buffer_store_dword v28, v143, s[8:11], s38 offen offset:0
  buffer_store_dword v29, v143, s[8:11], s38 offen offset:256
  buffer_store_dword v30, v143, s[8:11], s38 offen offset:512
  buffer_store_dword v31, v143, s[8:11], s38 offen offset:768
  buffer_store_dword v32, v143, s[8:11], s38 offen offset:1024
  s_add_u32 s38, s38, 20480
  s_add_u32 s33, s33, 1
  s_cmp_lt_u32 s33, 128
  s_cbranch_scc1 r_ln1
  v_mov_b32 v142, s33
  s_waitcnt vmcnt(0)
  buffer_store_dword v142, v145, s[8:11], 0 offen
  s_mov_b32 s35, 70656
  buffer_load_dwordx2 v[66:67], v144, s[8:11], s35 offen offset:0
  buffer_load_dwordx2 v[68:69], v144, s[8:11], s35 offen offset:512
  buffer_load_dwordx2 v[70:71], v144, s[8:11], s35 offen offset:1024
  buffer_load_dwordx2 v[72:73], v144, s[8:11], s35 offen offset:1536
  buffer_load_dwordx2 v[74:75], v144, s[8:11], s35 offen offset:2048
  s_mov_b32 s35, 73216
  buffer_load_dwordx2 v[56:57], v144, s[8:11], s35 offen offset:0
  buffer_load_dwordx2 v[58:59], v144, s[8:11], s35 offen offset:512
  buffer_load_dwordx2 v[60:61], v144, s[8:11], s35 offen offset:1024
  buffer_load_dwordx2 v[62:63], v144, s[8:11], s35 offen offset:1536
  buffer_load_dwordx2 v[64:65], v144, s[8:11], s35 offen offset:2048
  s_mov_b32 s35, 75776
  buffer_load_dwordx2 v[46:47], v144, s[8:11], s35 offen offset:0
  buffer_load_dwordx2 v[48:49], v144, s[8:11], s35 offen offset:512
  buffer_load_dwordx2 v[50:51], v144, s[8:11], s35 offen offset:1024
  buffer_load_dwordx2 v[52:53], v144, s[8:11], s35 offen offset:1536
  buffer_load_dwordx2 v[54:55], v144, s[8:11], s35 offen offset:2048
  s_mov_b32 s35, 78336
  buffer_load_dwordx2 v[76:77], v144, s[8:11], s35 offen offset:0
  buffer_load_dwordx2 v[78:79], v144, s[8:11], s35 offen offset:512
  buffer_load_dwordx2 v[80:81], v144, s[8:11], s35 offen offset:1024
  buffer_load_dwordx2 v[82:83], v144, s[8:11], s35 offen offset:1536
  buffer_load_dwordx2 v[84:85], v144, s[8:11], s35 offen offset:2048
  buffer_load_dword v22, v143, s[28:31], 0 offen offset:0
  buffer_load_dword v23, v143, s[28:31], 0 offen offset:256
  buffer_load_dword v24, v143, s[28:31], 0 offen offset:512
  buffer_load_dword v25, v143, s[28:31], 0 offen offset:768
  buffer_load_dword v26, v143, s[28:31], 0 offen offset:1024
  v_lshlrev_b32 v147, 4, v1
  v_add_u32 v147, 8192, v147
  s_lshl_b32 s35, s16, 7
  s_add_u32 s35, s35, 8192
  v_and_b32 v140, 31, v1
  v_lshl_add_u32 v150, v140, 2, s35
  s_waitcnt vmcnt(0)
  v_add_f32 v46, 1.0, v46
  v_add_f32 v47, 1.0, v47
  v_cvt_pk_bf16_f32 v140, v46, v47
  v_lshlrev_b32 v46, 16, v140
  v_and_b32 v47, 0xffff0000, v140
  v_add_f32 v48, 1.0, v48
  v_add_f32 v49, 1.0, v49
  v_cvt_pk_bf16_f32 v140, v48, v49
  v_lshlrev_b32 v48, 16, v140
  v_and_b32 v49, 0xffff0000, v140
  v_add_f32 v50, 1.0, v50
  v_add_f32 v51, 1.0, v51
  v_cvt_pk_bf16_f32 v140, v50, v51
  v_lshlrev_b32 v50, 16, v140
  v_and_b32 v51, 0xffff0000, v140
  v_add_f32 v52, 1.0, v52
  v_add_f32 v53, 1.0, v53
  v_cvt_pk_bf16_f32 v140, v52, v53
  v_lshlrev_b32 v52, 16, v140
  v_and_b32 v53, 0xffff0000, v140
  v_add_f32 v54, 1.0, v54
  v_add_f32 v55, 1.0, v55
  v_cvt_pk_bf16_f32 v140, v54, v55
  v_lshlrev_b32 v54, 16, v140
  v_and_b32 v55, 0xffff0000, v140
  v_lshlrev_b32 v86, 16, v22
  v_and_b32 v87, 0xffff0000, v22
  v_lshlrev_b32 v88, 16, v23
  v_and_b32 v89, 0xffff0000, v23
  v_lshlrev_b32 v90, 16, v24
  v_and_b32 v91, 0xffff0000, v24
  v_lshlrev_b32 v92, 16, v25
  v_and_b32 v93, 0xffff0000, v25
  v_lshlrev_b32 v94, 16, v26
  v_and_b32 v95, 0xffff0000, v26
  s_mov_b32 s33, s16
r_loop:
  s_lshl_b32 s40, s33, 4
  s_add_u32 s40, s40, s32
  s_mul_i32 s37, s40, 1280
  s_lshr_b32 s39, s33, 1
  s_mul_i32 s38, s39, 327680
  s_and_b32 s35, s40, 31
  s_mul_i32 s35, s35, 1280
  s_add_u32 s38, s38, s35
  s_add_u32 s38, s38, 226492416
  s_add_u32 s39, s39, 1
  buffer_load_dword v22, v143, s[20:23], s37 offen offset:0
  buffer_load_dword v23, v143, s[20:23], s37 offen offset:256
  buffer_load_dword v24, v143, s[20:23], s37 offen offset:512
  buffer_load_dword v25, v143, s[20:23], s37 offen offset:768
  buffer_load_dword v26, v143, s[20:23], s37 offen offset:1024
  s_mov_b32 s34, 0
pw_22:
  buffer_load_dword v146, v150, s[8:11], 0 offen sc1
  s_add_u32 s34, s34, 1
  s_cmp_gt_u32 s34, 65536
  s_cbranch_scc1 role_abort
  s_waitcnt vmcnt(0)
pc_24:
  v_cmp_gt_u32 vcc, s39, v146
  s_nop 0
  s_and_b32 vcc_lo, vcc_lo, 0xfffff
  s_and_b32 vcc_hi, vcc_hi, 0x0
  s_cmp_eq_u64 vcc, 0
  s_cbranch_scc1 po_23
  s_sleep 8
  s_branch pw_22
po_23:
  s_sleep 4
  s_mov_b32 s34, 0
r_poll:
  buffer_load_dwordx4 v[152:155], v147, s[8:11], 0 offen sc1
  s_add_u32 s34, s34, 1
  s_cmp_gt_u32 s34, 65536
  s_cbranch_scc1 role_abort
  s_waitcnt vmcnt(0)
  v_min3_u32 v140, v152, v153, v154
  v_min_u32 v140, v140, v155
  v_cmp_gt_u32 vcc, s39, v140
  s_nop 0
  s_and_b32 vcc_lo, vcc_lo, 0x1f1f1f1f
  s_and_b32 vcc_hi, vcc_hi, 0x1f1f1f1f
  s_cmp_eq_u64 vcc, 0
  s_cbranch_scc1 r_go
  s_sleep 8
  s_branch r_poll
r_go:
  buffer_load_dword v96, v143, s[8:11], s38 offen offset:0 sc1
  buffer_load_dword v97, v143, s[8:11], s38 offen offset:256 sc1
  buffer_load_dword v98, v143, s[8:11], s38 offen offset:512 sc1
  buffer_load_dword v99, v143, s[8:11], s38 offen offset:768 sc1
  buffer_load_dword v100, v143, s[8:11], s38 offen offset:1024 sc1
  s_add_u32 s38, s38, 40960
  buffer_load_dword v101, v143, s[8:11], s38 offen offset:0 sc1
  buffer_load_dword v102, v143, s[8:11], s38 offen offset:256 sc1
  buffer_load_dword v103, v143, s[8:11], s38 offen offset:512 sc1
  buffer_load_dword v104, v143, s[8:11], s38 offen offset:768 sc1
  buffer_load_dword v105, v143, s[8:11], s38 offen offset:1024 sc1
  s_add_u32 s38, s38, 40960
  buffer_load_dword v106, v143, s[8:11], s38 offen offset:0 sc1
  buffer_load_dword v107, v143, s[8:11], s38 offen offset:256 sc1
  buffer_load_dword v108, v143, s[8:11], s38 offen offset:512 sc1
  buffer_load_dword v109, v143, s[8:11], s38 offen offset:768 sc1
  buffer_load_dword v110, v143, s[8:11], s38 offen offset:1024 sc1
  s_add_u32 s38, s38, 40960
  buffer_load_dword v111, v143, s[8:11], s38 offen offset:0 sc1
  buffer_load_dword v112, v143, s[8:11], s38 offen offset:256 sc1
  buffer_load_dword v113, v143, s[8:11], s38 offen offset:512 sc1
  buffer_load_dword v114, v143, s[8:11], s38 offen offset:768 sc1
  buffer_load_dword v115, v143, s[8:11], s38 offen offset:1024 sc1
  s_add_u32 s38, s38, 40960
  buffer_load_dword v116, v143, s[8:11], s38 offen offset:0 sc1
  buffer_load_dword v117, v143, s[8:11], s38 offen offset:256 sc1
  buffer_load_dword v118, v143, s[8:11], s38 offen offset:512 sc1
  buffer_load_dword v119, v143, s[8:11], s38 offen offset:768 sc1
  buffer_load_dword v120, v143, s[8:11], s38 offen offset:1024 sc1
  s_add_u32 s38, s38, 40960
  buffer_load_dword v121, v143, s[8:11], s38 offen offset:0 sc1
  buffer_load_dword v122, v143, s[8:11], s38 offen offset:256 sc1
  buffer_load_dword v123, v143, s[8:11], s38 offen offset:512 sc1
  buffer_load_dword v124, v143, s[8:11], s38 offen offset:768 sc1
  buffer_load_dword v125, v143, s[8:11], s38 offen offset:1024 sc1
  s_add_u32 s38, s38, 40960
  buffer_load_dword v126, v143, s[8:11], s38 offen offset:0 sc1
  buffer_load_dword v127, v143, s[8:11], s38 offen offset:256 sc1
  buffer_load_dword v128, v143, s[8:11], s38 offen offset:512 sc1
  buffer_load_dword v129, v143, s[8:11], s38 offen offset:768 sc1
  buffer_load_dword v130, v143, s[8:11], s38 offen offset:1024 sc1
  s_add_u32 s38, s38, 40960
  buffer_load_dword v131, v143, s[8:11], s38 offen offset:0 sc1
  buffer_load_dword v132, v143, s[8:11], s38 offen offset:256 sc1
  buffer_load_dword v133, v143, s[8:11], s38 offen offset:512 sc1
  buffer_load_dword v134, v143, s[8:11], s38 offen offset:768 sc1
  buffer_load_dword v135, v143, s[8:11], s38 offen offset:1024 sc1
  s_add_u32 s38, s38, 40960
  v_lshlrev_b32 v2, 16, v22
  v_and_b32 v3, 0xffff0000, v22
  v_lshlrev_b32 v4, 16, v23
  v_and_b32 v5, 0xffff0000, v23
  v_lshlrev_b32 v6, 16, v24
  v_and_b32 v7, 0xffff0000, v24
  v_lshlrev_b32 v8, 16, v25
  v_and_b32 v9, 0xffff0000, v25
  v_lshlrev_b32 v10, 16, v26
  v_and_b32 v11, 0xffff0000, v26
  s_waitcnt vmcnt(35)
  v_lshlrev_b32 v12, 16, v96
  v_and_b32 v13, 0xffff0000, v96
  v_lshlrev_b32 v14, 16, v97
  v_and_b32 v15, 0xffff0000, v97
  v_lshlrev_b32 v16, 16, v98
  v_and_b32 v17, 0xffff0000, v98
  v_lshlrev_b32 v18, 16, v99
  v_and_b32 v19, 0xffff0000, v99
  v_lshlrev_b32 v20, 16, v100
  v_and_b32 v21, 0xffff0000, v100
  s_waitcnt vmcnt(30)
  v_dot2c_f32_bf16 v12, v101, v148
  v_dot2c_f32_bf16 v13, v101, v149
  v_dot2c_f32_bf16 v14, v102, v148
  v_dot2c_f32_bf16 v15, v102, v149
  v_dot2c_f32_bf16 v16, v103, v148
  v_dot2c_f32_bf16 v17, v103, v149
  v_dot2c_f32_bf16 v18, v104, v148
  v_dot2c_f32_bf16 v19, v104, v149
  v_dot2c_f32_bf16 v20, v105, v148
  v_dot2c_f32_bf16 v21, v105, v149
  s_waitcnt vmcnt(25)
  v_dot2c_f32_bf16 v12, v106, v148
  v_dot2c_f32_bf16 v13, v106, v149
  v_dot2c_f32_bf16 v14, v107, v148
  v_dot2c_f32_bf16 v15, v107, v149
  v_dot2c_f32_bf16 v16, v108, v148
  v_dot2c_f32_bf16 v17, v108, v149
  v_dot2c_f32_bf16 v18, v109, v148
  v_dot2c_f32_bf16 v19, v109, v149
  v_dot2c_f32_bf16 v20, v110, v148
  v_dot2c_f32_bf16 v21, v110, v149
  s_waitcnt vmcnt(20)
  v_dot2c_f32_bf16 v12, v111, v148
  v_dot2c_f32_bf16 v13, v111, v149
  v_dot2c_f32_bf16 v14, v112, v148
  v_dot2c_f32_bf16 v15, v112, v149
  v_dot2c_f32_bf16 v16, v113, v148
  v_dot2c_f32_bf16 v17, v113, v149
  v_dot2c_f32_bf16 v18, v114, v148
  v_dot2c_f32_bf16 v19, v114, v149
  v_dot2c_f32_bf16 v20, v115, v148
  v_dot2c_f32_bf16 v21, v115, v149
  s_waitcnt vmcnt(15)
  v_dot2c_f32_bf16 v12, v116, v148
  v_dot2c_f32_bf16 v13, v116, v149
  v_dot2c_f32_bf16 v14, v117, v148
  v_dot2c_f32_bf16 v15, v117, v149
  v_dot2c_f32_bf16 v16, v118, v148
  v_dot2c_f32_bf16 v17, v118, v149
  v_dot2c_f32_bf16 v18, v119, v148
  v_dot2c_f32_bf16 v19, v119, v149
  v_dot2c_f32_bf16 v20, v120, v148
  v_dot2c_f32_bf16 v21, v120, v149
  s_waitcnt vmcnt(10)
  v_dot2c_f32_bf16 v12, v121, v148
  v_dot2c_f32_bf16 v13, v121, v149
  v_dot2c_f32_bf16 v14, v122, v148
  v_dot2c_f32_bf16 v15, v122, v149
  v_dot2c_f32_bf16 v16, v123, v148
  v_dot2c_f32_bf16 v17, v123, v149
  v_dot2c_f32_bf16 v18, v124, v148
  v_dot2c_f32_bf16 v19, v124, v149
  v_dot2c_f32_bf16 v20, v125, v148
  v_dot2c_f32_bf16 v21, v125, v149
  s_waitcnt vmcnt(5)
  v_dot2c_f32_bf16 v12, v126, v148
  v_dot2c_f32_bf16 v13, v126, v149
  v_dot2c_f32_bf16 v14, v127, v148
  v_dot2c_f32_bf16 v15, v127, v149
  v_dot2c_f32_bf16 v16, v128, v148
  v_dot2c_f32_bf16 v17, v128, v149
  v_dot2c_f32_bf16 v18, v129, v148
  v_dot2c_f32_bf16 v19, v129, v149
  v_dot2c_f32_bf16 v20, v130, v148
  v_dot2c_f32_bf16 v21, v130, v149
  s_waitcnt vmcnt(0)
  v_dot2c_f32_bf16 v12, v131, v148
  v_dot2c_f32_bf16 v13, v131, v149
  v_dot2c_f32_bf16 v14, v132, v148
  v_dot2c_f32_bf16 v15, v132, v149
  v_dot2c_f32_bf16 v16, v133, v148
  v_dot2c_f32_bf16 v17, v133, v149
  v_dot2c_f32_bf16 v18, v134, v148
  v_dot2c_f32_bf16 v19, v134, v149
  v_dot2c_f32_bf16 v20, v135, v148
  v_dot2c_f32_bf16 v21, v135, v149
  v_cvt_pk_bf16_f32 v140, v12, v13
  v_lshlrev_b32 v12, 16, v140
  v_and_b32 v13, 0xffff0000, v140
  v_cvt_pk_bf16_f32 v140, v14, v15
  v_lshlrev_b32 v14, 16, v140
  v_and_b32 v15, 0xffff0000, v140
  v_cvt_pk_bf16_f32 v140, v16, v17
  v_lshlrev_b32 v16, 16, v140
  v_and_b32 v17, 0xffff0000, v140
  v_cvt_pk_bf16_f32 v140, v18, v19
  v_lshlrev_b32 v18, 16, v140
  v_and_b32 v19, 0xffff0000, v140
  v_cvt_pk_bf16_f32 v140, v20, v21
  v_lshlrev_b32 v20, 16, v140
  v_and_b32 v21, 0xffff0000, v140
  v_pk_mul_f32 v[12:13], v[12:13], v[66:67]
  v_cvt_pk_bf16_f32 v140, v12, v13
  v_lshlrev_b32 v12, 16, v140
  v_and_b32 v13, 0xffff0000, v140
  v_pk_mul_f32 v[14:15], v[14:15], v[68:69]
  v_cvt_pk_bf16_f32 v140, v14, v15
  v_lshlrev_b32 v14, 16, v140
  v_and_b32 v15, 0xffff0000, v140
  v_pk_mul_f32 v[16:17], v[16:17], v[70:71]
  v_cvt_pk_bf16_f32 v140, v16, v17
  v_lshlrev_b32 v16, 16, v140
  v_and_b32 v17, 0xffff0000, v140
  v_pk_mul_f32 v[18:19], v[18:19], v[72:73]
  v_cvt_pk_bf16_f32 v140, v18, v19
  v_lshlrev_b32 v18, 16, v140
  v_and_b32 v19, 0xffff0000, v140
  v_pk_mul_f32 v[20:21], v[20:21], v[74:75]
  v_cvt_pk_bf16_f32 v140, v20, v21
  v_lshlrev_b32 v20, 16, v140
  v_and_b32 v21, 0xffff0000, v140
  v_pk_add_f32 v[2:3], v[2:3], v[12:13]
  v_cvt_pk_bf16_f32 v34, v2, v3
  v_lshlrev_b32 v2, 16, v34
  v_and_b32 v3, 0xffff0000, v34
  v_pk_add_f32 v[4:5], v[4:5], v[14:15]
  v_cvt_pk_bf16_f32 v35, v4, v5
  v_lshlrev_b32 v4, 16, v35
  v_and_b32 v5, 0xffff0000, v35
  v_pk_add_f32 v[6:7], v[6:7], v[16:17]
  v_cvt_pk_bf16_f32 v36, v6, v7
  v_lshlrev_b32 v6, 16, v36
  v_and_b32 v7, 0xffff0000, v36
  v_pk_add_f32 v[8:9], v[8:9], v[18:19]
  v_cvt_pk_bf16_f32 v37, v8, v9
  v_lshlrev_b32 v8, 16, v37
  v_and_b32 v9, 0xffff0000, v37
  v_pk_add_f32 v[10:11], v[10:11], v[20:21]
  v_cvt_pk_bf16_f32 v38, v10, v11
  v_lshlrev_b32 v10, 16, v38
  v_and_b32 v11, 0xffff0000, v38
  s_add_u32 s35, s37, 5242880
  buffer_store_dword v34, v143, s[8:11], s35 offen offset:0 sc1
  buffer_store_dword v35, v143, s[8:11], s35 offen offset:256 sc1
  buffer_store_dword v36, v143, s[8:11], s35 offen offset:512 sc1
  buffer_store_dword v37, v143, s[8:11], s35 offen offset:768 sc1
  buffer_store_dword v38, v143, s[8:11], s35 offen offset:1024 sc1
  v_pk_add_f32 v[136:137], v[2:3], v[4:5]
  v_pk_add_f32 v[138:139], v[6:7], v[8:9]
  v_pk_add_f32 v[136:137], v[136:137], v[10:11]
  v_pk_add_f32 v[136:137], v[136:137], v[138:139]
  v_add_f32 v136, v136, v137
  s_nop 1
  v_add_f32_dpp v136, v136, v136 row_ror:8 row_mask:0xf bank_mask:0xf
  s_nop 1
  v_add_f32_dpp v136, v136, v136 row_ror:4 row_mask:0xf bank_mask:0xf
  s_nop 1
  v_add_f32_dpp v136, v136, v136 row_ror:2 row_mask:0xf bank_mask:0xf
  s_nop 1
  v_add_f32_dpp v136, v136, v136 row_ror:1 row_mask:0xf bank_mask:0xf
  v_mov_b32 v140, v136
  s_nop 1
  v_permlane16_swap_b32 v136, v140
  v_add_f32 v136, v136, v140
  v_mov_b32 v140, v136
  s_nop 1
  v_permlane32_swap_b32 v136, v140
  v_add_f32 v136, v136, v140
  v_mul_f32 v138, 0xbacccccd, v136
  v_mul_f32 v139, 0xbacccccd, v136
  v_pk_add_f32 v[12:13], v[2:3], v[138:139]
  v_pk_add_f32 v[14:15], v[4:5], v[138:139]
  v_pk_add_f32 v[16:17], v[6:7], v[138:139]
  v_pk_add_f32 v[18:19], v[8:9], v[138:139]
  v_pk_add_f32 v[20:21], v[10:11], v[138:139]
  v_pk_mul_f32 v[136:137], v[12:13], v[12:13]
  v_pk_fma_f32 v[136:137], v[14:15], v[14:15], v[136:137]
  v_pk_fma_f32 v[136:137], v[16:17], v[16:17], v[136:137]
  v_pk_fma_f32 v[136:137], v[18:19], v[18:19], v[136:137]
  v_pk_fma_f32 v[136:137], v[20:21], v[20:21], v[136:137]
  v_add_f32 v136, v136, v137
  v_cvt_pk_bf16_f32 v141, v138, v139
  v_lshlrev_b32 v138, 16, v141
  v_and_b32 v139, 0xffff0000, v141
  v_add_f32_dpp v136, v136, v136 row_ror:8 row_mask:0xf bank_mask:0xf
  s_nop 1
  v_add_f32_dpp v136, v136, v136 row_ror:4 row_mask:0xf bank_mask:0xf
  s_nop 1
  v_add_f32_dpp v136, v136, v136 row_ror:2 row_mask:0xf bank_mask:0xf
  s_nop 1
  v_add_f32_dpp v136, v136, v136 row_ror:1 row_mask:0xf bank_mask:0xf
  v_mov_b32 v140, v136
  s_nop 1
  v_permlane16_swap_b32 v136, v140
  v_add_f32 v136, v136, v140
  v_mov_b32 v140, v136
  s_nop 1
  v_permlane32_swap_b32 v136, v140
  v_add_f32 v136, v136, v140
  v_pk_add_f32 v[12:13], v[2:3], v[138:139]
  v_pk_add_f32 v[14:15], v[4:5], v[138:139]
  v_pk_add_f32 v[16:17], v[6:7], v[138:139]
  v_pk_add_f32 v[18:19], v[8:9], v[138:139]
  v_pk_add_f32 v[20:21], v[10:11], v[138:139]
  v_mul_f32 v136, 0x3acccccd, v136
  v_cvt_pk_bf16_f32 v136, v136, v136
  v_lshlrev_b32 v136, 16, v136
  v_add_f32 v136, 0x3727c5ac, v136
  v_cvt_pk_bf16_f32 v136, v136, v136
  v_lshlrev_b32 v136, 16, v136
  v_sqrt_f32 v136, v136
  v_cvt_pk_bf16_f32 v140, v12, v13
  v_lshlrev_b32 v12, 16, v140
  v_and_b32 v13, 0xffff0000, v140
  v_cvt_pk_bf16_f32 v136, v136, v136
  v_lshlrev_b32 v136, 16, v136
  v_rcp_f32 v136, v136
  v_cvt_pk_bf16_f32 v140, v14, v15
  v_lshlrev_b32 v14, 16, v140
  v_and_b32 v15, 0xffff0000, v140
  v_cvt_pk_bf16_f32 v140, v16, v17
  v_lshlrev_b32 v16, 16, v140
  v_and_b32 v17, 0xffff0000, v140
  v_cvt_pk_bf16_f32 v140, v18, v19
  v_lshlrev_b32 v18, 16, v140
  v_and_b32 v19, 0xffff0000, v140
  v_cvt_pk_bf16_f32 v140, v20, v21
  v_lshlrev_b32 v20, 16, v140
  v_and_b32 v21, 0xffff0000, v140
  v_mov_b32 v137, v136
  v_pk_mul_f32 v[12:13], v[12:13], v[136:137]
  v_cvt_pk_bf16_f32 v140, v12, v13
  v_lshlrev_b32 v12, 16, v140
  v_and_b32 v13, 0xffff0000, v140
  v_pk_mul_f32 v[14:15], v[14:15], v[136:137]
  v_cvt_pk_bf16_f32 v140, v14, v15
  v_lshlrev_b32 v14, 16, v140
  v_and_b32 v15, 0xffff0000, v140
  v_pk_mul_f32 v[16:17], v[16:17], v[136:137]
  v_cvt_pk_bf16_f32 v140, v16, v17
  v_lshlrev_b32 v16, 16, v140
  v_and_b32 v17, 0xffff0000, v140
  v_pk_mul_f32 v[18:19], v[18:19], v[136:137]
  v_cvt_pk_bf16_f32 v140, v18, v19
  v_lshlrev_b32 v18, 16, v140
  v_and_b32 v19, 0xffff0000, v140
  v_pk_mul_f32 v[20:21], v[20:21], v[136:137]
  v_cvt_pk_bf16_f32 v140, v20, v21
  v_lshlrev_b32 v20, 16, v140
  v_and_b32 v21, 0xffff0000, v140
  v_pk_mul_f32 v[12:13], v[12:13], v[46:47]
  v_cvt_pk_bf16_f32 v140, v12, v13
  v_lshlrev_b32 v12, 16, v140
  v_and_b32 v13, 0xffff0000, v140
  v_pk_mul_f32 v[14:15], v[14:15], v[48:49]
  v_cvt_pk_bf16_f32 v140, v14, v15
  v_lshlrev_b32 v14, 16, v140
  v_and_b32 v15, 0xffff0000, v140
  v_pk_mul_f32 v[16:17], v[16:17], v[50:51]
  v_cvt_pk_bf16_f32 v140, v16, v17
  v_lshlrev_b32 v16, 16, v140
  v_and_b32 v17, 0xffff0000, v140
  v_pk_mul_f32 v[18:19], v[18:19], v[52:53]
  v_cvt_pk_bf16_f32 v140, v18, v19
  v_lshlrev_b32 v18, 16, v140
  v_and_b32 v19, 0xffff0000, v140
  v_pk_mul_f32 v[20:21], v[20:21], v[54:55]
  v_cvt_pk_bf16_f32 v140, v20, v21
  v_lshlrev_b32 v20, 16, v140
  v_and_b32 v21, 0xffff0000, v140
  v_pk_add_f32 v[12:13], v[12:13], v[56:57]
  v_cvt_pk_bf16_f32 v28, v12, v13
  v_pk_add_f32 v[14:15], v[14:15], v[58:59]
  v_cvt_pk_bf16_f32 v29, v14, v15
  v_pk_add_f32 v[16:17], v[16:17], v[60:61]
  v_cvt_pk_bf16_f32 v30, v16, v17
  v_pk_add_f32 v[18:19], v[18:19], v[62:63]
  v_cvt_pk_bf16_f32 v31, v18, v19
  v_pk_add_f32 v[20:21], v[20:21], v[64:65]
  v_cvt_pk_bf16_f32 v32, v20, v21
  s_add_u32 s35, s37, 8388608
  buffer_store_dword v28, v143, s[8:11], s35 offen offset:0 sc1
  buffer_store_dword v29, v143, s[8:11], s35 offen offset:256 sc1
  buffer_store_dword v30, v143, s[8:11], s35 offen offset:512 sc1
  buffer_store_dword v31, v143, s[8:11], s35 offen offset:768 sc1
  buffer_store_dword v32, v143, s[8:11], s35 offen offset:1024 sc1
  v_lshlrev_b32 v12, 16, v28
  v_and_b32 v13, 0xffff0000, v28
  v_lshlrev_b32 v14, 16, v29
  v_and_b32 v15, 0xffff0000, v29
  v_lshlrev_b32 v16, 16, v30
  v_and_b32 v17, 0xffff0000, v30
  v_lshlrev_b32 v18, 16, v31
  v_and_b32 v19, 0xffff0000, v31
  v_lshlrev_b32 v20, 16, v32
  v_and_b32 v21, 0xffff0000, v32
  v_pk_mul_f32 v[136:137], v[12:13], v[86:87]
  v_pk_fma_f32 v[136:137], v[14:15], v[88:89], v[136:137]
  v_pk_fma_f32 v[136:137], v[16:17], v[90:91], v[136:137]
  v_pk_fma_f32 v[136:137], v[18:19], v[92:93], v[136:137]
  v_pk_fma_f32 v[136:137], v[20:21], v[94:95], v[136:137]
  v_add_f32 v136, v136, v137
  v_pk_mul_f32 v[12:13], v[12:13], v[76:77]
  v_cvt_pk_bf16_f32 v140, v12, v13
  v_lshlrev_b32 v12, 16, v140
  v_and_b32 v13, 0xffff0000, v140
  v_pk_mul_f32 v[14:15], v[14:15], v[78:79]
  v_cvt_pk_bf16_f32 v140, v14, v15
  v_lshlrev_b32 v14, 16, v140
  v_and_b32 v15, 0xffff0000, v140
  v_pk_mul_f32 v[16:17], v[16:17], v[80:81]
  v_cvt_pk_bf16_f32 v140, v16, v17
  v_lshlrev_b32 v16, 16, v140
  v_and_b32 v17, 0xffff0000, v140
  v_pk_mul_f32 v[18:19], v[18:19], v[82:83]
  v_cvt_pk_bf16_f32 v140, v18, v19
  v_lshlrev_b32 v18, 16, v140
  v_and_b32 v19, 0xffff0000, v140
  v_pk_mul_f32 v[20:21], v[20:21], v[84:85]
  v_cvt_pk_bf16_f32 v140, v20, v21
  v_lshlrev_b32 v20, 16, v140
  v_and_b32 v21, 0xffff0000, v140
  v_pk_add_f32 v[12:13], v[12:13], v[2:3]
  v_cvt_pk_bf16_f32 v40, v12, v13
  v_pk_add_f32 v[14:15], v[14:15], v[4:5]
  v_cvt_pk_bf16_f32 v41, v14, v15
  v_pk_add_f32 v[16:17], v[16:17], v[6:7]
  v_cvt_pk_bf16_f32 v42, v16, v17
  v_pk_add_f32 v[18:19], v[18:19], v[8:9]
  v_cvt_pk_bf16_f32 v43, v18, v19
  v_pk_add_f32 v[20:21], v[20:21], v[10:11]
  v_cvt_pk_bf16_f32 v44, v20, v21
  buffer_store_dword v40, v143, s[24:27], s37 offen offset:0 sc1
  buffer_store_dword v41, v143, s[24:27], s37 offen offset:256 sc1
  buffer_store_dword v42, v143, s[24:27], s37 offen offset:512 sc1
  buffer_store_dword v43, v143, s[24:27], s37 offen offset:768 sc1
  buffer_store_dword v44, v143, s[24:27], s37 offen offset:1024 sc1
  v_add_f32_dpp v136, v136, v136 row_ror:8 row_mask:0xf bank_mask:0xf
  s_nop 1
  v_add_f32_dpp v136, v136, v136 row_ror:4 row_mask:0xf bank_mask:0xf
  s_nop 1
  v_add_f32_dpp v136, v136, v136 row_ror:2 row_mask:0xf bank_mask:0xf
  s_nop 1
  v_add_f32_dpp v136, v136, v136 row_ror:1 row_mask:0xf bank_mask:0xf
  v_mov_b32 v140, v136
  s_nop 1
  v_permlane16_swap_b32 v136, v140
  v_add_f32 v136, v136, v140
  v_mov_b32 v140, v136
  s_nop 1
  v_permlane32_swap_b32 v136, v140
  v_add_f32 v136, v136, v140
  v_cvt_pk_bf16_f32 v136, v136, v136
  v_lshlrev_b32 v136, 16, v136
  v_ashrrev_i32 v140, 31, v136
  v_or_b32 v140, 0x80000000, v140
  v_xor_b32 v136, v136, v140
  v_and_b32 v136, 0xffff0000, v136
  s_sub_u32 s35, 2047, s40
  v_or_b32 v136, s35, v136
  s_lshr_b32 s35, s40, 2
  s_lshl_b32 s35, s35, 7
  s_lshl_b32 s36, s17, 2
  s_add_u32 s35, s35, s36
  s_add_u32 s35, s35, 2097152
  v_mov_b32 v141, s35
  s_waitcnt vmcnt(0)
  s_mov_b64 exec, 1
  buffer_store_dword v136, v141, s[8:11], 0 offen sc1
  s_mov_b64 exec, -1
  s_add_u32 s33, s33, 8
  s_cmp_lt_u32 s33, 128
  s_cbranch_scc1 r_loop
  s_endpgm
role_chain:
  s_load_dwordx2 s[20:21], s[0:1], 16
  s_mov_b32 s22, 7864320
  s_mov_b32 s23, 0x00020000
  s_load_dwordx2 s[24:25], s[0:1], 24
  s_mov_b32 s26, 7864320
  s_mov_b32 s27, 0x00020000
  s_load_dwordx2 s[28:29], s[0:1], 32
  s_mov_b32 s30, 7864320
  s_mov_b32 s31, 0x00020000
  s_load_dwordx2 s[32:33], s[0:1], 40
  s_mov_b32 s34, 7864320
  s_mov_b32 s35, 0x00020000
  s_mov_b32 s36, s18
  s_mul_i32 s37, s36, 43
  s_lshr_b32 s37, s37, 7
  s_mul_i32 s42, s37, 3
  s_sub_u32 s38, s36, s42
  s_lshl_b32 s39, s16, 2
  s_add_u32 s39, s39, s37
  v_lshrrev_b32 v140, 4, v1
  v_and_b32 v140, 3, v140
  v_lshlrev_b32 v140, 1, v140
  v_and_b32 v4, 7, v1
  v_xor_b32 v4, v4, v140
  v_lshlrev_b32 v4, 4, v4
  v_lshrrev_b32 v140, 3, v1
  v_mul_u32_u24 v140, 12288, v140
  v_add_u32 v4, v4, v140
  s_lshl_b32 s42, s17, 1
  v_lshrrev_b32 v140, 2, v1
  v_lshrrev_b32 v141, 1, v140
  v_and_b32 v141, 3, v141
  v_lshlrev_b32 v141, 1, v141
  v_bfe_u32 v5, v1, 1, 1
  v_add_u32 v5, s42, v5
  v_xor_b32 v5, v5, v141
  v_lshlrev_b32 v5, 4, v5
  v_lshlrev_b32 v140, 7, v140
  v_add_u32 v5, v5, v140
  v_and_b32 v140, 1, v1
  v_lshlrev_b32 v140, 3, v140
  v_add_u32 v5, v5, v140
  v_add_u32 v6, 40960, v5
  v_add_u32 v7, 81920, v5
  v_add_u32 v8, 122880, v5
  s_mul_i32 s43, s39, 384
  s_lshl_b32 s42, s38, 7
  s_add_u32 s43, s43, s42
  s_mul_i32 s42, s17, 1966080
  s_add_u32 s43, s43, s42
  s_waitcnt lgkmcnt(0)
  s_mov_b32 s44, s43
  s_mul_i32 s45, s17, 20480
  s_add_u32 s45, s45, 0
  s_mov_b32 m0, s45
  s_add_u32 s45, s45, 1024
  buffer_load_dwordx4 v4, s[20:23], s44 offen lds
  s_add_u32 s44, s44, 98304
  s_mov_b32 m0, s45
  s_add_u32 s45, s45, 1024
  buffer_load_dwordx4 v4, s[20:23], s44 offen lds
  s_add_u32 s44, s44, 98304
  s_mov_b32 m0, s45
  s_add_u32 s45, s45, 1024
  buffer_load_dwordx4 v4, s[20:23], s44 offen lds
  s_add_u32 s44, s44, 98304
  s_mov_b32 m0, s45
  s_add_u32 s45, s45, 1024
  buffer_load_dwordx4 v4, s[20:23], s44 offen lds
  s_add_u32 s44, s44, 98304
  s_mov_b32 m0, s45
  s_add_u32 s45, s45, 1024
  buffer_load_dwordx4 v4, s[20:23], s44 offen lds
  s_add_u32 s44, s44, 98304
  s_mov_b32 m0, s45
  s_add_u32 s45, s45, 1024
  buffer_load_dwordx4 v4, s[20:23], s44 offen lds
  s_add_u32 s44, s44, 98304
  s_mov_b32 m0, s45
  s_add_u32 s45, s45, 1024
  buffer_load_dwordx4 v4, s[20:23], s44 offen lds
  s_add_u32 s44, s44, 98304
  s_mov_b32 m0, s45
  s_add_u32 s45, s45, 1024
  buffer_load_dwordx4 v4, s[20:23], s44 offen lds
  s_add_u32 s44, s44, 98304
  s_mov_b32 m0, s45
  s_add_u32 s45, s45, 1024
  buffer_load_dwordx4 v4, s[20:23], s44 offen lds
  s_add_u32 s44, s44, 98304
  s_mov_b32 m0, s45
  s_add_u32 s45, s45, 1024
  buffer_load_dwordx4 v4, s[20:23], s44 offen lds
  s_add_u32 s44, s44, 98304
  s_mov_b32 m0, s45
  s_add_u32 s45, s45, 1024
  buffer_load_dwordx4 v4, s[20:23], s44 offen lds
  s_add_u32 s44, s44, 98304
  s_mov_b32 m0, s45
  s_add_u32 s45, s45, 1024
  buffer_load_dwordx4 v4, s[20:23], s44 offen lds
  s_add_u32 s44, s44, 98304
  s_mov_b32 m0, s45
  s_add_u32 s45, s45, 1024
  buffer_load_dwordx4 v4, s[20:23], s44 offen lds
  s_add_u32 s44, s44, 98304
  s_mov_b32 m0, s45
  s_add_u32 s45, s45, 1024
  buffer_load_dwordx4 v4, s[20:23], s44 offen lds
  s_add_u32 s44, s44, 98304
  s_mov_b32 m0, s45
  s_add_u32 s45, s45, 1024
  buffer_load_dwordx4 v4, s[20:23], s44 offen lds
  s_add_u32 s44, s44, 98304
  s_mov_b32 m0, s45
  s_add_u32 s45, s45, 1024
  buffer_load_dwordx4 v4, s[20:23], s44 offen lds
  s_add_u32 s44, s44, 98304
  s_mov_b32 m0, s45
  s_add_u32 s45, s45, 1024
  buffer_load_dwordx4 v4, s[20:23], s44 offen lds
  s_add_u32 s44, s44, 98304
  s_mov_b32 m0, s45
  s_add_u32 s45, s45, 1024
  buffer_load_dwordx4 v4, s[20:23], s44 offen lds
  s_add_u32 s44, s44, 98304
  s_mov_b32 m0, s45
  s_add_u32 s45, s45, 1024
  buffer_load_dwordx4 v4, s[20:23], s44 offen lds
  s_add_u32 s44, s44, 98304
  s_mov_b32 m0, s45
  s_add_u32 s45, s45, 1024
  buffer_load_dwordx4 v4, s[20:23], s44 offen lds
  s_add_u32 s44, s44, 98304
  s_mov_b32 s44, s43
  s_mul_i32 s45, s17, 20480
  s_add_u32 s45, s45, 81920
  s_mov_b32 m0, s45
  s_add_u32 s45, s45, 1024
  buffer_load_dwordx4 v4, s[24:27], s44 offen lds
  s_add_u32 s44, s44, 98304
  s_mov_b32 m0, s45
  s_add_u32 s45, s45, 1024
  buffer_load_dwordx4 v4, s[24:27], s44 offen lds
  s_add_u32 s44, s44, 98304
  s_mov_b32 m0, s45
  s_add_u32 s45, s45, 1024
  buffer_load_dwordx4 v4, s[24:27], s44 offen lds
  s_add_u32 s44, s44, 98304
  s_mov_b32 m0, s45
  s_add_u32 s45, s45, 1024
  buffer_load_dwordx4 v4, s[24:27], s44 offen lds
  s_add_u32 s44, s44, 98304
  s_mov_b32 m0, s45
  s_add_u32 s45, s45, 1024
  buffer_load_dwordx4 v4, s[24:27], s44 offen lds
  s_add_u32 s44, s44, 98304
  s_mov_b32 m0, s45
  s_add_u32 s45, s45, 1024
  buffer_load_dwordx4 v4, s[24:27], s44 offen lds
  s_add_u32 s44, s44, 98304
  s_mov_b32 m0, s45
  s_add_u32 s45, s45, 1024
  buffer_load_dwordx4 v4, s[24:27], s44 offen lds
  s_add_u32 s44, s44, 98304
  s_mov_b32 m0, s45
  s_add_u32 s45, s45, 1024
  buffer_load_dwordx4 v4, s[24:27], s44 offen lds
  s_add_u32 s44, s44, 98304
  s_mov_b32 m0, s45
  s_add_u32 s45, s45, 1024
  buffer_load_dwordx4 v4, s[24:27], s44 offen lds
  s_add_u32 s44, s44, 98304
  s_mov_b32 m0, s45
  s_add_u32 s45, s45, 1024
  buffer_load_dwordx4 v4, s[24:27], s44 offen lds
  s_add_u32 s44, s44, 98304
  s_mov_b32 m0, s45
  s_add_u32 s45, s45, 1024
  buffer_load_dwordx4 v4, s[24:27], s44 offen lds
  s_add_u32 s44, s44, 98304
  s_mov_b32 m0, s45
  s_add_u32 s45, s45, 1024
  buffer_load_dwordx4 v4, s[24:27], s44 offen lds
  s_add_u32 s44, s44, 98304
  s_mov_b32 m0, s45
  s_add_u32 s45, s45, 1024
  buffer_load_dwordx4 v4, s[24:27], s44 offen lds
  s_add_u32 s44, s44, 98304
  s_mov_b32 m0, s45
  s_add_u32 s45, s45, 1024
  buffer_load_dwordx4 v4, s[24:27], s44 offen lds
  s_add_u32 s44, s44, 98304
  s_mov_b32 m0, s45
  s_add_u32 s45, s45, 1024
  buffer_load_dwordx4 v4, s[24:27], s44 offen lds
  s_add_u32 s44, s44, 98304
  s_mov_b32 m0, s45
  s_add_u32 s45, s45, 1024
  buffer_load_dwordx4 v4, s[24:27], s44 offen lds
  s_add_u32 s44, s44, 98304
  s_mov_b32 m0, s45
  s_add_u32 s45, s45, 1024
  buffer_load_dwordx4 v4, s[24:27], s44 offen lds
  s_add_u32 s44, s44, 98304
  s_mov_b32 m0, s45
  s_add_u32 s45, s45, 1024
  buffer_load_dwordx4 v4, s[24:27], s44 offen lds
  s_add_u32 s44, s44, 98304
  s_mov_b32 m0, s45
  s_add_u32 s45, s45, 1024
  buffer_load_dwordx4 v4, s[24:27], s44 offen lds
  s_add_u32 s44, s44, 98304
  s_mov_b32 m0, s45
  s_add_u32 s45, s45, 1024
  buffer_load_dwordx4 v4, s[24:27], s44 offen lds
  s_add_u32 s44, s44, 98304
  s_waitcnt vmcnt(20)
  s_barrier
  ds_read_b64_tr_b16 a[0:1], v5 offset:0
  ds_read_b64_tr_b16 a[2:3], v5 offset:2048
  ds_read_b64_tr_b16 a[4:5], v5 offset:4096
  ds_read_b64_tr_b16 a[6:7], v5 offset:6144
  ds_read_b64_tr_b16 a[8:9], v5 offset:8192
  ds_read_b64_tr_b16 a[10:11], v5 offset:10240
  ds_read_b64_tr_b16 a[12:13], v5 offset:12288
  ds_read_b64_tr_b16 a[14:15], v5 offset:14336
  ds_read_b64_tr_b16 a[16:17], v5 offset:16384
  ds_read_b64_tr_b16 a[18:19], v5 offset:18432
  ds_read_b64_tr_b16 a[20:21], v5 offset:20480
  ds_read_b64_tr_b16 a[22:23], v5 offset:22528
  ds_read_b64_tr_b16 a[24:25], v5 offset:24576
  ds_read_b64_tr_b16 a[26:27], v5 offset:26624
  ds_read_b64_tr_b16 a[28:29], v5 offset:28672
  ds_read_b64_tr_b16 a[30:31], v5 offset:30720
  ds_read_b64_tr_b16 a[32:33], v5 offset:32768
  ds_read_b64_tr_b16 a[34:35], v5 offset:34816
  ds_read_b64_tr_b16 a[36:37], v5 offset:36864
  ds_read_b64_tr_b16 a[38:39], v5 offset:38912
  ds_read_b64_tr_b16 a[40:41], v6 offset:0
  ds_read_b64_tr_b16 a[42:43], v6 offset:2048
  ds_read_b64_tr_b16 a[44:45], v6 offset:4096
  ds_read_b64_tr_b16 a[46:47], v6 offset:6144
  ds_read_b64_tr_b16 a[48:49], v6 offset:8192
  ds_read_b64_tr_b16 a[50:51], v6 offset:10240
  ds_read_b64_tr_b16 a[52:53], v6 offset:12288
  ds_read_b64_tr_b16 a[54:55], v6 offset:14336
  ds_read_b64_tr_b16 a[56:57], v6 offset:16384
  ds_read_b64_tr_b16 a[58:59], v6 offset:18432
  ds_read_b64_tr_b16 a[60:61], v6 offset:20480
  ds_read_b64_tr_b16 a[62:63], v6 offset:22528
  ds_read_b64_tr_b16 a[64:65], v6 offset:24576
  ds_read_b64_tr_b16 a[66:67], v6 offset:26624
  ds_read_b64_tr_b16 a[68:69], v6 offset:28672
  ds_read_b64_tr_b16 a[70:71], v6 offset:30720
  ds_read_b64_tr_b16 a[72:73], v6 offset:32768
  ds_read_b64_tr_b16 a[74:75], v6 offset:34816
  ds_read_b64_tr_b16 a[76:77], v6 offset:36864
  ds_read_b64_tr_b16 a[78:79], v6 offset:38912
  s_waitcnt lgkmcnt(0)
  s_barrier
  s_mov_b32 s44, s43
  s_mul_i32 s45, s17, 20480
  s_add_u32 s45, s45, 0
  s_mov_b32 m0, s45
  s_add_u32 s45, s45, 1024
  buffer_load_dwordx4 v4, s[28:31], s44 offen lds
  s_add_u32 s44, s44, 98304
  s_mov_b32 m0, s45
  s_add_u32 s45, s45, 1024
  buffer_load_dwordx4 v4, s[28:31], s44 offen lds
  s_add_u32 s44, s44, 98304
  s_mov_b32 m0, s45
  s_add_u32 s45, s45, 1024
  buffer_load_dwordx4 v4, s[28:31], s44 offen lds
  s_add_u32 s44, s44, 98304
  s_mov_b32 m0, s45
  s_add_u32 s45, s45, 1024
  buffer_load_dwordx4 v4, s[28:31], s44 offen lds
  s_add_u32 s44, s44, 98304
  s_mov_b32 m0, s45
  s_add_u32 s45, s45, 1024
  buffer_load_dwordx4 v4, s[28:31], s44 offen lds
  s_add_u32 s44, s44, 98304
  s_mov_b32 m0, s45
  s_add_u32 s45, s45, 1024
  buffer_load_dwordx4 v4, s[28:31], s44 offen lds
  s_add_u32 s44, s44, 98304
  s_mov_b32 m0, s45
  s_add_u32 s45, s45, 1024
  buffer_load_dwordx4 v4, s[28:31], s44 offen lds
  s_add_u32 s44, s44, 98304
  s_mov_b32 m0, s45
  s_add_u32 s45, s45, 1024
  buffer_load_dwordx4 v4, s[28:31], s44 offen lds
  s_add_u32 s44, s44, 98304
  s_mov_b32 m0, s45
  s_add_u32 s45, s45, 1024
  buffer_load_dwordx4 v4, s[28:31], s44 offen lds
  s_add_u32 s44, s44, 98304
  s_mov_b32 m0, s45
  s_add_u32 s45, s45, 1024
  buffer_load_dwordx4 v4, s[28:31], s44 offen lds
  s_add_u32 s44, s44, 98304
  s_mov_b32 m0, s45
  s_add_u32 s45, s45, 1024
  buffer_load_dwordx4 v4, s[28:31], s44 offen lds
  s_add_u32 s44, s44, 98304
  s_mov_b32 m0, s45
  s_add_u32 s45, s45, 1024
  buffer_load_dwordx4 v4, s[28:31], s44 offen lds
  s_add_u32 s44, s44, 98304
  s_mov_b32 m0, s45
  s_add_u32 s45, s45, 1024
  buffer_load_dwordx4 v4, s[28:31], s44 offen lds
  s_add_u32 s44, s44, 98304
  s_mov_b32 m0, s45
  s_add_u32 s45, s45, 1024
  buffer_load_dwordx4 v4, s[28:31], s44 offen lds
  s_add_u32 s44, s44, 98304
  s_mov_b32 m0, s45
  s_add_u32 s45, s45, 1024
  buffer_load_dwordx4 v4, s[28:31], s44 offen lds
  s_add_u32 s44, s44, 98304
  s_mov_b32 m0, s45
  s_add_u32 s45, s45, 1024
  buffer_load_dwordx4 v4, s[28:31], s44 offen lds
  s_add_u32 s44, s44, 98304
  s_mov_b32 m0, s45
  s_add_u32 s45, s45, 1024
  buffer_load_dwordx4 v4, s[28:31], s44 offen lds
  s_add_u32 s44, s44, 98304
  s_mov_b32 m0, s45
  s_add_u32 s45, s45, 1024
  buffer_load_dwordx4 v4, s[28:31], s44 offen lds
  s_add_u32 s44, s44, 98304
  s_mov_b32 m0, s45
  s_add_u32 s45, s45, 1024
  buffer_load_dwordx4 v4, s[28:31], s44 offen lds
  s_add_u32 s44, s44, 98304
  s_mov_b32 m0, s45
  s_add_u32 s45, s45, 1024
  buffer_load_dwordx4 v4, s[28:31], s44 offen lds
  s_add_u32 s44, s44, 98304
  s_waitcnt vmcnt(20)
  s_barrier
  ds_read_b64_tr_b16 a[80:81], v7 offset:0
  ds_read_b64_tr_b16 a[82:83], v7 offset:2048
  ds_read_b64_tr_b16 a[84:85], v7 offset:4096
  ds_read_b64_tr_b16 a[86:87], v7 offset:6144
  ds_read_b64_tr_b16 a[88:89], v7 offset:8192
  ds_read_b64_tr_b16 a[90:91], v7 offset:10240
  ds_read_b64_tr_b16 a[92:93], v7 offset:12288
  ds_read_b64_tr_b16 a[94:95], v7 offset:14336
  ds_read_b64_tr_b16 a[96:97], v7 offset:16384
  ds_read_b64_tr_b16 a[98:99], v7 offset:18432
  ds_read_b64_tr_b16 a[100:101], v7 offset:20480
  ds_read_b64_tr_b16 a[102:103], v7 offset:22528
  ds_read_b64_tr_b16 a[104:105], v7 offset:24576
  ds_read_b64_tr_b16 a[106:107], v7 offset:26624
  ds_read_b64_tr_b16 a[108:109], v7 offset:28672
  ds_read_b64_tr_b16 a[110:111], v7 offset:30720
  ds_read_b64_tr_b16 a[112:113], v7 offset:32768
  ds_read_b64_tr_b16 a[114:115], v7 offset:34816
  ds_read_b64_tr_b16 a[116:117], v7 offset:36864
  ds_read_b64_tr_b16 a[118:119], v7 offset:38912
  ds_read_b64_tr_b16 a[120:121], v8 offset:0
  ds_read_b64_tr_b16 a[122:123], v8 offset:2048
  ds_read_b64_tr_b16 a[124:125], v8 offset:4096
  ds_read_b64_tr_b16 a[126:127], v8 offset:6144
  ds_read_b64_tr_b16 a[128:129], v8 offset:8192
  ds_read_b64_tr_b16 a[130:131], v8 offset:10240
  ds_read_b64_tr_b16 a[132:133], v8 offset:12288
  ds_read_b64_tr_b16 a[134:135], v8 offset:14336
  ds_read_b64_tr_b16 a[136:137], v8 offset:16384
  ds_read_b64_tr_b16 a[138:139], v8 offset:18432
  ds_read_b64_tr_b16 a[140:141], v8 offset:20480
  ds_read_b64_tr_b16 a[142:143], v8 offset:22528
  ds_read_b64_tr_b16 a[144:145], v8 offset:24576
  ds_read_b64_tr_b16 a[146:147], v8 offset:26624
  ds_read_b64_tr_b16 a[148:149], v8 offset:28672
  ds_read_b64_tr_b16 a[150:151], v8 offset:30720
  ds_read_b64_tr_b16 a[152:153], v8 offset:32768
  ds_read_b64_tr_b16 a[154:155], v8 offset:34816
  ds_read_b64_tr_b16 a[156:157], v8 offset:36864
  ds_read_b64_tr_b16 a[158:159], v8 offset:38912
  s_waitcnt lgkmcnt(0)
  s_barrier
  v_lshrrev_b32 v140, 4, v1
  v_and_b32 v140, 3, v140
  v_lshlrev_b32 v140, 1, v140
  v_and_b32 v9, 7, v1
  v_xor_b32 v9, v9, v140
  v_lshlrev_b32 v9, 4, v9
  v_lshrrev_b32 v140, 3, v1
  v_mul_u32_u24 v140, 0, v140
  v_add_u32 v9, v9, v140
  v_bfe_u32 v140, v1, 3, 2
  v_lshlrev_b32 v140, 2, v140
  v_bfe_u32 v141, v1, 5, 1
  v_lshl_add_u32 v140, v141, 1, v140
  v_mul_u32_u24 v140, 1280, v140
  v_add_u32 v9, v9, v140
  v_lshrrev_b32 v140, 2, v1
  v_lshrrev_b32 v141, 1, v140
  v_and_b32 v141, 3, v141
  v_lshlrev_b32 v141, 1, v141
  v_bfe_u32 v10, v1, 1, 1
  v_add_u32 v10, 0, v10
  v_xor_b32 v10, v10, v141
  v_lshlrev_b32 v10, 4, v10
  v_lshlrev_b32 v140, 7, v140
  v_add_u32 v10, v10, v140
  v_and_b32 v140, 1, v1
  v_lshlrev_b32 v140, 3, v140
  v_add_u32 v10, v10, v140
  v_lshrrev_b32 v140, 2, v1
  v_lshrrev_b32 v141, 1, v140
  v_and_b32 v141, 3, v141
  v_lshlrev_b32 v141, 1, v141
  v_bfe_u32 v11, v1, 1, 1
  v_add_u32 v11, 2, v11
  v_xor_b32 v11, v11, v141
  v_lshlrev_b32 v11, 4, v11
  v_lshlrev_b32 v140, 7, v140
  v_add_u32 v11, v11, v140
  v_and_b32 v140, 1, v1
  v_lshlrev_b32 v140, 3, v140
  v_add_u32 v11, v11, v140
  v_lshrrev_b32 v140, 2, v1
  v_lshrrev_b32 v141, 1, v140
  v_and_b32 v141, 3, v141
  v_lshlrev_b32 v141, 1, v141
  v_bfe_u32 v12, v1, 1, 1
  v_add_u32 v12, 4, v12
  v_xor_b32 v12, v12, v141
  v_lshlrev_b32 v12, 4, v12
  v_lshlrev_b32 v140, 7, v140
  v_add_u32 v12, v12, v140
  v_and_b32 v140, 1, v1
  v_lshlrev_b32 v140, 3, v140
  v_add_u32 v12, v12, v140
  v_lshrrev_b32 v140, 2, v1
  v_lshrrev_b32 v141, 1, v140
  v_and_b32 v141, 3, v141
  v_lshlrev_b32 v141, 1, v141
  v_bfe_u32 v13, v1, 1, 1
  v_add_u32 v13, 6, v13
  v_xor_b32 v13, v13, v141
  v_lshlrev_b32 v13, 4, v13
  v_lshlrev_b32 v140, 7, v140
  v_add_u32 v13, v13, v140
  v_and_b32 v140, 1, v1
  v_lshlrev_b32 v140, 3, v140
  v_add_u32 v13, v13, v140
  s_mul_i32 s45, s17, 20480
  s_add_u32 s45, s45, 81920
  v_add_u32 v10, s45, v10
  v_add_u32 v11, s45, v11
  v_add_u32 v12, s45, v12
  v_add_u32 v13, s45, v13
  s_lshl_b32 s42, s16, 2
  s_add_u32 s42, s42, s17
  s_mul_i32 s44, s42, 245760
  s_min_u32 s42, s36, 9
  s_lshl_b32 s42, s42, 7
  s_add_u32 s44, s44, s42
  s_mov_b32 m0, s45
  s_add_u32 s42, s44, 0
  s_add_u32 s45, s45, 1024
  buffer_load_dwordx4 v9, s[32:35], s42 offen lds
  s_mov_b32 m0, s45
  s_add_u32 s42, s44, 20480
  s_add_u32 s45, s45, 1024
  buffer_load_dwordx4 v9, s[32:35], s42 offen lds
  s_mov_b32 m0, s45
  s_add_u32 s42, s44, 1280
  s_add_u32 s45, s45, 1024
  buffer_load_dwordx4 v9, s[32:35], s42 offen lds
  s_mov_b32 m0, s45
  s_add_u32 s42, s44, 21760
  s_add_u32 s45, s45, 1024
  buffer_load_dwordx4 v9, s[32:35], s42 offen lds
  s_mov_b32 m0, s45
  s_add_u32 s42, s44, 40960
  s_add_u32 s45, s45, 1024
  buffer_load_dwordx4 v9, s[32:35], s42 offen lds
  s_mov_b32 m0, s45
  s_add_u32 s42, s44, 61440
  s_add_u32 s45, s45, 1024
  buffer_load_dwordx4 v9, s[32:35], s42 offen lds
  s_mov_b32 m0, s45
  s_add_u32 s42, s44, 42240
  s_add_u32 s45, s45, 1024
  buffer_load_dwordx4 v9, s[32:35], s42 offen lds
  s_mov_b32 m0, s45
  s_add_u32 s42, s44, 62720
  s_add_u32 s45, s45, 1024
  buffer_load_dwordx4 v9, s[32:35], s42 offen lds
  s_mov_b32 m0, s45
  s_add_u32 s42, s44, 81920
  s_add_u32 s45, s45, 1024
  buffer_load_dwordx4 v9, s[32:35], s42 offen lds
  s_mov_b32 m0, s45
  s_add_u32 s42, s44, 102400
  s_add_u32 s45, s45, 1024
  buffer_load_dwordx4 v9, s[32:35], s42 offen lds
  s_mov_b32 m0, s45
  s_add_u32 s42, s44, 83200
  s_add_u32 s45, s45, 1024
  buffer_load_dwordx4 v9, s[32:35], s42 offen lds
  s_mov_b32 m0, s45
  s_add_u32 s42, s44, 103680
  s_add_u32 s45, s45, 1024
  buffer_load_dwordx4 v9, s[32:35], s42 offen lds
  s_mov_b32 m0, s45
  s_add_u32 s42, s44, 122880
  s_add_u32 s45, s45, 1024
  buffer_load_dwordx4 v9, s[32:35], s42 offen lds
  s_mov_b32 m0, s45
  s_add_u32 s42, s44, 143360
  s_add_u32 s45, s45, 1024
  buffer_load_dwordx4 v9, s[32:35], s42 offen lds
  s_mov_b32 m0, s45
  s_add_u32 s42, s44, 124160
  s_add_u32 s45, s45, 1024
  buffer_load_dwordx4 v9, s[32:35], s42 offen lds
  s_mov_b32 m0, s45
  s_add_u32 s42, s44, 144640
  s_add_u32 s45, s45, 1024
  buffer_load_dwordx4 v9, s[32:35], s42 offen lds
  s_mov_b32 m0, s45
  s_add_u32 s42, s44, 163840
  s_add_u32 s45, s45, 1024
  buffer_load_dwordx4 v9, s[32:35], s42 offen lds
  s_mov_b32 m0, s45
  s_add_u32 s42, s44, 184320
  s_add_u32 s45, s45, 1024
  buffer_load_dwordx4 v9, s[32:35], s42 offen lds
  s_mov_b32 m0, s45
  s_add_u32 s42, s44, 165120
  s_add_u32 s45, s45, 1024
  buffer_load_dwordx4 v9, s[32:35], s42 offen lds
  s_mov_b32 m0, s45
  s_add_u32 s42, s44, 185600
  s_add_u32 s45, s45, 1024
  buffer_load_dwordx4 v9, s[32:35], s42 offen lds
  s_waitcnt vmcnt(20)
  s_barrier
  ds_read_b64_tr_b16 a[160:161], v5 offset:0
  ds_read_b64_tr_b16 a[162:163], v5 offset:2048
  ds_read_b64_tr_b16 a[164:165], v5 offset:4096
  ds_read_b64_tr_b16 a[166:167], v5 offset:6144
  ds_read_b64_tr_b16 a[168:169], v5 offset:8192
  ds_read_b64_tr_b16 a[170:171], v5 offset:10240
  ds_read_b64_tr_b16 a[172:173], v5 offset:12288
  ds_read_b64_tr_b16 a[174:175], v5 offset:14336
  ds_read_b64_tr_b16 a[176:177], v5 offset:16384
  ds_read_b64_tr_b16 a[178:179], v5 offset:18432
  ds_read_b64_tr_b16 a[180:181], v5 offset:20480
  ds_read_b64_tr_b16 a[182:183], v5 offset:22528
  ds_read_b64_tr_b16 a[184:185], v5 offset:24576
  ds_read_b64_tr_b16 a[186:187], v5 offset:26624
  ds_read_b64_tr_b16 a[188:189], v5 offset:28672
  ds_read_b64_tr_b16 a[190:191], v5 offset:30720
  ds_read_b64_tr_b16 a[192:193], v5 offset:32768
  ds_read_b64_tr_b16 a[194:195], v5 offset:34816
  ds_read_b64_tr_b16 a[196:197], v5 offset:36864
  ds_read_b64_tr_b16 a[198:199], v5 offset:38912
  ds_read_b64_tr_b16 a[200:201], v6 offset:0
  ds_read_b64_tr_b16 a[202:203], v6 offset:2048
  ds_read_b64_tr_b16 a[204:205], v6 offset:4096
  ds_read_b64_tr_b16 a[206:207], v6 offset:6144
  ds_read_b64_tr_b16 a[208:209], v6 offset:8192
  ds_read_b64_tr_b16 a[210:211], v6 offset:10240
  ds_read_b64_tr_b16 a[212:213], v6 offset:12288
  ds_read_b64_tr_b16 a[214:215], v6 offset:14336
  ds_read_b64_tr_b16 a[216:217], v6 offset:16384
  ds_read_b64_tr_b16 a[218:219], v6 offset:18432
  ds_read_b64_tr_b16 a[220:221], v6 offset:20480
  ds_read_b64_tr_b16 a[222:223], v6 offset:22528
  ds_read_b64_tr_b16 a[224:225], v6 offset:24576
  ds_read_b64_tr_b16 a[226:227], v6 offset:26624
  ds_read_b64_tr_b16 a[228:229], v6 offset:28672
  ds_read_b64_tr_b16 a[230:231], v6 offset:30720
  ds_read_b64_tr_b16 a[232:233], v6 offset:32768
  ds_read_b64_tr_b16 a[234:235], v6 offset:34816
  ds_read_b64_tr_b16 a[236:237], v6 offset:36864
  ds_read_b64_tr_b16 a[238:239], v6 offset:38912
  s_waitcnt vmcnt(0)
  ds_read_b64_tr_b16 v[176:177], v10 offset:0
  ds_read_b64_tr_b16 v[178:179], v10 offset:2048
  ds_read_b64_tr_b16 v[200:201], v11 offset:0
  ds_read_b64_tr_b16 v[202:203], v11 offset:2048
  ds_read_b64_tr_b16 v[224:225], v12 offset:0
  ds_read_b64_tr_b16 v[226:227], v12 offset:2048
  ds_read_b64_tr_b16 v[248:249], v13 offset:0
  ds_read_b64_tr_b16 v[250:251], v13 offset:2048
  ds_read_b64_tr_b16 v[180:181], v10 offset:4096
  ds_read_b64_tr_b16 v[182:183], v10 offset:6144
  ds_read_b64_tr_b16 v[204:205], v11 offset:4096
  ds_read_b64_tr_b16 v[206:207], v11 offset:6144
  ds_read_b64_tr_b16 v[228:229], v12 offset:4096
  ds_read_b64_tr_b16 v[230:231], v12 offset:6144
  ds_read_b64_tr_b16 v[252:253], v13 offset:4096
  ds_read_b64_tr_b16 v[254:255], v13 offset:6144
  ds_read_b64_tr_b16 v[184:185], v10 offset:8192
  ds_read_b64_tr_b16 v[186:187], v10 offset:10240
  ds_read_b64_tr_b16 v[208:209], v11 offset:8192
  ds_read_b64_tr_b16 v[210:211], v11 offset:10240
  ds_read_b64_tr_b16 v[232:233], v12 offset:8192
  ds_read_b64_tr_b16 v[234:235], v12 offset:10240
  ds_read_b64_tr_b16 a[240:241], v13 offset:8192
  ds_read_b64_tr_b16 a[242:243], v13 offset:10240
  ds_read_b64_tr_b16 v[188:189], v10 offset:12288
  ds_read_b64_tr_b16 v[190:191], v10 offset:14336
  ds_read_b64_tr_b16 v[212:213], v11 offset:12288
  ds_read_b64_tr_b16 v[214:215], v11 offset:14336
  ds_read_b64_tr_b16 v[236:237], v12 offset:12288
  ds_read_b64_tr_b16 v[238:239], v12 offset:14336
  ds_read_b64_tr_b16 a[244:245], v13 offset:12288
  ds_read_b64_tr_b16 a[246:247], v13 offset:14336
  ds_read_b64_tr_b16 v[192:193], v10 offset:16384
  ds_read_b64_tr_b16 v[194:195], v10 offset:18432
  ds_read_b64_tr_b16 v[216:217], v11 offset:16384
  ds_read_b64_tr_b16 v[218:219], v11 offset:18432
  ds_read_b64_tr_b16 v[240:241], v12 offset:16384
  ds_read_b64_tr_b16 v[242:243], v12 offset:18432
  ds_read_b64_tr_b16 a[248:249], v13 offset:16384
  ds_read_b64_tr_b16 a[250:251], v13 offset:18432
  s_waitcnt lgkmcnt(0)
  s_sub_u32 s45, s45, 20480
  s_mov_b32 m0, s45
  s_add_u32 s42, s44, 204800
  s_add_u32 s45, s45, 1024
  buffer_load_dwordx4 v9, s[32:35], s42 offen lds
  s_mov_b32 m0, s45
  s_add_u32 s42, s44, 225280
  s_add_u32 s45, s45, 1024
  buffer_load_dwordx4 v9, s[32:35], s42 offen lds
  s_mov_b32 m0, s45
  s_add_u32 s42, s44, 206080
  s_add_u32 s45, s45, 1024
  buffer_load_dwordx4 v9, s[32:35], s42 offen lds
  s_mov_b32 m0, s45
  s_add_u32 s42, s44, 226560
  s_add_u32 s45, s45, 1024
  buffer_load_dwordx4 v9, s[32:35], s42 offen lds
  s_waitcnt vmcnt(0)
  ds_read_b64_tr_b16 v[196:197], v10 offset:0
  ds_read_b64_tr_b16 v[198:199], v10 offset:2048
  ds_read_b64_tr_b16 v[220:221], v11 offset:0
  ds_read_b64_tr_b16 v[222:223], v11 offset:2048
  ds_read_b64_tr_b16 v[244:245], v12 offset:0
  ds_read_b64_tr_b16 v[246:247], v12 offset:2048
  ds_read_b64_tr_b16 a[252:253], v13 offset:0
  ds_read_b64_tr_b16 a[254:255], v13 offset:2048
  s_waitcnt lgkmcnt(0)
  s_barrier
  v_mov_b32 v84, -1
  v_mov_b32 v88, 0x3f803f80
  v_mov_b32 v85, -1
  v_mov_b32 v89, 0x3f803f80
  v_mov_b32 v86, -1
  v_mov_b32 v90, 0x3f803f80
  v_mov_b32 v87, -1
  v_mov_b32 v91, 0x3f803f80
  v_lshlrev_b32 v124, 4, v1
  v_lshlrev_b32 v125, 3, v1
  s_mul_i32 s42, s17, 2560
  v_add_u32 v126, s42, v124
  s_add_u32 s42, s42, 2048
  v_add_u32 v127, s42, v125
  v_lshrrev_b32 v4, 4, v1
  v_and_b32 v5, 7, v1
  v_bfe_u32 v6, v1, 3, 1
  v_and_b32 v7, 15, v1
  v_bfe_u32 v140, v1, 1, 1
  v_mul_u32_u24 v140, 0xaaaa, v140
  v_add_u32 v136, 0x4444, v140
  v_bfe_u32 v140, v1, 2, 1
  v_mov_b32 v137, 0x05040100
  v_mov_b32 v141, 0x03020706
  v_cmp_eq_u32 vcc, 1, v140
  s_nop 1
  v_cndmask_b32 v137, v137, v141, vcc
  s_lshl_b32 s42, s17, 9
  s_add_u32 s42, s42, 10240
  v_lshlrev_b32 v140, 5, v7
  v_lshl_add_u32 v140, v4, 2, v140
  v_add_u32 v128, s42, v140
  v_lshl_add_u32 v129, v4, 2, v128
  v_add_u32 v129, 2048, v129
  s_lshl_b32 s42, s17, 8
  v_lshl_add_u32 v130, v1, 2, s42
  s_lshl_b32 s42, s36, 10
  v_add_u32 v133, s42, v130
  s_lshl_b32 s42, s38, 10
  s_lshl_b32 s43, s38, 2
  s_add_u32 s43, s43, 3072
  s_cmp_lt_u32 s17, 2
  s_cselect_b32 s56, s42, s43
  s_add_u32 s43, s42, 4096
  s_cmp_eq_u32 s17, 0
  s_cselect_b32 s79, s42, s43
  s_cmp_eq_u32 s17, 2
  s_cselect_b32 s79, 3072, s79
  v_bfe_u32 v140, v1, 2, 2
  v_lshlrev_b32 v140, 1, v140
  v_and_b32 v141, 1, v1
  v_add_u32 v140, v140, v141
  v_lshl_add_u32 v140, v4, 3, v140
  v_lshlrev_b32 v140, 4, v140
  v_add_u32 v138, s42, v140
  v_lshl_add_u32 v142, v4, 3, v5
  v_lshlrev_b32 v142, 4, v142
  s_lshl_b32 s42, s17, 11
  s_add_u32 s42, s42, 14336
  v_add_u32 v131, s42, v142
  s_lshr_b32 s42, s17, 1
  s_lshl_b32 s42, s42, 10
  s_and_b32 s43, s17, 1
  s_lshl_b32 s43, s43, 8
  s_add_u32 s42, s42, s43
  s_add_u32 s42, s42, 14336
  v_and_b32 v140, 3, v1
  v_lshlrev_b32 v140, 5, v140
  v_bfe_u32 v141, v1, 4, 1
  v_lshl_add_u32 v140, v141, 4, v140
  v_bfe_u32 v141, v1, 5, 1
  v_lshl_add_u32 v140, v141, 3, v140
  v_bfe_u32 v141, v1, 2, 1
  v_lshl_add_u32 v140, v141, 9, v140
  v_bfe_u32 v141, v1, 3, 1
  v_lshl_add_u32 v140, v141, 7, v140
  v_add_u32 v132, s42, v140
  s_mov_b32 s66, 0x00ff00ff
  s_mov_b32 s67, 0x00ff00ff
  s_mov_b32 s68, 0xff00ff00
  s_mov_b32 s69, 0xff00ff00
  s_cmp_eq_u32 s17, 0
  s_cselect_b64 s[70:71], s[66:67], s[68:69]
  s_mul_i32 s46, s16, 10240
  s_add_u32 s46, s46, 131072
  s_add_u32 s47, s46, 81920
  s_lshl_b32 s42, s16, 17
  s_add_u32 s42, s42, 393216
  s_lshl_b32 s43, s37, 13
  s_add_u32 s48, s42, s43
  s_lshl_b32 s43, s17, 13
  s_add_u32 s49, s42, s43
  s_mul_i32 s57, s39, 196608
  s_add_u32 s57, s57, 16777216
  s_mul_i32 s59, s39, 786432
  s_add_u32 s59, s59, 92274688
  s_and_b32 s42, s17, 1
  s_mul_i32 s42, s42, 6144
  s_add_u32 s59, s59, s42
  s_lshl_b32 s42, s38, 11
  s_add_u32 s59, s59, s42
  s_lshl_b32 s42, s16, 2
  s_add_u32 s42, s42, s17
  s_mul_i32 s60, s42, 2621440
  s_add_u32 s60, s60, 142606336
  s_lshl_b32 s43, s36, 12
  s_add_u32 s60, s60, s43
  s_mul_i32 s58, s42, 655360
  s_add_u32 s58, s58, 25165824
  s_lshl_b32 s43, s36, 10
  s_add_u32 s58, s58, s43
  s_lshl_b32 s64, s36, 14
  s_lshl_b32 s42, s17, 11
  s_add_u32 s64, s64, s42
  s_add_u32 s64, s64, 1441792
  s_lshl_b32 s42, s16, 8
  v_lshlrev_b32 v134, 2, v1
  v_add_u32 v134, s42, v134
  s_lshl_b32 s43, s36, 4
  s_add_u32 s42, s42, s43
  s_lshl_b32 s43, s17, 2
  s_add_u32 s42, s42, s43
  s_add_u32 s42, s42, 4096
  v_mov_b32 v135, s42
  v_mov_b32 v139, 0
  s_mov_b32 s40, 0
  v_and_b32 v140, 15, v1
  v_lshlrev_b32 v170, 2, v1
  v_and_b32 v141, 3, v1
  v_mov_b32 v142, 0
  v_mov_b32 v143, 0x3f80
  v_cmp_eq_u32 vcc, 0, v141
  s_nop 1
  v_cndmask_b32 v142, v142, v143, vcc
  v_mov_b32 v143, 0x3f800000
  v_cmp_eq_u32 vcc, 1, v141
  s_nop 1
  v_cndmask_b32 v142, v142, v143, vcc
  v_lshrrev_b32 v140, 2, v140
  v_mov_b32 v143, 0
  v_cmp_eq_u32 vcc, 0, v140
  s_nop 1
  v_cndmask_b32 v172, v143, v142, vcc
  v_cmp_eq_u32 vcc, 1, v140
  s_nop 1
  v_cndmask_b32 v173, v143, v142, vcc
  v_cmp_eq_u32 vcc, 2, v140
  s_nop 1
  v_cndmask_b32 v174, v143, v142, vcc
  v_cmp_eq_u32 vcc, 3, v140
  s_nop 1
  v_cndmask_b32 v175, v143, v142, vcc
  v_mov_b32 v168, 0x3f803f80
  v_mov_b32 v169, 0
  s_cmp_lt_u32 s36, 10
  s_cbranch_scc0 chain_nw
  s_cmp_lt_u32 s17, 2
  s_cbranch_scc1 chain_pro_c0w
  s_cmp_eq_u32 s17, 2
  s_cbranch_scc1 chain_pro_c1w
  s_branch chain_pro_c2w
chain_nw:
  s_cmp_lt_u32 s17, 2
  s_cbranch_scc1 chain_pro_c0n
  s_cmp_eq_u32 s17, 2
  s_cbranch_scc1 chain_pro_c1n
  s_branch chain_pro_c2n
chain_pro_c0w:
  s_lshl_b32 s42, s16, 8
  s_add_u32 s61, s64, s42
  s_add_u32 s61, s61, 491520
  s_mov_b32 s41, 0
  s_mov_b32 s62, -1
  s_mov_b32 s63, -1
cal_25:
  s_waitcnt vmcnt(0)
  s_memtime s[72:73]
  s_waitcnt lgkmcnt(0)
  buffer_store_dword v84, v170, s[8:11], s61 offen sc1
  s_waitcnt vmcnt(0)
  s_memtime s[74:75]
  s_waitcnt lgkmcnt(0)
  s_sub_u32 s42, s74, s72
  s_min_u32 s42, s42, s62
  s_mov_b32 s62, s63
  s_mov_b32 s63, s42
  s_xor_b32 s61, s61, 8192
  s_add_u32 s41, s41, 1
  s_cmp_lt_u32 s41, 8
  s_cbranch_scc1 cal_25
  s_cmp_lt_u32 s62, s63
  s_cselect_b32 s42, 0, 8192
  s_add_u32 s64, s64, s42
  s_mov_b32 s78, 1
  v_mov_b32 v143, 0
  s_mov_b32 s41, 0
cpw_26:
  v_cmp_gt_u32 vcc, s78, v139
  s_nop 0
  s_and_b32 vcc_lo, vcc_lo, 0xfff000
  s_and_b32 vcc_hi, vcc_hi, 0xfffff0
  s_cmp_eq_u64 vcc, 0
  s_cbranch_scc1 cpo_27
  s_sleep 1
  buffer_load_dword v139, v134, s[8:11], 0 offen sc1
  s_add_u32 s41, s41, 1
  s_cmp_gt_u32 s41, 65536
  s_cbranch_scc1 chain_abort
  s_waitcnt vmcnt(0)
  s_branch cpw_26
cpo_27:
  buffer_load_dwordx4 v[60:63], v124, s[8:11], s59 offen offset:0 sc1
  buffer_load_dwordx4 v[64:67], v124, s[8:11], s59 offen offset:1024 sc1
  s_add_u32 s59, s59, 12288
  s_add_u32 s55, s48, 98304
  s_cmp_ge_u32 s40, 2
  s_cselect_b32 s43, 3072, 0
  s_add_u32 s57, s57, s43
  s_cmp_ge_u32 s40, 2
  s_cselect_b32 s43, 10240, 0
  s_add_u32 s58, s58, s43
  s_add_u32 s54, s55, s79
  s_and_b32 s42, s40, 3
  s_lshl_b32 s43, s42, 15
  s_add_u32 s52, s49, s43
  s_add_u32 s53, s52, 4096
  s_add_u32 s55, s48, s43
  s_add_u32 s50, s55, s56
  s_lshl_b32 s44, s38, 10
  s_add_u32 s51, s55, s44
  s_add_u32 s51, s51, 4096
  s_mul_i32 s62, s42, 163840
  s_add_u32 s62, s62, s64
  s_lshl_b32 s43, s16, 8
  s_add_u32 s61, s62, s43
  s_xor_b32 s63, s61, 8192
  v_mov_b32 v92, 0
  v_mov_b32 v93, 0
  v_mov_b32 v94, 0
  v_mov_b32 v95, 0
  v_mov_b32 v96, 0
  v_mov_b32 v97, 0
  v_mov_b32 v98, 0
  v_mov_b32 v99, 0
  v_mov_b32 v100, 0
  v_mov_b32 v101, 0
  v_mov_b32 v102, 0
  v_mov_b32 v103, 0
  v_mov_b32 v104, 0
  v_mov_b32 v105, 0
  v_mov_b32 v106, 0
  v_mov_b32 v107, 0
  v_mov_b32 v68, 0
  v_mov_b32 v69, 0
  v_mov_b32 v70, 0
  v_mov_b32 v71, 0
  v_mov_b32 v72, 0
  v_mov_b32 v73, 0
  v_mov_b32 v74, 0
  v_mov_b32 v75, 0
  v_mov_b32 v76, 0
  v_mov_b32 v77, 0
  v_mov_b32 v78, 0
  v_mov_b32 v79, 0
chain_loop_c0w:
  s_mov_b32 s41, 0
  buffer_load_dwordx4 v[152:155], v126, s[8:11], s46 offen sc1
  buffer_load_dwordx4 v[156:159], v126, s[8:11], s46 offen offset:1024 sc1
  buffer_load_dwordx2 v[160:161], v127, s[8:11], s46 offen sc1
  s_sleep 2
mq_28:
  buffer_load_dwordx4 v[162:165], v126, s[8:11], s46 offen sc1
  buffer_load_dwordx4 v[108:111], v126, s[8:11], s46 offen offset:1024 sc1
  buffer_load_dwordx2 v[112:113], v127, s[8:11], s46 offen sc1
  s_waitcnt vmcnt(3)
  v_max3_u32 v140, v152, v153, v154
  v_max3_u32 v141, v155, v156, v157
  v_max3_u32 v140, v140, v158, v159
  v_max3_u32 v141, v141, v160, v161
  v_max_u32 v140, v140, v141
  v_cmp_eq_u32 vcc, -1, v140
  s_cbranch_vccz mq_28_a
  buffer_load_dwordx4 v[152:155], v126, s[8:11], s46 offen sc1
  buffer_load_dwordx4 v[156:159], v126, s[8:11], s46 offen offset:1024 sc1
  buffer_load_dwordx2 v[160:161], v127, s[8:11], s46 offen sc1
  s_add_u32 s41, s41, 1
  s_cmp_gt_u32 s41, 65536
  s_cbranch_scc1 chain_abort
  s_waitcnt vmcnt(3)
  v_max3_u32 v140, v162, v163, v164
  v_max3_u32 v141, v165, v108, v109
  v_max3_u32 v140, v140, v110, v111
  v_max3_u32 v141, v141, v112, v113
  v_max_u32 v140, v140, v141
  v_cmp_eq_u32 vcc, -1, v140
  s_cbranch_vccnz mq_28
  ds_write_b128 v126, v[162:165]
  ds_write_b128 v126, v[108:111] offset:1024
  ds_write_b64 v127, v[112:113]
  s_branch mq_28_ok
mq_28_a:
  ds_write_b128 v126, v[152:155]
  ds_write_b128 v126, v[156:159] offset:1024
  ds_write_b64 v127, v[160:161]
mq_28_ok:
  s_waitcnt lgkmcnt(0)
  s_barrier
  ds_read_b128 v[4:7], v124 offset:0
  ds_read_b128 v[8:11], v124 offset:1024
  ds_read_b128 v[12:15], v124 offset:2048
  ds_read_b128 v[16:19], v124 offset:3072
  ds_read_b128 v[20:23], v124 offset:4096
  ds_read_b128 v[24:27], v124 offset:5120
  ds_read_b128 v[28:31], v124 offset:6144
  ds_read_b128 v[32:35], v124 offset:7168
  ds_read_b128 v[36:39], v124 offset:8192
  ds_read_b128 v[40:43], v124 offset:9216
  s_waitcnt lgkmcnt(9)
  v_smfmac_f32_16x16x64_bf16 v[68:71], v[4:7], a[0:7], v136
  v_smfmac_f32_16x16x64_bf16 v[72:75], v[4:7], a[80:87], v136
  buffer_load_dwordx4 v[44:47], v124, s[8:11], s60 offen offset:0 sc1
  s_waitcnt lgkmcnt(8)
  v_smfmac_f32_16x16x64_bf16 v[68:71], v[8:11], a[8:15], v136
  v_smfmac_f32_16x16x64_bf16 v[72:75], v[8:11], a[88:95], v136
  buffer_load_dwordx4 v[48:51], v124, s[8:11], s60 offen offset:1024 sc1
  s_waitcnt lgkmcnt(7)
  v_smfmac_f32_16x16x64_bf16 v[68:71], v[12:15], a[16:23], v136
  v_smfmac_f32_16x16x64_bf16 v[72:75], v[12:15], a[96:103], v136
  buffer_load_dwordx4 v[52:55], v124, s[8:11], s60 offen offset:2048 sc1
  s_waitcnt lgkmcnt(6)
  v_smfmac_f32_16x16x64_bf16 v[68:71], v[16:19], a[24:31], v136
  v_smfmac_f32_16x16x64_bf16 v[72:75], v[16:19], a[104:111], v136
  buffer_load_dwordx4 v[56:59], v124, s[8:11], s60 offen offset:3072 sc1
  s_add_u32 s60, s60, 40960
  s_waitcnt lgkmcnt(5)
  v_smfmac_f32_16x16x64_bf16 v[68:71], v[20:23], a[32:39], v136
  v_smfmac_f32_16x16x64_bf16 v[72:75], v[20:23], a[112:119], v136
  buffer_store_dwordx4 v[80:83], v124, s[8:11], s58 offen
  s_waitcnt lgkmcnt(4)
  v_smfmac_f32_16x16x64_bf16 v[68:71], v[24:27], a[40:47], v136
  v_smfmac_f32_16x16x64_bf16 v[72:75], v[24:27], a[120:127], v136
  buffer_store_dwordx4 v[84:87], v124, s[8:11], s54 offen
  s_waitcnt lgkmcnt(3)
  v_smfmac_f32_16x16x64_bf16 v[68:71], v[28:31], a[48:55], v136
  v_smfmac_f32_16x16x64_bf16 v[72:75], v[28:31], a[128:135], v136
  buffer_load_dword v139, v134, s[8:11], 0 offen sc1
  s_waitcnt lgkmcnt(2)
  v_smfmac_f32_16x16x64_bf16 v[68:71], v[32:35], a[56:63], v136
  v_smfmac_f32_16x16x64_bf16 v[72:75], v[32:35], a[136:143], v136
  s_waitcnt lgkmcnt(1)
  v_smfmac_f32_16x16x64_bf16 v[68:71], v[36:39], a[64:71], v136
  v_smfmac_f32_16x16x64_bf16 v[72:75], v[36:39], a[144:151], v136
  s_waitcnt lgkmcnt(0)
  v_smfmac_f32_16x16x64_bf16 v[68:71], v[40:43], a[72:79], v136
  v_smfmac_f32_16x16x64_bf16 v[72:75], v[40:43], a[152:159], v136
  v_smfmac_f32_16x16x64_bf16 v[76:79], v[4:7], a[160:167], v136
  v_smfmac_f32_16x16x64_bf16 v[76:79], v[8:11], a[168:175], v136
  s_nop 4
  v_add_f32 v68, v68, v70
  v_add_f32 v69, v69, v71
  v_add_f32 v72, v72, v74
  v_add_f32 v73, v73, v75
  v_smfmac_f32_16x16x64_bf16 v[76:79], v[12:15], a[176:183], v136
  v_cvt_pk_bf16_f32 v122, v68, v69
  v_cvt_pk_bf16_f32 v123, v72, v73
  ds_write2_b32 v128, v122, v122 offset0:0 offset1:4
  ds_write2_b32 v129, v123, v123 offset0:0 offset1:1
  v_smfmac_f32_16x16x64_bf16 v[76:79], v[16:19], a[184:191], v136
  v_smfmac_f32_16x16x64_bf16 v[76:79], v[20:23], a[192:199], v136
  s_waitcnt lgkmcnt(0)
  s_barrier
  ds_read_b64_tr_b16 v[144:145], v125 offset:10240
  ds_read_b64_tr_b16 v[146:147], v125 offset:10752
  ds_read_b64_tr_b16 v[148:149], v125 offset:11264
  ds_read_b64_tr_b16 v[150:151], v125 offset:11776
  v_smfmac_f32_16x16x64_bf16 v[76:79], v[24:27], a[200:207], v136
  v_smfmac_f32_16x16x64_bf16 v[76:79], v[28:31], a[208:215], v136
  v_smfmac_f32_16x16x64_bf16 v[76:79], v[32:35], a[216:223], v136
  s_waitcnt lgkmcnt(2)
  v_mfma_f32_16x16x32_bf16 v[80:83], v[60:63], v[144:147], 0
  s_waitcnt lgkmcnt(0)
  v_mfma_f32_16x16x32_bf16 v[80:83], v[64:67], v[148:151], v[80:83]
  v_smfmac_f32_16x16x64_bf16 v[76:79], v[36:39], a[224:231], v136
  v_smfmac_f32_16x16x64_bf16 v[76:79], v[40:43], a[232:239], v136
  s_mov_b64 exec, s[70:71]
  s_nop 4
  buffer_store_dwordx4 v[80:83], v124, s[8:11], s50 offen
  s_mov_b64 exec, -1
  v_add_f32 v76, v76, v78
  v_add_f32 v77, v77, v79
  v_cvt_pk_bf16_f32 v140, v76, v77
  s_nop 1
  v_mov_b32_dpp v141, v140 row_ror:4 row_mask:0xf bank_mask:0xa
  s_nop 1
  v_mov_b32_dpp v141, v140 row_ror:12 row_mask:0xf bank_mask:0x5
  v_perm_b32 v140, v141, v140, v137
  buffer_store_dword v140, v130, s[8:11], s51 offen
  s_sleep 2
  s_nop 3
  s_nop 3
  buffer_load_dwordx4 v[4:7], v124, s[8:11], s52 offen offset:0 sc1
  buffer_load_dwordx4 v[8:11], v124, s[8:11], s52 offen offset:1024 sc1
  buffer_load_dwordx4 v[12:15], v124, s[8:11], s52 offen offset:2048 sc1
  buffer_load_dwordx3 v[16:18], v124, s[8:11], s52 offen offset:3072 sc1
  buffer_load_dwordx4 v[20:23], v124, s[8:11], s53 offen offset:0 sc1
  buffer_load_dwordx4 v[24:27], v124, s[8:11], s53 offen offset:1024 sc1
  buffer_load_dwordx4 v[28:31], v124, s[8:11], s53 offen offset:2048 sc1
  s_mov_b32 s41, 0
  s_waitcnt vmcnt(3)
gs_29_in:
  v_pk_add_f32 v[152:153], v[4:5], v[8:9]
  v_pk_add_f32 v[154:155], v[6:7], v[10:11]
  v_add_f32 v156, v16, v17
  v_pk_add_f32 v[152:153], v[152:153], v[12:13]
  v_pk_add_f32 v[154:155], v[154:155], v[14:15]
  v_add_f32 v156, v156, v18
  v_cmp_u_f32 s[76:77], v152, v153
  v_cmp_u_f32 s[72:73], v154, v155
  v_cmp_u_f32 s[74:75], v156, v156
  v_max3_f32 v140, v152, v153, v154
  s_or_b64 s[72:73], s[76:77], s[72:73]
  v_max3_f32 v140, v140, v155, v156
  s_or_b64 s[72:73], s[72:73], s[74:75]
  s_waitcnt vmcnt(0)
  v_max3_u32 v142, v20, v21, v22
  v_max3_u32 v143, v23, v24, v25
  v_max3_u32 v142, v142, v26, v27
  v_max3_u32 v143, v143, v28, v29
  v_max3_u32 v142, v142, v30, v31
  v_max_u32 v142, v142, v143
  v_cmp_eq_u32 vcc, -1, v142
  s_nop 0
  s_or_b64 vcc, vcc, s[72:73]
  s_cbranch_vccnz gs_29
  v_smfmac_f32_16x16x64_bf16 v[92:95], v[20:23], v[176:183], v136
  v_max_f32_dpp v140, v140, v140 row_ror:8 row_mask:0xf bank_mask:0xf
  v_mov_b32 v141, v140
  v_smfmac_f32_16x16x64_bf16 v[96:99], v[20:23], v[200:207], v136
  v_mul_f32 v152, 0x3dd53b95, v152
  v_mul_f32 v153, 0x3dd53b95, v153
  v_smfmac_f32_16x16x64_bf16 v[100:103], v[20:23], v[224:231], v136
  v_permlane16_swap_b32 v140, v141
  v_max_f32 v140, v140, v141
  v_smfmac_f32_16x16x64_bf16 v[104:107], v[20:23], v[248:255], v136
  v_mov_b32 v141, v140
  v_mul_f32 v154, 0x3dd53b95, v154
  v_smfmac_f32_16x16x64_bf16 v[92:95], v[24:27], v[184:191], v136
  v_mul_f32 v155, 0x3dd53b95, v155
  v_permlane32_swap_b32 v140, v141
  v_smfmac_f32_16x16x64_bf16 v[96:99], v[24:27], v[208:215], v136
  v_max_f32 v140, v140, v141
  v_mul_f32 v156, 0x3dd53b95, v156
  v_smfmac_f32_16x16x64_bf16 v[100:103], v[24:27], v[232:239], v136
  v_mul_f32 v140, 0x3dd53b95, v140
  v_sub_f32 v156, v156, v140
  v_smfmac_f32_16x16x64_bf16 v[104:107], v[24:27], a[240:247], v136
  v_sub_f32 v152, v152, v140
  v_sub_f32 v153, v153, v140
  v_smfmac_f32_16x16x64_bf16 v[92:95], v[28:31], v[192:199], v136
  v_sub_f32 v154, v154, v140
  v_sub_f32 v155, v155, v140
  v_smfmac_f32_16x16x64_bf16 v[96:99], v[28:31], v[216:223], v136
  v_exp_f32 v156, v156
  v_exp_f32 v152, v152
  v_smfmac_f32_16x16x64_bf16 v[100:103], v[28:31], v[240:247], v136
  v_exp_f32 v153, v153
  v_exp_f32 v154, v154
  v_smfmac_f32_16x16x64_bf16 v[104:107], v[28:31], a[248:255], v136
  v_exp_f32 v155, v155
  v_mov_b32_dpp v157, v156 row_ror:8 row_mask:0xf bank_mask:0xf
  v_cvt_pk_bf16_f32 v116, v152, v153
  v_cvt_pk_bf16_f32 v117, v154, v155
  v_cvt_pk_bf16_f32 v120, v156, v157
  v_mov_b32_dpp v118, v116 row_ror:8 row_mask:0xf bank_mask:0xf
  v_mov_b32_dpp v119, v117 row_ror:8 row_mask:0xf bank_mask:0xf
  v_mov_b32 v121, v120
  s_nop 0
  v_mfma_f32_16x16x32_bf16 v[80:83], v[88:91], v[116:119], 0
  v_cvt_pk_bf16_f32 v108, v92, v93
  v_cvt_pk_bf16_f32 v109, v94, v95
  v_mfma_f32_16x16x32_bf16 v[152:155], v[44:47], v[116:119], 0
  v_cvt_pk_bf16_f32 v110, v96, v97
  v_cvt_pk_bf16_f32 v111, v98, v99
  v_mfma_f32_16x16x32_bf16 v[156:159], v[48:51], v[116:119], 0
  v_mfma_f32_16x16x16_bf16 v[80:83], v[168:169], v[120:121], v[80:83]
  v_cvt_pk_bf16_f32 v112, v100, v101
  v_cvt_pk_bf16_f32 v113, v102, v103
  v_mfma_f32_16x16x32_bf16 v[160:163], v[52:55], v[116:119], 0
  v_cvt_pk_bf16_f32 v114, v104, v105
  v_cvt_pk_bf16_f32 v115, v106, v107
  v_mfma_f32_16x16x32_bf16 v[164:167], v[56:59], v[116:119], 0
  s_add_u32 s40, s40, 1
  v_mfma_f32_16x16x16_bf16 v[152:155], v[108:109], v[120:121], v[152:155]
  v_mfma_f32_16x16x16_bf16 v[156:159], v[110:111], v[120:121], v[156:159]
  v_rcp_f32 v122, v80
  v_mfma_f32_16x16x16_bf16 v[160:163], v[112:113], v[120:121], v[160:163]
  s_nop 0
  v_mfma_f32_16x16x16_bf16 v[164:167], v[114:115], v[120:121], v[164:167]
  v_mov_b32 v123, v122
  s_cmp_eq_u32 s40, 64
  s_cbranch_scc1 chain_last_c0w
  s_mov_b64 exec, s[66:67]
  v_pk_mul_f32 v[152:153], v[122:123], v[152:153]
  v_pk_mul_f32 v[154:155], v[122:123], v[154:155]
  ds_write_b128 v131, v[152:155] offset:0
  v_pk_mul_f32 v[156:157], v[122:123], v[156:157]
  v_pk_mul_f32 v[158:159], v[122:123], v[158:159]
  ds_write_b128 v131, v[156:159] offset:512
  v_pk_mul_f32 v[160:161], v[122:123], v[160:161]
  v_pk_mul_f32 v[162:163], v[122:123], v[162:163]
  ds_write_b128 v131, v[160:163] offset:1024
  v_pk_mul_f32 v[164:165], v[122:123], v[164:165]
  v_pk_mul_f32 v[166:167], v[122:123], v[166:167]
  ds_write_b128 v131, v[164:167] offset:1536
  s_mov_b64 exec, -1
  s_waitcnt lgkmcnt(0)
  s_barrier
  ds_read_b64 v[144:145], v132 offset:0
  ds_read_b64 v[146:147], v132 offset:2048
  ds_read_b64 v[148:149], v132 offset:4096
  ds_read_b64 v[150:151], v132 offset:6144
  s_mov_b32 s45, s62
  s_waitcnt lgkmcnt(2)
  v_pk_add_f32 v[144:145], v[144:145], v[146:147]
  s_waitcnt lgkmcnt(0)
  v_pk_add_f32 v[148:149], v[148:149], v[150:151]
  v_pk_add_f32 v[122:123], v[144:145], v[148:149]
  v_cvt_pk_bf16_f32 v122, v122, v123
  buffer_store_dword v122, v170, s[8:11], s63 offen sc1
  buffer_store_dword v122, v170, s[8:11], s61 offen sc1
  s_add_u32 s78, s40, 1
  s_sub_u32 s42, s40, 1
  v_mov_b32 v143, s42
  buffer_store_dword v84, v133, s[8:11], s46 offen
  buffer_store_dword v143, v135, s[8:11], 0 offen
  s_mov_b32 s41, 0
cpw_31:
  v_cmp_gt_u32 vcc, s78, v139
  s_nop 0
  s_and_b32 vcc_lo, vcc_lo, 0xfff000
  s_and_b32 vcc_hi, vcc_hi, 0xfffff0
  s_cmp_eq_u64 vcc, 0
  s_cbranch_scc1 cpo_32
  s_sleep 1
  buffer_load_dword v139, v134, s[8:11], 0 offen sc1
  s_add_u32 s41, s41, 1
  s_cmp_gt_u32 s41, 65536
  s_cbranch_scc1 chain_abort
  s_waitcnt vmcnt(0)
  s_branch cpw_31
cpo_32:
  buffer_load_dwordx4 v[60:63], v124, s[8:11], s59 offen offset:0 sc1
  buffer_load_dwordx4 v[64:67], v124, s[8:11], s59 offen offset:1024 sc1
  s_add_u32 s59, s59, 12288
  v_add_f32 v92, v92, v94
  v_add_f32 v93, v93, v95
  v_cvt_pk_bf16_f32 v80, v92, v93
  v_add_f32 v96, v96, v98
  v_add_f32 v97, v97, v99
  v_cvt_pk_bf16_f32 v81, v96, v97
  v_add_f32 v100, v100, v102
  v_add_f32 v101, v101, v103
  v_cvt_pk_bf16_f32 v82, v100, v101
  v_add_f32 v104, v104, v106
  v_add_f32 v105, v105, v107
  v_cvt_pk_bf16_f32 v83, v104, v105
  s_mov_b32 s42, s46
  s_mov_b32 s46, s47
  s_mov_b32 s47, s42
  s_cmp_ge_u32 s40, 2
  s_cselect_b32 s43, 3072, 0
  s_add_u32 s57, s57, s43
  s_cmp_ge_u32 s40, 2
  s_cselect_b32 s43, 10240, 0
  s_add_u32 s58, s58, s43
  s_add_u32 s54, s55, s79
  s_and_b32 s42, s40, 3
  s_lshl_b32 s43, s42, 15
  s_add_u32 s52, s49, s43
  s_add_u32 s53, s52, 4096
  s_add_u32 s55, s48, s43
  s_add_u32 s50, s55, s56
  s_lshl_b32 s44, s38, 10
  s_add_u32 s51, s55, s44
  s_add_u32 s51, s51, 4096
  s_mul_i32 s62, s42, 163840
  s_add_u32 s62, s62, s64
  s_lshl_b32 s43, s16, 8
  s_add_u32 s61, s62, s43
  s_xor_b32 s63, s61, 8192
  v_mov_b32 v92, 0
  v_mov_b32 v93, 0
  v_mov_b32 v94, 0
  v_mov_b32 v95, 0
  v_mov_b32 v96, 0
  v_mov_b32 v97, 0
  v_mov_b32 v98, 0
  v_mov_b32 v99, 0
  v_mov_b32 v100, 0
  v_mov_b32 v101, 0
  v_mov_b32 v102, 0
  v_mov_b32 v103, 0
  v_mov_b32 v104, 0
  v_mov_b32 v105, 0
  v_mov_b32 v106, 0
  v_mov_b32 v107, 0
  v_mov_b32 v68, 0
  v_mov_b32 v69, 0
  v_mov_b32 v70, 0
  v_mov_b32 v71, 0
  v_mov_b32 v72, 0
  v_mov_b32 v73, 0
  v_mov_b32 v74, 0
  v_mov_b32 v75, 0
  v_mov_b32 v76, 0
  v_mov_b32 v77, 0
  v_mov_b32 v78, 0
  v_mov_b32 v79, 0
  s_sleep 2
  buffer_load_dwordx4 v[4:7], v124, s[8:11], s45 offen offset:0 sc1
  buffer_load_dwordx4 v[8:11], v124, s[8:11], s45 offen offset:1024 sc1
  s_mov_b32 s41, 0
xp_33:
  s_waitcnt vmcnt(0)
  v_mfma_f32_16x16x32_bf16 v[36:39], v[172:175], v[4:7], 0
  v_mfma_f32_16x16x32_bf16 v[36:39], v[172:175], v[8:11], v[36:39]
  s_nop 7
  v_cmp_u_f32 vcc, v36, v37
  v_cvt_pk_bf16_f32 v141, v36, v37
  s_cbranch_vccnz xp_33_r
  buffer_store_dword v141, v133, s[8:11], s46 offen
  s_branch chain_loop_c0w
gs_29:
  v_max3_u32 v142, v4, v5, v6
  v_max_u32 v142, v142, v7
  v_cmp_eq_u32 vcc, -1, v142
  s_cbranch_vccz gs_29_s0
  s_mov_b64 exec, vcc
  buffer_load_dwordx4 v[4:7], v124, s[8:11], s52 offen offset:0 sc1
  s_mov_b64 exec, -1
gs_29_s0:
  v_max3_u32 v142, v8, v9, v10
  v_max_u32 v142, v142, v11
  v_cmp_eq_u32 vcc, -1, v142
  s_cbranch_vccz gs_29_s1
  s_mov_b64 exec, vcc
  buffer_load_dwordx4 v[8:11], v124, s[8:11], s52 offen offset:1024 sc1
  s_mov_b64 exec, -1
gs_29_s1:
  v_max3_u32 v142, v12, v13, v14
  v_max_u32 v142, v142, v15
  v_cmp_eq_u32 vcc, -1, v142
  s_cbranch_vccz gs_29_s2
  s_mov_b64 exec, vcc
  buffer_load_dwordx4 v[12:15], v124, s[8:11], s52 offen offset:2048 sc1
  s_mov_b64 exec, -1
gs_29_s2:
  v_max3_u32 v142, v16, v17, v18
  v_cmp_eq_u32 vcc, -1, v142
  s_cbranch_vccz gs_29_s3
  s_mov_b64 exec, vcc
  buffer_load_dwordx3 v[16:18], v124, s[8:11], s52 offen offset:3072 sc1
  s_mov_b64 exec, -1
gs_29_s3:
  v_max3_u32 v142, v20, v21, v22
  v_max_u32 v142, v142, v23
  v_cmp_eq_u32 vcc, -1, v142
  s_cbranch_vccz gs_29_s4
  s_mov_b64 exec, vcc
  buffer_load_dwordx4 v[20:23], v124, s[8:11], s53 offen offset:0 sc1
  s_mov_b64 exec, -1
gs_29_s4:
  v_max3_u32 v142, v24, v25, v26
  v_max_u32 v142, v142, v27
  v_cmp_eq_u32 vcc, -1, v142
  s_cbranch_vccz gs_29_s5
  s_mov_b64 exec, vcc
  buffer_load_dwordx4 v[24:27], v124, s[8:11], s53 offen offset:1024 sc1
  s_mov_b64 exec, -1
gs_29_s5:
  v_max3_u32 v142, v28, v29, v30
  v_max_u32 v142, v142, v31
  v_cmp_eq_u32 vcc, -1, v142
  s_cbranch_vccz gs_29_s6
  s_mov_b64 exec, vcc
  buffer_load_dwordx4 v[28:31], v124, s[8:11], s53 offen offset:2048 sc1
  s_mov_b64 exec, -1
gs_29_s6:
  s_add_u32 s41, s41, 1
  s_cmp_gt_u32 s41, 65536
  s_cbranch_scc1 chain_abort
  s_waitcnt vmcnt(0)
  s_branch gs_29_in
xp_33_r:
  v_max3_u32 v140, v4, v5, v6
  v_max_u32 v140, v140, v7
  v_cmp_eq_u32 vcc, -1, v140
  s_cbranch_vccz xp_33_s0
  s_mov_b64 exec, vcc
  buffer_load_dwordx4 v[4:7], v124, s[8:11], s45 offen offset:0 sc1
  s_mov_b64 exec, -1
xp_33_s0:
  v_max3_u32 v140, v8, v9, v10
  v_max_u32 v140, v140, v11
  v_cmp_eq_u32 vcc, -1, v140
  s_cbranch_vccz xp_33_s1
  s_mov_b64 exec, vcc
  buffer_load_dwordx4 v[8:11], v124, s[8:11], s45 offen offset:1024 sc1
  s_mov_b64 exec, -1
xp_33_s1:
  s_add_u32 s41, s41, 1
  s_cmp_gt_u32 s41, 65536
  s_cbranch_scc1 chain_abort
  s_branch xp_33
chain_last_c0w:
  s_cmp_ge_u32 s40, 2
  s_cselect_b32 s43, 3072, 0
  s_add_u32 s57, s57, s43
  s_cmp_ge_u32 s40, 2
  s_cselect_b32 s43, 10240, 0
  s_add_u32 s58, s58, s43
  v_add_f32 v92, v92, v94
  v_add_f32 v93, v93, v95
  v_cvt_pk_bf16_f32 v80, v92, v93
  v_add_f32 v96, v96, v98
  v_add_f32 v97, v97, v99
  v_cvt_pk_bf16_f32 v81, v96, v97
  v_add_f32 v100, v100, v102
  v_add_f32 v101, v101, v103
  v_cvt_pk_bf16_f32 v82, v100, v101
  v_add_f32 v104, v104, v106
  v_add_f32 v105, v105, v107
  v_cvt_pk_bf16_f32 v83, v104, v105
  buffer_store_dwordx4 v[80:83], v124, s[8:11], s58 offen
  v_mov_b32 v143, s40
  s_branch chain_fin
chain_pro_c1w:
  s_lshl_b32 s42, s16, 8
  s_add_u32 s61, s64, s42
  s_add_u32 s61, s61, 491520
  s_mov_b32 s41, 0
  s_mov_b32 s62, -1
  s_mov_b32 s63, -1
cal_34:
  s_waitcnt vmcnt(0)
  s_memtime s[72:73]
  s_waitcnt lgkmcnt(0)
  buffer_store_dword v84, v170, s[8:11], s61 offen sc1
  s_waitcnt vmcnt(0)
  s_memtime s[74:75]
  s_waitcnt lgkmcnt(0)
  s_sub_u32 s42, s74, s72
  s_min_u32 s42, s42, s62
  s_mov_b32 s62, s63
  s_mov_b32 s63, s42
  s_xor_b32 s61, s61, 8192
  s_add_u32 s41, s41, 1
  s_cmp_lt_u32 s41, 8
  s_cbranch_scc1 cal_34
  s_cmp_lt_u32 s62, s63
  s_cselect_b32 s42, 0, 8192
  s_add_u32 s64, s64, s42
  s_mov_b32 s78, 1
  v_mov_b32 v143, 0
  s_mov_b32 s41, 0
cpw_35:
  v_cmp_gt_u32 vcc, s78, v139
  s_nop 0
  s_and_b32 vcc_lo, vcc_lo, 0xfff000
  s_and_b32 vcc_hi, vcc_hi, 0xfffff0
  s_cmp_eq_u64 vcc, 0
  s_cbranch_scc1 cpo_36
  s_sleep 1
  buffer_load_dword v139, v134, s[8:11], 0 offen sc1
  s_add_u32 s41, s41, 1
  s_cmp_gt_u32 s41, 65536
  s_cbranch_scc1 chain_abort
  s_waitcnt vmcnt(0)
  s_branch cpw_35
cpo_36:
  s_add_u32 s55, s48, 98304
  s_cmp_ge_u32 s40, 2
  s_cselect_b32 s43, 3072, 0
  s_add_u32 s57, s57, s43
  s_cmp_ge_u32 s40, 2
  s_cselect_b32 s43, 10240, 0
  s_add_u32 s58, s58, s43
  s_add_u32 s54, s55, s79
  s_and_b32 s42, s40, 3
  s_lshl_b32 s43, s42, 15
  s_add_u32 s52, s49, s43
  s_add_u32 s53, s52, 4096
  s_add_u32 s55, s48, s43
  s_add_u32 s50, s55, s56
  s_lshl_b32 s44, s38, 10
  s_add_u32 s51, s55, s44
  s_add_u32 s51, s51, 4096
  s_mul_i32 s62, s42, 163840
  s_add_u32 s62, s62, s64
  s_lshl_b32 s43, s16, 8
  s_add_u32 s61, s62, s43
  s_xor_b32 s63, s61, 8192
  v_mov_b32 v92, 0
  v_mov_b32 v93, 0
  v_mov_b32 v94, 0
  v_mov_b32 v95, 0
  v_mov_b32 v96, 0
  v_mov_b32 v97, 0
  v_mov_b32 v98, 0
  v_mov_b32 v99, 0
  v_mov_b32 v100, 0
  v_mov_b32 v101, 0
  v_mov_b32 v102, 0
  v_mov_b32 v103, 0
  v_mov_b32 v104, 0
  v_mov_b32 v105, 0
  v_mov_b32 v106, 0
  v_mov_b32 v107, 0
  v_mov_b32 v68, 0
  v_mov_b32 v69, 0
  v_mov_b32 v70, 0
  v_mov_b32 v71, 0
  v_mov_b32 v72, 0
  v_mov_b32 v73, 0
  v_mov_b32 v74, 0
  v_mov_b32 v75, 0
  v_mov_b32 v76, 0
  v_mov_b32 v77, 0
  v_mov_b32 v78, 0
  v_mov_b32 v79, 0
chain_loop_c1w:
  s_mov_b32 s41, 0
  buffer_load_dwordx4 v[152:155], v126, s[8:11], s46 offen sc1
  buffer_load_dwordx4 v[156:159], v126, s[8:11], s46 offen offset:1024 sc1
  buffer_load_dwordx2 v[160:161], v127, s[8:11], s46 offen sc1
  s_sleep 2
mq_37:
  buffer_load_dwordx4 v[162:165], v126, s[8:11], s46 offen sc1
  buffer_load_dwordx4 v[108:111], v126, s[8:11], s46 offen offset:1024 sc1
  buffer_load_dwordx2 v[112:113], v127, s[8:11], s46 offen sc1
  s_waitcnt vmcnt(3)
  v_max3_u32 v140, v152, v153, v154
  v_max3_u32 v141, v155, v156, v157
  v_max3_u32 v140, v140, v158, v159
  v_max3_u32 v141, v141, v160, v161
  v_max_u32 v140, v140, v141
  v_cmp_eq_u32 vcc, -1, v140
  s_cbranch_vccz mq_37_a
  buffer_load_dwordx4 v[152:155], v126, s[8:11], s46 offen sc1
  buffer_load_dwordx4 v[156:159], v126, s[8:11], s46 offen offset:1024 sc1
  buffer_load_dwordx2 v[160:161], v127, s[8:11], s46 offen sc1
  s_add_u32 s41, s41, 1
  s_cmp_gt_u32 s41, 65536
  s_cbranch_scc1 chain_abort
  s_waitcnt vmcnt(3)
  v_max3_u32 v140, v162, v163, v164
  v_max3_u32 v141, v165, v108, v109
  v_max3_u32 v140, v140, v110, v111
  v_max3_u32 v141, v141, v112, v113
  v_max_u32 v140, v140, v141
  v_cmp_eq_u32 vcc, -1, v140
  s_cbranch_vccnz mq_37
  ds_write_b128 v126, v[162:165]
  ds_write_b128 v126, v[108:111] offset:1024
  ds_write_b64 v127, v[112:113]
  s_branch mq_37_ok
mq_37_a:
  ds_write_b128 v126, v[152:155]
  ds_write_b128 v126, v[156:159] offset:1024
  ds_write_b64 v127, v[160:161]
mq_37_ok:
  s_waitcnt lgkmcnt(0)
  s_barrier
  ds_read_b128 v[4:7], v124 offset:0
  ds_read_b128 v[8:11], v124 offset:1024
  ds_read_b128 v[12:15], v124 offset:2048
  ds_read_b128 v[16:19], v124 offset:3072
  ds_read_b128 v[20:23], v124 offset:4096
  ds_read_b128 v[24:27], v124 offset:5120
  ds_read_b128 v[28:31], v124 offset:6144
  ds_read_b128 v[32:35], v124 offset:7168
  ds_read_b128 v[36:39], v124 offset:8192
  ds_read_b128 v[40:43], v124 offset:9216
  s_waitcnt lgkmcnt(9)
  v_smfmac_f32_16x16x64_bf16 v[68:71], v[4:7], a[0:7], v136
  v_smfmac_f32_16x16x64_bf16 v[72:75], v[4:7], a[80:87], v136
  buffer_load_dwordx4 v[44:47], v124, s[8:11], s60 offen offset:0 sc1
  s_waitcnt lgkmcnt(8)
  v_smfmac_f32_16x16x64_bf16 v[68:71], v[8:11], a[8:15], v136
  v_smfmac_f32_16x16x64_bf16 v[72:75], v[8:11], a[88:95], v136
  buffer_load_dwordx4 v[48:51], v124, s[8:11], s60 offen offset:1024 sc1
  s_waitcnt lgkmcnt(7)
  v_smfmac_f32_16x16x64_bf16 v[68:71], v[12:15], a[16:23], v136
  v_smfmac_f32_16x16x64_bf16 v[72:75], v[12:15], a[96:103], v136
  buffer_load_dwordx4 v[52:55], v124, s[8:11], s60 offen offset:2048 sc1
  s_waitcnt lgkmcnt(6)
  v_smfmac_f32_16x16x64_bf16 v[68:71], v[16:19], a[24:31], v136
  v_smfmac_f32_16x16x64_bf16 v[72:75], v[16:19], a[104:111], v136
  buffer_load_dwordx4 v[56:59], v124, s[8:11], s60 offen offset:3072 sc1
  s_add_u32 s60, s60, 40960
  s_waitcnt lgkmcnt(5)
  v_smfmac_f32_16x16x64_bf16 v[68:71], v[20:23], a[32:39], v136
  v_smfmac_f32_16x16x64_bf16 v[72:75], v[20:23], a[112:119], v136
  buffer_store_dwordx4 v[80:83], v124, s[8:11], s58 offen
  s_waitcnt lgkmcnt(4)
  v_smfmac_f32_16x16x64_bf16 v[68:71], v[24:27], a[40:47], v136
  v_smfmac_f32_16x16x64_bf16 v[72:75], v[24:27], a[120:127], v136
  buffer_store_dwordx4 v[84:87], v124, s[8:11], s54 offen
  s_waitcnt lgkmcnt(3)
  v_smfmac_f32_16x16x64_bf16 v[68:71], v[28:31], a[48:55], v136
  v_smfmac_f32_16x16x64_bf16 v[72:75], v[28:31], a[128:135], v136
  buffer_load_dword v139, v134, s[8:11], 0 offen sc1
  s_waitcnt lgkmcnt(2)
  v_smfmac_f32_16x16x64_bf16 v[68:71], v[32:35], a[56:63], v136
  v_smfmac_f32_16x16x64_bf16 v[72:75], v[32:35], a[136:143], v136
  s_waitcnt lgkmcnt(1)
  v_smfmac_f32_16x16x64_bf16 v[68:71], v[36:39], a[64:71], v136
  v_smfmac_f32_16x16x64_bf16 v[72:75], v[36:39], a[144:151], v136
  s_waitcnt lgkmcnt(0)
  v_smfmac_f32_16x16x64_bf16 v[68:71], v[40:43], a[72:79], v136
  v_smfmac_f32_16x16x64_bf16 v[72:75], v[40:43], a[152:159], v136
  v_smfmac_f32_16x16x64_bf16 v[76:79], v[4:7], a[160:167], v136
  v_smfmac_f32_16x16x64_bf16 v[76:79], v[8:11], a[168:175], v136
  s_nop 4
  v_add_f32 v68, v68, v70
  v_add_f32 v69, v69, v71
  v_add_f32 v72, v72, v74
  v_add_f32 v73, v73, v75
  v_smfmac_f32_16x16x64_bf16 v[76:79], v[12:15], a[176:183], v136
  v_cvt_pk_bf16_f32 v122, v68, v69
  v_cvt_pk_bf16_f32 v123, v72, v73
  ds_write2_b32 v128, v122, v122 offset0:0 offset1:4
  ds_write2_b32 v129, v123, v123 offset0:0 offset1:1
  v_smfmac_f32_16x16x64_bf16 v[76:79], v[16:19], a[184:191], v136
  v_smfmac_f32_16x16x64_bf16 v[76:79], v[20:23], a[192:199], v136
  s_waitcnt lgkmcnt(0)
  s_barrier
  ds_read_b64_tr_b16 v[144:145], v125 offset:10240
  ds_read_b64_tr_b16 v[60:61], v125 offset:12288
  ds_read_b64_tr_b16 v[146:147], v125 offset:10752
  ds_read_b64_tr_b16 v[62:63], v125 offset:12800
  ds_read_b64_tr_b16 v[148:149], v125 offset:11264
  ds_read_b64_tr_b16 v[64:65], v125 offset:13312
  ds_read_b64_tr_b16 v[150:151], v125 offset:11776
  ds_read_b64_tr_b16 v[66:67], v125 offset:13824
  v_smfmac_f32_16x16x64_bf16 v[76:79], v[24:27], a[200:207], v136
  v_smfmac_f32_16x16x64_bf16 v[76:79], v[28:31], a[208:215], v136
  v_smfmac_f32_16x16x64_bf16 v[76:79], v[32:35], a[216:223], v136
  s_waitcnt lgkmcnt(4)
  v_mfma_f32_16x16x32_bf16 v[80:83], v[60:63], v[144:147], 0
  s_waitcnt lgkmcnt(0)
  v_mfma_f32_16x16x32_bf16 v[80:83], v[64:67], v[148:151], v[80:83]
  v_smfmac_f32_16x16x64_bf16 v[76:79], v[36:39], a[224:231], v136
  v_smfmac_f32_16x16x64_bf16 v[76:79], v[40:43], a[232:239], v136
  s_nop 5
  v_cndmask_b32 v80, v80, v81, s[68:69]
  buffer_store_dword v80, v124, s[8:11], s50 offen
  v_add_f32 v76, v76, v78
  v_add_f32 v77, v77, v79
  v_cvt_pk_bf16_f32 v140, v76, v77
  s_nop 1
  v_mov_b32_dpp v141, v140 row_ror:4 row_mask:0xf bank_mask:0xa
  s_nop 1
  v_mov_b32_dpp v141, v140 row_ror:12 row_mask:0xf bank_mask:0x5
  v_perm_b32 v140, v141, v140, v137
  buffer_store_dword v140, v130, s[8:11], s51 offen
  s_sleep 2
  s_nop 3
  s_nop 3
  buffer_load_dwordx4 v[4:7], v124, s[8:11], s52 offen offset:0 sc1
  buffer_load_dwordx4 v[8:11], v124, s[8:11], s52 offen offset:1024 sc1
  buffer_load_dwordx4 v[12:15], v124, s[8:11], s52 offen offset:2048 sc1
  buffer_load_dwordx3 v[16:18], v124, s[8:11], s52 offen offset:3072 sc1
  buffer_load_dwordx4 v[20:23], v124, s[8:11], s53 offen offset:0 sc1
  buffer_load_dwordx4 v[24:27], v124, s[8:11], s53 offen offset:1024 sc1
  buffer_load_dwordx4 v[28:31], v124, s[8:11], s53 offen offset:2048 sc1
  s_mov_b32 s41, 0
  s_waitcnt vmcnt(3)
gs_38_in:
  v_pk_add_f32 v[152:153], v[4:5], v[8:9]
  v_pk_add_f32 v[154:155], v[6:7], v[10:11]
  v_add_f32 v156, v16, v17
  v_pk_add_f32 v[152:153], v[152:153], v[12:13]
  v_pk_add_f32 v[154:155], v[154:155], v[14:15]
  v_add_f32 v156, v156, v18
  v_cmp_u_f32 s[76:77], v152, v153
  v_cmp_u_f32 s[72:73], v154, v155
  v_cmp_u_f32 s[74:75], v156, v156
  v_max3_f32 v140, v152, v153, v154
  s_or_b64 s[72:73], s[76:77], s[72:73]
  v_max3_f32 v140, v140, v155, v156
  s_or_b64 s[72:73], s[72:73], s[74:75]
  s_waitcnt vmcnt(0)
  v_max3_u32 v142, v20, v21, v22
  v_max3_u32 v143, v23, v24, v25
  v_max3_u32 v142, v142, v26, v27
  v_max3_u32 v143, v143, v28, v29
  v_max3_u32 v142, v142, v30, v31
  v_max_u32 v142, v142, v143
  v_cmp_eq_u32 vcc, -1, v142
  s_nop 0
  s_or_b64 vcc, vcc, s[72:73]
  s_cbranch_vccnz gs_38
  v_smfmac_f32_16x16x64_bf16 v[92:95], v[20:23], v[176:183], v136
  v_max_f32_dpp v140, v140, v140 row_ror:8 row_mask:0xf bank_mask:0xf
  v_mov_b32 v141, v140
  v_smfmac_f32_16x16x64_bf16 v[96:99], v[20:23], v[200:207], v136
  v_mul_f32 v152, 0x3dd53b95, v152
  v_mul_f32 v153, 0x3dd53b95, v153
  v_smfmac_f32_16x16x64_bf16 v[100:103], v[20:23], v[224:231], v136
  v_permlane16_swap_b32 v140, v141
  v_max_f32 v140, v140, v141
  v_smfmac_f32_16x16x64_bf16 v[104:107], v[20:23], v[248:255], v136
  v_mov_b32 v141, v140
  v_mul_f32 v154, 0x3dd53b95, v154
  v_smfmac_f32_16x16x64_bf16 v[92:95], v[24:27], v[184:191], v136
  v_mul_f32 v155, 0x3dd53b95, v155
  v_permlane32_swap_b32 v140, v141
  v_smfmac_f32_16x16x64_bf16 v[96:99], v[24:27], v[208:215], v136
  v_max_f32 v140, v140, v141
  v_mul_f32 v156, 0x3dd53b95, v156
  v_smfmac_f32_16x16x64_bf16 v[100:103], v[24:27], v[232:239], v136
  v_mul_f32 v140, 0x3dd53b95, v140
  v_sub_f32 v156, v156, v140
  v_smfmac_f32_16x16x64_bf16 v[104:107], v[24:27], a[240:247], v136
  v_sub_f32 v152, v152, v140
  v_sub_f32 v153, v153, v140
  v_smfmac_f32_16x16x64_bf16 v[92:95], v[28:31], v[192:199], v136
  v_sub_f32 v154, v154, v140
  v_sub_f32 v155, v155, v140
  v_smfmac_f32_16x16x64_bf16 v[96:99], v[28:31], v[216:223], v136
  v_exp_f32 v156, v156
  v_exp_f32 v152, v152
  v_smfmac_f32_16x16x64_bf16 v[100:103], v[28:31], v[240:247], v136
  v_exp_f32 v153, v153
  v_exp_f32 v154, v154
  v_smfmac_f32_16x16x64_bf16 v[104:107], v[28:31], a[248:255], v136
  v_exp_f32 v155, v155
  v_mov_b32_dpp v157, v156 row_ror:8 row_mask:0xf bank_mask:0xf
  v_cvt_pk_bf16_f32 v116, v152, v153
  v_cvt_pk_bf16_f32 v117, v154, v155
  v_cvt_pk_bf16_f32 v120, v156, v157
  v_mov_b32_dpp v118, v116 row_ror:8 row_mask:0xf bank_mask:0xf
  v_mov_b32_dpp v119, v117 row_ror:8 row_mask:0xf bank_mask:0xf
  v_mov_b32 v121, v120
  s_nop 0
  v_mfma_f32_16x16x32_bf16 v[80:83], v[88:91], v[116:119], 0
  v_cvt_pk_bf16_f32 v108, v92, v93
  v_cvt_pk_bf16_f32 v109, v94, v95
  v_mfma_f32_16x16x32_bf16 v[152:155], v[44:47], v[116:119], 0
  v_cvt_pk_bf16_f32 v110, v96, v97
  v_cvt_pk_bf16_f32 v111, v98, v99
  v_mfma_f32_16x16x32_bf16 v[156:159], v[48:51], v[116:119], 0
  v_mfma_f32_16x16x16_bf16 v[80:83], v[168:169], v[120:121], v[80:83]
  v_cvt_pk_bf16_f32 v112, v100, v101
  v_cvt_pk_bf16_f32 v113, v102, v103
  v_mfma_f32_16x16x32_bf16 v[160:163], v[52:55], v[116:119], 0
  v_cvt_pk_bf16_f32 v114, v104, v105
  v_cvt_pk_bf16_f32 v115, v106, v107
  v_mfma_f32_16x16x32_bf16 v[164:167], v[56:59], v[116:119], 0
  s_add_u32 s40, s40, 1
  v_mfma_f32_16x16x16_bf16 v[152:155], v[108:109], v[120:121], v[152:155]
  v_mfma_f32_16x16x16_bf16 v[156:159], v[110:111], v[120:121], v[156:159]
  v_rcp_f32 v122, v80
  v_mfma_f32_16x16x16_bf16 v[160:163], v[112:113], v[120:121], v[160:163]
  s_nop 0
  v_mfma_f32_16x16x16_bf16 v[164:167], v[114:115], v[120:121], v[164:167]
  v_mov_b32 v123, v122
  s_cmp_eq_u32 s40, 64
  s_cbranch_scc1 chain_last_c1w
  s_mov_b64 exec, s[66:67]
  v_pk_mul_f32 v[152:153], v[122:123], v[152:153]
  v_pk_mul_f32 v[154:155], v[122:123], v[154:155]
  ds_write_b128 v131, v[152:155] offset:0
  v_pk_mul_f32 v[156:157], v[122:123], v[156:157]
  v_pk_mul_f32 v[158:159], v[122:123], v[158:159]
  ds_write_b128 v131, v[156:159] offset:512
  v_pk_mul_f32 v[160:161], v[122:123], v[160:161]
  v_pk_mul_f32 v[162:163], v[122:123], v[162:163]
  ds_write_b128 v131, v[160:163] offset:1024
  v_pk_mul_f32 v[164:165], v[122:123], v[164:165]
  v_pk_mul_f32 v[166:167], v[122:123], v[166:167]
  ds_write_b128 v131, v[164:167] offset:1536
  s_mov_b64 exec, -1
  s_waitcnt lgkmcnt(0)
  s_barrier
  ds_read_b64 v[144:145], v132 offset:0
  ds_read_b64 v[146:147], v132 offset:2048
  ds_read_b64 v[148:149], v132 offset:4096
  ds_read_b64 v[150:151], v132 offset:6144
  s_mov_b32 s45, s62
  s_waitcnt lgkmcnt(2)
  v_pk_add_f32 v[144:145], v[144:145], v[146:147]
  s_waitcnt lgkmcnt(0)
  v_pk_add_f32 v[148:149], v[148:149], v[150:151]
  v_pk_add_f32 v[122:123], v[144:145], v[148:149]
  v_cvt_pk_bf16_f32 v122, v122, v123
  buffer_store_dword v122, v170, s[8:11], s63 offen sc1
  buffer_store_dword v122, v170, s[8:11], s61 offen sc1
  s_add_u32 s78, s40, 1
  s_sub_u32 s42, s40, 1
  v_mov_b32 v143, s42
  buffer_store_dword v84, v133, s[8:11], s46 offen
  buffer_store_dword v143, v135, s[8:11], 0 offen
  s_mov_b32 s41, 0
cpw_40:
  v_cmp_gt_u32 vcc, s78, v139
  s_nop 0
  s_and_b32 vcc_lo, vcc_lo, 0xfff000
  s_and_b32 vcc_hi, vcc_hi, 0xfffff0
  s_cmp_eq_u64 vcc, 0
  s_cbranch_scc1 cpo_41
  s_sleep 1
  buffer_load_dword v139, v134, s[8:11], 0 offen sc1
  s_add_u32 s41, s41, 1
  s_cmp_gt_u32 s41, 65536
  s_cbranch_scc1 chain_abort
  s_waitcnt vmcnt(0)
  s_branch cpw_40
cpo_41:
  v_add_f32 v92, v92, v94
  v_add_f32 v93, v93, v95
  v_cvt_pk_bf16_f32 v80, v92, v93
  v_add_f32 v96, v96, v98
  v_add_f32 v97, v97, v99
  v_cvt_pk_bf16_f32 v81, v96, v97
  v_add_f32 v100, v100, v102
  v_add_f32 v101, v101, v103
  v_cvt_pk_bf16_f32 v82, v100, v101
  v_add_f32 v104, v104, v106
  v_add_f32 v105, v105, v107
  v_cvt_pk_bf16_f32 v83, v104, v105
  s_mov_b32 s42, s46
  s_mov_b32 s46, s47
  s_mov_b32 s47, s42
  s_cmp_ge_u32 s40, 2
  s_cselect_b32 s43, 3072, 0
  s_add_u32 s57, s57, s43
  s_cmp_ge_u32 s40, 2
  s_cselect_b32 s43, 10240, 0
  s_add_u32 s58, s58, s43
  s_add_u32 s54, s55, s79
  s_and_b32 s42, s40, 3
  s_lshl_b32 s43, s42, 15
  s_add_u32 s52, s49, s43
  s_add_u32 s53, s52, 4096
  s_add_u32 s55, s48, s43
  s_add_u32 s50, s55, s56
  s_lshl_b32 s44, s38, 10
  s_add_u32 s51, s55, s44
  s_add_u32 s51, s51, 4096
  s_mul_i32 s62, s42, 163840
  s_add_u32 s62, s62, s64
  s_lshl_b32 s43, s16, 8
  s_add_u32 s61, s62, s43
  s_xor_b32 s63, s61, 8192
  v_mov_b32 v92, 0
  v_mov_b32 v93, 0
  v_mov_b32 v94, 0
  v_mov_b32 v95, 0
  v_mov_b32 v96, 0
  v_mov_b32 v97, 0
  v_mov_b32 v98, 0
  v_mov_b32 v99, 0
  v_mov_b32 v100, 0
  v_mov_b32 v101, 0
  v_mov_b32 v102, 0
  v_mov_b32 v103, 0
  v_mov_b32 v104, 0
  v_mov_b32 v105, 0
  v_mov_b32 v106, 0
  v_mov_b32 v107, 0
  v_mov_b32 v68, 0
  v_mov_b32 v69, 0
  v_mov_b32 v70, 0
  v_mov_b32 v71, 0
  v_mov_b32 v72, 0
  v_mov_b32 v73, 0
  v_mov_b32 v74, 0
  v_mov_b32 v75, 0
  v_mov_b32 v76, 0
  v_mov_b32 v77, 0
  v_mov_b32 v78, 0
  v_mov_b32 v79, 0
  s_sleep 2
  buffer_load_dwordx4 v[4:7], v124, s[8:11], s45 offen offset:0 sc1
  buffer_load_dwordx4 v[8:11], v124, s[8:11], s45 offen offset:1024 sc1
  s_mov_b32 s41, 0
xp_42:
  s_waitcnt vmcnt(0)
  v_mfma_f32_16x16x32_bf16 v[36:39], v[172:175], v[4:7], 0
  v_mfma_f32_16x16x32_bf16 v[36:39], v[172:175], v[8:11], v[36:39]
  s_nop 7
  v_cmp_u_f32 vcc, v36, v37
  v_cvt_pk_bf16_f32 v141, v36, v37
  s_cbranch_vccnz xp_42_r
  buffer_store_dword v141, v133, s[8:11], s46 offen
  s_branch chain_loop_c1w
gs_38:
  v_max3_u32 v142, v4, v5, v6
  v_max_u32 v142, v142, v7
  v_cmp_eq_u32 vcc, -1, v142
  s_cbranch_vccz gs_38_s0
  s_mov_b64 exec, vcc
  buffer_load_dwordx4 v[4:7], v124, s[8:11], s52 offen offset:0 sc1
  s_mov_b64 exec, -1
gs_38_s0:
  v_max3_u32 v142, v8, v9, v10
  v_max_u32 v142, v142, v11
  v_cmp_eq_u32 vcc, -1, v142
  s_cbranch_vccz gs_38_s1
  s_mov_b64 exec, vcc
  buffer_load_dwordx4 v[8:11], v124, s[8:11], s52 offen offset:1024 sc1
  s_mov_b64 exec, -1
gs_38_s1:
  v_max3_u32 v142, v12, v13, v14
  v_max_u32 v142, v142, v15
  v_cmp_eq_u32 vcc, -1, v142
  s_cbranch_vccz gs_38_s2
  s_mov_b64 exec, vcc
  buffer_load_dwordx4 v[12:15], v124, s[8:11], s52 offen offset:2048 sc1
  s_mov_b64 exec, -1
gs_38_s2:
  v_max3_u32 v142, v16, v17, v18
  v_cmp_eq_u32 vcc, -1, v142
  s_cbranch_vccz gs_38_s3
  s_mov_b64 exec, vcc
  buffer_load_dwordx3 v[16:18], v124, s[8:11], s52 offen offset:3072 sc1
  s_mov_b64 exec, -1
gs_38_s3:
  v_max3_u32 v142, v20, v21, v22
  v_max_u32 v142, v142, v23
  v_cmp_eq_u32 vcc, -1, v142
  s_cbranch_vccz gs_38_s4
  s_mov_b64 exec, vcc
  buffer_load_dwordx4 v[20:23], v124, s[8:11], s53 offen offset:0 sc1
  s_mov_b64 exec, -1
gs_38_s4:
  v_max3_u32 v142, v24, v25, v26
  v_max_u32 v142, v142, v27
  v_cmp_eq_u32 vcc, -1, v142
  s_cbranch_vccz gs_38_s5
  s_mov_b64 exec, vcc
  buffer_load_dwordx4 v[24:27], v124, s[8:11], s53 offen offset:1024 sc1
  s_mov_b64 exec, -1
gs_38_s5:
  v_max3_u32 v142, v28, v29, v30
  v_max_u32 v142, v142, v31
  v_cmp_eq_u32 vcc, -1, v142
  s_cbranch_vccz gs_38_s6
  s_mov_b64 exec, vcc
  buffer_load_dwordx4 v[28:31], v124, s[8:11], s53 offen offset:2048 sc1
  s_mov_b64 exec, -1
gs_38_s6:
  s_add_u32 s41, s41, 1
  s_cmp_gt_u32 s41, 65536
  s_cbranch_scc1 chain_abort
  s_waitcnt vmcnt(0)
  s_branch gs_38_in
xp_42_r:
  v_max3_u32 v140, v4, v5, v6
  v_max_u32 v140, v140, v7
  v_cmp_eq_u32 vcc, -1, v140
  s_cbranch_vccz xp_42_s0
  s_mov_b64 exec, vcc
  buffer_load_dwordx4 v[4:7], v124, s[8:11], s45 offen offset:0 sc1
  s_mov_b64 exec, -1
xp_42_s0:
  v_max3_u32 v140, v8, v9, v10
  v_max_u32 v140, v140, v11
  v_cmp_eq_u32 vcc, -1, v140
  s_cbranch_vccz xp_42_s1
  s_mov_b64 exec, vcc
  buffer_load_dwordx4 v[8:11], v124, s[8:11], s45 offen offset:1024 sc1
  s_mov_b64 exec, -1
xp_42_s1:
  s_add_u32 s41, s41, 1
  s_cmp_gt_u32 s41, 65536
  s_cbranch_scc1 chain_abort
  s_branch xp_42
chain_last_c1w:
  s_cmp_ge_u32 s40, 2
  s_cselect_b32 s43, 3072, 0
  s_add_u32 s57, s57, s43
  s_cmp_ge_u32 s40, 2
  s_cselect_b32 s43, 10240, 0
  s_add_u32 s58, s58, s43
  v_add_f32 v92, v92, v94
  v_add_f32 v93, v93, v95
  v_cvt_pk_bf16_f32 v80, v92, v93
  v_add_f32 v96, v96, v98
  v_add_f32 v97, v97, v99
  v_cvt_pk_bf16_f32 v81, v96, v97
  v_add_f32 v100, v100, v102
  v_add_f32 v101, v101, v103
  v_cvt_pk_bf16_f32 v82, v100, v101
  v_add_f32 v104, v104, v106
  v_add_f32 v105, v105, v107
  v_cvt_pk_bf16_f32 v83, v104, v105
  buffer_store_dwordx4 v[80:83], v124, s[8:11], s58 offen
  v_mov_b32 v143, s40
  s_branch chain_fin
chain_pro_c2w:
  s_lshl_b32 s42, s16, 8
  s_add_u32 s61, s64, s42
  s_add_u32 s61, s61, 491520
  s_mov_b32 s41, 0
  s_mov_b32 s62, -1
  s_mov_b32 s63, -1
cal_43:
  s_waitcnt vmcnt(0)
  s_memtime s[72:73]
  s_waitcnt lgkmcnt(0)
  buffer_store_dword v84, v170, s[8:11], s61 offen sc1
  s_waitcnt vmcnt(0)
  s_memtime s[74:75]
  s_waitcnt lgkmcnt(0)
  s_sub_u32 s42, s74, s72
  s_min_u32 s42, s42, s62
  s_mov_b32 s62, s63
  s_mov_b32 s63, s42
  s_xor_b32 s61, s61, 8192
  s_add_u32 s41, s41, 1
  s_cmp_lt_u32 s41, 8
  s_cbranch_scc1 cal_43
  s_cmp_lt_u32 s62, s63
  s_cselect_b32 s42, 0, 8192
  s_add_u32 s64, s64, s42
  s_mov_b32 s78, 1
  v_mov_b32 v143, 0
  s_mov_b32 s41, 0
cpw_44:
  v_cmp_gt_u32 vcc, s78, v139
  s_nop 0
  s_and_b32 vcc_lo, vcc_lo, 0xfff000
  s_and_b32 vcc_hi, vcc_hi, 0xfffff0
  s_cmp_eq_u64 vcc, 0
  s_cbranch_scc1 cpo_45
  s_sleep 1
  buffer_load_dword v139, v134, s[8:11], 0 offen sc1
  s_add_u32 s41, s41, 1
  s_cmp_gt_u32 s41, 65536
  s_cbranch_scc1 chain_abort
  s_waitcnt vmcnt(0)
  s_branch cpw_44
cpo_45:
  s_add_u32 s55, s48, 98304
  s_cmp_ge_u32 s40, 2
  s_cselect_b32 s43, 3072, 0
  s_add_u32 s57, s57, s43
  s_cmp_ge_u32 s40, 2
  s_cselect_b32 s43, 10240, 0
  s_add_u32 s58, s58, s43
  s_add_u32 s54, s55, s79
  s_and_b32 s42, s40, 3
  s_lshl_b32 s43, s42, 15
  s_add_u32 s52, s49, s43
  s_add_u32 s53, s52, 4096
  s_add_u32 s55, s48, s43
  s_add_u32 s50, s55, s56
  s_lshl_b32 s44, s38, 10
  s_add_u32 s51, s55, s44
  s_add_u32 s51, s51, 4096
  s_mul_i32 s62, s42, 163840
  s_add_u32 s62, s62, s64
  s_lshl_b32 s43, s16, 8
  s_add_u32 s61, s62, s43
  s_xor_b32 s63, s61, 8192
  v_mov_b32 v92, 0
  v_mov_b32 v93, 0
  v_mov_b32 v94, 0
  v_mov_b32 v95, 0
  v_mov_b32 v96, 0
  v_mov_b32 v97, 0
  v_mov_b32 v98, 0
  v_mov_b32 v99, 0
  v_mov_b32 v100, 0
  v_mov_b32 v101, 0
  v_mov_b32 v102, 0
  v_mov_b32 v103, 0
  v_mov_b32 v104, 0
  v_mov_b32 v105, 0
  v_mov_b32 v106, 0
  v_mov_b32 v107, 0
  v_mov_b32 v68, 0
  v_mov_b32 v69, 0
  v_mov_b32 v70, 0
  v_mov_b32 v71, 0
  v_mov_b32 v72, 0
  v_mov_b32 v73, 0
  v_mov_b32 v74, 0
  v_mov_b32 v75, 0
  v_mov_b32 v76, 0
  v_mov_b32 v77, 0
  v_mov_b32 v78, 0
  v_mov_b32 v79, 0
chain_loop_c2w:
  s_mov_b32 s41, 0
  buffer_load_dwordx4 v[152:155], v126, s[8:11], s46 offen sc1
  buffer_load_dwordx4 v[156:159], v126, s[8:11], s46 offen offset:1024 sc1
  buffer_load_dwordx2 v[160:161], v127, s[8:11], s46 offen sc1
  s_sleep 2
mq_46:
  buffer_load_dwordx4 v[162:165], v126, s[8:11], s46 offen sc1
  buffer_load_dwordx4 v[108:111], v126, s[8:11], s46 offen offset:1024 sc1
  buffer_load_dwordx2 v[112:113], v127, s[8:11], s46 offen sc1
  s_waitcnt vmcnt(3)
  v_max3_u32 v140, v152, v153, v154
  v_max3_u32 v141, v155, v156, v157
  v_max3_u32 v140, v140, v158, v159
  v_max3_u32 v141, v141, v160, v161
  v_max_u32 v140, v140, v141
  v_cmp_eq_u32 vcc, -1, v140
  s_cbranch_vccz mq_46_a
  buffer_load_dwordx4 v[152:155], v126, s[8:11], s46 offen sc1
  buffer_load_dwordx4 v[156:159], v126, s[8:11], s46 offen offset:1024 sc1
  buffer_load_dwordx2 v[160:161], v127, s[8:11], s46 offen sc1
  s_add_u32 s41, s41, 1
  s_cmp_gt_u32 s41, 65536
  s_cbranch_scc1 chain_abort
  s_waitcnt vmcnt(3)
  v_max3_u32 v140, v162, v163, v164
  v_max3_u32 v141, v165, v108, v109
  v_max3_u32 v140, v140, v110, v111
  v_max3_u32 v141, v141, v112, v113
  v_max_u32 v140, v140, v141
  v_cmp_eq_u32 vcc, -1, v140
  s_cbranch_vccnz mq_46
  ds_write_b128 v126, v[162:165]
  ds_write_b128 v126, v[108:111] offset:1024
  ds_write_b64 v127, v[112:113]
  s_branch mq_46_ok
mq_46_a:
  ds_write_b128 v126, v[152:155]
  ds_write_b128 v126, v[156:159] offset:1024
  ds_write_b64 v127, v[160:161]
mq_46_ok:
  s_waitcnt lgkmcnt(0)
  s_barrier
  ds_read_b128 v[4:7], v124 offset:0
  ds_read_b128 v[8:11], v124 offset:1024
  ds_read_b128 v[12:15], v124 offset:2048
  ds_read_b128 v[16:19], v124 offset:3072
  ds_read_b128 v[20:23], v124 offset:4096
  ds_read_b128 v[24:27], v124 offset:5120
  ds_read_b128 v[28:31], v124 offset:6144
  ds_read_b128 v[32:35], v124 offset:7168
  ds_read_b128 v[36:39], v124 offset:8192
  ds_read_b128 v[40:43], v124 offset:9216
  s_waitcnt lgkmcnt(9)
  v_smfmac_f32_16x16x64_bf16 v[68:71], v[4:7], a[0:7], v136
  v_smfmac_f32_16x16x64_bf16 v[72:75], v[4:7], a[80:87], v136
  buffer_load_dwordx4 v[44:47], v124, s[8:11], s60 offen offset:0 sc1
  s_waitcnt lgkmcnt(8)
  v_smfmac_f32_16x16x64_bf16 v[68:71], v[8:11], a[8:15], v136
  v_smfmac_f32_16x16x64_bf16 v[72:75], v[8:11], a[88:95], v136
  buffer_load_dwordx4 v[48:51], v124, s[8:11], s60 offen offset:1024 sc1
  s_waitcnt lgkmcnt(7)
  v_smfmac_f32_16x16x64_bf16 v[68:71], v[12:15], a[16:23], v136
  v_smfmac_f32_16x16x64_bf16 v[72:75], v[12:15], a[96:103], v136
  buffer_load_dwordx4 v[52:55], v124, s[8:11], s60 offen offset:2048 sc1
  s_waitcnt lgkmcnt(6)
  v_smfmac_f32_16x16x64_bf16 v[68:71], v[16:19], a[24:31], v136
  v_smfmac_f32_16x16x64_bf16 v[72:75], v[16:19], a[104:111], v136
  buffer_load_dwordx4 v[56:59], v124, s[8:11], s60 offen offset:3072 sc1
  s_add_u32 s60, s60, 40960
  s_waitcnt lgkmcnt(5)
  v_smfmac_f32_16x16x64_bf16 v[68:71], v[20:23], a[32:39], v136
  v_smfmac_f32_16x16x64_bf16 v[72:75], v[20:23], a[112:119], v136
  buffer_store_dwordx4 v[80:83], v124, s[8:11], s58 offen
  s_waitcnt lgkmcnt(4)
  v_smfmac_f32_16x16x64_bf16 v[68:71], v[24:27], a[40:47], v136
  v_smfmac_f32_16x16x64_bf16 v[72:75], v[24:27], a[120:127], v136
  buffer_store_dwordx4 v[60:63], v138, s[8:11], s57 offen
  s_waitcnt lgkmcnt(3)
  v_smfmac_f32_16x16x64_bf16 v[68:71], v[28:31], a[48:55], v136
  v_smfmac_f32_16x16x64_bf16 v[72:75], v[28:31], a[128:135], v136
  buffer_store_dwordx4 v[64:67], v138, s[8:11], s57 offen offset:512
  s_waitcnt lgkmcnt(2)
  v_smfmac_f32_16x16x64_bf16 v[68:71], v[32:35], a[56:63], v136
  v_smfmac_f32_16x16x64_bf16 v[72:75], v[32:35], a[136:143], v136
  buffer_load_dword v139, v134, s[8:11], 0 offen sc1
  s_waitcnt lgkmcnt(1)
  v_smfmac_f32_16x16x64_bf16 v[68:71], v[36:39], a[64:71], v136
  v_smfmac_f32_16x16x64_bf16 v[72:75], v[36:39], a[144:151], v136
  s_waitcnt lgkmcnt(0)
  v_smfmac_f32_16x16x64_bf16 v[68:71], v[40:43], a[72:79], v136
  v_smfmac_f32_16x16x64_bf16 v[72:75], v[40:43], a[152:159], v136
  v_smfmac_f32_16x16x64_bf16 v[76:79], v[4:7], a[160:167], v136
  v_smfmac_f32_16x16x64_bf16 v[76:79], v[8:11], a[168:175], v136
  s_nop 4
  v_add_f32 v68, v68, v70
  v_add_f32 v69, v69, v71
  v_add_f32 v72, v72, v74
  v_add_f32 v73, v73, v75
  v_smfmac_f32_16x16x64_bf16 v[76:79], v[12:15], a[176:183], v136
  v_cvt_pk_bf16_f32 v122, v68, v69
  v_cvt_pk_bf16_f32 v123, v72, v73
  ds_write2_b32 v128, v122, v122 offset0:0 offset1:4
  ds_write2_b32 v129, v123, v123 offset0:0 offset1:1
  v_smfmac_f32_16x16x64_bf16 v[76:79], v[16:19], a[184:191], v136
  v_smfmac_f32_16x16x64_bf16 v[76:79], v[20:23], a[192:199], v136
  s_waitcnt lgkmcnt(0)
  s_barrier
  ds_read_b64_tr_b16 v[60:61], v125 offset:12288
  ds_read_b64_tr_b16 v[62:63], v125 offset:12800
  ds_read_b64_tr_b16 v[64:65], v125 offset:13312
  ds_read_b64_tr_b16 v[66:67], v125 offset:13824
  v_smfmac_f32_16x16x64_bf16 v[76:79], v[24:27], a[200:207], v136
  v_smfmac_f32_16x16x64_bf16 v[76:79], v[28:31], a[208:215], v136
  v_smfmac_f32_16x16x64_bf16 v[76:79], v[32:35], a[216:223], v136
  v_smfmac_f32_16x16x64_bf16 v[76:79], v[36:39], a[224:231], v136
  v_smfmac_f32_16x16x64_bf16 v[76:79], v[40:43], a[232:239], v136
  s_nop 7
  v_add_f32 v76, v76, v78
  v_add_f32 v77, v77, v79
  v_cvt_pk_bf16_f32 v140, v76, v77
  s_nop 1
  v_mov_b32_dpp v141, v140 row_ror:4 row_mask:0xf bank_mask:0xa
  s_nop 1
  v_mov_b32_dpp v141, v140 row_ror:12 row_mask:0xf bank_mask:0x5
  v_perm_b32 v140, v141, v140, v137
  buffer_store_dword v140, v130, s[8:11], s51 offen
  s_sleep 4
  buffer_load_dwordx4 v[4:7], v124, s[8:11], s52 offen offset:0 sc1
  buffer_load_dwordx4 v[8:11], v124, s[8:11], s52 offen offset:1024 sc1
  buffer_load_dwordx4 v[12:15], v124, s[8:11], s52 offen offset:2048 sc1
  buffer_load_dwordx3 v[16:18], v124, s[8:11], s52 offen offset:3072 sc1
  buffer_load_dwordx4 v[20:23], v124, s[8:11], s53 offen offset:0 sc1
  buffer_load_dwordx4 v[24:27], v124, s[8:11], s53 offen offset:1024 sc1
  buffer_load_dwordx4 v[28:31], v124, s[8:11], s53 offen offset:2048 sc1
  s_mov_b32 s41, 0
  s_waitcnt vmcnt(3)
gs_47_in:
  v_pk_add_f32 v[152:153], v[4:5], v[8:9]
  v_pk_add_f32 v[154:155], v[6:7], v[10:11]
  v_add_f32 v156, v16, v17
  v_pk_add_f32 v[152:153], v[152:153], v[12:13]
  v_pk_add_f32 v[154:155], v[154:155], v[14:15]
  v_add_f32 v156, v156, v18
  v_cmp_u_f32 s[76:77], v152, v153
  v_cmp_u_f32 s[72:73], v154, v155
  v_cmp_u_f32 s[74:75], v156, v156
  v_max3_f32 v140, v152, v153, v154
  s_or_b64 s[72:73], s[76:77], s[72:73]
  v_max3_f32 v140, v140, v155, v156
  s_or_b64 s[72:73], s[72:73], s[74:75]
  s_waitcnt vmcnt(0)
  v_max3_u32 v142, v20, v21, v22
  v_max3_u32 v143, v23, v24, v25
  v_max3_u32 v142, v142, v26, v27
  v_max3_u32 v143, v143, v28, v29
  v_max3_u32 v142, v142, v30, v31
  v_max_u32 v142, v142, v143
  v_cmp_eq_u32 vcc, -1, v142
  s_nop 0
  s_or_b64 vcc, vcc, s[72:73]
  s_cbranch_vccnz gs_47
  v_smfmac_f32_16x16x64_bf16 v[92:95], v[20:23], v[176:183], v136
  v_max_f32_dpp v140, v140, v140 row_ror:8 row_mask:0xf bank_mask:0xf
  v_mov_b32 v141, v140
  v_smfmac_f32_16x16x64_bf16 v[96:99], v[20:23], v[200:207], v136
  v_mul_f32 v152, 0x3dd53b95, v152
  v_mul_f32 v153, 0x3dd53b95, v153
  v_smfmac_f32_16x16x64_bf16 v[100:103], v[20:23], v[224:231], v136
  v_permlane16_swap_b32 v140, v141
  v_max_f32 v140, v140, v141
  v_smfmac_f32_16x16x64_bf16 v[104:107], v[20:23], v[248:255], v136
  v_mov_b32 v141, v140
  v_mul_f32 v154, 0x3dd53b95, v154
  v_smfmac_f32_16x16x64_bf16 v[92:95], v[24:27], v[184:191], v136
  v_mul_f32 v155, 0x3dd53b95, v155
  v_permlane32_swap_b32 v140, v141
  v_smfmac_f32_16x16x64_bf16 v[96:99], v[24:27], v[208:215], v136
  v_max_f32 v140, v140, v141
  v_mul_f32 v156, 0x3dd53b95, v156
  v_smfmac_f32_16x16x64_bf16 v[100:103], v[24:27], v[232:239], v136
  v_mul_f32 v140, 0x3dd53b95, v140
  v_sub_f32 v156, v156, v140
  v_smfmac_f32_16x16x64_bf16 v[104:107], v[24:27], a[240:247], v136
  v_sub_f32 v152, v152, v140
  v_sub_f32 v153, v153, v140
  v_smfmac_f32_16x16x64_bf16 v[92:95], v[28:31], v[192:199], v136
  v_sub_f32 v154, v154, v140
  v_sub_f32 v155, v155, v140
  v_smfmac_f32_16x16x64_bf16 v[96:99], v[28:31], v[216:223], v136
  v_exp_f32 v156, v156
  v_exp_f32 v152, v152
  v_smfmac_f32_16x16x64_bf16 v[100:103], v[28:31], v[240:247], v136
  v_exp_f32 v153, v153
  v_exp_f32 v154, v154
  v_smfmac_f32_16x16x64_bf16 v[104:107], v[28:31], a[248:255], v136
  v_exp_f32 v155, v155
  v_mov_b32_dpp v157, v156 row_ror:8 row_mask:0xf bank_mask:0xf
  v_cvt_pk_bf16_f32 v116, v152, v153
  v_cvt_pk_bf16_f32 v117, v154, v155
  v_cvt_pk_bf16_f32 v120, v156, v157
  v_mov_b32_dpp v118, v116 row_ror:8 row_mask:0xf bank_mask:0xf
  v_mov_b32_dpp v119, v117 row_ror:8 row_mask:0xf bank_mask:0xf
  v_mov_b32 v121, v120
  s_nop 0
  v_mfma_f32_16x16x32_bf16 v[80:83], v[88:91], v[116:119], 0
  v_cvt_pk_bf16_f32 v108, v92, v93
  v_cvt_pk_bf16_f32 v109, v94, v95
  v_mfma_f32_16x16x32_bf16 v[152:155], v[44:47], v[116:119], 0
  v_cvt_pk_bf16_f32 v110, v96, v97
  v_cvt_pk_bf16_f32 v111, v98, v99
  v_mfma_f32_16x16x32_bf16 v[156:159], v[48:51], v[116:119], 0
  v_mfma_f32_16x16x16_bf16 v[80:83], v[168:169], v[120:121], v[80:83]
  v_cvt_pk_bf16_f32 v112, v100, v101
  v_cvt_pk_bf16_f32 v113, v102, v103
  v_mfma_f32_16x16x32_bf16 v[160:163], v[52:55], v[116:119], 0
  v_cvt_pk_bf16_f32 v114, v104, v105
  v_cvt_pk_bf16_f32 v115, v106, v107
  v_mfma_f32_16x16x32_bf16 v[164:167], v[56:59], v[116:119], 0
  s_add_u32 s40, s40, 1
  v_mfma_f32_16x16x16_bf16 v[152:155], v[108:109], v[120:121], v[152:155]
  v_mfma_f32_16x16x16_bf16 v[156:159], v[110:111], v[120:121], v[156:159]
  v_rcp_f32 v122, v80
  v_mfma_f32_16x16x16_bf16 v[160:163], v[112:113], v[120:121], v[160:163]
  s_nop 0
  v_mfma_f32_16x16x16_bf16 v[164:167], v[114:115], v[120:121], v[164:167]
  v_mov_b32 v123, v122
  s_cmp_eq_u32 s40, 64
  s_cbranch_scc1 chain_last_c2w
  s_mov_b64 exec, s[66:67]
  v_pk_mul_f32 v[152:153], v[122:123], v[152:153]
  v_pk_mul_f32 v[154:155], v[122:123], v[154:155]
  ds_write_b128 v131, v[152:155] offset:0
  v_pk_mul_f32 v[156:157], v[122:123], v[156:157]
  v_pk_mul_f32 v[158:159], v[122:123], v[158:159]
  ds_write_b128 v131, v[156:159] offset:512
  v_pk_mul_f32 v[160:161], v[122:123], v[160:161]
  v_pk_mul_f32 v[162:163], v[122:123], v[162:163]
  ds_write_b128 v131, v[160:163] offset:1024
  v_pk_mul_f32 v[164:165], v[122:123], v[164:165]
  v_pk_mul_f32 v[166:167], v[122:123], v[166:167]
  ds_write_b128 v131, v[164:167] offset:1536
  s_mov_b64 exec, -1
  s_waitcnt lgkmcnt(0)
  s_barrier
  ds_read_b64 v[144:145], v132 offset:0
  ds_read_b64 v[146:147], v132 offset:2048
  ds_read_b64 v[148:149], v132 offset:4096
  ds_read_b64 v[150:151], v132 offset:6144
  s_mov_b32 s45, s62
  s_waitcnt lgkmcnt(2)
  v_pk_add_f32 v[144:145], v[144:145], v[146:147]
  s_waitcnt lgkmcnt(0)
  v_pk_add_f32 v[148:149], v[148:149], v[150:151]
  v_pk_add_f32 v[122:123], v[144:145], v[148:149]
  v_cvt_pk_bf16_f32 v122, v122, v123
  buffer_store_dword v122, v170, s[8:11], s63 offen sc1
  buffer_store_dword v122, v170, s[8:11], s61 offen sc1
  s_add_u32 s78, s40, 1
  s_sub_u32 s42, s40, 1
  v_mov_b32 v143, s42
  buffer_store_dword v84, v133, s[8:11], s46 offen
  buffer_store_dword v143, v135, s[8:11], 0 offen
  s_mov_b32 s41, 0
cpw_49:
  v_cmp_gt_u32 vcc, s78, v139
  s_nop 0
  s_and_b32 vcc_lo, vcc_lo, 0xfff000
  s_and_b32 vcc_hi, vcc_hi, 0xfffff0
  s_cmp_eq_u64 vcc, 0
  s_cbranch_scc1 cpo_50
  s_sleep 1
  buffer_load_dword v139, v134, s[8:11], 0 offen sc1
  s_add_u32 s41, s41, 1
  s_cmp_gt_u32 s41, 65536
  s_cbranch_scc1 chain_abort
  s_waitcnt vmcnt(0)
  s_branch cpw_49
cpo_50:
  v_add_f32 v92, v92, v94
  v_add_f32 v93, v93, v95
  v_cvt_pk_bf16_f32 v80, v92, v93
  v_add_f32 v96, v96, v98
  v_add_f32 v97, v97, v99
  v_cvt_pk_bf16_f32 v81, v96, v97
  v_add_f32 v100, v100, v102
  v_add_f32 v101, v101, v103
  v_cvt_pk_bf16_f32 v82, v100, v101
  v_add_f32 v104, v104, v106
  v_add_f32 v105, v105, v107
  v_cvt_pk_bf16_f32 v83, v104, v105
  s_mov_b32 s42, s46
  s_mov_b32 s46, s47
  s_mov_b32 s47, s42
  s_cmp_ge_u32 s40, 2
  s_cselect_b32 s43, 3072, 0
  s_add_u32 s57, s57, s43
  s_cmp_ge_u32 s40, 2
  s_cselect_b32 s43, 10240, 0
  s_add_u32 s58, s58, s43
  s_add_u32 s54, s55, s79
  s_and_b32 s42, s40, 3
  s_lshl_b32 s43, s42, 15
  s_add_u32 s52, s49, s43
  s_add_u32 s53, s52, 4096
  s_add_u32 s55, s48, s43
  s_add_u32 s50, s55, s56
  s_lshl_b32 s44, s38, 10
  s_add_u32 s51, s55, s44
  s_add_u32 s51, s51, 4096
  s_mul_i32 s62, s42, 163840
  s_add_u32 s62, s62, s64
  s_lshl_b32 s43, s16, 8
  s_add_u32 s61, s62, s43
  s_xor_b32 s63, s61, 8192
  v_mov_b32 v92, 0
  v_mov_b32 v93, 0
  v_mov_b32 v94, 0
  v_mov_b32 v95, 0
  v_mov_b32 v96, 0
  v_mov_b32 v97, 0
  v_mov_b32 v98, 0
  v_mov_b32 v99, 0
  v_mov_b32 v100, 0
  v_mov_b32 v101, 0
  v_mov_b32 v102, 0
  v_mov_b32 v103, 0
  v_mov_b32 v104, 0
  v_mov_b32 v105, 0
  v_mov_b32 v106, 0
  v_mov_b32 v107, 0
  v_mov_b32 v68, 0
  v_mov_b32 v69, 0
  v_mov_b32 v70, 0
  v_mov_b32 v71, 0
  v_mov_b32 v72, 0
  v_mov_b32 v73, 0
  v_mov_b32 v74, 0
  v_mov_b32 v75, 0
  v_mov_b32 v76, 0
  v_mov_b32 v77, 0
  v_mov_b32 v78, 0
  v_mov_b32 v79, 0
  s_sleep 2
  buffer_load_dwordx4 v[4:7], v124, s[8:11], s45 offen offset:0 sc1
  buffer_load_dwordx4 v[8:11], v124, s[8:11], s45 offen offset:1024 sc1
  s_mov_b32 s41, 0
xp_51:
  s_waitcnt vmcnt(0)
  v_mfma_f32_16x16x32_bf16 v[36:39], v[172:175], v[4:7], 0
  v_mfma_f32_16x16x32_bf16 v[36:39], v[172:175], v[8:11], v[36:39]
  s_nop 7
  v_cmp_u_f32 vcc, v36, v37
  v_cvt_pk_bf16_f32 v141, v36, v37
  s_cbranch_vccnz xp_51_r
  buffer_store_dword v141, v133, s[8:11], s46 offen
  s_branch chain_loop_c2w
gs_47:
  v_max3_u32 v142, v4, v5, v6
  v_max_u32 v142, v142, v7
  v_cmp_eq_u32 vcc, -1, v142
  s_cbranch_vccz gs_47_s0
  s_mov_b64 exec, vcc
  buffer_load_dwordx4 v[4:7], v124, s[8:11], s52 offen offset:0 sc1
  s_mov_b64 exec, -1
gs_47_s0:
  v_max3_u32 v142, v8, v9, v10
  v_max_u32 v142, v142, v11
  v_cmp_eq_u32 vcc, -1, v142
  s_cbranch_vccz gs_47_s1
  s_mov_b64 exec, vcc
  buffer_load_dwordx4 v[8:11], v124, s[8:11], s52 offen offset:1024 sc1
  s_mov_b64 exec, -1
gs_47_s1:
  v_max3_u32 v142, v12, v13, v14
  v_max_u32 v142, v142, v15
  v_cmp_eq_u32 vcc, -1, v142
  s_cbranch_vccz gs_47_s2
  s_mov_b64 exec, vcc
  buffer_load_dwordx4 v[12:15], v124, s[8:11], s52 offen offset:2048 sc1
  s_mov_b64 exec, -1
gs_47_s2:
  v_max3_u32 v142, v16, v17, v18
  v_cmp_eq_u32 vcc, -1, v142
  s_cbranch_vccz gs_47_s3
  s_mov_b64 exec, vcc
  buffer_load_dwordx3 v[16:18], v124, s[8:11], s52 offen offset:3072 sc1
  s_mov_b64 exec, -1
gs_47_s3:
  v_max3_u32 v142, v20, v21, v22
  v_max_u32 v142, v142, v23
  v_cmp_eq_u32 vcc, -1, v142
  s_cbranch_vccz gs_47_s4
  s_mov_b64 exec, vcc
  buffer_load_dwordx4 v[20:23], v124, s[8:11], s53 offen offset:0 sc1
  s_mov_b64 exec, -1
gs_47_s4:
  v_max3_u32 v142, v24, v25, v26
  v_max_u32 v142, v142, v27
  v_cmp_eq_u32 vcc, -1, v142
  s_cbranch_vccz gs_47_s5
  s_mov_b64 exec, vcc
  buffer_load_dwordx4 v[24:27], v124, s[8:11], s53 offen offset:1024 sc1
  s_mov_b64 exec, -1
gs_47_s5:
  v_max3_u32 v142, v28, v29, v30
  v_max_u32 v142, v142, v31
  v_cmp_eq_u32 vcc, -1, v142
  s_cbranch_vccz gs_47_s6
  s_mov_b64 exec, vcc
  buffer_load_dwordx4 v[28:31], v124, s[8:11], s53 offen offset:2048 sc1
  s_mov_b64 exec, -1
gs_47_s6:
  s_add_u32 s41, s41, 1
  s_cmp_gt_u32 s41, 65536
  s_cbranch_scc1 chain_abort
  s_waitcnt vmcnt(0)
  s_branch gs_47_in
xp_51_r:
  v_max3_u32 v140, v4, v5, v6
  v_max_u32 v140, v140, v7
  v_cmp_eq_u32 vcc, -1, v140
  s_cbranch_vccz xp_51_s0
  s_mov_b64 exec, vcc
  buffer_load_dwordx4 v[4:7], v124, s[8:11], s45 offen offset:0 sc1
  s_mov_b64 exec, -1
xp_51_s0:
  v_max3_u32 v140, v8, v9, v10
  v_max_u32 v140, v140, v11
  v_cmp_eq_u32 vcc, -1, v140
  s_cbranch_vccz xp_51_s1
  s_mov_b64 exec, vcc
  buffer_load_dwordx4 v[8:11], v124, s[8:11], s45 offen offset:1024 sc1
  s_mov_b64 exec, -1
xp_51_s1:
  s_add_u32 s41, s41, 1
  s_cmp_gt_u32 s41, 65536
  s_cbranch_scc1 chain_abort
  s_branch xp_51
chain_last_c2w:
  s_cmp_ge_u32 s40, 2
  s_cselect_b32 s43, 3072, 0
  s_add_u32 s57, s57, s43
  s_cmp_ge_u32 s40, 2
  s_cselect_b32 s43, 10240, 0
  s_add_u32 s58, s58, s43
  v_add_f32 v92, v92, v94
  v_add_f32 v93, v93, v95
  v_cvt_pk_bf16_f32 v80, v92, v93
  v_add_f32 v96, v96, v98
  v_add_f32 v97, v97, v99
  v_cvt_pk_bf16_f32 v81, v96, v97
  v_add_f32 v100, v100, v102
  v_add_f32 v101, v101, v103
  v_cvt_pk_bf16_f32 v82, v100, v101
  v_add_f32 v104, v104, v106
  v_add_f32 v105, v105, v107
  v_cvt_pk_bf16_f32 v83, v104, v105
  buffer_store_dwordx4 v[60:63], v138, s[8:11], s57 offen
  buffer_store_dwordx4 v[64:67], v138, s[8:11], s57 offen offset:512
  buffer_store_dwordx4 v[80:83], v124, s[8:11], s58 offen
  v_mov_b32 v143, s40
  s_branch chain_fin
chain_pro_c0n:
  s_sub_u32 s42, s36, 10
  s_lshl_b32 s42, s42, 2
  s_add_u32 s42, s42, s17
  s_cmp_lt_u32 s42, 4
  s_cselect_b32 s63, 16, 8
  s_lshl_b32 s63, s63, 13
  s_lshl_b32 s64, s42, 13
  s_lshl_b32 s42, s16, 8
  s_add_u32 s64, s64, s42
  s_add_u32 s64, s64, 1441792
  v_lshrrev_b32 v140, 4, v1
  v_lshlrev_b32 v140, 11, v140
  v_and_b32 v141, 15, v1
  v_lshl_add_u32 v131, v141, 4, v140
  s_mov_b32 s78, 1
  v_mov_b32 v143, 0
  s_mov_b32 s41, 0
cpw_52:
  v_cmp_gt_u32 vcc, s78, v139
  s_nop 0
  s_and_b32 vcc_lo, vcc_lo, 0xfff000
  s_and_b32 vcc_hi, vcc_hi, 0xfffff0
  s_cmp_eq_u64 vcc, 0
  s_cbranch_scc1 cpo_53
  s_sleep 1
  buffer_load_dword v139, v134, s[8:11], 0 offen sc1
  s_add_u32 s41, s41, 1
  s_cmp_gt_u32 s41, 65536
  s_cbranch_scc1 chain_abort
  s_waitcnt vmcnt(0)
  s_branch cpw_52
cpo_53:
  buffer_load_dwordx4 v[60:63], v124, s[8:11], s59 offen offset:0 sc1
  buffer_load_dwordx4 v[64:67], v124, s[8:11], s59 offen offset:1024 sc1
  s_add_u32 s59, s59, 12288
  s_add_u32 s55, s48, 98304
  s_cmp_ge_u32 s40, 2
  s_cselect_b32 s43, 3072, 0
  s_add_u32 s57, s57, s43
  s_add_u32 s54, s55, s79
  s_and_b32 s42, s40, 3
  s_lshl_b32 s43, s42, 15
  s_add_u32 s52, s49, s43
  s_add_u32 s53, s52, 4096
  s_add_u32 s55, s48, s43
  s_add_u32 s50, s55, s56
  s_lshl_b32 s44, s38, 10
  s_add_u32 s51, s55, s44
  s_add_u32 s51, s51, 4096
  v_mov_b32 v68, 0
  v_mov_b32 v69, 0
  v_mov_b32 v70, 0
  v_mov_b32 v71, 0
  v_mov_b32 v72, 0
  v_mov_b32 v73, 0
  v_mov_b32 v74, 0
  v_mov_b32 v75, 0
  v_mov_b32 v76, 0
  v_mov_b32 v77, 0
  v_mov_b32 v78, 0
  v_mov_b32 v79, 0
chain_loop_c0n:
  s_mov_b32 s41, 0
  buffer_load_dwordx4 v[152:155], v126, s[8:11], s46 offen sc1
  buffer_load_dwordx4 v[156:159], v126, s[8:11], s46 offen offset:1024 sc1
  buffer_load_dwordx2 v[160:161], v127, s[8:11], s46 offen sc1
  s_sleep 2
mq_54:
  buffer_load_dwordx4 v[162:165], v126, s[8:11], s46 offen sc1
  buffer_load_dwordx4 v[108:111], v126, s[8:11], s46 offen offset:1024 sc1
  buffer_load_dwordx2 v[112:113], v127, s[8:11], s46 offen sc1
  s_waitcnt vmcnt(3)
  v_max3_u32 v140, v152, v153, v154
  v_max3_u32 v141, v155, v156, v157
  v_max3_u32 v140, v140, v158, v159
  v_max3_u32 v141, v141, v160, v161
  v_max_u32 v140, v140, v141
  v_cmp_eq_u32 vcc, -1, v140
  s_cbranch_vccz mq_54_a
  buffer_load_dwordx4 v[152:155], v126, s[8:11], s46 offen sc1
  buffer_load_dwordx4 v[156:159], v126, s[8:11], s46 offen offset:1024 sc1
  buffer_load_dwordx2 v[160:161], v127, s[8:11], s46 offen sc1
  s_add_u32 s41, s41, 1
  s_cmp_gt_u32 s41, 65536
  s_cbranch_scc1 chain_abort
  s_waitcnt vmcnt(3)
  v_max3_u32 v140, v162, v163, v164
  v_max3_u32 v141, v165, v108, v109
  v_max3_u32 v140, v140, v110, v111
  v_max3_u32 v141, v141, v112, v113
  v_max_u32 v140, v140, v141
  v_cmp_eq_u32 vcc, -1, v140
  s_cbranch_vccnz mq_54
  ds_write_b128 v126, v[162:165]
  ds_write_b128 v126, v[108:111] offset:1024
  ds_write_b64 v127, v[112:113]
  s_branch mq_54_ok
mq_54_a:
  ds_write_b128 v126, v[152:155]
  ds_write_b128 v126, v[156:159] offset:1024
  ds_write_b64 v127, v[160:161]
mq_54_ok:
  s_waitcnt lgkmcnt(0)
  s_barrier
  ds_read_b128 v[4:7], v124 offset:0
  ds_read_b128 v[8:11], v124 offset:1024
  ds_read_b128 v[12:15], v124 offset:2048
  ds_read_b128 v[16:19], v124 offset:3072
  ds_read_b128 v[20:23], v124 offset:4096
  ds_read_b128 v[24:27], v124 offset:5120
  ds_read_b128 v[28:31], v124 offset:6144
  ds_read_b128 v[32:35], v124 offset:7168
  ds_read_b128 v[36:39], v124 offset:8192
  ds_read_b128 v[40:43], v124 offset:9216
  s_waitcnt lgkmcnt(9)
  v_smfmac_f32_16x16x64_bf16 v[68:71], v[4:7], a[0:7], v136
  v_smfmac_f32_16x16x64_bf16 v[72:75], v[4:7], a[80:87], v136
  buffer_store_dwordx4 v[84:87], v124, s[8:11], s54 offen
  s_waitcnt lgkmcnt(8)
  v_smfmac_f32_16x16x64_bf16 v[68:71], v[8:11], a[8:15], v136
  v_smfmac_f32_16x16x64_bf16 v[72:75], v[8:11], a[88:95], v136
  buffer_load_dword v139, v134, s[8:11], 0 offen sc1
  s_waitcnt lgkmcnt(7)
  v_smfmac_f32_16x16x64_bf16 v[68:71], v[12:15], a[16:23], v136
  v_smfmac_f32_16x16x64_bf16 v[72:75], v[12:15], a[96:103], v136
  s_waitcnt lgkmcnt(6)
  v_smfmac_f32_16x16x64_bf16 v[68:71], v[16:19], a[24:31], v136
  v_smfmac_f32_16x16x64_bf16 v[72:75], v[16:19], a[104:111], v136
  s_waitcnt lgkmcnt(5)
  v_smfmac_f32_16x16x64_bf16 v[68:71], v[20:23], a[32:39], v136
  v_smfmac_f32_16x16x64_bf16 v[72:75], v[20:23], a[112:119], v136
  s_waitcnt lgkmcnt(4)
  v_smfmac_f32_16x16x64_bf16 v[68:71], v[24:27], a[40:47], v136
  v_smfmac_f32_16x16x64_bf16 v[72:75], v[24:27], a[120:127], v136
  s_waitcnt lgkmcnt(3)
  v_smfmac_f32_16x16x64_bf16 v[68:71], v[28:31], a[48:55], v136
  v_smfmac_f32_16x16x64_bf16 v[72:75], v[28:31], a[128:135], v136
  s_waitcnt lgkmcnt(2)
  v_smfmac_f32_16x16x64_bf16 v[68:71], v[32:35], a[56:63], v136
  v_smfmac_f32_16x16x64_bf16 v[72:75], v[32:35], a[136:143], v136
  s_waitcnt lgkmcnt(1)
  v_smfmac_f32_16x16x64_bf16 v[68:71], v[36:39], a[64:71], v136
  v_smfmac_f32_16x16x64_bf16 v[72:75], v[36:39], a[144:151], v136
  s_waitcnt lgkmcnt(0)
  v_smfmac_f32_16x16x64_bf16 v[68:71], v[40:43], a[72:79], v136
  v_smfmac_f32_16x16x64_bf16 v[72:75], v[40:43], a[152:159], v136
  v_smfmac_f32_16x16x64_bf16 v[76:79], v[4:7], a[160:167], v136
  v_smfmac_f32_16x16x64_bf16 v[76:79], v[8:11], a[168:175], v136
  s_nop 4
  v_add_f32 v68, v68, v70
  v_add_f32 v69, v69, v71
  v_add_f32 v72, v72, v74
  v_add_f32 v73, v73, v75
  v_smfmac_f32_16x16x64_bf16 v[76:79], v[12:15], a[176:183], v136
  v_cvt_pk_bf16_f32 v122, v68, v69
  v_cvt_pk_bf16_f32 v123, v72, v73
  ds_write2_b32 v128, v122, v122 offset0:0 offset1:4
  ds_write2_b32 v129, v123, v123 offset0:0 offset1:1
  v_smfmac_f32_16x16x64_bf16 v[76:79], v[16:19], a[184:191], v136
  v_smfmac_f32_16x16x64_bf16 v[76:79], v[20:23], a[192:199], v136
  s_waitcnt lgkmcnt(0)
  s_barrier
  ds_read_b64_tr_b16 v[144:145], v125 offset:10240
  ds_read_b64_tr_b16 v[146:147], v125 offset:10752
  ds_read_b64_tr_b16 v[148:149], v125 offset:11264
  ds_read_b64_tr_b16 v[150:151], v125 offset:11776
  v_smfmac_f32_16x16x64_bf16 v[76:79], v[24:27], a[200:207], v136
  v_smfmac_f32_16x16x64_bf16 v[76:79], v[28:31], a[208:215], v136
  v_smfmac_f32_16x16x64_bf16 v[76:79], v[32:35], a[216:223], v136
  s_waitcnt lgkmcnt(2)
  v_mfma_f32_16x16x32_bf16 v[80:83], v[60:63], v[144:147], 0
  s_waitcnt lgkmcnt(0)
  v_mfma_f32_16x16x32_bf16 v[80:83], v[64:67], v[148:151], v[80:83]
  v_smfmac_f32_16x16x64_bf16 v[76:79], v[36:39], a[224:231], v136
  v_smfmac_f32_16x16x64_bf16 v[76:79], v[40:43], a[232:239], v136
  s_mov_b64 exec, s[70:71]
  s_nop 4
  buffer_store_dwordx4 v[80:83], v124, s[8:11], s50 offen
  s_mov_b64 exec, -1
  v_add_f32 v76, v76, v78
  v_add_f32 v77, v77, v79
  v_cvt_pk_bf16_f32 v140, v76, v77
  s_nop 1
  v_mov_b32_dpp v141, v140 row_ror:4 row_mask:0xf bank_mask:0xa
  s_nop 1
  v_mov_b32_dpp v141, v140 row_ror:12 row_mask:0xf bank_mask:0x5
  v_perm_b32 v140, v141, v140, v137
  buffer_store_dword v140, v130, s[8:11], s51 offen
  s_and_b32 s42, s40, 3
  s_xor_b32 s42, s42, 2
  s_mul_i32 s42, s42, 163840
  s_add_u32 s42, s42, s64
  s_add_u32 s43, s42, 65536
  s_add_u32 s44, s42, s63
  s_waitcnt vmcnt(0)
  s_barrier
  buffer_store_dwordx4 v[84:87], v131, s[8:11], s42 offen sc1
  buffer_store_dwordx4 v[84:87], v131, s[8:11], s43 offen sc1
  buffer_store_dwordx4 v[84:87], v131, s[8:11], s44 offen sc1
  v_mov_b32 v143, s40
  s_add_u32 s40, s40, 1
  s_cmp_eq_u32 s40, 64
  s_cbranch_scc1 chain_last_c0n
  s_add_u32 s78, s40, 1
  s_waitcnt vmcnt(0)
  buffer_store_dword v143, v135, s[8:11], 0 offen
  s_mov_b32 s41, 0
cpw_55:
  v_cmp_gt_u32 vcc, s78, v139
  s_nop 0
  s_and_b32 vcc_lo, vcc_lo, 0xfff000
  s_and_b32 vcc_hi, vcc_hi, 0xfffff0
  s_cmp_eq_u64 vcc, 0
  s_cbranch_scc1 cpo_56
  s_sleep 1
  buffer_load_dword v139, v134, s[8:11], 0 offen sc1
  s_add_u32 s41, s41, 1
  s_cmp_gt_u32 s41, 65536
  s_cbranch_scc1 chain_abort
  s_waitcnt vmcnt(0)
  s_branch cpw_55
cpo_56:
  buffer_load_dwordx4 v[60:63], v124, s[8:11], s59 offen offset:0 sc1
  buffer_load_dwordx4 v[64:67], v124, s[8:11], s59 offen offset:1024 sc1
  s_add_u32 s59, s59, 12288
  s_mov_b32 s42, s46
  s_mov_b32 s46, s47
  s_mov_b32 s47, s42
  s_cmp_ge_u32 s40, 2
  s_cselect_b32 s43, 3072, 0
  s_add_u32 s57, s57, s43
  s_add_u32 s54, s55, s79
  s_and_b32 s42, s40, 3
  s_lshl_b32 s43, s42, 15
  s_add_u32 s52, s49, s43
  s_add_u32 s53, s52, 4096
  s_add_u32 s55, s48, s43
  s_add_u32 s50, s55, s56
  s_lshl_b32 s44, s38, 10
  s_add_u32 s51, s55, s44
  s_add_u32 s51, s51, 4096
  v_mov_b32 v68, 0
  v_mov_b32 v69, 0
  v_mov_b32 v70, 0
  v_mov_b32 v71, 0
  v_mov_b32 v72, 0
  v_mov_b32 v73, 0
  v_mov_b32 v74, 0
  v_mov_b32 v75, 0
  v_mov_b32 v76, 0
  v_mov_b32 v77, 0
  v_mov_b32 v78, 0
  v_mov_b32 v79, 0
  s_sleep 16
  s_branch chain_loop_c0n
chain_last_c0n:
  s_cmp_ge_u32 s40, 2
  s_cselect_b32 s43, 3072, 0
  s_add_u32 s57, s57, s43
  s_waitcnt lgkmcnt(0)
  v_mov_b32 v143, s40
  s_branch chain_fin
chain_pro_c1n:
  s_sub_u32 s42, s36, 10
  s_lshl_b32 s42, s42, 2
  s_add_u32 s42, s42, s17
  s_cmp_lt_u32 s42, 4
  s_cselect_b32 s63, 16, 8
  s_lshl_b32 s63, s63, 13
  s_lshl_b32 s64, s42, 13
  s_lshl_b32 s42, s16, 8
  s_add_u32 s64, s64, s42
  s_add_u32 s64, s64, 1441792
  v_lshrrev_b32 v140, 4, v1
  v_lshlrev_b32 v140, 11, v140
  v_and_b32 v141, 15, v1
  v_lshl_add_u32 v131, v141, 4, v140
  s_mov_b32 s78, 1
  v_mov_b32 v143, 0
  s_mov_b32 s41, 0
cpw_57:
  v_cmp_gt_u32 vcc, s78, v139
  s_nop 0
  s_and_b32 vcc_lo, vcc_lo, 0xfff000
  s_and_b32 vcc_hi, vcc_hi, 0xfffff0
  s_cmp_eq_u64 vcc, 0
  s_cbranch_scc1 cpo_58
  s_sleep 1
  buffer_load_dword v139, v134, s[8:11], 0 offen sc1
  s_add_u32 s41, s41, 1
  s_cmp_gt_u32 s41, 65536
  s_cbranch_scc1 chain_abort
  s_waitcnt vmcnt(0)
  s_branch cpw_57
cpo_58:
  s_add_u32 s55, s48, 98304
  s_cmp_ge_u32 s40, 2
  s_cselect_b32 s43, 3072, 0
  s_add_u32 s57, s57, s43
  s_add_u32 s54, s55, s79
  s_and_b32 s42, s40, 3
  s_lshl_b32 s43, s42, 15
  s_add_u32 s52, s49, s43
  s_add_u32 s53, s52, 4096
  s_add_u32 s55, s48, s43
  s_add_u32 s50, s55, s56
  s_lshl_b32 s44, s38, 10
  s_add_u32 s51, s55, s44
  s_add_u32 s51, s51, 4096
  v_mov_b32 v68, 0
  v_mov_b32 v69, 0
  v_mov_b32 v70, 0
  v_mov_b32 v71, 0
  v_mov_b32 v72, 0
  v_mov_b32 v73, 0
  v_mov_b32 v74, 0
  v_mov_b32 v75, 0
  v_mov_b32 v76, 0
  v_mov_b32 v77, 0
  v_mov_b32 v78, 0
  v_mov_b32 v79, 0
chain_loop_c1n:
  s_mov_b32 s41, 0
  buffer_load_dwordx4 v[152:155], v126, s[8:11], s46 offen sc1
  buffer_load_dwordx4 v[156:159], v126, s[8:11], s46 offen offset:1024 sc1
  buffer_load_dwordx2 v[160:161], v127, s[8:11], s46 offen sc1
  s_sleep 2
mq_59:
  buffer_load_dwordx4 v[162:165], v126, s[8:11], s46 offen sc1
  buffer_load_dwordx4 v[108:111], v126, s[8:11], s46 offen offset:1024 sc1
  buffer_load_dwordx2 v[112:113], v127, s[8:11], s46 offen sc1
  s_waitcnt vmcnt(3)
  v_max3_u32 v140, v152, v153, v154
  v_max3_u32 v141, v155, v156, v157
  v_max3_u32 v140, v140, v158, v159
  v_max3_u32 v141, v141, v160, v161
  v_max_u32 v140, v140, v141
  v_cmp_eq_u32 vcc, -1, v140
  s_cbranch_vccz mq_59_a
  buffer_load_dwordx4 v[152:155], v126, s[8:11], s46 offen sc1
  buffer_load_dwordx4 v[156:159], v126, s[8:11], s46 offen offset:1024 sc1
  buffer_load_dwordx2 v[160:161], v127, s[8:11], s46 offen sc1
  s_add_u32 s41, s41, 1
  s_cmp_gt_u32 s41, 65536
  s_cbranch_scc1 chain_abort
  s_waitcnt vmcnt(3)
  v_max3_u32 v140, v162, v163, v164
  v_max3_u32 v141, v165, v108, v109
  v_max3_u32 v140, v140, v110, v111
  v_max3_u32 v141, v141, v112, v113
  v_max_u32 v140, v140, v141
  v_cmp_eq_u32 vcc, -1, v140
  s_cbranch_vccnz mq_59
  ds_write_b128 v126, v[162:165]
  ds_write_b128 v126, v[108:111] offset:1024
  ds_write_b64 v127, v[112:113]
  s_branch mq_59_ok
mq_59_a:
  ds_write_b128 v126, v[152:155]
  ds_write_b128 v126, v[156:159] offset:1024
  ds_write_b64 v127, v[160:161]
mq_59_ok:
  s_waitcnt lgkmcnt(0)
  s_barrier
  ds_read_b128 v[4:7], v124 offset:0
  ds_read_b128 v[8:11], v124 offset:1024
  ds_read_b128 v[12:15], v124 offset:2048
  ds_read_b128 v[16:19], v124 offset:3072
  ds_read_b128 v[20:23], v124 offset:4096
  ds_read_b128 v[24:27], v124 offset:5120
  ds_read_b128 v[28:31], v124 offset:6144
  ds_read_b128 v[32:35], v124 offset:7168
  ds_read_b128 v[36:39], v124 offset:8192
  ds_read_b128 v[40:43], v124 offset:9216
  s_waitcnt lgkmcnt(9)
  v_smfmac_f32_16x16x64_bf16 v[68:71], v[4:7], a[0:7], v136
  v_smfmac_f32_16x16x64_bf16 v[72:75], v[4:7], a[80:87], v136
  buffer_store_dwordx4 v[84:87], v124, s[8:11], s54 offen
  s_waitcnt lgkmcnt(8)
  v_smfmac_f32_16x16x64_bf16 v[68:71], v[8:11], a[8:15], v136
  v_smfmac_f32_16x16x64_bf16 v[72:75], v[8:11], a[88:95], v136
  buffer_load_dword v139, v134, s[8:11], 0 offen sc1
  s_waitcnt lgkmcnt(7)
  v_smfmac_f32_16x16x64_bf16 v[68:71], v[12:15], a[16:23], v136
  v_smfmac_f32_16x16x64_bf16 v[72:75], v[12:15], a[96:103], v136
  s_waitcnt lgkmcnt(6)
  v_smfmac_f32_16x16x64_bf16 v[68:71], v[16:19], a[24:31], v136
  v_smfmac_f32_16x16x64_bf16 v[72:75], v[16:19], a[104:111], v136
  s_waitcnt lgkmcnt(5)
  v_smfmac_f32_16x16x64_bf16 v[68:71], v[20:23], a[32:39], v136
  v_smfmac_f32_16x16x64_bf16 v[72:75], v[20:23], a[112:119], v136
  s_waitcnt lgkmcnt(4)
  v_smfmac_f32_16x16x64_bf16 v[68:71], v[24:27], a[40:47], v136
  v_smfmac_f32_16x16x64_bf16 v[72:75], v[24:27], a[120:127], v136
  s_waitcnt lgkmcnt(3)
  v_smfmac_f32_16x16x64_bf16 v[68:71], v[28:31], a[48:55], v136
  v_smfmac_f32_16x16x64_bf16 v[72:75], v[28:31], a[128:135], v136
  s_waitcnt lgkmcnt(2)
  v_smfmac_f32_16x16x64_bf16 v[68:71], v[32:35], a[56:63], v136
  v_smfmac_f32_16x16x64_bf16 v[72:75], v[32:35], a[136:143], v136
  s_waitcnt lgkmcnt(1)
  v_smfmac_f32_16x16x64_bf16 v[68:71], v[36:39], a[64:71], v136
  v_smfmac_f32_16x16x64_bf16 v[72:75], v[36:39], a[144:151], v136
  s_waitcnt lgkmcnt(0)
  v_smfmac_f32_16x16x64_bf16 v[68:71], v[40:43], a[72:79], v136
  v_smfmac_f32_16x16x64_bf16 v[72:75], v[40:43], a[152:159], v136
  v_smfmac_f32_16x16x64_bf16 v[76:79], v[4:7], a[160:167], v136
  v_smfmac_f32_16x16x64_bf16 v[76:79], v[8:11], a[168:175], v136
  s_nop 4
  v_add_f32 v68, v68, v70
  v_add_f32 v69, v69, v71
  v_add_f32 v72, v72, v74
  v_add_f32 v73, v73, v75
  v_smfmac_f32_16x16x64_bf16 v[76:79], v[12:15], a[176:183], v136
  v_cvt_pk_bf16_f32 v122, v68, v69
  v_cvt_pk_bf16_f32 v123, v72, v73
  ds_write2_b32 v128, v122, v122 offset0:0 offset1:4
  ds_write2_b32 v129, v123, v123 offset0:0 offset1:1
  v_smfmac_f32_16x16x64_bf16 v[76:79], v[16:19], a[184:191], v136
  v_smfmac_f32_16x16x64_bf16 v[76:79], v[20:23], a[192:199], v136
  s_waitcnt lgkmcnt(0)
  s_barrier
  ds_read_b64_tr_b16 v[144:145], v125 offset:10240
  ds_read_b64_tr_b16 v[60:61], v125 offset:12288
  ds_read_b64_tr_b16 v[146:147], v125 offset:10752
  ds_read_b64_tr_b16 v[62:63], v125 offset:12800
  ds_read_b64_tr_b16 v[148:149], v125 offset:11264
  ds_read_b64_tr_b16 v[64:65], v125 offset:13312
  ds_read_b64_tr_b16 v[150:151], v125 offset:11776
  ds_read_b64_tr_b16 v[66:67], v125 offset:13824
  v_smfmac_f32_16x16x64_bf16 v[76:79], v[24:27], a[200:207], v136
  v_smfmac_f32_16x16x64_bf16 v[76:79], v[28:31], a[208:215], v136
  v_smfmac_f32_16x16x64_bf16 v[76:79], v[32:35], a[216:223], v136
  s_waitcnt lgkmcnt(4)
  v_mfma_f32_16x16x32_bf16 v[80:83], v[60:63], v[144:147], 0
  s_waitcnt lgkmcnt(0)
  v_mfma_f32_16x16x32_bf16 v[80:83], v[64:67], v[148:151], v[80:83]
  v_smfmac_f32_16x16x64_bf16 v[76:79], v[36:39], a[224:231], v136
  v_smfmac_f32_16x16x64_bf16 v[76:79], v[40:43], a[232:239], v136
  s_nop 5
  v_cndmask_b32 v80, v80, v81, s[68:69]
  buffer_store_dword v80, v124, s[8:11], s50 offen
  v_add_f32 v76, v76, v78
  v_add_f32 v77, v77, v79
  v_cvt_pk_bf16_f32 v140, v76, v77
  s_nop 1
  v_mov_b32_dpp v141, v140 row_ror:4 row_mask:0xf bank_mask:0xa
  s_nop 1
  v_mov_b32_dpp v141, v140 row_ror:12 row_mask:0xf bank_mask:0x5
  v_perm_b32 v140, v141, v140, v137
  buffer_store_dword v140, v130, s[8:11], s51 offen
  s_and_b32 s42, s40, 3
  s_xor_b32 s42, s42, 2
  s_mul_i32 s42, s42, 163840
  s_add_u32 s42, s42, s64
  s_add_u32 s43, s42, 65536
  s_add_u32 s44, s42, s63
  s_waitcnt vmcnt(0)
  s_barrier
  buffer_store_dwordx4 v[84:87], v131, s[8:11], s42 offen sc1
  buffer_store_dwordx4 v[84:87], v131, s[8:11], s43 offen sc1
  buffer_store_dwordx4 v[84:87], v131, s[8:11], s44 offen sc1
  v_mov_b32 v143, s40
  s_add_u32 s40, s40, 1
  s_cmp_eq_u32 s40, 64
  s_cbranch_scc1 chain_last_c1n
  s_add_u32 s78, s40, 1
  s_waitcnt vmcnt(0)
  buffer_store_dword v143, v135, s[8:11], 0 offen
  s_mov_b32 s41, 0
cpw_60:
  v_cmp_gt_u32 vcc, s78, v139
  s_nop 0
  s_and_b32 vcc_lo, vcc_lo, 0xfff000
  s_and_b32 vcc_hi, vcc_hi, 0xfffff0
  s_cmp_eq_u64 vcc, 0
  s_cbranch_scc1 cpo_61
  s_sleep 1
  buffer_load_dword v139, v134, s[8:11], 0 offen sc1
  s_add_u32 s41, s41, 1
  s_cmp_gt_u32 s41, 65536
  s_cbranch_scc1 chain_abort
  s_waitcnt vmcnt(0)
  s_branch cpw_60
cpo_61:
  s_mov_b32 s42, s46
  s_mov_b32 s46, s47
  s_mov_b32 s47, s42
  s_cmp_ge_u32 s40, 2
  s_cselect_b32 s43, 3072, 0
  s_add_u32 s57, s57, s43
  s_add_u32 s54, s55, s79
  s_and_b32 s42, s40, 3
  s_lshl_b32 s43, s42, 15
  s_add_u32 s52, s49, s43
  s_add_u32 s53, s52, 4096
  s_add_u32 s55, s48, s43
  s_add_u32 s50, s55, s56
  s_lshl_b32 s44, s38, 10
  s_add_u32 s51, s55, s44
  s_add_u32 s51, s51, 4096
  v_mov_b32 v68, 0
  v_mov_b32 v69, 0
  v_mov_b32 v70, 0
  v_mov_b32 v71, 0
  v_mov_b32 v72, 0
  v_mov_b32 v73, 0
  v_mov_b32 v74, 0
  v_mov_b32 v75, 0
  v_mov_b32 v76, 0
  v_mov_b32 v77, 0
  v_mov_b32 v78, 0
  v_mov_b32 v79, 0
  s_sleep 16
  s_branch chain_loop_c1n
chain_last_c1n:
  s_cmp_ge_u32 s40, 2
  s_cselect_b32 s43, 3072, 0
  s_add_u32 s57, s57, s43
  s_waitcnt lgkmcnt(0)
  v_mov_b32 v143, s40
  s_branch chain_fin
chain_pro_c2n:
  s_sub_u32 s42, s36, 10
  s_lshl_b32 s42, s42, 2
  s_add_u32 s42, s42, s17
  s_cmp_lt_u32 s42, 4
  s_cselect_b32 s63, 16, 8
  s_lshl_b32 s63, s63, 13
  s_lshl_b32 s64, s42, 13
  s_lshl_b32 s42, s16, 8
  s_add_u32 s64, s64, s42
  s_add_u32 s64, s64, 1441792
  v_lshrrev_b32 v140, 4, v1
  v_lshlrev_b32 v140, 11, v140
  v_and_b32 v141, 15, v1
  v_lshl_add_u32 v131, v141, 4, v140
  s_mov_b32 s78, 1
  v_mov_b32 v143, 0
  s_mov_b32 s41, 0
cpw_62:
  v_cmp_gt_u32 vcc, s78, v139
  s_nop 0
  s_and_b32 vcc_lo, vcc_lo, 0xfff000
  s_and_b32 vcc_hi, vcc_hi, 0xfffff0
  s_cmp_eq_u64 vcc, 0
  s_cbranch_scc1 cpo_63
  s_sleep 1
  buffer_load_dword v139, v134, s[8:11], 0 offen sc1
  s_add_u32 s41, s41, 1
  s_cmp_gt_u32 s41, 65536
  s_cbranch_scc1 chain_abort
  s_waitcnt vmcnt(0)
  s_branch cpw_62
cpo_63:
  s_add_u32 s55, s48, 98304
  s_cmp_ge_u32 s40, 2
  s_cselect_b32 s43, 3072, 0
  s_add_u32 s57, s57, s43
  s_add_u32 s54, s55, s79
  s_and_b32 s42, s40, 3
  s_lshl_b32 s43, s42, 15
  s_add_u32 s52, s49, s43
  s_add_u32 s53, s52, 4096
  s_add_u32 s55, s48, s43
  s_add_u32 s50, s55, s56
  s_lshl_b32 s44, s38, 10
  s_add_u32 s51, s55, s44
  s_add_u32 s51, s51, 4096
  v_mov_b32 v68, 0
  v_mov_b32 v69, 0
  v_mov_b32 v70, 0
  v_mov_b32 v71, 0
  v_mov_b32 v72, 0
  v_mov_b32 v73, 0
  v_mov_b32 v74, 0
  v_mov_b32 v75, 0
  v_mov_b32 v76, 0
  v_mov_b32 v77, 0
  v_mov_b32 v78, 0
  v_mov_b32 v79, 0
chain_loop_c2n:
  s_mov_b32 s41, 0
  buffer_load_dwordx4 v[152:155], v126, s[8:11], s46 offen sc1
  buffer_load_dwordx4 v[156:159], v126, s[8:11], s46 offen offset:1024 sc1
  buffer_load_dwordx2 v[160:161], v127, s[8:11], s46 offen sc1
  s_sleep 2
mq_64:
  buffer_load_dwordx4 v[162:165], v126, s[8:11], s46 offen sc1
  buffer_load_dwordx4 v[108:111], v126, s[8:11], s46 offen offset:1024 sc1
  buffer_load_dwordx2 v[112:113], v127, s[8:11], s46 offen sc1
  s_waitcnt vmcnt(3)
  v_max3_u32 v140, v152, v153, v154
  v_max3_u32 v141, v155, v156, v157
  v_max3_u32 v140, v140, v158, v159
  v_max3_u32 v141, v141, v160, v161
  v_max_u32 v140, v140, v141
  v_cmp_eq_u32 vcc, -1, v140
  s_cbranch_vccz mq_64_a
  buffer_load_dwordx4 v[152:155], v126, s[8:11], s46 offen sc1
  buffer_load_dwordx4 v[156:159], v126, s[8:11], s46 offen offset:1024 sc1
  buffer_load_dwordx2 v[160:161], v127, s[8:11], s46 offen sc1
  s_add_u32 s41, s41, 1
  s_cmp_gt_u32 s41, 65536
  s_cbranch_scc1 chain_abort
  s_waitcnt vmcnt(3)
  v_max3_u32 v140, v162, v163, v164
  v_max3_u32 v141, v165, v108, v109
  v_max3_u32 v140, v140, v110, v111
  v_max3_u32 v141, v141, v112, v113
  v_max_u32 v140, v140, v141
  v_cmp_eq_u32 vcc, -1, v140
  s_cbranch_vccnz mq_64
  ds_write_b128 v126, v[162:165]
  ds_write_b128 v126, v[108:111] offset:1024
  ds_write_b64 v127, v[112:113]
  s_branch mq_64_ok
mq_64_a:
  ds_write_b128 v126, v[152:155]
  ds_write_b128 v126, v[156:159] offset:1024
  ds_write_b64 v127, v[160:161]
mq_64_ok:
  s_waitcnt lgkmcnt(0)
  s_barrier
  ds_read_b128 v[4:7], v124 offset:0
  ds_read_b128 v[8:11], v124 offset:1024
  ds_read_b128 v[12:15], v124 offset:2048
  ds_read_b128 v[16:19], v124 offset:3072
  ds_read_b128 v[20:23], v124 offset:4096
  ds_read_b128 v[24:27], v124 offset:5120
  ds_read_b128 v[28:31], v124 offset:6144
  ds_read_b128 v[32:35], v124 offset:7168
  ds_read_b128 v[36:39], v124 offset:8192
  ds_read_b128 v[40:43], v124 offset:9216
  s_waitcnt lgkmcnt(9)
  v_smfmac_f32_16x16x64_bf16 v[68:71], v[4:7], a[0:7], v136
  v_smfmac_f32_16x16x64_bf16 v[72:75], v[4:7], a[80:87], v136
  buffer_store_dwordx4 v[60:63], v138, s[8:11], s57 offen
  s_waitcnt lgkmcnt(8)
  v_smfmac_f32_16x16x64_bf16 v[68:71], v[8:11], a[8:15], v136
  v_smfmac_f32_16x16x64_bf16 v[72:75], v[8:11], a[88:95], v136
  buffer_store_dwordx4 v[64:67], v138, s[8:11], s57 offen offset:512
  s_waitcnt lgkmcnt(7)
  v_smfmac_f32_16x16x64_bf16 v[68:71], v[12:15], a[16:23], v136
  v_smfmac_f32_16x16x64_bf16 v[72:75], v[12:15], a[96:103], v136
  buffer_load_dword v139, v134, s[8:11], 0 offen sc1
  s_waitcnt lgkmcnt(6)
  v_smfmac_f32_16x16x64_bf16 v[68:71], v[16:19], a[24:31], v136
  v_smfmac_f32_16x16x64_bf16 v[72:75], v[16:19], a[104:111], v136
  s_waitcnt lgkmcnt(5)
  v_smfmac_f32_16x16x64_bf16 v[68:71], v[20:23], a[32:39], v136
  v_smfmac_f32_16x16x64_bf16 v[72:75], v[20:23], a[112:119], v136
  s_waitcnt lgkmcnt(4)
  v_smfmac_f32_16x16x64_bf16 v[68:71], v[24:27], a[40:47], v136
  v_smfmac_f32_16x16x64_bf16 v[72:75], v[24:27], a[120:127], v136
  s_waitcnt lgkmcnt(3)
  v_smfmac_f32_16x16x64_bf16 v[68:71], v[28:31], a[48:55], v136
  v_smfmac_f32_16x16x64_bf16 v[72:75], v[28:31], a[128:135], v136
  s_waitcnt lgkmcnt(2)
  v_smfmac_f32_16x16x64_bf16 v[68:71], v[32:35], a[56:63], v136
  v_smfmac_f32_16x16x64_bf16 v[72:75], v[32:35], a[136:143], v136
  s_waitcnt lgkmcnt(1)
  v_smfmac_f32_16x16x64_bf16 v[68:71], v[36:39], a[64:71], v136
  v_smfmac_f32_16x16x64_bf16 v[72:75], v[36:39], a[144:151], v136
  s_waitcnt lgkmcnt(0)
  v_smfmac_f32_16x16x64_bf16 v[68:71], v[40:43], a[72:79], v136
  v_smfmac_f32_16x16x64_bf16 v[72:75], v[40:43], a[152:159], v136
  v_smfmac_f32_16x16x64_bf16 v[76:79], v[4:7], a[160:167], v136
  v_smfmac_f32_16x16x64_bf16 v[76:79], v[8:11], a[168:175], v136
  s_nop 4
  v_add_f32 v68, v68, v70
  v_add_f32 v69, v69, v71
  v_add_f32 v72, v72, v74
  v_add_f32 v73, v73, v75
  v_smfmac_f32_16x16x64_bf16 v[76:79], v[12:15], a[176:183], v136
  v_cvt_pk_bf16_f32 v122, v68, v69
  v_cvt_pk_bf16_f32 v123, v72, v73
  ds_write2_b32 v128, v122, v122 offset0:0 offset1:4
  ds_write2_b32 v129, v123, v123 offset0:0 offset1:1
  v_smfmac_f32_16x16x64_bf16 v[76:79], v[16:19], a[184:191], v136
  v_smfmac_f32_16x16x64_bf16 v[76:79], v[20:23], a[192:199], v136
  s_waitcnt lgkmcnt(0)
  s_barrier
  ds_read_b64_tr_b16 v[60:61], v125 offset:12288
  ds_read_b64_tr_b16 v[62:63], v125 offset:12800
  ds_read_b64_tr_b16 v[64:65], v125 offset:13312
  ds_read_b64_tr_b16 v[66:67], v125 offset:13824
  v_smfmac_f32_16x16x64_bf16 v[76:79], v[24:27], a[200:207], v136
  v_smfmac_f32_16x16x64_bf16 v[76:79], v[28:31], a[208:215], v136
  v_smfmac_f32_16x16x64_bf16 v[76:79], v[32:35], a[216:223], v136
  v_smfmac_f32_16x16x64_bf16 v[76:79], v[36:39], a[224:231], v136
  v_smfmac_f32_16x16x64_bf16 v[76:79], v[40:43], a[232:239], v136
  s_nop 7
  v_add_f32 v76, v76, v78
  v_add_f32 v77, v77, v79
  v_cvt_pk_bf16_f32 v140, v76, v77
  s_nop 1
  v_mov_b32_dpp v141, v140 row_ror:4 row_mask:0xf bank_mask:0xa
  s_nop 1
  v_mov_b32_dpp v141, v140 row_ror:12 row_mask:0xf bank_mask:0x5
  v_perm_b32 v140, v141, v140, v137
  buffer_store_dword v140, v130, s[8:11], s51 offen
  s_and_b32 s42, s40, 3
  s_xor_b32 s42, s42, 2
  s_mul_i32 s42, s42, 163840
  s_add_u32 s42, s42, s64
  s_add_u32 s43, s42, 65536
  s_add_u32 s44, s42, s63
  s_waitcnt vmcnt(0)
  s_barrier
  buffer_store_dwordx4 v[84:87], v131, s[8:11], s42 offen sc1
  buffer_store_dwordx4 v[84:87], v131, s[8:11], s43 offen sc1
  buffer_store_dwordx4 v[84:87], v131, s[8:11], s44 offen sc1
  v_mov_b32 v143, s40
  s_add_u32 s40, s40, 1
  s_cmp_eq_u32 s40, 64
  s_cbranch_scc1 chain_last_c2n
  s_add_u32 s78, s40, 1
  s_waitcnt vmcnt(0)
  buffer_store_dword v143, v135, s[8:11], 0 offen
  s_mov_b32 s41, 0
cpw_65:
  v_cmp_gt_u32 vcc, s78, v139
  s_nop 0
  s_and_b32 vcc_lo, vcc_lo, 0xfff000
  s_and_b32 vcc_hi, vcc_hi, 0xfffff0
  s_cmp_eq_u64 vcc, 0
  s_cbranch_scc1 cpo_66
  s_sleep 1
  buffer_load_dword v139, v134, s[8:11], 0 offen sc1
  s_add_u32 s41, s41, 1
  s_cmp_gt_u32 s41, 65536
  s_cbranch_scc1 chain_abort
  s_waitcnt vmcnt(0)
  s_branch cpw_65
cpo_66:
  s_mov_b32 s42, s46
  s_mov_b32 s46, s47
  s_mov_b32 s47, s42
  s_cmp_ge_u32 s40, 2
  s_cselect_b32 s43, 3072, 0
  s_add_u32 s57, s57, s43
  s_add_u32 s54, s55, s79
  s_and_b32 s42, s40, 3
  s_lshl_b32 s43, s42, 15
  s_add_u32 s52, s49, s43
  s_add_u32 s53, s52, 4096
  s_add_u32 s55, s48, s43
  s_add_u32 s50, s55, s56
  s_lshl_b32 s44, s38, 10
  s_add_u32 s51, s55, s44
  s_add_u32 s51, s51, 4096
  v_mov_b32 v68, 0
  v_mov_b32 v69, 0
  v_mov_b32 v70, 0
  v_mov_b32 v71, 0
  v_mov_b32 v72, 0
  v_mov_b32 v73, 0
  v_mov_b32 v74, 0
  v_mov_b32 v75, 0
  v_mov_b32 v76, 0
  v_mov_b32 v77, 0
  v_mov_b32 v78, 0
  v_mov_b32 v79, 0
  s_sleep 16
  s_branch chain_loop_c2n
chain_last_c2n:
  s_cmp_ge_u32 s40, 2
  s_cselect_b32 s43, 3072, 0
  s_add_u32 s57, s57, s43
  s_waitcnt lgkmcnt(0)
  buffer_store_dwordx4 v[60:63], v138, s[8:11], s57 offen
  buffer_store_dwordx4 v[64:67], v138, s[8:11], s57 offen offset:512
  v_mov_b32 v143, s40
  s_branch chain_fin
chain_fin:
  s_waitcnt vmcnt(0)
  buffer_store_dword v143, v135, s[8:11], 0 offen
  s_endpgm
chain_abort:
  v_mov_b32 v140, 128
  v_mov_b32 v141, 1
  s_mov_b64 exec, 1
  buffer_atomic_add v141, v140, s[12:15], 0 offen
  s_endpgm
.section .rodata,"a"
.p2align 6
.amdhsa_kernel init_kernel
  .amdhsa_next_free_vgpr 256
  .amdhsa_next_free_sgpr 102
  .amdhsa_accum_offset 256
  .amdhsa_group_segment_fixed_size 0
  .amdhsa_kernarg_size 136
  .amdhsa_user_sgpr_count 2
  .amdhsa_user_sgpr_kernarg_segment_ptr 1
  .amdhsa_system_sgpr_workgroup_id_x 1
.end_amdhsa_kernel
.p2align 6
.amdhsa_kernel main_kernel
  .amdhsa_next_free_vgpr 512
  .amdhsa_next_free_sgpr 102
  .amdhsa_accum_offset 256
  .amdhsa_group_segment_fixed_size 0
  .amdhsa_kernarg_size 136
  .amdhsa_user_sgpr_count 2
  .amdhsa_user_sgpr_kernarg_segment_ptr 1
  .amdhsa_system_sgpr_workgroup_id_x 1
.end_amdhsa_kernel
```

```asm
; @launch kernel=init_kernel grid=(64,1,1) block=(256,1,1) lds=8192
; @launch kernel=main_kernel grid=(256,1,1) block=(256,1,1) lds=163840
.amdgcn_target "amdgcn-amd-amdhsa--gfx950"
.text
.globl init_kernel
.p2align 8
.type init_kernel,@function
init_kernel:
  s_load_dwordx2 s[8:9], s[0:1], 128
  s_mov_b32 s10, 268435456
  s_mov_b32 s11, 0x00020000
  s_load_dwordx2 s[12:13], s[0:1], 8
  s_mov_b32 s14, 10240
  s_mov_b32 s15, 0x00020000
  s_load_dwordx2 s[16:17], s[0:1], 96
  s_mov_b32 s18, 1280
  s_mov_b32 s19, 0x00020000
  s_load_dwordx2 s[20:21], s[0:1], 104
  s_mov_b32 s22, 4915200
  s_mov_b32 s23, 0x00020000
  s_cmp_ge_u32 s2, 64
  s_cbranch_scc1 init_end
  s_lshl_b32 s3, s2, 8
  v_add_u32 v1, s3, v0
  v_lshlrev_b32 v2, 4, v1
  v_mov_b32 v4, -1
  v_mov_b32 v5, -1
  v_mov_b32 v6, -1
  v_mov_b32 v7, -1
  v_mov_b32 v8, 0
  v_mov_b32 v9, 0
  v_mov_b32 v10, 0
  v_mov_b32 v11, 0
  s_waitcnt lgkmcnt(0)
  s_mov_b32 s4, 212992
  buffer_store_dwordx4 v[4:7], v2, s[8:11], s4 offen
  s_mov_b32 s4, 475136
  buffer_store_dwordx4 v[4:7], v2, s[8:11], s4 offen
  s_mov_b32 s4, 737280
  buffer_store_dwordx4 v[4:7], v2, s[8:11], s4 offen
  s_mov_b32 s4, 999424
  buffer_store_dwordx4 v[4:7], v2, s[8:11], s4 offen
  s_mov_b32 s4, 1261568
  buffer_store_dwordx4 v[4:7], v2, s[8:11], s4 offen
  s_mov_b32 s4, 1523712
  buffer_store_dwordx4 v[4:7], v2, s[8:11], s4 offen
  s_mov_b32 s4, 1785856
  buffer_store_dwordx4 v[4:7], v2, s[8:11], s4 offen
  s_mov_b32 s4, 2048000
  buffer_store_dwordx4 v[4:7], v2, s[8:11], s4 offen
  s_mov_b32 s4, 2310144
  buffer_store_dwordx4 v[4:7], v2, s[8:11], s4 offen
  s_mov_b32 s4, 2572288
  buffer_store_dwordx4 v[4:7], v2, s[8:11], s4 offen
  s_cmp_ge_u32 s2, 16
  s_cbranch_scc1 init_nf
  buffer_store_dwordx4 v[8:11], v2, s[8:11], 0 offen
init_nf:
  s_cmp_ge_u32 s2, 60
  s_cbranch_scc0 init_mod
  s_sub_u32 s5, s2, 60
  s_lshl_b32 s5, s5, 8
  v_add_u32 v1, s5, v0
  v_cmp_gt_u32 vcc, 640, v1
  s_nop 0
  s_and_b64 exec, exec, vcc
  s_cbranch_execz init_end
  v_lshrrev_b32 v12, 6, v1
  v_lshlrev_b32 v12, 7, v12
  v_bfe_u32 v13, v1, 5, 1
  v_lshlrev_b32 v13, 6, v13
  v_add_u32 v12, v12, v13
  v_bfe_u32 v13, v1, 4, 1
  v_lshlrev_b32 v13, 4, v13
  v_add_u32 v12, v12, v13
  v_bfe_u32 v13, v1, 1, 1
  v_lshlrev_b32 v13, 2, v13
  v_add_u32 v12, v12, v13
  v_bfe_u32 v13, v1, 2, 2
  v_lshlrev_b32 v13, 1, v13
  v_and_b32 v18, 1, v1
  v_add_u32 v13, v13, v18
  v_mul_u32_u24 v13, 1280, v13
  v_add_u32 v12, v12, v13
  buffer_load_dword v14, v12, s[12:15], 0 offen
  buffer_load_dword v15, v12, s[12:15], 0 offen offset:32
  buffer_load_dword v16, v12, s[12:15], 0 offen offset:8
  buffer_load_dword v17, v12, s[12:15], 0 offen offset:40
  v_lshlrev_b32 v2, 4, v1
  s_waitcnt vmcnt(0)
  s_mov_b32 s4, 131072
  buffer_store_dwordx4 v[14:17], v2, s[8:11], s4 offen
  s_mov_b32 s4, 141312
  buffer_store_dwordx4 v[14:17], v2, s[8:11], s4 offen
  s_mov_b32 s4, 151552
  buffer_store_dwordx4 v[14:17], v2, s[8:11], s4 offen
  s_mov_b32 s4, 161792
  buffer_store_dwordx4 v[14:17], v2, s[8:11], s4 offen
  s_mov_b32 s4, 172032
  buffer_store_dwordx4 v[14:17], v2, s[8:11], s4 offen
  s_mov_b32 s4, 182272
  buffer_store_dwordx4 v[14:17], v2, s[8:11], s4 offen
  s_mov_b32 s4, 192512
  buffer_store_dwordx4 v[14:17], v2, s[8:11], s4 offen
  s_mov_b32 s4, 202752
  buffer_store_dwordx4 v[14:17], v2, s[8:11], s4 offen
  s_branch init_end
init_mod:
  v_lshlrev_b32 v12, 2, v0
  buffer_load_dword v13, v12, s[16:19], 0 offen
  buffer_load_dword v14, v12, s[16:19], 0 offen offset:1024
  v_lshrrev_b32 v20, 5, v0
  v_and_b32 v21, 31, v0
  v_mul_u32_u24 v22, 614400, v20
  v_lshlrev_b32 v23, 2, v21
  v_add_u32 v22, v22, v23
  s_lshl_b32 s6, s2, 7
  buffer_load_dword v40, v22, s[20:23], s6 offen
  s_add_u32 s6, s6, 7680
  buffer_load_dword v41, v22, s[20:23], s6 offen
  s_add_u32 s6, s6, 7680
  buffer_load_dword v42, v22, s[20:23], s6 offen
  s_add_u32 s6, s6, 7680
  buffer_load_dword v43, v22, s[20:23], s6 offen
  s_add_u32 s6, s6, 7680
  buffer_load_dword v44, v22, s[20:23], s6 offen
  s_add_u32 s6, s6, 7680
  buffer_load_dword v45, v22, s[20:23], s6 offen
  s_add_u32 s6, s6, 7680
  buffer_load_dword v46, v22, s[20:23], s6 offen
  s_add_u32 s6, s6, 7680
  buffer_load_dword v47, v22, s[20:23], s6 offen
  s_add_u32 s6, s6, 7680
  buffer_load_dword v48, v22, s[20:23], s6 offen
  s_add_u32 s6, s6, 7680
  buffer_load_dword v49, v22, s[20:23], s6 offen
  s_add_u32 s6, s6, 7680
  buffer_load_dword v50, v22, s[20:23], s6 offen
  s_add_u32 s6, s6, 7680
  buffer_load_dword v51, v22, s[20:23], s6 offen
  s_add_u32 s6, s6, 7680
  buffer_load_dword v52, v22, s[20:23], s6 offen
  s_add_u32 s6, s6, 7680
  buffer_load_dword v53, v22, s[20:23], s6 offen
  s_add_u32 s6, s6, 7680
  buffer_load_dword v54, v22, s[20:23], s6 offen
  s_add_u32 s6, s6, 7680
  buffer_load_dword v55, v22, s[20:23], s6 offen
  s_add_u32 s6, s6, 7680
  buffer_load_dword v56, v22, s[20:23], s6 offen
  s_add_u32 s6, s6, 7680
  buffer_load_dword v57, v22, s[20:23], s6 offen
  s_add_u32 s6, s6, 7680
  buffer_load_dword v58, v22, s[20:23], s6 offen
  s_add_u32 s6, s6, 7680
  buffer_load_dword v59, v22, s[20:23], s6 offen
  s_add_u32 s6, s6, 7680
  buffer_load_dword v60, v22, s[20:23], s6 offen
  s_add_u32 s6, s6, 7680
  buffer_load_dword v61, v22, s[20:23], s6 offen
  s_add_u32 s6, s6, 7680
  buffer_load_dword v62, v22, s[20:23], s6 offen
  s_add_u32 s6, s6, 7680
  buffer_load_dword v63, v22, s[20:23], s6 offen
  s_add_u32 s6, s6, 7680
  buffer_load_dword v64, v22, s[20:23], s6 offen
  s_add_u32 s6, s6, 7680
  buffer_load_dword v65, v22, s[20:23], s6 offen
  s_add_u32 s6, s6, 7680
  buffer_load_dword v66, v22, s[20:23], s6 offen
  s_add_u32 s6, s6, 7680
  buffer_load_dword v67, v22, s[20:23], s6 offen
  s_add_u32 s6, s6, 7680
  buffer_load_dword v68, v22, s[20:23], s6 offen
  s_add_u32 s6, s6, 7680
  buffer_load_dword v69, v22, s[20:23], s6 offen
  s_add_u32 s6, s6, 7680
  buffer_load_dword v70, v22, s[20:23], s6 offen
  s_add_u32 s6, s6, 7680
  buffer_load_dword v71, v22, s[20:23], s6 offen
  s_add_u32 s6, s6, 7680
  buffer_load_dword v72, v22, s[20:23], s6 offen
  s_add_u32 s6, s6, 7680
  buffer_load_dword v73, v22, s[20:23], s6 offen
  s_add_u32 s6, s6, 7680
  buffer_load_dword v74, v22, s[20:23], s6 offen
  s_add_u32 s6, s6, 7680
  buffer_load_dword v75, v22, s[20:23], s6 offen
  s_add_u32 s6, s6, 7680
  buffer_load_dword v76, v22, s[20:23], s6 offen
  s_add_u32 s6, s6, 7680
  buffer_load_dword v77, v22, s[20:23], s6 offen
  s_add_u32 s6, s6, 7680
  buffer_load_dword v78, v22, s[20:23], s6 offen
  s_add_u32 s6, s6, 7680
  buffer_load_dword v79, v22, s[20:23], s6 offen
  s_add_u32 s6, s6, 7680
  buffer_load_dword v80, v22, s[20:23], s6 offen
  s_add_u32 s6, s6, 7680
  buffer_load_dword v81, v22, s[20:23], s6 offen
  s_add_u32 s6, s6, 7680
  buffer_load_dword v82, v22, s[20:23], s6 offen
  s_add_u32 s6, s6, 7680
  buffer_load_dword v83, v22, s[20:23], s6 offen
  s_add_u32 s6, s6, 7680
  buffer_load_dword v84, v22, s[20:23], s6 offen
  s_add_u32 s6, s6, 7680
  buffer_load_dword v85, v22, s[20:23], s6 offen
  s_add_u32 s6, s6, 7680
  buffer_load_dword v86, v22, s[20:23], s6 offen
  s_add_u32 s6, s6, 7680
  buffer_load_dword v87, v22, s[20:23], s6 offen
  s_add_u32 s6, s6, 7680
  buffer_load_dword v88, v22, s[20:23], s6 offen
  s_add_u32 s6, s6, 7680
  buffer_load_dword v89, v22, s[20:23], s6 offen
  s_add_u32 s6, s6, 7680
  buffer_load_dword v90, v22, s[20:23], s6 offen
  s_add_u32 s6, s6, 7680
  buffer_load_dword v91, v22, s[20:23], s6 offen
  s_add_u32 s6, s6, 7680
  buffer_load_dword v92, v22, s[20:23], s6 offen
  s_add_u32 s6, s6, 7680
  buffer_load_dword v93, v22, s[20:23], s6 offen
  s_add_u32 s6, s6, 7680
  buffer_load_dword v94, v22, s[20:23], s6 offen
  s_add_u32 s6, s6, 7680
  buffer_load_dword v95, v22, s[20:23], s6 offen
  s_add_u32 s6, s6, 7680
  buffer_load_dword v96, v22, s[20:23], s6 offen
  s_add_u32 s6, s6, 7680
  buffer_load_dword v97, v22, s[20:23], s6 offen
  s_add_u32 s6, s6, 7680
  buffer_load_dword v98, v22, s[20:23], s6 offen
  s_add_u32 s6, s6, 7680
  buffer_load_dword v99, v22, s[20:23], s6 offen
  s_add_u32 s6, s6, 7680
  buffer_load_dword v100, v22, s[20:23], s6 offen
  s_add_u32 s6, s6, 7680
  buffer_load_dword v101, v22, s[20:23], s6 offen
  s_add_u32 s6, s6, 7680
  buffer_load_dword v102, v22, s[20:23], s6 offen
  s_add_u32 s6, s6, 7680
  buffer_load_dword v103, v22, s[20:23], s6 offen
  s_add_u32 s6, s6, 7680
  buffer_load_dword v104, v22, s[20:23], s6 offen
  s_add_u32 s6, s6, 7680
  buffer_load_dword v105, v22, s[20:23], s6 offen
  s_add_u32 s6, s6, 7680
  buffer_load_dword v106, v22, s[20:23], s6 offen
  s_add_u32 s6, s6, 7680
  buffer_load_dword v107, v22, s[20:23], s6 offen
  s_add_u32 s6, s6, 7680
  buffer_load_dword v108, v22, s[20:23], s6 offen
  s_add_u32 s6, s6, 7680
  buffer_load_dword v109, v22, s[20:23], s6 offen
  s_add_u32 s6, s6, 7680
  buffer_load_dword v110, v22, s[20:23], s6 offen
  s_add_u32 s6, s6, 7680
  buffer_load_dword v111, v22, s[20:23], s6 offen
  s_add_u32 s6, s6, 7680
  buffer_load_dword v112, v22, s[20:23], s6 offen
  s_add_u32 s6, s6, 7680
  buffer_load_dword v113, v22, s[20:23], s6 offen
  s_add_u32 s6, s6, 7680
  buffer_load_dword v114, v22, s[20:23], s6 offen
  s_add_u32 s6, s6, 7680
  buffer_load_dword v115, v22, s[20:23], s6 offen
  s_add_u32 s6, s6, 7680
  buffer_load_dword v116, v22, s[20:23], s6 offen
  s_add_u32 s6, s6, 7680
  buffer_load_dword v117, v22, s[20:23], s6 offen
  s_add_u32 s6, s6, 7680
  buffer_load_dword v118, v22, s[20:23], s6 offen
  s_add_u32 s6, s6, 7680
  buffer_load_dword v119, v22, s[20:23], s6 offen
  s_add_u32 s6, s6, 7680
  s_waitcnt vmcnt(63)
  s_waitcnt vmcnt(63)
  v_lshlrev_b32 v24, 16, v13
  v_and_b32 v25, 0xffff0000, v13
  v_mul_f32 v30, 0xbfb8aa3b, v24
  v_mul_f32 v31, 0xbfb8aa3b, v25
  v_exp_f32 v30, v30
  v_exp_f32 v31, v31
  v_add_f32 v30, 1.0, v30
  v_add_f32 v31, 1.0, v31
  v_rcp_f32 v30, v30
  v_rcp_f32 v31, v31
  v_mul_f32 v24, v24, v30
  v_mul_f32 v25, v25, v31
  v_cvt_pk_bf16_f32 v30, v24, v25
  v_lshlrev_b32 v24, 16, v30
  v_and_b32 v25, 0xffff0000, v30
  v_lshlrev_b32 v26, 16, v14
  v_and_b32 v27, 0xffff0000, v14
  v_mul_f32 v30, 0xbfb8aa3b, v26
  v_mul_f32 v31, 0xbfb8aa3b, v27
  v_exp_f32 v30, v30
  v_exp_f32 v31, v31
  v_add_f32 v30, 1.0, v30
  v_add_f32 v31, 1.0, v31
  v_rcp_f32 v30, v30
  v_rcp_f32 v31, v31
  v_mul_f32 v26, v26, v30
  v_mul_f32 v27, v27, v31
  v_cvt_pk_bf16_f32 v30, v26, v27
  v_lshlrev_b32 v26, 16, v30
  v_and_b32 v27, 0xffff0000, v30
  v_lshlrev_b32 v12, 3, v0
  ds_write_b64 v12, v[24:25]
  ds_write_b64 v12, v[26:27] offset:2048
  s_waitcnt lgkmcnt(0)
  s_barrier
  v_mul_u32_u24 v12, 320, v20
  v_mov_b32 v24, 0
  v_mov_b32 v25, 0
  ds_read_b128 v[124:127], v12 offset:0
  ds_read_b128 v[128:131], v12 offset:16
  ds_read_b128 v[132:135], v12 offset:32
  ds_read_b128 v[136:139], v12 offset:48
  ds_read_b128 v[140:143], v12 offset:64
  ds_read_b128 v[144:147], v12 offset:80
  ds_read_b128 v[148:151], v12 offset:96
  ds_read_b128 v[152:155], v12 offset:112
  ds_read_b128 v[156:159], v12 offset:128
  ds_read_b128 v[160:163], v12 offset:144
  ds_read_b128 v[164:167], v12 offset:160
  ds_read_b128 v[168:171], v12 offset:176
  ds_read_b128 v[172:175], v12 offset:192
  ds_read_b128 v[176:179], v12 offset:208
  ds_read_b128 v[180:183], v12 offset:224
  ds_read_b128 v[184:187], v12 offset:240
  ds_read_b128 v[188:191], v12 offset:256
  ds_read_b128 v[192:195], v12 offset:272
  ds_read_b128 v[196:199], v12 offset:288
  ds_read_b128 v[200:203], v12 offset:304
  s_waitcnt vmcnt(0) lgkmcnt(0)
  v_lshlrev_b32 v26, 16, v40
  v_and_b32 v27, 0xffff0000, v40
  v_fmac_f32 v24, v26, v124
  v_fmac_f32 v25, v27, v124
  v_lshlrev_b32 v26, 16, v41
  v_and_b32 v27, 0xffff0000, v41
  v_fmac_f32 v24, v26, v125
  v_fmac_f32 v25, v27, v125
  v_lshlrev_b32 v26, 16, v42
  v_and_b32 v27, 0xffff0000, v42
  v_fmac_f32 v24, v26, v126
  v_fmac_f32 v25, v27, v126
  v_lshlrev_b32 v26, 16, v43
  v_and_b32 v27, 0xffff0000, v43
  v_fmac_f32 v24, v26, v127
  v_fmac_f32 v25, v27, v127
  v_lshlrev_b32 v26, 16, v44
  v_and_b32 v27, 0xffff0000, v44
  v_fmac_f32 v24, v26, v128
  v_fmac_f32 v25, v27, v128
  v_lshlrev_b32 v26, 16, v45
  v_and_b32 v27, 0xffff0000, v45
  v_fmac_f32 v24, v26, v129
  v_fmac_f32 v25, v27, v129
  v_lshlrev_b32 v26, 16, v46
  v_and_b32 v27, 0xffff0000, v46
  v_fmac_f32 v24, v26, v130
  v_fmac_f32 v25, v27, v130
  v_lshlrev_b32 v26, 16, v47
  v_and_b32 v27, 0xffff0000, v47
  v_fmac_f32 v24, v26, v131
  v_fmac_f32 v25, v27, v131
  v_lshlrev_b32 v26, 16, v48
  v_and_b32 v27, 0xffff0000, v48
  v_fmac_f32 v24, v26, v132
  v_fmac_f32 v25, v27, v132
  v_lshlrev_b32 v26, 16, v49
  v_and_b32 v27, 0xffff0000, v49
  v_fmac_f32 v24, v26, v133
  v_fmac_f32 v25, v27, v133
  v_lshlrev_b32 v26, 16, v50
  v_and_b32 v27, 0xffff0000, v50
  v_fmac_f32 v24, v26, v134
  v_fmac_f32 v25, v27, v134
  v_lshlrev_b32 v26, 16, v51
  v_and_b32 v27, 0xffff0000, v51
  v_fmac_f32 v24, v26, v135
  v_fmac_f32 v25, v27, v135
  v_lshlrev_b32 v26, 16, v52
  v_and_b32 v27, 0xffff0000, v52
  v_fmac_f32 v24, v26, v136
  v_fmac_f32 v25, v27, v136
  v_lshlrev_b32 v26, 16, v53
  v_and_b32 v27, 0xffff0000, v53
  v_fmac_f32 v24, v26, v137
  v_fmac_f32 v25, v27, v137
  v_lshlrev_b32 v26, 16, v54
  v_and_b32 v27, 0xffff0000, v54
  v_fmac_f32 v24, v26, v138
  v_fmac_f32 v25, v27, v138
  v_lshlrev_b32 v26, 16, v55
  v_and_b32 v27, 0xffff0000, v55
  v_fmac_f32 v24, v26, v139
  v_fmac_f32 v25, v27, v139
  v_lshlrev_b32 v26, 16, v56
  v_and_b32 v27, 0xffff0000, v56
  v_fmac_f32 v24, v26, v140
  v_fmac_f32 v25, v27, v140
  v_lshlrev_b32 v26, 16, v57
  v_and_b32 v27, 0xffff0000, v57
  v_fmac_f32 v24, v26, v141
  v_fmac_f32 v25, v27, v141
  v_lshlrev_b32 v26, 16, v58
  v_and_b32 v27, 0xffff0000, v58
  v_fmac_f32 v24, v26, v142
  v_fmac_f32 v25, v27, v142
  v_lshlrev_b32 v26, 16, v59
  v_and_b32 v27, 0xffff0000, v59
  v_fmac_f32 v24, v26, v143
  v_fmac_f32 v25, v27, v143
  v_lshlrev_b32 v26, 16, v60
  v_and_b32 v27, 0xffff0000, v60
  v_fmac_f32 v24, v26, v144
  v_fmac_f32 v25, v27, v144
  v_lshlrev_b32 v26, 16, v61
  v_and_b32 v27, 0xffff0000, v61
  v_fmac_f32 v24, v26, v145
  v_fmac_f32 v25, v27, v145
  v_lshlrev_b32 v26, 16, v62
  v_and_b32 v27, 0xffff0000, v62
  v_fmac_f32 v24, v26, v146
  v_fmac_f32 v25, v27, v146
  v_lshlrev_b32 v26, 16, v63
  v_and_b32 v27, 0xffff0000, v63
  v_fmac_f32 v24, v26, v147
  v_fmac_f32 v25, v27, v147
  v_lshlrev_b32 v26, 16, v64
  v_and_b32 v27, 0xffff0000, v64
  v_fmac_f32 v24, v26, v148
  v_fmac_f32 v25, v27, v148
  v_lshlrev_b32 v26, 16, v65
  v_and_b32 v27, 0xffff0000, v65
  v_fmac_f32 v24, v26, v149
  v_fmac_f32 v25, v27, v149
  v_lshlrev_b32 v26, 16, v66
  v_and_b32 v27, 0xffff0000, v66
  v_fmac_f32 v24, v26, v150
  v_fmac_f32 v25, v27, v150
  v_lshlrev_b32 v26, 16, v67
  v_and_b32 v27, 0xffff0000, v67
  v_fmac_f32 v24, v26, v151
  v_fmac_f32 v25, v27, v151
  v_lshlrev_b32 v26, 16, v68
  v_and_b32 v27, 0xffff0000, v68
  v_fmac_f32 v24, v26, v152
  v_fmac_f32 v25, v27, v152
  v_lshlrev_b32 v26, 16, v69
  v_and_b32 v27, 0xffff0000, v69
  v_fmac_f32 v24, v26, v153
  v_fmac_f32 v25, v27, v153
  v_lshlrev_b32 v26, 16, v70
  v_and_b32 v27, 0xffff0000, v70
  v_fmac_f32 v24, v26, v154
  v_fmac_f32 v25, v27, v154
  v_lshlrev_b32 v26, 16, v71
  v_and_b32 v27, 0xffff0000, v71
  v_fmac_f32 v24, v26, v155
  v_fmac_f32 v25, v27, v155
  v_lshlrev_b32 v26, 16, v72
  v_and_b32 v27, 0xffff0000, v72
  v_fmac_f32 v24, v26, v156
  v_fmac_f32 v25, v27, v156
  v_lshlrev_b32 v26, 16, v73
  v_and_b32 v27, 0xffff0000, v73
  v_fmac_f32 v24, v26, v157
  v_fmac_f32 v25, v27, v157
  v_lshlrev_b32 v26, 16, v74
  v_and_b32 v27, 0xffff0000, v74
  v_fmac_f32 v24, v26, v158
  v_fmac_f32 v25, v27, v158
  v_lshlrev_b32 v26, 16, v75
  v_and_b32 v27, 0xffff0000, v75
  v_fmac_f32 v24, v26, v159
  v_fmac_f32 v25, v27, v159
  v_lshlrev_b32 v26, 16, v76
  v_and_b32 v27, 0xffff0000, v76
  v_fmac_f32 v24, v26, v160
  v_fmac_f32 v25, v27, v160
  v_lshlrev_b32 v26, 16, v77
  v_and_b32 v27, 0xffff0000, v77
  v_fmac_f32 v24, v26, v161
  v_fmac_f32 v25, v27, v161
  v_lshlrev_b32 v26, 16, v78
  v_and_b32 v27, 0xffff0000, v78
  v_fmac_f32 v24, v26, v162
  v_fmac_f32 v25, v27, v162
  v_lshlrev_b32 v26, 16, v79
  v_and_b32 v27, 0xffff0000, v79
  v_fmac_f32 v24, v26, v163
  v_fmac_f32 v25, v27, v163
  v_lshlrev_b32 v26, 16, v80
  v_and_b32 v27, 0xffff0000, v80
  v_fmac_f32 v24, v26, v164
  v_fmac_f32 v25, v27, v164
  v_lshlrev_b32 v26, 16, v81
  v_and_b32 v27, 0xffff0000, v81
  v_fmac_f32 v24, v26, v165
  v_fmac_f32 v25, v27, v165
  v_lshlrev_b32 v26, 16, v82
  v_and_b32 v27, 0xffff0000, v82
  v_fmac_f32 v24, v26, v166
  v_fmac_f32 v25, v27, v166
  v_lshlrev_b32 v26, 16, v83
  v_and_b32 v27, 0xffff0000, v83
  v_fmac_f32 v24, v26, v167
  v_fmac_f32 v25, v27, v167
  v_lshlrev_b32 v26, 16, v84
  v_and_b32 v27, 0xffff0000, v84
  v_fmac_f32 v24, v26, v168
  v_fmac_f32 v25, v27, v168
  v_lshlrev_b32 v26, 16, v85
  v_and_b32 v27, 0xffff0000, v85
  v_fmac_f32 v24, v26, v169
  v_fmac_f32 v25, v27, v169
  v_lshlrev_b32 v26, 16, v86
  v_and_b32 v27, 0xffff0000, v86
  v_fmac_f32 v24, v26, v170
  v_fmac_f32 v25, v27, v170
  v_lshlrev_b32 v26, 16, v87
  v_and_b32 v27, 0xffff0000, v87
  v_fmac_f32 v24, v26, v171
  v_fmac_f32 v25, v27, v171
  v_lshlrev_b32 v26, 16, v88
  v_and_b32 v27, 0xffff0000, v88
  v_fmac_f32 v24, v26, v172
  v_fmac_f32 v25, v27, v172
  v_lshlrev_b32 v26, 16, v89
  v_and_b32 v27, 0xffff0000, v89
  v_fmac_f32 v24, v26, v173
  v_fmac_f32 v25, v27, v173
  v_lshlrev_b32 v26, 16, v90
  v_and_b32 v27, 0xffff0000, v90
  v_fmac_f32 v24, v26, v174
  v_fmac_f32 v25, v27, v174
  v_lshlrev_b32 v26, 16, v91
  v_and_b32 v27, 0xffff0000, v91
  v_fmac_f32 v24, v26, v175
  v_fmac_f32 v25, v27, v175
  v_lshlrev_b32 v26, 16, v92
  v_and_b32 v27, 0xffff0000, v92
  v_fmac_f32 v24, v26, v176
  v_fmac_f32 v25, v27, v176
  v_lshlrev_b32 v26, 16, v93
  v_and_b32 v27, 0xffff0000, v93
  v_fmac_f32 v24, v26, v177
  v_fmac_f32 v25, v27, v177
  v_lshlrev_b32 v26, 16, v94
  v_and_b32 v27, 0xffff0000, v94
  v_fmac_f32 v24, v26, v178
  v_fmac_f32 v25, v27, v178
  v_lshlrev_b32 v26, 16, v95
  v_and_b32 v27, 0xffff0000, v95
  v_fmac_f32 v24, v26, v179
  v_fmac_f32 v25, v27, v179
  v_lshlrev_b32 v26, 16, v96
  v_and_b32 v27, 0xffff0000, v96
  v_fmac_f32 v24, v26, v180
  v_fmac_f32 v25, v27, v180
  v_lshlrev_b32 v26, 16, v97
  v_and_b32 v27, 0xffff0000, v97
  v_fmac_f32 v24, v26, v181
  v_fmac_f32 v25, v27, v181
  v_lshlrev_b32 v26, 16, v98
  v_and_b32 v27, 0xffff0000, v98
  v_fmac_f32 v24, v26, v182
  v_fmac_f32 v25, v27, v182
  v_lshlrev_b32 v26, 16, v99
  v_and_b32 v27, 0xffff0000, v99
  v_fmac_f32 v24, v26, v183
  v_fmac_f32 v25, v27, v183
  v_lshlrev_b32 v26, 16, v100
  v_and_b32 v27, 0xffff0000, v100
  v_fmac_f32 v24, v26, v184
  v_fmac_f32 v25, v27, v184
  v_lshlrev_b32 v26, 16, v101
  v_and_b32 v27, 0xffff0000, v101
  v_fmac_f32 v24, v26, v185
  v_fmac_f32 v25, v27, v185
  v_lshlrev_b32 v26, 16, v102
  v_and_b32 v27, 0xffff0000, v102
  v_fmac_f32 v24, v26, v186
  v_fmac_f32 v25, v27, v186
  v_lshlrev_b32 v26, 16, v103
  v_and_b32 v27, 0xffff0000, v103
  v_fmac_f32 v24, v26, v187
  v_fmac_f32 v25, v27, v187
  v_lshlrev_b32 v26, 16, v104
  v_and_b32 v27, 0xffff0000, v104
  v_fmac_f32 v24, v26, v188
  v_fmac_f32 v25, v27, v188
  v_lshlrev_b32 v26, 16, v105
  v_and_b32 v27, 0xffff0000, v105
  v_fmac_f32 v24, v26, v189
  v_fmac_f32 v25, v27, v189
  v_lshlrev_b32 v26, 16, v106
  v_and_b32 v27, 0xffff0000, v106
  v_fmac_f32 v24, v26, v190
  v_fmac_f32 v25, v27, v190
  v_lshlrev_b32 v26, 16, v107
  v_and_b32 v27, 0xffff0000, v107
  v_fmac_f32 v24, v26, v191
  v_fmac_f32 v25, v27, v191
  v_lshlrev_b32 v26, 16, v108
  v_and_b32 v27, 0xffff0000, v108
  v_fmac_f32 v24, v26, v192
  v_fmac_f32 v25, v27, v192
  v_lshlrev_b32 v26, 16, v109
  v_and_b32 v27, 0xffff0000, v109
  v_fmac_f32 v24, v26, v193
  v_fmac_f32 v25, v27, v193
  v_lshlrev_b32 v26, 16, v110
  v_and_b32 v27, 0xffff0000, v110
  v_fmac_f32 v24, v26, v194
  v_fmac_f32 v25, v27, v194
  v_lshlrev_b32 v26, 16, v111
  v_and_b32 v27, 0xffff0000, v111
  v_fmac_f32 v24, v26, v195
  v_fmac_f32 v25, v27, v195
  v_lshlrev_b32 v26, 16, v112
  v_and_b32 v27, 0xffff0000, v112
  v_fmac_f32 v24, v26, v196
  v_fmac_f32 v25, v27, v196
  v_lshlrev_b32 v26, 16, v113
  v_and_b32 v27, 0xffff0000, v113
  v_fmac_f32 v24, v26, v197
  v_fmac_f32 v25, v27, v197
  v_lshlrev_b32 v26, 16, v114
  v_and_b32 v27, 0xffff0000, v114
  v_fmac_f32 v24, v26, v198
  v_fmac_f32 v25, v27, v198
  v_lshlrev_b32 v26, 16, v115
  v_and_b32 v27, 0xffff0000, v115
  v_fmac_f32 v24, v26, v199
  v_fmac_f32 v25, v27, v199
  v_lshlrev_b32 v26, 16, v116
  v_and_b32 v27, 0xffff0000, v116
  v_fmac_f32 v24, v26, v200
  v_fmac_f32 v25, v27, v200
  v_lshlrev_b32 v26, 16, v117
  v_and_b32 v27, 0xffff0000, v117
  v_fmac_f32 v24, v26, v201
  v_fmac_f32 v25, v27, v201
  v_lshlrev_b32 v26, 16, v118
  v_and_b32 v27, 0xffff0000, v118
  v_fmac_f32 v24, v26, v202
  v_fmac_f32 v25, v27, v202
  v_lshlrev_b32 v26, 16, v119
  v_and_b32 v27, 0xffff0000, v119
  v_fmac_f32 v24, v26, v203
  v_fmac_f32 v25, v27, v203
  v_lshlrev_b32 v12, 3, v0
  ds_write_b64 v12, v[24:25] offset:4096
  s_waitcnt lgkmcnt(0)
  s_barrier
  v_cmp_gt_u32 vcc, 32, v0
  s_nop 0
  s_and_b64 exec, exec, vcc
  s_cbranch_execz init_end
  ds_read_b64 v[40:41], v12 offset:4096
  ds_read_b64 v[42:43], v12 offset:4352
  ds_read_b64 v[44:45], v12 offset:4608
  ds_read_b64 v[46:47], v12 offset:4864
  ds_read_b64 v[48:49], v12 offset:5120
  ds_read_b64 v[50:51], v12 offset:5376
  ds_read_b64 v[52:53], v12 offset:5632
  ds_read_b64 v[54:55], v12 offset:5888
  s_waitcnt lgkmcnt(0)
  v_add_f32 v40, v40, v42
  v_add_f32 v41, v41, v43
  v_add_f32 v40, v40, v44
  v_add_f32 v41, v41, v45
  v_add_f32 v40, v40, v46
  v_add_f32 v41, v41, v47
  v_add_f32 v40, v40, v48
  v_add_f32 v41, v41, v49
  v_add_f32 v40, v40, v50
  v_add_f32 v41, v41, v51
  v_add_f32 v40, v40, v52
  v_add_f32 v41, v41, v53
  v_add_f32 v40, v40, v54
  v_add_f32 v41, v41, v55
  v_cvt_pk_bf16_f32 v30, v40, v41
  v_lshlrev_b32 v40, 16, v30
  v_and_b32 v41, 0xffff0000, v30
  s_lshl_b32 s6, s2, 8
  s_add_u32 s6, s6, 65536
  buffer_store_dwordx2 v[40:41], v12, s[8:11], s6 offen
init_end:
  s_endpgm
.globl main_kernel
.p2align 8
.type main_kernel,@function
main_kernel:
  s_load_dwordx2 s[8:9], s[0:1], 128
  s_mov_b32 s10, 268435456
  s_mov_b32 s11, 0x00020000
  s_load_dwordx2 s[12:13], s[0:1], 120
  s_mov_b32 s14, 256
  s_mov_b32 s15, 0x00020000
  s_getreg_b32 s16, hwreg(HW_REG_XCC_ID)
  s_and_b32 s16, s16, 7
  v_and_b32 v1, 63, v0
  v_lshrrev_b32 v2, 6, v0
  s_nop 0
  v_readfirstlane_b32 s17, v2
  v_mov_b32 v3, 1
  s_lshl_b32 s3, s16, 2
  v_mov_b32 v4, s3
  v_mov_b32 v5, 0
  s_waitcnt lgkmcnt(0)
  v_cmp_eq_u32 vcc, 0, v0
  s_nop 0
  s_and_b64 exec, exec, vcc
  s_cbranch_execz main_tk
  buffer_atomic_add v3, v4, s[12:15], 0 offen sc0
  s_waitcnt vmcnt(0)
  ds_write_b32 v5, v3
  s_waitcnt lgkmcnt(0)
main_tk:
  s_mov_b64 exec, -1
  s_barrier
  ds_read_b32 v3, v5
  s_waitcnt lgkmcnt(0)
  v_readfirstlane_b32 s18, v3
  s_barrier
  s_cmp_lt_u32 s18, 12
  s_cbranch_scc1 role_chain
  s_cmp_lt_u32 s18, 21
  s_cbranch_scc1 role_p
  s_cmp_lt_u32 s18, 26
  s_cbranch_scc1 role_ua
  s_cmp_lt_u32 s18, 28
  s_cbranch_scc1 role_sm
  s_cmp_lt_u32 s18, 32
  s_cbranch_scc1 role_r
role_none:
  s_endpgm
role_abort:
  v_mov_b32 v2, 132
  v_mov_b32 v3, 1
  s_mov_b64 exec, 1
  buffer_atomic_add v3, v2, s[12:15], 0 offen
  s_endpgm
role_p:
  s_sub_u32 s24, s18, 12
  s_lshl_b32 s24, s24, 2
  s_add_u32 s24, s24, s17
  s_mul_i32 s25, s24, 43
  s_lshr_b32 s25, s25, 9
  s_mul_i32 s30, s25, 12
  s_sub_u32 s30, s24, s30
  s_mul_i32 s26, s30, 43
  s_lshr_b32 s26, s26, 7
  s_mul_i32 s31, s26, 3
  s_sub_u32 s27, s30, s31
  s_load_dwordx2 s[20:21], s[0:1], 16
  s_load_dwordx2 s[4:5], s[0:1], 24
  s_load_dwordx2 s[6:7], s[0:1], 32
  s_mov_b32 s22, 7864320
  s_mov_b32 s23, 0x00020000
  s_waitcnt lgkmcnt(0)
  s_cmp_eq_u32 s25, 1
  s_cselect_b64 s[20:21], s[4:5], s[20:21]
  s_cmp_eq_u32 s25, 2
  s_cselect_b64 s[20:21], s[6:7], s[20:21]
  v_lshrrev_b32 v107, 4, v1
  v_and_b32 v107, 3, v107
  v_lshlrev_b32 v107, 1, v107
  v_and_b32 v52, 7, v1
  v_xor_b32 v52, v52, v107
  v_lshlrev_b32 v52, 4, v52
  v_lshrrev_b32 v107, 3, v1
  v_mul_u32_u24 v107, 0, v107
  v_add_u32 v52, v52, v107
  v_bfe_u32 v107, v1, 3, 2
  v_bfe_u32 v108, v1, 5, 1
  v_lshl_add_u32 v107, v108, 3, v107
  v_mul_u32_u24 v107, 12288, v107
  v_add_u32 v52, v52, v107
  s_mul_i32 s33, s17, 40960
  v_lshrrev_b32 v107, 2, v1
  v_lshrrev_b32 v108, 1, v107
  v_and_b32 v108, 3, v108
  v_lshlrev_b32 v108, 1, v108
  v_bfe_u32 v110, v1, 1, 1
  v_add_u32 v110, 0, v110
  v_xor_b32 v110, v110, v108
  v_lshlrev_b32 v110, 4, v110
  v_lshlrev_b32 v107, 7, v107
  v_add_u32 v110, v110, v107
  v_and_b32 v107, 1, v1
  v_lshlrev_b32 v107, 3, v107
  v_add_u32 v110, v110, v107
  v_add_u32 v110, s33, v110
  v_lshrrev_b32 v107, 2, v1
  v_lshrrev_b32 v108, 1, v107
  v_and_b32 v108, 3, v108
  v_lshlrev_b32 v108, 1, v108
  v_bfe_u32 v111, v1, 1, 1
  v_add_u32 v111, 2, v111
  v_xor_b32 v111, v111, v108
  v_lshlrev_b32 v111, 4, v111
  v_lshlrev_b32 v107, 7, v107
  v_add_u32 v111, v111, v107
  v_and_b32 v107, 1, v1
  v_lshlrev_b32 v107, 3, v107
  v_add_u32 v111, v111, v107
  v_add_u32 v111, s33, v111
  v_lshrrev_b32 v107, 2, v1
  v_lshrrev_b32 v108, 1, v107
  v_and_b32 v108, 3, v108
  v_lshlrev_b32 v108, 1, v108
  v_bfe_u32 v112, v1, 1, 1
  v_add_u32 v112, 4, v112
  v_xor_b32 v112, v112, v108
  v_lshlrev_b32 v112, 4, v112
  v_lshlrev_b32 v107, 7, v107
  v_add_u32 v112, v112, v107
  v_and_b32 v107, 1, v1
  v_lshlrev_b32 v107, 3, v107
  v_add_u32 v112, v112, v107
  v_add_u32 v112, s33, v112
  v_lshrrev_b32 v107, 2, v1
  v_lshrrev_b32 v108, 1, v107
  v_and_b32 v108, 3, v108
  v_lshlrev_b32 v108, 1, v108
  v_bfe_u32 v113, v1, 1, 1
  v_add_u32 v113, 6, v113
  v_xor_b32 v113, v113, v108
  v_lshlrev_b32 v113, 4, v113
  v_lshlrev_b32 v107, 7, v107
  v_add_u32 v113, v113, v107
  v_and_b32 v107, 1, v1
  v_lshlrev_b32 v107, 3, v107
  v_add_u32 v113, v113, v107
  v_add_u32 v113, s33, v113
  s_lshl_b32 s30, s16, 2
  s_add_u32 s30, s30, s26
  s_mul_i32 s32, s30, 384
  s_lshl_b32 s31, s27, 7
  s_add_u32 s32, s32, s31
  s_lshl_b32 s38, s16, 22
  s_mul_i32 s30, s26, 12288
  s_add_u32 s38, s38, s30
  s_mul_i32 s30, s25, 49152
  s_add_u32 s38, s38, s30
  s_lshl_b32 s31, s27, 11
  s_add_u32 s38, s38, s31
  s_add_u32 s38, s38, 67108864
  s_mov_b32 s35, s38
  s_mov_b32 s31, s33
  s_mov_b32 m0, s31
  s_add_u32 s30, s32, 0
  s_add_u32 s31, s31, 1024
  buffer_load_dwordx4 v52, s[20:23], s30 offen lds
  s_mov_b32 m0, s31
  s_add_u32 s30, s32, 196608
  s_add_u32 s31, s31, 1024
  buffer_load_dwordx4 v52, s[20:23], s30 offen lds
  s_mov_b32 m0, s31
  s_add_u32 s30, s32, 49152
  s_add_u32 s31, s31, 1024
  buffer_load_dwordx4 v52, s[20:23], s30 offen lds
  s_mov_b32 m0, s31
  s_add_u32 s30, s32, 245760
  s_add_u32 s31, s31, 1024
  buffer_load_dwordx4 v52, s[20:23], s30 offen lds
  s_mov_b32 m0, s31
  s_add_u32 s30, s32, 393216
  s_add_u32 s31, s31, 1024
  buffer_load_dwordx4 v52, s[20:23], s30 offen lds
  s_mov_b32 m0, s31
  s_add_u32 s30, s32, 589824
  s_add_u32 s31, s31, 1024
  buffer_load_dwordx4 v52, s[20:23], s30 offen lds
  s_mov_b32 m0, s31
  s_add_u32 s30, s32, 442368
  s_add_u32 s31, s31, 1024
  buffer_load_dwordx4 v52, s[20:23], s30 offen lds
  s_mov_b32 m0, s31
  s_add_u32 s30, s32, 638976
  s_add_u32 s31, s31, 1024
  buffer_load_dwordx4 v52, s[20:23], s30 offen lds
  s_mov_b32 m0, s31
  s_add_u32 s30, s32, 786432
  s_add_u32 s31, s31, 1024
  buffer_load_dwordx4 v52, s[20:23], s30 offen lds
  s_mov_b32 m0, s31
  s_add_u32 s30, s32, 983040
  s_add_u32 s31, s31, 1024
  buffer_load_dwordx4 v52, s[20:23], s30 offen lds
  s_mov_b32 m0, s31
  s_add_u32 s30, s32, 835584
  s_add_u32 s31, s31, 1024
  buffer_load_dwordx4 v52, s[20:23], s30 offen lds
  s_mov_b32 m0, s31
  s_add_u32 s30, s32, 1032192
  s_add_u32 s31, s31, 1024
  buffer_load_dwordx4 v52, s[20:23], s30 offen lds
  s_mov_b32 m0, s31
  s_add_u32 s30, s32, 1179648
  s_add_u32 s31, s31, 1024
  buffer_load_dwordx4 v52, s[20:23], s30 offen lds
  s_mov_b32 m0, s31
  s_add_u32 s30, s32, 1376256
  s_add_u32 s31, s31, 1024
  buffer_load_dwordx4 v52, s[20:23], s30 offen lds
  s_mov_b32 m0, s31
  s_add_u32 s30, s32, 1228800
  s_add_u32 s31, s31, 1024
  buffer_load_dwordx4 v52, s[20:23], s30 offen lds
  s_mov_b32 m0, s31
  s_add_u32 s30, s32, 1425408
  s_add_u32 s31, s31, 1024
  buffer_load_dwordx4 v52, s[20:23], s30 offen lds
  s_mov_b32 m0, s31
  s_add_u32 s30, s32, 1572864
  s_add_u32 s31, s31, 1024
  buffer_load_dwordx4 v52, s[20:23], s30 offen lds
  s_mov_b32 m0, s31
  s_add_u32 s30, s32, 1769472
  s_add_u32 s31, s31, 1024
  buffer_load_dwordx4 v52, s[20:23], s30 offen lds
  s_mov_b32 m0, s31
  s_add_u32 s30, s32, 1622016
  s_add_u32 s31, s31, 1024
  buffer_load_dwordx4 v52, s[20:23], s30 offen lds
  s_mov_b32 m0, s31
  s_add_u32 s30, s32, 1818624
  s_add_u32 s31, s31, 1024
  buffer_load_dwordx4 v52, s[20:23], s30 offen lds
  s_mov_b32 m0, s31
  s_add_u32 s30, s32, 1966080
  s_add_u32 s31, s31, 1024
  buffer_load_dwordx4 v52, s[20:23], s30 offen lds
  s_mov_b32 m0, s31
  s_add_u32 s30, s32, 2162688
  s_add_u32 s31, s31, 1024
  buffer_load_dwordx4 v52, s[20:23], s30 offen lds
  s_mov_b32 m0, s31
  s_add_u32 s30, s32, 2015232
  s_add_u32 s31, s31, 1024
  buffer_load_dwordx4 v52, s[20:23], s30 offen lds
  s_mov_b32 m0, s31
  s_add_u32 s30, s32, 2211840
  s_add_u32 s31, s31, 1024
  buffer_load_dwordx4 v52, s[20:23], s30 offen lds
  s_mov_b32 m0, s31
  s_add_u32 s30, s32, 2359296
  s_add_u32 s31, s31, 1024
  buffer_load_dwordx4 v52, s[20:23], s30 offen lds
  s_mov_b32 m0, s31
  s_add_u32 s30, s32, 2555904
  s_add_u32 s31, s31, 1024
  buffer_load_dwordx4 v52, s[20:23], s30 offen lds
  s_mov_b32 m0, s31
  s_add_u32 s30, s32, 2408448
  s_add_u32 s31, s31, 1024
  buffer_load_dwordx4 v52, s[20:23], s30 offen lds
  s_mov_b32 m0, s31
  s_add_u32 s30, s32, 2605056
  s_add_u32 s31, s31, 1024
  buffer_load_dwordx4 v52, s[20:23], s30 offen lds
  s_mov_b32 m0, s31
  s_add_u32 s30, s32, 2752512
  s_add_u32 s31, s31, 1024
  buffer_load_dwordx4 v52, s[20:23], s30 offen lds
  s_mov_b32 m0, s31
  s_add_u32 s30, s32, 2949120
  s_add_u32 s31, s31, 1024
  buffer_load_dwordx4 v52, s[20:23], s30 offen lds
  s_mov_b32 m0, s31
  s_add_u32 s30, s32, 2801664
  s_add_u32 s31, s31, 1024
  buffer_load_dwordx4 v52, s[20:23], s30 offen lds
  s_mov_b32 m0, s31
  s_add_u32 s30, s32, 2998272
  s_add_u32 s31, s31, 1024
  buffer_load_dwordx4 v52, s[20:23], s30 offen lds
  s_mov_b32 m0, s31
  s_add_u32 s30, s32, 3145728
  s_add_u32 s31, s31, 1024
  buffer_load_dwordx4 v52, s[20:23], s30 offen lds
  s_mov_b32 m0, s31
  s_add_u32 s30, s32, 3342336
  s_add_u32 s31, s31, 1024
  buffer_load_dwordx4 v52, s[20:23], s30 offen lds
  s_mov_b32 m0, s31
  s_add_u32 s30, s32, 3194880
  s_add_u32 s31, s31, 1024
  buffer_load_dwordx4 v52, s[20:23], s30 offen lds
  s_mov_b32 m0, s31
  s_add_u32 s30, s32, 3391488
  s_add_u32 s31, s31, 1024
  buffer_load_dwordx4 v52, s[20:23], s30 offen lds
  s_mov_b32 m0, s31
  s_add_u32 s30, s32, 3538944
  s_add_u32 s31, s31, 1024
  buffer_load_dwordx4 v52, s[20:23], s30 offen lds
  s_mov_b32 m0, s31
  s_add_u32 s30, s32, 3735552
  s_add_u32 s31, s31, 1024
  buffer_load_dwordx4 v52, s[20:23], s30 offen lds
  s_mov_b32 m0, s31
  s_add_u32 s30, s32, 3588096
  s_add_u32 s31, s31, 1024
  buffer_load_dwordx4 v52, s[20:23], s30 offen lds
  s_mov_b32 m0, s31
  s_add_u32 s30, s32, 3784704
  s_add_u32 s31, s31, 1024
  buffer_load_dwordx4 v52, s[20:23], s30 offen lds
  s_waitcnt vmcnt(36)
  ds_read_b64_tr_b16 v[192:193], v110 offset:0
  ds_read_b64_tr_b16 v[194:195], v110 offset:2048
  ds_read_b64_tr_b16 a[16:17], v111 offset:0
  ds_read_b64_tr_b16 a[18:19], v111 offset:2048
  ds_read_b64_tr_b16 a[96:97], v112 offset:0
  ds_read_b64_tr_b16 a[98:99], v112 offset:2048
  ds_read_b64_tr_b16 a[176:177], v113 offset:0
  ds_read_b64_tr_b16 a[178:179], v113 offset:2048
  s_waitcnt vmcnt(32)
  ds_read_b64_tr_b16 v[196:197], v110 offset:4096
  ds_read_b64_tr_b16 v[198:199], v110 offset:6144
  ds_read_b64_tr_b16 a[20:21], v111 offset:4096
  ds_read_b64_tr_b16 a[22:23], v111 offset:6144
  ds_read_b64_tr_b16 a[100:101], v112 offset:4096
  ds_read_b64_tr_b16 a[102:103], v112 offset:6144
  ds_read_b64_tr_b16 a[180:181], v113 offset:4096
  ds_read_b64_tr_b16 a[182:183], v113 offset:6144
  s_waitcnt lgkmcnt(0)
  s_waitcnt vmcnt(28)
  ds_read_b64_tr_b16 v[200:201], v110 offset:8192
  ds_read_b64_tr_b16 v[202:203], v110 offset:10240
  ds_read_b64_tr_b16 a[24:25], v111 offset:8192
  ds_read_b64_tr_b16 a[26:27], v111 offset:10240
  ds_read_b64_tr_b16 a[104:105], v112 offset:8192
  ds_read_b64_tr_b16 a[106:107], v112 offset:10240
  ds_read_b64_tr_b16 a[184:185], v113 offset:8192
  ds_read_b64_tr_b16 a[186:187], v113 offset:10240
  s_waitcnt vmcnt(24)
  ds_read_b64_tr_b16 v[204:205], v110 offset:12288
  ds_read_b64_tr_b16 v[206:207], v110 offset:14336
  ds_read_b64_tr_b16 a[28:29], v111 offset:12288
  ds_read_b64_tr_b16 a[30:31], v111 offset:14336
  ds_read_b64_tr_b16 a[108:109], v112 offset:12288
  ds_read_b64_tr_b16 a[110:111], v112 offset:14336
  ds_read_b64_tr_b16 a[188:189], v113 offset:12288
  ds_read_b64_tr_b16 a[190:191], v113 offset:14336
  s_waitcnt lgkmcnt(0)
  s_waitcnt vmcnt(20)
  ds_read_b64_tr_b16 v[208:209], v110 offset:16384
  ds_read_b64_tr_b16 v[210:211], v110 offset:18432
  ds_read_b64_tr_b16 a[32:33], v111 offset:16384
  ds_read_b64_tr_b16 a[34:35], v111 offset:18432
  ds_read_b64_tr_b16 a[112:113], v112 offset:16384
  ds_read_b64_tr_b16 a[114:115], v112 offset:18432
  ds_read_b64_tr_b16 a[192:193], v113 offset:16384
  ds_read_b64_tr_b16 a[194:195], v113 offset:18432
  s_waitcnt vmcnt(16)
  ds_read_b64_tr_b16 v[212:213], v110 offset:20480
  ds_read_b64_tr_b16 v[214:215], v110 offset:22528
  ds_read_b64_tr_b16 a[36:37], v111 offset:20480
  ds_read_b64_tr_b16 a[38:39], v111 offset:22528
  ds_read_b64_tr_b16 a[116:117], v112 offset:20480
  ds_read_b64_tr_b16 a[118:119], v112 offset:22528
  ds_read_b64_tr_b16 a[196:197], v113 offset:20480
  ds_read_b64_tr_b16 a[198:199], v113 offset:22528
  s_waitcnt lgkmcnt(0)
  s_waitcnt vmcnt(12)
  ds_read_b64_tr_b16 v[216:217], v110 offset:24576
  ds_read_b64_tr_b16 v[218:219], v110 offset:26624
  ds_read_b64_tr_b16 a[40:41], v111 offset:24576
  ds_read_b64_tr_b16 a[42:43], v111 offset:26624
  ds_read_b64_tr_b16 a[120:121], v112 offset:24576
  ds_read_b64_tr_b16 a[122:123], v112 offset:26624
  ds_read_b64_tr_b16 a[200:201], v113 offset:24576
  ds_read_b64_tr_b16 a[202:203], v113 offset:26624
  s_waitcnt vmcnt(8)
  ds_read_b64_tr_b16 v[220:221], v110 offset:28672
  ds_read_b64_tr_b16 v[222:223], v110 offset:30720
  ds_read_b64_tr_b16 a[44:45], v111 offset:28672
  ds_read_b64_tr_b16 a[46:47], v111 offset:30720
  ds_read_b64_tr_b16 a[124:125], v112 offset:28672
  ds_read_b64_tr_b16 a[126:127], v112 offset:30720
  ds_read_b64_tr_b16 a[204:205], v113 offset:28672
  ds_read_b64_tr_b16 a[206:207], v113 offset:30720
  s_waitcnt lgkmcnt(0)
  s_waitcnt vmcnt(4)
  ds_read_b64_tr_b16 v[224:225], v110 offset:32768
  ds_read_b64_tr_b16 v[226:227], v110 offset:34816
  ds_read_b64_tr_b16 a[48:49], v111 offset:32768
  ds_read_b64_tr_b16 a[50:51], v111 offset:34816
  ds_read_b64_tr_b16 a[128:129], v112 offset:32768
  ds_read_b64_tr_b16 a[130:131], v112 offset:34816
  ds_read_b64_tr_b16 a[208:209], v113 offset:32768
  ds_read_b64_tr_b16 a[210:211], v113 offset:34816
  s_waitcnt vmcnt(0)
  ds_read_b64_tr_b16 v[228:229], v110 offset:36864
  ds_read_b64_tr_b16 v[230:231], v110 offset:38912
  ds_read_b64_tr_b16 a[52:53], v111 offset:36864
  ds_read_b64_tr_b16 a[54:55], v111 offset:38912
  ds_read_b64_tr_b16 a[132:133], v112 offset:36864
  ds_read_b64_tr_b16 a[134:135], v112 offset:38912
  ds_read_b64_tr_b16 a[212:213], v113 offset:36864
  ds_read_b64_tr_b16 a[214:215], v113 offset:38912
  s_waitcnt lgkmcnt(0)
  s_mov_b32 s31, s33
  s_mov_b32 m0, s31
  s_add_u32 s30, s32, 3932160
  s_add_u32 s31, s31, 1024
  buffer_load_dwordx4 v52, s[20:23], s30 offen lds
  s_mov_b32 m0, s31
  s_add_u32 s30, s32, 4128768
  s_add_u32 s31, s31, 1024
  buffer_load_dwordx4 v52, s[20:23], s30 offen lds
  s_mov_b32 m0, s31
  s_add_u32 s30, s32, 3981312
  s_add_u32 s31, s31, 1024
  buffer_load_dwordx4 v52, s[20:23], s30 offen lds
  s_mov_b32 m0, s31
  s_add_u32 s30, s32, 4177920
  s_add_u32 s31, s31, 1024
  buffer_load_dwordx4 v52, s[20:23], s30 offen lds
  s_mov_b32 m0, s31
  s_add_u32 s30, s32, 4325376
  s_add_u32 s31, s31, 1024
  buffer_load_dwordx4 v52, s[20:23], s30 offen lds
  s_mov_b32 m0, s31
  s_add_u32 s30, s32, 4521984
  s_add_u32 s31, s31, 1024
  buffer_load_dwordx4 v52, s[20:23], s30 offen lds
  s_mov_b32 m0, s31
  s_add_u32 s30, s32, 4374528
  s_add_u32 s31, s31, 1024
  buffer_load_dwordx4 v52, s[20:23], s30 offen lds
  s_mov_b32 m0, s31
  s_add_u32 s30, s32, 4571136
  s_add_u32 s31, s31, 1024
  buffer_load_dwordx4 v52, s[20:23], s30 offen lds
  s_mov_b32 m0, s31
  s_add_u32 s30, s32, 4718592
  s_add_u32 s31, s31, 1024
  buffer_load_dwordx4 v52, s[20:23], s30 offen lds
  s_mov_b32 m0, s31
  s_add_u32 s30, s32, 4915200
  s_add_u32 s31, s31, 1024
  buffer_load_dwordx4 v52, s[20:23], s30 offen lds
  s_mov_b32 m0, s31
  s_add_u32 s30, s32, 4767744
  s_add_u32 s31, s31, 1024
  buffer_load_dwordx4 v52, s[20:23], s30 offen lds
  s_mov_b32 m0, s31
  s_add_u32 s30, s32, 4964352
  s_add_u32 s31, s31, 1024
  buffer_load_dwordx4 v52, s[20:23], s30 offen lds
  s_mov_b32 m0, s31
  s_add_u32 s30, s32, 5111808
  s_add_u32 s31, s31, 1024
  buffer_load_dwordx4 v52, s[20:23], s30 offen lds
  s_mov_b32 m0, s31
  s_add_u32 s30, s32, 5308416
  s_add_u32 s31, s31, 1024
  buffer_load_dwordx4 v52, s[20:23], s30 offen lds
  s_mov_b32 m0, s31
  s_add_u32 s30, s32, 5160960
  s_add_u32 s31, s31, 1024
  buffer_load_dwordx4 v52, s[20:23], s30 offen lds
  s_mov_b32 m0, s31
  s_add_u32 s30, s32, 5357568
  s_add_u32 s31, s31, 1024
  buffer_load_dwordx4 v52, s[20:23], s30 offen lds
  s_mov_b32 m0, s31
  s_add_u32 s30, s32, 5505024
  s_add_u32 s31, s31, 1024
  buffer_load_dwordx4 v52, s[20:23], s30 offen lds
  s_mov_b32 m0, s31
  s_add_u32 s30, s32, 5701632
  s_add_u32 s31, s31, 1024
  buffer_load_dwordx4 v52, s[20:23], s30 offen lds
  s_mov_b32 m0, s31
  s_add_u32 s30, s32, 5554176
  s_add_u32 s31, s31, 1024
  buffer_load_dwordx4 v52, s[20:23], s30 offen lds
  s_mov_b32 m0, s31
  s_add_u32 s30, s32, 5750784
  s_add_u32 s31, s31, 1024
  buffer_load_dwordx4 v52, s[20:23], s30 offen lds
  s_mov_b32 m0, s31
  s_add_u32 s30, s32, 5898240
  s_add_u32 s31, s31, 1024
  buffer_load_dwordx4 v52, s[20:23], s30 offen lds
  s_mov_b32 m0, s31
  s_add_u32 s30, s32, 6094848
  s_add_u32 s31, s31, 1024
  buffer_load_dwordx4 v52, s[20:23], s30 offen lds
  s_mov_b32 m0, s31
  s_add_u32 s30, s32, 5947392
  s_add_u32 s31, s31, 1024
  buffer_load_dwordx4 v52, s[20:23], s30 offen lds
  s_mov_b32 m0, s31
  s_add_u32 s30, s32, 6144000
  s_add_u32 s31, s31, 1024
  buffer_load_dwordx4 v52, s[20:23], s30 offen lds
  s_mov_b32 m0, s31
  s_add_u32 s30, s32, 6291456
  s_add_u32 s31, s31, 1024
  buffer_load_dwordx4 v52, s[20:23], s30 offen lds
  s_mov_b32 m0, s31
  s_add_u32 s30, s32, 6488064
  s_add_u32 s31, s31, 1024
  buffer_load_dwordx4 v52, s[20:23], s30 offen lds
  s_mov_b32 m0, s31
  s_add_u32 s30, s32, 6340608
  s_add_u32 s31, s31, 1024
  buffer_load_dwordx4 v52, s[20:23], s30 offen lds
  s_mov_b32 m0, s31
  s_add_u32 s30, s32, 6537216
  s_add_u32 s31, s31, 1024
  buffer_load_dwordx4 v52, s[20:23], s30 offen lds
  s_mov_b32 m0, s31
  s_add_u32 s30, s32, 6684672
  s_add_u32 s31, s31, 1024
  buffer_load_dwordx4 v52, s[20:23], s30 offen lds
  s_mov_b32 m0, s31
  s_add_u32 s30, s32, 6881280
  s_add_u32 s31, s31, 1024
  buffer_load_dwordx4 v52, s[20:23], s30 offen lds
  s_mov_b32 m0, s31
  s_add_u32 s30, s32, 6733824
  s_add_u32 s31, s31, 1024
  buffer_load_dwordx4 v52, s[20:23], s30 offen lds
  s_mov_b32 m0, s31
  s_add_u32 s30, s32, 6930432
  s_add_u32 s31, s31, 1024
  buffer_load_dwordx4 v52, s[20:23], s30 offen lds
  s_mov_b32 m0, s31
  s_add_u32 s30, s32, 7077888
  s_add_u32 s31, s31, 1024
  buffer_load_dwordx4 v52, s[20:23], s30 offen lds
  s_mov_b32 m0, s31
  s_add_u32 s30, s32, 7274496
  s_add_u32 s31, s31, 1024
  buffer_load_dwordx4 v52, s[20:23], s30 offen lds
  s_mov_b32 m0, s31
  s_add_u32 s30, s32, 7127040
  s_add_u32 s31, s31, 1024
  buffer_load_dwordx4 v52, s[20:23], s30 offen lds
  s_mov_b32 m0, s31
  s_add_u32 s30, s32, 7323648
  s_add_u32 s31, s31, 1024
  buffer_load_dwordx4 v52, s[20:23], s30 offen lds
  s_mov_b32 m0, s31
  s_add_u32 s30, s32, 7471104
  s_add_u32 s31, s31, 1024
  buffer_load_dwordx4 v52, s[20:23], s30 offen lds
  s_mov_b32 m0, s31
  s_add_u32 s30, s32, 7667712
  s_add_u32 s31, s31, 1024
  buffer_load_dwordx4 v52, s[20:23], s30 offen lds
  s_mov_b32 m0, s31
  s_add_u32 s30, s32, 7520256
  s_add_u32 s31, s31, 1024
  buffer_load_dwordx4 v52, s[20:23], s30 offen lds
  s_mov_b32 m0, s31
  s_add_u32 s30, s32, 7716864
  s_add_u32 s31, s31, 1024
  buffer_load_dwordx4 v52, s[20:23], s30 offen lds
  s_waitcnt vmcnt(36)
  ds_read_b64_tr_b16 v[232:233], v110 offset:0
  ds_read_b64_tr_b16 v[234:235], v110 offset:2048
  ds_read_b64_tr_b16 a[56:57], v111 offset:0
  ds_read_b64_tr_b16 a[58:59], v111 offset:2048
  ds_read_b64_tr_b16 a[136:137], v112 offset:0
  ds_read_b64_tr_b16 a[138:139], v112 offset:2048
  ds_read_b64_tr_b16 a[216:217], v113 offset:0
  ds_read_b64_tr_b16 a[218:219], v113 offset:2048
  s_waitcnt vmcnt(32)
  ds_read_b64_tr_b16 v[236:237], v110 offset:4096
  ds_read_b64_tr_b16 v[238:239], v110 offset:6144
  ds_read_b64_tr_b16 a[60:61], v111 offset:4096
  ds_read_b64_tr_b16 a[62:63], v111 offset:6144
  ds_read_b64_tr_b16 a[140:141], v112 offset:4096
  ds_read_b64_tr_b16 a[142:143], v112 offset:6144
  ds_read_b64_tr_b16 a[220:221], v113 offset:4096
  ds_read_b64_tr_b16 a[222:223], v113 offset:6144
  s_waitcnt lgkmcnt(0)
  s_waitcnt vmcnt(28)
  ds_read_b64_tr_b16 v[240:241], v110 offset:8192
  ds_read_b64_tr_b16 v[242:243], v110 offset:10240
  ds_read_b64_tr_b16 a[64:65], v111 offset:8192
  ds_read_b64_tr_b16 a[66:67], v111 offset:10240
  ds_read_b64_tr_b16 a[144:145], v112 offset:8192
  ds_read_b64_tr_b16 a[146:147], v112 offset:10240
  ds_read_b64_tr_b16 a[224:225], v113 offset:8192
  ds_read_b64_tr_b16 a[226:227], v113 offset:10240
  s_waitcnt vmcnt(24)
  ds_read_b64_tr_b16 v[244:245], v110 offset:12288
  ds_read_b64_tr_b16 v[246:247], v110 offset:14336
  ds_read_b64_tr_b16 a[68:69], v111 offset:12288
  ds_read_b64_tr_b16 a[70:71], v111 offset:14336
  ds_read_b64_tr_b16 a[148:149], v112 offset:12288
  ds_read_b64_tr_b16 a[150:151], v112 offset:14336
  ds_read_b64_tr_b16 a[228:229], v113 offset:12288
  ds_read_b64_tr_b16 a[230:231], v113 offset:14336
  s_waitcnt lgkmcnt(0)
  s_waitcnt vmcnt(20)
  ds_read_b64_tr_b16 v[248:249], v110 offset:16384
  ds_read_b64_tr_b16 v[250:251], v110 offset:18432
  ds_read_b64_tr_b16 a[72:73], v111 offset:16384
  ds_read_b64_tr_b16 a[74:75], v111 offset:18432
  ds_read_b64_tr_b16 a[152:153], v112 offset:16384
  ds_read_b64_tr_b16 a[154:155], v112 offset:18432
  ds_read_b64_tr_b16 a[232:233], v113 offset:16384
  ds_read_b64_tr_b16 a[234:235], v113 offset:18432
  s_waitcnt vmcnt(16)
  ds_read_b64_tr_b16 v[252:253], v110 offset:20480
  ds_read_b64_tr_b16 v[254:255], v110 offset:22528
  ds_read_b64_tr_b16 a[76:77], v111 offset:20480
  ds_read_b64_tr_b16 a[78:79], v111 offset:22528
  ds_read_b64_tr_b16 a[156:157], v112 offset:20480
  ds_read_b64_tr_b16 a[158:159], v112 offset:22528
  ds_read_b64_tr_b16 a[236:237], v113 offset:20480
  ds_read_b64_tr_b16 a[238:239], v113 offset:22528
  s_waitcnt lgkmcnt(0)
  s_waitcnt vmcnt(12)
  ds_read_b64_tr_b16 a[0:1], v110 offset:24576
  ds_read_b64_tr_b16 a[2:3], v110 offset:26624
  ds_read_b64_tr_b16 a[80:81], v111 offset:24576
  ds_read_b64_tr_b16 a[82:83], v111 offset:26624
  ds_read_b64_tr_b16 a[160:161], v112 offset:24576
  ds_read_b64_tr_b16 a[162:163], v112 offset:26624
  ds_read_b64_tr_b16 a[240:241], v113 offset:24576
  ds_read_b64_tr_b16 a[242:243], v113 offset:26624
  s_waitcnt vmcnt(8)
  ds_read_b64_tr_b16 a[4:5], v110 offset:28672
  ds_read_b64_tr_b16 a[6:7], v110 offset:30720
  ds_read_b64_tr_b16 a[84:85], v111 offset:28672
  ds_read_b64_tr_b16 a[86:87], v111 offset:30720
  ds_read_b64_tr_b16 a[164:165], v112 offset:28672
  ds_read_b64_tr_b16 a[166:167], v112 offset:30720
  ds_read_b64_tr_b16 a[244:245], v113 offset:28672
  ds_read_b64_tr_b16 a[246:247], v113 offset:30720
  s_waitcnt lgkmcnt(0)
  s_waitcnt vmcnt(4)
  ds_read_b64_tr_b16 a[8:9], v110 offset:32768
  ds_read_b64_tr_b16 a[10:11], v110 offset:34816
  ds_read_b64_tr_b16 a[88:89], v111 offset:32768
  ds_read_b64_tr_b16 a[90:91], v111 offset:34816
  ds_read_b64_tr_b16 a[168:169], v112 offset:32768
  ds_read_b64_tr_b16 a[170:171], v112 offset:34816
  ds_read_b64_tr_b16 a[248:249], v113 offset:32768
  ds_read_b64_tr_b16 a[250:251], v113 offset:34816
  s_waitcnt vmcnt(0)
  ds_read_b64_tr_b16 a[12:13], v110 offset:36864
  ds_read_b64_tr_b16 a[14:15], v110 offset:38912
  ds_read_b64_tr_b16 a[92:93], v111 offset:36864
  ds_read_b64_tr_b16 a[94:95], v111 offset:38912
  ds_read_b64_tr_b16 a[172:173], v112 offset:36864
  ds_read_b64_tr_b16 a[174:175], v112 offset:38912
  ds_read_b64_tr_b16 a[252:253], v113 offset:36864
  ds_read_b64_tr_b16 a[254:255], v113 offset:38912
  s_waitcnt lgkmcnt(0)
  v_lshlrev_b32 v100, 4, v1
  s_mul_i32 s37, s17, 10240
  v_mov_b32 v103, v100
  s_mul_i32 s34, s16, 2621440
  s_add_u32 s34, s34, 247463936
  s_add_u32 s34, s34, s37
  s_lshl_b32 s30, s16, 8
  v_lshl_add_u32 v105, v1, 2, s30
  v_add_u32 v105, 12288, v105
  v_add_u32 v107, 4032, v105
  v_cmp_gt_u32 vcc, 16, v1
  s_nop 1
  v_cndmask_b32 v105, v107, v105, vcc
  v_cndmask_b32 v102, 1, 2, vcc
  v_cndmask_b32 v101, -8, 2, vcc
  s_lshl_b32 s31, s24, 2
  s_add_u32 s30, s30, s31
  s_add_u32 s30, s30, 0
  v_mov_b32 v104, s30
  s_mov_b32 s28, 0
  s_mov_b32 s36, 2
  s_barrier
  s_mov_b32 s29, 0
pw_1:
  buffer_load_dword v106, v105, s[8:11], 0 offen sc1
  s_add_u32 s29, s29, 1
  s_cmp_gt_u32 s29, 65536
  s_cbranch_scc1 role_abort
  s_waitcnt vmcnt(0)
pc_3:
  v_cmp_gt_u32 vcc, s36, v106
  s_nop 0
  s_and_b32 vcc_lo, vcc_lo, 0xffff
  s_and_b32 vcc_hi, vcc_hi, 0x0
  s_cmp_eq_u64 vcc, 0
  s_cbranch_scc1 po_2
  s_sleep 2
  s_branch pw_1
po_2:
  s_add_u32 m0, s37, 0
  s_add_u32 s30, s34, 0
  buffer_load_dwordx4 v100, s[8:11], s30 offen offset:0 sc1 lds
  buffer_load_dwordx4 v100, s[8:11], s30 offen offset:1024 sc1 lds
  buffer_load_dwordx4 v100, s[8:11], s30 offen offset:2048 sc1 lds
  buffer_load_dwordx4 v100, s[8:11], s30 offen offset:3072 sc1 lds
  s_add_u32 m0, s37, 4096
  s_add_u32 s30, s34, 4096
  buffer_load_dwordx4 v100, s[8:11], s30 offen offset:0 sc1 lds
  buffer_load_dwordx4 v100, s[8:11], s30 offen offset:1024 sc1 lds
  buffer_load_dwordx4 v100, s[8:11], s30 offen offset:2048 sc1 lds
  buffer_load_dwordx4 v100, s[8:11], s30 offen offset:3072 sc1 lds
  s_add_u32 m0, s37, 8192
  s_add_u32 s30, s34, 8192
  buffer_load_dwordx4 v100, s[8:11], s30 offen offset:0 sc1 lds
  buffer_load_dwordx4 v100, s[8:11], s30 offen offset:1024 sc1 lds
  s_xor_b32 s37, s37, 0x10000
  s_waitcnt vmcnt(0)
  s_barrier
p_loop:
  s_waitcnt lgkmcnt(0)
  v_add_u32 v101, v101, v102
  v_min_i32 v101, 128, v101
  ds_read_b128 v[36:39], v103 offset:0
  ds_read_b128 v[40:43], v103 offset:1024
  ds_read_b128 v[44:47], v103 offset:2048
  s_mov_b32 s29, 0
  s_branch pc_6
pw_4:
  buffer_load_dword v106, v105, s[8:11], 0 offen sc1
  s_add_u32 s29, s29, 1
  s_cmp_gt_u32 s29, 65536
  s_cbranch_scc1 role_abort
  s_waitcnt vmcnt(0)
pc_6:
  v_cmp_gt_i32 vcc, v101, v106
  s_nop 0
  s_and_b32 vcc_lo, vcc_lo, 0xffffff
  s_and_b32 vcc_hi, vcc_hi, 0x0
  s_cmp_eq_u64 vcc, 0
  s_cbranch_scc1 po_5
  s_sleep 8
  s_branch pw_4
po_5:
  s_cmp_lt_u32 s28, 63
  s_cselect_b32 s30, 40960, 0
  s_add_u32 s34, s34, s30
  s_add_u32 s32, s35, 6144
  s_and_b32 s30, s28, 7
  s_mul_i32 s30, s30, 147456
  s_add_u32 s35, s38, s30
  v_mov_b32 v109, s28
  s_waitcnt lgkmcnt(2)
  v_mfma_f32_16x16x32_bf16 v[4:7], v[192:195], v[36:39], 0
  ds_read_b128 v[48:51], v103 offset:3072
  v_mfma_f32_16x16x32_bf16 v[8:11], a[16:19], v[36:39], 0
  v_mfma_f32_16x16x32_bf16 v[12:15], a[96:99], v[36:39], 0
  v_mfma_f32_16x16x32_bf16 v[16:19], a[176:179], v[36:39], 0
  s_waitcnt lgkmcnt(2)
  v_mfma_f32_16x16x32_bf16 v[4:7], v[196:199], v[40:43], v[4:7]
  ds_read_b128 v[36:39], v103 offset:4096
  v_mfma_f32_16x16x32_bf16 v[8:11], a[20:23], v[40:43], v[8:11]
  v_cvt_pk_bf16_f32 v92, v20, v21
  v_mfma_f32_16x16x32_bf16 v[12:15], a[100:103], v[40:43], v[12:15]
  v_cvt_pk_bf16_f32 v93, v22, v23
  v_mfma_f32_16x16x32_bf16 v[16:19], a[180:183], v[40:43], v[16:19]
  s_waitcnt lgkmcnt(2)
  v_mfma_f32_16x16x32_bf16 v[4:7], v[200:203], v[44:47], v[4:7]
  ds_read_b128 v[40:43], v103 offset:5120
  v_mfma_f32_16x16x32_bf16 v[8:11], a[24:27], v[44:47], v[8:11]
  v_cvt_pk_bf16_f32 v94, v24, v25
  v_mfma_f32_16x16x32_bf16 v[12:15], a[104:107], v[44:47], v[12:15]
  v_cvt_pk_bf16_f32 v95, v26, v27
  v_mfma_f32_16x16x32_bf16 v[16:19], a[184:187], v[44:47], v[16:19]
  s_waitcnt lgkmcnt(2)
  v_mfma_f32_16x16x32_bf16 v[4:7], v[204:207], v[48:51], v[4:7]
  ds_read_b128 v[44:47], v103 offset:6144
  v_mfma_f32_16x16x32_bf16 v[8:11], a[28:31], v[48:51], v[8:11]
  buffer_store_dwordx4 v[92:95], v100, s[8:11], s32 offen offset:0
  v_mfma_f32_16x16x32_bf16 v[12:15], a[108:111], v[48:51], v[12:15]
  v_cvt_pk_bf16_f32 v96, v28, v29
  v_mfma_f32_16x16x32_bf16 v[16:19], a[188:191], v[48:51], v[16:19]
  s_waitcnt lgkmcnt(2)
  v_mfma_f32_16x16x32_bf16 v[4:7], v[208:211], v[36:39], v[4:7]
  ds_read_b128 v[48:51], v103 offset:7168
  v_mfma_f32_16x16x32_bf16 v[8:11], a[32:35], v[36:39], v[8:11]
  v_cvt_pk_bf16_f32 v97, v30, v31
  v_mfma_f32_16x16x32_bf16 v[12:15], a[112:115], v[36:39], v[12:15]
  v_cvt_pk_bf16_f32 v98, v32, v33
  v_mfma_f32_16x16x32_bf16 v[16:19], a[192:195], v[36:39], v[16:19]
  s_waitcnt lgkmcnt(2)
  v_mfma_f32_16x16x32_bf16 v[4:7], v[212:215], v[40:43], v[4:7]
  ds_read_b128 v[36:39], v103 offset:8192
  v_mfma_f32_16x16x32_bf16 v[8:11], a[36:39], v[40:43], v[8:11]
  v_cvt_pk_bf16_f32 v99, v34, v35
  v_mfma_f32_16x16x32_bf16 v[12:15], a[116:119], v[40:43], v[12:15]
  buffer_store_dwordx4 v[96:99], v100, s[8:11], s32 offen offset:1024
  v_mfma_f32_16x16x32_bf16 v[16:19], a[196:199], v[40:43], v[16:19]
  s_waitcnt lgkmcnt(2)
  v_mfma_f32_16x16x32_bf16 v[4:7], v[216:219], v[44:47], v[4:7]
  ds_read_b128 v[40:43], v103 offset:9216
  v_mfma_f32_16x16x32_bf16 v[8:11], a[40:43], v[44:47], v[8:11]
  s_add_u32 m0, s37, 0
  s_add_u32 s30, s34, 0
  buffer_load_dwordx4 v100, s[8:11], s30 offen offset:0 sc1 lds
  v_mfma_f32_16x16x32_bf16 v[12:15], a[120:123], v[44:47], v[12:15]
  v_mfma_f32_16x16x32_bf16 v[16:19], a[200:203], v[44:47], v[16:19]
  s_waitcnt lgkmcnt(2)
  v_mfma_f32_16x16x32_bf16 v[4:7], v[220:223], v[48:51], v[4:7]
  ds_read_b128 v[44:47], v103 offset:10240
  v_mfma_f32_16x16x32_bf16 v[8:11], a[44:47], v[48:51], v[8:11]
  buffer_load_dwordx4 v100, s[8:11], s30 offen offset:1024 sc1 lds
  v_mfma_f32_16x16x32_bf16 v[12:15], a[124:127], v[48:51], v[12:15]
  v_mfma_f32_16x16x32_bf16 v[16:19], a[204:207], v[48:51], v[16:19]
  s_waitcnt lgkmcnt(2)
  v_mfma_f32_16x16x32_bf16 v[4:7], v[224:227], v[36:39], v[4:7]
  ds_read_b128 v[48:51], v103 offset:11264
  v_mfma_f32_16x16x32_bf16 v[8:11], a[48:51], v[36:39], v[8:11]
  buffer_load_dwordx4 v100, s[8:11], s30 offen offset:2048 sc1 lds
  v_mfma_f32_16x16x32_bf16 v[12:15], a[128:131], v[36:39], v[12:15]
  v_mfma_f32_16x16x32_bf16 v[16:19], a[208:211], v[36:39], v[16:19]
  s_waitcnt lgkmcnt(2)
  v_mfma_f32_16x16x32_bf16 v[4:7], v[228:231], v[40:43], v[4:7]
  ds_read_b128 v[36:39], v103 offset:12288
  v_mfma_f32_16x16x32_bf16 v[8:11], a[52:55], v[40:43], v[8:11]
  buffer_load_dwordx4 v100, s[8:11], s30 offen offset:3072 sc1 lds
  v_mfma_f32_16x16x32_bf16 v[12:15], a[132:135], v[40:43], v[12:15]
  v_mfma_f32_16x16x32_bf16 v[16:19], a[212:215], v[40:43], v[16:19]
  s_waitcnt lgkmcnt(2)
  v_mfma_f32_16x16x32_bf16 v[4:7], v[232:235], v[44:47], v[4:7]
  ds_read_b128 v[40:43], v103 offset:13312
  v_mfma_f32_16x16x32_bf16 v[8:11], a[56:59], v[44:47], v[8:11]
  s_add_u32 m0, s37, 4096
  s_add_u32 s30, s34, 4096
  buffer_load_dwordx4 v100, s[8:11], s30 offen offset:0 sc1 lds
  v_mfma_f32_16x16x32_bf16 v[12:15], a[136:139], v[44:47], v[12:15]
  v_mfma_f32_16x16x32_bf16 v[16:19], a[216:219], v[44:47], v[16:19]
  s_waitcnt lgkmcnt(2)
  v_mfma_f32_16x16x32_bf16 v[4:7], v[236:239], v[48:51], v[4:7]
  ds_read_b128 v[44:47], v103 offset:14336
  v_mfma_f32_16x16x32_bf16 v[8:11], a[60:63], v[48:51], v[8:11]
  buffer_load_dwordx4 v100, s[8:11], s30 offen offset:1024 sc1 lds
  v_mfma_f32_16x16x32_bf16 v[12:15], a[140:143], v[48:51], v[12:15]
  v_mfma_f32_16x16x32_bf16 v[16:19], a[220:223], v[48:51], v[16:19]
  s_waitcnt lgkmcnt(2)
  v_mfma_f32_16x16x32_bf16 v[4:7], v[240:243], v[36:39], v[4:7]
  ds_read_b128 v[48:51], v103 offset:15360
  v_mfma_f32_16x16x32_bf16 v[8:11], a[64:67], v[36:39], v[8:11]
  buffer_load_dwordx4 v100, s[8:11], s30 offen offset:2048 sc1 lds
  v_mfma_f32_16x16x32_bf16 v[12:15], a[144:147], v[36:39], v[12:15]
  v_mfma_f32_16x16x32_bf16 v[16:19], a[224:227], v[36:39], v[16:19]
  s_waitcnt lgkmcnt(2)
  v_mfma_f32_16x16x32_bf16 v[4:7], v[244:247], v[40:43], v[4:7]
  ds_read_b128 v[36:39], v103 offset:16384
  v_mfma_f32_16x16x32_bf16 v[8:11], a[68:71], v[40:43], v[8:11]
  buffer_load_dwordx4 v100, s[8:11], s30 offen offset:3072 sc1 lds
  v_mfma_f32_16x16x32_bf16 v[12:15], a[148:151], v[40:43], v[12:15]
  v_mfma_f32_16x16x32_bf16 v[16:19], a[228:231], v[40:43], v[16:19]
  s_waitcnt lgkmcnt(2)
  v_mfma_f32_16x16x32_bf16 v[4:7], v[248:251], v[44:47], v[4:7]
  ds_read_b128 v[40:43], v103 offset:17408
  v_mfma_f32_16x16x32_bf16 v[8:11], a[72:75], v[44:47], v[8:11]
  s_add_u32 m0, s37, 8192
  s_add_u32 s30, s34, 8192
  buffer_load_dwordx4 v100, s[8:11], s30 offen offset:0 sc1 lds
  v_mfma_f32_16x16x32_bf16 v[12:15], a[152:155], v[44:47], v[12:15]
  v_mfma_f32_16x16x32_bf16 v[16:19], a[232:235], v[44:47], v[16:19]
  s_waitcnt lgkmcnt(2)
  v_mfma_f32_16x16x32_bf16 v[4:7], v[252:255], v[48:51], v[4:7]
  ds_read_b128 v[44:47], v103 offset:18432
  v_mfma_f32_16x16x32_bf16 v[8:11], a[76:79], v[48:51], v[8:11]
  buffer_load_dwordx4 v100, s[8:11], s30 offen offset:1024 sc1 lds
  v_mfma_f32_16x16x32_bf16 v[12:15], a[156:159], v[48:51], v[12:15]
  v_mfma_f32_16x16x32_bf16 v[16:19], a[236:239], v[48:51], v[16:19]
  s_waitcnt lgkmcnt(2)
  v_mfma_f32_16x16x32_bf16 v[4:7], a[0:3], v[36:39], v[4:7]
  ds_read_b128 v[48:51], v103 offset:19456
  v_mfma_f32_16x16x32_bf16 v[8:11], a[80:83], v[36:39], v[8:11]
  s_waitcnt vmcnt(10)
  v_mfma_f32_16x16x32_bf16 v[12:15], a[160:163], v[36:39], v[12:15]
  buffer_store_dword v109, v104, s[8:11], 0 offen
  v_mfma_f32_16x16x32_bf16 v[16:19], a[240:243], v[36:39], v[16:19]
  s_waitcnt lgkmcnt(2)
  v_mfma_f32_16x16x32_bf16 v[4:7], a[4:7], v[40:43], v[4:7]
  ds_read_b128 v[36:39], v103 offset:20480
  v_mfma_f32_16x16x32_bf16 v[8:11], a[84:87], v[40:43], v[8:11]
  buffer_load_dword v106, v105, s[8:11], 0 offen sc1
  v_mfma_f32_16x16x32_bf16 v[12:15], a[164:167], v[40:43], v[12:15]
  v_mfma_f32_16x16x32_bf16 v[16:19], a[244:247], v[40:43], v[16:19]
  s_waitcnt lgkmcnt(2)
  v_mfma_f32_16x16x32_bf16 v[4:7], a[8:11], v[44:47], v[4:7]
  ds_read_b128 v[40:43], v103 offset:21504
  v_mfma_f32_16x16x32_bf16 v[8:11], a[88:91], v[44:47], v[8:11]
  v_mfma_f32_16x16x32_bf16 v[12:15], a[168:171], v[44:47], v[12:15]
  v_mfma_f32_16x16x32_bf16 v[16:19], a[248:251], v[44:47], v[16:19]
  s_waitcnt lgkmcnt(2)
  v_mfma_f32_16x16x32_bf16 v[4:7], a[12:15], v[48:51], v[4:7]
  ds_read_b128 v[44:47], v103 offset:22528
  v_mfma_f32_16x16x32_bf16 v[8:11], a[92:95], v[48:51], v[8:11]
  v_mfma_f32_16x16x32_bf16 v[12:15], a[172:175], v[48:51], v[12:15]
  v_mfma_f32_16x16x32_bf16 v[16:19], a[252:255], v[48:51], v[16:19]
  s_waitcnt lgkmcnt(2)
  v_mfma_f32_16x16x32_bf16 v[20:23], v[192:195], v[36:39], 0
  ds_read_b128 v[48:51], v103 offset:23552
  v_mfma_f32_16x16x32_bf16 v[24:27], a[16:19], v[36:39], 0
  v_mfma_f32_16x16x32_bf16 v[28:31], a[96:99], v[36:39], 0
  v_mfma_f32_16x16x32_bf16 v[32:35], a[176:179], v[36:39], 0
  s_waitcnt lgkmcnt(2)
  v_mfma_f32_16x16x32_bf16 v[20:23], v[196:199], v[40:43], v[20:23]
  ds_read_b128 v[36:39], v103 offset:24576
  v_mfma_f32_16x16x32_bf16 v[24:27], a[20:23], v[40:43], v[24:27]
  v_cvt_pk_bf16_f32 v92, v4, v5
  v_mfma_f32_16x16x32_bf16 v[28:31], a[100:103], v[40:43], v[28:31]
  v_cvt_pk_bf16_f32 v93, v6, v7
  v_mfma_f32_16x16x32_bf16 v[32:35], a[180:183], v[40:43], v[32:35]
  s_waitcnt lgkmcnt(2)
  v_mfma_f32_16x16x32_bf16 v[20:23], v[200:203], v[44:47], v[20:23]
  ds_read_b128 v[40:43], v103 offset:25600
  v_mfma_f32_16x16x32_bf16 v[24:27], a[24:27], v[44:47], v[24:27]
  v_cvt_pk_bf16_f32 v94, v8, v9
  v_mfma_f32_16x16x32_bf16 v[28:31], a[104:107], v[44:47], v[28:31]
  v_cvt_pk_bf16_f32 v95, v10, v11
  v_mfma_f32_16x16x32_bf16 v[32:35], a[184:187], v[44:47], v[32:35]
  s_waitcnt lgkmcnt(2)
  v_mfma_f32_16x16x32_bf16 v[20:23], v[204:207], v[48:51], v[20:23]
  ds_read_b128 v[44:47], v103 offset:26624
  v_mfma_f32_16x16x32_bf16 v[24:27], a[28:31], v[48:51], v[24:27]
  buffer_store_dwordx4 v[92:95], v100, s[8:11], s35 offen offset:0
  v_mfma_f32_16x16x32_bf16 v[28:31], a[108:111], v[48:51], v[28:31]
  v_cvt_pk_bf16_f32 v96, v12, v13
  v_mfma_f32_16x16x32_bf16 v[32:35], a[188:191], v[48:51], v[32:35]
  s_waitcnt lgkmcnt(2)
  v_mfma_f32_16x16x32_bf16 v[20:23], v[208:211], v[36:39], v[20:23]
  ds_read_b128 v[48:51], v103 offset:27648
  v_mfma_f32_16x16x32_bf16 v[24:27], a[32:35], v[36:39], v[24:27]
  v_cvt_pk_bf16_f32 v97, v14, v15
  v_mfma_f32_16x16x32_bf16 v[28:31], a[112:115], v[36:39], v[28:31]
  v_cvt_pk_bf16_f32 v98, v16, v17
  v_mfma_f32_16x16x32_bf16 v[32:35], a[192:195], v[36:39], v[32:35]
  s_waitcnt lgkmcnt(2)
  v_mfma_f32_16x16x32_bf16 v[20:23], v[212:215], v[40:43], v[20:23]
  ds_read_b128 v[36:39], v103 offset:28672
  v_mfma_f32_16x16x32_bf16 v[24:27], a[36:39], v[40:43], v[24:27]
  v_cvt_pk_bf16_f32 v99, v18, v19
  v_mfma_f32_16x16x32_bf16 v[28:31], a[116:119], v[40:43], v[28:31]
  buffer_store_dwordx4 v[96:99], v100, s[8:11], s35 offen offset:1024
  v_mfma_f32_16x16x32_bf16 v[32:35], a[196:199], v[40:43], v[32:35]
  s_waitcnt lgkmcnt(2)
  v_mfma_f32_16x16x32_bf16 v[20:23], v[216:219], v[44:47], v[20:23]
  ds_read_b128 v[40:43], v103 offset:29696
  v_mfma_f32_16x16x32_bf16 v[24:27], a[40:43], v[44:47], v[24:27]
  v_mfma_f32_16x16x32_bf16 v[28:31], a[120:123], v[44:47], v[28:31]
  v_mfma_f32_16x16x32_bf16 v[32:35], a[200:203], v[44:47], v[32:35]
  s_waitcnt lgkmcnt(2)
  v_mfma_f32_16x16x32_bf16 v[20:23], v[220:223], v[48:51], v[20:23]
  ds_read_b128 v[44:47], v103 offset:30720
  v_mfma_f32_16x16x32_bf16 v[24:27], a[44:47], v[48:51], v[24:27]
  v_mfma_f32_16x16x32_bf16 v[28:31], a[124:127], v[48:51], v[28:31]
  v_mfma_f32_16x16x32_bf16 v[32:35], a[204:207], v[48:51], v[32:35]
  s_waitcnt lgkmcnt(2)
  v_mfma_f32_16x16x32_bf16 v[20:23], v[224:227], v[36:39], v[20:23]
  ds_read_b128 v[48:51], v103 offset:31744
  v_mfma_f32_16x16x32_bf16 v[24:27], a[48:51], v[36:39], v[24:27]
  v_mfma_f32_16x16x32_bf16 v[28:31], a[128:131], v[36:39], v[28:31]
  v_mfma_f32_16x16x32_bf16 v[32:35], a[208:211], v[36:39], v[32:35]
  s_waitcnt lgkmcnt(2)
  v_mfma_f32_16x16x32_bf16 v[20:23], v[228:231], v[40:43], v[20:23]
  ds_read_b128 v[36:39], v103 offset:32768
  v_mfma_f32_16x16x32_bf16 v[24:27], a[52:55], v[40:43], v[24:27]
  v_mfma_f32_16x16x32_bf16 v[28:31], a[132:135], v[40:43], v[28:31]
  v_mfma_f32_16x16x32_bf16 v[32:35], a[212:215], v[40:43], v[32:35]
  s_waitcnt lgkmcnt(2)
  v_mfma_f32_16x16x32_bf16 v[20:23], v[232:235], v[44:47], v[20:23]
  ds_read_b128 v[40:43], v103 offset:33792
  v_mfma_f32_16x16x32_bf16 v[24:27], a[56:59], v[44:47], v[24:27]
  v_mfma_f32_16x16x32_bf16 v[28:31], a[136:139], v[44:47], v[28:31]
  v_mfma_f32_16x16x32_bf16 v[32:35], a[216:219], v[44:47], v[32:35]
  s_waitcnt lgkmcnt(2)
  v_mfma_f32_16x16x32_bf16 v[20:23], v[236:239], v[48:51], v[20:23]
  ds_read_b128 v[44:47], v103 offset:34816
  v_mfma_f32_16x16x32_bf16 v[24:27], a[60:63], v[48:51], v[24:27]
  v_mfma_f32_16x16x32_bf16 v[28:31], a[140:143], v[48:51], v[28:31]
  v_mfma_f32_16x16x32_bf16 v[32:35], a[220:223], v[48:51], v[32:35]
  s_waitcnt lgkmcnt(2)
  v_mfma_f32_16x16x32_bf16 v[20:23], v[240:243], v[36:39], v[20:23]
  ds_read_b128 v[48:51], v103 offset:35840
  v_mfma_f32_16x16x32_bf16 v[24:27], a[64:67], v[36:39], v[24:27]
  v_mfma_f32_16x16x32_bf16 v[28:31], a[144:147], v[36:39], v[28:31]
  v_mfma_f32_16x16x32_bf16 v[32:35], a[224:227], v[36:39], v[32:35]
  s_waitcnt lgkmcnt(2)
  v_mfma_f32_16x16x32_bf16 v[20:23], v[244:247], v[40:43], v[20:23]
  ds_read_b128 v[36:39], v103 offset:36864
  v_mfma_f32_16x16x32_bf16 v[24:27], a[68:71], v[40:43], v[24:27]
  v_mfma_f32_16x16x32_bf16 v[28:31], a[148:151], v[40:43], v[28:31]
  v_mfma_f32_16x16x32_bf16 v[32:35], a[228:231], v[40:43], v[32:35]
  s_waitcnt lgkmcnt(2)
  v_mfma_f32_16x16x32_bf16 v[20:23], v[248:251], v[44:47], v[20:23]
  ds_read_b128 v[40:43], v103 offset:37888
  v_mfma_f32_16x16x32_bf16 v[24:27], a[72:75], v[44:47], v[24:27]
  v_mfma_f32_16x16x32_bf16 v[28:31], a[152:155], v[44:47], v[28:31]
  v_mfma_f32_16x16x32_bf16 v[32:35], a[232:235], v[44:47], v[32:35]
  s_waitcnt lgkmcnt(2)
  v_mfma_f32_16x16x32_bf16 v[20:23], v[252:255], v[48:51], v[20:23]
  ds_read_b128 v[44:47], v103 offset:38912
  v_mfma_f32_16x16x32_bf16 v[24:27], a[76:79], v[48:51], v[24:27]
  v_mfma_f32_16x16x32_bf16 v[28:31], a[156:159], v[48:51], v[28:31]
  v_mfma_f32_16x16x32_bf16 v[32:35], a[236:239], v[48:51], v[32:35]
  s_waitcnt lgkmcnt(2)
  v_mfma_f32_16x16x32_bf16 v[20:23], a[0:3], v[36:39], v[20:23]
  ds_read_b128 v[48:51], v103 offset:39936
  v_mfma_f32_16x16x32_bf16 v[24:27], a[80:83], v[36:39], v[24:27]
  v_mfma_f32_16x16x32_bf16 v[28:31], a[160:163], v[36:39], v[28:31]
  v_mfma_f32_16x16x32_bf16 v[32:35], a[240:243], v[36:39], v[32:35]
  s_waitcnt lgkmcnt(2)
  v_mfma_f32_16x16x32_bf16 v[20:23], a[4:7], v[40:43], v[20:23]
  v_mfma_f32_16x16x32_bf16 v[24:27], a[84:87], v[40:43], v[24:27]
  v_mfma_f32_16x16x32_bf16 v[28:31], a[164:167], v[40:43], v[28:31]
  v_mfma_f32_16x16x32_bf16 v[32:35], a[244:247], v[40:43], v[32:35]
  s_waitcnt lgkmcnt(1)
  v_mfma_f32_16x16x32_bf16 v[20:23], a[8:11], v[44:47], v[20:23]
  v_mfma_f32_16x16x32_bf16 v[24:27], a[88:91], v[44:47], v[24:27]
  v_mfma_f32_16x16x32_bf16 v[28:31], a[168:171], v[44:47], v[28:31]
  v_mfma_f32_16x16x32_bf16 v[32:35], a[248:251], v[44:47], v[32:35]
  s_waitcnt lgkmcnt(0)
  v_mfma_f32_16x16x32_bf16 v[20:23], a[12:15], v[48:51], v[20:23]
  v_mfma_f32_16x16x32_bf16 v[24:27], a[92:95], v[48:51], v[24:27]
  v_mfma_f32_16x16x32_bf16 v[28:31], a[172:175], v[48:51], v[28:31]
  v_mfma_f32_16x16x32_bf16 v[32:35], a[252:255], v[48:51], v[32:35]
  s_xor_b32 s37, s37, 0x10000
  v_xor_b32 v103, 0x10000, v103
  s_add_u32 s28, s28, 1
  s_cmp_lt_u32 s28, 64
  s_waitcnt vmcnt(2) lgkmcnt(0)
  s_barrier
  s_cbranch_scc1 p_loop
  s_add_u32 s32, s35, 6144
  v_cvt_pk_bf16_f32 v92, v20, v21
  v_cvt_pk_bf16_f32 v93, v22, v23
  v_cvt_pk_bf16_f32 v94, v24, v25
  v_cvt_pk_bf16_f32 v95, v26, v27
  buffer_store_dwordx4 v[92:95], v100, s[8:11], s32 offen offset:0
  v_cvt_pk_bf16_f32 v96, v28, v29
  v_cvt_pk_bf16_f32 v97, v30, v31
  v_cvt_pk_bf16_f32 v98, v32, v33
  v_cvt_pk_bf16_f32 v99, v34, v35
  buffer_store_dwordx4 v[96:99], v100, s[8:11], s32 offen offset:1024
  v_mov_b32 v109, s28
  s_waitcnt vmcnt(0)
  buffer_store_dword v109, v104, s[8:11], 0 offen
  s_branch role_moe
role_moe:
  s_cmp_gt_u32 s18, 14
  s_cbranch_scc1 moe_end
  s_load_dwordx2 s[20:21], s[0:1], 72
  s_mov_b32 s22, 1966080
  s_mov_b32 s23, 0x00020000
  s_load_dwordx2 s[24:25], s[0:1], 80
  s_mov_b32 s26, 1966080
  s_mov_b32 s27, 0x00020000
  s_load_dwordx2 s[28:29], s[0:1], 88
  s_mov_b32 s30, 1966080
  s_mov_b32 s31, 0x00020000
  s_load_dwordx2 s[32:33], s[0:1], 112
  s_mov_b32 s34, 2621440
  s_mov_b32 s35, 0x00020000
  s_mul_i32 s36, s16, 3
  s_add_u32 s36, s36, s18
  s_sub_u32 s36, s36, 12
  s_mul_i32 s41, s17, 40960
  v_lshrrev_b32 v131, 4, v1
  v_and_b32 v131, 3, v131
  v_lshlrev_b32 v131, 1, v131
  v_and_b32 v4, 7, v1
  v_xor_b32 v4, v4, v131
  v_lshlrev_b32 v4, 4, v4
  v_lshrrev_b32 v131, 3, v1
  v_mul_u32_u24 v131, 0, v131
  v_add_u32 v4, v4, v131
  v_lshrrev_b32 v131, 4, v1
  v_and_b32 v131, 3, v131
  v_lshlrev_b32 v131, 1, v131
  v_and_b32 v5, 7, v1
  v_xor_b32 v5, v5, v131
  v_lshlrev_b32 v5, 4, v5
  v_lshrrev_b32 v131, 3, v1
  v_mul_u32_u24 v131, 1280, v131
  v_add_u32 v5, v5, v131
  v_bfe_u32 v131, v1, 3, 2
  v_bfe_u32 v132, v1, 5, 1
  v_lshl_add_u32 v131, v132, 3, v131
  v_mul_u32_u24 v131, 3072, v131
  v_add_u32 v4, v4, v131
  v_lshrrev_b32 v131, 2, v1
  v_lshrrev_b32 v132, 1, v131
  v_and_b32 v132, 3, v132
  v_lshlrev_b32 v132, 1, v132
  v_bfe_u32 v152, v1, 1, 1
  v_add_u32 v152, 0, v152
  v_xor_b32 v152, v152, v132
  v_lshlrev_b32 v152, 4, v152
  v_lshlrev_b32 v131, 7, v131
  v_add_u32 v152, v152, v131
  v_and_b32 v131, 1, v1
  v_lshlrev_b32 v131, 3, v131
  v_add_u32 v152, v152, v131
  v_add_u32 v152, s41, v152
  v_lshrrev_b32 v131, 2, v1
  v_lshrrev_b32 v132, 1, v131
  v_and_b32 v132, 3, v132
  v_lshlrev_b32 v132, 1, v132
  v_bfe_u32 v153, v1, 1, 1
  v_add_u32 v153, 2, v153
  v_xor_b32 v153, v153, v132
  v_lshlrev_b32 v153, 4, v153
  v_lshlrev_b32 v131, 7, v131
  v_add_u32 v153, v153, v131
  v_and_b32 v131, 1, v1
  v_lshlrev_b32 v131, 3, v131
  v_add_u32 v153, v153, v131
  v_add_u32 v153, s41, v153
  v_lshrrev_b32 v131, 2, v1
  v_lshrrev_b32 v132, 1, v131
  v_and_b32 v132, 3, v132
  v_lshlrev_b32 v132, 1, v132
  v_bfe_u32 v154, v1, 1, 1
  v_add_u32 v154, 4, v154
  v_xor_b32 v154, v154, v132
  v_lshlrev_b32 v154, 4, v154
  v_lshlrev_b32 v131, 7, v131
  v_add_u32 v154, v154, v131
  v_and_b32 v131, 1, v1
  v_lshlrev_b32 v131, 3, v131
  v_add_u32 v154, v154, v131
  v_add_u32 v154, s41, v154
  v_lshrrev_b32 v131, 2, v1
  v_lshrrev_b32 v132, 1, v131
  v_and_b32 v132, 3, v132
  v_lshlrev_b32 v132, 1, v132
  v_bfe_u32 v155, v1, 1, 1
  v_add_u32 v155, 6, v155
  v_xor_b32 v155, v155, v132
  v_lshlrev_b32 v155, 4, v155
  v_lshlrev_b32 v131, 7, v131
  v_add_u32 v155, v155, v131
  v_and_b32 v131, 1, v1
  v_lshlrev_b32 v131, 3, v131
  v_add_u32 v155, v155, v131
  v_add_u32 v155, s41, v155
  s_mul_i32 s40, s17, 491520
  s_lshl_b32 s38, s36, 7
  s_add_u32 s40, s40, s38
  s_waitcnt lgkmcnt(0)
  s_barrier
  s_add_u32 m0, s41, 0
  s_add_u32 s38, s40, 0
  buffer_load_dwordx4 v4, s[20:23], s38 offen lds
  s_add_u32 m0, s41, 1024
  s_add_u32 s38, s40, 49152
  buffer_load_dwordx4 v4, s[20:23], s38 offen lds
  s_add_u32 m0, s41, 2048
  s_add_u32 s38, s40, 12288
  buffer_load_dwordx4 v4, s[20:23], s38 offen lds
  s_add_u32 m0, s41, 3072
  s_add_u32 s38, s40, 61440
  buffer_load_dwordx4 v4, s[20:23], s38 offen lds
  s_add_u32 m0, s41, 4096
  s_add_u32 s38, s40, 98304
  buffer_load_dwordx4 v4, s[20:23], s38 offen lds
  s_add_u32 m0, s41, 5120
  s_add_u32 s38, s40, 147456
  buffer_load_dwordx4 v4, s[20:23], s38 offen lds
  s_add_u32 m0, s41, 6144
  s_add_u32 s38, s40, 110592
  buffer_load_dwordx4 v4, s[20:23], s38 offen lds
  s_add_u32 m0, s41, 7168
  s_add_u32 s38, s40, 159744
  buffer_load_dwordx4 v4, s[20:23], s38 offen lds
  s_add_u32 m0, s41, 8192
  s_add_u32 s38, s40, 196608
  buffer_load_dwordx4 v4, s[20:23], s38 offen lds
  s_add_u32 m0, s41, 9216
  s_add_u32 s38, s40, 245760
  buffer_load_dwordx4 v4, s[20:23], s38 offen lds
  s_add_u32 m0, s41, 10240
  s_add_u32 s38, s40, 208896
  buffer_load_dwordx4 v4, s[20:23], s38 offen lds
  s_add_u32 m0, s41, 11264
  s_add_u32 s38, s40, 258048
  buffer_load_dwordx4 v4, s[20:23], s38 offen lds
  s_add_u32 m0, s41, 12288
  s_add_u32 s38, s40, 294912
  buffer_load_dwordx4 v4, s[20:23], s38 offen lds
  s_add_u32 m0, s41, 13312
  s_add_u32 s38, s40, 344064
  buffer_load_dwordx4 v4, s[20:23], s38 offen lds
  s_add_u32 m0, s41, 14336
  s_add_u32 s38, s40, 307200
  buffer_load_dwordx4 v4, s[20:23], s38 offen lds
  s_add_u32 m0, s41, 15360
  s_add_u32 s38, s40, 356352
  buffer_load_dwordx4 v4, s[20:23], s38 offen lds
  s_add_u32 m0, s41, 16384
  s_add_u32 s38, s40, 393216
  buffer_load_dwordx4 v4, s[20:23], s38 offen lds
  s_add_u32 m0, s41, 17408
  s_add_u32 s38, s40, 442368
  buffer_load_dwordx4 v4, s[20:23], s38 offen lds
  s_add_u32 m0, s41, 18432
  s_add_u32 s38, s40, 405504
  buffer_load_dwordx4 v4, s[20:23], s38 offen lds
  s_add_u32 m0, s41, 19456
  s_add_u32 s38, s40, 454656
  buffer_load_dwordx4 v4, s[20:23], s38 offen lds
  s_add_u32 m0, s41, 20480
  s_add_u32 s38, s40, 0
  buffer_load_dwordx4 v4, s[24:27], s38 offen lds
  s_add_u32 m0, s41, 21504
  s_add_u32 s38, s40, 49152
  buffer_load_dwordx4 v4, s[24:27], s38 offen lds
  s_add_u32 m0, s41, 22528
  s_add_u32 s38, s40, 12288
  buffer_load_dwordx4 v4, s[24:27], s38 offen lds
  s_add_u32 m0, s41, 23552
  s_add_u32 s38, s40, 61440
  buffer_load_dwordx4 v4, s[24:27], s38 offen lds
  s_add_u32 m0, s41, 24576
  s_add_u32 s38, s40, 98304
  buffer_load_dwordx4 v4, s[24:27], s38 offen lds
  s_add_u32 m0, s41, 25600
  s_add_u32 s38, s40, 147456
  buffer_load_dwordx4 v4, s[24:27], s38 offen lds
  s_add_u32 m0, s41, 26624
  s_add_u32 s38, s40, 110592
  buffer_load_dwordx4 v4, s[24:27], s38 offen lds
  s_add_u32 m0, s41, 27648
  s_add_u32 s38, s40, 159744
  buffer_load_dwordx4 v4, s[24:27], s38 offen lds
  s_add_u32 m0, s41, 28672
  s_add_u32 s38, s40, 196608
  buffer_load_dwordx4 v4, s[24:27], s38 offen lds
  s_add_u32 m0, s41, 29696
  s_add_u32 s38, s40, 245760
  buffer_load_dwordx4 v4, s[24:27], s38 offen lds
  s_add_u32 m0, s41, 30720
  s_add_u32 s38, s40, 208896
  buffer_load_dwordx4 v4, s[24:27], s38 offen lds
  s_add_u32 m0, s41, 31744
  s_add_u32 s38, s40, 258048
  buffer_load_dwordx4 v4, s[24:27], s38 offen lds
  s_add_u32 m0, s41, 32768
  s_add_u32 s38, s40, 294912
  buffer_load_dwordx4 v4, s[24:27], s38 offen lds
  s_add_u32 m0, s41, 33792
  s_add_u32 s38, s40, 344064
  buffer_load_dwordx4 v4, s[24:27], s38 offen lds
  s_add_u32 m0, s41, 34816
  s_add_u32 s38, s40, 307200
  buffer_load_dwordx4 v4, s[24:27], s38 offen lds
  s_add_u32 m0, s41, 35840
  s_add_u32 s38, s40, 356352
  buffer_load_dwordx4 v4, s[24:27], s38 offen lds
  s_add_u32 m0, s41, 36864
  s_add_u32 s38, s40, 393216
  buffer_load_dwordx4 v4, s[24:27], s38 offen lds
  s_add_u32 m0, s41, 37888
  s_add_u32 s38, s40, 442368
  buffer_load_dwordx4 v4, s[24:27], s38 offen lds
  s_add_u32 m0, s41, 38912
  s_add_u32 s38, s40, 405504
  buffer_load_dwordx4 v4, s[24:27], s38 offen lds
  s_add_u32 m0, s41, 39936
  s_add_u32 s38, s40, 454656
  buffer_load_dwordx4 v4, s[24:27], s38 offen lds
  s_waitcnt vmcnt(36)
  ds_read_b64_tr_b16 a[0:1], v152 offset:0
  ds_read_b64_tr_b16 a[2:3], v152 offset:2048
  ds_read_b64_tr_b16 a[20:21], v153 offset:0
  ds_read_b64_tr_b16 a[22:23], v153 offset:2048
  ds_read_b64_tr_b16 a[40:41], v154 offset:0
  ds_read_b64_tr_b16 a[42:43], v154 offset:2048
  ds_read_b64_tr_b16 a[60:61], v155 offset:0
  ds_read_b64_tr_b16 a[62:63], v155 offset:2048
  s_waitcnt vmcnt(32)
  ds_read_b64_tr_b16 a[4:5], v152 offset:4096
  ds_read_b64_tr_b16 a[6:7], v152 offset:6144
  ds_read_b64_tr_b16 a[24:25], v153 offset:4096
  ds_read_b64_tr_b16 a[26:27], v153 offset:6144
  ds_read_b64_tr_b16 a[44:45], v154 offset:4096
  ds_read_b64_tr_b16 a[46:47], v154 offset:6144
  ds_read_b64_tr_b16 a[64:65], v155 offset:4096
  ds_read_b64_tr_b16 a[66:67], v155 offset:6144
  s_waitcnt lgkmcnt(0)
  s_waitcnt vmcnt(28)
  ds_read_b64_tr_b16 a[8:9], v152 offset:8192
  ds_read_b64_tr_b16 a[10:11], v152 offset:10240
  ds_read_b64_tr_b16 a[28:29], v153 offset:8192
  ds_read_b64_tr_b16 a[30:31], v153 offset:10240
  ds_read_b64_tr_b16 a[48:49], v154 offset:8192
  ds_read_b64_tr_b16 a[50:51], v154 offset:10240
  ds_read_b64_tr_b16 a[68:69], v155 offset:8192
  ds_read_b64_tr_b16 a[70:71], v155 offset:10240
  s_waitcnt vmcnt(24)
  ds_read_b64_tr_b16 a[12:13], v152 offset:12288
  ds_read_b64_tr_b16 a[14:15], v152 offset:14336
  ds_read_b64_tr_b16 a[32:33], v153 offset:12288
  ds_read_b64_tr_b16 a[34:35], v153 offset:14336
  ds_read_b64_tr_b16 a[52:53], v154 offset:12288
  ds_read_b64_tr_b16 a[54:55], v154 offset:14336
  ds_read_b64_tr_b16 a[72:73], v155 offset:12288
  ds_read_b64_tr_b16 a[74:75], v155 offset:14336
  s_waitcnt lgkmcnt(0)
  s_waitcnt vmcnt(20)
  ds_read_b64_tr_b16 a[16:17], v152 offset:16384
  ds_read_b64_tr_b16 a[18:19], v152 offset:18432
  ds_read_b64_tr_b16 a[36:37], v153 offset:16384
  ds_read_b64_tr_b16 a[38:39], v153 offset:18432
  ds_read_b64_tr_b16 a[56:57], v154 offset:16384
  ds_read_b64_tr_b16 a[58:59], v154 offset:18432
  ds_read_b64_tr_b16 a[76:77], v155 offset:16384
  ds_read_b64_tr_b16 a[78:79], v155 offset:18432
  s_waitcnt vmcnt(16)
  ds_read_b64_tr_b16 a[80:81], v152 offset:20480
  ds_read_b64_tr_b16 a[82:83], v152 offset:22528
  ds_read_b64_tr_b16 a[100:101], v153 offset:20480
  ds_read_b64_tr_b16 a[102:103], v153 offset:22528
  ds_read_b64_tr_b16 a[120:121], v154 offset:20480
  ds_read_b64_tr_b16 a[122:123], v154 offset:22528
  ds_read_b64_tr_b16 a[140:141], v155 offset:20480
  ds_read_b64_tr_b16 a[142:143], v155 offset:22528
  s_waitcnt lgkmcnt(0)
  s_waitcnt vmcnt(12)
  ds_read_b64_tr_b16 a[84:85], v152 offset:24576
  ds_read_b64_tr_b16 a[86:87], v152 offset:26624
  ds_read_b64_tr_b16 a[104:105], v153 offset:24576
  ds_read_b64_tr_b16 a[106:107], v153 offset:26624
  ds_read_b64_tr_b16 a[124:125], v154 offset:24576
  ds_read_b64_tr_b16 a[126:127], v154 offset:26624
  ds_read_b64_tr_b16 a[144:145], v155 offset:24576
  ds_read_b64_tr_b16 a[146:147], v155 offset:26624
  s_waitcnt vmcnt(8)
  ds_read_b64_tr_b16 a[88:89], v152 offset:28672
  ds_read_b64_tr_b16 a[90:91], v152 offset:30720
  ds_read_b64_tr_b16 a[108:109], v153 offset:28672
  ds_read_b64_tr_b16 a[110:111], v153 offset:30720
  ds_read_b64_tr_b16 a[128:129], v154 offset:28672
  ds_read_b64_tr_b16 a[130:131], v154 offset:30720
  ds_read_b64_tr_b16 a[148:149], v155 offset:28672
  ds_read_b64_tr_b16 a[150:151], v155 offset:30720
  s_waitcnt lgkmcnt(0)
  s_waitcnt vmcnt(4)
  ds_read_b64_tr_b16 a[92:93], v152 offset:32768
  ds_read_b64_tr_b16 a[94:95], v152 offset:34816
  ds_read_b64_tr_b16 a[112:113], v153 offset:32768
  ds_read_b64_tr_b16 a[114:115], v153 offset:34816
  ds_read_b64_tr_b16 a[132:133], v154 offset:32768
  ds_read_b64_tr_b16 a[134:135], v154 offset:34816
  ds_read_b64_tr_b16 a[152:153], v155 offset:32768
  ds_read_b64_tr_b16 a[154:155], v155 offset:34816
  s_waitcnt vmcnt(0)
  ds_read_b64_tr_b16 a[96:97], v152 offset:36864
  ds_read_b64_tr_b16 a[98:99], v152 offset:38912
  ds_read_b64_tr_b16 a[116:117], v153 offset:36864
  ds_read_b64_tr_b16 a[118:119], v153 offset:38912
  ds_read_b64_tr_b16 a[136:137], v154 offset:36864
  ds_read_b64_tr_b16 a[138:139], v154 offset:38912
  ds_read_b64_tr_b16 a[156:157], v155 offset:36864
  ds_read_b64_tr_b16 a[158:159], v155 offset:38912
  s_waitcnt lgkmcnt(0)
  s_mul_i32 s40, s36, 81920
  s_mul_i32 s38, s17, 320
  s_add_u32 s40, s40, s38
  s_add_u32 m0, s41, 0
  s_add_u32 s38, s40, 0
  buffer_load_dwordx4 v5, s[28:31], s38 offen lds
  s_add_u32 m0, s41, 1024
  s_add_u32 s38, s40, 10240
  buffer_load_dwordx4 v5, s[28:31], s38 offen lds
  s_add_u32 m0, s41, 2048
  s_add_u32 s38, s40, 20480
  buffer_load_dwordx4 v5, s[28:31], s38 offen lds
  s_add_u32 m0, s41, 3072
  s_add_u32 s38, s40, 30720
  buffer_load_dwordx4 v5, s[28:31], s38 offen lds
  s_add_u32 m0, s41, 4096
  s_add_u32 s38, s40, 40960
  buffer_load_dwordx4 v5, s[28:31], s38 offen lds
  s_add_u32 m0, s41, 5120
  s_add_u32 s38, s40, 51200
  buffer_load_dwordx4 v5, s[28:31], s38 offen lds
  s_add_u32 m0, s41, 6144
  s_add_u32 s38, s40, 61440
  buffer_load_dwordx4 v5, s[28:31], s38 offen lds
  s_add_u32 m0, s41, 7168
  s_add_u32 s38, s40, 71680
  buffer_load_dwordx4 v5, s[28:31], s38 offen lds
  s_add_u32 m0, s41, 8192
  s_add_u32 s38, s40, 128
  buffer_load_dwordx4 v5, s[28:31], s38 offen lds
  s_add_u32 m0, s41, 9216
  s_add_u32 s38, s40, 10368
  buffer_load_dwordx4 v5, s[28:31], s38 offen lds
  s_add_u32 m0, s41, 10240
  s_add_u32 s38, s40, 20608
  buffer_load_dwordx4 v5, s[28:31], s38 offen lds
  s_add_u32 m0, s41, 11264
  s_add_u32 s38, s40, 30848
  buffer_load_dwordx4 v5, s[28:31], s38 offen lds
  s_add_u32 m0, s41, 12288
  s_add_u32 s38, s40, 41088
  buffer_load_dwordx4 v5, s[28:31], s38 offen lds
  s_add_u32 m0, s41, 13312
  s_add_u32 s38, s40, 51328
  buffer_load_dwordx4 v5, s[28:31], s38 offen lds
  s_add_u32 m0, s41, 14336
  s_add_u32 s38, s40, 61568
  buffer_load_dwordx4 v5, s[28:31], s38 offen lds
  s_add_u32 m0, s41, 15360
  s_add_u32 s38, s40, 71808
  buffer_load_dwordx4 v5, s[28:31], s38 offen lds
  s_add_u32 m0, s41, 16384
  s_add_u32 s38, s40, 256
  buffer_load_dwordx4 v5, s[28:31], s38 offen lds
  s_add_u32 m0, s41, 17408
  s_add_u32 s38, s40, 10496
  buffer_load_dwordx4 v5, s[28:31], s38 offen lds
  s_add_u32 m0, s41, 18432
  s_add_u32 s38, s40, 20736
  buffer_load_dwordx4 v5, s[28:31], s38 offen lds
  s_add_u32 m0, s41, 19456
  s_add_u32 s38, s40, 30976
  buffer_load_dwordx4 v5, s[28:31], s38 offen lds
  s_add_u32 m0, s41, 20480
  s_add_u32 s38, s40, 41216
  buffer_load_dwordx4 v5, s[28:31], s38 offen lds
  s_add_u32 m0, s41, 21504
  s_add_u32 s38, s40, 51456
  buffer_load_dwordx4 v5, s[28:31], s38 offen lds
  s_add_u32 m0, s41, 22528
  s_add_u32 s38, s40, 61696
  buffer_load_dwordx4 v5, s[28:31], s38 offen lds
  s_add_u32 m0, s41, 23552
  s_add_u32 s38, s40, 71936
  buffer_load_dwordx4 v5, s[28:31], s38 offen lds
  s_waitcnt vmcnt(0)
  ds_read_b64_tr_b16 a[160:161], v152 offset:0
  ds_read_b64_tr_b16 a[162:163], v152 offset:2048
  ds_read_b64_tr_b16 a[164:165], v152 offset:4096
  ds_read_b64_tr_b16 a[166:167], v152 offset:6144
  ds_read_b64_tr_b16 a[168:169], v153 offset:0
  ds_read_b64_tr_b16 a[170:171], v153 offset:2048
  ds_read_b64_tr_b16 a[172:173], v153 offset:4096
  ds_read_b64_tr_b16 a[174:175], v153 offset:6144
  ds_read_b64_tr_b16 a[176:177], v154 offset:0
  ds_read_b64_tr_b16 a[178:179], v154 offset:2048
  ds_read_b64_tr_b16 a[180:181], v154 offset:4096
  ds_read_b64_tr_b16 a[182:183], v154 offset:6144
  s_waitcnt lgkmcnt(0)
  ds_read_b64_tr_b16 a[184:185], v155 offset:0
  ds_read_b64_tr_b16 a[186:187], v155 offset:2048
  ds_read_b64_tr_b16 a[188:189], v155 offset:4096
  ds_read_b64_tr_b16 a[190:191], v155 offset:6144
  ds_read_b64_tr_b16 a[192:193], v152 offset:8192
  ds_read_b64_tr_b16 a[194:195], v152 offset:10240
  ds_read_b64_tr_b16 a[196:197], v152 offset:12288
  ds_read_b64_tr_b16 a[198:199], v152 offset:14336
  ds_read_b64_tr_b16 a[200:201], v153 offset:8192
  ds_read_b64_tr_b16 a[202:203], v153 offset:10240
  ds_read_b64_tr_b16 a[204:205], v153 offset:12288
  ds_read_b64_tr_b16 a[206:207], v153 offset:14336
  s_waitcnt lgkmcnt(0)
  ds_read_b64_tr_b16 a[208:209], v154 offset:8192
  ds_read_b64_tr_b16 a[210:211], v154 offset:10240
  ds_read_b64_tr_b16 a[212:213], v154 offset:12288
  ds_read_b64_tr_b16 a[214:215], v154 offset:14336
  ds_read_b64_tr_b16 a[216:217], v155 offset:8192
  ds_read_b64_tr_b16 a[218:219], v155 offset:10240
  ds_read_b64_tr_b16 a[220:221], v155 offset:12288
  ds_read_b64_tr_b16 a[222:223], v155 offset:14336
  ds_read_b64_tr_b16 a[224:225], v152 offset:16384
  ds_read_b64_tr_b16 a[226:227], v152 offset:18432
  ds_read_b64_tr_b16 a[228:229], v152 offset:20480
  ds_read_b64_tr_b16 a[230:231], v152 offset:22528
  s_waitcnt lgkmcnt(0)
  ds_read_b64_tr_b16 a[232:233], v153 offset:16384
  ds_read_b64_tr_b16 a[234:235], v153 offset:18432
  ds_read_b64_tr_b16 a[236:237], v153 offset:20480
  ds_read_b64_tr_b16 a[238:239], v153 offset:22528
  v_lshlrev_b32 v120, 4, v1
  v_lshrrev_b32 v131, 2, v1
  v_and_b32 v132, 3, v1
  v_lshlrev_b32 v132, 2, v132
  v_lshl_add_u32 v121, v131, 7, v132
  s_lshl_b32 s38, s16, 8
  s_add_u32 s38, s38, 16384
  v_mov_b32 v123, s38
  v_mov_b32 v124, 0
  v_lshrrev_b32 v131, 4, v1
  v_and_b32 v132, 7, v1
  v_lshlrev_b32 v132, 4, v132
  v_lshl_add_u32 v127, v131, 7, v132
  v_lshrrev_b32 v131, 5, v1
  v_mul_u32_u24 v131, 20480, v131
  v_and_b32 v132, 31, v1
  v_lshl_add_u32 v128, v132, 4, v131
  s_mul_i32 s47, s17, 24
  s_add_u32 s47, s47, s36
  s_mov_b32 s42, 0
  s_mov_b32 s44, 2097152
  s_waitcnt lgkmcnt(0)
  s_barrier
  s_mov_b32 s48, 0
  s_mov_b32 s49, 0
  s_mov_b32 s50, 0
  s_mov_b32 s51, 0
  s_mov_b32 s52, 0
  s_mov_b32 s53, 0
  s_mov_b32 s54, 0
  s_mov_b32 s55, 0
moe_chunk:
  s_lshl_b32 s43, s42, 1
  s_add_u32 s43, s43, 6
  s_min_u32 s43, s43, 64
  s_mov_b32 s37, 0
  s_branch pc_9
pw_7:
  buffer_load_dword v124, v123, s[8:11], 0 offen sc1
  s_add_u32 s37, s37, 1
  s_cmp_gt_u32 s37, 65536
  s_cbranch_scc1 role_abort
  s_waitcnt vmcnt(0)
pc_9:
  v_cmp_gt_u32 vcc, s43, v124
  s_nop 0
  s_and_b32 vcc_lo, vcc_lo, 0x1
  s_and_b32 vcc_hi, vcc_hi, 0x0
  s_cmp_eq_u64 vcc, 0
  s_cbranch_scc1 po_8
  s_sleep 8
  s_branch pw_7
po_8:
  s_cmp_lt_u32 s42, 31
  s_cbranch_scc1 moe_kp0
  s_sleep 48
moe_kp0:
  s_mov_b32 s37, 0
moe_kp:
  buffer_load_dword v122, v121, s[8:11], s44 offen sc1
  s_add_u32 s37, s37, 1
  s_cmp_gt_u32 s37, 65536
  s_cbranch_scc1 role_abort
  s_waitcnt vmcnt(0)
  v_cmp_eq_u32 vcc, -1, v122
  s_cbranch_vccz moe_ins
  s_sleep 4
  s_branch moe_kp
moe_ins:
  v_cmp_lt_u32 vcc, s55, v122
  s_cbranch_vccz moe_nx
  s_ff1_i32_b64 s38, vcc
  v_readlane_b32 s45, v122, s38
  v_writelane_b32 v122, 0, s38
  s_min_u32 s46, s48, s45
  s_max_u32 s48, s48, s45
  s_min_u32 s45, s49, s46
  s_max_u32 s49, s49, s46
  s_min_u32 s46, s50, s45
  s_max_u32 s50, s50, s45
  s_min_u32 s45, s51, s46
  s_max_u32 s51, s51, s46
  s_min_u32 s46, s52, s45
  s_max_u32 s52, s52, s45
  s_min_u32 s45, s53, s46
  s_max_u32 s53, s53, s46
  s_min_u32 s46, s54, s45
  s_max_u32 s54, s54, s45
  s_min_u32 s45, s55, s46
  s_max_u32 s55, s55, s46
  s_branch moe_ins
moe_nx:
  s_add_u32 s44, s44, 2048
  s_add_u32 s42, s42, 1
  s_cmp_lt_u32 s42, 32
  s_cbranch_scc1 moe_chunk
  s_mov_b32 exec_lo, 0x1010101
  s_mov_b32 exec_hi, 0x1010101
  v_mov_b32 v125, s48
  s_mov_b32 exec_lo, 0x2020202
  s_mov_b32 exec_hi, 0x2020202
  v_mov_b32 v125, s49
  s_mov_b32 exec_lo, 0x4040404
  s_mov_b32 exec_hi, 0x4040404
  v_mov_b32 v125, s50
  s_mov_b32 exec_lo, 0x8080808
  s_mov_b32 exec_hi, 0x8080808
  v_mov_b32 v125, s51
  s_mov_b32 exec_lo, 0x10101010
  s_mov_b32 exec_hi, 0x10101010
  v_mov_b32 v125, s52
  s_mov_b32 exec_lo, 0x20202020
  s_mov_b32 exec_hi, 0x20202020
  v_mov_b32 v125, s53
  s_mov_b32 exec_lo, 0x40404040
  s_mov_b32 exec_hi, 0x40404040
  v_mov_b32 v125, s54
  s_mov_b32 exec_lo, 0x80808080
  s_mov_b32 exec_hi, 0x80808080
  v_mov_b32 v125, s55
  s_mov_b64 exec, -1
  v_and_b32 v131, 0x7ff, v125
  v_sub_u32 v131, 2047, v131
  v_mul_u32_u24 v129, 1280, v131
  v_lshrrev_b32 v132, 4, v1
  v_lshl_add_u32 v126, v132, 4, v129
  s_mul_i32 s38, s17, 320
  s_add_u32 s38, s38, 8388608
  buffer_load_dwordx4 v[4:7], v126, s[8:11], s38 offen offset:0 sc1
  buffer_load_dwordx4 v[8:11], v126, s[8:11], s38 offen offset:64 sc1
  buffer_load_dwordx4 v[12:15], v126, s[8:11], s38 offen offset:128 sc1
  buffer_load_dwordx4 v[16:19], v126, s[8:11], s38 offen offset:192 sc1
  buffer_load_dwordx4 v[20:23], v126, s[8:11], s38 offen offset:256 sc1
  v_bfe_u32 v132, v1, 3, 2
  s_min_u32 s40, s47, 39
  s_lshl_b32 s39, s40, 5
  v_lshl_add_u32 v133, v132, 3, s39
  v_add_u32 v129, v129, v133
  v_lshlrev_b32 v133, 1, v133
  s_mov_b32 s38, 5242880
  s_mov_b32 s39, 8388608
  s_mov_b32 s45, 78336
  buffer_load_dwordx2 v[136:137], v129, s[8:11], s38 offen sc1
  buffer_load_dwordx2 v[138:139], v129, s[8:11], s39 offen sc1
  buffer_load_dwordx4 v[140:143], v133, s[8:11], s45 offen
  v_and_b32 v131, 0xffff0000, v125
  v_ashrrev_i32 v132, 31, v131
  v_not_b32 v132, v132
  v_or_b32 v132, 0x80000000, v132
  v_and_b32 v132, 0xffff0000, v132
  v_xor_b32 v131, v131, v132
  v_mul_f32 v131, 0xbfb8aa3b, v131
  v_exp_f32 v131, v131
  s_nop 0
  v_add_f32 v131, 1.0, v131
  v_rcp_f32 v131, v131
  s_nop 0
  v_cvt_pk_bf16_f32 v131, v131, v131
  v_lshlrev_b32 v130, 16, v131
  s_lshl_b32 s38, s17, 13
  v_add_u32 v133, s38, v120
  s_lshl_b32 s38, s17, 10
  v_add_u32 v134, s38, v120
  s_waitcnt vmcnt(7)
  v_mfma_f32_16x16x32_bf16 v[24:27], a[0:3], v[4:7], 0
  v_mfma_f32_16x16x32_bf16 v[28:31], a[20:23], v[4:7], 0
  v_mfma_f32_16x16x32_bf16 v[32:35], a[40:43], v[4:7], 0
  v_mfma_f32_16x16x32_bf16 v[36:39], a[60:63], v[4:7], 0
  v_mfma_f32_16x16x32_bf16 v[40:43], a[80:83], v[4:7], 0
  v_mfma_f32_16x16x32_bf16 v[44:47], a[100:103], v[4:7], 0
  v_mfma_f32_16x16x32_bf16 v[48:51], a[120:123], v[4:7], 0
  v_mfma_f32_16x16x32_bf16 v[52:55], a[140:143], v[4:7], 0
  s_waitcnt vmcnt(6)
  v_mfma_f32_16x16x32_bf16 v[24:27], a[4:7], v[8:11], v[24:27]
  v_mfma_f32_16x16x32_bf16 v[28:31], a[24:27], v[8:11], v[28:31]
  v_mfma_f32_16x16x32_bf16 v[32:35], a[44:47], v[8:11], v[32:35]
  v_mfma_f32_16x16x32_bf16 v[36:39], a[64:67], v[8:11], v[36:39]
  v_mfma_f32_16x16x32_bf16 v[40:43], a[84:87], v[8:11], v[40:43]
  v_mfma_f32_16x16x32_bf16 v[44:47], a[104:107], v[8:11], v[44:47]
  v_mfma_f32_16x16x32_bf16 v[48:51], a[124:127], v[8:11], v[48:51]
  v_mfma_f32_16x16x32_bf16 v[52:55], a[144:147], v[8:11], v[52:55]
  s_waitcnt vmcnt(5)
  v_mfma_f32_16x16x32_bf16 v[24:27], a[8:11], v[12:15], v[24:27]
  v_mfma_f32_16x16x32_bf16 v[28:31], a[28:31], v[12:15], v[28:31]
  v_mfma_f32_16x16x32_bf16 v[32:35], a[48:51], v[12:15], v[32:35]
  v_mfma_f32_16x16x32_bf16 v[36:39], a[68:71], v[12:15], v[36:39]
  v_mfma_f32_16x16x32_bf16 v[40:43], a[88:91], v[12:15], v[40:43]
  v_mfma_f32_16x16x32_bf16 v[44:47], a[108:111], v[12:15], v[44:47]
  v_mfma_f32_16x16x32_bf16 v[48:51], a[128:131], v[12:15], v[48:51]
  v_mfma_f32_16x16x32_bf16 v[52:55], a[148:151], v[12:15], v[52:55]
  s_waitcnt vmcnt(4)
  v_mfma_f32_16x16x32_bf16 v[24:27], a[12:15], v[16:19], v[24:27]
  v_mfma_f32_16x16x32_bf16 v[28:31], a[32:35], v[16:19], v[28:31]
  v_mfma_f32_16x16x32_bf16 v[32:35], a[52:55], v[16:19], v[32:35]
  v_mfma_f32_16x16x32_bf16 v[36:39], a[72:75], v[16:19], v[36:39]
  v_mfma_f32_16x16x32_bf16 v[40:43], a[92:95], v[16:19], v[40:43]
  v_mfma_f32_16x16x32_bf16 v[44:47], a[112:115], v[16:19], v[44:47]
  v_mfma_f32_16x16x32_bf16 v[48:51], a[132:135], v[16:19], v[48:51]
  v_mfma_f32_16x16x32_bf16 v[52:55], a[152:155], v[16:19], v[52:55]
  s_waitcnt vmcnt(3)
  v_mfma_f32_16x16x32_bf16 v[24:27], a[16:19], v[20:23], v[24:27]
  v_mfma_f32_16x16x32_bf16 v[28:31], a[36:39], v[20:23], v[28:31]
  v_mfma_f32_16x16x32_bf16 v[32:35], a[56:59], v[20:23], v[32:35]
  v_mfma_f32_16x16x32_bf16 v[36:39], a[76:79], v[20:23], v[36:39]
  v_mfma_f32_16x16x32_bf16 v[40:43], a[96:99], v[20:23], v[40:43]
  v_mfma_f32_16x16x32_bf16 v[44:47], a[116:119], v[20:23], v[44:47]
  v_mfma_f32_16x16x32_bf16 v[48:51], a[136:139], v[20:23], v[48:51]
  v_mfma_f32_16x16x32_bf16 v[52:55], a[156:159], v[20:23], v[52:55]
  s_nop 0
  ds_write_b128 v133, v[24:27] offset:0
  ds_write_b128 v133, v[28:31] offset:1024
  ds_write_b128 v133, v[32:35] offset:2048
  ds_write_b128 v133, v[36:39] offset:3072
  ds_write_b128 v133, v[40:43] offset:4096
  ds_write_b128 v133, v[44:47] offset:5120
  ds_write_b128 v133, v[48:51] offset:6144
  ds_write_b128 v133, v[52:55] offset:7168
  s_waitcnt lgkmcnt(0)
  s_barrier
  ds_read_b128 v[64:67], v134 offset:0
  ds_read_b128 v[80:83], v134 offset:4096
  ds_read_b128 v[68:71], v134 offset:8192
  ds_read_b128 v[84:87], v134 offset:12288
  ds_read_b128 v[72:75], v134 offset:16384
  ds_read_b128 v[88:91], v134 offset:20480
  ds_read_b128 v[76:79], v134 offset:24576
  ds_read_b128 v[92:95], v134 offset:28672
  s_waitcnt lgkmcnt(0)
  v_pk_add_f32 v[64:65], v[64:65], v[68:69]
  v_pk_add_f32 v[72:73], v[72:73], v[76:77]
  v_pk_add_f32 v[66:67], v[66:67], v[70:71]
  v_pk_add_f32 v[74:75], v[74:75], v[78:79]
  v_pk_add_f32 v[64:65], v[64:65], v[72:73]
  v_cvt_pk_bf16_f32 v131, v64, v65
  v_lshlrev_b32 v64, 16, v131
  v_and_b32 v65, 0xffff0000, v131
  v_pk_add_f32 v[66:67], v[66:67], v[74:75]
  v_cvt_pk_bf16_f32 v131, v66, v67
  v_lshlrev_b32 v66, 16, v131
  v_and_b32 v67, 0xffff0000, v131
  v_pk_add_f32 v[80:81], v[80:81], v[84:85]
  v_pk_add_f32 v[88:89], v[88:89], v[92:93]
  v_pk_add_f32 v[82:83], v[82:83], v[86:87]
  v_pk_add_f32 v[90:91], v[90:91], v[94:95]
  v_pk_add_f32 v[80:81], v[80:81], v[88:89]
  v_cvt_pk_bf16_f32 v131, v80, v81
  v_lshlrev_b32 v80, 16, v131
  v_and_b32 v81, 0xffff0000, v131
  v_pk_add_f32 v[82:83], v[82:83], v[90:91]
  v_cvt_pk_bf16_f32 v131, v82, v83
  v_lshlrev_b32 v82, 16, v131
  v_and_b32 v83, 0xffff0000, v131
  v_mul_f32 v148, 0xbfb8aa3b, v64
  v_mul_f32 v149, 0xbfb8aa3b, v65
  v_mul_f32 v150, 0xbfb8aa3b, v66
  v_mul_f32 v151, 0xbfb8aa3b, v67
  v_exp_f32 v148, v148
  v_exp_f32 v149, v149
  v_exp_f32 v150, v150
  v_exp_f32 v151, v151
  v_add_f32 v148, 1.0, v148
  v_add_f32 v149, 1.0, v149
  v_add_f32 v150, 1.0, v150
  v_add_f32 v151, 1.0, v151
  v_rcp_f32 v148, v148
  v_rcp_f32 v149, v149
  v_rcp_f32 v150, v150
  v_rcp_f32 v151, v151
  v_pk_mul_f32 v[64:65], v[64:65], v[148:149]
  v_cvt_pk_bf16_f32 v131, v64, v65
  v_lshlrev_b32 v64, 16, v131
  v_and_b32 v65, 0xffff0000, v131
  v_pk_mul_f32 v[64:65], v[64:65], v[80:81]
  v_cvt_pk_bf16_f32 v148, v64, v65
  v_pk_mul_f32 v[66:67], v[66:67], v[150:151]
  v_cvt_pk_bf16_f32 v131, v66, v67
  v_lshlrev_b32 v66, 16, v131
  v_and_b32 v67, 0xffff0000, v131
  v_pk_mul_f32 v[66:67], v[66:67], v[82:83]
  v_cvt_pk_bf16_f32 v149, v66, v67
  s_lshr_b32 s38, s17, 1
  s_lshl_b32 s38, s38, 10
  s_and_b32 s39, s17, 1
  s_lshl_b32 s39, s39, 3
  s_add_u32 s38, s38, s39
  v_add_u32 v133, s38, v120
  ds_write_b64 v133, v[148:149] offset:32768
  s_waitcnt lgkmcnt(0)
  s_barrier
  ds_read_b128 v[112:115], v120 offset:32768
  ds_read_b128 v[116:119], v120 offset:33792
  s_mul_i32 s38, s36, 20480
  s_mul_i32 s39, s17, 5120
  s_add_u32 s38, s38, s39
  s_add_u32 s38, s38, 2326528
  s_add_u32 s39, s38, 4096
  s_waitcnt lgkmcnt(0)
  v_mfma_f32_16x16x32_bf16 v[24:27], a[160:163], v[112:115], 0
  v_mfma_f32_16x16x32_bf16 v[28:31], a[168:171], v[112:115], 0
  v_mfma_f32_16x16x32_bf16 v[32:35], a[176:179], v[112:115], 0
  v_mfma_f32_16x16x32_bf16 v[36:39], a[184:187], v[112:115], 0
  v_mfma_f32_16x16x32_bf16 v[40:43], a[192:195], v[112:115], 0
  v_mfma_f32_16x16x32_bf16 v[44:47], a[200:203], v[112:115], 0
  v_mfma_f32_16x16x32_bf16 v[48:51], a[208:211], v[112:115], 0
  v_mfma_f32_16x16x32_bf16 v[52:55], a[216:219], v[112:115], 0
  v_mfma_f32_16x16x32_bf16 v[56:59], a[224:227], v[112:115], 0
  v_mfma_f32_16x16x32_bf16 v[60:63], a[232:235], v[112:115], 0
  v_mfma_f32_16x16x32_bf16 v[24:27], a[164:167], v[116:119], v[24:27]
  v_mfma_f32_16x16x32_bf16 v[28:31], a[172:175], v[116:119], v[28:31]
  v_mfma_f32_16x16x32_bf16 v[32:35], a[180:183], v[116:119], v[32:35]
  v_mfma_f32_16x16x32_bf16 v[36:39], a[188:191], v[116:119], v[36:39]
  v_mfma_f32_16x16x32_bf16 v[40:43], a[196:199], v[116:119], v[40:43]
  v_mfma_f32_16x16x32_bf16 v[44:47], a[204:207], v[116:119], v[44:47]
  v_mfma_f32_16x16x32_bf16 v[48:51], a[212:215], v[116:119], v[48:51]
  v_mfma_f32_16x16x32_bf16 v[52:55], a[220:223], v[116:119], v[52:55]
  v_mfma_f32_16x16x32_bf16 v[56:59], a[228:231], v[116:119], v[56:59]
  v_mfma_f32_16x16x32_bf16 v[60:63], a[236:239], v[116:119], v[60:63]
  s_mov_b32 exec_lo, 0x00ff00ff
  s_mov_b32 exec_hi, 0x00ff00ff
  buffer_store_dwordx4 v[24:27], v127, s[8:11], s38 offen offset:0 sc1
  buffer_store_dwordx4 v[28:31], v127, s[8:11], s38 offen offset:512 sc1
  buffer_store_dwordx4 v[32:35], v127, s[8:11], s38 offen offset:1024 sc1
  buffer_store_dwordx4 v[36:39], v127, s[8:11], s38 offen offset:1536 sc1
  buffer_store_dwordx4 v[40:43], v127, s[8:11], s38 offen offset:2048 sc1
  buffer_store_dwordx4 v[44:47], v127, s[8:11], s38 offen offset:2560 sc1
  buffer_store_dwordx4 v[48:51], v127, s[8:11], s38 offen offset:3072 sc1
  buffer_store_dwordx4 v[52:55], v127, s[8:11], s38 offen offset:3584 sc1
  buffer_store_dwordx4 v[56:59], v127, s[8:11], s39 offen offset:0 sc1
  buffer_store_dwordx4 v[60:63], v127, s[8:11], s39 offen offset:512 sc1
  s_mov_b64 exec, -1
  s_cmp_ge_u32 s47, 40
  s_cbranch_scc1 moe_end
  s_lshl_b32 s40, s47, 9
  s_add_u32 s40, s40, 2326528
  s_sleep 8
  s_mov_b32 s37, 0
moe_yp:
  s_mov_b32 s38, s40
  buffer_load_dwordx4 v[64:67], v128, s[8:11], s38 offen sc1
  s_add_u32 s38, s38, 40960
  buffer_load_dwordx4 v[68:71], v128, s[8:11], s38 offen sc1
  s_add_u32 s38, s38, 40960
  buffer_load_dwordx4 v[72:75], v128, s[8:11], s38 offen sc1
  s_add_u32 s38, s38, 40960
  buffer_load_dwordx4 v[76:79], v128, s[8:11], s38 offen sc1
  s_add_u32 s38, s38, 40960
  buffer_load_dwordx4 v[80:83], v128, s[8:11], s38 offen sc1
  s_add_u32 s38, s38, 40960
  buffer_load_dwordx4 v[84:87], v128, s[8:11], s38 offen sc1
  s_add_u32 s38, s38, 40960
  buffer_load_dwordx4 v[88:91], v128, s[8:11], s38 offen sc1
  s_add_u32 s38, s38, 40960
  buffer_load_dwordx4 v[92:95], v128, s[8:11], s38 offen sc1
  s_add_u32 s38, s38, 40960
  buffer_load_dwordx4 v[96:99], v128, s[8:11], s38 offen sc1
  s_add_u32 s38, s38, 40960
  buffer_load_dwordx4 v[100:103], v128, s[8:11], s38 offen sc1
  s_add_u32 s38, s38, 40960
  buffer_load_dwordx4 v[104:107], v128, s[8:11], s38 offen sc1
  s_add_u32 s38, s38, 40960
  buffer_load_dwordx4 v[108:111], v128, s[8:11], s38 offen sc1
  s_add_u32 s38, s38, 40960
  s_add_u32 s37, s37, 1
  s_cmp_gt_u32 s37, 65536
  s_cbranch_scc1 role_abort
  s_waitcnt vmcnt(10)
  v_pk_add_f32 v[144:145], v[64:65], v[68:69]
  v_pk_add_f32 v[146:147], v[66:67], v[70:71]
  s_waitcnt vmcnt(9)
  v_pk_add_f32 v[144:145], v[144:145], v[72:73]
  v_pk_add_f32 v[146:147], v[146:147], v[74:75]
  s_waitcnt vmcnt(8)
  v_pk_add_f32 v[144:145], v[144:145], v[76:77]
  v_pk_add_f32 v[146:147], v[146:147], v[78:79]
  s_waitcnt vmcnt(7)
  v_pk_add_f32 v[144:145], v[144:145], v[80:81]
  v_pk_add_f32 v[146:147], v[146:147], v[82:83]
  s_waitcnt vmcnt(6)
  v_pk_add_f32 v[144:145], v[144:145], v[84:85]
  v_pk_add_f32 v[146:147], v[146:147], v[86:87]
  s_waitcnt vmcnt(5)
  v_pk_add_f32 v[144:145], v[144:145], v[88:89]
  v_pk_add_f32 v[146:147], v[146:147], v[90:91]
  s_waitcnt vmcnt(4)
  v_pk_add_f32 v[144:145], v[144:145], v[92:93]
  v_pk_add_f32 v[146:147], v[146:147], v[94:95]
  s_waitcnt vmcnt(3)
  v_pk_add_f32 v[144:145], v[144:145], v[96:97]
  v_pk_add_f32 v[146:147], v[146:147], v[98:99]
  s_waitcnt vmcnt(2)
  v_pk_add_f32 v[144:145], v[144:145], v[100:101]
  v_pk_add_f32 v[146:147], v[146:147], v[102:103]
  s_waitcnt vmcnt(1)
  v_pk_add_f32 v[144:145], v[144:145], v[104:105]
  v_pk_add_f32 v[146:147], v[146:147], v[106:107]
  s_waitcnt vmcnt(0)
  v_pk_add_f32 v[144:145], v[144:145], v[108:109]
  v_pk_add_f32 v[146:147], v[146:147], v[110:111]
  v_add_f32 v131, v144, v145
  v_add_f32 v132, v146, v147
  v_cmp_u_f32 vcc, v131, v132
  s_cbranch_vccz moe_yok
  s_sleep 2
  s_branch moe_yp
moe_yok:
  v_mov_b32 v148, v144
  v_mov_b32 v149, v145
  v_mov_b32 v150, v146
  v_mov_b32 v151, v147
  v_permlane32_swap_b32 v144, v148
  v_permlane32_swap_b32 v145, v149
  v_permlane32_swap_b32 v146, v150
  v_permlane32_swap_b32 v147, v151
  v_lshlrev_b32 v64, 16, v136
  v_and_b32 v65, 0xffff0000, v136
  v_lshlrev_b32 v68, 16, v138
  v_and_b32 v69, 0xffff0000, v138
  v_lshlrev_b32 v66, 16, v137
  v_and_b32 v67, 0xffff0000, v137
  v_lshlrev_b32 v70, 16, v139
  v_and_b32 v71, 0xffff0000, v139
  v_pk_add_f32 v[144:145], v[144:145], v[148:149]
  v_cvt_pk_bf16_f32 v131, v144, v145
  v_lshlrev_b32 v144, 16, v131
  v_and_b32 v145, 0xffff0000, v131
  v_mul_f32 v144, v144, v130
  v_mul_f32 v145, v145, v130
  v_cvt_pk_bf16_f32 v131, v144, v145
  v_lshlrev_b32 v144, 16, v131
  v_and_b32 v145, 0xffff0000, v131
  v_pk_add_f32 v[144:145], v[144:145], v[68:69]
  v_cvt_pk_bf16_f32 v131, v144, v145
  v_lshlrev_b32 v144, 16, v131
  v_and_b32 v145, 0xffff0000, v131
  v_pk_mul_f32 v[144:145], v[144:145], v[140:141]
  v_cvt_pk_bf16_f32 v131, v144, v145
  v_lshlrev_b32 v144, 16, v131
  v_and_b32 v145, 0xffff0000, v131
  v_pk_add_f32 v[144:145], v[144:145], v[64:65]
  v_cvt_pk_bf16_f32 v148, v144, v145
  v_pk_add_f32 v[146:147], v[146:147], v[150:151]
  v_cvt_pk_bf16_f32 v131, v146, v147
  v_lshlrev_b32 v146, 16, v131
  v_and_b32 v147, 0xffff0000, v131
  v_mul_f32 v146, v146, v130
  v_mul_f32 v147, v147, v130
  v_cvt_pk_bf16_f32 v131, v146, v147
  v_lshlrev_b32 v146, 16, v131
  v_and_b32 v147, 0xffff0000, v131
  v_pk_add_f32 v[146:147], v[146:147], v[70:71]
  v_cvt_pk_bf16_f32 v131, v146, v147
  v_lshlrev_b32 v146, 16, v131
  v_and_b32 v147, 0xffff0000, v131
  v_pk_mul_f32 v[146:147], v[146:147], v[142:143]
  v_cvt_pk_bf16_f32 v131, v146, v147
  v_lshlrev_b32 v146, 16, v131
  v_and_b32 v147, 0xffff0000, v131
  v_pk_add_f32 v[146:147], v[146:147], v[66:67]
  v_cvt_pk_bf16_f32 v149, v146, v147
  s_mov_b32 exec_hi, 0
  buffer_store_dwordx2 v[148:149], v129, s[32:35], 0 offen sc1
moe_end:
  s_endpgm
role_ua:
  s_load_dwordx2 s[20:21], s[0:1], 40
  s_mov_b32 s22, 7864320
  s_mov_b32 s23, 0x00020000
  s_sub_u32 s24, s18, 21
  s_lshl_b32 s25, s16, 2
  s_add_u32 s25, s25, s17
  s_lshl_b32 s35, s24, 2
  s_add_u32 s35, s35, s17
  v_lshrrev_b32 v206, 4, v1
  v_and_b32 v206, 3, v206
  v_lshlrev_b32 v206, 1, v206
  v_and_b32 v4, 7, v1
  v_xor_b32 v4, v4, v206
  v_lshlrev_b32 v4, 4, v4
  v_lshrrev_b32 v206, 3, v1
  v_mul_u32_u24 v206, 1280, v206
  v_add_u32 v4, v4, v206
  s_mul_i32 s31, s17, 40960
  v_lshrrev_b32 v206, 2, v1
  v_lshrrev_b32 v207, 1, v206
  v_and_b32 v207, 3, v207
  v_lshlrev_b32 v207, 1, v207
  v_bfe_u32 v218, v1, 1, 1
  v_add_u32 v218, 0, v218
  v_xor_b32 v218, v218, v207
  v_lshlrev_b32 v218, 4, v218
  v_lshlrev_b32 v206, 7, v206
  v_add_u32 v218, v218, v206
  v_and_b32 v206, 1, v1
  v_lshlrev_b32 v206, 3, v206
  v_add_u32 v218, v218, v206
  v_add_u32 v218, s31, v218
  v_lshrrev_b32 v206, 2, v1
  v_lshrrev_b32 v207, 1, v206
  v_and_b32 v207, 3, v207
  v_lshlrev_b32 v207, 1, v207
  v_bfe_u32 v219, v1, 1, 1
  v_add_u32 v219, 2, v219
  v_xor_b32 v219, v219, v207
  v_lshlrev_b32 v219, 4, v219
  v_lshlrev_b32 v206, 7, v206
  v_add_u32 v219, v219, v206
  v_and_b32 v206, 1, v1
  v_lshlrev_b32 v206, 3, v206
  v_add_u32 v219, v219, v206
  v_add_u32 v219, s31, v219
  v_lshrrev_b32 v206, 2, v1
  v_lshrrev_b32 v207, 1, v206
  v_and_b32 v207, 3, v207
  v_lshlrev_b32 v207, 1, v207
  v_bfe_u32 v220, v1, 1, 1
  v_add_u32 v220, 4, v220
  v_xor_b32 v220, v220, v207
  v_lshlrev_b32 v220, 4, v220
  v_lshlrev_b32 v206, 7, v206
  v_add_u32 v220, v220, v206
  v_and_b32 v206, 1, v1
  v_lshlrev_b32 v206, 3, v206
  v_add_u32 v220, v220, v206
  v_add_u32 v220, s31, v220
  v_lshrrev_b32 v206, 2, v1
  v_lshrrev_b32 v207, 1, v206
  v_and_b32 v207, 3, v207
  v_lshlrev_b32 v207, 1, v207
  v_bfe_u32 v221, v1, 1, 1
  v_add_u32 v221, 6, v221
  v_xor_b32 v221, v221, v207
  v_lshlrev_b32 v221, 4, v221
  v_lshlrev_b32 v206, 7, v206
  v_add_u32 v221, v221, v206
  v_and_b32 v206, 1, v1
  v_lshlrev_b32 v206, 3, v206
  v_add_u32 v221, v221, v206
  v_add_u32 v221, s31, v221
  s_mul_i32 s30, s25, 245760
  s_lshl_b32 s28, s24, 8
  s_add_u32 s30, s30, s28
  s_waitcnt lgkmcnt(0)
  s_add_u32 m0, s31, 0
  s_add_u32 s28, s30, 0
  buffer_load_dwordx4 v4, s[20:23], s28 offen lds
  s_add_u32 m0, s31, 1024
  s_add_u32 s28, s30, 10240
  buffer_load_dwordx4 v4, s[20:23], s28 offen lds
  s_add_u32 m0, s31, 2048
  s_add_u32 s28, s30, 20480
  buffer_load_dwordx4 v4, s[20:23], s28 offen lds
  s_add_u32 m0, s31, 3072
  s_add_u32 s28, s30, 30720
  buffer_load_dwordx4 v4, s[20:23], s28 offen lds
  s_add_u32 m0, s31, 4096
  s_add_u32 s28, s30, 40960
  buffer_load_dwordx4 v4, s[20:23], s28 offen lds
  s_add_u32 m0, s31, 5120
  s_add_u32 s28, s30, 51200
  buffer_load_dwordx4 v4, s[20:23], s28 offen lds
  s_add_u32 m0, s31, 6144
  s_add_u32 s28, s30, 61440
  buffer_load_dwordx4 v4, s[20:23], s28 offen lds
  s_add_u32 m0, s31, 7168
  s_add_u32 s28, s30, 71680
  buffer_load_dwordx4 v4, s[20:23], s28 offen lds
  s_add_u32 m0, s31, 8192
  s_add_u32 s28, s30, 81920
  buffer_load_dwordx4 v4, s[20:23], s28 offen lds
  s_add_u32 m0, s31, 9216
  s_add_u32 s28, s30, 92160
  buffer_load_dwordx4 v4, s[20:23], s28 offen lds
  s_add_u32 m0, s31, 10240
  s_add_u32 s28, s30, 102400
  buffer_load_dwordx4 v4, s[20:23], s28 offen lds
  s_add_u32 m0, s31, 11264
  s_add_u32 s28, s30, 112640
  buffer_load_dwordx4 v4, s[20:23], s28 offen lds
  s_add_u32 m0, s31, 12288
  s_add_u32 s28, s30, 122880
  buffer_load_dwordx4 v4, s[20:23], s28 offen lds
  s_add_u32 m0, s31, 13312
  s_add_u32 s28, s30, 133120
  buffer_load_dwordx4 v4, s[20:23], s28 offen lds
  s_add_u32 m0, s31, 14336
  s_add_u32 s28, s30, 143360
  buffer_load_dwordx4 v4, s[20:23], s28 offen lds
  s_add_u32 m0, s31, 15360
  s_add_u32 s28, s30, 153600
  buffer_load_dwordx4 v4, s[20:23], s28 offen lds
  s_add_u32 m0, s31, 16384
  s_add_u32 s28, s30, 163840
  buffer_load_dwordx4 v4, s[20:23], s28 offen lds
  s_add_u32 m0, s31, 17408
  s_add_u32 s28, s30, 174080
  buffer_load_dwordx4 v4, s[20:23], s28 offen lds
  s_add_u32 m0, s31, 18432
  s_add_u32 s28, s30, 184320
  buffer_load_dwordx4 v4, s[20:23], s28 offen lds
  s_add_u32 m0, s31, 19456
  s_add_u32 s28, s30, 194560
  buffer_load_dwordx4 v4, s[20:23], s28 offen lds
  s_add_u32 m0, s31, 20480
  s_add_u32 s28, s30, 204800
  buffer_load_dwordx4 v4, s[20:23], s28 offen lds
  s_add_u32 m0, s31, 21504
  s_add_u32 s28, s30, 215040
  buffer_load_dwordx4 v4, s[20:23], s28 offen lds
  s_add_u32 m0, s31, 22528
  s_add_u32 s28, s30, 225280
  buffer_load_dwordx4 v4, s[20:23], s28 offen lds
  s_add_u32 m0, s31, 23552
  s_add_u32 s28, s30, 235520
  buffer_load_dwordx4 v4, s[20:23], s28 offen lds
  s_add_u32 m0, s31, 24576
  s_add_u32 s28, s30, 128
  buffer_load_dwordx4 v4, s[20:23], s28 offen lds
  s_add_u32 m0, s31, 25600
  s_add_u32 s28, s30, 10368
  buffer_load_dwordx4 v4, s[20:23], s28 offen lds
  s_add_u32 m0, s31, 26624
  s_add_u32 s28, s30, 20608
  buffer_load_dwordx4 v4, s[20:23], s28 offen lds
  s_add_u32 m0, s31, 27648
  s_add_u32 s28, s30, 30848
  buffer_load_dwordx4 v4, s[20:23], s28 offen lds
  s_add_u32 m0, s31, 28672
  s_add_u32 s28, s30, 41088
  buffer_load_dwordx4 v4, s[20:23], s28 offen lds
  s_add_u32 m0, s31, 29696
  s_add_u32 s28, s30, 51328
  buffer_load_dwordx4 v4, s[20:23], s28 offen lds
  s_add_u32 m0, s31, 30720
  s_add_u32 s28, s30, 61568
  buffer_load_dwordx4 v4, s[20:23], s28 offen lds
  s_add_u32 m0, s31, 31744
  s_add_u32 s28, s30, 71808
  buffer_load_dwordx4 v4, s[20:23], s28 offen lds
  s_add_u32 m0, s31, 32768
  s_add_u32 s28, s30, 82048
  buffer_load_dwordx4 v4, s[20:23], s28 offen lds
  s_add_u32 m0, s31, 33792
  s_add_u32 s28, s30, 92288
  buffer_load_dwordx4 v4, s[20:23], s28 offen lds
  s_add_u32 m0, s31, 34816
  s_add_u32 s28, s30, 102528
  buffer_load_dwordx4 v4, s[20:23], s28 offen lds
  s_add_u32 m0, s31, 35840
  s_add_u32 s28, s30, 112768
  buffer_load_dwordx4 v4, s[20:23], s28 offen lds
  s_add_u32 m0, s31, 36864
  s_add_u32 s28, s30, 123008
  buffer_load_dwordx4 v4, s[20:23], s28 offen lds
  s_add_u32 m0, s31, 37888
  s_add_u32 s28, s30, 133248
  buffer_load_dwordx4 v4, s[20:23], s28 offen lds
  s_add_u32 m0, s31, 38912
  s_add_u32 s28, s30, 143488
  buffer_load_dwordx4 v4, s[20:23], s28 offen lds
  s_add_u32 m0, s31, 39936
  s_add_u32 s28, s30, 153728
  buffer_load_dwordx4 v4, s[20:23], s28 offen lds
  s_waitcnt vmcnt(36)
  ds_read_b64_tr_b16 a[0:1], v218 offset:0
  ds_read_b64_tr_b16 a[2:3], v218 offset:2048
  ds_read_b64_tr_b16 a[24:25], v219 offset:0
  ds_read_b64_tr_b16 a[26:27], v219 offset:2048
  ds_read_b64_tr_b16 a[48:49], v220 offset:0
  ds_read_b64_tr_b16 a[50:51], v220 offset:2048
  ds_read_b64_tr_b16 a[72:73], v221 offset:0
  ds_read_b64_tr_b16 a[74:75], v221 offset:2048
  s_waitcnt vmcnt(32)
  ds_read_b64_tr_b16 a[4:5], v218 offset:4096
  ds_read_b64_tr_b16 a[6:7], v218 offset:6144
  ds_read_b64_tr_b16 a[28:29], v219 offset:4096
  ds_read_b64_tr_b16 a[30:31], v219 offset:6144
  ds_read_b64_tr_b16 a[52:53], v220 offset:4096
  ds_read_b64_tr_b16 a[54:55], v220 offset:6144
  ds_read_b64_tr_b16 a[76:77], v221 offset:4096
  ds_read_b64_tr_b16 a[78:79], v221 offset:6144
  s_waitcnt lgkmcnt(0)
  s_waitcnt vmcnt(28)
  ds_read_b64_tr_b16 a[8:9], v218 offset:8192
  ds_read_b64_tr_b16 a[10:11], v218 offset:10240
  ds_read_b64_tr_b16 a[32:33], v219 offset:8192
  ds_read_b64_tr_b16 a[34:35], v219 offset:10240
  ds_read_b64_tr_b16 a[56:57], v220 offset:8192
  ds_read_b64_tr_b16 a[58:59], v220 offset:10240
  ds_read_b64_tr_b16 a[80:81], v221 offset:8192
  ds_read_b64_tr_b16 a[82:83], v221 offset:10240
  s_waitcnt vmcnt(24)
  ds_read_b64_tr_b16 a[12:13], v218 offset:12288
  ds_read_b64_tr_b16 a[14:15], v218 offset:14336
  ds_read_b64_tr_b16 a[36:37], v219 offset:12288
  ds_read_b64_tr_b16 a[38:39], v219 offset:14336
  ds_read_b64_tr_b16 a[60:61], v220 offset:12288
  ds_read_b64_tr_b16 a[62:63], v220 offset:14336
  ds_read_b64_tr_b16 a[84:85], v221 offset:12288
  ds_read_b64_tr_b16 a[86:87], v221 offset:14336
  s_waitcnt lgkmcnt(0)
  s_waitcnt vmcnt(20)
  ds_read_b64_tr_b16 a[16:17], v218 offset:16384
  ds_read_b64_tr_b16 a[18:19], v218 offset:18432
  ds_read_b64_tr_b16 a[40:41], v219 offset:16384
  ds_read_b64_tr_b16 a[42:43], v219 offset:18432
  ds_read_b64_tr_b16 a[64:65], v220 offset:16384
  ds_read_b64_tr_b16 a[66:67], v220 offset:18432
  ds_read_b64_tr_b16 a[88:89], v221 offset:16384
  ds_read_b64_tr_b16 a[90:91], v221 offset:18432
  s_waitcnt vmcnt(16)
  ds_read_b64_tr_b16 a[20:21], v218 offset:20480
  ds_read_b64_tr_b16 a[22:23], v218 offset:22528
  ds_read_b64_tr_b16 a[44:45], v219 offset:20480
  ds_read_b64_tr_b16 a[46:47], v219 offset:22528
  ds_read_b64_tr_b16 a[68:69], v220 offset:20480
  ds_read_b64_tr_b16 a[70:71], v220 offset:22528
  ds_read_b64_tr_b16 a[92:93], v221 offset:20480
  ds_read_b64_tr_b16 a[94:95], v221 offset:22528
  s_waitcnt lgkmcnt(0)
  s_add_u32 m0, s31, 0
  s_add_u32 s28, s30, 163968
  buffer_load_dwordx4 v4, s[20:23], s28 offen lds
  s_add_u32 m0, s31, 1024
  s_add_u32 s28, s30, 174208
  buffer_load_dwordx4 v4, s[20:23], s28 offen lds
  s_add_u32 m0, s31, 2048
  s_add_u32 s28, s30, 184448
  buffer_load_dwordx4 v4, s[20:23], s28 offen lds
  s_add_u32 m0, s31, 3072
  s_add_u32 s28, s30, 194688
  buffer_load_dwordx4 v4, s[20:23], s28 offen lds
  s_add_u32 m0, s31, 4096
  s_add_u32 s28, s30, 204928
  buffer_load_dwordx4 v4, s[20:23], s28 offen lds
  s_add_u32 m0, s31, 5120
  s_add_u32 s28, s30, 215168
  buffer_load_dwordx4 v4, s[20:23], s28 offen lds
  s_add_u32 m0, s31, 6144
  s_add_u32 s28, s30, 225408
  buffer_load_dwordx4 v4, s[20:23], s28 offen lds
  s_add_u32 m0, s31, 7168
  s_add_u32 s28, s30, 235648
  buffer_load_dwordx4 v4, s[20:23], s28 offen lds
  s_waitcnt vmcnt(20)
  ds_read_b64_tr_b16 a[96:97], v218 offset:24576
  ds_read_b64_tr_b16 a[98:99], v218 offset:26624
  ds_read_b64_tr_b16 a[120:121], v219 offset:24576
  ds_read_b64_tr_b16 a[122:123], v219 offset:26624
  ds_read_b64_tr_b16 a[144:145], v220 offset:24576
  ds_read_b64_tr_b16 a[146:147], v220 offset:26624
  ds_read_b64_tr_b16 a[168:169], v221 offset:24576
  ds_read_b64_tr_b16 a[170:171], v221 offset:26624
  s_waitcnt vmcnt(16)
  ds_read_b64_tr_b16 a[100:101], v218 offset:28672
  ds_read_b64_tr_b16 a[102:103], v218 offset:30720
  ds_read_b64_tr_b16 a[124:125], v219 offset:28672
  ds_read_b64_tr_b16 a[126:127], v219 offset:30720
  ds_read_b64_tr_b16 a[148:149], v220 offset:28672
  ds_read_b64_tr_b16 a[150:151], v220 offset:30720
  ds_read_b64_tr_b16 a[172:173], v221 offset:28672
  ds_read_b64_tr_b16 a[174:175], v221 offset:30720
  s_waitcnt lgkmcnt(0)
  s_waitcnt vmcnt(12)
  ds_read_b64_tr_b16 a[104:105], v218 offset:32768
  ds_read_b64_tr_b16 a[106:107], v218 offset:34816
  ds_read_b64_tr_b16 a[128:129], v219 offset:32768
  ds_read_b64_tr_b16 a[130:131], v219 offset:34816
  ds_read_b64_tr_b16 a[152:153], v220 offset:32768
  ds_read_b64_tr_b16 a[154:155], v220 offset:34816
  ds_read_b64_tr_b16 a[176:177], v221 offset:32768
  ds_read_b64_tr_b16 a[178:179], v221 offset:34816
  s_waitcnt vmcnt(8)
  ds_read_b64_tr_b16 a[108:109], v218 offset:36864
  ds_read_b64_tr_b16 a[110:111], v218 offset:38912
  ds_read_b64_tr_b16 a[132:133], v219 offset:36864
  ds_read_b64_tr_b16 a[134:135], v219 offset:38912
  ds_read_b64_tr_b16 a[156:157], v220 offset:36864
  ds_read_b64_tr_b16 a[158:159], v220 offset:38912
  ds_read_b64_tr_b16 a[180:181], v221 offset:36864
  ds_read_b64_tr_b16 a[182:183], v221 offset:38912
  s_waitcnt lgkmcnt(0)
  s_waitcnt vmcnt(4)
  ds_read_b64_tr_b16 a[112:113], v218 offset:0
  ds_read_b64_tr_b16 a[114:115], v218 offset:2048
  ds_read_b64_tr_b16 a[136:137], v219 offset:0
  ds_read_b64_tr_b16 a[138:139], v219 offset:2048
  ds_read_b64_tr_b16 a[160:161], v220 offset:0
  ds_read_b64_tr_b16 a[162:163], v220 offset:2048
  ds_read_b64_tr_b16 a[184:185], v221 offset:0
  ds_read_b64_tr_b16 a[186:187], v221 offset:2048
  s_waitcnt vmcnt(0)
  ds_read_b64_tr_b16 a[116:117], v218 offset:4096
  ds_read_b64_tr_b16 a[118:119], v218 offset:6144
  ds_read_b64_tr_b16 a[140:141], v219 offset:4096
  ds_read_b64_tr_b16 a[142:143], v219 offset:6144
  ds_read_b64_tr_b16 a[164:165], v220 offset:4096
  ds_read_b64_tr_b16 a[166:167], v220 offset:6144
  ds_read_b64_tr_b16 a[188:189], v221 offset:4096
  ds_read_b64_tr_b16 a[190:191], v221 offset:6144
  s_waitcnt lgkmcnt(0)
  s_barrier
  v_lshlrev_b32 v196, 4, v1
  v_add_u32 v205, 131072, v196
  v_bfe_u32 v206, v1, 2, 1
  v_and_b32 v207, 3, v1
  v_lshl_add_u32 v206, v206, 3, v207
  v_lshrrev_b32 v207, 4, v1
  v_lshl_add_u32 v206, v207, 4, v206
  v_lshlrev_b32 v206, 4, v206
  v_bfe_u32 v207, v1, 3, 1
  v_mul_u32_u24 v208, 1088, v207
  s_lshl_b32 s28, s17, 11
  v_add3_u32 v214, v206, v208, s28
  v_xor_b32 v215, 64, v214
  s_lshl_b32 s28, s17, 13
  v_add_u32 v216, s28, v196
  v_xor_b32 v217, 64, v216
  s_lshr_b32 s28, s17, 1
  s_lshl_b32 s28, s28, 10
  s_and_b32 s29, s17, 1
  s_lshl_b32 s30, s29, 3
  s_add_u32 s28, s28, s30
  s_add_u32 s28, s28, 141312
  v_lshl_add_u32 v206, v207, 2, v206
  v_add_u32 v197, s28, v206
  s_lshl_b32 s28, s17, 11
  s_add_u32 s42, s28, 131072
  s_add_u32 s44, s28, 141312
  s_lshl_b32 s29, s29, 10
  s_add_u32 s43, s29, 139264
  s_lshl_b32 s30, s16, 22
  s_add_u32 s30, s30, 67108864
  s_add_u32 s47, s30, s29
  s_add_u32 s47, s47, 1404928
  s_add_u32 s48, s30, s28
  s_add_u32 s48, s48, 1396736
  s_mul_i32 s49, s17, 10240
  s_lshl_b32 s28, s24, 11
  s_add_u32 s49, s49, s28
  s_add_u32 s49, s49, s30
  s_add_u32 s49, s49, 1343488
  s_mul_i32 s50, s17, 12288
  s_add_u32 s50, s50, s30
  s_add_u32 s50, s50, 98304
  s_mov_b32 s32, s50
  s_mul_i32 s51, s17, 40960
  s_lshl_b32 s28, s24, 13
  s_add_u32 s51, s51, s28
  s_add_u32 s51, s51, s30
  s_add_u32 s51, s51, 1179648
  v_and_b32 v206, 15, v1
  v_mul_u32_u24 v206, 1280, v206
  v_lshrrev_b32 v207, 4, v1
  v_lshl_add_u32 v198, v207, 4, v206
  s_lshl_b32 s28, s16, 8
  v_lshl_add_u32 v201, v1, 2, s28
  v_add_u32 v202, 16384, v201
  s_mul_i32 s29, s17, 12
  s_add_u32 s29, s29, 96
  v_add_u32 v201, s29, v201
  s_lshl_b32 s29, s35, 2
  s_add_u32 s28, s28, s29
  s_add_u32 s28, s28, 144
  v_mov_b32 v199, s28
  s_lshl_b32 s28, s16, 7
  s_add_u32 s28, s28, s29
  s_add_u32 s40, s28, 2162688
  s_add_u32 s28, s28, 2293760
  v_mov_b32 v200, s28
  s_mul_i32 s39, s16, 40960
  s_lshl_b32 s28, s35, 6
  s_add_u32 s39, s39, s28
  s_add_u32 s39, s39, 226492416
  s_mov_b32 s26, 0
  s_mov_b32 s34, 1
  s_mov_b32 s27, 0
pw_10:
  buffer_load_dword v203, v201, s[8:11], 0 offen sc1
  s_add_u32 s27, s27, 1
  s_cmp_gt_u32 s27, 65536
  s_cbranch_scc1 role_abort
  s_waitcnt vmcnt(0)
pc_12:
  v_cmp_gt_u32 vcc, s34, v203
  s_nop 0
  s_and_b32 vcc_lo, vcc_lo, 0x7
  s_and_b32 vcc_hi, vcc_hi, 0x0
  s_cmp_eq_u64 vcc, 0
  s_cbranch_scc1 po_11
  s_sleep 4
  s_branch pw_10
po_11:
  s_add_u32 s45, s32, 4096
  s_add_u32 s46, s32, 8192
  buffer_load_dwordx4 v[4:7], v196, s[8:11], s32 offen offset:0 sc1
  buffer_load_dwordx4 v[8:11], v196, s[8:11], s32 offen offset:1024 sc1
  buffer_load_dwordx4 v[12:15], v196, s[8:11], s32 offen offset:2048 sc1
  buffer_load_dwordx4 v[16:19], v196, s[8:11], s32 offen offset:3072 sc1
  buffer_load_dwordx4 v[20:23], v196, s[8:11], s45 offen offset:0 sc1
  buffer_load_dwordx4 v[24:27], v196, s[8:11], s45 offen offset:1024 sc1
  buffer_load_dwordx4 v[28:31], v196, s[8:11], s45 offen offset:2048 sc1
  buffer_load_dwordx4 v[32:35], v196, s[8:11], s45 offen offset:3072 sc1
  buffer_load_dwordx4 v[36:39], v196, s[8:11], s46 offen offset:0 sc1
  buffer_load_dwordx4 v[40:43], v196, s[8:11], s46 offen offset:1024 sc1
  buffer_load_dwordx4 v[44:47], v196, s[8:11], s46 offen offset:2048 sc1
  buffer_load_dwordx4 v[48:51], v196, s[8:11], s46 offen offset:3072 sc1
ua_loop0:
  s_and_b32 s41, s26, 3
  s_mul_i32 s28, s41, 227328
  s_add_u32 s38, s47, s28
  s_add_u32 s36, s48, s28
  s_add_u32 s37, s49, s28
  s_add_u32 s33, s51, s28
  s_lshl_b32 s41, s41, 15
  v_add_u32 v210, s41, v214
  v_add_u32 v211, s41, v215
  v_add_u32 v212, s41, v216
  v_add_u32 v213, s41, v217
  s_cmp_ge_u32 s26, 4
  s_cbranch_scc1 ua_ao0
  s_waitcnt vmcnt(0)
  s_branch ua_u0
ua_ao0:
  s_sub_u32 s34, s26, 3
  ds_read_b128 v[92:95], v210 offset:0
  ds_read_b128 v[96:99], v211 offset:0
  ds_read_b128 v[100:103], v210 offset:8192
  ds_read_b128 v[104:107], v211 offset:8192
  ds_read_b128 v[108:111], v210 offset:16384
  ds_read_b128 v[112:115], v211 offset:16384
  ds_read_b128 v[116:119], v210 offset:24576
  ds_read_b128 v[120:123], v211 offset:24576
  s_mov_b32 s27, 0
pw_13:
  buffer_load_dword v204, v202, s[8:11], 0 offen sc1
  s_add_u32 s27, s27, 1
  s_cmp_gt_u32 s27, 65536
  s_cbranch_scc1 role_abort
  s_waitcnt vmcnt(0)
pc_15:
  v_cmp_gt_u32 vcc, s34, v204
  s_nop 0
  s_and_b32 vcc_lo, vcc_lo, 0xff
  s_and_b32 vcc_hi, vcc_hi, 0x0
  s_cmp_eq_u64 vcc, 0
  s_cbranch_scc1 po_14
  s_sleep 2
  s_branch pw_13
po_14:
  s_mov_b32 m0, s42
  v_mov_b32 v200, s40
  buffer_load_dwordx4 v196, s[8:11], s36 offen sc1 lds
  buffer_load_dwordx4 v196, s[8:11], s36 offen offset:1024 sc1 lds
  s_mov_b32 m0, s44
  s_nop 0
  buffer_load_dwordx4 v196, s[8:11], s37 offen sc1 lds
  buffer_load_dwordx4 v196, s[8:11], s37 offen offset:1024 sc1 lds
  s_mov_b32 m0, s43
  s_nop 0
  buffer_load_dwordx4 v196, s[8:11], s38 offen sc1 lds
  s_add_u32 s40, s40, 1024
  s_add_u32 s28, s39, 20480
  s_waitcnt vmcnt(0) lgkmcnt(0)
  s_barrier
  ds_read_b128 v[124:127], v205 offset:0
  ds_read_b128 v[128:131], v205 offset:1024
  ds_read_b128 v[132:135], v205 offset:2048
  ds_read_b128 v[136:139], v205 offset:3072
  ds_read_b128 v[140:143], v205 offset:4096
  ds_read_b128 v[144:147], v205 offset:5120
  ds_read_b128 v[148:151], v205 offset:6144
  ds_read_b128 v[152:155], v205 offset:7168
  s_waitcnt lgkmcnt(6)
  v_mfma_f32_16x16x32_bf16 v[172:175], v[92:95], v[124:127], 0
  ds_read_b128 v[164:167], v205 offset:8192
  v_mfma_f32_16x16x32_bf16 v[176:179], v[96:99], v[124:127], 0
  ds_read_b128 v[168:171], v205 offset:9216
  v_mfma_f32_16x16x32_bf16 v[180:183], v[92:95], v[128:131], 0
  ds_read_b32 v156, v197 offset:0
  v_mfma_f32_16x16x32_bf16 v[184:187], v[96:99], v[128:131], 0
  ds_read_b32 v157, v197 offset:2048
  s_waitcnt lgkmcnt(8)
  v_mfma_f32_16x16x32_bf16 v[172:175], v[100:103], v[132:135], v[172:175]
  ds_read_b32 v158, v197 offset:4096
  v_mfma_f32_16x16x32_bf16 v[176:179], v[104:107], v[132:135], v[176:179]
  ds_read_b32 v159, v197 offset:6144
  v_mfma_f32_16x16x32_bf16 v[180:183], v[100:103], v[136:139], v[180:183]
  ds_read_b32 v160, v197 offset:64
  v_mfma_f32_16x16x32_bf16 v[184:187], v[104:107], v[136:139], v[184:187]
  ds_read_b32 v161, v197 offset:2112
  s_waitcnt lgkmcnt(10)
  v_mfma_f32_16x16x32_bf16 v[172:175], v[108:111], v[140:143], v[172:175]
  ds_read_b32 v162, v197 offset:4160
  v_mfma_f32_16x16x32_bf16 v[176:179], v[112:115], v[140:143], v[176:179]
  ds_read_b32 v163, v197 offset:6208
  v_mfma_f32_16x16x32_bf16 v[180:183], v[108:111], v[144:147], v[180:183]
  v_mfma_f32_16x16x32_bf16 v[184:187], v[112:115], v[144:147], v[184:187]
  s_waitcnt lgkmcnt(10)
  v_mfma_f32_16x16x32_bf16 v[172:175], v[116:119], v[148:151], v[172:175]
  v_mfma_f32_16x16x32_bf16 v[176:179], v[120:123], v[148:151], v[176:179]
  v_mfma_f32_16x16x32_bf16 v[180:183], v[116:119], v[152:155], v[180:183]
  v_mfma_f32_16x16x32_bf16 v[184:187], v[120:123], v[152:155], v[184:187]
  s_waitcnt lgkmcnt(0)
  v_mfma_f32_16x16x32_bf16 v[172:175], v[156:159], v[164:167], v[172:175]
  v_mfma_f32_16x16x32_bf16 v[176:179], v[160:163], v[164:167], v[176:179]
  v_mfma_f32_16x16x32_bf16 v[180:183], v[156:159], v[168:171], v[180:183]
  v_mfma_f32_16x16x32_bf16 v[184:187], v[160:163], v[168:171], v[184:187]
  s_barrier
  s_nop 3
  v_cvt_pk_bf16_f32 v188, v172, v173
  v_cvt_pk_bf16_f32 v189, v174, v175
  v_cvt_pk_bf16_f32 v190, v176, v177
  v_cvt_pk_bf16_f32 v191, v178, v179
  buffer_store_dwordx4 v[188:191], v198, s[8:11], s39 offen sc1
  v_cvt_pk_bf16_f32 v192, v180, v181
  v_cvt_pk_bf16_f32 v193, v182, v183
  v_cvt_pk_bf16_f32 v194, v184, v185
  v_cvt_pk_bf16_f32 v195, v186, v187
  buffer_store_dwordx4 v[192:195], v198, s[8:11], s28 offen sc1
  s_add_u32 s39, s39, 327680
  s_cmp_lt_u32 s26, 64
  s_cbranch_scc1 ua_u0
  s_waitcnt vmcnt(0)
  s_mov_b64 exec, 1
  buffer_store_dword v208, v200, s[8:11], 0 offen sc1
  s_mov_b64 exec, -1
  s_add_u32 s26, s26, 1
  s_cmp_ge_u32 s26, 68
  s_cbranch_scc1 ua_end
  s_branch ua_loop0
ua_u0:
  s_add_u32 s34, s26, 2
  s_min_u32 s34, s34, 64
  s_mov_b32 s27, 0
  s_branch pc_18
pw_16:
  buffer_load_dword v203, v201, s[8:11], 0 offen sc1
  s_add_u32 s27, s27, 1
  s_cmp_gt_u32 s27, 65536
  s_cbranch_scc1 role_abort
  s_waitcnt vmcnt(0)
pc_18:
  v_cmp_gt_u32 vcc, s34, v203
  s_nop 0
  s_and_b32 vcc_lo, vcc_lo, 0x7
  s_and_b32 vcc_hi, vcc_hi, 0x0
  s_cmp_eq_u64 vcc, 0
  s_cbranch_scc1 po_17
  s_sleep 4
  s_branch pw_16
po_17:
  s_add_u32 s26, s26, 1
  s_and_b32 s28, s26, 7
  s_mul_i32 s28, s28, 147456
  s_add_u32 s32, s50, s28
  v_mov_b32 v208, s26
  s_add_u32 s30, s33, 4096
  s_add_u32 s45, s32, 4096
  s_add_u32 s46, s32, 8192
  v_mfma_f32_16x16x32_bf16 v[52:55], v[4:7], a[0:3], 0
  v_mfma_f32_16x16x32_bf16 v[56:59], v[28:31], a[0:3], 0
  v_mfma_f32_16x16x32_bf16 v[60:63], v[4:7], a[24:27], 0
  v_mfma_f32_16x16x32_bf16 v[64:67], v[28:31], a[24:27], 0
  buffer_load_dwordx4 a[192:195], v196, s[8:11], s32 offen offset:0 sc1
  v_mfma_f32_16x16x32_bf16 v[52:55], v[8:11], a[4:7], v[52:55]
  v_mfma_f32_16x16x32_bf16 v[56:59], v[32:35], a[4:7], v[56:59]
  v_mfma_f32_16x16x32_bf16 v[60:63], v[8:11], a[28:31], v[60:63]
  v_mfma_f32_16x16x32_bf16 v[64:67], v[32:35], a[28:31], v[64:67]
  buffer_load_dwordx4 a[196:199], v196, s[8:11], s32 offen offset:1024 sc1
  v_mfma_f32_16x16x32_bf16 v[52:55], v[12:15], a[8:11], v[52:55]
  v_mfma_f32_16x16x32_bf16 v[56:59], v[36:39], a[8:11], v[56:59]
  v_mfma_f32_16x16x32_bf16 v[60:63], v[12:15], a[32:35], v[60:63]
  v_mfma_f32_16x16x32_bf16 v[64:67], v[36:39], a[32:35], v[64:67]
  buffer_load_dwordx4 a[200:203], v196, s[8:11], s32 offen offset:2048 sc1
  v_mfma_f32_16x16x32_bf16 v[52:55], v[16:19], a[12:15], v[52:55]
  v_mfma_f32_16x16x32_bf16 v[56:59], v[40:43], a[12:15], v[56:59]
  v_mfma_f32_16x16x32_bf16 v[60:63], v[16:19], a[36:39], v[60:63]
  v_mfma_f32_16x16x32_bf16 v[64:67], v[40:43], a[36:39], v[64:67]
  buffer_load_dwordx4 a[204:207], v196, s[8:11], s32 offen offset:3072 sc1
  v_mfma_f32_16x16x32_bf16 v[52:55], v[20:23], a[16:19], v[52:55]
  v_mfma_f32_16x16x32_bf16 v[56:59], v[44:47], a[16:19], v[56:59]
  v_mfma_f32_16x16x32_bf16 v[60:63], v[20:23], a[40:43], v[60:63]
  v_mfma_f32_16x16x32_bf16 v[64:67], v[44:47], a[40:43], v[64:67]
  buffer_load_dwordx4 a[208:211], v196, s[8:11], s45 offen offset:0 sc1
  v_mfma_f32_16x16x32_bf16 v[52:55], v[24:27], a[20:23], v[52:55]
  v_mfma_f32_16x16x32_bf16 v[56:59], v[48:51], a[20:23], v[56:59]
  v_mfma_f32_16x16x32_bf16 v[60:63], v[24:27], a[44:47], v[60:63]
  v_mfma_f32_16x16x32_bf16 v[64:67], v[48:51], a[44:47], v[64:67]
  buffer_load_dwordx4 a[212:215], v196, s[8:11], s45 offen offset:1024 sc1
  v_mfma_f32_16x16x32_bf16 v[68:71], v[4:7], a[48:51], 0
  v_mfma_f32_16x16x32_bf16 v[72:75], v[28:31], a[48:51], 0
  v_mfma_f32_16x16x32_bf16 v[76:79], v[4:7], a[72:75], 0
  v_mfma_f32_16x16x32_bf16 v[80:83], v[28:31], a[72:75], 0
  buffer_load_dwordx4 a[216:219], v196, s[8:11], s45 offen offset:2048 sc1
  v_mfma_f32_16x16x32_bf16 v[68:71], v[8:11], a[52:55], v[68:71]
  v_cvt_pk_bf16_f32 v84, v52, v53
  v_mfma_f32_16x16x32_bf16 v[72:75], v[32:35], a[52:55], v[72:75]
  v_cvt_pk_bf16_f32 v85, v54, v55
  v_mfma_f32_16x16x32_bf16 v[76:79], v[8:11], a[76:79], v[76:79]
  v_cvt_pk_bf16_f32 v86, v56, v57
  v_mfma_f32_16x16x32_bf16 v[80:83], v[32:35], a[76:79], v[80:83]
  buffer_load_dwordx4 a[220:223], v196, s[8:11], s45 offen offset:3072 sc1
  v_mfma_f32_16x16x32_bf16 v[68:71], v[12:15], a[56:59], v[68:71]
  v_cvt_pk_bf16_f32 v87, v58, v59
  v_mfma_f32_16x16x32_bf16 v[72:75], v[36:39], a[56:59], v[72:75]
  buffer_store_dwordx4 v[84:87], v196, s[8:11], s33 offen offset:0
  v_mfma_f32_16x16x32_bf16 v[76:79], v[12:15], a[80:83], v[76:79]
  ds_write_b128 v212, v[84:87] offset:0
  v_mfma_f32_16x16x32_bf16 v[80:83], v[36:39], a[80:83], v[80:83]
  buffer_load_dwordx4 a[224:227], v196, s[8:11], s46 offen offset:0 sc1
  v_mfma_f32_16x16x32_bf16 v[68:71], v[16:19], a[60:63], v[68:71]
  v_cvt_pk_bf16_f32 v88, v60, v61
  v_mfma_f32_16x16x32_bf16 v[72:75], v[40:43], a[60:63], v[72:75]
  v_cvt_pk_bf16_f32 v89, v62, v63
  v_mfma_f32_16x16x32_bf16 v[76:79], v[16:19], a[84:87], v[76:79]
  v_cvt_pk_bf16_f32 v90, v64, v65
  v_mfma_f32_16x16x32_bf16 v[80:83], v[40:43], a[84:87], v[80:83]
  buffer_load_dwordx4 a[228:231], v196, s[8:11], s46 offen offset:1024 sc1
  v_mfma_f32_16x16x32_bf16 v[68:71], v[20:23], a[64:67], v[68:71]
  v_cvt_pk_bf16_f32 v91, v66, v67
  v_mfma_f32_16x16x32_bf16 v[72:75], v[44:47], a[64:67], v[72:75]
  buffer_store_dwordx4 v[88:91], v196, s[8:11], s33 offen offset:1024
  v_mfma_f32_16x16x32_bf16 v[76:79], v[20:23], a[88:91], v[76:79]
  ds_write_b128 v213, v[88:91] offset:1024
  v_mfma_f32_16x16x32_bf16 v[80:83], v[44:47], a[88:91], v[80:83]
  buffer_load_dwordx4 a[232:235], v196, s[8:11], s46 offen offset:2048 sc1
  v_mfma_f32_16x16x32_bf16 v[68:71], v[24:27], a[68:71], v[68:71]
  v_mfma_f32_16x16x32_bf16 v[72:75], v[48:51], a[68:71], v[72:75]
  v_mfma_f32_16x16x32_bf16 v[76:79], v[24:27], a[92:95], v[76:79]
  v_mfma_f32_16x16x32_bf16 v[80:83], v[48:51], a[92:95], v[80:83]
  buffer_load_dwordx4 a[236:239], v196, s[8:11], s46 offen offset:3072 sc1
  s_waitcnt vmcnt(14)
  s_mov_b64 exec, 1
  buffer_store_dword v208, v200, s[8:11], 0 offen sc1
  s_mov_b64 exec, -1
  v_mfma_f32_16x16x32_bf16 v[52:55], v[4:7], a[96:99], 0
  v_mfma_f32_16x16x32_bf16 v[56:59], v[28:31], a[96:99], 0
  v_mfma_f32_16x16x32_bf16 v[60:63], v[4:7], a[120:123], 0
  v_mfma_f32_16x16x32_bf16 v[64:67], v[28:31], a[120:123], 0
  v_mfma_f32_16x16x32_bf16 v[52:55], v[8:11], a[100:103], v[52:55]
  v_cvt_pk_bf16_f32 v84, v68, v69
  v_mfma_f32_16x16x32_bf16 v[56:59], v[32:35], a[100:103], v[56:59]
  v_cvt_pk_bf16_f32 v85, v70, v71
  v_mfma_f32_16x16x32_bf16 v[60:63], v[8:11], a[124:127], v[60:63]
  v_cvt_pk_bf16_f32 v86, v72, v73
  v_mfma_f32_16x16x32_bf16 v[64:67], v[32:35], a[124:127], v[64:67]
  v_cvt_pk_bf16_f32 v87, v74, v75
  v_mfma_f32_16x16x32_bf16 v[52:55], v[12:15], a[104:107], v[52:55]
  buffer_store_dwordx4 v[84:87], v196, s[8:11], s33 offen offset:2048
  v_mfma_f32_16x16x32_bf16 v[56:59], v[36:39], a[104:107], v[56:59]
  ds_write_b128 v212, v[84:87] offset:2048
  v_mfma_f32_16x16x32_bf16 v[60:63], v[12:15], a[128:131], v[60:63]
  v_cvt_pk_bf16_f32 v88, v76, v77
  v_mfma_f32_16x16x32_bf16 v[64:67], v[36:39], a[128:131], v[64:67]
  v_cvt_pk_bf16_f32 v89, v78, v79
  v_mfma_f32_16x16x32_bf16 v[52:55], v[16:19], a[108:111], v[52:55]
  v_cvt_pk_bf16_f32 v90, v80, v81
  v_mfma_f32_16x16x32_bf16 v[56:59], v[40:43], a[108:111], v[56:59]
  v_cvt_pk_bf16_f32 v91, v82, v83
  v_mfma_f32_16x16x32_bf16 v[60:63], v[16:19], a[132:135], v[60:63]
  buffer_store_dwordx4 v[88:91], v196, s[8:11], s33 offen offset:3072
  v_mfma_f32_16x16x32_bf16 v[64:67], v[40:43], a[132:135], v[64:67]
  ds_write_b128 v213, v[88:91] offset:3072
  v_mfma_f32_16x16x32_bf16 v[52:55], v[20:23], a[112:115], v[52:55]
  v_mfma_f32_16x16x32_bf16 v[56:59], v[44:47], a[112:115], v[56:59]
  v_mfma_f32_16x16x32_bf16 v[60:63], v[20:23], a[136:139], v[60:63]
  v_mfma_f32_16x16x32_bf16 v[64:67], v[44:47], a[136:139], v[64:67]
  v_mfma_f32_16x16x32_bf16 v[52:55], v[24:27], a[116:119], v[52:55]
  v_mfma_f32_16x16x32_bf16 v[56:59], v[48:51], a[116:119], v[56:59]
  v_mfma_f32_16x16x32_bf16 v[60:63], v[24:27], a[140:143], v[60:63]
  v_mfma_f32_16x16x32_bf16 v[64:67], v[48:51], a[140:143], v[64:67]
  v_mfma_f32_16x16x32_bf16 v[68:71], v[4:7], a[144:147], 0
  v_mfma_f32_16x16x32_bf16 v[72:75], v[28:31], a[144:147], 0
  v_mfma_f32_16x16x32_bf16 v[76:79], v[4:7], a[168:171], 0
  v_mfma_f32_16x16x32_bf16 v[80:83], v[28:31], a[168:171], 0
  v_mfma_f32_16x16x32_bf16 v[68:71], v[8:11], a[148:151], v[68:71]
  v_cvt_pk_bf16_f32 v84, v52, v53
  v_mfma_f32_16x16x32_bf16 v[72:75], v[32:35], a[148:151], v[72:75]
  v_cvt_pk_bf16_f32 v85, v54, v55
  v_mfma_f32_16x16x32_bf16 v[76:79], v[8:11], a[172:175], v[76:79]
  v_cvt_pk_bf16_f32 v86, v56, v57
  v_mfma_f32_16x16x32_bf16 v[80:83], v[32:35], a[172:175], v[80:83]
  v_cvt_pk_bf16_f32 v87, v58, v59
  v_mfma_f32_16x16x32_bf16 v[68:71], v[12:15], a[152:155], v[68:71]
  buffer_store_dwordx4 v[84:87], v196, s[8:11], s30 offen offset:0
  v_mfma_f32_16x16x32_bf16 v[72:75], v[36:39], a[152:155], v[72:75]
  ds_write_b128 v212, v[84:87] offset:4096
  v_mfma_f32_16x16x32_bf16 v[76:79], v[12:15], a[176:179], v[76:79]
  v_cvt_pk_bf16_f32 v88, v60, v61
  v_mfma_f32_16x16x32_bf16 v[80:83], v[36:39], a[176:179], v[80:83]
  v_cvt_pk_bf16_f32 v89, v62, v63
  v_mfma_f32_16x16x32_bf16 v[68:71], v[16:19], a[156:159], v[68:71]
  v_cvt_pk_bf16_f32 v90, v64, v65
  v_mfma_f32_16x16x32_bf16 v[72:75], v[40:43], a[156:159], v[72:75]
  v_cvt_pk_bf16_f32 v91, v66, v67
  v_mfma_f32_16x16x32_bf16 v[76:79], v[16:19], a[180:183], v[76:79]
  buffer_store_dwordx4 v[88:91], v196, s[8:11], s30 offen offset:1024
  v_mfma_f32_16x16x32_bf16 v[80:83], v[40:43], a[180:183], v[80:83]
  ds_write_b128 v213, v[88:91] offset:5120
  v_mfma_f32_16x16x32_bf16 v[68:71], v[20:23], a[160:163], v[68:71]
  v_mfma_f32_16x16x32_bf16 v[72:75], v[44:47], a[160:163], v[72:75]
  v_mfma_f32_16x16x32_bf16 v[76:79], v[20:23], a[184:187], v[76:79]
  v_mfma_f32_16x16x32_bf16 v[80:83], v[44:47], a[184:187], v[80:83]
  v_mfma_f32_16x16x32_bf16 v[68:71], v[24:27], a[164:167], v[68:71]
  v_mfma_f32_16x16x32_bf16 v[72:75], v[48:51], a[164:167], v[72:75]
  v_mfma_f32_16x16x32_bf16 v[76:79], v[24:27], a[188:191], v[76:79]
  v_mfma_f32_16x16x32_bf16 v[80:83], v[48:51], a[188:191], v[80:83]
  s_nop 4
  v_cvt_pk_bf16_f32 v84, v68, v69
  v_cvt_pk_bf16_f32 v85, v70, v71
  v_cvt_pk_bf16_f32 v86, v72, v73
  v_cvt_pk_bf16_f32 v87, v74, v75
  buffer_store_dwordx4 v[84:87], v196, s[8:11], s30 offen offset:2048
  ds_write_b128 v212, v[84:87] offset:6144
  v_cvt_pk_bf16_f32 v88, v76, v77
  v_cvt_pk_bf16_f32 v89, v78, v79
  v_cvt_pk_bf16_f32 v90, v80, v81
  v_cvt_pk_bf16_f32 v91, v82, v83
  buffer_store_dwordx4 v[88:91], v196, s[8:11], s30 offen offset:3072
  ds_write_b128 v213, v[88:91] offset:7168
  buffer_load_dword v203, v201, s[8:11], 0 offen sc1
  s_waitcnt vmcnt(0) lgkmcnt(0)
  buffer_store_dword v208, v199, s[8:11], 0 offen
  s_cmp_eq_u32 s26, 4
  s_cbranch_scc0 ua_nb0
  s_barrier
ua_nb0:
ua_loop1:
  s_and_b32 s41, s26, 3
  s_mul_i32 s28, s41, 227328
  s_add_u32 s38, s47, s28
  s_add_u32 s36, s48, s28
  s_add_u32 s37, s49, s28
  s_add_u32 s33, s51, s28
  s_lshl_b32 s41, s41, 15
  v_add_u32 v210, s41, v214
  v_add_u32 v211, s41, v215
  v_add_u32 v212, s41, v216
  v_add_u32 v213, s41, v217
  s_cmp_ge_u32 s26, 4
  s_cbranch_scc1 ua_ao1
  s_waitcnt vmcnt(0)
  s_branch ua_u1
ua_ao1:
  s_sub_u32 s34, s26, 3
  ds_read_b128 v[92:95], v210 offset:0
  ds_read_b128 v[96:99], v211 offset:0
  ds_read_b128 v[100:103], v210 offset:8192
  ds_read_b128 v[104:107], v211 offset:8192
  ds_read_b128 v[108:111], v210 offset:16384
  ds_read_b128 v[112:115], v211 offset:16384
  ds_read_b128 v[116:119], v210 offset:24576
  ds_read_b128 v[120:123], v211 offset:24576
  s_mov_b32 s27, 0
pw_19:
  buffer_load_dword v204, v202, s[8:11], 0 offen sc1
  s_add_u32 s27, s27, 1
  s_cmp_gt_u32 s27, 65536
  s_cbranch_scc1 role_abort
  s_waitcnt vmcnt(0)
pc_21:
  v_cmp_gt_u32 vcc, s34, v204
  s_nop 0
  s_and_b32 vcc_lo, vcc_lo, 0xff
  s_and_b32 vcc_hi, vcc_hi, 0x0
  s_cmp_eq_u64 vcc, 0
  s_cbranch_scc1 po_20
  s_sleep 2
  s_branch pw_19
po_20:
  s_mov_b32 m0, s42
  v_mov_b32 v200, s40
  buffer_load_dwordx4 v196, s[8:11], s36 offen sc1 lds
  buffer_load_dwordx4 v196, s[8:11], s36 offen offset:1024 sc1 lds
  s_mov_b32 m0, s44
  s_nop 0
  buffer_load_dwordx4 v196, s[8:11], s37 offen sc1 lds
  buffer_load_dwordx4 v196, s[8:11], s37 offen offset:1024 sc1 lds
  s_mov_b32 m0, s43
  s_nop 0
  buffer_load_dwordx4 v196, s[8:11], s38 offen sc1 lds
  s_add_u32 s40, s40, 1024
  s_add_u32 s28, s39, 20480
  s_waitcnt vmcnt(0) lgkmcnt(0)
  s_barrier
  ds_read_b128 v[124:127], v205 offset:0
  ds_read_b128 v[128:131], v205 offset:1024
  ds_read_b128 v[132:135], v205 offset:2048
  ds_read_b128 v[136:139], v205 offset:3072
  ds_read_b128 v[140:143], v205 offset:4096
  ds_read_b128 v[144:147], v205 offset:5120
  ds_read_b128 v[148:151], v205 offset:6144
  ds_read_b128 v[152:155], v205 offset:7168
  s_waitcnt lgkmcnt(6)
  v_mfma_f32_16x16x32_bf16 v[172:175], v[92:95], v[124:127], 0
  ds_read_b128 v[164:167], v205 offset:8192
  v_mfma_f32_16x16x32_bf16 v[176:179], v[96:99], v[124:127], 0
  ds_read_b128 v[168:171], v205 offset:9216
  v_mfma_f32_16x16x32_bf16 v[180:183], v[92:95], v[128:131], 0
  ds_read_b32 v156, v197 offset:0
  v_mfma_f32_16x16x32_bf16 v[184:187], v[96:99], v[128:131], 0
  ds_read_b32 v157, v197 offset:2048
  s_waitcnt lgkmcnt(8)
  v_mfma_f32_16x16x32_bf16 v[172:175], v[100:103], v[132:135], v[172:175]
  ds_read_b32 v158, v197 offset:4096
  v_mfma_f32_16x16x32_bf16 v[176:179], v[104:107], v[132:135], v[176:179]
  ds_read_b32 v159, v197 offset:6144
  v_mfma_f32_16x16x32_bf16 v[180:183], v[100:103], v[136:139], v[180:183]
  ds_read_b32 v160, v197 offset:64
  v_mfma_f32_16x16x32_bf16 v[184:187], v[104:107], v[136:139], v[184:187]
  ds_read_b32 v161, v197 offset:2112
  s_waitcnt lgkmcnt(10)
  v_mfma_f32_16x16x32_bf16 v[172:175], v[108:111], v[140:143], v[172:175]
  ds_read_b32 v162, v197 offset:4160
  v_mfma_f32_16x16x32_bf16 v[176:179], v[112:115], v[140:143], v[176:179]
  ds_read_b32 v163, v197 offset:6208
  v_mfma_f32_16x16x32_bf16 v[180:183], v[108:111], v[144:147], v[180:183]
  v_mfma_f32_16x16x32_bf16 v[184:187], v[112:115], v[144:147], v[184:187]
  s_waitcnt lgkmcnt(10)
  v_mfma_f32_16x16x32_bf16 v[172:175], v[116:119], v[148:151], v[172:175]
  v_mfma_f32_16x16x32_bf16 v[176:179], v[120:123], v[148:151], v[176:179]
  v_mfma_f32_16x16x32_bf16 v[180:183], v[116:119], v[152:155], v[180:183]
  v_mfma_f32_16x16x32_bf16 v[184:187], v[120:123], v[152:155], v[184:187]
  s_waitcnt lgkmcnt(0)
  v_mfma_f32_16x16x32_bf16 v[172:175], v[156:159], v[164:167], v[172:175]
  v_mfma_f32_16x16x32_bf16 v[176:179], v[160:163], v[164:167], v[176:179]
  v_mfma_f32_16x16x32_bf16 v[180:183], v[156:159], v[168:171], v[180:183]
  v_mfma_f32_16x16x32_bf16 v[184:187], v[160:163], v[168:171], v[184:187]
  s_barrier
  s_nop 3
  v_cvt_pk_bf16_f32 v188, v172, v173
  v_cvt_pk_bf16_f32 v189, v174, v175
  v_cvt_pk_bf16_f32 v190, v176, v177
  v_cvt_pk_bf16_f32 v191, v178, v179
  buffer_store_dwordx4 v[188:191], v198, s[8:11], s39 offen sc1
  v_cvt_pk_bf16_f32 v192, v180, v181
  v_cvt_pk_bf16_f32 v193, v182, v183
  v_cvt_pk_bf16_f32 v194, v184, v185
  v_cvt_pk_bf16_f32 v195, v186, v187
  buffer_store_dwordx4 v[192:195], v198, s[8:11], s28 offen sc1
  s_add_u32 s39, s39, 327680
  s_cmp_lt_u32 s26, 64
  s_cbranch_scc1 ua_u1
  s_waitcnt vmcnt(0)
  s_mov_b64 exec, 1
  buffer_store_dword v208, v200, s[8:11], 0 offen sc1
  s_mov_b64 exec, -1
  s_add_u32 s26, s26, 1
  s_cmp_ge_u32 s26, 68
  s_cbranch_scc1 ua_end
  s_branch ua_loop1
ua_u1:
  s_add_u32 s34, s26, 2
  s_min_u32 s34, s34, 64
  s_mov_b32 s27, 0
  s_branch pc_24
pw_22:
  buffer_load_dword v203, v201, s[8:11], 0 offen sc1
  s_add_u32 s27, s27, 1
  s_cmp_gt_u32 s27, 65536
  s_cbranch_scc1 role_abort
  s_waitcnt vmcnt(0)
pc_24:
  v_cmp_gt_u32 vcc, s34, v203
  s_nop 0
  s_and_b32 vcc_lo, vcc_lo, 0x7
  s_and_b32 vcc_hi, vcc_hi, 0x0
  s_cmp_eq_u64 vcc, 0
  s_cbranch_scc1 po_23
  s_sleep 4
  s_branch pw_22
po_23:
  s_add_u32 s26, s26, 1
  s_and_b32 s28, s26, 7
  s_mul_i32 s28, s28, 147456
  s_add_u32 s32, s50, s28
  v_mov_b32 v208, s26
  s_add_u32 s30, s33, 4096
  s_add_u32 s45, s32, 4096
  s_add_u32 s46, s32, 8192
  v_mfma_f32_16x16x32_bf16 v[52:55], a[192:195], a[0:3], 0
  v_mfma_f32_16x16x32_bf16 v[56:59], a[216:219], a[0:3], 0
  v_mfma_f32_16x16x32_bf16 v[60:63], a[192:195], a[24:27], 0
  v_mfma_f32_16x16x32_bf16 v[64:67], a[216:219], a[24:27], 0
  buffer_load_dwordx4 v[4:7], v196, s[8:11], s32 offen offset:0 sc1
  v_mfma_f32_16x16x32_bf16 v[52:55], a[196:199], a[4:7], v[52:55]
  v_mfma_f32_16x16x32_bf16 v[56:59], a[220:223], a[4:7], v[56:59]
  v_mfma_f32_16x16x32_bf16 v[60:63], a[196:199], a[28:31], v[60:63]
  v_mfma_f32_16x16x32_bf16 v[64:67], a[220:223], a[28:31], v[64:67]
  buffer_load_dwordx4 v[8:11], v196, s[8:11], s32 offen offset:1024 sc1
  v_mfma_f32_16x16x32_bf16 v[52:55], a[200:203], a[8:11], v[52:55]
  v_mfma_f32_16x16x32_bf16 v[56:59], a[224:227], a[8:11], v[56:59]
  v_mfma_f32_16x16x32_bf16 v[60:63], a[200:203], a[32:35], v[60:63]
  v_mfma_f32_16x16x32_bf16 v[64:67], a[224:227], a[32:35], v[64:67]
  buffer_load_dwordx4 v[12:15], v196, s[8:11], s32 offen offset:2048 sc1
  v_mfma_f32_16x16x32_bf16 v[52:55], a[204:207], a[12:15], v[52:55]
  v_mfma_f32_16x16x32_bf16 v[56:59], a[228:231], a[12:15], v[56:59]
  v_mfma_f32_16x16x32_bf16 v[60:63], a[204:207], a[36:39], v[60:63]
  v_mfma_f32_16x16x32_bf16 v[64:67], a[228:231], a[36:39], v[64:67]
  buffer_load_dwordx4 v[16:19], v196, s[8:11], s32 offen offset:3072 sc1
  v_mfma_f32_16x16x32_bf16 v[52:55], a[208:211], a[16:19], v[52:55]
  v_mfma_f32_16x16x32_bf16 v[56:59], a[232:235], a[16:19], v[56:59]
  v_mfma_f32_16x16x32_bf16 v[60:63], a[208:211], a[40:43], v[60:63]
  v_mfma_f32_16x16x32_bf16 v[64:67], a[232:235], a[40:43], v[64:67]
  buffer_load_dwordx4 v[20:23], v196, s[8:11], s45 offen offset:0 sc1
  v_mfma_f32_16x16x32_bf16 v[52:55], a[212:215], a[20:23], v[52:55]
  v_mfma_f32_16x16x32_bf16 v[56:59], a[236:239], a[20:23], v[56:59]
  v_mfma_f32_16x16x32_bf16 v[60:63], a[212:215], a[44:47], v[60:63]
  v_mfma_f32_16x16x32_bf16 v[64:67], a[236:239], a[44:47], v[64:67]
  buffer_load_dwordx4 v[24:27], v196, s[8:11], s45 offen offset:1024 sc1
  v_mfma_f32_16x16x32_bf16 v[68:71], a[192:195], a[48:51], 0
  v_mfma_f32_16x16x32_bf16 v[72:75], a[216:219], a[48:51], 0
  v_mfma_f32_16x16x32_bf16 v[76:79], a[192:195], a[72:75], 0
  v_mfma_f32_16x16x32_bf16 v[80:83], a[216:219], a[72:75], 0
  buffer_load_dwordx4 v[28:31], v196, s[8:11], s45 offen offset:2048 sc1
  v_mfma_f32_16x16x32_bf16 v[68:71], a[196:199], a[52:55], v[68:71]
  v_cvt_pk_bf16_f32 v84, v52, v53
  v_mfma_f32_16x16x32_bf16 v[72:75], a[220:223], a[52:55], v[72:75]
  v_cvt_pk_bf16_f32 v85, v54, v55
  v_mfma_f32_16x16x32_bf16 v[76:79], a[196:199], a[76:79], v[76:79]
  v_cvt_pk_bf16_f32 v86, v56, v57
  v_mfma_f32_16x16x32_bf16 v[80:83], a[220:223], a[76:79], v[80:83]
  buffer_load_dwordx4 v[32:35], v196, s[8:11], s45 offen offset:3072 sc1
  v_mfma_f32_16x16x32_bf16 v[68:71], a[200:203], a[56:59], v[68:71]
  v_cvt_pk_bf16_f32 v87, v58, v59
  v_mfma_f32_16x16x32_bf16 v[72:75], a[224:227], a[56:59], v[72:75]
  buffer_store_dwordx4 v[84:87], v196, s[8:11], s33 offen offset:0
  v_mfma_f32_16x16x32_bf16 v[76:79], a[200:203], a[80:83], v[76:79]
  ds_write_b128 v212, v[84:87] offset:0
  v_mfma_f32_16x16x32_bf16 v[80:83], a[224:227], a[80:83], v[80:83]
  buffer_load_dwordx4 v[36:39], v196, s[8:11], s46 offen offset:0 sc1
  v_mfma_f32_16x16x32_bf16 v[68:71], a[204:207], a[60:63], v[68:71]
  v_cvt_pk_bf16_f32 v88, v60, v61
  v_mfma_f32_16x16x32_bf16 v[72:75], a[228:231], a[60:63], v[72:75]
  v_cvt_pk_bf16_f32 v89, v62, v63
  v_mfma_f32_16x16x32_bf16 v[76:79], a[204:207], a[84:87], v[76:79]
  v_cvt_pk_bf16_f32 v90, v64, v65
  v_mfma_f32_16x16x32_bf16 v[80:83], a[228:231], a[84:87], v[80:83]
  buffer_load_dwordx4 v[40:43], v196, s[8:11], s46 offen offset:1024 sc1
  v_mfma_f32_16x16x32_bf16 v[68:71], a[208:211], a[64:67], v[68:71]
  v_cvt_pk_bf16_f32 v91, v66, v67
  v_mfma_f32_16x16x32_bf16 v[72:75], a[232:235], a[64:67], v[72:75]
  buffer_store_dwordx4 v[88:91], v196, s[8:11], s33 offen offset:1024
  v_mfma_f32_16x16x32_bf16 v[76:79], a[208:211], a[88:91], v[76:79]
  ds_write_b128 v213, v[88:91] offset:1024
  v_mfma_f32_16x16x32_bf16 v[80:83], a[232:235], a[88:91], v[80:83]
  buffer_load_dwordx4 v[44:47], v196, s[8:11], s46 offen offset:2048 sc1
  v_mfma_f32_16x16x32_bf16 v[68:71], a[212:215], a[68:71], v[68:71]
  v_mfma_f32_16x16x32_bf16 v[72:75], a[236:239], a[68:71], v[72:75]
  v_mfma_f32_16x16x32_bf16 v[76:79], a[212:215], a[92:95], v[76:79]
  v_mfma_f32_16x16x32_bf16 v[80:83], a[236:239], a[92:95], v[80:83]
  buffer_load_dwordx4 v[48:51], v196, s[8:11], s46 offen offset:3072 sc1
  s_waitcnt vmcnt(14)
  s_mov_b64 exec, 1
  buffer_store_dword v208, v200, s[8:11], 0 offen sc1
  s_mov_b64 exec, -1
  v_mfma_f32_16x16x32_bf16 v[52:55], a[192:195], a[96:99], 0
  v_mfma_f32_16x16x32_bf16 v[56:59], a[216:219], a[96:99], 0
  v_mfma_f32_16x16x32_bf16 v[60:63], a[192:195], a[120:123], 0
  v_mfma_f32_16x16x32_bf16 v[64:67], a[216:219], a[120:123], 0
  v_mfma_f32_16x16x32_bf16 v[52:55], a[196:199], a[100:103], v[52:55]
  v_cvt_pk_bf16_f32 v84, v68, v69
  v_mfma_f32_16x16x32_bf16 v[56:59], a[220:223], a[100:103], v[56:59]
  v_cvt_pk_bf16_f32 v85, v70, v71
  v_mfma_f32_16x16x32_bf16 v[60:63], a[196:199], a[124:127], v[60:63]
  v_cvt_pk_bf16_f32 v86, v72, v73
  v_mfma_f32_16x16x32_bf16 v[64:67], a[220:223], a[124:127], v[64:67]
  v_cvt_pk_bf16_f32 v87, v74, v75
  v_mfma_f32_16x16x32_bf16 v[52:55], a[200:203], a[104:107], v[52:55]
  buffer_store_dwordx4 v[84:87], v196, s[8:11], s33 offen offset:2048
  v_mfma_f32_16x16x32_bf16 v[56:59], a[224:227], a[104:107], v[56:59]
  ds_write_b128 v212, v[84:87] offset:2048
  v_mfma_f32_16x16x32_bf16 v[60:63], a[200:203], a[128:131], v[60:63]
  v_cvt_pk_bf16_f32 v88, v76, v77
  v_mfma_f32_16x16x32_bf16 v[64:67], a[224:227], a[128:131], v[64:67]
  v_cvt_pk_bf16_f32 v89, v78, v79
  v_mfma_f32_16x16x32_bf16 v[52:55], a[204:207], a[108:111], v[52:55]
  v_cvt_pk_bf16_f32 v90, v80, v81
  v_mfma_f32_16x16x32_bf16 v[56:59], a[228:231], a[108:111], v[56:59]
  v_cvt_pk_bf16_f32 v91, v82, v83
  v_mfma_f32_16x16x32_bf16 v[60:63], a[204:207], a[132:135], v[60:63]
  buffer_store_dwordx4 v[88:91], v196, s[8:11], s33 offen offset:3072
  v_mfma_f32_16x16x32_bf16 v[64:67], a[228:231], a[132:135], v[64:67]
  ds_write_b128 v213, v[88:91] offset:3072
  v_mfma_f32_16x16x32_bf16 v[52:55], a[208:211], a[112:115], v[52:55]
  v_mfma_f32_16x16x32_bf16 v[56:59], a[232:235], a[112:115], v[56:59]
  v_mfma_f32_16x16x32_bf16 v[60:63], a[208:211], a[136:139], v[60:63]
  v_mfma_f32_16x16x32_bf16 v[64:67], a[232:235], a[136:139], v[64:67]
  v_mfma_f32_16x16x32_bf16 v[52:55], a[212:215], a[116:119], v[52:55]
  v_mfma_f32_16x16x32_bf16 v[56:59], a[236:239], a[116:119], v[56:59]
  v_mfma_f32_16x16x32_bf16 v[60:63], a[212:215], a[140:143], v[60:63]
  v_mfma_f32_16x16x32_bf16 v[64:67], a[236:239], a[140:143], v[64:67]
  v_mfma_f32_16x16x32_bf16 v[68:71], a[192:195], a[144:147], 0
  v_mfma_f32_16x16x32_bf16 v[72:75], a[216:219], a[144:147], 0
  v_mfma_f32_16x16x32_bf16 v[76:79], a[192:195], a[168:171], 0
  v_mfma_f32_16x16x32_bf16 v[80:83], a[216:219], a[168:171], 0
  v_mfma_f32_16x16x32_bf16 v[68:71], a[196:199], a[148:151], v[68:71]
  v_cvt_pk_bf16_f32 v84, v52, v53
  v_mfma_f32_16x16x32_bf16 v[72:75], a[220:223], a[148:151], v[72:75]
  v_cvt_pk_bf16_f32 v85, v54, v55
  v_mfma_f32_16x16x32_bf16 v[76:79], a[196:199], a[172:175], v[76:79]
  v_cvt_pk_bf16_f32 v86, v56, v57
  v_mfma_f32_16x16x32_bf16 v[80:83], a[220:223], a[172:175], v[80:83]
  v_cvt_pk_bf16_f32 v87, v58, v59
  v_mfma_f32_16x16x32_bf16 v[68:71], a[200:203], a[152:155], v[68:71]
  buffer_store_dwordx4 v[84:87], v196, s[8:11], s30 offen offset:0
  v_mfma_f32_16x16x32_bf16 v[72:75], a[224:227], a[152:155], v[72:75]
  ds_write_b128 v212, v[84:87] offset:4096
  v_mfma_f32_16x16x32_bf16 v[76:79], a[200:203], a[176:179], v[76:79]
  v_cvt_pk_bf16_f32 v88, v60, v61
  v_mfma_f32_16x16x32_bf16 v[80:83], a[224:227], a[176:179], v[80:83]
  v_cvt_pk_bf16_f32 v89, v62, v63
  v_mfma_f32_16x16x32_bf16 v[68:71], a[204:207], a[156:159], v[68:71]
  v_cvt_pk_bf16_f32 v90, v64, v65
  v_mfma_f32_16x16x32_bf16 v[72:75], a[228:231], a[156:159], v[72:75]
  v_cvt_pk_bf16_f32 v91, v66, v67
  v_mfma_f32_16x16x32_bf16 v[76:79], a[204:207], a[180:183], v[76:79]
  buffer_store_dwordx4 v[88:91], v196, s[8:11], s30 offen offset:1024
  v_mfma_f32_16x16x32_bf16 v[80:83], a[228:231], a[180:183], v[80:83]
  ds_write_b128 v213, v[88:91] offset:5120
  v_mfma_f32_16x16x32_bf16 v[68:71], a[208:211], a[160:163], v[68:71]
  v_mfma_f32_16x16x32_bf16 v[72:75], a[232:235], a[160:163], v[72:75]
  v_mfma_f32_16x16x32_bf16 v[76:79], a[208:211], a[184:187], v[76:79]
  v_mfma_f32_16x16x32_bf16 v[80:83], a[232:235], a[184:187], v[80:83]
  v_mfma_f32_16x16x32_bf16 v[68:71], a[212:215], a[164:167], v[68:71]
  v_mfma_f32_16x16x32_bf16 v[72:75], a[236:239], a[164:167], v[72:75]
  v_mfma_f32_16x16x32_bf16 v[76:79], a[212:215], a[188:191], v[76:79]
  v_mfma_f32_16x16x32_bf16 v[80:83], a[236:239], a[188:191], v[80:83]
  s_nop 4
  v_cvt_pk_bf16_f32 v84, v68, v69
  v_cvt_pk_bf16_f32 v85, v70, v71
  v_cvt_pk_bf16_f32 v86, v72, v73
  v_cvt_pk_bf16_f32 v87, v74, v75
  buffer_store_dwordx4 v[84:87], v196, s[8:11], s30 offen offset:2048
  ds_write_b128 v212, v[84:87] offset:6144
  v_cvt_pk_bf16_f32 v88, v76, v77
  v_cvt_pk_bf16_f32 v89, v78, v79
  v_cvt_pk_bf16_f32 v90, v80, v81
  v_cvt_pk_bf16_f32 v91, v82, v83
  buffer_store_dwordx4 v[88:91], v196, s[8:11], s30 offen offset:3072
  ds_write_b128 v213, v[88:91] offset:7168
  buffer_load_dword v203, v201, s[8:11], 0 offen sc1
  s_waitcnt vmcnt(0) lgkmcnt(0)
  buffer_store_dword v208, v199, s[8:11], 0 offen
  s_cmp_eq_u32 s26, 4
  s_cbranch_scc0 ua_nb1
  s_barrier
ua_nb1:
  s_branch ua_loop0
ua_end:
  s_endpgm
role_sm:
  s_sub_u32 s20, s18, 26
  s_lshl_b32 s20, s20, 2
  s_add_u32 s20, s20, s17
  s_lshr_b32 s21, s20, 1
  s_and_b32 s22, s20, 1
  s_lshl_b32 s23, s16, 2
  s_add_u32 s23, s23, s21
  v_lshlrev_b32 v128, 4, v1
  v_bfe_u32 v135, v1, 2, 2
  v_and_b32 v136, 1, v1
  v_lshl_add_u32 v135, v135, 1, v136
  v_lshrrev_b32 v136, 4, v1
  v_lshl_add_u32 v135, v136, 3, v135
  v_lshlrev_b32 v129, 4, v135
  v_and_b32 v135, 15, v1
  s_lshl_b32 s26, s22, 4
  v_add_u32 v135, s26, v135
  v_lshlrev_b32 v136, 2, v136
  v_sub_u32 v135, v135, v136
  v_mov_b32 v136, 0
  v_mov_b32 v137, 0xf149f2ca
  v_cmp_le_i32 vcc, 0, v135
  s_nop 1
  v_cndmask_b32 v112, v137, v136, vcc
  v_cmp_le_i32 vcc, 1, v135
  s_nop 1
  v_cndmask_b32 v113, v137, v136, vcc
  v_cmp_le_i32 vcc, 2, v135
  s_nop 1
  v_cndmask_b32 v114, v137, v136, vcc
  v_cmp_le_i32 vcc, 3, v135
  s_nop 1
  v_cndmask_b32 v115, v137, v136, vcc
  v_cmp_le_i32 vcc, 16, v135
  s_nop 1
  v_cndmask_b32 v116, v137, v136, vcc
  v_cmp_le_i32 vcc, 17, v135
  s_nop 1
  v_cndmask_b32 v117, v137, v136, vcc
  v_cmp_le_i32 vcc, 18, v135
  s_nop 1
  v_cndmask_b32 v118, v137, v136, vcc
  v_cmp_le_i32 vcc, 19, v135
  s_nop 1
  v_cndmask_b32 v119, v137, v136, vcc
  v_mov_b32 v124, 0x3d93cd3a
  v_mov_b32 v125, 0x3d93cd3a
  s_lshl_b32 s26, s16, 8
  v_lshl_add_u32 v130, v1, 2, s26
  v_add_u32 v131, 4096, v130
  s_mul_i32 s27, s21, 12
  v_add_u32 v130, s27, v130
  s_lshl_b32 s27, s20, 2
  s_add_u32 s26, s26, s27
  s_add_u32 s26, s26, 16384
  v_mov_b32 v132, s26
  s_lshl_b32 s28, s16, 22
  s_add_u32 s28, s28, 67108864
  s_mul_i32 s35, s21, 12288
  s_add_u32 s35, s35, s28
  s_mul_i32 s26, s22, 6144
  s_add_u32 s36, s35, s26
  s_add_u32 s35, s35, 49152
  s_mul_i32 s37, s21, 3072
  s_add_u32 s37, s37, s28
  s_add_u32 s37, s37, 1384448
  s_lshl_b32 s26, s22, 10
  s_add_u32 s28, s28, s26
  s_lshl_b32 s38, s21, 11
  s_add_u32 s38, s38, s28
  s_add_u32 s38, s38, 1396736
  s_lshl_b32 s39, s21, 2
  s_add_u32 s39, s39, s28
  s_add_u32 s39, s39, 1404928
  s_mov_b32 s34, 1
  v_mov_b32 v133, 0
sm_loop:
  s_sub_u32 s24, s34, 1
  s_and_b32 s26, s24, 7
  s_mul_i32 s26, s26, 147456
  s_add_u32 s30, s35, s26
  s_add_u32 s29, s36, s26
  s_and_b32 s26, s24, 3
  s_mul_i32 s26, s26, 227328
  s_add_u32 s31, s37, s26
  s_add_u32 s32, s38, s26
  s_add_u32 s33, s39, s26
  s_mov_b32 s25, 0
  s_branch pc_27
pw_25:
  buffer_load_dword v133, v130, s[8:11], 0 offen sc1
  s_add_u32 s25, s25, 1
  s_cmp_gt_u32 s25, 65536
  s_cbranch_scc1 role_abort
  s_waitcnt vmcnt(0)
pc_27:
  v_cmp_gt_u32 vcc, s34, v133
  s_nop 0
  s_and_b32 vcc_lo, vcc_lo, 0x7007
  s_and_b32 vcc_hi, vcc_hi, 0x0
  s_cmp_eq_u64 vcc, 0
  s_cbranch_scc1 po_26
  s_sleep 4
  s_branch pw_25
po_26:
  s_add_u32 s26, s30, 4096
  s_add_u32 s27, s30, 8192
  s_add_u32 s28, s29, 4096
  buffer_load_dwordx4 v[4:7], v128, s[8:11], s29 offen offset:0 sc1
  buffer_load_dwordx4 v[28:31], v128, s[8:11], s30 offen offset:0 sc1
  buffer_load_dwordx4 v[52:55], v128, s[8:11], s26 offen offset:2048 sc1
  buffer_load_dwordx4 v[8:11], v128, s[8:11], s29 offen offset:1024 sc1
  buffer_load_dwordx4 v[32:35], v128, s[8:11], s30 offen offset:1024 sc1
  buffer_load_dwordx4 v[56:59], v128, s[8:11], s26 offen offset:3072 sc1
  buffer_load_dwordx4 v[12:15], v128, s[8:11], s29 offen offset:2048 sc1
  buffer_load_dwordx4 v[36:39], v128, s[8:11], s30 offen offset:2048 sc1
  buffer_load_dwordx4 v[60:63], v128, s[8:11], s27 offen offset:0 sc1
  buffer_load_dwordx4 v[16:19], v128, s[8:11], s29 offen offset:3072 sc1
  buffer_load_dwordx4 v[40:43], v128, s[8:11], s30 offen offset:3072 sc1
  buffer_load_dwordx4 v[64:67], v128, s[8:11], s27 offen offset:1024 sc1
  buffer_load_dwordx4 v[20:23], v128, s[8:11], s28 offen offset:0 sc1
  buffer_load_dwordx4 v[44:47], v128, s[8:11], s26 offen offset:0 sc1
  buffer_load_dwordx4 v[68:71], v128, s[8:11], s27 offen offset:2048 sc1
  buffer_load_dwordx4 v[24:27], v128, s[8:11], s28 offen offset:1024 sc1
  buffer_load_dwordx4 v[48:51], v128, s[8:11], s26 offen offset:1024 sc1
  buffer_load_dwordx4 v[72:75], v128, s[8:11], s27 offen offset:3072 sc1
  buffer_load_dword v133, v130, s[8:11], 0 offen sc1
  s_waitcnt vmcnt(16)
  v_mfma_f32_16x16x32_bf16 v[100:103], v[28:31], v[4:7], 0
  v_mfma_f32_16x16x32_bf16 v[104:107], v[52:55], v[4:7], 0
  s_waitcnt vmcnt(13)
  v_mfma_f32_16x16x32_bf16 v[100:103], v[32:35], v[8:11], v[100:103]
  v_mfma_f32_16x16x32_bf16 v[104:107], v[56:59], v[8:11], v[104:107]
  s_waitcnt vmcnt(10)
  v_mfma_f32_16x16x32_bf16 v[100:103], v[36:39], v[12:15], v[100:103]
  v_mfma_f32_16x16x32_bf16 v[104:107], v[60:63], v[12:15], v[104:107]
  s_waitcnt vmcnt(7)
  v_mfma_f32_16x16x32_bf16 v[100:103], v[40:43], v[16:19], v[100:103]
  v_mfma_f32_16x16x32_bf16 v[104:107], v[64:67], v[16:19], v[104:107]
  s_waitcnt vmcnt(4)
  v_mfma_f32_16x16x32_bf16 v[100:103], v[44:47], v[20:23], v[100:103]
  v_mfma_f32_16x16x32_bf16 v[104:107], v[68:71], v[20:23], v[104:107]
  s_waitcnt vmcnt(1)
  v_mfma_f32_16x16x32_bf16 v[100:103], v[48:51], v[24:27], v[100:103]
  v_mfma_f32_16x16x32_bf16 v[104:107], v[72:75], v[24:27], v[104:107]
  s_nop 6
  v_cvt_pk_bf16_f32 v135, v100, v101
  v_lshlrev_b32 v100, 16, v135
  v_and_b32 v101, 0xffff0000, v135
  v_cvt_pk_bf16_f32 v135, v102, v103
  v_lshlrev_b32 v102, 16, v135
  v_and_b32 v103, 0xffff0000, v135
  v_cvt_pk_bf16_f32 v135, v104, v105
  v_lshlrev_b32 v104, 16, v135
  v_and_b32 v105, 0xffff0000, v135
  v_cvt_pk_bf16_f32 v135, v106, v107
  v_lshlrev_b32 v106, 16, v135
  v_and_b32 v107, 0xffff0000, v135
  v_pk_fma_f32 v[100:101], v[100:101], v[124:125], v[112:113]
  v_cvt_pk_bf16_f32 v135, v100, v101
  v_lshlrev_b32 v100, 16, v135
  v_and_b32 v101, 0xffff0000, v135
  v_pk_fma_f32 v[102:103], v[102:103], v[124:125], v[114:115]
  v_cvt_pk_bf16_f32 v135, v102, v103
  v_lshlrev_b32 v102, 16, v135
  v_and_b32 v103, 0xffff0000, v135
  v_pk_fma_f32 v[104:105], v[104:105], v[124:125], v[116:117]
  v_cvt_pk_bf16_f32 v135, v104, v105
  v_lshlrev_b32 v104, 16, v135
  v_and_b32 v105, 0xffff0000, v135
  v_pk_fma_f32 v[106:107], v[106:107], v[124:125], v[118:119]
  v_cvt_pk_bf16_f32 v135, v106, v107
  v_lshlrev_b32 v106, 16, v135
  v_and_b32 v107, 0xffff0000, v135
  v_max3_f32 v137, v100, v101, v102
  v_max3_f32 v137, v137, v103, v104
  v_max3_f32 v137, v137, v105, v106
  v_max_f32 v137, v137, v107
  s_mov_b32 s25, 0
pw_28:
  buffer_load_dword v134, v131, s[8:11], 0 offen sc1
  s_add_u32 s25, s25, 1
  s_cmp_gt_u32 s25, 65536
  s_cbranch_scc1 role_abort
  s_waitcnt vmcnt(0)
pc_30:
  v_cmp_gt_u32 vcc, s34, v134
  s_nop 0
  s_and_b32 vcc_lo, vcc_lo, 0xffffffff
  s_and_b32 vcc_hi, vcc_hi, 0xffff
  s_cmp_eq_u64 vcc, 0
  s_cbranch_scc1 po_29
  s_sleep 2
  s_branch pw_28
po_29:
  buffer_load_dwordx4 v[76:79], v129, s[8:11], s31 offen offset:0 sc1
  buffer_load_dwordx4 v[80:83], v129, s[8:11], s31 offen offset:512 sc1
  buffer_load_dwordx4 v[84:87], v129, s[8:11], s31 offen offset:1024 sc1
  buffer_load_dwordx4 v[88:91], v129, s[8:11], s31 offen offset:1536 sc1
  buffer_load_dwordx4 v[92:95], v129, s[8:11], s31 offen offset:2048 sc1
  buffer_load_dwordx4 v[96:99], v129, s[8:11], s31 offen offset:2560 sc1
  s_waitcnt vmcnt(5)
  v_mfma_f32_16x16x32_bf16 v[108:111], v[76:79], v[4:7], 0
  s_waitcnt vmcnt(4)
  v_mfma_f32_16x16x32_bf16 v[108:111], v[80:83], v[8:11], v[108:111]
  s_waitcnt vmcnt(3)
  v_mfma_f32_16x16x32_bf16 v[108:111], v[84:87], v[12:15], v[108:111]
  s_waitcnt vmcnt(2)
  v_mfma_f32_16x16x32_bf16 v[108:111], v[88:91], v[16:19], v[108:111]
  s_waitcnt vmcnt(1)
  v_mfma_f32_16x16x32_bf16 v[108:111], v[92:95], v[20:23], v[108:111]
  s_waitcnt vmcnt(0)
  v_mfma_f32_16x16x32_bf16 v[108:111], v[96:99], v[24:27], v[108:111]
  s_nop 7
  v_cvt_pk_bf16_f32 v135, v108, v109
  v_lshlrev_b32 v108, 16, v135
  v_and_b32 v109, 0xffff0000, v135
  v_pk_mul_f32 v[108:109], v[108:109], v[124:125]
  v_cvt_pk_bf16_f32 v135, v108, v109
  v_lshlrev_b32 v108, 16, v135
  v_and_b32 v109, 0xffff0000, v135
  v_max3_f32 v137, v137, v108, v109
  v_mov_b32 v136, v137
  s_nop 1
  v_permlane16_swap_b32 v137, v136
  v_max_f32 v137, v137, v136
  v_mov_b32 v136, v137
  s_nop 1
  v_permlane32_swap_b32 v137, v136
  v_max_f32 v137, v137, v136
  v_sub_f32 v100, v100, v137
  v_sub_f32 v101, v101, v137
  v_sub_f32 v102, v102, v137
  v_sub_f32 v103, v103, v137
  v_sub_f32 v104, v104, v137
  v_sub_f32 v105, v105, v137
  v_sub_f32 v106, v106, v137
  v_sub_f32 v107, v107, v137
  v_sub_f32 v108, v108, v137
  v_sub_f32 v109, v109, v137
  v_mul_f32 v100, 0x3fb8aa3b, v100
  v_mul_f32 v101, 0x3fb8aa3b, v101
  v_mul_f32 v102, 0x3fb8aa3b, v102
  v_mul_f32 v103, 0x3fb8aa3b, v103
  v_mul_f32 v104, 0x3fb8aa3b, v104
  v_mul_f32 v105, 0x3fb8aa3b, v105
  v_mul_f32 v106, 0x3fb8aa3b, v106
  v_mul_f32 v107, 0x3fb8aa3b, v107
  v_mul_f32 v108, 0x3fb8aa3b, v108
  v_mul_f32 v109, 0x3fb8aa3b, v109
  v_exp_f32 v100, v100
  v_exp_f32 v101, v101
  v_exp_f32 v102, v102
  v_exp_f32 v103, v103
  v_exp_f32 v104, v104
  v_exp_f32 v105, v105
  v_exp_f32 v106, v106
  v_exp_f32 v107, v107
  v_exp_f32 v108, v108
  v_exp_f32 v109, v109
  v_pk_add_f32 v[126:127], v[100:101], v[102:103]
  v_pk_add_f32 v[110:111], v[104:105], v[106:107]
  v_pk_add_f32 v[126:127], v[126:127], v[108:109]
  v_pk_add_f32 v[126:127], v[126:127], v[110:111]
  v_add_f32 v137, v126, v127
  v_mov_b32 v136, v137
  s_nop 1
  v_permlane16_swap_b32 v137, v136
  v_add_f32 v137, v137, v136
  v_mov_b32 v136, v137
  s_nop 1
  v_permlane32_swap_b32 v137, v136
  v_add_f32 v137, v137, v136
  v_rcp_f32 v126, v137
  s_nop 0
  v_mov_b32 v127, v126
  v_pk_mul_f32 v[100:101], v[100:101], v[126:127]
  v_cvt_pk_bf16_f32 v120, v100, v101
  v_pk_mul_f32 v[102:103], v[102:103], v[126:127]
  v_cvt_pk_bf16_f32 v121, v102, v103
  v_pk_mul_f32 v[104:105], v[104:105], v[126:127]
  v_cvt_pk_bf16_f32 v122, v104, v105
  v_pk_mul_f32 v[106:107], v[106:107], v[126:127]
  v_cvt_pk_bf16_f32 v123, v106, v107
  v_pk_mul_f32 v[108:109], v[108:109], v[126:127]
  buffer_store_dwordx4 v[120:123], v128, s[8:11], s32 offen
  v_cvt_pk_bf16_f32 v138, v108, v109
  buffer_store_dword v138, v128, s[8:11], s33 offen
  v_mov_b32 v137, s34
  s_add_u32 s34, s34, 1
  s_waitcnt vmcnt(0)
  buffer_store_dword v137, v132, s[8:11], 0 offen
  s_cmp_le_u32 s34, 64
  s_cbranch_scc1 sm_loop
  s_endpgm
role_r:
  s_load_dwordx2 s[20:21], s[0:1], 0
  s_mov_b32 s22, 2621440
  s_mov_b32 s23, 0x00020000
  s_load_dwordx2 s[24:25], s[0:1], 112
  s_mov_b32 s26, 2621440
  s_mov_b32 s27, 0x00020000
  s_load_dwordx2 s[28:29], s[0:1], 64
  s_mov_b32 s30, 1280
  s_mov_b32 s31, 0x00020000
  s_sub_u32 s32, s18, 28
  s_lshl_b32 s32, s32, 2
  s_add_u32 s32, s32, s17
  v_lshlrev_b32 v143, 2, v1
  v_lshlrev_b32 v144, 3, v1
  s_lshl_b32 s35, s16, 8
  s_lshl_b32 s36, s32, 2
  s_add_u32 s35, s35, s36
  s_add_u32 s35, s35, 12288
  v_mov_b32 v145, s35
  v_mov_b32 v148, 0x00003f80
  v_mov_b32 v149, 0x3f800000
  s_mul_i32 s37, s32, 1280
  s_mul_i32 s38, s16, 2621440
  s_add_u32 s38, s38, 247463936
  s_lshl_b32 s35, s32, 4
  s_add_u32 s38, s38, s35
  v_lshrrev_b32 v140, 2, v1
  v_and_b32 v141, 3, v1
  v_lshlrev_b32 v141, 2, v141
  v_lshl_add_u32 v96, v140, 8, v141
  v_add_u32 v97, 4096, v96
  v_add_u32 v98, 8192, v96
  v_add_u32 v99, 12288, v96
  v_add_u32 v100, 16384, v96
  s_waitcnt lgkmcnt(0)
  s_mov_b32 s35, 65536
  buffer_load_dwordx2 v[56:57], v144, s[8:11], s35 offen offset:0
  buffer_load_dwordx2 v[58:59], v144, s[8:11], s35 offen offset:512
  buffer_load_dwordx2 v[60:61], v144, s[8:11], s35 offen offset:1024
  buffer_load_dwordx2 v[62:63], v144, s[8:11], s35 offen offset:1536
  buffer_load_dwordx2 v[64:65], v144, s[8:11], s35 offen offset:2048
  s_mov_b32 s35, 68096
  buffer_load_dwordx2 v[46:47], v144, s[8:11], s35 offen offset:0
  buffer_load_dwordx2 v[48:49], v144, s[8:11], s35 offen offset:512
  buffer_load_dwordx2 v[50:51], v144, s[8:11], s35 offen offset:1024
  buffer_load_dwordx2 v[52:53], v144, s[8:11], s35 offen offset:1536
  buffer_load_dwordx2 v[54:55], v144, s[8:11], s35 offen offset:2048
  buffer_load_dword v22, v143, s[20:23], s37 offen offset:0
  buffer_load_dword v23, v143, s[20:23], s37 offen offset:256
  buffer_load_dword v24, v143, s[20:23], s37 offen offset:512
  buffer_load_dword v25, v143, s[20:23], s37 offen offset:768
  buffer_load_dword v26, v143, s[20:23], s37 offen offset:1024
  s_waitcnt vmcnt(5)
  v_add_f32 v46, 1.0, v46
  v_add_f32 v47, 1.0, v47
  v_cvt_pk_bf16_f32 v140, v46, v47
  v_lshlrev_b32 v46, 16, v140
  v_and_b32 v47, 0xffff0000, v140
  v_add_f32 v48, 1.0, v48
  v_add_f32 v49, 1.0, v49
  v_cvt_pk_bf16_f32 v140, v48, v49
  v_lshlrev_b32 v48, 16, v140
  v_and_b32 v49, 0xffff0000, v140
  v_add_f32 v50, 1.0, v50
  v_add_f32 v51, 1.0, v51
  v_cvt_pk_bf16_f32 v140, v50, v51
  v_lshlrev_b32 v50, 16, v140
  v_and_b32 v51, 0xffff0000, v140
  v_add_f32 v52, 1.0, v52
  v_add_f32 v53, 1.0, v53
  v_cvt_pk_bf16_f32 v140, v52, v53
  v_lshlrev_b32 v52, 16, v140
  v_and_b32 v53, 0xffff0000, v140
  v_add_f32 v54, 1.0, v54
  v_add_f32 v55, 1.0, v55
  v_cvt_pk_bf16_f32 v140, v54, v55
  v_lshlrev_b32 v54, 16, v140
  v_and_b32 v55, 0xffff0000, v140
  s_mov_b32 s33, 0
  s_waitcnt vmcnt(0)
r_ln1:
  s_waitcnt vmcnt(6)
  v_lshlrev_b32 v2, 16, v22
  v_and_b32 v3, 0xffff0000, v22
  v_lshlrev_b32 v4, 16, v23
  v_and_b32 v5, 0xffff0000, v23
  v_lshlrev_b32 v6, 16, v24
  v_and_b32 v7, 0xffff0000, v24
  v_lshlrev_b32 v8, 16, v25
  v_and_b32 v9, 0xffff0000, v25
  v_lshlrev_b32 v10, 16, v26
  v_and_b32 v11, 0xffff0000, v26
  s_add_u32 s37, s37, 20480
  s_min_u32 s37, s37, 2620160
  buffer_load_dword v22, v143, s[20:23], s37 offen offset:0
  buffer_load_dword v23, v143, s[20:23], s37 offen offset:256
  buffer_load_dword v24, v143, s[20:23], s37 offen offset:512
  buffer_load_dword v25, v143, s[20:23], s37 offen offset:768
  buffer_load_dword v26, v143, s[20:23], s37 offen offset:1024
  v_pk_add_f32 v[136:137], v[2:3], v[4:5]
  v_pk_add_f32 v[138:139], v[6:7], v[8:9]
  v_pk_add_f32 v[136:137], v[136:137], v[10:11]
  v_pk_add_f32 v[136:137], v[136:137], v[138:139]
  v_add_f32 v136, v136, v137
  s_nop 1
  v_add_f32_dpp v136, v136, v136 row_ror:8 row_mask:0xf bank_mask:0xf
  s_nop 1
  v_add_f32_dpp v136, v136, v136 row_ror:4 row_mask:0xf bank_mask:0xf
  s_nop 1
  v_add_f32_dpp v136, v136, v136 row_ror:2 row_mask:0xf bank_mask:0xf
  s_nop 1
  v_add_f32_dpp v136, v136, v136 row_ror:1 row_mask:0xf bank_mask:0xf
  v_mov_b32 v140, v136
  s_nop 1
  v_permlane16_swap_b32 v136, v140
  v_add_f32 v136, v136, v140
  v_mov_b32 v140, v136
  s_nop 1
  v_permlane32_swap_b32 v136, v140
  v_add_f32 v136, v136, v140
  v_mul_f32 v138, 0xbacccccd, v136
  v_mul_f32 v139, 0xbacccccd, v136
  v_pk_add_f32 v[12:13], v[2:3], v[138:139]
  v_pk_add_f32 v[14:15], v[4:5], v[138:139]
  v_pk_add_f32 v[16:17], v[6:7], v[138:139]
  v_pk_add_f32 v[18:19], v[8:9], v[138:139]
  v_pk_add_f32 v[20:21], v[10:11], v[138:139]
  v_pk_mul_f32 v[136:137], v[12:13], v[12:13]
  v_pk_fma_f32 v[136:137], v[14:15], v[14:15], v[136:137]
  v_pk_fma_f32 v[136:137], v[16:17], v[16:17], v[136:137]
  v_pk_fma_f32 v[136:137], v[18:19], v[18:19], v[136:137]
  v_pk_fma_f32 v[136:137], v[20:21], v[20:21], v[136:137]
  v_add_f32 v136, v136, v137
  v_cvt_pk_bf16_f32 v141, v138, v139
  v_lshlrev_b32 v138, 16, v141
  v_and_b32 v139, 0xffff0000, v141
  v_add_f32_dpp v136, v136, v136 row_ror:8 row_mask:0xf bank_mask:0xf
  s_nop 1
  v_add_f32_dpp v136, v136, v136 row_ror:4 row_mask:0xf bank_mask:0xf
  s_nop 1
  v_add_f32_dpp v136, v136, v136 row_ror:2 row_mask:0xf bank_mask:0xf
  s_nop 1
  v_add_f32_dpp v136, v136, v136 row_ror:1 row_mask:0xf bank_mask:0xf
  v_mov_b32 v140, v136
  s_nop 1
  v_permlane16_swap_b32 v136, v140
  v_add_f32 v136, v136, v140
  v_mov_b32 v140, v136
  s_nop 1
  v_permlane32_swap_b32 v136, v140
  v_add_f32 v136, v136, v140
  v_pk_add_f32 v[12:13], v[2:3], v[138:139]
  v_pk_add_f32 v[14:15], v[4:5], v[138:139]
  v_pk_add_f32 v[16:17], v[6:7], v[138:139]
  v_pk_add_f32 v[18:19], v[8:9], v[138:139]
  v_pk_add_f32 v[20:21], v[10:11], v[138:139]
  v_mul_f32 v136, 0x3acccccd, v136
  v_cvt_pk_bf16_f32 v136, v136, v136
  v_lshlrev_b32 v136, 16, v136
  v_add_f32 v136, 0x3727c5ac, v136
  v_cvt_pk_bf16_f32 v136, v136, v136
  v_lshlrev_b32 v136, 16, v136
  v_sqrt_f32 v136, v136
  v_cvt_pk_bf16_f32 v140, v12, v13
  v_lshlrev_b32 v12, 16, v140
  v_and_b32 v13, 0xffff0000, v140
  v_cvt_pk_bf16_f32 v136, v136, v136
  v_lshlrev_b32 v136, 16, v136
  v_rcp_f32 v136, v136
  v_cvt_pk_bf16_f32 v140, v14, v15
  v_lshlrev_b32 v14, 16, v140
  v_and_b32 v15, 0xffff0000, v140
  v_cvt_pk_bf16_f32 v140, v16, v17
  v_lshlrev_b32 v16, 16, v140
  v_and_b32 v17, 0xffff0000, v140
  v_cvt_pk_bf16_f32 v140, v18, v19
  v_lshlrev_b32 v18, 16, v140
  v_and_b32 v19, 0xffff0000, v140
  v_cvt_pk_bf16_f32 v140, v20, v21
  v_lshlrev_b32 v20, 16, v140
  v_and_b32 v21, 0xffff0000, v140
  v_mov_b32 v137, v136
  v_pk_mul_f32 v[12:13], v[12:13], v[136:137]
  v_cvt_pk_bf16_f32 v140, v12, v13
  v_lshlrev_b32 v12, 16, v140
  v_and_b32 v13, 0xffff0000, v140
  v_pk_mul_f32 v[14:15], v[14:15], v[136:137]
  v_cvt_pk_bf16_f32 v140, v14, v15
  v_lshlrev_b32 v14, 16, v140
  v_and_b32 v15, 0xffff0000, v140
  v_pk_mul_f32 v[16:17], v[16:17], v[136:137]
  v_cvt_pk_bf16_f32 v140, v16, v17
  v_lshlrev_b32 v16, 16, v140
  v_and_b32 v17, 0xffff0000, v140
  v_pk_mul_f32 v[18:19], v[18:19], v[136:137]
  v_cvt_pk_bf16_f32 v140, v18, v19
  v_lshlrev_b32 v18, 16, v140
  v_and_b32 v19, 0xffff0000, v140
  v_pk_mul_f32 v[20:21], v[20:21], v[136:137]
  v_cvt_pk_bf16_f32 v140, v20, v21
  v_lshlrev_b32 v20, 16, v140
  v_and_b32 v21, 0xffff0000, v140
  v_pk_mul_f32 v[12:13], v[12:13], v[46:47]
  v_cvt_pk_bf16_f32 v140, v12, v13
  v_lshlrev_b32 v12, 16, v140
  v_and_b32 v13, 0xffff0000, v140
  v_pk_mul_f32 v[14:15], v[14:15], v[48:49]
  v_cvt_pk_bf16_f32 v140, v14, v15
  v_lshlrev_b32 v14, 16, v140
  v_and_b32 v15, 0xffff0000, v140
  v_pk_mul_f32 v[16:17], v[16:17], v[50:51]
  v_cvt_pk_bf16_f32 v140, v16, v17
  v_lshlrev_b32 v16, 16, v140
  v_and_b32 v17, 0xffff0000, v140
  v_pk_mul_f32 v[18:19], v[18:19], v[52:53]
  v_cvt_pk_bf16_f32 v140, v18, v19
  v_lshlrev_b32 v18, 16, v140
  v_and_b32 v19, 0xffff0000, v140
  v_pk_mul_f32 v[20:21], v[20:21], v[54:55]
  v_cvt_pk_bf16_f32 v140, v20, v21
  v_lshlrev_b32 v20, 16, v140
  v_and_b32 v21, 0xffff0000, v140
  v_pk_add_f32 v[12:13], v[12:13], v[56:57]
  v_cvt_pk_bf16_f32 v28, v12, v13
  v_pk_add_f32 v[14:15], v[14:15], v[58:59]
  v_cvt_pk_bf16_f32 v29, v14, v15
  v_pk_add_f32 v[16:17], v[16:17], v[60:61]
  v_cvt_pk_bf16_f32 v30, v16, v17
  v_pk_add_f32 v[18:19], v[18:19], v[62:63]
  v_cvt_pk_bf16_f32 v31, v18, v19
  v_pk_add_f32 v[20:21], v[20:21], v[64:65]
  v_cvt_pk_bf16_f32 v32, v20, v21
  v_mov_b32 v142, s33
  s_waitcnt vmcnt(5)
  buffer_store_dword v142, v145, s[8:11], 0 offen
  buffer_store_dword v28, v96, s[8:11], s38 offen
  buffer_store_dword v29, v97, s[8:11], s38 offen
  buffer_store_dword v30, v98, s[8:11], s38 offen
  buffer_store_dword v31, v99, s[8:11], s38 offen
  buffer_store_dword v32, v100, s[8:11], s38 offen
  s_add_u32 s38, s38, 20480
  s_add_u32 s33, s33, 1
  s_cmp_lt_u32 s33, 128
  s_cbranch_scc1 r_ln1
  v_mov_b32 v142, s33
  s_waitcnt vmcnt(0)
  buffer_store_dword v142, v145, s[8:11], 0 offen
  s_mov_b32 s35, 70656
  buffer_load_dwordx2 v[66:67], v144, s[8:11], s35 offen offset:0
  buffer_load_dwordx2 v[68:69], v144, s[8:11], s35 offen offset:512
  buffer_load_dwordx2 v[70:71], v144, s[8:11], s35 offen offset:1024
  buffer_load_dwordx2 v[72:73], v144, s[8:11], s35 offen offset:1536
  buffer_load_dwordx2 v[74:75], v144, s[8:11], s35 offen offset:2048
  s_mov_b32 s35, 73216
  buffer_load_dwordx2 v[56:57], v144, s[8:11], s35 offen offset:0
  buffer_load_dwordx2 v[58:59], v144, s[8:11], s35 offen offset:512
  buffer_load_dwordx2 v[60:61], v144, s[8:11], s35 offen offset:1024
  buffer_load_dwordx2 v[62:63], v144, s[8:11], s35 offen offset:1536
  buffer_load_dwordx2 v[64:65], v144, s[8:11], s35 offen offset:2048
  s_mov_b32 s35, 75776
  buffer_load_dwordx2 v[46:47], v144, s[8:11], s35 offen offset:0
  buffer_load_dwordx2 v[48:49], v144, s[8:11], s35 offen offset:512
  buffer_load_dwordx2 v[50:51], v144, s[8:11], s35 offen offset:1024
  buffer_load_dwordx2 v[52:53], v144, s[8:11], s35 offen offset:1536
  buffer_load_dwordx2 v[54:55], v144, s[8:11], s35 offen offset:2048
  s_mov_b32 s35, 78336
  buffer_load_dwordx2 v[76:77], v144, s[8:11], s35 offen offset:0
  buffer_load_dwordx2 v[78:79], v144, s[8:11], s35 offen offset:512
  buffer_load_dwordx2 v[80:81], v144, s[8:11], s35 offen offset:1024
  buffer_load_dwordx2 v[82:83], v144, s[8:11], s35 offen offset:1536
  buffer_load_dwordx2 v[84:85], v144, s[8:11], s35 offen offset:2048
  buffer_load_dword v22, v143, s[28:31], 0 offen offset:0
  buffer_load_dword v23, v143, s[28:31], 0 offen offset:256
  buffer_load_dword v24, v143, s[28:31], 0 offen offset:512
  buffer_load_dword v25, v143, s[28:31], 0 offen offset:768
  buffer_load_dword v26, v143, s[28:31], 0 offen offset:1024
  v_lshlrev_b32 v147, 4, v1
  s_lshl_b32 s35, s16, 8
  s_add_u32 s35, s35, 16384
  v_and_b32 v140, 7, v1
  v_lshl_add_u32 v150, v140, 2, s35
  s_waitcnt vmcnt(0)
  v_add_f32 v46, 1.0, v46
  v_add_f32 v47, 1.0, v47
  v_cvt_pk_bf16_f32 v140, v46, v47
  v_lshlrev_b32 v46, 16, v140
  v_and_b32 v47, 0xffff0000, v140
  v_add_f32 v48, 1.0, v48
  v_add_f32 v49, 1.0, v49
  v_cvt_pk_bf16_f32 v140, v48, v49
  v_lshlrev_b32 v48, 16, v140
  v_and_b32 v49, 0xffff0000, v140
  v_add_f32 v50, 1.0, v50
  v_add_f32 v51, 1.0, v51
  v_cvt_pk_bf16_f32 v140, v50, v51
  v_lshlrev_b32 v50, 16, v140
  v_and_b32 v51, 0xffff0000, v140
  v_add_f32 v52, 1.0, v52
  v_add_f32 v53, 1.0, v53
  v_cvt_pk_bf16_f32 v140, v52, v53
  v_lshlrev_b32 v52, 16, v140
  v_and_b32 v53, 0xffff0000, v140
  v_add_f32 v54, 1.0, v54
  v_add_f32 v55, 1.0, v55
  v_cvt_pk_bf16_f32 v140, v54, v55
  v_lshlrev_b32 v54, 16, v140
  v_and_b32 v55, 0xffff0000, v140
  v_lshlrev_b32 v86, 16, v22
  v_and_b32 v87, 0xffff0000, v22
  v_lshlrev_b32 v88, 16, v23
  v_and_b32 v89, 0xffff0000, v23
  v_lshlrev_b32 v90, 16, v24
  v_and_b32 v91, 0xffff0000, v24
  v_lshlrev_b32 v92, 16, v25
  v_and_b32 v93, 0xffff0000, v25
  v_lshlrev_b32 v94, 16, v26
  v_and_b32 v95, 0xffff0000, v26
  s_mov_b32 s33, s16
r_loop:
  s_lshl_b32 s40, s33, 4
  s_add_u32 s40, s40, s32
  s_mul_i32 s37, s40, 1280
  s_lshr_b32 s39, s33, 1
  s_mul_i32 s38, s39, 327680
  s_and_b32 s35, s40, 31
  s_mul_i32 s35, s35, 1280
  s_add_u32 s38, s38, s35
  s_add_u32 s38, s38, 226492416
  s_add_u32 s41, s39, 3
  s_min_u32 s41, s41, 64
  s_lshl_b32 s36, s39, 10
  s_add_u32 s36, s36, 2162688
  buffer_load_dword v22, v143, s[20:23], s37 offen offset:0
  buffer_load_dword v23, v143, s[20:23], s37 offen offset:256
  buffer_load_dword v24, v143, s[20:23], s37 offen offset:512
  buffer_load_dword v25, v143, s[20:23], s37 offen offset:768
  buffer_load_dword v26, v143, s[20:23], s37 offen offset:1024
  s_mov_b32 s34, 0
pw_31:
  buffer_load_dword v146, v150, s[8:11], 0 offen sc1
  s_add_u32 s34, s34, 1
  s_cmp_gt_u32 s34, 65536
  s_cbranch_scc1 role_abort
  s_waitcnt vmcnt(0)
pc_33:
  v_cmp_gt_u32 vcc, s41, v146
  s_nop 0
  s_and_b32 vcc_lo, vcc_lo, 0xff
  s_and_b32 vcc_hi, vcc_hi, 0x0
  s_cmp_eq_u64 vcc, 0
  s_cbranch_scc1 po_32
  s_sleep 8
  s_branch pw_31
po_32:
  s_cmp_lt_u32 s39, 63
  s_cbranch_scc1 r_p0
  s_sleep 16
r_p0:
  s_mov_b32 s34, 0
r_poll:
  buffer_load_dwordx4 v[152:155], v147, s[8:11], s36 offen sc1
  s_add_u32 s34, s34, 1
  s_cmp_gt_u32 s34, 65536
  s_cbranch_scc1 role_abort
  s_waitcnt vmcnt(0)
  v_max3_u32 v140, v152, v153, v154
  v_max_u32 v140, v140, v155
  v_cmp_eq_u32 vcc, -1, v140
  s_nop 0
  s_and_b32 vcc_lo, vcc_lo, 0x1f1f1f1f
  s_and_b32 vcc_hi, vcc_hi, 0x1f1f1f1f
  s_cmp_eq_u64 vcc, 0
  s_cbranch_scc1 r_go
  s_sleep 4
  s_branch r_poll
r_go:
  buffer_load_dword v96, v143, s[8:11], s38 offen offset:0 sc1
  buffer_load_dword v97, v143, s[8:11], s38 offen offset:256 sc1
  buffer_load_dword v98, v143, s[8:11], s38 offen offset:512 sc1
  buffer_load_dword v99, v143, s[8:11], s38 offen offset:768 sc1
  buffer_load_dword v100, v143, s[8:11], s38 offen offset:1024 sc1
  s_add_u32 s38, s38, 40960
  buffer_load_dword v101, v143, s[8:11], s38 offen offset:0 sc1
  buffer_load_dword v102, v143, s[8:11], s38 offen offset:256 sc1
  buffer_load_dword v103, v143, s[8:11], s38 offen offset:512 sc1
  buffer_load_dword v104, v143, s[8:11], s38 offen offset:768 sc1
  buffer_load_dword v105, v143, s[8:11], s38 offen offset:1024 sc1
  s_add_u32 s38, s38, 40960
  buffer_load_dword v106, v143, s[8:11], s38 offen offset:0 sc1
  buffer_load_dword v107, v143, s[8:11], s38 offen offset:256 sc1
  buffer_load_dword v108, v143, s[8:11], s38 offen offset:512 sc1
  buffer_load_dword v109, v143, s[8:11], s38 offen offset:768 sc1
  buffer_load_dword v110, v143, s[8:11], s38 offen offset:1024 sc1
  s_add_u32 s38, s38, 40960
  buffer_load_dword v111, v143, s[8:11], s38 offen offset:0 sc1
  buffer_load_dword v112, v143, s[8:11], s38 offen offset:256 sc1
  buffer_load_dword v113, v143, s[8:11], s38 offen offset:512 sc1
  buffer_load_dword v114, v143, s[8:11], s38 offen offset:768 sc1
  buffer_load_dword v115, v143, s[8:11], s38 offen offset:1024 sc1
  s_add_u32 s38, s38, 40960
  buffer_load_dword v116, v143, s[8:11], s38 offen offset:0 sc1
  buffer_load_dword v117, v143, s[8:11], s38 offen offset:256 sc1
  buffer_load_dword v118, v143, s[8:11], s38 offen offset:512 sc1
  buffer_load_dword v119, v143, s[8:11], s38 offen offset:768 sc1
  buffer_load_dword v120, v143, s[8:11], s38 offen offset:1024 sc1
  s_add_u32 s38, s38, 40960
  buffer_load_dword v121, v143, s[8:11], s38 offen offset:0 sc1
  buffer_load_dword v122, v143, s[8:11], s38 offen offset:256 sc1
  buffer_load_dword v123, v143, s[8:11], s38 offen offset:512 sc1
  buffer_load_dword v124, v143, s[8:11], s38 offen offset:768 sc1
  buffer_load_dword v125, v143, s[8:11], s38 offen offset:1024 sc1
  s_add_u32 s38, s38, 40960
  buffer_load_dword v126, v143, s[8:11], s38 offen offset:0 sc1
  buffer_load_dword v127, v143, s[8:11], s38 offen offset:256 sc1
  buffer_load_dword v128, v143, s[8:11], s38 offen offset:512 sc1
  buffer_load_dword v129, v143, s[8:11], s38 offen offset:768 sc1
  buffer_load_dword v130, v143, s[8:11], s38 offen offset:1024 sc1
  s_add_u32 s38, s38, 40960
  buffer_load_dword v131, v143, s[8:11], s38 offen offset:0 sc1
  buffer_load_dword v132, v143, s[8:11], s38 offen offset:256 sc1
  buffer_load_dword v133, v143, s[8:11], s38 offen offset:512 sc1
  buffer_load_dword v134, v143, s[8:11], s38 offen offset:768 sc1
  buffer_load_dword v135, v143, s[8:11], s38 offen offset:1024 sc1
  s_add_u32 s38, s38, 40960
  v_lshlrev_b32 v2, 16, v22
  v_and_b32 v3, 0xffff0000, v22
  v_lshlrev_b32 v4, 16, v23
  v_and_b32 v5, 0xffff0000, v23
  v_lshlrev_b32 v6, 16, v24
  v_and_b32 v7, 0xffff0000, v24
  v_lshlrev_b32 v8, 16, v25
  v_and_b32 v9, 0xffff0000, v25
  v_lshlrev_b32 v10, 16, v26
  v_and_b32 v11, 0xffff0000, v26
  s_waitcnt vmcnt(35)
  v_lshlrev_b32 v12, 16, v96
  v_and_b32 v13, 0xffff0000, v96
  v_lshlrev_b32 v14, 16, v97
  v_and_b32 v15, 0xffff0000, v97
  v_lshlrev_b32 v16, 16, v98
  v_and_b32 v17, 0xffff0000, v98
  v_lshlrev_b32 v18, 16, v99
  v_and_b32 v19, 0xffff0000, v99
  v_lshlrev_b32 v20, 16, v100
  v_and_b32 v21, 0xffff0000, v100
  s_waitcnt vmcnt(30)
  v_dot2c_f32_bf16 v12, v101, v148
  v_dot2c_f32_bf16 v13, v101, v149
  v_dot2c_f32_bf16 v14, v102, v148
  v_dot2c_f32_bf16 v15, v102, v149
  v_dot2c_f32_bf16 v16, v103, v148
  v_dot2c_f32_bf16 v17, v103, v149
  v_dot2c_f32_bf16 v18, v104, v148
  v_dot2c_f32_bf16 v19, v104, v149
  v_dot2c_f32_bf16 v20, v105, v148
  v_dot2c_f32_bf16 v21, v105, v149
  s_waitcnt vmcnt(25)
  v_dot2c_f32_bf16 v12, v106, v148
  v_dot2c_f32_bf16 v13, v106, v149
  v_dot2c_f32_bf16 v14, v107, v148
  v_dot2c_f32_bf16 v15, v107, v149
  v_dot2c_f32_bf16 v16, v108, v148
  v_dot2c_f32_bf16 v17, v108, v149
  v_dot2c_f32_bf16 v18, v109, v148
  v_dot2c_f32_bf16 v19, v109, v149
  v_dot2c_f32_bf16 v20, v110, v148
  v_dot2c_f32_bf16 v21, v110, v149
  s_waitcnt vmcnt(20)
  v_dot2c_f32_bf16 v12, v111, v148
  v_dot2c_f32_bf16 v13, v111, v149
  v_dot2c_f32_bf16 v14, v112, v148
  v_dot2c_f32_bf16 v15, v112, v149
  v_dot2c_f32_bf16 v16, v113, v148
  v_dot2c_f32_bf16 v17, v113, v149
  v_dot2c_f32_bf16 v18, v114, v148
  v_dot2c_f32_bf16 v19, v114, v149
  v_dot2c_f32_bf16 v20, v115, v148
  v_dot2c_f32_bf16 v21, v115, v149
  s_waitcnt vmcnt(15)
  v_dot2c_f32_bf16 v12, v116, v148
  v_dot2c_f32_bf16 v13, v116, v149
  v_dot2c_f32_bf16 v14, v117, v148
  v_dot2c_f32_bf16 v15, v117, v149
  v_dot2c_f32_bf16 v16, v118, v148
  v_dot2c_f32_bf16 v17, v118, v149
  v_dot2c_f32_bf16 v18, v119, v148
  v_dot2c_f32_bf16 v19, v119, v149
  v_dot2c_f32_bf16 v20, v120, v148
  v_dot2c_f32_bf16 v21, v120, v149
  s_waitcnt vmcnt(10)
  v_dot2c_f32_bf16 v12, v121, v148
  v_dot2c_f32_bf16 v13, v121, v149
  v_dot2c_f32_bf16 v14, v122, v148
  v_dot2c_f32_bf16 v15, v122, v149
  v_dot2c_f32_bf16 v16, v123, v148
  v_dot2c_f32_bf16 v17, v123, v149
  v_dot2c_f32_bf16 v18, v124, v148
  v_dot2c_f32_bf16 v19, v124, v149
  v_dot2c_f32_bf16 v20, v125, v148
  v_dot2c_f32_bf16 v21, v125, v149
  s_waitcnt vmcnt(5)
  v_dot2c_f32_bf16 v12, v126, v148
  v_dot2c_f32_bf16 v13, v126, v149
  v_dot2c_f32_bf16 v14, v127, v148
  v_dot2c_f32_bf16 v15, v127, v149
  v_dot2c_f32_bf16 v16, v128, v148
  v_dot2c_f32_bf16 v17, v128, v149
  v_dot2c_f32_bf16 v18, v129, v148
  v_dot2c_f32_bf16 v19, v129, v149
  v_dot2c_f32_bf16 v20, v130, v148
  v_dot2c_f32_bf16 v21, v130, v149
  s_waitcnt vmcnt(0)
  v_dot2c_f32_bf16 v12, v131, v148
  v_dot2c_f32_bf16 v13, v131, v149
  v_dot2c_f32_bf16 v14, v132, v148
  v_dot2c_f32_bf16 v15, v132, v149
  v_dot2c_f32_bf16 v16, v133, v148
  v_dot2c_f32_bf16 v17, v133, v149
  v_dot2c_f32_bf16 v18, v134, v148
  v_dot2c_f32_bf16 v19, v134, v149
  v_dot2c_f32_bf16 v20, v135, v148
  v_dot2c_f32_bf16 v21, v135, v149
  v_cvt_pk_bf16_f32 v140, v12, v13
  v_lshlrev_b32 v12, 16, v140
  v_and_b32 v13, 0xffff0000, v140
  v_cvt_pk_bf16_f32 v140, v14, v15
  v_lshlrev_b32 v14, 16, v140
  v_and_b32 v15, 0xffff0000, v140
  v_cvt_pk_bf16_f32 v140, v16, v17
  v_lshlrev_b32 v16, 16, v140
  v_and_b32 v17, 0xffff0000, v140
  v_cvt_pk_bf16_f32 v140, v18, v19
  v_lshlrev_b32 v18, 16, v140
  v_and_b32 v19, 0xffff0000, v140
  v_cvt_pk_bf16_f32 v140, v20, v21
  v_lshlrev_b32 v20, 16, v140
  v_and_b32 v21, 0xffff0000, v140
  v_pk_mul_f32 v[12:13], v[12:13], v[66:67]
  v_cvt_pk_bf16_f32 v140, v12, v13
  v_lshlrev_b32 v12, 16, v140
  v_and_b32 v13, 0xffff0000, v140
  v_pk_mul_f32 v[14:15], v[14:15], v[68:69]
  v_cvt_pk_bf16_f32 v140, v14, v15
  v_lshlrev_b32 v14, 16, v140
  v_and_b32 v15, 0xffff0000, v140
  v_pk_mul_f32 v[16:17], v[16:17], v[70:71]
  v_cvt_pk_bf16_f32 v140, v16, v17
  v_lshlrev_b32 v16, 16, v140
  v_and_b32 v17, 0xffff0000, v140
  v_pk_mul_f32 v[18:19], v[18:19], v[72:73]
  v_cvt_pk_bf16_f32 v140, v18, v19
  v_lshlrev_b32 v18, 16, v140
  v_and_b32 v19, 0xffff0000, v140
  v_pk_mul_f32 v[20:21], v[20:21], v[74:75]
  v_cvt_pk_bf16_f32 v140, v20, v21
  v_lshlrev_b32 v20, 16, v140
  v_and_b32 v21, 0xffff0000, v140
  v_pk_add_f32 v[2:3], v[2:3], v[12:13]
  v_cvt_pk_bf16_f32 v34, v2, v3
  v_lshlrev_b32 v2, 16, v34
  v_and_b32 v3, 0xffff0000, v34
  v_pk_add_f32 v[4:5], v[4:5], v[14:15]
  v_cvt_pk_bf16_f32 v35, v4, v5
  v_lshlrev_b32 v4, 16, v35
  v_and_b32 v5, 0xffff0000, v35
  v_pk_add_f32 v[6:7], v[6:7], v[16:17]
  v_cvt_pk_bf16_f32 v36, v6, v7
  v_lshlrev_b32 v6, 16, v36
  v_and_b32 v7, 0xffff0000, v36
  v_pk_add_f32 v[8:9], v[8:9], v[18:19]
  v_cvt_pk_bf16_f32 v37, v8, v9
  v_lshlrev_b32 v8, 16, v37
  v_and_b32 v9, 0xffff0000, v37
  v_pk_add_f32 v[10:11], v[10:11], v[20:21]
  v_cvt_pk_bf16_f32 v38, v10, v11
  v_lshlrev_b32 v10, 16, v38
  v_and_b32 v11, 0xffff0000, v38
  s_add_u32 s35, s37, 5242880
  buffer_store_dword v34, v143, s[8:11], s35 offen offset:0 sc1
  buffer_store_dword v35, v143, s[8:11], s35 offen offset:256 sc1
  buffer_store_dword v36, v143, s[8:11], s35 offen offset:512 sc1
  buffer_store_dword v37, v143, s[8:11], s35 offen offset:768 sc1
  buffer_store_dword v38, v143, s[8:11], s35 offen offset:1024 sc1
  v_pk_add_f32 v[136:137], v[2:3], v[4:5]
  v_pk_add_f32 v[138:139], v[6:7], v[8:9]
  v_pk_add_f32 v[136:137], v[136:137], v[10:11]
  v_pk_add_f32 v[136:137], v[136:137], v[138:139]
  v_add_f32 v136, v136, v137
  s_nop 1
  v_add_f32_dpp v136, v136, v136 row_ror:8 row_mask:0xf bank_mask:0xf
  s_nop 1
  v_add_f32_dpp v136, v136, v136 row_ror:4 row_mask:0xf bank_mask:0xf
  s_nop 1
  v_add_f32_dpp v136, v136, v136 row_ror:2 row_mask:0xf bank_mask:0xf
  s_nop 1
  v_add_f32_dpp v136, v136, v136 row_ror:1 row_mask:0xf bank_mask:0xf
  v_mov_b32 v140, v136
  s_nop 1
  v_permlane16_swap_b32 v136, v140
  v_add_f32 v136, v136, v140
  v_mov_b32 v140, v136
  s_nop 1
  v_permlane32_swap_b32 v136, v140
  v_add_f32 v136, v136, v140
  v_mul_f32 v138, 0xbacccccd, v136
  v_mul_f32 v139, 0xbacccccd, v136
  v_pk_add_f32 v[12:13], v[2:3], v[138:139]
  v_pk_add_f32 v[14:15], v[4:5], v[138:139]
  v_pk_add_f32 v[16:17], v[6:7], v[138:139]
  v_pk_add_f32 v[18:19], v[8:9], v[138:139]
  v_pk_add_f32 v[20:21], v[10:11], v[138:139]
  v_pk_mul_f32 v[136:137], v[12:13], v[12:13]
  v_pk_fma_f32 v[136:137], v[14:15], v[14:15], v[136:137]
  v_pk_fma_f32 v[136:137], v[16:17], v[16:17], v[136:137]
  v_pk_fma_f32 v[136:137], v[18:19], v[18:19], v[136:137]
  v_pk_fma_f32 v[136:137], v[20:21], v[20:21], v[136:137]
  v_add_f32 v136, v136, v137
  v_cvt_pk_bf16_f32 v141, v138, v139
  v_lshlrev_b32 v138, 16, v141
  v_and_b32 v139, 0xffff0000, v141
  v_add_f32_dpp v136, v136, v136 row_ror:8 row_mask:0xf bank_mask:0xf
  s_nop 1
  v_add_f32_dpp v136, v136, v136 row_ror:4 row_mask:0xf bank_mask:0xf
  s_nop 1
  v_add_f32_dpp v136, v136, v136 row_ror:2 row_mask:0xf bank_mask:0xf
  s_nop 1
  v_add_f32_dpp v136, v136, v136 row_ror:1 row_mask:0xf bank_mask:0xf
  v_mov_b32 v140, v136
  s_nop 1
  v_permlane16_swap_b32 v136, v140
  v_add_f32 v136, v136, v140
  v_mov_b32 v140, v136
  s_nop 1
  v_permlane32_swap_b32 v136, v140
  v_add_f32 v136, v136, v140
  v_pk_add_f32 v[12:13], v[2:3], v[138:139]
  v_pk_add_f32 v[14:15], v[4:5], v[138:139]
  v_pk_add_f32 v[16:17], v[6:7], v[138:139]
  v_pk_add_f32 v[18:19], v[8:9], v[138:139]
  v_pk_add_f32 v[20:21], v[10:11], v[138:139]
  v_mul_f32 v136, 0x3acccccd, v136
  v_cvt_pk_bf16_f32 v136, v136, v136
  v_lshlrev_b32 v136, 16, v136
  v_add_f32 v136, 0x3727c5ac, v136
  v_cvt_pk_bf16_f32 v136, v136, v136
  v_lshlrev_b32 v136, 16, v136
  v_sqrt_f32 v136, v136
  v_cvt_pk_bf16_f32 v140, v12, v13
  v_lshlrev_b32 v12, 16, v140
  v_and_b32 v13, 0xffff0000, v140
  v_cvt_pk_bf16_f32 v136, v136, v136
  v_lshlrev_b32 v136, 16, v136
  v_rcp_f32 v136, v136
  v_cvt_pk_bf16_f32 v140, v14, v15
  v_lshlrev_b32 v14, 16, v140
  v_and_b32 v15, 0xffff0000, v140
  v_cvt_pk_bf16_f32 v140, v16, v17
  v_lshlrev_b32 v16, 16, v140
  v_and_b32 v17, 0xffff0000, v140
  v_cvt_pk_bf16_f32 v140, v18, v19
  v_lshlrev_b32 v18, 16, v140
  v_and_b32 v19, 0xffff0000, v140
  v_cvt_pk_bf16_f32 v140, v20, v21
  v_lshlrev_b32 v20, 16, v140
  v_and_b32 v21, 0xffff0000, v140
  v_mov_b32 v137, v136
  v_pk_mul_f32 v[12:13], v[12:13], v[136:137]
  v_cvt_pk_bf16_f32 v140, v12, v13
  v_lshlrev_b32 v12, 16, v140
  v_and_b32 v13, 0xffff0000, v140
  v_pk_mul_f32 v[14:15], v[14:15], v[136:137]
  v_cvt_pk_bf16_f32 v140, v14, v15
  v_lshlrev_b32 v14, 16, v140
  v_and_b32 v15, 0xffff0000, v140
  v_pk_mul_f32 v[16:17], v[16:17], v[136:137]
  v_cvt_pk_bf16_f32 v140, v16, v17
  v_lshlrev_b32 v16, 16, v140
  v_and_b32 v17, 0xffff0000, v140
  v_pk_mul_f32 v[18:19], v[18:19], v[136:137]
  v_cvt_pk_bf16_f32 v140, v18, v19
  v_lshlrev_b32 v18, 16, v140
  v_and_b32 v19, 0xffff0000, v140
  v_pk_mul_f32 v[20:21], v[20:21], v[136:137]
  v_cvt_pk_bf16_f32 v140, v20, v21
  v_lshlrev_b32 v20, 16, v140
  v_and_b32 v21, 0xffff0000, v140
  v_pk_mul_f32 v[12:13], v[12:13], v[46:47]
  v_cvt_pk_bf16_f32 v140, v12, v13
  v_lshlrev_b32 v12, 16, v140
  v_and_b32 v13, 0xffff0000, v140
  v_pk_mul_f32 v[14:15], v[14:15], v[48:49]
  v_cvt_pk_bf16_f32 v140, v14, v15
  v_lshlrev_b32 v14, 16, v140
  v_and_b32 v15, 0xffff0000, v140
  v_pk_mul_f32 v[16:17], v[16:17], v[50:51]
  v_cvt_pk_bf16_f32 v140, v16, v17
  v_lshlrev_b32 v16, 16, v140
  v_and_b32 v17, 0xffff0000, v140
  v_pk_mul_f32 v[18:19], v[18:19], v[52:53]
  v_cvt_pk_bf16_f32 v140, v18, v19
  v_lshlrev_b32 v18, 16, v140
  v_and_b32 v19, 0xffff0000, v140
  v_pk_mul_f32 v[20:21], v[20:21], v[54:55]
  v_cvt_pk_bf16_f32 v140, v20, v21
  v_lshlrev_b32 v20, 16, v140
  v_and_b32 v21, 0xffff0000, v140
  v_pk_add_f32 v[12:13], v[12:13], v[56:57]
  v_cvt_pk_bf16_f32 v28, v12, v13
  v_pk_add_f32 v[14:15], v[14:15], v[58:59]
  v_cvt_pk_bf16_f32 v29, v14, v15
  v_pk_add_f32 v[16:17], v[16:17], v[60:61]
  v_cvt_pk_bf16_f32 v30, v16, v17
  v_pk_add_f32 v[18:19], v[18:19], v[62:63]
  v_cvt_pk_bf16_f32 v31, v18, v19
  v_pk_add_f32 v[20:21], v[20:21], v[64:65]
  v_cvt_pk_bf16_f32 v32, v20, v21
  s_add_u32 s35, s37, 8388608
  buffer_store_dword v28, v143, s[8:11], s35 offen offset:0 sc1
  buffer_store_dword v29, v143, s[8:11], s35 offen offset:256 sc1
  buffer_store_dword v30, v143, s[8:11], s35 offen offset:512 sc1
  buffer_store_dword v31, v143, s[8:11], s35 offen offset:768 sc1
  buffer_store_dword v32, v143, s[8:11], s35 offen offset:1024 sc1
  v_lshlrev_b32 v12, 16, v28
  v_and_b32 v13, 0xffff0000, v28
  v_lshlrev_b32 v14, 16, v29
  v_and_b32 v15, 0xffff0000, v29
  v_lshlrev_b32 v16, 16, v30
  v_and_b32 v17, 0xffff0000, v30
  v_lshlrev_b32 v18, 16, v31
  v_and_b32 v19, 0xffff0000, v31
  v_lshlrev_b32 v20, 16, v32
  v_and_b32 v21, 0xffff0000, v32
  v_pk_mul_f32 v[136:137], v[12:13], v[86:87]
  v_pk_fma_f32 v[136:137], v[14:15], v[88:89], v[136:137]
  v_pk_fma_f32 v[136:137], v[16:17], v[90:91], v[136:137]
  v_pk_fma_f32 v[136:137], v[18:19], v[92:93], v[136:137]
  v_pk_fma_f32 v[136:137], v[20:21], v[94:95], v[136:137]
  v_add_f32 v136, v136, v137
  v_pk_mul_f32 v[12:13], v[12:13], v[76:77]
  v_cvt_pk_bf16_f32 v140, v12, v13
  v_lshlrev_b32 v12, 16, v140
  v_and_b32 v13, 0xffff0000, v140
  v_pk_mul_f32 v[14:15], v[14:15], v[78:79]
  v_cvt_pk_bf16_f32 v140, v14, v15
  v_lshlrev_b32 v14, 16, v140
  v_and_b32 v15, 0xffff0000, v140
  v_pk_mul_f32 v[16:17], v[16:17], v[80:81]
  v_cvt_pk_bf16_f32 v140, v16, v17
  v_lshlrev_b32 v16, 16, v140
  v_and_b32 v17, 0xffff0000, v140
  v_pk_mul_f32 v[18:19], v[18:19], v[82:83]
  v_cvt_pk_bf16_f32 v140, v18, v19
  v_lshlrev_b32 v18, 16, v140
  v_and_b32 v19, 0xffff0000, v140
  v_pk_mul_f32 v[20:21], v[20:21], v[84:85]
  v_cvt_pk_bf16_f32 v140, v20, v21
  v_lshlrev_b32 v20, 16, v140
  v_and_b32 v21, 0xffff0000, v140
  v_pk_add_f32 v[12:13], v[12:13], v[2:3]
  v_cvt_pk_bf16_f32 v40, v12, v13
  v_pk_add_f32 v[14:15], v[14:15], v[4:5]
  v_cvt_pk_bf16_f32 v41, v14, v15
  v_pk_add_f32 v[16:17], v[16:17], v[6:7]
  v_cvt_pk_bf16_f32 v42, v16, v17
  v_pk_add_f32 v[18:19], v[18:19], v[8:9]
  v_cvt_pk_bf16_f32 v43, v18, v19
  v_pk_add_f32 v[20:21], v[20:21], v[10:11]
  v_cvt_pk_bf16_f32 v44, v20, v21
  buffer_store_dword v40, v143, s[24:27], s37 offen offset:0 sc1
  buffer_store_dword v41, v143, s[24:27], s37 offen offset:256 sc1
  buffer_store_dword v42, v143, s[24:27], s37 offen offset:512 sc1
  buffer_store_dword v43, v143, s[24:27], s37 offen offset:768 sc1
  buffer_store_dword v44, v143, s[24:27], s37 offen offset:1024 sc1
  v_add_f32_dpp v136, v136, v136 row_ror:8 row_mask:0xf bank_mask:0xf
  s_nop 1
  v_add_f32_dpp v136, v136, v136 row_ror:4 row_mask:0xf bank_mask:0xf
  s_nop 1
  v_add_f32_dpp v136, v136, v136 row_ror:2 row_mask:0xf bank_mask:0xf
  s_nop 1
  v_add_f32_dpp v136, v136, v136 row_ror:1 row_mask:0xf bank_mask:0xf
  v_mov_b32 v140, v136
  s_nop 1
  v_permlane16_swap_b32 v136, v140
  v_add_f32 v136, v136, v140
  v_mov_b32 v140, v136
  s_nop 1
  v_permlane32_swap_b32 v136, v140
  v_add_f32 v136, v136, v140
  v_cvt_pk_bf16_f32 v136, v136, v136
  v_lshlrev_b32 v136, 16, v136
  v_ashrrev_i32 v140, 31, v136
  v_or_b32 v140, 0x80000000, v140
  v_xor_b32 v136, v136, v140
  v_and_b32 v136, 0xffff0000, v136
  s_sub_u32 s35, 2047, s40
  v_or_b32 v136, s35, v136
  s_lshr_b32 s35, s40, 2
  s_lshl_b32 s35, s35, 7
  s_lshl_b32 s36, s17, 2
  s_add_u32 s35, s35, s36
  s_add_u32 s35, s35, 2097152
  v_mov_b32 v141, s35
  s_waitcnt vmcnt(0)
  s_mov_b64 exec, 1
  buffer_store_dword v136, v141, s[8:11], 0 offen sc1
  s_mov_b64 exec, -1
  s_add_u32 s33, s33, 8
  s_cmp_lt_u32 s33, 128
  s_cbranch_scc1 r_loop
  s_endpgm
role_chain:
  s_load_dwordx2 s[20:21], s[0:1], 16
  s_mov_b32 s22, 7864320
  s_mov_b32 s23, 0x00020000
  s_load_dwordx2 s[24:25], s[0:1], 24
  s_mov_b32 s26, 7864320
  s_mov_b32 s27, 0x00020000
  s_load_dwordx2 s[28:29], s[0:1], 32
  s_mov_b32 s30, 7864320
  s_mov_b32 s31, 0x00020000
  s_load_dwordx2 s[32:33], s[0:1], 40
  s_mov_b32 s34, 7864320
  s_mov_b32 s35, 0x00020000
  s_mov_b32 s36, s18
  s_mul_i32 s37, s36, 43
  s_lshr_b32 s37, s37, 7
  s_mul_i32 s42, s37, 3
  s_sub_u32 s38, s36, s42
  s_lshl_b32 s39, s16, 2
  s_add_u32 s39, s39, s37
  v_lshrrev_b32 v140, 4, v1
  v_and_b32 v140, 3, v140
  v_lshlrev_b32 v140, 1, v140
  v_and_b32 v4, 7, v1
  v_xor_b32 v4, v4, v140
  v_lshlrev_b32 v4, 4, v4
  v_lshrrev_b32 v140, 3, v1
  v_mul_u32_u24 v140, 12288, v140
  v_add_u32 v4, v4, v140
  s_lshl_b32 s42, s17, 1
  v_lshrrev_b32 v140, 2, v1
  v_lshrrev_b32 v141, 1, v140
  v_and_b32 v141, 3, v141
  v_lshlrev_b32 v141, 1, v141
  v_bfe_u32 v5, v1, 1, 1
  v_add_u32 v5, s42, v5
  v_xor_b32 v5, v5, v141
  v_lshlrev_b32 v5, 4, v5
  v_lshlrev_b32 v140, 7, v140
  v_add_u32 v5, v5, v140
  v_and_b32 v140, 1, v1
  v_lshlrev_b32 v140, 3, v140
  v_add_u32 v5, v5, v140
  v_add_u32 v6, 40960, v5
  v_add_u32 v7, 81920, v5
  v_add_u32 v8, 122880, v5
  s_mul_i32 s43, s39, 384
  s_lshl_b32 s42, s38, 7
  s_add_u32 s43, s43, s42
  s_mul_i32 s42, s17, 1966080
  s_add_u32 s43, s43, s42
  s_waitcnt lgkmcnt(0)
  s_mov_b32 s44, s43
  s_mul_i32 s45, s17, 20480
  s_add_u32 s45, s45, 0
  s_mov_b32 m0, s45
  s_add_u32 s45, s45, 1024
  buffer_load_dwordx4 v4, s[20:23], s44 offen lds
  s_add_u32 s44, s44, 98304
  s_mov_b32 m0, s45
  s_add_u32 s45, s45, 1024
  buffer_load_dwordx4 v4, s[20:23], s44 offen lds
  s_add_u32 s44, s44, 98304
  s_mov_b32 m0, s45
  s_add_u32 s45, s45, 1024
  buffer_load_dwordx4 v4, s[20:23], s44 offen lds
  s_add_u32 s44, s44, 98304
  s_mov_b32 m0, s45
  s_add_u32 s45, s45, 1024
  buffer_load_dwordx4 v4, s[20:23], s44 offen lds
  s_add_u32 s44, s44, 98304
  s_mov_b32 m0, s45
  s_add_u32 s45, s45, 1024
  buffer_load_dwordx4 v4, s[20:23], s44 offen lds
  s_add_u32 s44, s44, 98304
  s_mov_b32 m0, s45
  s_add_u32 s45, s45, 1024
  buffer_load_dwordx4 v4, s[20:23], s44 offen lds
  s_add_u32 s44, s44, 98304
  s_mov_b32 m0, s45
  s_add_u32 s45, s45, 1024
  buffer_load_dwordx4 v4, s[20:23], s44 offen lds
  s_add_u32 s44, s44, 98304
  s_mov_b32 m0, s45
  s_add_u32 s45, s45, 1024
  buffer_load_dwordx4 v4, s[20:23], s44 offen lds
  s_add_u32 s44, s44, 98304
  s_mov_b32 m0, s45
  s_add_u32 s45, s45, 1024
  buffer_load_dwordx4 v4, s[20:23], s44 offen lds
  s_add_u32 s44, s44, 98304
  s_mov_b32 m0, s45
  s_add_u32 s45, s45, 1024
  buffer_load_dwordx4 v4, s[20:23], s44 offen lds
  s_add_u32 s44, s44, 98304
  s_mov_b32 m0, s45
  s_add_u32 s45, s45, 1024
  buffer_load_dwordx4 v4, s[20:23], s44 offen lds
  s_add_u32 s44, s44, 98304
  s_mov_b32 m0, s45
  s_add_u32 s45, s45, 1024
  buffer_load_dwordx4 v4, s[20:23], s44 offen lds
  s_add_u32 s44, s44, 98304
  s_mov_b32 m0, s45
  s_add_u32 s45, s45, 1024
  buffer_load_dwordx4 v4, s[20:23], s44 offen lds
  s_add_u32 s44, s44, 98304
  s_mov_b32 m0, s45
  s_add_u32 s45, s45, 1024
  buffer_load_dwordx4 v4, s[20:23], s44 offen lds
  s_add_u32 s44, s44, 98304
  s_mov_b32 m0, s45
  s_add_u32 s45, s45, 1024
  buffer_load_dwordx4 v4, s[20:23], s44 offen lds
  s_add_u32 s44, s44, 98304
  s_mov_b32 m0, s45
  s_add_u32 s45, s45, 1024
  buffer_load_dwordx4 v4, s[20:23], s44 offen lds
  s_add_u32 s44, s44, 98304
  s_mov_b32 m0, s45
  s_add_u32 s45, s45, 1024
  buffer_load_dwordx4 v4, s[20:23], s44 offen lds
  s_add_u32 s44, s44, 98304
  s_mov_b32 m0, s45
  s_add_u32 s45, s45, 1024
  buffer_load_dwordx4 v4, s[20:23], s44 offen lds
  s_add_u32 s44, s44, 98304
  s_mov_b32 m0, s45
  s_add_u32 s45, s45, 1024
  buffer_load_dwordx4 v4, s[20:23], s44 offen lds
  s_add_u32 s44, s44, 98304
  s_mov_b32 m0, s45
  s_add_u32 s45, s45, 1024
  buffer_load_dwordx4 v4, s[20:23], s44 offen lds
  s_add_u32 s44, s44, 98304
  s_mov_b32 s44, s43
  s_mul_i32 s45, s17, 20480
  s_add_u32 s45, s45, 81920
  s_mov_b32 m0, s45
  s_add_u32 s45, s45, 1024
  buffer_load_dwordx4 v4, s[24:27], s44 offen lds
  s_add_u32 s44, s44, 98304
  s_mov_b32 m0, s45
  s_add_u32 s45, s45, 1024
  buffer_load_dwordx4 v4, s[24:27], s44 offen lds
  s_add_u32 s44, s44, 98304
  s_mov_b32 m0, s45
  s_add_u32 s45, s45, 1024
  buffer_load_dwordx4 v4, s[24:27], s44 offen lds
  s_add_u32 s44, s44, 98304
  s_mov_b32 m0, s45
  s_add_u32 s45, s45, 1024
  buffer_load_dwordx4 v4, s[24:27], s44 offen lds
  s_add_u32 s44, s44, 98304
  s_mov_b32 m0, s45
  s_add_u32 s45, s45, 1024
  buffer_load_dwordx4 v4, s[24:27], s44 offen lds
  s_add_u32 s44, s44, 98304
  s_mov_b32 m0, s45
  s_add_u32 s45, s45, 1024
  buffer_load_dwordx4 v4, s[24:27], s44 offen lds
  s_add_u32 s44, s44, 98304
  s_mov_b32 m0, s45
  s_add_u32 s45, s45, 1024
  buffer_load_dwordx4 v4, s[24:27], s44 offen lds
  s_add_u32 s44, s44, 98304
  s_mov_b32 m0, s45
  s_add_u32 s45, s45, 1024
  buffer_load_dwordx4 v4, s[24:27], s44 offen lds
  s_add_u32 s44, s44, 98304
  s_mov_b32 m0, s45
  s_add_u32 s45, s45, 1024
  buffer_load_dwordx4 v4, s[24:27], s44 offen lds
  s_add_u32 s44, s44, 98304
  s_mov_b32 m0, s45
  s_add_u32 s45, s45, 1024
  buffer_load_dwordx4 v4, s[24:27], s44 offen lds
  s_add_u32 s44, s44, 98304
  s_mov_b32 m0, s45
  s_add_u32 s45, s45, 1024
  buffer_load_dwordx4 v4, s[24:27], s44 offen lds
  s_add_u32 s44, s44, 98304
  s_mov_b32 m0, s45
  s_add_u32 s45, s45, 1024
  buffer_load_dwordx4 v4, s[24:27], s44 offen lds
  s_add_u32 s44, s44, 98304
  s_mov_b32 m0, s45
  s_add_u32 s45, s45, 1024
  buffer_load_dwordx4 v4, s[24:27], s44 offen lds
  s_add_u32 s44, s44, 98304
  s_mov_b32 m0, s45
  s_add_u32 s45, s45, 1024
  buffer_load_dwordx4 v4, s[24:27], s44 offen lds
  s_add_u32 s44, s44, 98304
  s_mov_b32 m0, s45
  s_add_u32 s45, s45, 1024
  buffer_load_dwordx4 v4, s[24:27], s44 offen lds
  s_add_u32 s44, s44, 98304
  s_mov_b32 m0, s45
  s_add_u32 s45, s45, 1024
  buffer_load_dwordx4 v4, s[24:27], s44 offen lds
  s_add_u32 s44, s44, 98304
  s_mov_b32 m0, s45
  s_add_u32 s45, s45, 1024
  buffer_load_dwordx4 v4, s[24:27], s44 offen lds
  s_add_u32 s44, s44, 98304
  s_mov_b32 m0, s45
  s_add_u32 s45, s45, 1024
  buffer_load_dwordx4 v4, s[24:27], s44 offen lds
  s_add_u32 s44, s44, 98304
  s_mov_b32 m0, s45
  s_add_u32 s45, s45, 1024
  buffer_load_dwordx4 v4, s[24:27], s44 offen lds
  s_add_u32 s44, s44, 98304
  s_mov_b32 m0, s45
  s_add_u32 s45, s45, 1024
  buffer_load_dwordx4 v4, s[24:27], s44 offen lds
  s_add_u32 s44, s44, 98304
  s_waitcnt vmcnt(20)
  s_barrier
  ds_read_b64_tr_b16 a[0:1], v5 offset:0
  ds_read_b64_tr_b16 a[2:3], v5 offset:2048
  ds_read_b64_tr_b16 a[4:5], v5 offset:4096
  ds_read_b64_tr_b16 a[6:7], v5 offset:6144
  ds_read_b64_tr_b16 a[8:9], v5 offset:8192
  ds_read_b64_tr_b16 a[10:11], v5 offset:10240
  ds_read_b64_tr_b16 a[12:13], v5 offset:12288
  ds_read_b64_tr_b16 a[14:15], v5 offset:14336
  ds_read_b64_tr_b16 a[16:17], v5 offset:16384
  ds_read_b64_tr_b16 a[18:19], v5 offset:18432
  ds_read_b64_tr_b16 a[20:21], v5 offset:20480
  ds_read_b64_tr_b16 a[22:23], v5 offset:22528
  ds_read_b64_tr_b16 a[24:25], v5 offset:24576
  ds_read_b64_tr_b16 a[26:27], v5 offset:26624
  ds_read_b64_tr_b16 a[28:29], v5 offset:28672
  ds_read_b64_tr_b16 a[30:31], v5 offset:30720
  ds_read_b64_tr_b16 a[32:33], v5 offset:32768
  ds_read_b64_tr_b16 a[34:35], v5 offset:34816
  ds_read_b64_tr_b16 a[36:37], v5 offset:36864
  ds_read_b64_tr_b16 a[38:39], v5 offset:38912
  ds_read_b64_tr_b16 a[40:41], v6 offset:0
  ds_read_b64_tr_b16 a[42:43], v6 offset:2048
  ds_read_b64_tr_b16 a[44:45], v6 offset:4096
  ds_read_b64_tr_b16 a[46:47], v6 offset:6144
  ds_read_b64_tr_b16 a[48:49], v6 offset:8192
  ds_read_b64_tr_b16 a[50:51], v6 offset:10240
  ds_read_b64_tr_b16 a[52:53], v6 offset:12288
  ds_read_b64_tr_b16 a[54:55], v6 offset:14336
  ds_read_b64_tr_b16 a[56:57], v6 offset:16384
  ds_read_b64_tr_b16 a[58:59], v6 offset:18432
  ds_read_b64_tr_b16 a[60:61], v6 offset:20480
  ds_read_b64_tr_b16 a[62:63], v6 offset:22528
  ds_read_b64_tr_b16 a[64:65], v6 offset:24576
  ds_read_b64_tr_b16 a[66:67], v6 offset:26624
  ds_read_b64_tr_b16 a[68:69], v6 offset:28672
  ds_read_b64_tr_b16 a[70:71], v6 offset:30720
  ds_read_b64_tr_b16 a[72:73], v6 offset:32768
  ds_read_b64_tr_b16 a[74:75], v6 offset:34816
  ds_read_b64_tr_b16 a[76:77], v6 offset:36864
  ds_read_b64_tr_b16 a[78:79], v6 offset:38912
  s_waitcnt lgkmcnt(0)
  s_barrier
  s_mov_b32 s44, s43
  s_mul_i32 s45, s17, 20480
  s_add_u32 s45, s45, 0
  s_mov_b32 m0, s45
  s_add_u32 s45, s45, 1024
  buffer_load_dwordx4 v4, s[28:31], s44 offen lds
  s_add_u32 s44, s44, 98304
  s_mov_b32 m0, s45
  s_add_u32 s45, s45, 1024
  buffer_load_dwordx4 v4, s[28:31], s44 offen lds
  s_add_u32 s44, s44, 98304
  s_mov_b32 m0, s45
  s_add_u32 s45, s45, 1024
  buffer_load_dwordx4 v4, s[28:31], s44 offen lds
  s_add_u32 s44, s44, 98304
  s_mov_b32 m0, s45
  s_add_u32 s45, s45, 1024
  buffer_load_dwordx4 v4, s[28:31], s44 offen lds
  s_add_u32 s44, s44, 98304
  s_mov_b32 m0, s45
  s_add_u32 s45, s45, 1024
  buffer_load_dwordx4 v4, s[28:31], s44 offen lds
  s_add_u32 s44, s44, 98304
  s_mov_b32 m0, s45
  s_add_u32 s45, s45, 1024
  buffer_load_dwordx4 v4, s[28:31], s44 offen lds
  s_add_u32 s44, s44, 98304
  s_mov_b32 m0, s45
  s_add_u32 s45, s45, 1024
  buffer_load_dwordx4 v4, s[28:31], s44 offen lds
  s_add_u32 s44, s44, 98304
  s_mov_b32 m0, s45
  s_add_u32 s45, s45, 1024
  buffer_load_dwordx4 v4, s[28:31], s44 offen lds
  s_add_u32 s44, s44, 98304
  s_mov_b32 m0, s45
  s_add_u32 s45, s45, 1024
  buffer_load_dwordx4 v4, s[28:31], s44 offen lds
  s_add_u32 s44, s44, 98304
  s_mov_b32 m0, s45
  s_add_u32 s45, s45, 1024
  buffer_load_dwordx4 v4, s[28:31], s44 offen lds
  s_add_u32 s44, s44, 98304
  s_mov_b32 m0, s45
  s_add_u32 s45, s45, 1024
  buffer_load_dwordx4 v4, s[28:31], s44 offen lds
  s_add_u32 s44, s44, 98304
  s_mov_b32 m0, s45
  s_add_u32 s45, s45, 1024
  buffer_load_dwordx4 v4, s[28:31], s44 offen lds
  s_add_u32 s44, s44, 98304
  s_mov_b32 m0, s45
  s_add_u32 s45, s45, 1024
  buffer_load_dwordx4 v4, s[28:31], s44 offen lds
  s_add_u32 s44, s44, 98304
  s_mov_b32 m0, s45
  s_add_u32 s45, s45, 1024
  buffer_load_dwordx4 v4, s[28:31], s44 offen lds
  s_add_u32 s44, s44, 98304
  s_mov_b32 m0, s45
  s_add_u32 s45, s45, 1024
  buffer_load_dwordx4 v4, s[28:31], s44 offen lds
  s_add_u32 s44, s44, 98304
  s_mov_b32 m0, s45
  s_add_u32 s45, s45, 1024
  buffer_load_dwordx4 v4, s[28:31], s44 offen lds
  s_add_u32 s44, s44, 98304
  s_mov_b32 m0, s45
  s_add_u32 s45, s45, 1024
  buffer_load_dwordx4 v4, s[28:31], s44 offen lds
  s_add_u32 s44, s44, 98304
  s_mov_b32 m0, s45
  s_add_u32 s45, s45, 1024
  buffer_load_dwordx4 v4, s[28:31], s44 offen lds
  s_add_u32 s44, s44, 98304
  s_mov_b32 m0, s45
  s_add_u32 s45, s45, 1024
  buffer_load_dwordx4 v4, s[28:31], s44 offen lds
  s_add_u32 s44, s44, 98304
  s_mov_b32 m0, s45
  s_add_u32 s45, s45, 1024
  buffer_load_dwordx4 v4, s[28:31], s44 offen lds
  s_add_u32 s44, s44, 98304
  s_waitcnt vmcnt(20)
  s_barrier
  ds_read_b64_tr_b16 a[80:81], v7 offset:0
  ds_read_b64_tr_b16 a[82:83], v7 offset:2048
  ds_read_b64_tr_b16 a[84:85], v7 offset:4096
  ds_read_b64_tr_b16 a[86:87], v7 offset:6144
  ds_read_b64_tr_b16 a[88:89], v7 offset:8192
  ds_read_b64_tr_b16 a[90:91], v7 offset:10240
  ds_read_b64_tr_b16 a[92:93], v7 offset:12288
  ds_read_b64_tr_b16 a[94:95], v7 offset:14336
  ds_read_b64_tr_b16 a[96:97], v7 offset:16384
  ds_read_b64_tr_b16 a[98:99], v7 offset:18432
  ds_read_b64_tr_b16 a[100:101], v7 offset:20480
  ds_read_b64_tr_b16 a[102:103], v7 offset:22528
  ds_read_b64_tr_b16 a[104:105], v7 offset:24576
  ds_read_b64_tr_b16 a[106:107], v7 offset:26624
  ds_read_b64_tr_b16 a[108:109], v7 offset:28672
  ds_read_b64_tr_b16 a[110:111], v7 offset:30720
  ds_read_b64_tr_b16 a[112:113], v7 offset:32768
  ds_read_b64_tr_b16 a[114:115], v7 offset:34816
  ds_read_b64_tr_b16 a[116:117], v7 offset:36864
  ds_read_b64_tr_b16 a[118:119], v7 offset:38912
  ds_read_b64_tr_b16 a[120:121], v8 offset:0
  ds_read_b64_tr_b16 a[122:123], v8 offset:2048
  ds_read_b64_tr_b16 a[124:125], v8 offset:4096
  ds_read_b64_tr_b16 a[126:127], v8 offset:6144
  ds_read_b64_tr_b16 a[128:129], v8 offset:8192
  ds_read_b64_tr_b16 a[130:131], v8 offset:10240
  ds_read_b64_tr_b16 a[132:133], v8 offset:12288
  ds_read_b64_tr_b16 a[134:135], v8 offset:14336
  ds_read_b64_tr_b16 a[136:137], v8 offset:16384
  ds_read_b64_tr_b16 a[138:139], v8 offset:18432
  ds_read_b64_tr_b16 a[140:141], v8 offset:20480
  ds_read_b64_tr_b16 a[142:143], v8 offset:22528
  ds_read_b64_tr_b16 a[144:145], v8 offset:24576
  ds_read_b64_tr_b16 a[146:147], v8 offset:26624
  ds_read_b64_tr_b16 a[148:149], v8 offset:28672
  ds_read_b64_tr_b16 a[150:151], v8 offset:30720
  ds_read_b64_tr_b16 a[152:153], v8 offset:32768
  ds_read_b64_tr_b16 a[154:155], v8 offset:34816
  ds_read_b64_tr_b16 a[156:157], v8 offset:36864
  ds_read_b64_tr_b16 a[158:159], v8 offset:38912
  s_waitcnt lgkmcnt(0)
  s_barrier
  v_lshrrev_b32 v140, 4, v1
  v_and_b32 v140, 3, v140
  v_lshlrev_b32 v140, 1, v140
  v_and_b32 v9, 7, v1
  v_xor_b32 v9, v9, v140
  v_lshlrev_b32 v9, 4, v9
  v_lshrrev_b32 v140, 3, v1
  v_mul_u32_u24 v140, 0, v140
  v_add_u32 v9, v9, v140
  v_bfe_u32 v140, v1, 3, 2
  v_lshlrev_b32 v140, 2, v140
  v_bfe_u32 v141, v1, 5, 1
  v_lshl_add_u32 v140, v141, 1, v140
  v_mul_u32_u24 v140, 1280, v140
  v_add_u32 v9, v9, v140
  v_lshrrev_b32 v140, 2, v1
  v_lshrrev_b32 v141, 1, v140
  v_and_b32 v141, 3, v141
  v_lshlrev_b32 v141, 1, v141
  v_bfe_u32 v10, v1, 1, 1
  v_add_u32 v10, 0, v10
  v_xor_b32 v10, v10, v141
  v_lshlrev_b32 v10, 4, v10
  v_lshlrev_b32 v140, 7, v140
  v_add_u32 v10, v10, v140
  v_and_b32 v140, 1, v1
  v_lshlrev_b32 v140, 3, v140
  v_add_u32 v10, v10, v140
  v_lshrrev_b32 v140, 2, v1
  v_lshrrev_b32 v141, 1, v140
  v_and_b32 v141, 3, v141
  v_lshlrev_b32 v141, 1, v141
  v_bfe_u32 v11, v1, 1, 1
  v_add_u32 v11, 2, v11
  v_xor_b32 v11, v11, v141
  v_lshlrev_b32 v11, 4, v11
  v_lshlrev_b32 v140, 7, v140
  v_add_u32 v11, v11, v140
  v_and_b32 v140, 1, v1
  v_lshlrev_b32 v140, 3, v140
  v_add_u32 v11, v11, v140
  v_lshrrev_b32 v140, 2, v1
  v_lshrrev_b32 v141, 1, v140
  v_and_b32 v141, 3, v141
  v_lshlrev_b32 v141, 1, v141
  v_bfe_u32 v12, v1, 1, 1
  v_add_u32 v12, 4, v12
  v_xor_b32 v12, v12, v141
  v_lshlrev_b32 v12, 4, v12
  v_lshlrev_b32 v140, 7, v140
  v_add_u32 v12, v12, v140
  v_and_b32 v140, 1, v1
  v_lshlrev_b32 v140, 3, v140
  v_add_u32 v12, v12, v140
  v_lshrrev_b32 v140, 2, v1
  v_lshrrev_b32 v141, 1, v140
  v_and_b32 v141, 3, v141
  v_lshlrev_b32 v141, 1, v141
  v_bfe_u32 v13, v1, 1, 1
  v_add_u32 v13, 6, v13
  v_xor_b32 v13, v13, v141
  v_lshlrev_b32 v13, 4, v13
  v_lshlrev_b32 v140, 7, v140
  v_add_u32 v13, v13, v140
  v_and_b32 v140, 1, v1
  v_lshlrev_b32 v140, 3, v140
  v_add_u32 v13, v13, v140
  s_mul_i32 s45, s17, 20480
  s_add_u32 s45, s45, 81920
  v_add_u32 v10, s45, v10
  v_add_u32 v11, s45, v11
  v_add_u32 v12, s45, v12
  v_add_u32 v13, s45, v13
  s_lshl_b32 s42, s16, 2
  s_add_u32 s42, s42, s17
  s_mul_i32 s44, s42, 245760
  s_min_u32 s42, s36, 9
  s_lshl_b32 s42, s42, 7
  s_add_u32 s44, s44, s42
  s_mov_b32 m0, s45
  s_add_u32 s42, s44, 0
  s_add_u32 s45, s45, 1024
  buffer_load_dwordx4 v9, s[32:35], s42 offen lds
  s_mov_b32 m0, s45
  s_add_u32 s42, s44, 20480
  s_add_u32 s45, s45, 1024
  buffer_load_dwordx4 v9, s[32:35], s42 offen lds
  s_mov_b32 m0, s45
  s_add_u32 s42, s44, 1280
  s_add_u32 s45, s45, 1024
  buffer_load_dwordx4 v9, s[32:35], s42 offen lds
  s_mov_b32 m0, s45
  s_add_u32 s42, s44, 21760
  s_add_u32 s45, s45, 1024
  buffer_load_dwordx4 v9, s[32:35], s42 offen lds
  s_mov_b32 m0, s45
  s_add_u32 s42, s44, 40960
  s_add_u32 s45, s45, 1024
  buffer_load_dwordx4 v9, s[32:35], s42 offen lds
  s_mov_b32 m0, s45
  s_add_u32 s42, s44, 61440
  s_add_u32 s45, s45, 1024
  buffer_load_dwordx4 v9, s[32:35], s42 offen lds
  s_mov_b32 m0, s45
  s_add_u32 s42, s44, 42240
  s_add_u32 s45, s45, 1024
  buffer_load_dwordx4 v9, s[32:35], s42 offen lds
  s_mov_b32 m0, s45
  s_add_u32 s42, s44, 62720
  s_add_u32 s45, s45, 1024
  buffer_load_dwordx4 v9, s[32:35], s42 offen lds
  s_mov_b32 m0, s45
  s_add_u32 s42, s44, 81920
  s_add_u32 s45, s45, 1024
  buffer_load_dwordx4 v9, s[32:35], s42 offen lds
  s_mov_b32 m0, s45
  s_add_u32 s42, s44, 102400
  s_add_u32 s45, s45, 1024
  buffer_load_dwordx4 v9, s[32:35], s42 offen lds
  s_mov_b32 m0, s45
  s_add_u32 s42, s44, 83200
  s_add_u32 s45, s45, 1024
  buffer_load_dwordx4 v9, s[32:35], s42 offen lds
  s_mov_b32 m0, s45
  s_add_u32 s42, s44, 103680
  s_add_u32 s45, s45, 1024
  buffer_load_dwordx4 v9, s[32:35], s42 offen lds
  s_mov_b32 m0, s45
  s_add_u32 s42, s44, 122880
  s_add_u32 s45, s45, 1024
  buffer_load_dwordx4 v9, s[32:35], s42 offen lds
  s_mov_b32 m0, s45
  s_add_u32 s42, s44, 143360
  s_add_u32 s45, s45, 1024
  buffer_load_dwordx4 v9, s[32:35], s42 offen lds
  s_mov_b32 m0, s45
  s_add_u32 s42, s44, 124160
  s_add_u32 s45, s45, 1024
  buffer_load_dwordx4 v9, s[32:35], s42 offen lds
  s_mov_b32 m0, s45
  s_add_u32 s42, s44, 144640
  s_add_u32 s45, s45, 1024
  buffer_load_dwordx4 v9, s[32:35], s42 offen lds
  s_mov_b32 m0, s45
  s_add_u32 s42, s44, 163840
  s_add_u32 s45, s45, 1024
  buffer_load_dwordx4 v9, s[32:35], s42 offen lds
  s_mov_b32 m0, s45
  s_add_u32 s42, s44, 184320
  s_add_u32 s45, s45, 1024
  buffer_load_dwordx4 v9, s[32:35], s42 offen lds
  s_mov_b32 m0, s45
  s_add_u32 s42, s44, 165120
  s_add_u32 s45, s45, 1024
  buffer_load_dwordx4 v9, s[32:35], s42 offen lds
  s_mov_b32 m0, s45
  s_add_u32 s42, s44, 185600
  s_add_u32 s45, s45, 1024
  buffer_load_dwordx4 v9, s[32:35], s42 offen lds
  s_waitcnt vmcnt(20)
  s_barrier
  ds_read_b64_tr_b16 a[160:161], v5 offset:0
  ds_read_b64_tr_b16 a[162:163], v5 offset:2048
  ds_read_b64_tr_b16 a[164:165], v5 offset:4096
  ds_read_b64_tr_b16 a[166:167], v5 offset:6144
  ds_read_b64_tr_b16 a[168:169], v5 offset:8192
  ds_read_b64_tr_b16 a[170:171], v5 offset:10240
  ds_read_b64_tr_b16 a[172:173], v5 offset:12288
  ds_read_b64_tr_b16 a[174:175], v5 offset:14336
  ds_read_b64_tr_b16 a[176:177], v5 offset:16384
  ds_read_b64_tr_b16 a[178:179], v5 offset:18432
  ds_read_b64_tr_b16 a[180:181], v5 offset:20480
  ds_read_b64_tr_b16 a[182:183], v5 offset:22528
  ds_read_b64_tr_b16 a[184:185], v5 offset:24576
  ds_read_b64_tr_b16 a[186:187], v5 offset:26624
  ds_read_b64_tr_b16 a[188:189], v5 offset:28672
  ds_read_b64_tr_b16 a[190:191], v5 offset:30720
  ds_read_b64_tr_b16 a[192:193], v5 offset:32768
  ds_read_b64_tr_b16 a[194:195], v5 offset:34816
  ds_read_b64_tr_b16 a[196:197], v5 offset:36864
  ds_read_b64_tr_b16 a[198:199], v5 offset:38912
  ds_read_b64_tr_b16 a[200:201], v6 offset:0
  ds_read_b64_tr_b16 a[202:203], v6 offset:2048
  ds_read_b64_tr_b16 a[204:205], v6 offset:4096
  ds_read_b64_tr_b16 a[206:207], v6 offset:6144
  ds_read_b64_tr_b16 a[208:209], v6 offset:8192
  ds_read_b64_tr_b16 a[210:211], v6 offset:10240
  ds_read_b64_tr_b16 a[212:213], v6 offset:12288
  ds_read_b64_tr_b16 a[214:215], v6 offset:14336
  ds_read_b64_tr_b16 a[216:217], v6 offset:16384
  ds_read_b64_tr_b16 a[218:219], v6 offset:18432
  ds_read_b64_tr_b16 a[220:221], v6 offset:20480
  ds_read_b64_tr_b16 a[222:223], v6 offset:22528
  ds_read_b64_tr_b16 a[224:225], v6 offset:24576
  ds_read_b64_tr_b16 a[226:227], v6 offset:26624
  ds_read_b64_tr_b16 a[228:229], v6 offset:28672
  ds_read_b64_tr_b16 a[230:231], v6 offset:30720
  ds_read_b64_tr_b16 a[232:233], v6 offset:32768
  ds_read_b64_tr_b16 a[234:235], v6 offset:34816
  ds_read_b64_tr_b16 a[236:237], v6 offset:36864
  ds_read_b64_tr_b16 a[238:239], v6 offset:38912
  s_waitcnt vmcnt(0)
  ds_read_b64_tr_b16 v[176:177], v10 offset:0
  ds_read_b64_tr_b16 v[178:179], v10 offset:2048
  ds_read_b64_tr_b16 v[200:201], v11 offset:0
  ds_read_b64_tr_b16 v[202:203], v11 offset:2048
  ds_read_b64_tr_b16 v[224:225], v12 offset:0
  ds_read_b64_tr_b16 v[226:227], v12 offset:2048
  ds_read_b64_tr_b16 v[248:249], v13 offset:0
  ds_read_b64_tr_b16 v[250:251], v13 offset:2048
  ds_read_b64_tr_b16 v[180:181], v10 offset:4096
  ds_read_b64_tr_b16 v[182:183], v10 offset:6144
  ds_read_b64_tr_b16 v[204:205], v11 offset:4096
  ds_read_b64_tr_b16 v[206:207], v11 offset:6144
  ds_read_b64_tr_b16 v[228:229], v12 offset:4096
  ds_read_b64_tr_b16 v[230:231], v12 offset:6144
  ds_read_b64_tr_b16 v[252:253], v13 offset:4096
  ds_read_b64_tr_b16 v[254:255], v13 offset:6144
  ds_read_b64_tr_b16 v[184:185], v10 offset:8192
  ds_read_b64_tr_b16 v[186:187], v10 offset:10240
  ds_read_b64_tr_b16 v[208:209], v11 offset:8192
  ds_read_b64_tr_b16 v[210:211], v11 offset:10240
  ds_read_b64_tr_b16 v[232:233], v12 offset:8192
  ds_read_b64_tr_b16 v[234:235], v12 offset:10240
  ds_read_b64_tr_b16 a[240:241], v13 offset:8192
  ds_read_b64_tr_b16 a[242:243], v13 offset:10240
  ds_read_b64_tr_b16 v[188:189], v10 offset:12288
  ds_read_b64_tr_b16 v[190:191], v10 offset:14336
  ds_read_b64_tr_b16 v[212:213], v11 offset:12288
  ds_read_b64_tr_b16 v[214:215], v11 offset:14336
  ds_read_b64_tr_b16 v[236:237], v12 offset:12288
  ds_read_b64_tr_b16 v[238:239], v12 offset:14336
  ds_read_b64_tr_b16 a[244:245], v13 offset:12288
  ds_read_b64_tr_b16 a[246:247], v13 offset:14336
  ds_read_b64_tr_b16 v[192:193], v10 offset:16384
  ds_read_b64_tr_b16 v[194:195], v10 offset:18432
  ds_read_b64_tr_b16 v[216:217], v11 offset:16384
  ds_read_b64_tr_b16 v[218:219], v11 offset:18432
  ds_read_b64_tr_b16 v[240:241], v12 offset:16384
  ds_read_b64_tr_b16 v[242:243], v12 offset:18432
  ds_read_b64_tr_b16 a[248:249], v13 offset:16384
  ds_read_b64_tr_b16 a[250:251], v13 offset:18432
  s_waitcnt lgkmcnt(0)
  s_sub_u32 s45, s45, 20480
  s_mov_b32 m0, s45
  s_add_u32 s42, s44, 204800
  s_add_u32 s45, s45, 1024
  buffer_load_dwordx4 v9, s[32:35], s42 offen lds
  s_mov_b32 m0, s45
  s_add_u32 s42, s44, 225280
  s_add_u32 s45, s45, 1024
  buffer_load_dwordx4 v9, s[32:35], s42 offen lds
  s_mov_b32 m0, s45
  s_add_u32 s42, s44, 206080
  s_add_u32 s45, s45, 1024
  buffer_load_dwordx4 v9, s[32:35], s42 offen lds
  s_mov_b32 m0, s45
  s_add_u32 s42, s44, 226560
  s_add_u32 s45, s45, 1024
  buffer_load_dwordx4 v9, s[32:35], s42 offen lds
  s_waitcnt vmcnt(0)
  ds_read_b64_tr_b16 v[196:197], v10 offset:0
  ds_read_b64_tr_b16 v[198:199], v10 offset:2048
  ds_read_b64_tr_b16 v[220:221], v11 offset:0
  ds_read_b64_tr_b16 v[222:223], v11 offset:2048
  ds_read_b64_tr_b16 v[244:245], v12 offset:0
  ds_read_b64_tr_b16 v[246:247], v12 offset:2048
  ds_read_b64_tr_b16 a[252:253], v13 offset:0
  ds_read_b64_tr_b16 a[254:255], v13 offset:2048
  s_waitcnt lgkmcnt(0)
  s_barrier
  v_mov_b32 v84, -1
  v_mov_b32 v88, 0x3f803f80
  v_mov_b32 v85, -1
  v_mov_b32 v89, 0x3f803f80
  v_mov_b32 v86, -1
  v_mov_b32 v90, 0x3f803f80
  v_mov_b32 v87, -1
  v_mov_b32 v91, 0x3f803f80
  v_lshlrev_b32 v124, 4, v1
  v_lshlrev_b32 v125, 3, v1
  s_mul_i32 s42, s17, 2560
  v_add_u32 v126, s42, v124
  s_add_u32 s42, s42, 2048
  v_add_u32 v127, s42, v125
  v_lshrrev_b32 v4, 4, v1
  v_and_b32 v5, 7, v1
  v_bfe_u32 v6, v1, 3, 1
  v_and_b32 v7, 15, v1
  v_bfe_u32 v140, v1, 1, 1
  v_mul_u32_u24 v140, 0xaaaa, v140
  v_add_u32 v136, 0x4444, v140
  v_bfe_u32 v140, v1, 2, 1
  v_mov_b32 v137, 0x05040100
  v_mov_b32 v141, 0x03020706
  v_cmp_eq_u32 vcc, 1, v140
  s_nop 1
  v_cndmask_b32 v137, v137, v141, vcc
  s_lshl_b32 s42, s17, 9
  s_add_u32 s42, s42, 10240
  v_lshlrev_b32 v140, 5, v7
  v_lshl_add_u32 v140, v4, 2, v140
  v_add_u32 v128, s42, v140
  v_lshl_add_u32 v129, v4, 2, v128
  v_add_u32 v129, 2048, v129
  s_lshl_b32 s42, s17, 8
  v_lshl_add_u32 v130, v1, 2, s42
  s_lshl_b32 s42, s36, 10
  v_add_u32 v133, s42, v130
  s_lshl_b32 s42, s38, 10
  s_lshl_b32 s43, s38, 2
  s_add_u32 s43, s43, 3072
  s_cmp_lt_u32 s17, 2
  s_cselect_b32 s56, s42, s43
  s_add_u32 s43, s42, 4096
  s_cmp_eq_u32 s17, 0
  s_cselect_b32 s79, s42, s43
  s_cmp_eq_u32 s17, 2
  s_cselect_b32 s79, 3072, s79
  v_bfe_u32 v140, v1, 2, 2
  v_lshlrev_b32 v140, 1, v140
  v_and_b32 v141, 1, v1
  v_add_u32 v140, v140, v141
  v_lshl_add_u32 v140, v4, 3, v140
  v_lshlrev_b32 v140, 4, v140
  v_add_u32 v138, s42, v140
  v_lshl_add_u32 v142, v4, 3, v5
  v_lshlrev_b32 v142, 4, v142
  s_lshl_b32 s42, s17, 11
  s_add_u32 s42, s42, 14336
  v_add_u32 v131, s42, v142
  s_lshr_b32 s42, s17, 1
  s_lshl_b32 s42, s42, 10
  s_and_b32 s43, s17, 1
  s_lshl_b32 s43, s43, 8
  s_add_u32 s42, s42, s43
  s_add_u32 s42, s42, 14336
  v_and_b32 v140, 3, v1
  v_lshlrev_b32 v140, 5, v140
  v_bfe_u32 v141, v1, 4, 1
  v_lshl_add_u32 v140, v141, 4, v140
  v_bfe_u32 v141, v1, 5, 1
  v_lshl_add_u32 v140, v141, 3, v140
  v_bfe_u32 v141, v1, 2, 1
  v_lshl_add_u32 v140, v141, 9, v140
  v_bfe_u32 v141, v1, 3, 1
  v_lshl_add_u32 v140, v141, 7, v140
  v_add_u32 v132, s42, v140
  s_mov_b32 s66, 0x00ff00ff
  s_mov_b32 s67, 0x00ff00ff
  s_mov_b32 s68, 0xff00ff00
  s_mov_b32 s69, 0xff00ff00
  s_cmp_eq_u32 s17, 0
  s_cselect_b64 s[70:71], s[66:67], s[68:69]
  s_mul_i32 s46, s16, 10240
  s_add_u32 s46, s46, 131072
  s_add_u32 s47, s46, 81920
  s_lshl_b32 s42, s16, 17
  s_add_u32 s42, s42, 393216
  s_lshl_b32 s43, s37, 13
  s_add_u32 s48, s42, s43
  s_lshl_b32 s43, s17, 13
  s_add_u32 s49, s42, s43
  s_lshl_b32 s44, s16, 22
  s_add_u32 s44, s44, 67108864
  s_mul_i32 s24, s37, 3072
  s_add_u32 s24, s24, s44
  s_add_u32 s24, s24, 1384448
  s_mul_i32 s59, s37, 12288
  s_add_u32 s59, s59, s44
  s_add_u32 s59, s59, 49152
  s_and_b32 s42, s17, 1
  s_mul_i32 s42, s42, 6144
  s_add_u32 s59, s59, s42
  s_lshl_b32 s42, s38, 11
  s_add_u32 s59, s59, s42
  s_mul_i32 s26, s17, 40960
  s_add_u32 s26, s26, s44
  s_add_u32 s26, s26, 1179648
  s_lshl_b32 s43, s36, 12
  s_add_u32 s26, s26, s43
  s_mul_i32 s25, s17, 10240
  s_add_u32 s25, s25, s44
  s_add_u32 s25, s25, 1343488
  s_lshl_b32 s43, s36, 10
  s_add_u32 s25, s25, s43
  s_lshl_b32 s64, s36, 14
  s_lshl_b32 s42, s17, 11
  s_add_u32 s64, s64, s42
  s_add_u32 s64, s64, 1441792
  s_lshl_b32 s42, s16, 8
  v_lshlrev_b32 v134, 2, v1
  v_add_u32 v134, s42, v134
  s_lshl_b32 s43, s36, 4
  s_add_u32 s42, s42, s43
  s_lshl_b32 s43, s17, 2
  s_add_u32 s42, s42, s43
  s_add_u32 s42, s42, 4096
  v_mov_b32 v135, s42
  v_mov_b32 v139, 0
  s_mov_b32 s40, 0
  v_and_b32 v140, 15, v1
  v_lshlrev_b32 v170, 2, v1
  v_and_b32 v141, 3, v1
  v_mov_b32 v142, 0
  v_mov_b32 v143, 0x3f80
  v_cmp_eq_u32 vcc, 0, v141
  s_nop 1
  v_cndmask_b32 v142, v142, v143, vcc
  v_mov_b32 v143, 0x3f800000
  v_cmp_eq_u32 vcc, 1, v141
  s_nop 1
  v_cndmask_b32 v142, v142, v143, vcc
  v_lshrrev_b32 v140, 2, v140
  v_mov_b32 v143, 0
  v_cmp_eq_u32 vcc, 0, v140
  s_nop 1
  v_cndmask_b32 v172, v143, v142, vcc
  v_cmp_eq_u32 vcc, 1, v140
  s_nop 1
  v_cndmask_b32 v173, v143, v142, vcc
  v_cmp_eq_u32 vcc, 2, v140
  s_nop 1
  v_cndmask_b32 v174, v143, v142, vcc
  v_cmp_eq_u32 vcc, 3, v140
  s_nop 1
  v_cndmask_b32 v175, v143, v142, vcc
  v_mov_b32 v168, 0x3f803f80
  v_mov_b32 v169, 0
  s_cmp_lt_u32 s36, 10
  s_cbranch_scc0 chain_nw
  s_cmp_lt_u32 s17, 2
  s_cbranch_scc1 chain_pro_c0w
  s_cmp_eq_u32 s17, 2
  s_cbranch_scc1 chain_pro_c1w
  s_branch chain_pro_c2w
chain_nw:
  s_cmp_lt_u32 s17, 2
  s_cbranch_scc1 chain_pro_c0n
  s_cmp_eq_u32 s17, 2
  s_cbranch_scc1 chain_pro_c1n
  s_branch chain_pro_c2n
chain_pro_c0w:
  s_lshl_b32 s42, s16, 8
  s_add_u32 s61, s64, s42
  s_add_u32 s61, s61, 491520
  s_mov_b32 s41, 0
  s_mov_b32 s62, -1
  s_mov_b32 s63, -1
cal_34:
  s_waitcnt vmcnt(0)
  s_memtime s[72:73]
  s_waitcnt lgkmcnt(0)
  buffer_store_dword v84, v170, s[8:11], s61 offen sc1
  s_waitcnt vmcnt(0)
  s_memtime s[74:75]
  s_waitcnt lgkmcnt(0)
  s_sub_u32 s42, s74, s72
  s_min_u32 s42, s42, s62
  s_mov_b32 s62, s63
  s_mov_b32 s63, s42
  s_xor_b32 s61, s61, 8192
  s_add_u32 s41, s41, 1
  s_cmp_lt_u32 s41, 8
  s_cbranch_scc1 cal_34
  s_cmp_lt_u32 s62, s63
  s_cselect_b32 s42, 0, 8192
  s_add_u32 s64, s64, s42
  s_mov_b32 s78, 1
  v_mov_b32 v143, 0
  s_mov_b32 s41, 0
cpw_35:
  v_cmp_gt_u32 vcc, s78, v139
  s_nop 0
  s_and_b32 vcc_lo, vcc_lo, 0xfff000
  s_and_b32 vcc_hi, vcc_hi, 0xfffff0
  s_cmp_eq_u64 vcc, 0
  s_cbranch_scc1 cpo_36
  s_sleep 1
  buffer_load_dword v139, v134, s[8:11], 0 offen sc1
  s_add_u32 s41, s41, 1
  s_cmp_gt_u32 s41, 65536
  s_cbranch_scc1 chain_abort
  s_waitcnt vmcnt(0)
  s_branch cpw_35
cpo_36:
  s_sub_u32 s42, s78, 1
  s_and_b32 s42, s42, 7
  s_mul_i32 s42, s42, 147456
  s_add_u32 s42, s42, s59
  buffer_load_dwordx4 v[60:63], v124, s[8:11], s42 offen offset:0 sc1
  buffer_load_dwordx4 v[64:67], v124, s[8:11], s42 offen offset:1024 sc1
  s_add_u32 s55, s48, 98304
  s_sub_u32 s43, s40, 1
  s_and_b32 s43, s43, 3
  s_mul_i32 s43, s43, 227328
  s_add_u32 s57, s24, s43
  s_add_u32 s58, s25, s43
  s_add_u32 s54, s55, s79
  s_and_b32 s42, s40, 3
  s_lshl_b32 s43, s42, 15
  s_add_u32 s52, s49, s43
  s_add_u32 s53, s52, 4096
  s_add_u32 s55, s48, s43
  s_add_u32 s50, s55, s56
  s_lshl_b32 s44, s38, 10
  s_add_u32 s51, s55, s44
  s_add_u32 s51, s51, 4096
  s_mul_i32 s60, s42, 227328
  s_add_u32 s60, s60, s26
  s_mul_i32 s62, s42, 163840
  s_add_u32 s62, s62, s64
  s_lshl_b32 s43, s16, 8
  s_add_u32 s61, s62, s43
  s_xor_b32 s63, s61, 8192
  v_mov_b32 v92, 0
  v_mov_b32 v93, 0
  v_mov_b32 v94, 0
  v_mov_b32 v95, 0
  v_mov_b32 v96, 0
  v_mov_b32 v97, 0
  v_mov_b32 v98, 0
  v_mov_b32 v99, 0
  v_mov_b32 v100, 0
  v_mov_b32 v101, 0
  v_mov_b32 v102, 0
  v_mov_b32 v103, 0
  v_mov_b32 v104, 0
  v_mov_b32 v105, 0
  v_mov_b32 v106, 0
  v_mov_b32 v107, 0
  v_mov_b32 v68, 0
  v_mov_b32 v69, 0
  v_mov_b32 v70, 0
  v_mov_b32 v71, 0
  v_mov_b32 v72, 0
  v_mov_b32 v73, 0
  v_mov_b32 v74, 0
  v_mov_b32 v75, 0
  v_mov_b32 v76, 0
  v_mov_b32 v77, 0
  v_mov_b32 v78, 0
  v_mov_b32 v79, 0
chain_loop_c0w:
  s_mov_b32 s41, 0
  buffer_load_dwordx4 v[152:155], v126, s[8:11], s46 offen sc1
  buffer_load_dwordx4 v[156:159], v126, s[8:11], s46 offen offset:1024 sc1
  buffer_load_dwordx2 v[160:161], v127, s[8:11], s46 offen sc1
  s_sleep 2
mq_37:
  buffer_load_dwordx4 v[162:165], v126, s[8:11], s46 offen sc1
  buffer_load_dwordx4 v[108:111], v126, s[8:11], s46 offen offset:1024 sc1
  buffer_load_dwordx2 v[112:113], v127, s[8:11], s46 offen sc1
  s_waitcnt vmcnt(3)
  v_max3_u32 v140, v152, v153, v154
  v_max3_u32 v141, v155, v156, v157
  v_max3_u32 v140, v140, v158, v159
  v_max3_u32 v141, v141, v160, v161
  v_max_u32 v140, v140, v141
  v_cmp_eq_u32 vcc, -1, v140
  s_cbranch_vccz mq_37_a
  buffer_load_dwordx4 v[152:155], v126, s[8:11], s46 offen sc1
  buffer_load_dwordx4 v[156:159], v126, s[8:11], s46 offen offset:1024 sc1
  buffer_load_dwordx2 v[160:161], v127, s[8:11], s46 offen sc1
  s_add_u32 s41, s41, 1
  s_cmp_gt_u32 s41, 65536
  s_cbranch_scc1 chain_abort
  s_waitcnt vmcnt(3)
  v_max3_u32 v140, v162, v163, v164
  v_max3_u32 v141, v165, v108, v109
  v_max3_u32 v140, v140, v110, v111
  v_max3_u32 v141, v141, v112, v113
  v_max_u32 v140, v140, v141
  v_cmp_eq_u32 vcc, -1, v140
  s_cbranch_vccnz mq_37
  ds_write_b128 v126, v[162:165]
  ds_write_b128 v126, v[108:111] offset:1024
  ds_write_b64 v127, v[112:113]
  s_branch mq_37_ok
mq_37_a:
  ds_write_b128 v126, v[152:155]
  ds_write_b128 v126, v[156:159] offset:1024
  ds_write_b64 v127, v[160:161]
mq_37_ok:
  s_waitcnt lgkmcnt(0)
  s_barrier
  ds_read_b128 v[4:7], v124 offset:0
  ds_read_b128 v[8:11], v124 offset:1024
  ds_read_b128 v[12:15], v124 offset:2048
  ds_read_b128 v[16:19], v124 offset:3072
  ds_read_b128 v[20:23], v124 offset:4096
  ds_read_b128 v[24:27], v124 offset:5120
  ds_read_b128 v[28:31], v124 offset:6144
  ds_read_b128 v[32:35], v124 offset:7168
  ds_read_b128 v[36:39], v124 offset:8192
  ds_read_b128 v[40:43], v124 offset:9216
  s_waitcnt lgkmcnt(9)
  v_smfmac_f32_16x16x64_bf16 v[68:71], v[4:7], a[0:7], v136
  v_smfmac_f32_16x16x64_bf16 v[72:75], v[4:7], a[80:87], v136
  buffer_load_dwordx4 v[44:47], v124, s[8:11], s60 offen offset:0 sc1
  s_waitcnt lgkmcnt(8)
  v_smfmac_f32_16x16x64_bf16 v[68:71], v[8:11], a[8:15], v136
  v_smfmac_f32_16x16x64_bf16 v[72:75], v[8:11], a[88:95], v136
  buffer_load_dwordx4 v[48:51], v124, s[8:11], s60 offen offset:1024 sc1
  s_waitcnt lgkmcnt(7)
  v_smfmac_f32_16x16x64_bf16 v[68:71], v[12:15], a[16:23], v136
  v_smfmac_f32_16x16x64_bf16 v[72:75], v[12:15], a[96:103], v136
  buffer_load_dwordx4 v[52:55], v124, s[8:11], s60 offen offset:2048 sc1
  s_waitcnt lgkmcnt(6)
  v_smfmac_f32_16x16x64_bf16 v[68:71], v[16:19], a[24:31], v136
  v_smfmac_f32_16x16x64_bf16 v[72:75], v[16:19], a[104:111], v136
  buffer_load_dwordx4 v[56:59], v124, s[8:11], s60 offen offset:3072 sc1
  s_waitcnt lgkmcnt(5)
  v_smfmac_f32_16x16x64_bf16 v[68:71], v[20:23], a[32:39], v136
  v_smfmac_f32_16x16x64_bf16 v[72:75], v[20:23], a[112:119], v136
  buffer_store_dwordx4 v[80:83], v124, s[8:11], s58 offen
  s_waitcnt lgkmcnt(4)
  v_smfmac_f32_16x16x64_bf16 v[68:71], v[24:27], a[40:47], v136
  v_smfmac_f32_16x16x64_bf16 v[72:75], v[24:27], a[120:127], v136
  buffer_store_dwordx4 v[84:87], v124, s[8:11], s54 offen
  s_waitcnt lgkmcnt(3)
  v_smfmac_f32_16x16x64_bf16 v[68:71], v[28:31], a[48:55], v136
  v_smfmac_f32_16x16x64_bf16 v[72:75], v[28:31], a[128:135], v136
  buffer_load_dword v139, v134, s[8:11], 0 offen sc1
  s_waitcnt lgkmcnt(2)
  v_smfmac_f32_16x16x64_bf16 v[68:71], v[32:35], a[56:63], v136
  v_smfmac_f32_16x16x64_bf16 v[72:75], v[32:35], a[136:143], v136
  s_waitcnt lgkmcnt(1)
  v_smfmac_f32_16x16x64_bf16 v[68:71], v[36:39], a[64:71], v136
  v_smfmac_f32_16x16x64_bf16 v[72:75], v[36:39], a[144:151], v136
  s_waitcnt lgkmcnt(0)
  v_smfmac_f32_16x16x64_bf16 v[68:71], v[40:43], a[72:79], v136
  v_smfmac_f32_16x16x64_bf16 v[72:75], v[40:43], a[152:159], v136
  v_smfmac_f32_16x16x64_bf16 v[76:79], v[4:7], a[160:167], v136
  v_smfmac_f32_16x16x64_bf16 v[76:79], v[8:11], a[168:175], v136
  s_nop 4
  v_add_f32 v68, v68, v70
  v_add_f32 v69, v69, v71
  v_add_f32 v72, v72, v74
  v_add_f32 v73, v73, v75
  v_smfmac_f32_16x16x64_bf16 v[76:79], v[12:15], a[176:183], v136
  v_cvt_pk_bf16_f32 v122, v68, v69
  v_cvt_pk_bf16_f32 v123, v72, v73
  ds_write2_b32 v128, v122, v122 offset0:0 offset1:4
  ds_write2_b32 v129, v123, v123 offset0:0 offset1:1
  v_smfmac_f32_16x16x64_bf16 v[76:79], v[16:19], a[184:191], v136
  v_smfmac_f32_16x16x64_bf16 v[76:79], v[20:23], a[192:199], v136
  s_waitcnt lgkmcnt(0)
  s_barrier
  ds_read_b64_tr_b16 v[144:145], v125 offset:10240
  ds_read_b64_tr_b16 v[146:147], v125 offset:10752
  ds_read_b64_tr_b16 v[148:149], v125 offset:11264
  ds_read_b64_tr_b16 v[150:151], v125 offset:11776
  v_smfmac_f32_16x16x64_bf16 v[76:79], v[24:27], a[200:207], v136
  v_smfmac_f32_16x16x64_bf16 v[76:79], v[28:31], a[208:215], v136
  v_smfmac_f32_16x16x64_bf16 v[76:79], v[32:35], a[216:223], v136
  s_waitcnt lgkmcnt(2)
  v_mfma_f32_16x16x32_bf16 v[80:83], v[60:63], v[144:147], 0
  s_waitcnt lgkmcnt(0)
  v_mfma_f32_16x16x32_bf16 v[80:83], v[64:67], v[148:151], v[80:83]
  v_smfmac_f32_16x16x64_bf16 v[76:79], v[36:39], a[224:231], v136
  v_smfmac_f32_16x16x64_bf16 v[76:79], v[40:43], a[232:239], v136
  s_mov_b64 exec, s[70:71]
  s_nop 4
  buffer_store_dwordx4 v[80:83], v124, s[8:11], s50 offen
  s_mov_b64 exec, -1
  v_add_f32 v76, v76, v78
  v_add_f32 v77, v77, v79
  v_cvt_pk_bf16_f32 v140, v76, v77
  s_nop 1
  v_mov_b32_dpp v141, v140 row_ror:4 row_mask:0xf bank_mask:0xa
  s_nop 1
  v_mov_b32_dpp v141, v140 row_ror:12 row_mask:0xf bank_mask:0x5
  v_perm_b32 v140, v141, v140, v137
  buffer_store_dword v140, v130, s[8:11], s51 offen
  s_sleep 2
  s_nop 3
  s_nop 3
  buffer_load_dwordx4 v[4:7], v124, s[8:11], s52 offen offset:0 sc1
  buffer_load_dwordx4 v[8:11], v124, s[8:11], s52 offen offset:1024 sc1
  buffer_load_dwordx4 v[12:15], v124, s[8:11], s52 offen offset:2048 sc1
  buffer_load_dwordx3 v[16:18], v124, s[8:11], s52 offen offset:3072 sc1
  buffer_load_dwordx4 v[20:23], v124, s[8:11], s53 offen offset:0 sc1
  buffer_load_dwordx4 v[24:27], v124, s[8:11], s53 offen offset:1024 sc1
  buffer_load_dwordx4 v[28:31], v124, s[8:11], s53 offen offset:2048 sc1
  s_mov_b32 s41, 0
  s_waitcnt vmcnt(3)
gs_38_in:
  v_pk_add_f32 v[152:153], v[4:5], v[8:9]
  v_pk_add_f32 v[154:155], v[6:7], v[10:11]
  v_add_f32 v156, v16, v17
  v_pk_add_f32 v[152:153], v[152:153], v[12:13]
  v_pk_add_f32 v[154:155], v[154:155], v[14:15]
  v_add_f32 v156, v156, v18
  v_cmp_u_f32 s[76:77], v152, v153
  v_cmp_u_f32 s[72:73], v154, v155
  v_cmp_u_f32 s[74:75], v156, v156
  v_max3_f32 v140, v152, v153, v154
  s_or_b64 s[72:73], s[76:77], s[72:73]
  v_max3_f32 v140, v140, v155, v156
  s_or_b64 s[72:73], s[72:73], s[74:75]
  s_waitcnt vmcnt(0)
  v_max3_u32 v142, v20, v21, v22
  v_max3_u32 v143, v23, v24, v25
  v_max3_u32 v142, v142, v26, v27
  v_max3_u32 v143, v143, v28, v29
  v_max3_u32 v142, v142, v30, v31
  v_max_u32 v142, v142, v143
  v_cmp_eq_u32 vcc, -1, v142
  s_nop 0
  s_or_b64 vcc, vcc, s[72:73]
  s_cbranch_vccnz gs_38
  v_smfmac_f32_16x16x64_bf16 v[92:95], v[20:23], v[176:183], v136
  v_max_f32_dpp v140, v140, v140 row_ror:8 row_mask:0xf bank_mask:0xf
  v_mov_b32 v141, v140
  v_smfmac_f32_16x16x64_bf16 v[96:99], v[20:23], v[200:207], v136
  v_mul_f32 v152, 0x3dd53b95, v152
  v_mul_f32 v153, 0x3dd53b95, v153
  v_smfmac_f32_16x16x64_bf16 v[100:103], v[20:23], v[224:231], v136
  v_permlane16_swap_b32 v140, v141
  v_max_f32 v140, v140, v141
  v_smfmac_f32_16x16x64_bf16 v[104:107], v[20:23], v[248:255], v136
  v_mov_b32 v141, v140
  v_mul_f32 v154, 0x3dd53b95, v154
  v_smfmac_f32_16x16x64_bf16 v[92:95], v[24:27], v[184:191], v136
  v_mul_f32 v155, 0x3dd53b95, v155
  v_permlane32_swap_b32 v140, v141
  v_smfmac_f32_16x16x64_bf16 v[96:99], v[24:27], v[208:215], v136
  v_max_f32 v140, v140, v141
  v_mul_f32 v156, 0x3dd53b95, v156
  v_smfmac_f32_16x16x64_bf16 v[100:103], v[24:27], v[232:239], v136
  v_mul_f32 v140, 0x3dd53b95, v140
  v_sub_f32 v156, v156, v140
  v_smfmac_f32_16x16x64_bf16 v[104:107], v[24:27], a[240:247], v136
  v_sub_f32 v152, v152, v140
  v_sub_f32 v153, v153, v140
  v_smfmac_f32_16x16x64_bf16 v[92:95], v[28:31], v[192:199], v136
  v_sub_f32 v154, v154, v140
  v_sub_f32 v155, v155, v140
  v_smfmac_f32_16x16x64_bf16 v[96:99], v[28:31], v[216:223], v136
  v_exp_f32 v156, v156
  v_exp_f32 v152, v152
  v_smfmac_f32_16x16x64_bf16 v[100:103], v[28:31], v[240:247], v136
  v_exp_f32 v153, v153
  v_exp_f32 v154, v154
  v_smfmac_f32_16x16x64_bf16 v[104:107], v[28:31], a[248:255], v136
  v_exp_f32 v155, v155
  v_mov_b32_dpp v157, v156 row_ror:8 row_mask:0xf bank_mask:0xf
  v_cvt_pk_bf16_f32 v116, v152, v153
  v_cvt_pk_bf16_f32 v117, v154, v155
  v_cvt_pk_bf16_f32 v120, v156, v157
  v_mov_b32_dpp v118, v116 row_ror:8 row_mask:0xf bank_mask:0xf
  v_mov_b32_dpp v119, v117 row_ror:8 row_mask:0xf bank_mask:0xf
  v_mov_b32 v121, v120
  s_nop 0
  v_mfma_f32_16x16x32_bf16 v[80:83], v[88:91], v[116:119], 0
  v_cvt_pk_bf16_f32 v108, v92, v93
  v_cvt_pk_bf16_f32 v109, v94, v95
  v_mfma_f32_16x16x32_bf16 v[152:155], v[44:47], v[116:119], 0
  v_cvt_pk_bf16_f32 v110, v96, v97
  v_cvt_pk_bf16_f32 v111, v98, v99
  v_mfma_f32_16x16x32_bf16 v[156:159], v[48:51], v[116:119], 0
  v_mfma_f32_16x16x16_bf16 v[80:83], v[168:169], v[120:121], v[80:83]
  v_cvt_pk_bf16_f32 v112, v100, v101
  v_cvt_pk_bf16_f32 v113, v102, v103
  v_mfma_f32_16x16x32_bf16 v[160:163], v[52:55], v[116:119], 0
  v_cvt_pk_bf16_f32 v114, v104, v105
  v_cvt_pk_bf16_f32 v115, v106, v107
  v_mfma_f32_16x16x32_bf16 v[164:167], v[56:59], v[116:119], 0
  s_add_u32 s40, s40, 1
  v_mfma_f32_16x16x16_bf16 v[152:155], v[108:109], v[120:121], v[152:155]
  v_mfma_f32_16x16x16_bf16 v[156:159], v[110:111], v[120:121], v[156:159]
  v_rcp_f32 v122, v80
  v_mfma_f32_16x16x16_bf16 v[160:163], v[112:113], v[120:121], v[160:163]
  s_nop 0
  v_mfma_f32_16x16x16_bf16 v[164:167], v[114:115], v[120:121], v[164:167]
  v_mov_b32 v123, v122
  s_cmp_eq_u32 s40, 64
  s_cbranch_scc1 chain_last_c0w
  s_mov_b64 exec, s[66:67]
  v_pk_mul_f32 v[152:153], v[122:123], v[152:153]
  v_pk_mul_f32 v[154:155], v[122:123], v[154:155]
  ds_write_b128 v131, v[152:155] offset:0
  v_pk_mul_f32 v[156:157], v[122:123], v[156:157]
  v_pk_mul_f32 v[158:159], v[122:123], v[158:159]
  ds_write_b128 v131, v[156:159] offset:512
  v_pk_mul_f32 v[160:161], v[122:123], v[160:161]
  v_pk_mul_f32 v[162:163], v[122:123], v[162:163]
  ds_write_b128 v131, v[160:163] offset:1024
  v_pk_mul_f32 v[164:165], v[122:123], v[164:165]
  v_pk_mul_f32 v[166:167], v[122:123], v[166:167]
  ds_write_b128 v131, v[164:167] offset:1536
  s_mov_b64 exec, -1
  s_waitcnt lgkmcnt(0)
  s_barrier
  ds_read_b64 v[144:145], v132 offset:0
  ds_read_b64 v[146:147], v132 offset:2048
  ds_read_b64 v[148:149], v132 offset:4096
  ds_read_b64 v[150:151], v132 offset:6144
  s_mov_b32 s45, s62
  s_waitcnt lgkmcnt(2)
  v_pk_add_f32 v[144:145], v[144:145], v[146:147]
  s_waitcnt lgkmcnt(0)
  v_pk_add_f32 v[148:149], v[148:149], v[150:151]
  v_pk_add_f32 v[122:123], v[144:145], v[148:149]
  v_cvt_pk_bf16_f32 v122, v122, v123
  buffer_store_dword v122, v170, s[8:11], s63 offen sc1
  buffer_store_dword v122, v170, s[8:11], s61 offen sc1
  s_add_u32 s78, s40, 1
  s_sub_u32 s42, s40, 1
  v_mov_b32 v143, s42
  buffer_store_dword v84, v133, s[8:11], s46 offen
  buffer_store_dword v143, v135, s[8:11], 0 offen
  s_mov_b32 s41, 0
cpw_40:
  v_cmp_gt_u32 vcc, s78, v139
  s_nop 0
  s_and_b32 vcc_lo, vcc_lo, 0xfff000
  s_and_b32 vcc_hi, vcc_hi, 0xfffff0
  s_cmp_eq_u64 vcc, 0
  s_cbranch_scc1 cpo_41
  s_sleep 1
  buffer_load_dword v139, v134, s[8:11], 0 offen sc1
  s_add_u32 s41, s41, 1
  s_cmp_gt_u32 s41, 65536
  s_cbranch_scc1 chain_abort
  s_waitcnt vmcnt(0)
  s_branch cpw_40
cpo_41:
  s_sub_u32 s42, s78, 1
  s_and_b32 s42, s42, 7
  s_mul_i32 s42, s42, 147456
  s_add_u32 s42, s42, s59
  buffer_load_dwordx4 v[60:63], v124, s[8:11], s42 offen offset:0 sc1
  buffer_load_dwordx4 v[64:67], v124, s[8:11], s42 offen offset:1024 sc1
  v_add_f32 v92, v92, v94
  v_add_f32 v93, v93, v95
  v_cvt_pk_bf16_f32 v80, v92, v93
  v_add_f32 v96, v96, v98
  v_add_f32 v97, v97, v99
  v_cvt_pk_bf16_f32 v81, v96, v97
  v_add_f32 v100, v100, v102
  v_add_f32 v101, v101, v103
  v_cvt_pk_bf16_f32 v82, v100, v101
  v_add_f32 v104, v104, v106
  v_add_f32 v105, v105, v107
  v_cvt_pk_bf16_f32 v83, v104, v105
  s_mov_b32 s42, s46
  s_mov_b32 s46, s47
  s_mov_b32 s47, s42
  s_sub_u32 s43, s40, 1
  s_and_b32 s43, s43, 3
  s_mul_i32 s43, s43, 227328
  s_add_u32 s57, s24, s43
  s_add_u32 s58, s25, s43
  s_add_u32 s54, s55, s79
  s_and_b32 s42, s40, 3
  s_lshl_b32 s43, s42, 15
  s_add_u32 s52, s49, s43
  s_add_u32 s53, s52, 4096
  s_add_u32 s55, s48, s43
  s_add_u32 s50, s55, s56
  s_lshl_b32 s44, s38, 10
  s_add_u32 s51, s55, s44
  s_add_u32 s51, s51, 4096
  s_mul_i32 s60, s42, 227328
  s_add_u32 s60, s60, s26
  s_mul_i32 s62, s42, 163840
  s_add_u32 s62, s62, s64
  s_lshl_b32 s43, s16, 8
  s_add_u32 s61, s62, s43
  s_xor_b32 s63, s61, 8192
  v_mov_b32 v92, 0
  v_mov_b32 v93, 0
  v_mov_b32 v94, 0
  v_mov_b32 v95, 0
  v_mov_b32 v96, 0
  v_mov_b32 v97, 0
  v_mov_b32 v98, 0
  v_mov_b32 v99, 0
  v_mov_b32 v100, 0
  v_mov_b32 v101, 0
  v_mov_b32 v102, 0
  v_mov_b32 v103, 0
  v_mov_b32 v104, 0
  v_mov_b32 v105, 0
  v_mov_b32 v106, 0
  v_mov_b32 v107, 0
  v_mov_b32 v68, 0
  v_mov_b32 v69, 0
  v_mov_b32 v70, 0
  v_mov_b32 v71, 0
  v_mov_b32 v72, 0
  v_mov_b32 v73, 0
  v_mov_b32 v74, 0
  v_mov_b32 v75, 0
  v_mov_b32 v76, 0
  v_mov_b32 v77, 0
  v_mov_b32 v78, 0
  v_mov_b32 v79, 0
  s_sleep 2
  buffer_load_dwordx4 v[4:7], v124, s[8:11], s45 offen offset:0 sc1
  buffer_load_dwordx4 v[8:11], v124, s[8:11], s45 offen offset:1024 sc1
  s_mov_b32 s41, 0
xp_42:
  s_waitcnt vmcnt(0)
  v_mfma_f32_16x16x32_bf16 v[36:39], v[172:175], v[4:7], 0
  v_mfma_f32_16x16x32_bf16 v[36:39], v[172:175], v[8:11], v[36:39]
  s_nop 7
  v_cmp_u_f32 vcc, v36, v37
  v_cvt_pk_bf16_f32 v141, v36, v37
  s_cbranch_vccnz xp_42_r
  buffer_store_dword v141, v133, s[8:11], s46 offen
  s_branch chain_loop_c0w
gs_38:
  v_max3_u32 v142, v4, v5, v6
  v_max_u32 v142, v142, v7
  v_cmp_eq_u32 vcc, -1, v142
  s_cbranch_vccz gs_38_s0
  s_mov_b64 exec, vcc
  buffer_load_dwordx4 v[4:7], v124, s[8:11], s52 offen offset:0 sc1
  s_mov_b64 exec, -1
gs_38_s0:
  v_max3_u32 v142, v8, v9, v10
  v_max_u32 v142, v142, v11
  v_cmp_eq_u32 vcc, -1, v142
  s_cbranch_vccz gs_38_s1
  s_mov_b64 exec, vcc
  buffer_load_dwordx4 v[8:11], v124, s[8:11], s52 offen offset:1024 sc1
  s_mov_b64 exec, -1
gs_38_s1:
  v_max3_u32 v142, v12, v13, v14
  v_max_u32 v142, v142, v15
  v_cmp_eq_u32 vcc, -1, v142
  s_cbranch_vccz gs_38_s2
  s_mov_b64 exec, vcc
  buffer_load_dwordx4 v[12:15], v124, s[8:11], s52 offen offset:2048 sc1
  s_mov_b64 exec, -1
gs_38_s2:
  v_max3_u32 v142, v16, v17, v18
  v_cmp_eq_u32 vcc, -1, v142
  s_cbranch_vccz gs_38_s3
  s_mov_b64 exec, vcc
  buffer_load_dwordx3 v[16:18], v124, s[8:11], s52 offen offset:3072 sc1
  s_mov_b64 exec, -1
gs_38_s3:
  v_max3_u32 v142, v20, v21, v22
  v_max_u32 v142, v142, v23
  v_cmp_eq_u32 vcc, -1, v142
  s_cbranch_vccz gs_38_s4
  s_mov_b64 exec, vcc
  buffer_load_dwordx4 v[20:23], v124, s[8:11], s53 offen offset:0 sc1
  s_mov_b64 exec, -1
gs_38_s4:
  v_max3_u32 v142, v24, v25, v26
  v_max_u32 v142, v142, v27
  v_cmp_eq_u32 vcc, -1, v142
  s_cbranch_vccz gs_38_s5
  s_mov_b64 exec, vcc
  buffer_load_dwordx4 v[24:27], v124, s[8:11], s53 offen offset:1024 sc1
  s_mov_b64 exec, -1
gs_38_s5:
  v_max3_u32 v142, v28, v29, v30
  v_max_u32 v142, v142, v31
  v_cmp_eq_u32 vcc, -1, v142
  s_cbranch_vccz gs_38_s6
  s_mov_b64 exec, vcc
  buffer_load_dwordx4 v[28:31], v124, s[8:11], s53 offen offset:2048 sc1
  s_mov_b64 exec, -1
gs_38_s6:
  s_add_u32 s41, s41, 1
  s_cmp_gt_u32 s41, 65536
  s_cbranch_scc1 chain_abort
  s_waitcnt vmcnt(0)
  s_branch gs_38_in
xp_42_r:
  v_max3_u32 v140, v4, v5, v6
  v_max_u32 v140, v140, v7
  v_cmp_eq_u32 vcc, -1, v140
  s_cbranch_vccz xp_42_s0
  s_mov_b64 exec, vcc
  buffer_load_dwordx4 v[4:7], v124, s[8:11], s45 offen offset:0 sc1
  s_mov_b64 exec, -1
xp_42_s0:
  v_max3_u32 v140, v8, v9, v10
  v_max_u32 v140, v140, v11
  v_cmp_eq_u32 vcc, -1, v140
  s_cbranch_vccz xp_42_s1
  s_mov_b64 exec, vcc
  buffer_load_dwordx4 v[8:11], v124, s[8:11], s45 offen offset:1024 sc1
  s_mov_b64 exec, -1
xp_42_s1:
  s_add_u32 s41, s41, 1
  s_cmp_gt_u32 s41, 65536
  s_cbranch_scc1 chain_abort
  s_branch xp_42
chain_last_c0w:
  s_sub_u32 s43, s40, 1
  s_and_b32 s43, s43, 3
  s_mul_i32 s43, s43, 227328
  s_add_u32 s57, s24, s43
  s_add_u32 s58, s25, s43
  v_add_f32 v92, v92, v94
  v_add_f32 v93, v93, v95
  v_cvt_pk_bf16_f32 v80, v92, v93
  v_add_f32 v96, v96, v98
  v_add_f32 v97, v97, v99
  v_cvt_pk_bf16_f32 v81, v96, v97
  v_add_f32 v100, v100, v102
  v_add_f32 v101, v101, v103
  v_cvt_pk_bf16_f32 v82, v100, v101
  v_add_f32 v104, v104, v106
  v_add_f32 v105, v105, v107
  v_cvt_pk_bf16_f32 v83, v104, v105
  buffer_store_dwordx4 v[80:83], v124, s[8:11], s58 offen
  v_mov_b32 v143, s40
  s_branch chain_fin
chain_pro_c1w:
  s_lshl_b32 s42, s16, 8
  s_add_u32 s61, s64, s42
  s_add_u32 s61, s61, 491520
  s_mov_b32 s41, 0
  s_mov_b32 s62, -1
  s_mov_b32 s63, -1
cal_43:
  s_waitcnt vmcnt(0)
  s_memtime s[72:73]
  s_waitcnt lgkmcnt(0)
  buffer_store_dword v84, v170, s[8:11], s61 offen sc1
  s_waitcnt vmcnt(0)
  s_memtime s[74:75]
  s_waitcnt lgkmcnt(0)
  s_sub_u32 s42, s74, s72
  s_min_u32 s42, s42, s62
  s_mov_b32 s62, s63
  s_mov_b32 s63, s42
  s_xor_b32 s61, s61, 8192
  s_add_u32 s41, s41, 1
  s_cmp_lt_u32 s41, 8
  s_cbranch_scc1 cal_43
  s_cmp_lt_u32 s62, s63
  s_cselect_b32 s42, 0, 8192
  s_add_u32 s64, s64, s42
  s_mov_b32 s78, 1
  v_mov_b32 v143, 0
  s_mov_b32 s41, 0
cpw_44:
  v_cmp_gt_u32 vcc, s78, v139
  s_nop 0
  s_and_b32 vcc_lo, vcc_lo, 0xfff000
  s_and_b32 vcc_hi, vcc_hi, 0xfffff0
  s_cmp_eq_u64 vcc, 0
  s_cbranch_scc1 cpo_45
  s_sleep 1
  buffer_load_dword v139, v134, s[8:11], 0 offen sc1
  s_add_u32 s41, s41, 1
  s_cmp_gt_u32 s41, 65536
  s_cbranch_scc1 chain_abort
  s_waitcnt vmcnt(0)
  s_branch cpw_44
cpo_45:
  s_add_u32 s55, s48, 98304
  s_sub_u32 s43, s40, 1
  s_and_b32 s43, s43, 3
  s_mul_i32 s43, s43, 227328
  s_add_u32 s57, s24, s43
  s_add_u32 s58, s25, s43
  s_add_u32 s54, s55, s79
  s_and_b32 s42, s40, 3
  s_lshl_b32 s43, s42, 15
  s_add_u32 s52, s49, s43
  s_add_u32 s53, s52, 4096
  s_add_u32 s55, s48, s43
  s_add_u32 s50, s55, s56
  s_lshl_b32 s44, s38, 10
  s_add_u32 s51, s55, s44
  s_add_u32 s51, s51, 4096
  s_mul_i32 s60, s42, 227328
  s_add_u32 s60, s60, s26
  s_mul_i32 s62, s42, 163840
  s_add_u32 s62, s62, s64
  s_lshl_b32 s43, s16, 8
  s_add_u32 s61, s62, s43
  s_xor_b32 s63, s61, 8192
  v_mov_b32 v92, 0
  v_mov_b32 v93, 0
  v_mov_b32 v94, 0
  v_mov_b32 v95, 0
  v_mov_b32 v96, 0
  v_mov_b32 v97, 0
  v_mov_b32 v98, 0
  v_mov_b32 v99, 0
  v_mov_b32 v100, 0
  v_mov_b32 v101, 0
  v_mov_b32 v102, 0
  v_mov_b32 v103, 0
  v_mov_b32 v104, 0
  v_mov_b32 v105, 0
  v_mov_b32 v106, 0
  v_mov_b32 v107, 0
  v_mov_b32 v68, 0
  v_mov_b32 v69, 0
  v_mov_b32 v70, 0
  v_mov_b32 v71, 0
  v_mov_b32 v72, 0
  v_mov_b32 v73, 0
  v_mov_b32 v74, 0
  v_mov_b32 v75, 0
  v_mov_b32 v76, 0
  v_mov_b32 v77, 0
  v_mov_b32 v78, 0
  v_mov_b32 v79, 0
chain_loop_c1w:
  s_mov_b32 s41, 0
  buffer_load_dwordx4 v[152:155], v126, s[8:11], s46 offen sc1
  buffer_load_dwordx4 v[156:159], v126, s[8:11], s46 offen offset:1024 sc1
  buffer_load_dwordx2 v[160:161], v127, s[8:11], s46 offen sc1
  s_sleep 2
mq_46:
  buffer_load_dwordx4 v[162:165], v126, s[8:11], s46 offen sc1
  buffer_load_dwordx4 v[108:111], v126, s[8:11], s46 offen offset:1024 sc1
  buffer_load_dwordx2 v[112:113], v127, s[8:11], s46 offen sc1
  s_waitcnt vmcnt(3)
  v_max3_u32 v140, v152, v153, v154
  v_max3_u32 v141, v155, v156, v157
  v_max3_u32 v140, v140, v158, v159
  v_max3_u32 v141, v141, v160, v161
  v_max_u32 v140, v140, v141
  v_cmp_eq_u32 vcc, -1, v140
  s_cbranch_vccz mq_46_a
  buffer_load_dwordx4 v[152:155], v126, s[8:11], s46 offen sc1
  buffer_load_dwordx4 v[156:159], v126, s[8:11], s46 offen offset:1024 sc1
  buffer_load_dwordx2 v[160:161], v127, s[8:11], s46 offen sc1
  s_add_u32 s41, s41, 1
  s_cmp_gt_u32 s41, 65536
  s_cbranch_scc1 chain_abort
  s_waitcnt vmcnt(3)
  v_max3_u32 v140, v162, v163, v164
  v_max3_u32 v141, v165, v108, v109
  v_max3_u32 v140, v140, v110, v111
  v_max3_u32 v141, v141, v112, v113
  v_max_u32 v140, v140, v141
  v_cmp_eq_u32 vcc, -1, v140
  s_cbranch_vccnz mq_46
  ds_write_b128 v126, v[162:165]
  ds_write_b128 v126, v[108:111] offset:1024
  ds_write_b64 v127, v[112:113]
  s_branch mq_46_ok
mq_46_a:
  ds_write_b128 v126, v[152:155]
  ds_write_b128 v126, v[156:159] offset:1024
  ds_write_b64 v127, v[160:161]
mq_46_ok:
  s_waitcnt lgkmcnt(0)
  s_barrier
  ds_read_b128 v[4:7], v124 offset:0
  ds_read_b128 v[8:11], v124 offset:1024
  ds_read_b128 v[12:15], v124 offset:2048
  ds_read_b128 v[16:19], v124 offset:3072
  ds_read_b128 v[20:23], v124 offset:4096
  ds_read_b128 v[24:27], v124 offset:5120
  ds_read_b128 v[28:31], v124 offset:6144
  ds_read_b128 v[32:35], v124 offset:7168
  ds_read_b128 v[36:39], v124 offset:8192
  ds_read_b128 v[40:43], v124 offset:9216
  s_waitcnt lgkmcnt(9)
  v_smfmac_f32_16x16x64_bf16 v[68:71], v[4:7], a[0:7], v136
  v_smfmac_f32_16x16x64_bf16 v[72:75], v[4:7], a[80:87], v136
  buffer_load_dwordx4 v[44:47], v124, s[8:11], s60 offen offset:0 sc1
  s_waitcnt lgkmcnt(8)
  v_smfmac_f32_16x16x64_bf16 v[68:71], v[8:11], a[8:15], v136
  v_smfmac_f32_16x16x64_bf16 v[72:75], v[8:11], a[88:95], v136
  buffer_load_dwordx4 v[48:51], v124, s[8:11], s60 offen offset:1024 sc1
  s_waitcnt lgkmcnt(7)
  v_smfmac_f32_16x16x64_bf16 v[68:71], v[12:15], a[16:23], v136
  v_smfmac_f32_16x16x64_bf16 v[72:75], v[12:15], a[96:103], v136
  buffer_load_dwordx4 v[52:55], v124, s[8:11], s60 offen offset:2048 sc1
  s_waitcnt lgkmcnt(6)
  v_smfmac_f32_16x16x64_bf16 v[68:71], v[16:19], a[24:31], v136
  v_smfmac_f32_16x16x64_bf16 v[72:75], v[16:19], a[104:111], v136
  buffer_load_dwordx4 v[56:59], v124, s[8:11], s60 offen offset:3072 sc1
  s_waitcnt lgkmcnt(5)
  v_smfmac_f32_16x16x64_bf16 v[68:71], v[20:23], a[32:39], v136
  v_smfmac_f32_16x16x64_bf16 v[72:75], v[20:23], a[112:119], v136
  buffer_store_dwordx4 v[80:83], v124, s[8:11], s58 offen
  s_waitcnt lgkmcnt(4)
  v_smfmac_f32_16x16x64_bf16 v[68:71], v[24:27], a[40:47], v136
  v_smfmac_f32_16x16x64_bf16 v[72:75], v[24:27], a[120:127], v136
  buffer_store_dwordx4 v[84:87], v124, s[8:11], s54 offen
  s_waitcnt lgkmcnt(3)
  v_smfmac_f32_16x16x64_bf16 v[68:71], v[28:31], a[48:55], v136
  v_smfmac_f32_16x16x64_bf16 v[72:75], v[28:31], a[128:135], v136
  buffer_load_dword v139, v134, s[8:11], 0 offen sc1
  s_waitcnt lgkmcnt(2)
  v_smfmac_f32_16x16x64_bf16 v[68:71], v[32:35], a[56:63], v136
  v_smfmac_f32_16x16x64_bf16 v[72:75], v[32:35], a[136:143], v136
  s_waitcnt lgkmcnt(1)
  v_smfmac_f32_16x16x64_bf16 v[68:71], v[36:39], a[64:71], v136
  v_smfmac_f32_16x16x64_bf16 v[72:75], v[36:39], a[144:151], v136
  s_waitcnt lgkmcnt(0)
  v_smfmac_f32_16x16x64_bf16 v[68:71], v[40:43], a[72:79], v136
  v_smfmac_f32_16x16x64_bf16 v[72:75], v[40:43], a[152:159], v136
  v_smfmac_f32_16x16x64_bf16 v[76:79], v[4:7], a[160:167], v136
  v_smfmac_f32_16x16x64_bf16 v[76:79], v[8:11], a[168:175], v136
  s_nop 4
  v_add_f32 v68, v68, v70
  v_add_f32 v69, v69, v71
  v_add_f32 v72, v72, v74
  v_add_f32 v73, v73, v75
  v_smfmac_f32_16x16x64_bf16 v[76:79], v[12:15], a[176:183], v136
  v_cvt_pk_bf16_f32 v122, v68, v69
  v_cvt_pk_bf16_f32 v123, v72, v73
  ds_write2_b32 v128, v122, v122 offset0:0 offset1:4
  ds_write2_b32 v129, v123, v123 offset0:0 offset1:1
  v_smfmac_f32_16x16x64_bf16 v[76:79], v[16:19], a[184:191], v136
  v_smfmac_f32_16x16x64_bf16 v[76:79], v[20:23], a[192:199], v136
  s_waitcnt lgkmcnt(0)
  s_barrier
  ds_read_b64_tr_b16 v[144:145], v125 offset:10240
  ds_read_b64_tr_b16 v[60:61], v125 offset:12288
  ds_read_b64_tr_b16 v[146:147], v125 offset:10752
  ds_read_b64_tr_b16 v[62:63], v125 offset:12800
  ds_read_b64_tr_b16 v[148:149], v125 offset:11264
  ds_read_b64_tr_b16 v[64:65], v125 offset:13312
  ds_read_b64_tr_b16 v[150:151], v125 offset:11776
  ds_read_b64_tr_b16 v[66:67], v125 offset:13824
  v_smfmac_f32_16x16x64_bf16 v[76:79], v[24:27], a[200:207], v136
  v_smfmac_f32_16x16x64_bf16 v[76:79], v[28:31], a[208:215], v136
  v_smfmac_f32_16x16x64_bf16 v[76:79], v[32:35], a[216:223], v136
  s_waitcnt lgkmcnt(4)
  v_mfma_f32_16x16x32_bf16 v[80:83], v[60:63], v[144:147], 0
  s_waitcnt lgkmcnt(0)
  v_mfma_f32_16x16x32_bf16 v[80:83], v[64:67], v[148:151], v[80:83]
  v_smfmac_f32_16x16x64_bf16 v[76:79], v[36:39], a[224:231], v136
  v_smfmac_f32_16x16x64_bf16 v[76:79], v[40:43], a[232:239], v136
  s_nop 5
  v_cndmask_b32 v80, v80, v81, s[68:69]
  buffer_store_dword v80, v124, s[8:11], s50 offen
  v_add_f32 v76, v76, v78
  v_add_f32 v77, v77, v79
  v_cvt_pk_bf16_f32 v140, v76, v77
  s_nop 1
  v_mov_b32_dpp v141, v140 row_ror:4 row_mask:0xf bank_mask:0xa
  s_nop 1
  v_mov_b32_dpp v141, v140 row_ror:12 row_mask:0xf bank_mask:0x5
  v_perm_b32 v140, v141, v140, v137
  buffer_store_dword v140, v130, s[8:11], s51 offen
  s_sleep 2
  s_nop 3
  s_nop 3
  buffer_load_dwordx4 v[4:7], v124, s[8:11], s52 offen offset:0 sc1
  buffer_load_dwordx4 v[8:11], v124, s[8:11], s52 offen offset:1024 sc1
  buffer_load_dwordx4 v[12:15], v124, s[8:11], s52 offen offset:2048 sc1
  buffer_load_dwordx3 v[16:18], v124, s[8:11], s52 offen offset:3072 sc1
  buffer_load_dwordx4 v[20:23], v124, s[8:11], s53 offen offset:0 sc1
  buffer_load_dwordx4 v[24:27], v124, s[8:11], s53 offen offset:1024 sc1
  buffer_load_dwordx4 v[28:31], v124, s[8:11], s53 offen offset:2048 sc1
  s_mov_b32 s41, 0
  s_waitcnt vmcnt(3)
gs_47_in:
  v_pk_add_f32 v[152:153], v[4:5], v[8:9]
  v_pk_add_f32 v[154:155], v[6:7], v[10:11]
  v_add_f32 v156, v16, v17
  v_pk_add_f32 v[152:153], v[152:153], v[12:13]
  v_pk_add_f32 v[154:155], v[154:155], v[14:15]
  v_add_f32 v156, v156, v18
  v_cmp_u_f32 s[76:77], v152, v153
  v_cmp_u_f32 s[72:73], v154, v155
  v_cmp_u_f32 s[74:75], v156, v156
  v_max3_f32 v140, v152, v153, v154
  s_or_b64 s[72:73], s[76:77], s[72:73]
  v_max3_f32 v140, v140, v155, v156
  s_or_b64 s[72:73], s[72:73], s[74:75]
  s_waitcnt vmcnt(0)
  v_max3_u32 v142, v20, v21, v22
  v_max3_u32 v143, v23, v24, v25
  v_max3_u32 v142, v142, v26, v27
  v_max3_u32 v143, v143, v28, v29
  v_max3_u32 v142, v142, v30, v31
  v_max_u32 v142, v142, v143
  v_cmp_eq_u32 vcc, -1, v142
  s_nop 0
  s_or_b64 vcc, vcc, s[72:73]
  s_cbranch_vccnz gs_47
  v_smfmac_f32_16x16x64_bf16 v[92:95], v[20:23], v[176:183], v136
  v_max_f32_dpp v140, v140, v140 row_ror:8 row_mask:0xf bank_mask:0xf
  v_mov_b32 v141, v140
  v_smfmac_f32_16x16x64_bf16 v[96:99], v[20:23], v[200:207], v136
  v_mul_f32 v152, 0x3dd53b95, v152
  v_mul_f32 v153, 0x3dd53b95, v153
  v_smfmac_f32_16x16x64_bf16 v[100:103], v[20:23], v[224:231], v136
  v_permlane16_swap_b32 v140, v141
  v_max_f32 v140, v140, v141
  v_smfmac_f32_16x16x64_bf16 v[104:107], v[20:23], v[248:255], v136
  v_mov_b32 v141, v140
  v_mul_f32 v154, 0x3dd53b95, v154
  v_smfmac_f32_16x16x64_bf16 v[92:95], v[24:27], v[184:191], v136
  v_mul_f32 v155, 0x3dd53b95, v155
  v_permlane32_swap_b32 v140, v141
  v_smfmac_f32_16x16x64_bf16 v[96:99], v[24:27], v[208:215], v136
  v_max_f32 v140, v140, v141
  v_mul_f32 v156, 0x3dd53b95, v156
  v_smfmac_f32_16x16x64_bf16 v[100:103], v[24:27], v[232:239], v136
  v_mul_f32 v140, 0x3dd53b95, v140
  v_sub_f32 v156, v156, v140
  v_smfmac_f32_16x16x64_bf16 v[104:107], v[24:27], a[240:247], v136
  v_sub_f32 v152, v152, v140
  v_sub_f32 v153, v153, v140
  v_smfmac_f32_16x16x64_bf16 v[92:95], v[28:31], v[192:199], v136
  v_sub_f32 v154, v154, v140
  v_sub_f32 v155, v155, v140
  v_smfmac_f32_16x16x64_bf16 v[96:99], v[28:31], v[216:223], v136
  v_exp_f32 v156, v156
  v_exp_f32 v152, v152
  v_smfmac_f32_16x16x64_bf16 v[100:103], v[28:31], v[240:247], v136
  v_exp_f32 v153, v153
  v_exp_f32 v154, v154
  v_smfmac_f32_16x16x64_bf16 v[104:107], v[28:31], a[248:255], v136
  v_exp_f32 v155, v155
  v_mov_b32_dpp v157, v156 row_ror:8 row_mask:0xf bank_mask:0xf
  v_cvt_pk_bf16_f32 v116, v152, v153
  v_cvt_pk_bf16_f32 v117, v154, v155
  v_cvt_pk_bf16_f32 v120, v156, v157
  v_mov_b32_dpp v118, v116 row_ror:8 row_mask:0xf bank_mask:0xf
  v_mov_b32_dpp v119, v117 row_ror:8 row_mask:0xf bank_mask:0xf
  v_mov_b32 v121, v120
  s_nop 0
  v_mfma_f32_16x16x32_bf16 v[80:83], v[88:91], v[116:119], 0
  v_cvt_pk_bf16_f32 v108, v92, v93
  v_cvt_pk_bf16_f32 v109, v94, v95
  v_mfma_f32_16x16x32_bf16 v[152:155], v[44:47], v[116:119], 0
  v_cvt_pk_bf16_f32 v110, v96, v97
  v_cvt_pk_bf16_f32 v111, v98, v99
  v_mfma_f32_16x16x32_bf16 v[156:159], v[48:51], v[116:119], 0
  v_mfma_f32_16x16x16_bf16 v[80:83], v[168:169], v[120:121], v[80:83]
  v_cvt_pk_bf16_f32 v112, v100, v101
  v_cvt_pk_bf16_f32 v113, v102, v103
  v_mfma_f32_16x16x32_bf16 v[160:163], v[52:55], v[116:119], 0
  v_cvt_pk_bf16_f32 v114, v104, v105
  v_cvt_pk_bf16_f32 v115, v106, v107
  v_mfma_f32_16x16x32_bf16 v[164:167], v[56:59], v[116:119], 0
  s_add_u32 s40, s40, 1
  v_mfma_f32_16x16x16_bf16 v[152:155], v[108:109], v[120:121], v[152:155]
  v_mfma_f32_16x16x16_bf16 v[156:159], v[110:111], v[120:121], v[156:159]
  v_rcp_f32 v122, v80
  v_mfma_f32_16x16x16_bf16 v[160:163], v[112:113], v[120:121], v[160:163]
  s_nop 0
  v_mfma_f32_16x16x16_bf16 v[164:167], v[114:115], v[120:121], v[164:167]
  v_mov_b32 v123, v122
  s_cmp_eq_u32 s40, 64
  s_cbranch_scc1 chain_last_c1w
  s_mov_b64 exec, s[66:67]
  v_pk_mul_f32 v[152:153], v[122:123], v[152:153]
  v_pk_mul_f32 v[154:155], v[122:123], v[154:155]
  ds_write_b128 v131, v[152:155] offset:0
  v_pk_mul_f32 v[156:157], v[122:123], v[156:157]
  v_pk_mul_f32 v[158:159], v[122:123], v[158:159]
  ds_write_b128 v131, v[156:159] offset:512
  v_pk_mul_f32 v[160:161], v[122:123], v[160:161]
  v_pk_mul_f32 v[162:163], v[122:123], v[162:163]
  ds_write_b128 v131, v[160:163] offset:1024
  v_pk_mul_f32 v[164:165], v[122:123], v[164:165]
  v_pk_mul_f32 v[166:167], v[122:123], v[166:167]
  ds_write_b128 v131, v[164:167] offset:1536
  s_mov_b64 exec, -1
  s_waitcnt lgkmcnt(0)
  s_barrier
  ds_read_b64 v[144:145], v132 offset:0
  ds_read_b64 v[146:147], v132 offset:2048
  ds_read_b64 v[148:149], v132 offset:4096
  ds_read_b64 v[150:151], v132 offset:6144
  s_mov_b32 s45, s62
  s_waitcnt lgkmcnt(2)
  v_pk_add_f32 v[144:145], v[144:145], v[146:147]
  s_waitcnt lgkmcnt(0)
  v_pk_add_f32 v[148:149], v[148:149], v[150:151]
  v_pk_add_f32 v[122:123], v[144:145], v[148:149]
  v_cvt_pk_bf16_f32 v122, v122, v123
  buffer_store_dword v122, v170, s[8:11], s63 offen sc1
  buffer_store_dword v122, v170, s[8:11], s61 offen sc1
  s_add_u32 s78, s40, 1
  s_sub_u32 s42, s40, 1
  v_mov_b32 v143, s42
  buffer_store_dword v84, v133, s[8:11], s46 offen
  buffer_store_dword v143, v135, s[8:11], 0 offen
  s_mov_b32 s41, 0
cpw_49:
  v_cmp_gt_u32 vcc, s78, v139
  s_nop 0
  s_and_b32 vcc_lo, vcc_lo, 0xfff000
  s_and_b32 vcc_hi, vcc_hi, 0xfffff0
  s_cmp_eq_u64 vcc, 0
  s_cbranch_scc1 cpo_50
  s_sleep 1
  buffer_load_dword v139, v134, s[8:11], 0 offen sc1
  s_add_u32 s41, s41, 1
  s_cmp_gt_u32 s41, 65536
  s_cbranch_scc1 chain_abort
  s_waitcnt vmcnt(0)
  s_branch cpw_49
cpo_50:
  v_add_f32 v92, v92, v94
  v_add_f32 v93, v93, v95
  v_cvt_pk_bf16_f32 v80, v92, v93
  v_add_f32 v96, v96, v98
  v_add_f32 v97, v97, v99
  v_cvt_pk_bf16_f32 v81, v96, v97
  v_add_f32 v100, v100, v102
  v_add_f32 v101, v101, v103
  v_cvt_pk_bf16_f32 v82, v100, v101
  v_add_f32 v104, v104, v106
  v_add_f32 v105, v105, v107
  v_cvt_pk_bf16_f32 v83, v104, v105
  s_mov_b32 s42, s46
  s_mov_b32 s46, s47
  s_mov_b32 s47, s42
  s_sub_u32 s43, s40, 1
  s_and_b32 s43, s43, 3
  s_mul_i32 s43, s43, 227328
  s_add_u32 s57, s24, s43
  s_add_u32 s58, s25, s43
  s_add_u32 s54, s55, s79
  s_and_b32 s42, s40, 3
  s_lshl_b32 s43, s42, 15
  s_add_u32 s52, s49, s43
  s_add_u32 s53, s52, 4096
  s_add_u32 s55, s48, s43
  s_add_u32 s50, s55, s56
  s_lshl_b32 s44, s38, 10
  s_add_u32 s51, s55, s44
  s_add_u32 s51, s51, 4096
  s_mul_i32 s60, s42, 227328
  s_add_u32 s60, s60, s26
  s_mul_i32 s62, s42, 163840
  s_add_u32 s62, s62, s64
  s_lshl_b32 s43, s16, 8
  s_add_u32 s61, s62, s43
  s_xor_b32 s63, s61, 8192
  v_mov_b32 v92, 0
  v_mov_b32 v93, 0
  v_mov_b32 v94, 0
  v_mov_b32 v95, 0
  v_mov_b32 v96, 0
  v_mov_b32 v97, 0
  v_mov_b32 v98, 0
  v_mov_b32 v99, 0
  v_mov_b32 v100, 0
  v_mov_b32 v101, 0
  v_mov_b32 v102, 0
  v_mov_b32 v103, 0
  v_mov_b32 v104, 0
  v_mov_b32 v105, 0
  v_mov_b32 v106, 0
  v_mov_b32 v107, 0
  v_mov_b32 v68, 0
  v_mov_b32 v69, 0
  v_mov_b32 v70, 0
  v_mov_b32 v71, 0
  v_mov_b32 v72, 0
  v_mov_b32 v73, 0
  v_mov_b32 v74, 0
  v_mov_b32 v75, 0
  v_mov_b32 v76, 0
  v_mov_b32 v77, 0
  v_mov_b32 v78, 0
  v_mov_b32 v79, 0
  s_sleep 2
  buffer_load_dwordx4 v[4:7], v124, s[8:11], s45 offen offset:0 sc1
  buffer_load_dwordx4 v[8:11], v124, s[8:11], s45 offen offset:1024 sc1
  s_mov_b32 s41, 0
xp_51:
  s_waitcnt vmcnt(0)
  v_mfma_f32_16x16x32_bf16 v[36:39], v[172:175], v[4:7], 0
  v_mfma_f32_16x16x32_bf16 v[36:39], v[172:175], v[8:11], v[36:39]
  s_nop 7
  v_cmp_u_f32 vcc, v36, v37
  v_cvt_pk_bf16_f32 v141, v36, v37
  s_cbranch_vccnz xp_51_r
  buffer_store_dword v141, v133, s[8:11], s46 offen
  s_branch chain_loop_c1w
gs_47:
  v_max3_u32 v142, v4, v5, v6
  v_max_u32 v142, v142, v7
  v_cmp_eq_u32 vcc, -1, v142
  s_cbranch_vccz gs_47_s0
  s_mov_b64 exec, vcc
  buffer_load_dwordx4 v[4:7], v124, s[8:11], s52 offen offset:0 sc1
  s_mov_b64 exec, -1
gs_47_s0:
  v_max3_u32 v142, v8, v9, v10
  v_max_u32 v142, v142, v11
  v_cmp_eq_u32 vcc, -1, v142
  s_cbranch_vccz gs_47_s1
  s_mov_b64 exec, vcc
  buffer_load_dwordx4 v[8:11], v124, s[8:11], s52 offen offset:1024 sc1
  s_mov_b64 exec, -1
gs_47_s1:
  v_max3_u32 v142, v12, v13, v14
  v_max_u32 v142, v142, v15
  v_cmp_eq_u32 vcc, -1, v142
  s_cbranch_vccz gs_47_s2
  s_mov_b64 exec, vcc
  buffer_load_dwordx4 v[12:15], v124, s[8:11], s52 offen offset:2048 sc1
  s_mov_b64 exec, -1
gs_47_s2:
  v_max3_u32 v142, v16, v17, v18
  v_cmp_eq_u32 vcc, -1, v142
  s_cbranch_vccz gs_47_s3
  s_mov_b64 exec, vcc
  buffer_load_dwordx3 v[16:18], v124, s[8:11], s52 offen offset:3072 sc1
  s_mov_b64 exec, -1
gs_47_s3:
  v_max3_u32 v142, v20, v21, v22
  v_max_u32 v142, v142, v23
  v_cmp_eq_u32 vcc, -1, v142
  s_cbranch_vccz gs_47_s4
  s_mov_b64 exec, vcc
  buffer_load_dwordx4 v[20:23], v124, s[8:11], s53 offen offset:0 sc1
  s_mov_b64 exec, -1
gs_47_s4:
  v_max3_u32 v142, v24, v25, v26
  v_max_u32 v142, v142, v27
  v_cmp_eq_u32 vcc, -1, v142
  s_cbranch_vccz gs_47_s5
  s_mov_b64 exec, vcc
  buffer_load_dwordx4 v[24:27], v124, s[8:11], s53 offen offset:1024 sc1
  s_mov_b64 exec, -1
gs_47_s5:
  v_max3_u32 v142, v28, v29, v30
  v_max_u32 v142, v142, v31
  v_cmp_eq_u32 vcc, -1, v142
  s_cbranch_vccz gs_47_s6
  s_mov_b64 exec, vcc
  buffer_load_dwordx4 v[28:31], v124, s[8:11], s53 offen offset:2048 sc1
  s_mov_b64 exec, -1
gs_47_s6:
  s_add_u32 s41, s41, 1
  s_cmp_gt_u32 s41, 65536
  s_cbranch_scc1 chain_abort
  s_waitcnt vmcnt(0)
  s_branch gs_47_in
xp_51_r:
  v_max3_u32 v140, v4, v5, v6
  v_max_u32 v140, v140, v7
  v_cmp_eq_u32 vcc, -1, v140
  s_cbranch_vccz xp_51_s0
  s_mov_b64 exec, vcc
  buffer_load_dwordx4 v[4:7], v124, s[8:11], s45 offen offset:0 sc1
  s_mov_b64 exec, -1
xp_51_s0:
  v_max3_u32 v140, v8, v9, v10
  v_max_u32 v140, v140, v11
  v_cmp_eq_u32 vcc, -1, v140
  s_cbranch_vccz xp_51_s1
  s_mov_b64 exec, vcc
  buffer_load_dwordx4 v[8:11], v124, s[8:11], s45 offen offset:1024 sc1
  s_mov_b64 exec, -1
xp_51_s1:
  s_add_u32 s41, s41, 1
  s_cmp_gt_u32 s41, 65536
  s_cbranch_scc1 chain_abort
  s_branch xp_51
chain_last_c1w:
  s_sub_u32 s43, s40, 1
  s_and_b32 s43, s43, 3
  s_mul_i32 s43, s43, 227328
  s_add_u32 s57, s24, s43
  s_add_u32 s58, s25, s43
  v_add_f32 v92, v92, v94
  v_add_f32 v93, v93, v95
  v_cvt_pk_bf16_f32 v80, v92, v93
  v_add_f32 v96, v96, v98
  v_add_f32 v97, v97, v99
  v_cvt_pk_bf16_f32 v81, v96, v97
  v_add_f32 v100, v100, v102
  v_add_f32 v101, v101, v103
  v_cvt_pk_bf16_f32 v82, v100, v101
  v_add_f32 v104, v104, v106
  v_add_f32 v105, v105, v107
  v_cvt_pk_bf16_f32 v83, v104, v105
  buffer_store_dwordx4 v[80:83], v124, s[8:11], s58 offen
  v_mov_b32 v143, s40
  s_branch chain_fin
chain_pro_c2w:
  s_lshl_b32 s42, s16, 8
  s_add_u32 s61, s64, s42
  s_add_u32 s61, s61, 491520
  s_mov_b32 s41, 0
  s_mov_b32 s62, -1
  s_mov_b32 s63, -1
cal_52:
  s_waitcnt vmcnt(0)
  s_memtime s[72:73]
  s_waitcnt lgkmcnt(0)
  buffer_store_dword v84, v170, s[8:11], s61 offen sc1
  s_waitcnt vmcnt(0)
  s_memtime s[74:75]
  s_waitcnt lgkmcnt(0)
  s_sub_u32 s42, s74, s72
  s_min_u32 s42, s42, s62
  s_mov_b32 s62, s63
  s_mov_b32 s63, s42
  s_xor_b32 s61, s61, 8192
  s_add_u32 s41, s41, 1
  s_cmp_lt_u32 s41, 8
  s_cbranch_scc1 cal_52
  s_cmp_lt_u32 s62, s63
  s_cselect_b32 s42, 0, 8192
  s_add_u32 s64, s64, s42
  s_mov_b32 s78, 1
  v_mov_b32 v143, 0
  s_mov_b32 s41, 0
cpw_53:
  v_cmp_gt_u32 vcc, s78, v139
  s_nop 0
  s_and_b32 vcc_lo, vcc_lo, 0xfff000
  s_and_b32 vcc_hi, vcc_hi, 0xfffff0
  s_cmp_eq_u64 vcc, 0
  s_cbranch_scc1 cpo_54
  s_sleep 1
  buffer_load_dword v139, v134, s[8:11], 0 offen sc1
  s_add_u32 s41, s41, 1
  s_cmp_gt_u32 s41, 65536
  s_cbranch_scc1 chain_abort
  s_waitcnt vmcnt(0)
  s_branch cpw_53
cpo_54:
  s_add_u32 s55, s48, 98304
  s_sub_u32 s43, s40, 1
  s_and_b32 s43, s43, 3
  s_mul_i32 s43, s43, 227328
  s_add_u32 s57, s24, s43
  s_add_u32 s58, s25, s43
  s_add_u32 s54, s55, s79
  s_and_b32 s42, s40, 3
  s_lshl_b32 s43, s42, 15
  s_add_u32 s52, s49, s43
  s_add_u32 s53, s52, 4096
  s_add_u32 s55, s48, s43
  s_add_u32 s50, s55, s56
  s_lshl_b32 s44, s38, 10
  s_add_u32 s51, s55, s44
  s_add_u32 s51, s51, 4096
  s_mul_i32 s60, s42, 227328
  s_add_u32 s60, s60, s26
  s_mul_i32 s62, s42, 163840
  s_add_u32 s62, s62, s64
  s_lshl_b32 s43, s16, 8
  s_add_u32 s61, s62, s43
  s_xor_b32 s63, s61, 8192
  v_mov_b32 v92, 0
  v_mov_b32 v93, 0
  v_mov_b32 v94, 0
  v_mov_b32 v95, 0
  v_mov_b32 v96, 0
  v_mov_b32 v97, 0
  v_mov_b32 v98, 0
  v_mov_b32 v99, 0
  v_mov_b32 v100, 0
  v_mov_b32 v101, 0
  v_mov_b32 v102, 0
  v_mov_b32 v103, 0
  v_mov_b32 v104, 0
  v_mov_b32 v105, 0
  v_mov_b32 v106, 0
  v_mov_b32 v107, 0
  v_mov_b32 v68, 0
  v_mov_b32 v69, 0
  v_mov_b32 v70, 0
  v_mov_b32 v71, 0
  v_mov_b32 v72, 0
  v_mov_b32 v73, 0
  v_mov_b32 v74, 0
  v_mov_b32 v75, 0
  v_mov_b32 v76, 0
  v_mov_b32 v77, 0
  v_mov_b32 v78, 0
  v_mov_b32 v79, 0
chain_loop_c2w:
  s_mov_b32 s41, 0
  buffer_load_dwordx4 v[152:155], v126, s[8:11], s46 offen sc1
  buffer_load_dwordx4 v[156:159], v126, s[8:11], s46 offen offset:1024 sc1
  buffer_load_dwordx2 v[160:161], v127, s[8:11], s46 offen sc1
  s_sleep 2
mq_55:
  buffer_load_dwordx4 v[162:165], v126, s[8:11], s46 offen sc1
  buffer_load_dwordx4 v[108:111], v126, s[8:11], s46 offen offset:1024 sc1
  buffer_load_dwordx2 v[112:113], v127, s[8:11], s46 offen sc1
  s_waitcnt vmcnt(3)
  v_max3_u32 v140, v152, v153, v154
  v_max3_u32 v141, v155, v156, v157
  v_max3_u32 v140, v140, v158, v159
  v_max3_u32 v141, v141, v160, v161
  v_max_u32 v140, v140, v141
  v_cmp_eq_u32 vcc, -1, v140
  s_cbranch_vccz mq_55_a
  buffer_load_dwordx4 v[152:155], v126, s[8:11], s46 offen sc1
  buffer_load_dwordx4 v[156:159], v126, s[8:11], s46 offen offset:1024 sc1
  buffer_load_dwordx2 v[160:161], v127, s[8:11], s46 offen sc1
  s_add_u32 s41, s41, 1
  s_cmp_gt_u32 s41, 65536
  s_cbranch_scc1 chain_abort
  s_waitcnt vmcnt(3)
  v_max3_u32 v140, v162, v163, v164
  v_max3_u32 v141, v165, v108, v109
  v_max3_u32 v140, v140, v110, v111
  v_max3_u32 v141, v141, v112, v113
  v_max_u32 v140, v140, v141
  v_cmp_eq_u32 vcc, -1, v140
  s_cbranch_vccnz mq_55
  ds_write_b128 v126, v[162:165]
  ds_write_b128 v126, v[108:111] offset:1024
  ds_write_b64 v127, v[112:113]
  s_branch mq_55_ok
mq_55_a:
  ds_write_b128 v126, v[152:155]
  ds_write_b128 v126, v[156:159] offset:1024
  ds_write_b64 v127, v[160:161]
mq_55_ok:
  s_waitcnt lgkmcnt(0)
  s_barrier
  ds_read_b128 v[4:7], v124 offset:0
  ds_read_b128 v[8:11], v124 offset:1024
  ds_read_b128 v[12:15], v124 offset:2048
  ds_read_b128 v[16:19], v124 offset:3072
  ds_read_b128 v[20:23], v124 offset:4096
  ds_read_b128 v[24:27], v124 offset:5120
  ds_read_b128 v[28:31], v124 offset:6144
  ds_read_b128 v[32:35], v124 offset:7168
  ds_read_b128 v[36:39], v124 offset:8192
  ds_read_b128 v[40:43], v124 offset:9216
  s_waitcnt lgkmcnt(9)
  v_smfmac_f32_16x16x64_bf16 v[68:71], v[4:7], a[0:7], v136
  v_smfmac_f32_16x16x64_bf16 v[72:75], v[4:7], a[80:87], v136
  buffer_load_dwordx4 v[44:47], v124, s[8:11], s60 offen offset:0 sc1
  s_waitcnt lgkmcnt(8)
  v_smfmac_f32_16x16x64_bf16 v[68:71], v[8:11], a[8:15], v136
  v_smfmac_f32_16x16x64_bf16 v[72:75], v[8:11], a[88:95], v136
  buffer_load_dwordx4 v[48:51], v124, s[8:11], s60 offen offset:1024 sc1
  s_waitcnt lgkmcnt(7)
  v_smfmac_f32_16x16x64_bf16 v[68:71], v[12:15], a[16:23], v136
  v_smfmac_f32_16x16x64_bf16 v[72:75], v[12:15], a[96:103], v136
  buffer_load_dwordx4 v[52:55], v124, s[8:11], s60 offen offset:2048 sc1
  s_waitcnt lgkmcnt(6)
  v_smfmac_f32_16x16x64_bf16 v[68:71], v[16:19], a[24:31], v136
  v_smfmac_f32_16x16x64_bf16 v[72:75], v[16:19], a[104:111], v136
  buffer_load_dwordx4 v[56:59], v124, s[8:11], s60 offen offset:3072 sc1
  s_waitcnt lgkmcnt(5)
  v_smfmac_f32_16x16x64_bf16 v[68:71], v[20:23], a[32:39], v136
  v_smfmac_f32_16x16x64_bf16 v[72:75], v[20:23], a[112:119], v136
  buffer_store_dwordx4 v[80:83], v124, s[8:11], s58 offen
  s_waitcnt lgkmcnt(4)
  v_smfmac_f32_16x16x64_bf16 v[68:71], v[24:27], a[40:47], v136
  v_smfmac_f32_16x16x64_bf16 v[72:75], v[24:27], a[120:127], v136
  buffer_store_dwordx4 v[60:63], v138, s[8:11], s57 offen
  s_waitcnt lgkmcnt(3)
  v_smfmac_f32_16x16x64_bf16 v[68:71], v[28:31], a[48:55], v136
  v_smfmac_f32_16x16x64_bf16 v[72:75], v[28:31], a[128:135], v136
  buffer_store_dwordx4 v[64:67], v138, s[8:11], s57 offen offset:512
  s_waitcnt lgkmcnt(2)
  v_smfmac_f32_16x16x64_bf16 v[68:71], v[32:35], a[56:63], v136
  v_smfmac_f32_16x16x64_bf16 v[72:75], v[32:35], a[136:143], v136
  buffer_load_dword v139, v134, s[8:11], 0 offen sc1
  s_waitcnt lgkmcnt(1)
  v_smfmac_f32_16x16x64_bf16 v[68:71], v[36:39], a[64:71], v136
  v_smfmac_f32_16x16x64_bf16 v[72:75], v[36:39], a[144:151], v136
  s_waitcnt lgkmcnt(0)
  v_smfmac_f32_16x16x64_bf16 v[68:71], v[40:43], a[72:79], v136
  v_smfmac_f32_16x16x64_bf16 v[72:75], v[40:43], a[152:159], v136
  v_smfmac_f32_16x16x64_bf16 v[76:79], v[4:7], a[160:167], v136
  v_smfmac_f32_16x16x64_bf16 v[76:79], v[8:11], a[168:175], v136
  s_nop 4
  v_add_f32 v68, v68, v70
  v_add_f32 v69, v69, v71
  v_add_f32 v72, v72, v74
  v_add_f32 v73, v73, v75
  v_smfmac_f32_16x16x64_bf16 v[76:79], v[12:15], a[176:183], v136
  v_cvt_pk_bf16_f32 v122, v68, v69
  v_cvt_pk_bf16_f32 v123, v72, v73
  ds_write2_b32 v128, v122, v122 offset0:0 offset1:4
  ds_write2_b32 v129, v123, v123 offset0:0 offset1:1
  v_smfmac_f32_16x16x64_bf16 v[76:79], v[16:19], a[184:191], v136
  v_smfmac_f32_16x16x64_bf16 v[76:79], v[20:23], a[192:199], v136
  s_waitcnt lgkmcnt(0)
  s_barrier
  ds_read_b64_tr_b16 v[60:61], v125 offset:12288
  ds_read_b64_tr_b16 v[62:63], v125 offset:12800
  ds_read_b64_tr_b16 v[64:65], v125 offset:13312
  ds_read_b64_tr_b16 v[66:67], v125 offset:13824
  v_smfmac_f32_16x16x64_bf16 v[76:79], v[24:27], a[200:207], v136
  v_smfmac_f32_16x16x64_bf16 v[76:79], v[28:31], a[208:215], v136
  v_smfmac_f32_16x16x64_bf16 v[76:79], v[32:35], a[216:223], v136
  v_smfmac_f32_16x16x64_bf16 v[76:79], v[36:39], a[224:231], v136
  v_smfmac_f32_16x16x64_bf16 v[76:79], v[40:43], a[232:239], v136
  s_nop 7
  v_add_f32 v76, v76, v78
  v_add_f32 v77, v77, v79
  v_cvt_pk_bf16_f32 v140, v76, v77
  s_nop 1
  v_mov_b32_dpp v141, v140 row_ror:4 row_mask:0xf bank_mask:0xa
  s_nop 1
  v_mov_b32_dpp v141, v140 row_ror:12 row_mask:0xf bank_mask:0x5
  v_perm_b32 v140, v141, v140, v137
  buffer_store_dword v140, v130, s[8:11], s51 offen
  s_sleep 4
  buffer_load_dwordx4 v[4:7], v124, s[8:11], s52 offen offset:0 sc1
  buffer_load_dwordx4 v[8:11], v124, s[8:11], s52 offen offset:1024 sc1
  buffer_load_dwordx4 v[12:15], v124, s[8:11], s52 offen offset:2048 sc1
  buffer_load_dwordx3 v[16:18], v124, s[8:11], s52 offen offset:3072 sc1
  buffer_load_dwordx4 v[20:23], v124, s[8:11], s53 offen offset:0 sc1
  buffer_load_dwordx4 v[24:27], v124, s[8:11], s53 offen offset:1024 sc1
  buffer_load_dwordx4 v[28:31], v124, s[8:11], s53 offen offset:2048 sc1
  s_mov_b32 s41, 0
  s_waitcnt vmcnt(3)
gs_56_in:
  v_pk_add_f32 v[152:153], v[4:5], v[8:9]
  v_pk_add_f32 v[154:155], v[6:7], v[10:11]
  v_add_f32 v156, v16, v17
  v_pk_add_f32 v[152:153], v[152:153], v[12:13]
  v_pk_add_f32 v[154:155], v[154:155], v[14:15]
  v_add_f32 v156, v156, v18
  v_cmp_u_f32 s[76:77], v152, v153
  v_cmp_u_f32 s[72:73], v154, v155
  v_cmp_u_f32 s[74:75], v156, v156
  v_max3_f32 v140, v152, v153, v154
  s_or_b64 s[72:73], s[76:77], s[72:73]
  v_max3_f32 v140, v140, v155, v156
  s_or_b64 s[72:73], s[72:73], s[74:75]
  s_waitcnt vmcnt(0)
  v_max3_u32 v142, v20, v21, v22
  v_max3_u32 v143, v23, v24, v25
  v_max3_u32 v142, v142, v26, v27
  v_max3_u32 v143, v143, v28, v29
  v_max3_u32 v142, v142, v30, v31
  v_max_u32 v142, v142, v143
  v_cmp_eq_u32 vcc, -1, v142
  s_nop 0
  s_or_b64 vcc, vcc, s[72:73]
  s_cbranch_vccnz gs_56
  v_smfmac_f32_16x16x64_bf16 v[92:95], v[20:23], v[176:183], v136
  v_max_f32_dpp v140, v140, v140 row_ror:8 row_mask:0xf bank_mask:0xf
  v_mov_b32 v141, v140
  v_smfmac_f32_16x16x64_bf16 v[96:99], v[20:23], v[200:207], v136
  v_mul_f32 v152, 0x3dd53b95, v152
  v_mul_f32 v153, 0x3dd53b95, v153
  v_smfmac_f32_16x16x64_bf16 v[100:103], v[20:23], v[224:231], v136
  v_permlane16_swap_b32 v140, v141
  v_max_f32 v140, v140, v141
  v_smfmac_f32_16x16x64_bf16 v[104:107], v[20:23], v[248:255], v136
  v_mov_b32 v141, v140
  v_mul_f32 v154, 0x3dd53b95, v154
  v_smfmac_f32_16x16x64_bf16 v[92:95], v[24:27], v[184:191], v136
  v_mul_f32 v155, 0x3dd53b95, v155
  v_permlane32_swap_b32 v140, v141
  v_smfmac_f32_16x16x64_bf16 v[96:99], v[24:27], v[208:215], v136
  v_max_f32 v140, v140, v141
  v_mul_f32 v156, 0x3dd53b95, v156
  v_smfmac_f32_16x16x64_bf16 v[100:103], v[24:27], v[232:239], v136
  v_mul_f32 v140, 0x3dd53b95, v140
  v_sub_f32 v156, v156, v140
  v_smfmac_f32_16x16x64_bf16 v[104:107], v[24:27], a[240:247], v136
  v_sub_f32 v152, v152, v140
  v_sub_f32 v153, v153, v140
  v_smfmac_f32_16x16x64_bf16 v[92:95], v[28:31], v[192:199], v136
  v_sub_f32 v154, v154, v140
  v_sub_f32 v155, v155, v140
  v_smfmac_f32_16x16x64_bf16 v[96:99], v[28:31], v[216:223], v136
  v_exp_f32 v156, v156
  v_exp_f32 v152, v152
  v_smfmac_f32_16x16x64_bf16 v[100:103], v[28:31], v[240:247], v136
  v_exp_f32 v153, v153
  v_exp_f32 v154, v154
  v_smfmac_f32_16x16x64_bf16 v[104:107], v[28:31], a[248:255], v136
  v_exp_f32 v155, v155
  v_mov_b32_dpp v157, v156 row_ror:8 row_mask:0xf bank_mask:0xf
  v_cvt_pk_bf16_f32 v116, v152, v153
  v_cvt_pk_bf16_f32 v117, v154, v155
  v_cvt_pk_bf16_f32 v120, v156, v157
  v_mov_b32_dpp v118, v116 row_ror:8 row_mask:0xf bank_mask:0xf
  v_mov_b32_dpp v119, v117 row_ror:8 row_mask:0xf bank_mask:0xf
  v_mov_b32 v121, v120
  s_nop 0
  v_mfma_f32_16x16x32_bf16 v[80:83], v[88:91], v[116:119], 0
  v_cvt_pk_bf16_f32 v108, v92, v93
  v_cvt_pk_bf16_f32 v109, v94, v95
  v_mfma_f32_16x16x32_bf16 v[152:155], v[44:47], v[116:119], 0
  v_cvt_pk_bf16_f32 v110, v96, v97
  v_cvt_pk_bf16_f32 v111, v98, v99
  v_mfma_f32_16x16x32_bf16 v[156:159], v[48:51], v[116:119], 0
  v_mfma_f32_16x16x16_bf16 v[80:83], v[168:169], v[120:121], v[80:83]
  v_cvt_pk_bf16_f32 v112, v100, v101
  v_cvt_pk_bf16_f32 v113, v102, v103
  v_mfma_f32_16x16x32_bf16 v[160:163], v[52:55], v[116:119], 0
  v_cvt_pk_bf16_f32 v114, v104, v105
  v_cvt_pk_bf16_f32 v115, v106, v107
  v_mfma_f32_16x16x32_bf16 v[164:167], v[56:59], v[116:119], 0
  s_add_u32 s40, s40, 1
  v_mfma_f32_16x16x16_bf16 v[152:155], v[108:109], v[120:121], v[152:155]
  v_mfma_f32_16x16x16_bf16 v[156:159], v[110:111], v[120:121], v[156:159]
  v_rcp_f32 v122, v80
  v_mfma_f32_16x16x16_bf16 v[160:163], v[112:113], v[120:121], v[160:163]
  s_nop 0
  v_mfma_f32_16x16x16_bf16 v[164:167], v[114:115], v[120:121], v[164:167]
  v_mov_b32 v123, v122
  s_cmp_eq_u32 s40, 64
  s_cbranch_scc1 chain_last_c2w
  s_mov_b64 exec, s[66:67]
  v_pk_mul_f32 v[152:153], v[122:123], v[152:153]
  v_pk_mul_f32 v[154:155], v[122:123], v[154:155]
  ds_write_b128 v131, v[152:155] offset:0
  v_pk_mul_f32 v[156:157], v[122:123], v[156:157]
  v_pk_mul_f32 v[158:159], v[122:123], v[158:159]
  ds_write_b128 v131, v[156:159] offset:512
  v_pk_mul_f32 v[160:161], v[122:123], v[160:161]
  v_pk_mul_f32 v[162:163], v[122:123], v[162:163]
  ds_write_b128 v131, v[160:163] offset:1024
  v_pk_mul_f32 v[164:165], v[122:123], v[164:165]
  v_pk_mul_f32 v[166:167], v[122:123], v[166:167]
  ds_write_b128 v131, v[164:167] offset:1536
  s_mov_b64 exec, -1
  s_waitcnt lgkmcnt(0)
  s_barrier
  ds_read_b64 v[144:145], v132 offset:0
  ds_read_b64 v[146:147], v132 offset:2048
  ds_read_b64 v[148:149], v132 offset:4096
  ds_read_b64 v[150:151], v132 offset:6144
  s_mov_b32 s45, s62
  s_waitcnt lgkmcnt(2)
  v_pk_add_f32 v[144:145], v[144:145], v[146:147]
  s_waitcnt lgkmcnt(0)
  v_pk_add_f32 v[148:149], v[148:149], v[150:151]
  v_pk_add_f32 v[122:123], v[144:145], v[148:149]
  v_cvt_pk_bf16_f32 v122, v122, v123
  buffer_store_dword v122, v170, s[8:11], s63 offen sc1
  buffer_store_dword v122, v170, s[8:11], s61 offen sc1
  s_add_u32 s78, s40, 1
  s_sub_u32 s42, s40, 1
  v_mov_b32 v143, s42
  buffer_store_dword v84, v133, s[8:11], s46 offen
  buffer_store_dword v143, v135, s[8:11], 0 offen
  s_mov_b32 s41, 0
cpw_58:
  v_cmp_gt_u32 vcc, s78, v139
  s_nop 0
  s_and_b32 vcc_lo, vcc_lo, 0xfff000
  s_and_b32 vcc_hi, vcc_hi, 0xfffff0
  s_cmp_eq_u64 vcc, 0
  s_cbranch_scc1 cpo_59
  s_sleep 1
  buffer_load_dword v139, v134, s[8:11], 0 offen sc1
  s_add_u32 s41, s41, 1
  s_cmp_gt_u32 s41, 65536
  s_cbranch_scc1 chain_abort
  s_waitcnt vmcnt(0)
  s_branch cpw_58
cpo_59:
  v_add_f32 v92, v92, v94
  v_add_f32 v93, v93, v95
  v_cvt_pk_bf16_f32 v80, v92, v93
  v_add_f32 v96, v96, v98
  v_add_f32 v97, v97, v99
  v_cvt_pk_bf16_f32 v81, v96, v97
  v_add_f32 v100, v100, v102
  v_add_f32 v101, v101, v103
  v_cvt_pk_bf16_f32 v82, v100, v101
  v_add_f32 v104, v104, v106
  v_add_f32 v105, v105, v107
  v_cvt_pk_bf16_f32 v83, v104, v105
  s_mov_b32 s42, s46
  s_mov_b32 s46, s47
  s_mov_b32 s47, s42
  s_sub_u32 s43, s40, 1
  s_and_b32 s43, s43, 3
  s_mul_i32 s43, s43, 227328
  s_add_u32 s57, s24, s43
  s_add_u32 s58, s25, s43
  s_add_u32 s54, s55, s79
  s_and_b32 s42, s40, 3
  s_lshl_b32 s43, s42, 15
  s_add_u32 s52, s49, s43
  s_add_u32 s53, s52, 4096
  s_add_u32 s55, s48, s43
  s_add_u32 s50, s55, s56
  s_lshl_b32 s44, s38, 10
  s_add_u32 s51, s55, s44
  s_add_u32 s51, s51, 4096
  s_mul_i32 s60, s42, 227328
  s_add_u32 s60, s60, s26
  s_mul_i32 s62, s42, 163840
  s_add_u32 s62, s62, s64
  s_lshl_b32 s43, s16, 8
  s_add_u32 s61, s62, s43
  s_xor_b32 s63, s61, 8192
  v_mov_b32 v92, 0
  v_mov_b32 v93, 0
  v_mov_b32 v94, 0
  v_mov_b32 v95, 0
  v_mov_b32 v96, 0
  v_mov_b32 v97, 0
  v_mov_b32 v98, 0
  v_mov_b32 v99, 0
  v_mov_b32 v100, 0
  v_mov_b32 v101, 0
  v_mov_b32 v102, 0
  v_mov_b32 v103, 0
  v_mov_b32 v104, 0
  v_mov_b32 v105, 0
  v_mov_b32 v106, 0
  v_mov_b32 v107, 0
  v_mov_b32 v68, 0
  v_mov_b32 v69, 0
  v_mov_b32 v70, 0
  v_mov_b32 v71, 0
  v_mov_b32 v72, 0
  v_mov_b32 v73, 0
  v_mov_b32 v74, 0
  v_mov_b32 v75, 0
  v_mov_b32 v76, 0
  v_mov_b32 v77, 0
  v_mov_b32 v78, 0
  v_mov_b32 v79, 0
  s_sleep 2
  buffer_load_dwordx4 v[4:7], v124, s[8:11], s45 offen offset:0 sc1
  buffer_load_dwordx4 v[8:11], v124, s[8:11], s45 offen offset:1024 sc1
  s_mov_b32 s41, 0
xp_60:
  s_waitcnt vmcnt(0)
  v_mfma_f32_16x16x32_bf16 v[36:39], v[172:175], v[4:7], 0
  v_mfma_f32_16x16x32_bf16 v[36:39], v[172:175], v[8:11], v[36:39]
  s_nop 7
  v_cmp_u_f32 vcc, v36, v37
  v_cvt_pk_bf16_f32 v141, v36, v37
  s_cbranch_vccnz xp_60_r
  buffer_store_dword v141, v133, s[8:11], s46 offen
  s_branch chain_loop_c2w
gs_56:
  v_max3_u32 v142, v4, v5, v6
  v_max_u32 v142, v142, v7
  v_cmp_eq_u32 vcc, -1, v142
  s_cbranch_vccz gs_56_s0
  s_mov_b64 exec, vcc
  buffer_load_dwordx4 v[4:7], v124, s[8:11], s52 offen offset:0 sc1
  s_mov_b64 exec, -1
gs_56_s0:
  v_max3_u32 v142, v8, v9, v10
  v_max_u32 v142, v142, v11
  v_cmp_eq_u32 vcc, -1, v142
  s_cbranch_vccz gs_56_s1
  s_mov_b64 exec, vcc
  buffer_load_dwordx4 v[8:11], v124, s[8:11], s52 offen offset:1024 sc1
  s_mov_b64 exec, -1
gs_56_s1:
  v_max3_u32 v142, v12, v13, v14
  v_max_u32 v142, v142, v15
  v_cmp_eq_u32 vcc, -1, v142
  s_cbranch_vccz gs_56_s2
  s_mov_b64 exec, vcc
  buffer_load_dwordx4 v[12:15], v124, s[8:11], s52 offen offset:2048 sc1
  s_mov_b64 exec, -1
gs_56_s2:
  v_max3_u32 v142, v16, v17, v18
  v_cmp_eq_u32 vcc, -1, v142
  s_cbranch_vccz gs_56_s3
  s_mov_b64 exec, vcc
  buffer_load_dwordx3 v[16:18], v124, s[8:11], s52 offen offset:3072 sc1
  s_mov_b64 exec, -1
gs_56_s3:
  v_max3_u32 v142, v20, v21, v22
  v_max_u32 v142, v142, v23
  v_cmp_eq_u32 vcc, -1, v142
  s_cbranch_vccz gs_56_s4
  s_mov_b64 exec, vcc
  buffer_load_dwordx4 v[20:23], v124, s[8:11], s53 offen offset:0 sc1
  s_mov_b64 exec, -1
gs_56_s4:
  v_max3_u32 v142, v24, v25, v26
  v_max_u32 v142, v142, v27
  v_cmp_eq_u32 vcc, -1, v142
  s_cbranch_vccz gs_56_s5
  s_mov_b64 exec, vcc
  buffer_load_dwordx4 v[24:27], v124, s[8:11], s53 offen offset:1024 sc1
  s_mov_b64 exec, -1
gs_56_s5:
  v_max3_u32 v142, v28, v29, v30
  v_max_u32 v142, v142, v31
  v_cmp_eq_u32 vcc, -1, v142
  s_cbranch_vccz gs_56_s6
  s_mov_b64 exec, vcc
  buffer_load_dwordx4 v[28:31], v124, s[8:11], s53 offen offset:2048 sc1
  s_mov_b64 exec, -1
gs_56_s6:
  s_add_u32 s41, s41, 1
  s_cmp_gt_u32 s41, 65536
  s_cbranch_scc1 chain_abort
  s_waitcnt vmcnt(0)
  s_branch gs_56_in
xp_60_r:
  v_max3_u32 v140, v4, v5, v6
  v_max_u32 v140, v140, v7
  v_cmp_eq_u32 vcc, -1, v140
  s_cbranch_vccz xp_60_s0
  s_mov_b64 exec, vcc
  buffer_load_dwordx4 v[4:7], v124, s[8:11], s45 offen offset:0 sc1
  s_mov_b64 exec, -1
xp_60_s0:
  v_max3_u32 v140, v8, v9, v10
  v_max_u32 v140, v140, v11
  v_cmp_eq_u32 vcc, -1, v140
  s_cbranch_vccz xp_60_s1
  s_mov_b64 exec, vcc
  buffer_load_dwordx4 v[8:11], v124, s[8:11], s45 offen offset:1024 sc1
  s_mov_b64 exec, -1
xp_60_s1:
  s_add_u32 s41, s41, 1
  s_cmp_gt_u32 s41, 65536
  s_cbranch_scc1 chain_abort
  s_branch xp_60
chain_last_c2w:
  s_sub_u32 s43, s40, 1
  s_and_b32 s43, s43, 3
  s_mul_i32 s43, s43, 227328
  s_add_u32 s57, s24, s43
  s_add_u32 s58, s25, s43
  v_add_f32 v92, v92, v94
  v_add_f32 v93, v93, v95
  v_cvt_pk_bf16_f32 v80, v92, v93
  v_add_f32 v96, v96, v98
  v_add_f32 v97, v97, v99
  v_cvt_pk_bf16_f32 v81, v96, v97
  v_add_f32 v100, v100, v102
  v_add_f32 v101, v101, v103
  v_cvt_pk_bf16_f32 v82, v100, v101
  v_add_f32 v104, v104, v106
  v_add_f32 v105, v105, v107
  v_cvt_pk_bf16_f32 v83, v104, v105
  buffer_store_dwordx4 v[60:63], v138, s[8:11], s57 offen
  buffer_store_dwordx4 v[64:67], v138, s[8:11], s57 offen offset:512
  buffer_store_dwordx4 v[80:83], v124, s[8:11], s58 offen
  v_mov_b32 v143, s40
  s_branch chain_fin
chain_pro_c0n:
  s_sub_u32 s42, s36, 10
  s_lshl_b32 s42, s42, 2
  s_add_u32 s42, s42, s17
  s_cmp_lt_u32 s42, 4
  s_cselect_b32 s63, 16, 8
  s_lshl_b32 s63, s63, 13
  s_lshl_b32 s64, s42, 13
  s_lshl_b32 s42, s16, 8
  s_add_u32 s64, s64, s42
  s_add_u32 s64, s64, 1441792
  v_lshrrev_b32 v140, 4, v1
  v_lshlrev_b32 v140, 11, v140
  v_and_b32 v141, 15, v1
  v_lshl_add_u32 v131, v141, 4, v140
  s_mov_b32 s78, 1
  v_mov_b32 v143, 0
  s_mov_b32 s41, 0
cpw_61:
  v_cmp_gt_u32 vcc, s78, v139
  s_nop 0
  s_and_b32 vcc_lo, vcc_lo, 0xfff000
  s_and_b32 vcc_hi, vcc_hi, 0xfffff0
  s_cmp_eq_u64 vcc, 0
  s_cbranch_scc1 cpo_62
  s_sleep 1
  buffer_load_dword v139, v134, s[8:11], 0 offen sc1
  s_add_u32 s41, s41, 1
  s_cmp_gt_u32 s41, 65536
  s_cbranch_scc1 chain_abort
  s_waitcnt vmcnt(0)
  s_branch cpw_61
cpo_62:
  s_sub_u32 s42, s78, 1
  s_and_b32 s42, s42, 7
  s_mul_i32 s42, s42, 147456
  s_add_u32 s42, s42, s59
  buffer_load_dwordx4 v[60:63], v124, s[8:11], s42 offen offset:0 sc1
  buffer_load_dwordx4 v[64:67], v124, s[8:11], s42 offen offset:1024 sc1
  s_add_u32 s55, s48, 98304
  s_sub_u32 s43, s40, 1
  s_and_b32 s43, s43, 3
  s_mul_i32 s43, s43, 227328
  s_add_u32 s57, s24, s43
  s_add_u32 s54, s55, s79
  s_and_b32 s42, s40, 3
  s_lshl_b32 s43, s42, 15
  s_add_u32 s52, s49, s43
  s_add_u32 s53, s52, 4096
  s_add_u32 s55, s48, s43
  s_add_u32 s50, s55, s56
  s_lshl_b32 s44, s38, 10
  s_add_u32 s51, s55, s44
  s_add_u32 s51, s51, 4096
  v_mov_b32 v68, 0
  v_mov_b32 v69, 0
  v_mov_b32 v70, 0
  v_mov_b32 v71, 0
  v_mov_b32 v72, 0
  v_mov_b32 v73, 0
  v_mov_b32 v74, 0
  v_mov_b32 v75, 0
  v_mov_b32 v76, 0
  v_mov_b32 v77, 0
  v_mov_b32 v78, 0
  v_mov_b32 v79, 0
chain_loop_c0n:
  s_mov_b32 s41, 0
  buffer_load_dwordx4 v[152:155], v126, s[8:11], s46 offen sc1
  buffer_load_dwordx4 v[156:159], v126, s[8:11], s46 offen offset:1024 sc1
  buffer_load_dwordx2 v[160:161], v127, s[8:11], s46 offen sc1
  s_sleep 2
mq_63:
  buffer_load_dwordx4 v[162:165], v126, s[8:11], s46 offen sc1
  buffer_load_dwordx4 v[108:111], v126, s[8:11], s46 offen offset:1024 sc1
  buffer_load_dwordx2 v[112:113], v127, s[8:11], s46 offen sc1
  s_waitcnt vmcnt(3)
  v_max3_u32 v140, v152, v153, v154
  v_max3_u32 v141, v155, v156, v157
  v_max3_u32 v140, v140, v158, v159
  v_max3_u32 v141, v141, v160, v161
  v_max_u32 v140, v140, v141
  v_cmp_eq_u32 vcc, -1, v140
  s_cbranch_vccz mq_63_a
  buffer_load_dwordx4 v[152:155], v126, s[8:11], s46 offen sc1
  buffer_load_dwordx4 v[156:159], v126, s[8:11], s46 offen offset:1024 sc1
  buffer_load_dwordx2 v[160:161], v127, s[8:11], s46 offen sc1
  s_add_u32 s41, s41, 1
  s_cmp_gt_u32 s41, 65536
  s_cbranch_scc1 chain_abort
  s_waitcnt vmcnt(3)
  v_max3_u32 v140, v162, v163, v164
  v_max3_u32 v141, v165, v108, v109
  v_max3_u32 v140, v140, v110, v111
  v_max3_u32 v141, v141, v112, v113
  v_max_u32 v140, v140, v141
  v_cmp_eq_u32 vcc, -1, v140
  s_cbranch_vccnz mq_63
  ds_write_b128 v126, v[162:165]
  ds_write_b128 v126, v[108:111] offset:1024
  ds_write_b64 v127, v[112:113]
  s_branch mq_63_ok
mq_63_a:
  ds_write_b128 v126, v[152:155]
  ds_write_b128 v126, v[156:159] offset:1024
  ds_write_b64 v127, v[160:161]
mq_63_ok:
  s_waitcnt lgkmcnt(0)
  s_barrier
  ds_read_b128 v[4:7], v124 offset:0
  ds_read_b128 v[8:11], v124 offset:1024
  ds_read_b128 v[12:15], v124 offset:2048
  ds_read_b128 v[16:19], v124 offset:3072
  ds_read_b128 v[20:23], v124 offset:4096
  ds_read_b128 v[24:27], v124 offset:5120
  ds_read_b128 v[28:31], v124 offset:6144
  ds_read_b128 v[32:35], v124 offset:7168
  ds_read_b128 v[36:39], v124 offset:8192
  ds_read_b128 v[40:43], v124 offset:9216
  s_waitcnt lgkmcnt(9)
  v_smfmac_f32_16x16x64_bf16 v[68:71], v[4:7], a[0:7], v136
  v_smfmac_f32_16x16x64_bf16 v[72:75], v[4:7], a[80:87], v136
  buffer_store_dwordx4 v[84:87], v124, s[8:11], s54 offen
  s_waitcnt lgkmcnt(8)
  v_smfmac_f32_16x16x64_bf16 v[68:71], v[8:11], a[8:15], v136
  v_smfmac_f32_16x16x64_bf16 v[72:75], v[8:11], a[88:95], v136
  buffer_load_dword v139, v134, s[8:11], 0 offen sc1
  s_waitcnt lgkmcnt(7)
  v_smfmac_f32_16x16x64_bf16 v[68:71], v[12:15], a[16:23], v136
  v_smfmac_f32_16x16x64_bf16 v[72:75], v[12:15], a[96:103], v136
  s_waitcnt lgkmcnt(6)
  v_smfmac_f32_16x16x64_bf16 v[68:71], v[16:19], a[24:31], v136
  v_smfmac_f32_16x16x64_bf16 v[72:75], v[16:19], a[104:111], v136
  s_waitcnt lgkmcnt(5)
  v_smfmac_f32_16x16x64_bf16 v[68:71], v[20:23], a[32:39], v136
  v_smfmac_f32_16x16x64_bf16 v[72:75], v[20:23], a[112:119], v136
  s_waitcnt lgkmcnt(4)
  v_smfmac_f32_16x16x64_bf16 v[68:71], v[24:27], a[40:47], v136
  v_smfmac_f32_16x16x64_bf16 v[72:75], v[24:27], a[120:127], v136
  s_waitcnt lgkmcnt(3)
  v_smfmac_f32_16x16x64_bf16 v[68:71], v[28:31], a[48:55], v136
  v_smfmac_f32_16x16x64_bf16 v[72:75], v[28:31], a[128:135], v136
  s_waitcnt lgkmcnt(2)
  v_smfmac_f32_16x16x64_bf16 v[68:71], v[32:35], a[56:63], v136
  v_smfmac_f32_16x16x64_bf16 v[72:75], v[32:35], a[136:143], v136
  s_waitcnt lgkmcnt(1)
  v_smfmac_f32_16x16x64_bf16 v[68:71], v[36:39], a[64:71], v136
  v_smfmac_f32_16x16x64_bf16 v[72:75], v[36:39], a[144:151], v136
  s_waitcnt lgkmcnt(0)
  v_smfmac_f32_16x16x64_bf16 v[68:71], v[40:43], a[72:79], v136
  v_smfmac_f32_16x16x64_bf16 v[72:75], v[40:43], a[152:159], v136
  v_smfmac_f32_16x16x64_bf16 v[76:79], v[4:7], a[160:167], v136
  v_smfmac_f32_16x16x64_bf16 v[76:79], v[8:11], a[168:175], v136
  s_nop 4
  v_add_f32 v68, v68, v70
  v_add_f32 v69, v69, v71
  v_add_f32 v72, v72, v74
  v_add_f32 v73, v73, v75
  v_smfmac_f32_16x16x64_bf16 v[76:79], v[12:15], a[176:183], v136
  v_cvt_pk_bf16_f32 v122, v68, v69
  v_cvt_pk_bf16_f32 v123, v72, v73
  ds_write2_b32 v128, v122, v122 offset0:0 offset1:4
  ds_write2_b32 v129, v123, v123 offset0:0 offset1:1
  v_smfmac_f32_16x16x64_bf16 v[76:79], v[16:19], a[184:191], v136
  v_smfmac_f32_16x16x64_bf16 v[76:79], v[20:23], a[192:199], v136
  s_waitcnt lgkmcnt(0)
  s_barrier
  ds_read_b64_tr_b16 v[144:145], v125 offset:10240
  ds_read_b64_tr_b16 v[146:147], v125 offset:10752
  ds_read_b64_tr_b16 v[148:149], v125 offset:11264
  ds_read_b64_tr_b16 v[150:151], v125 offset:11776
  v_smfmac_f32_16x16x64_bf16 v[76:79], v[24:27], a[200:207], v136
  v_smfmac_f32_16x16x64_bf16 v[76:79], v[28:31], a[208:215], v136
  v_smfmac_f32_16x16x64_bf16 v[76:79], v[32:35], a[216:223], v136
  s_waitcnt lgkmcnt(2)
  v_mfma_f32_16x16x32_bf16 v[80:83], v[60:63], v[144:147], 0
  s_waitcnt lgkmcnt(0)
  v_mfma_f32_16x16x32_bf16 v[80:83], v[64:67], v[148:151], v[80:83]
  v_smfmac_f32_16x16x64_bf16 v[76:79], v[36:39], a[224:231], v136
  v_smfmac_f32_16x16x64_bf16 v[76:79], v[40:43], a[232:239], v136
  s_mov_b64 exec, s[70:71]
  s_nop 4
  buffer_store_dwordx4 v[80:83], v124, s[8:11], s50 offen
  s_mov_b64 exec, -1
  v_add_f32 v76, v76, v78
  v_add_f32 v77, v77, v79
  v_cvt_pk_bf16_f32 v140, v76, v77
  s_nop 1
  v_mov_b32_dpp v141, v140 row_ror:4 row_mask:0xf bank_mask:0xa
  s_nop 1
  v_mov_b32_dpp v141, v140 row_ror:12 row_mask:0xf bank_mask:0x5
  v_perm_b32 v140, v141, v140, v137
  buffer_store_dword v140, v130, s[8:11], s51 offen
  s_and_b32 s42, s40, 3
  s_xor_b32 s42, s42, 2
  s_mul_i32 s42, s42, 163840
  s_add_u32 s42, s42, s64
  s_add_u32 s43, s42, 65536
  s_add_u32 s44, s42, s63
  s_waitcnt vmcnt(0)
  s_barrier
  buffer_store_dwordx4 v[84:87], v131, s[8:11], s42 offen sc1
  buffer_store_dwordx4 v[84:87], v131, s[8:11], s43 offen sc1
  buffer_store_dwordx4 v[84:87], v131, s[8:11], s44 offen sc1
  v_mov_b32 v143, s40
  s_add_u32 s40, s40, 1
  s_cmp_eq_u32 s40, 64
  s_cbranch_scc1 chain_last_c0n
  s_add_u32 s78, s40, 1
  s_waitcnt vmcnt(0)
  buffer_store_dword v143, v135, s[8:11], 0 offen
  s_mov_b32 s41, 0
cpw_64:
  v_cmp_gt_u32 vcc, s78, v139
  s_nop 0
  s_and_b32 vcc_lo, vcc_lo, 0xfff000
  s_and_b32 vcc_hi, vcc_hi, 0xfffff0
  s_cmp_eq_u64 vcc, 0
  s_cbranch_scc1 cpo_65
  s_sleep 1
  buffer_load_dword v139, v134, s[8:11], 0 offen sc1
  s_add_u32 s41, s41, 1
  s_cmp_gt_u32 s41, 65536
  s_cbranch_scc1 chain_abort
  s_waitcnt vmcnt(0)
  s_branch cpw_64
cpo_65:
  s_sub_u32 s42, s78, 1
  s_and_b32 s42, s42, 7
  s_mul_i32 s42, s42, 147456
  s_add_u32 s42, s42, s59
  buffer_load_dwordx4 v[60:63], v124, s[8:11], s42 offen offset:0 sc1
  buffer_load_dwordx4 v[64:67], v124, s[8:11], s42 offen offset:1024 sc1
  s_mov_b32 s42, s46
  s_mov_b32 s46, s47
  s_mov_b32 s47, s42
  s_sub_u32 s43, s40, 1
  s_and_b32 s43, s43, 3
  s_mul_i32 s43, s43, 227328
  s_add_u32 s57, s24, s43
  s_add_u32 s54, s55, s79
  s_and_b32 s42, s40, 3
  s_lshl_b32 s43, s42, 15
  s_add_u32 s52, s49, s43
  s_add_u32 s53, s52, 4096
  s_add_u32 s55, s48, s43
  s_add_u32 s50, s55, s56
  s_lshl_b32 s44, s38, 10
  s_add_u32 s51, s55, s44
  s_add_u32 s51, s51, 4096
  v_mov_b32 v68, 0
  v_mov_b32 v69, 0
  v_mov_b32 v70, 0
  v_mov_b32 v71, 0
  v_mov_b32 v72, 0
  v_mov_b32 v73, 0
  v_mov_b32 v74, 0
  v_mov_b32 v75, 0
  v_mov_b32 v76, 0
  v_mov_b32 v77, 0
  v_mov_b32 v78, 0
  v_mov_b32 v79, 0
  s_sleep 16
  s_branch chain_loop_c0n
chain_last_c0n:
  s_sub_u32 s43, s40, 1
  s_and_b32 s43, s43, 3
  s_mul_i32 s43, s43, 227328
  s_add_u32 s57, s24, s43
  s_waitcnt lgkmcnt(0)
  v_mov_b32 v143, s40
  s_branch chain_fin
chain_pro_c1n:
  s_sub_u32 s42, s36, 10
  s_lshl_b32 s42, s42, 2
  s_add_u32 s42, s42, s17
  s_cmp_lt_u32 s42, 4
  s_cselect_b32 s63, 16, 8
  s_lshl_b32 s63, s63, 13
  s_lshl_b32 s64, s42, 13
  s_lshl_b32 s42, s16, 8
  s_add_u32 s64, s64, s42
  s_add_u32 s64, s64, 1441792
  v_lshrrev_b32 v140, 4, v1
  v_lshlrev_b32 v140, 11, v140
  v_and_b32 v141, 15, v1
  v_lshl_add_u32 v131, v141, 4, v140
  s_mov_b32 s78, 1
  v_mov_b32 v143, 0
  s_mov_b32 s41, 0
cpw_66:
  v_cmp_gt_u32 vcc, s78, v139
  s_nop 0
  s_and_b32 vcc_lo, vcc_lo, 0xfff000
  s_and_b32 vcc_hi, vcc_hi, 0xfffff0
  s_cmp_eq_u64 vcc, 0
  s_cbranch_scc1 cpo_67
  s_sleep 1
  buffer_load_dword v139, v134, s[8:11], 0 offen sc1
  s_add_u32 s41, s41, 1
  s_cmp_gt_u32 s41, 65536
  s_cbranch_scc1 chain_abort
  s_waitcnt vmcnt(0)
  s_branch cpw_66
cpo_67:
  s_add_u32 s55, s48, 98304
  s_sub_u32 s43, s40, 1
  s_and_b32 s43, s43, 3
  s_mul_i32 s43, s43, 227328
  s_add_u32 s57, s24, s43
  s_add_u32 s54, s55, s79
  s_and_b32 s42, s40, 3
  s_lshl_b32 s43, s42, 15
  s_add_u32 s52, s49, s43
  s_add_u32 s53, s52, 4096
  s_add_u32 s55, s48, s43
  s_add_u32 s50, s55, s56
  s_lshl_b32 s44, s38, 10
  s_add_u32 s51, s55, s44
  s_add_u32 s51, s51, 4096
  v_mov_b32 v68, 0
  v_mov_b32 v69, 0
  v_mov_b32 v70, 0
  v_mov_b32 v71, 0
  v_mov_b32 v72, 0
  v_mov_b32 v73, 0
  v_mov_b32 v74, 0
  v_mov_b32 v75, 0
  v_mov_b32 v76, 0
  v_mov_b32 v77, 0
  v_mov_b32 v78, 0
  v_mov_b32 v79, 0
chain_loop_c1n:
  s_mov_b32 s41, 0
  buffer_load_dwordx4 v[152:155], v126, s[8:11], s46 offen sc1
  buffer_load_dwordx4 v[156:159], v126, s[8:11], s46 offen offset:1024 sc1
  buffer_load_dwordx2 v[160:161], v127, s[8:11], s46 offen sc1
  s_sleep 2
mq_68:
  buffer_load_dwordx4 v[162:165], v126, s[8:11], s46 offen sc1
  buffer_load_dwordx4 v[108:111], v126, s[8:11], s46 offen offset:1024 sc1
  buffer_load_dwordx2 v[112:113], v127, s[8:11], s46 offen sc1
  s_waitcnt vmcnt(3)
  v_max3_u32 v140, v152, v153, v154
  v_max3_u32 v141, v155, v156, v157
  v_max3_u32 v140, v140, v158, v159
  v_max3_u32 v141, v141, v160, v161
  v_max_u32 v140, v140, v141
  v_cmp_eq_u32 vcc, -1, v140
  s_cbranch_vccz mq_68_a
  buffer_load_dwordx4 v[152:155], v126, s[8:11], s46 offen sc1
  buffer_load_dwordx4 v[156:159], v126, s[8:11], s46 offen offset:1024 sc1
  buffer_load_dwordx2 v[160:161], v127, s[8:11], s46 offen sc1
  s_add_u32 s41, s41, 1
  s_cmp_gt_u32 s41, 65536
  s_cbranch_scc1 chain_abort
  s_waitcnt vmcnt(3)
  v_max3_u32 v140, v162, v163, v164
  v_max3_u32 v141, v165, v108, v109
  v_max3_u32 v140, v140, v110, v111
  v_max3_u32 v141, v141, v112, v113
  v_max_u32 v140, v140, v141
  v_cmp_eq_u32 vcc, -1, v140
  s_cbranch_vccnz mq_68
  ds_write_b128 v126, v[162:165]
  ds_write_b128 v126, v[108:111] offset:1024
  ds_write_b64 v127, v[112:113]
  s_branch mq_68_ok
mq_68_a:
  ds_write_b128 v126, v[152:155]
  ds_write_b128 v126, v[156:159] offset:1024
  ds_write_b64 v127, v[160:161]
mq_68_ok:
  s_waitcnt lgkmcnt(0)
  s_barrier
  ds_read_b128 v[4:7], v124 offset:0
  ds_read_b128 v[8:11], v124 offset:1024
  ds_read_b128 v[12:15], v124 offset:2048
  ds_read_b128 v[16:19], v124 offset:3072
  ds_read_b128 v[20:23], v124 offset:4096
  ds_read_b128 v[24:27], v124 offset:5120
  ds_read_b128 v[28:31], v124 offset:6144
  ds_read_b128 v[32:35], v124 offset:7168
  ds_read_b128 v[36:39], v124 offset:8192
  ds_read_b128 v[40:43], v124 offset:9216
  s_waitcnt lgkmcnt(9)
  v_smfmac_f32_16x16x64_bf16 v[68:71], v[4:7], a[0:7], v136
  v_smfmac_f32_16x16x64_bf16 v[72:75], v[4:7], a[80:87], v136
  buffer_store_dwordx4 v[84:87], v124, s[8:11], s54 offen
  s_waitcnt lgkmcnt(8)
  v_smfmac_f32_16x16x64_bf16 v[68:71], v[8:11], a[8:15], v136
  v_smfmac_f32_16x16x64_bf16 v[72:75], v[8:11], a[88:95], v136
  buffer_load_dword v139, v134, s[8:11], 0 offen sc1
  s_waitcnt lgkmcnt(7)
  v_smfmac_f32_16x16x64_bf16 v[68:71], v[12:15], a[16:23], v136
  v_smfmac_f32_16x16x64_bf16 v[72:75], v[12:15], a[96:103], v136
  s_waitcnt lgkmcnt(6)
  v_smfmac_f32_16x16x64_bf16 v[68:71], v[16:19], a[24:31], v136
  v_smfmac_f32_16x16x64_bf16 v[72:75], v[16:19], a[104:111], v136
  s_waitcnt lgkmcnt(5)
  v_smfmac_f32_16x16x64_bf16 v[68:71], v[20:23], a[32:39], v136
  v_smfmac_f32_16x16x64_bf16 v[72:75], v[20:23], a[112:119], v136
  s_waitcnt lgkmcnt(4)
  v_smfmac_f32_16x16x64_bf16 v[68:71], v[24:27], a[40:47], v136
  v_smfmac_f32_16x16x64_bf16 v[72:75], v[24:27], a[120:127], v136
  s_waitcnt lgkmcnt(3)
  v_smfmac_f32_16x16x64_bf16 v[68:71], v[28:31], a[48:55], v136
  v_smfmac_f32_16x16x64_bf16 v[72:75], v[28:31], a[128:135], v136
  s_waitcnt lgkmcnt(2)
  v_smfmac_f32_16x16x64_bf16 v[68:71], v[32:35], a[56:63], v136
  v_smfmac_f32_16x16x64_bf16 v[72:75], v[32:35], a[136:143], v136
  s_waitcnt lgkmcnt(1)
  v_smfmac_f32_16x16x64_bf16 v[68:71], v[36:39], a[64:71], v136
  v_smfmac_f32_16x16x64_bf16 v[72:75], v[36:39], a[144:151], v136
  s_waitcnt lgkmcnt(0)
  v_smfmac_f32_16x16x64_bf16 v[68:71], v[40:43], a[72:79], v136
  v_smfmac_f32_16x16x64_bf16 v[72:75], v[40:43], a[152:159], v136
  v_smfmac_f32_16x16x64_bf16 v[76:79], v[4:7], a[160:167], v136
  v_smfmac_f32_16x16x64_bf16 v[76:79], v[8:11], a[168:175], v136
  s_nop 4
  v_add_f32 v68, v68, v70
  v_add_f32 v69, v69, v71
  v_add_f32 v72, v72, v74
  v_add_f32 v73, v73, v75
  v_smfmac_f32_16x16x64_bf16 v[76:79], v[12:15], a[176:183], v136
  v_cvt_pk_bf16_f32 v122, v68, v69
  v_cvt_pk_bf16_f32 v123, v72, v73
  ds_write2_b32 v128, v122, v122 offset0:0 offset1:4
  ds_write2_b32 v129, v123, v123 offset0:0 offset1:1
  v_smfmac_f32_16x16x64_bf16 v[76:79], v[16:19], a[184:191], v136
  v_smfmac_f32_16x16x64_bf16 v[76:79], v[20:23], a[192:199], v136
  s_waitcnt lgkmcnt(0)
  s_barrier
  ds_read_b64_tr_b16 v[144:145], v125 offset:10240
  ds_read_b64_tr_b16 v[60:61], v125 offset:12288
  ds_read_b64_tr_b16 v[146:147], v125 offset:10752
  ds_read_b64_tr_b16 v[62:63], v125 offset:12800
  ds_read_b64_tr_b16 v[148:149], v125 offset:11264
  ds_read_b64_tr_b16 v[64:65], v125 offset:13312
  ds_read_b64_tr_b16 v[150:151], v125 offset:11776
  ds_read_b64_tr_b16 v[66:67], v125 offset:13824
  v_smfmac_f32_16x16x64_bf16 v[76:79], v[24:27], a[200:207], v136
  v_smfmac_f32_16x16x64_bf16 v[76:79], v[28:31], a[208:215], v136
  v_smfmac_f32_16x16x64_bf16 v[76:79], v[32:35], a[216:223], v136
  s_waitcnt lgkmcnt(4)
  v_mfma_f32_16x16x32_bf16 v[80:83], v[60:63], v[144:147], 0
  s_waitcnt lgkmcnt(0)
  v_mfma_f32_16x16x32_bf16 v[80:83], v[64:67], v[148:151], v[80:83]
  v_smfmac_f32_16x16x64_bf16 v[76:79], v[36:39], a[224:231], v136
  v_smfmac_f32_16x16x64_bf16 v[76:79], v[40:43], a[232:239], v136
  s_nop 5
  v_cndmask_b32 v80, v80, v81, s[68:69]
  buffer_store_dword v80, v124, s[8:11], s50 offen
  v_add_f32 v76, v76, v78
  v_add_f32 v77, v77, v79
  v_cvt_pk_bf16_f32 v140, v76, v77
  s_nop 1
  v_mov_b32_dpp v141, v140 row_ror:4 row_mask:0xf bank_mask:0xa
  s_nop 1
  v_mov_b32_dpp v141, v140 row_ror:12 row_mask:0xf bank_mask:0x5
  v_perm_b32 v140, v141, v140, v137
  buffer_store_dword v140, v130, s[8:11], s51 offen
  s_and_b32 s42, s40, 3
  s_xor_b32 s42, s42, 2
  s_mul_i32 s42, s42, 163840
  s_add_u32 s42, s42, s64
  s_add_u32 s43, s42, 65536
  s_add_u32 s44, s42, s63
  s_waitcnt vmcnt(0)
  s_barrier
  buffer_store_dwordx4 v[84:87], v131, s[8:11], s42 offen sc1
  buffer_store_dwordx4 v[84:87], v131, s[8:11], s43 offen sc1
  buffer_store_dwordx4 v[84:87], v131, s[8:11], s44 offen sc1
  v_mov_b32 v143, s40
  s_add_u32 s40, s40, 1
  s_cmp_eq_u32 s40, 64
  s_cbranch_scc1 chain_last_c1n
  s_add_u32 s78, s40, 1
  s_waitcnt vmcnt(0)
  buffer_store_dword v143, v135, s[8:11], 0 offen
  s_mov_b32 s41, 0
cpw_69:
  v_cmp_gt_u32 vcc, s78, v139
  s_nop 0
  s_and_b32 vcc_lo, vcc_lo, 0xfff000
  s_and_b32 vcc_hi, vcc_hi, 0xfffff0
  s_cmp_eq_u64 vcc, 0
  s_cbranch_scc1 cpo_70
  s_sleep 1
  buffer_load_dword v139, v134, s[8:11], 0 offen sc1
  s_add_u32 s41, s41, 1
  s_cmp_gt_u32 s41, 65536
  s_cbranch_scc1 chain_abort
  s_waitcnt vmcnt(0)
  s_branch cpw_69
cpo_70:
  s_mov_b32 s42, s46
  s_mov_b32 s46, s47
  s_mov_b32 s47, s42
  s_sub_u32 s43, s40, 1
  s_and_b32 s43, s43, 3
  s_mul_i32 s43, s43, 227328
  s_add_u32 s57, s24, s43
  s_add_u32 s54, s55, s79
  s_and_b32 s42, s40, 3
  s_lshl_b32 s43, s42, 15
  s_add_u32 s52, s49, s43
  s_add_u32 s53, s52, 4096
  s_add_u32 s55, s48, s43
  s_add_u32 s50, s55, s56
  s_lshl_b32 s44, s38, 10
  s_add_u32 s51, s55, s44
  s_add_u32 s51, s51, 4096
  v_mov_b32 v68, 0
  v_mov_b32 v69, 0
  v_mov_b32 v70, 0
  v_mov_b32 v71, 0
  v_mov_b32 v72, 0
  v_mov_b32 v73, 0
  v_mov_b32 v74, 0
  v_mov_b32 v75, 0
  v_mov_b32 v76, 0
  v_mov_b32 v77, 0
  v_mov_b32 v78, 0
  v_mov_b32 v79, 0
  s_sleep 16
  s_branch chain_loop_c1n
chain_last_c1n:
  s_sub_u32 s43, s40, 1
  s_and_b32 s43, s43, 3
  s_mul_i32 s43, s43, 227328
  s_add_u32 s57, s24, s43
  s_waitcnt lgkmcnt(0)
  v_mov_b32 v143, s40
  s_branch chain_fin
chain_pro_c2n:
  s_sub_u32 s42, s36, 10
  s_lshl_b32 s42, s42, 2
  s_add_u32 s42, s42, s17
  s_cmp_lt_u32 s42, 4
  s_cselect_b32 s63, 16, 8
  s_lshl_b32 s63, s63, 13
  s_lshl_b32 s64, s42, 13
  s_lshl_b32 s42, s16, 8
  s_add_u32 s64, s64, s42
  s_add_u32 s64, s64, 1441792
  v_lshrrev_b32 v140, 4, v1
  v_lshlrev_b32 v140, 11, v140
  v_and_b32 v141, 15, v1
  v_lshl_add_u32 v131, v141, 4, v140
  s_mov_b32 s78, 1
  v_mov_b32 v143, 0
  s_mov_b32 s41, 0
cpw_71:
  v_cmp_gt_u32 vcc, s78, v139
  s_nop 0
  s_and_b32 vcc_lo, vcc_lo, 0xfff000
  s_and_b32 vcc_hi, vcc_hi, 0xfffff0
  s_cmp_eq_u64 vcc, 0
  s_cbranch_scc1 cpo_72
  s_sleep 1
  buffer_load_dword v139, v134, s[8:11], 0 offen sc1
  s_add_u32 s41, s41, 1
  s_cmp_gt_u32 s41, 65536
  s_cbranch_scc1 chain_abort
  s_waitcnt vmcnt(0)
  s_branch cpw_71
cpo_72:
  s_add_u32 s55, s48, 98304
  s_sub_u32 s43, s40, 1
  s_and_b32 s43, s43, 3
  s_mul_i32 s43, s43, 227328
  s_add_u32 s57, s24, s43
  s_add_u32 s54, s55, s79
  s_and_b32 s42, s40, 3
  s_lshl_b32 s43, s42, 15
  s_add_u32 s52, s49, s43
  s_add_u32 s53, s52, 4096
  s_add_u32 s55, s48, s43
  s_add_u32 s50, s55, s56
  s_lshl_b32 s44, s38, 10
  s_add_u32 s51, s55, s44
  s_add_u32 s51, s51, 4096
  v_mov_b32 v68, 0
  v_mov_b32 v69, 0
  v_mov_b32 v70, 0
  v_mov_b32 v71, 0
  v_mov_b32 v72, 0
  v_mov_b32 v73, 0
  v_mov_b32 v74, 0
  v_mov_b32 v75, 0
  v_mov_b32 v76, 0
  v_mov_b32 v77, 0
  v_mov_b32 v78, 0
  v_mov_b32 v79, 0
chain_loop_c2n:
  s_mov_b32 s41, 0
  buffer_load_dwordx4 v[152:155], v126, s[8:11], s46 offen sc1
  buffer_load_dwordx4 v[156:159], v126, s[8:11], s46 offen offset:1024 sc1
  buffer_load_dwordx2 v[160:161], v127, s[8:11], s46 offen sc1
  s_sleep 2
mq_73:
  buffer_load_dwordx4 v[162:165], v126, s[8:11], s46 offen sc1
  buffer_load_dwordx4 v[108:111], v126, s[8:11], s46 offen offset:1024 sc1
  buffer_load_dwordx2 v[112:113], v127, s[8:11], s46 offen sc1
  s_waitcnt vmcnt(3)
  v_max3_u32 v140, v152, v153, v154
  v_max3_u32 v141, v155, v156, v157
  v_max3_u32 v140, v140, v158, v159
  v_max3_u32 v141, v141, v160, v161
  v_max_u32 v140, v140, v141
  v_cmp_eq_u32 vcc, -1, v140
  s_cbranch_vccz mq_73_a
  buffer_load_dwordx4 v[152:155], v126, s[8:11], s46 offen sc1
  buffer_load_dwordx4 v[156:159], v126, s[8:11], s46 offen offset:1024 sc1
  buffer_load_dwordx2 v[160:161], v127, s[8:11], s46 offen sc1
  s_add_u32 s41, s41, 1
  s_cmp_gt_u32 s41, 65536
  s_cbranch_scc1 chain_abort
  s_waitcnt vmcnt(3)
  v_max3_u32 v140, v162, v163, v164
  v_max3_u32 v141, v165, v108, v109
  v_max3_u32 v140, v140, v110, v111
  v_max3_u32 v141, v141, v112, v113
  v_max_u32 v140, v140, v141
  v_cmp_eq_u32 vcc, -1, v140
  s_cbranch_vccnz mq_73
  ds_write_b128 v126, v[162:165]
  ds_write_b128 v126, v[108:111] offset:1024
  ds_write_b64 v127, v[112:113]
  s_branch mq_73_ok
mq_73_a:
  ds_write_b128 v126, v[152:155]
  ds_write_b128 v126, v[156:159] offset:1024
  ds_write_b64 v127, v[160:161]
mq_73_ok:
  s_waitcnt lgkmcnt(0)
  s_barrier
  ds_read_b128 v[4:7], v124 offset:0
  ds_read_b128 v[8:11], v124 offset:1024
  ds_read_b128 v[12:15], v124 offset:2048
  ds_read_b128 v[16:19], v124 offset:3072
  ds_read_b128 v[20:23], v124 offset:4096
  ds_read_b128 v[24:27], v124 offset:5120
  ds_read_b128 v[28:31], v124 offset:6144
  ds_read_b128 v[32:35], v124 offset:7168
  ds_read_b128 v[36:39], v124 offset:8192
  ds_read_b128 v[40:43], v124 offset:9216
  s_waitcnt lgkmcnt(9)
  v_smfmac_f32_16x16x64_bf16 v[68:71], v[4:7], a[0:7], v136
  v_smfmac_f32_16x16x64_bf16 v[72:75], v[4:7], a[80:87], v136
  buffer_store_dwordx4 v[60:63], v138, s[8:11], s57 offen
  s_waitcnt lgkmcnt(8)
  v_smfmac_f32_16x16x64_bf16 v[68:71], v[8:11], a[8:15], v136
  v_smfmac_f32_16x16x64_bf16 v[72:75], v[8:11], a[88:95], v136
  buffer_store_dwordx4 v[64:67], v138, s[8:11], s57 offen offset:512
  s_waitcnt lgkmcnt(7)
  v_smfmac_f32_16x16x64_bf16 v[68:71], v[12:15], a[16:23], v136
  v_smfmac_f32_16x16x64_bf16 v[72:75], v[12:15], a[96:103], v136
  buffer_load_dword v139, v134, s[8:11], 0 offen sc1
  s_waitcnt lgkmcnt(6)
  v_smfmac_f32_16x16x64_bf16 v[68:71], v[16:19], a[24:31], v136
  v_smfmac_f32_16x16x64_bf16 v[72:75], v[16:19], a[104:111], v136
  s_waitcnt lgkmcnt(5)
  v_smfmac_f32_16x16x64_bf16 v[68:71], v[20:23], a[32:39], v136
  v_smfmac_f32_16x16x64_bf16 v[72:75], v[20:23], a[112:119], v136
  s_waitcnt lgkmcnt(4)
  v_smfmac_f32_16x16x64_bf16 v[68:71], v[24:27], a[40:47], v136
  v_smfmac_f32_16x16x64_bf16 v[72:75], v[24:27], a[120:127], v136
  s_waitcnt lgkmcnt(3)
  v_smfmac_f32_16x16x64_bf16 v[68:71], v[28:31], a[48:55], v136
  v_smfmac_f32_16x16x64_bf16 v[72:75], v[28:31], a[128:135], v136
  s_waitcnt lgkmcnt(2)
  v_smfmac_f32_16x16x64_bf16 v[68:71], v[32:35], a[56:63], v136
  v_smfmac_f32_16x16x64_bf16 v[72:75], v[32:35], a[136:143], v136
  s_waitcnt lgkmcnt(1)
  v_smfmac_f32_16x16x64_bf16 v[68:71], v[36:39], a[64:71], v136
  v_smfmac_f32_16x16x64_bf16 v[72:75], v[36:39], a[144:151], v136
  s_waitcnt lgkmcnt(0)
  v_smfmac_f32_16x16x64_bf16 v[68:71], v[40:43], a[72:79], v136
  v_smfmac_f32_16x16x64_bf16 v[72:75], v[40:43], a[152:159], v136
  v_smfmac_f32_16x16x64_bf16 v[76:79], v[4:7], a[160:167], v136
  v_smfmac_f32_16x16x64_bf16 v[76:79], v[8:11], a[168:175], v136
  s_nop 4
  v_add_f32 v68, v68, v70
  v_add_f32 v69, v69, v71
  v_add_f32 v72, v72, v74
  v_add_f32 v73, v73, v75
  v_smfmac_f32_16x16x64_bf16 v[76:79], v[12:15], a[176:183], v136
  v_cvt_pk_bf16_f32 v122, v68, v69
  v_cvt_pk_bf16_f32 v123, v72, v73
  ds_write2_b32 v128, v122, v122 offset0:0 offset1:4
  ds_write2_b32 v129, v123, v123 offset0:0 offset1:1
  v_smfmac_f32_16x16x64_bf16 v[76:79], v[16:19], a[184:191], v136
  v_smfmac_f32_16x16x64_bf16 v[76:79], v[20:23], a[192:199], v136
  s_waitcnt lgkmcnt(0)
  s_barrier
  ds_read_b64_tr_b16 v[60:61], v125 offset:12288
  ds_read_b64_tr_b16 v[62:63], v125 offset:12800
  ds_read_b64_tr_b16 v[64:65], v125 offset:13312
  ds_read_b64_tr_b16 v[66:67], v125 offset:13824
  v_smfmac_f32_16x16x64_bf16 v[76:79], v[24:27], a[200:207], v136
  v_smfmac_f32_16x16x64_bf16 v[76:79], v[28:31], a[208:215], v136
  v_smfmac_f32_16x16x64_bf16 v[76:79], v[32:35], a[216:223], v136
  v_smfmac_f32_16x16x64_bf16 v[76:79], v[36:39], a[224:231], v136
  v_smfmac_f32_16x16x64_bf16 v[76:79], v[40:43], a[232:239], v136
  s_nop 7
  v_add_f32 v76, v76, v78
  v_add_f32 v77, v77, v79
  v_cvt_pk_bf16_f32 v140, v76, v77
  s_nop 1
  v_mov_b32_dpp v141, v140 row_ror:4 row_mask:0xf bank_mask:0xa
  s_nop 1
  v_mov_b32_dpp v141, v140 row_ror:12 row_mask:0xf bank_mask:0x5
  v_perm_b32 v140, v141, v140, v137
  buffer_store_dword v140, v130, s[8:11], s51 offen
  s_and_b32 s42, s40, 3
  s_xor_b32 s42, s42, 2
  s_mul_i32 s42, s42, 163840
  s_add_u32 s42, s42, s64
  s_add_u32 s43, s42, 65536
  s_add_u32 s44, s42, s63
  s_waitcnt vmcnt(0)
  s_barrier
  buffer_store_dwordx4 v[84:87], v131, s[8:11], s42 offen sc1
  buffer_store_dwordx4 v[84:87], v131, s[8:11], s43 offen sc1
  buffer_store_dwordx4 v[84:87], v131, s[8:11], s44 offen sc1
  v_mov_b32 v143, s40
  s_add_u32 s40, s40, 1
  s_cmp_eq_u32 s40, 64
  s_cbranch_scc1 chain_last_c2n
  s_add_u32 s78, s40, 1
  s_waitcnt vmcnt(0)
  buffer_store_dword v143, v135, s[8:11], 0 offen
  s_mov_b32 s41, 0
cpw_74:
  v_cmp_gt_u32 vcc, s78, v139
  s_nop 0
  s_and_b32 vcc_lo, vcc_lo, 0xfff000
  s_and_b32 vcc_hi, vcc_hi, 0xfffff0
  s_cmp_eq_u64 vcc, 0
  s_cbranch_scc1 cpo_75
  s_sleep 1
  buffer_load_dword v139, v134, s[8:11], 0 offen sc1
  s_add_u32 s41, s41, 1
  s_cmp_gt_u32 s41, 65536
  s_cbranch_scc1 chain_abort
  s_waitcnt vmcnt(0)
  s_branch cpw_74
cpo_75:
  s_mov_b32 s42, s46
  s_mov_b32 s46, s47
  s_mov_b32 s47, s42
  s_sub_u32 s43, s40, 1
  s_and_b32 s43, s43, 3
  s_mul_i32 s43, s43, 227328
  s_add_u32 s57, s24, s43
  s_add_u32 s54, s55, s79
  s_and_b32 s42, s40, 3
  s_lshl_b32 s43, s42, 15
  s_add_u32 s52, s49, s43
  s_add_u32 s53, s52, 4096
  s_add_u32 s55, s48, s43
  s_add_u32 s50, s55, s56
  s_lshl_b32 s44, s38, 10
  s_add_u32 s51, s55, s44
  s_add_u32 s51, s51, 4096
  v_mov_b32 v68, 0
  v_mov_b32 v69, 0
  v_mov_b32 v70, 0
  v_mov_b32 v71, 0
  v_mov_b32 v72, 0
  v_mov_b32 v73, 0
  v_mov_b32 v74, 0
  v_mov_b32 v75, 0
  v_mov_b32 v76, 0
  v_mov_b32 v77, 0
  v_mov_b32 v78, 0
  v_mov_b32 v79, 0
  s_sleep 16
  s_branch chain_loop_c2n
chain_last_c2n:
  s_sub_u32 s43, s40, 1
  s_and_b32 s43, s43, 3
  s_mul_i32 s43, s43, 227328
  s_add_u32 s57, s24, s43
  s_waitcnt lgkmcnt(0)
  buffer_store_dwordx4 v[60:63], v138, s[8:11], s57 offen
  buffer_store_dwordx4 v[64:67], v138, s[8:11], s57 offen offset:512
  v_mov_b32 v143, s40
  s_branch chain_fin
chain_fin:
  s_waitcnt vmcnt(0)
  buffer_store_dword v143, v135, s[8:11], 0 offen
  s_endpgm
chain_abort:
  v_mov_b32 v140, 128
  v_mov_b32 v141, 1
  s_mov_b64 exec, 1
  buffer_atomic_add v141, v140, s[12:15], 0 offen
  s_endpgm
.section .rodata,"a"
.p2align 6
.amdhsa_kernel init_kernel
  .amdhsa_next_free_vgpr 256
  .amdhsa_next_free_sgpr 102
  .amdhsa_accum_offset 256
  .amdhsa_group_segment_fixed_size 0
  .amdhsa_kernarg_size 136
  .amdhsa_user_sgpr_count 2
  .amdhsa_user_sgpr_kernarg_segment_ptr 1
  .amdhsa_system_sgpr_workgroup_id_x 1
.end_amdhsa_kernel
.p2align 6
.amdhsa_kernel main_kernel
  .amdhsa_next_free_vgpr 512
  .amdhsa_next_free_sgpr 102
  .amdhsa_accum_offset 256
  .amdhsa_group_segment_fixed_size 0
  .amdhsa_kernarg_size 136
  .amdhsa_user_sgpr_count 2
  .amdhsa_user_sgpr_kernarg_segment_ptr 1
  .amdhsa_system_sgpr_workgroup_id_x 1
.end_amdhsa_kernel
```

```asm
; @launch kernel=main_kernel grid=(256,1,1) block=(256,1,1) lds=163840
.amdgcn_target "amdgcn-amd-amdhsa--gfx950"
.text
.globl main_kernel
.p2align 8
.type main_kernel,@function
main_kernel:
  s_load_dwordx2 s[8:9], s[0:1], 128
  s_mov_b32 s10, 268435456
  s_mov_b32 s11, 0x00020000
  s_load_dwordx2 s[12:13], s[0:1], 120
  s_mov_b32 s14, 256
  s_mov_b32 s15, 0x00020000
  s_load_dword s4, s[0:1], 0
  s_load_dword s5, s[0:1], 64
  s_getreg_b32 s16, hwreg(HW_REG_XCC_ID)
  s_and_b32 s16, s16, 7
  v_and_b32 v1, 63, v0
  v_lshrrev_b32 v2, 6, v0
  s_nop 0
  v_readfirstlane_b32 s17, v2
  v_mov_b32 v3, 1
  s_lshl_b32 s3, s16, 2
  v_mov_b32 v4, s3
  v_mov_b32 v5, 0
  s_waitcnt lgkmcnt(0)
  v_cmp_eq_u32 vcc, 0, v0
  s_nop 0
  s_and_b64 exec, exec, vcc
  s_cbranch_execz main_tk
  buffer_atomic_add v3, v4, s[12:15], 0 offen sc0
  s_waitcnt vmcnt(0)
  ds_write_b32 v5, v3
  s_waitcnt lgkmcnt(0)
main_tk:
  s_mov_b64 exec, -1
  s_barrier
  ds_read_b32 v3, v5
  s_waitcnt lgkmcnt(0)
  v_readfirstlane_b32 s18, v3
  s_barrier
  s_cmp_ge_u32 s18, 32
  s_cbranch_scc1 role_none
  s_sub_u32 s18, 31, s18
  s_cmp_lt_u32 s18, 12
  s_cbranch_scc1 role_chain
  s_cmp_lt_u32 s18, 21
  s_cbranch_scc1 role_p
  s_cmp_lt_u32 s18, 26
  s_cbranch_scc1 role_ua
  s_cmp_lt_u32 s18, 28
  s_cbranch_scc1 role_sm
  s_cmp_lt_u32 s18, 32
  s_cbranch_scc1 role_r
role_none:
  s_endpgm
role_abort:
  v_mov_b32 v2, 132
  v_mov_b32 v3, 1
  s_mov_b64 exec, 1
  buffer_atomic_add v3, v2, s[12:15], 0 offen
  s_endpgm
role_p:
  s_sub_u32 s24, s18, 12
  s_lshl_b32 s24, s24, 2
  s_add_u32 s24, s24, s17
  s_mul_i32 s25, s24, 43
  s_lshr_b32 s25, s25, 9
  s_mul_i32 s30, s25, 12
  s_sub_u32 s30, s24, s30
  s_mul_i32 s26, s30, 43
  s_lshr_b32 s26, s26, 7
  s_mul_i32 s31, s26, 3
  s_sub_u32 s27, s30, s31
  s_load_dwordx2 s[20:21], s[0:1], 16
  s_load_dwordx2 s[4:5], s[0:1], 24
  s_load_dwordx2 s[6:7], s[0:1], 32
  s_mov_b32 s22, 7864320
  s_mov_b32 s23, 0x00020000
  s_waitcnt lgkmcnt(0)
  s_cmp_eq_u32 s25, 1
  s_cselect_b64 s[20:21], s[4:5], s[20:21]
  s_cmp_eq_u32 s25, 2
  s_cselect_b64 s[20:21], s[6:7], s[20:21]
  v_lshrrev_b32 v107, 4, v1
  v_and_b32 v107, 3, v107
  v_lshlrev_b32 v107, 1, v107
  v_and_b32 v52, 7, v1
  v_xor_b32 v52, v52, v107
  v_lshlrev_b32 v52, 4, v52
  v_lshrrev_b32 v107, 3, v1
  v_mul_u32_u24 v107, 0, v107
  v_add_u32 v52, v52, v107
  v_bfe_u32 v107, v1, 3, 2
  v_bfe_u32 v108, v1, 5, 1
  v_lshl_add_u32 v107, v108, 3, v107
  v_mul_u32_u24 v107, 12288, v107
  v_add_u32 v52, v52, v107
  s_mul_i32 s33, s17, 40960
  v_lshrrev_b32 v107, 2, v1
  v_lshrrev_b32 v108, 1, v107
  v_and_b32 v108, 3, v108
  v_lshlrev_b32 v108, 1, v108
  v_bfe_u32 v112, v1, 1, 1
  v_add_u32 v112, 0, v112
  v_xor_b32 v112, v112, v108
  v_lshlrev_b32 v112, 4, v112
  v_lshlrev_b32 v107, 7, v107
  v_add_u32 v112, v112, v107
  v_and_b32 v107, 1, v1
  v_lshlrev_b32 v107, 3, v107
  v_add_u32 v112, v112, v107
  v_add_u32 v112, s33, v112
  v_lshrrev_b32 v107, 2, v1
  v_lshrrev_b32 v108, 1, v107
  v_and_b32 v108, 3, v108
  v_lshlrev_b32 v108, 1, v108
  v_bfe_u32 v113, v1, 1, 1
  v_add_u32 v113, 2, v113
  v_xor_b32 v113, v113, v108
  v_lshlrev_b32 v113, 4, v113
  v_lshlrev_b32 v107, 7, v107
  v_add_u32 v113, v113, v107
  v_and_b32 v107, 1, v1
  v_lshlrev_b32 v107, 3, v107
  v_add_u32 v113, v113, v107
  v_add_u32 v113, s33, v113
  v_lshrrev_b32 v107, 2, v1
  v_lshrrev_b32 v108, 1, v107
  v_and_b32 v108, 3, v108
  v_lshlrev_b32 v108, 1, v108
  v_bfe_u32 v114, v1, 1, 1
  v_add_u32 v114, 4, v114
  v_xor_b32 v114, v114, v108
  v_lshlrev_b32 v114, 4, v114
  v_lshlrev_b32 v107, 7, v107
  v_add_u32 v114, v114, v107
  v_and_b32 v107, 1, v1
  v_lshlrev_b32 v107, 3, v107
  v_add_u32 v114, v114, v107
  v_add_u32 v114, s33, v114
  v_lshrrev_b32 v107, 2, v1
  v_lshrrev_b32 v108, 1, v107
  v_and_b32 v108, 3, v108
  v_lshlrev_b32 v108, 1, v108
  v_bfe_u32 v115, v1, 1, 1
  v_add_u32 v115, 6, v115
  v_xor_b32 v115, v115, v108
  v_lshlrev_b32 v115, 4, v115
  v_lshlrev_b32 v107, 7, v107
  v_add_u32 v115, v115, v107
  v_and_b32 v107, 1, v1
  v_lshlrev_b32 v107, 3, v107
  v_add_u32 v115, v115, v107
  v_add_u32 v115, s33, v115
  s_lshl_b32 s30, s16, 2
  s_add_u32 s30, s30, s26
  s_mul_i32 s32, s30, 384
  s_lshl_b32 s31, s27, 7
  s_add_u32 s32, s32, s31
  s_lshl_b32 s38, s16, 22
  s_mul_i32 s30, s26, 12288
  s_add_u32 s38, s38, s30
  s_mul_i32 s30, s25, 49152
  s_add_u32 s38, s38, s30
  s_lshl_b32 s31, s27, 11
  s_add_u32 s38, s38, s31
  s_add_u32 s38, s38, 67108864
  s_mov_b32 s35, s38
  s_mov_b32 s39, 6144
  s_cmp_lg_u32 s24, 8
  s_cbranch_scc1 p_nc
  s_lshl_b32 s92, s16, 8
  s_add_u32 s92, s92, 1933312
  s_mov_b32 s93, 0
  s_mov_b32 s94, -1
  s_mov_b32 s95, -1
  v_lshlrev_b32 v92, 2, v1
  v_mov_b32 v93, -1
  s_waitcnt vmcnt(0)
boot_cal:
  s_memtime s[88:89]
  s_waitcnt lgkmcnt(0)
  buffer_store_dword v93, v92, s[8:11], s92 offen sc1
  s_waitcnt vmcnt(0)
  s_memtime s[90:91]
  s_waitcnt lgkmcnt(0)
  s_sub_u32 s88, s90, s88
  s_min_u32 s88, s88, s94
  s_mov_b32 s94, s95
  s_mov_b32 s95, s88
  s_xor_b32 s92, s92, 8192
  s_add_u32 s93, s93, 1
  s_cmp_lt_u32 s93, 10
  s_cbranch_scc1 boot_cal
  v_mov_b32 v92, 192
  s_mov_b32 s93, 0
gw_1:
  buffer_load_dword v93, v92, s[12:15], 0 offen sc1
  s_add_u32 s93, s93, 1
  s_cmp_gt_u32 s93, 65536
  s_cbranch_scc1 role_abort
  s_waitcnt vmcnt(0)
  v_cmp_gt_u32 vcc, 16, v93
  s_cbranch_vccz gk_2
  s_sleep 8
  s_branch gw_1
gk_2:
  s_cmp_lt_u32 s94, s95
  s_cselect_b32 s93, 1, 2
  s_lshl_b32 s92, s16, 8
  v_mov_b32 v92, s93
  v_mov_b32 v93, s92
  s_mov_b64 exec, 1
  buffer_store_dword v92, v93, s[8:11], 0 offen offset:240
  s_mov_b64 exec, -1
  s_branch p_go
p_nc:
  s_cmp_lg_u32 s25, 0
  s_cbranch_scc1 p_go
p_go:
  v_and_b32 v110, 15, v1
  v_lshlrev_b32 v110, 7, v110
  v_bfe_u32 v107, v1, 4, 1
  v_mad_u32_u24 v110, v107, s39, v110
  v_lshrrev_b32 v107, 5, v1
  v_mul_u32_u24 v107, 147456, v107
  v_add_u32 v109, v107, v110
  s_add_u32 s39, s38, 294912
  s_add_u32 m0, s33, 0
  s_add_u32 s30, s32, 0
  buffer_load_dwordx4 v52, s[20:23], s30 offen nt lds
  s_add_u32 m0, s33, 1024
  s_add_u32 s30, s32, 196608
  buffer_load_dwordx4 v52, s[20:23], s30 offen nt lds
  s_add_u32 m0, s33, 2048
  s_add_u32 s30, s32, 49152
  buffer_load_dwordx4 v52, s[20:23], s30 offen nt lds
  s_add_u32 m0, s33, 3072
  s_add_u32 s30, s32, 245760
  buffer_load_dwordx4 v52, s[20:23], s30 offen nt lds
  s_add_u32 m0, s33, 4096
  s_add_u32 s30, s32, 393216
  buffer_load_dwordx4 v52, s[20:23], s30 offen nt lds
  s_add_u32 m0, s33, 5120
  s_add_u32 s30, s32, 589824
  buffer_load_dwordx4 v52, s[20:23], s30 offen nt lds
  s_add_u32 m0, s33, 6144
  s_add_u32 s30, s32, 442368
  buffer_load_dwordx4 v52, s[20:23], s30 offen nt lds
  s_add_u32 m0, s33, 7168
  s_add_u32 s30, s32, 638976
  buffer_load_dwordx4 v52, s[20:23], s30 offen nt lds
  s_add_u32 m0, s33, 8192
  s_add_u32 s30, s32, 786432
  buffer_load_dwordx4 v52, s[20:23], s30 offen nt lds
  s_add_u32 m0, s33, 9216
  s_add_u32 s30, s32, 983040
  buffer_load_dwordx4 v52, s[20:23], s30 offen nt lds
  s_add_u32 m0, s33, 10240
  s_add_u32 s30, s32, 835584
  buffer_load_dwordx4 v52, s[20:23], s30 offen nt lds
  s_add_u32 m0, s33, 11264
  s_add_u32 s30, s32, 1032192
  buffer_load_dwordx4 v52, s[20:23], s30 offen nt lds
  s_add_u32 m0, s33, 12288
  s_add_u32 s30, s32, 1179648
  buffer_load_dwordx4 v52, s[20:23], s30 offen nt lds
  s_add_u32 m0, s33, 13312
  s_add_u32 s30, s32, 1376256
  buffer_load_dwordx4 v52, s[20:23], s30 offen nt lds
  s_add_u32 m0, s33, 14336
  s_add_u32 s30, s32, 1228800
  buffer_load_dwordx4 v52, s[20:23], s30 offen nt lds
  s_add_u32 m0, s33, 15360
  s_add_u32 s30, s32, 1425408
  buffer_load_dwordx4 v52, s[20:23], s30 offen nt lds
  s_add_u32 m0, s33, 16384
  s_add_u32 s30, s32, 1572864
  buffer_load_dwordx4 v52, s[20:23], s30 offen nt lds
  s_add_u32 m0, s33, 17408
  s_add_u32 s30, s32, 1769472
  buffer_load_dwordx4 v52, s[20:23], s30 offen nt lds
  s_add_u32 m0, s33, 18432
  s_add_u32 s30, s32, 1622016
  buffer_load_dwordx4 v52, s[20:23], s30 offen nt lds
  s_add_u32 m0, s33, 19456
  s_add_u32 s30, s32, 1818624
  buffer_load_dwordx4 v52, s[20:23], s30 offen nt lds
  s_add_u32 m0, s33, 20480
  s_add_u32 s30, s32, 1966080
  buffer_load_dwordx4 v52, s[20:23], s30 offen nt lds
  s_add_u32 m0, s33, 21504
  s_add_u32 s30, s32, 2162688
  buffer_load_dwordx4 v52, s[20:23], s30 offen nt lds
  s_add_u32 m0, s33, 22528
  s_add_u32 s30, s32, 2015232
  buffer_load_dwordx4 v52, s[20:23], s30 offen nt lds
  s_add_u32 m0, s33, 23552
  s_add_u32 s30, s32, 2211840
  buffer_load_dwordx4 v52, s[20:23], s30 offen nt lds
  s_waitcnt vmcnt(20)
  s_add_u32 m0, s33, 24576
  s_add_u32 s30, s32, 2359296
  buffer_load_dwordx4 v52, s[20:23], s30 offen nt lds
  s_add_u32 m0, s33, 25600
  s_add_u32 s30, s32, 2555904
  buffer_load_dwordx4 v52, s[20:23], s30 offen nt lds
  s_add_u32 m0, s33, 26624
  s_add_u32 s30, s32, 2408448
  buffer_load_dwordx4 v52, s[20:23], s30 offen nt lds
  s_add_u32 m0, s33, 27648
  s_add_u32 s30, s32, 2605056
  buffer_load_dwordx4 v52, s[20:23], s30 offen nt lds
  ds_read_b64_tr_b16 v[192:193], v112 offset:0
  ds_read_b64_tr_b16 v[194:195], v112 offset:2048
  ds_read_b64_tr_b16 a[16:17], v113 offset:0
  ds_read_b64_tr_b16 a[18:19], v113 offset:2048
  ds_read_b64_tr_b16 a[96:97], v114 offset:0
  ds_read_b64_tr_b16 a[98:99], v114 offset:2048
  ds_read_b64_tr_b16 a[176:177], v115 offset:0
  ds_read_b64_tr_b16 a[178:179], v115 offset:2048
  s_waitcnt lgkmcnt(8)
  s_waitcnt vmcnt(20)
  s_add_u32 m0, s33, 28672
  s_add_u32 s30, s32, 2752512
  buffer_load_dwordx4 v52, s[20:23], s30 offen nt lds
  s_add_u32 m0, s33, 29696
  s_add_u32 s30, s32, 2949120
  buffer_load_dwordx4 v52, s[20:23], s30 offen nt lds
  s_add_u32 m0, s33, 30720
  s_add_u32 s30, s32, 2801664
  buffer_load_dwordx4 v52, s[20:23], s30 offen nt lds
  s_add_u32 m0, s33, 31744
  s_add_u32 s30, s32, 2998272
  buffer_load_dwordx4 v52, s[20:23], s30 offen nt lds
  ds_read_b64_tr_b16 v[196:197], v112 offset:4096
  ds_read_b64_tr_b16 v[198:199], v112 offset:6144
  ds_read_b64_tr_b16 a[20:21], v113 offset:4096
  ds_read_b64_tr_b16 a[22:23], v113 offset:6144
  ds_read_b64_tr_b16 a[100:101], v114 offset:4096
  ds_read_b64_tr_b16 a[102:103], v114 offset:6144
  ds_read_b64_tr_b16 a[180:181], v115 offset:4096
  ds_read_b64_tr_b16 a[182:183], v115 offset:6144
  s_waitcnt lgkmcnt(8)
  s_waitcnt vmcnt(20)
  s_add_u32 m0, s33, 32768
  s_add_u32 s30, s32, 3145728
  buffer_load_dwordx4 v52, s[20:23], s30 offen nt lds
  s_add_u32 m0, s33, 33792
  s_add_u32 s30, s32, 3342336
  buffer_load_dwordx4 v52, s[20:23], s30 offen nt lds
  s_add_u32 m0, s33, 34816
  s_add_u32 s30, s32, 3194880
  buffer_load_dwordx4 v52, s[20:23], s30 offen nt lds
  s_add_u32 m0, s33, 35840
  s_add_u32 s30, s32, 3391488
  buffer_load_dwordx4 v52, s[20:23], s30 offen nt lds
  ds_read_b64_tr_b16 v[200:201], v112 offset:8192
  ds_read_b64_tr_b16 v[202:203], v112 offset:10240
  ds_read_b64_tr_b16 a[24:25], v113 offset:8192
  ds_read_b64_tr_b16 a[26:27], v113 offset:10240
  ds_read_b64_tr_b16 a[104:105], v114 offset:8192
  ds_read_b64_tr_b16 a[106:107], v114 offset:10240
  ds_read_b64_tr_b16 a[184:185], v115 offset:8192
  ds_read_b64_tr_b16 a[186:187], v115 offset:10240
  s_waitcnt lgkmcnt(8)
  s_waitcnt vmcnt(20)
  s_add_u32 m0, s33, 36864
  s_add_u32 s30, s32, 3538944
  buffer_load_dwordx4 v52, s[20:23], s30 offen nt lds
  s_add_u32 m0, s33, 37888
  s_add_u32 s30, s32, 3735552
  buffer_load_dwordx4 v52, s[20:23], s30 offen nt lds
  s_add_u32 m0, s33, 38912
  s_add_u32 s30, s32, 3588096
  buffer_load_dwordx4 v52, s[20:23], s30 offen nt lds
  s_add_u32 m0, s33, 39936
  s_add_u32 s30, s32, 3784704
  buffer_load_dwordx4 v52, s[20:23], s30 offen nt lds
  ds_read_b64_tr_b16 v[204:205], v112 offset:12288
  ds_read_b64_tr_b16 v[206:207], v112 offset:14336
  ds_read_b64_tr_b16 a[28:29], v113 offset:12288
  ds_read_b64_tr_b16 a[30:31], v113 offset:14336
  ds_read_b64_tr_b16 a[108:109], v114 offset:12288
  ds_read_b64_tr_b16 a[110:111], v114 offset:14336
  ds_read_b64_tr_b16 a[188:189], v115 offset:12288
  ds_read_b64_tr_b16 a[190:191], v115 offset:14336
  s_waitcnt lgkmcnt(8)
  s_waitcnt vmcnt(20)
  s_add_u32 m0, s33, 0
  s_add_u32 s30, s32, 3932160
  buffer_load_dwordx4 v52, s[20:23], s30 offen nt lds
  s_add_u32 m0, s33, 1024
  s_add_u32 s30, s32, 4128768
  buffer_load_dwordx4 v52, s[20:23], s30 offen nt lds
  s_add_u32 m0, s33, 2048
  s_add_u32 s30, s32, 3981312
  buffer_load_dwordx4 v52, s[20:23], s30 offen nt lds
  s_add_u32 m0, s33, 3072
  s_add_u32 s30, s32, 4177920
  buffer_load_dwordx4 v52, s[20:23], s30 offen nt lds
  ds_read_b64_tr_b16 v[208:209], v112 offset:16384
  ds_read_b64_tr_b16 v[210:211], v112 offset:18432
  ds_read_b64_tr_b16 a[32:33], v113 offset:16384
  ds_read_b64_tr_b16 a[34:35], v113 offset:18432
  ds_read_b64_tr_b16 a[112:113], v114 offset:16384
  ds_read_b64_tr_b16 a[114:115], v114 offset:18432
  ds_read_b64_tr_b16 a[192:193], v115 offset:16384
  ds_read_b64_tr_b16 a[194:195], v115 offset:18432
  s_waitcnt lgkmcnt(8)
  s_waitcnt vmcnt(20)
  s_add_u32 m0, s33, 4096
  s_add_u32 s30, s32, 4325376
  buffer_load_dwordx4 v52, s[20:23], s30 offen nt lds
  s_add_u32 m0, s33, 5120
  s_add_u32 s30, s32, 4521984
  buffer_load_dwordx4 v52, s[20:23], s30 offen nt lds
  s_add_u32 m0, s33, 6144
  s_add_u32 s30, s32, 4374528
  buffer_load_dwordx4 v52, s[20:23], s30 offen nt lds
  s_add_u32 m0, s33, 7168
  s_add_u32 s30, s32, 4571136
  buffer_load_dwordx4 v52, s[20:23], s30 offen nt lds
  ds_read_b64_tr_b16 v[212:213], v112 offset:20480
  ds_read_b64_tr_b16 v[214:215], v112 offset:22528
  ds_read_b64_tr_b16 a[36:37], v113 offset:20480
  ds_read_b64_tr_b16 a[38:39], v113 offset:22528
  ds_read_b64_tr_b16 a[116:117], v114 offset:20480
  ds_read_b64_tr_b16 a[118:119], v114 offset:22528
  ds_read_b64_tr_b16 a[196:197], v115 offset:20480
  ds_read_b64_tr_b16 a[198:199], v115 offset:22528
  s_waitcnt lgkmcnt(8)
  s_waitcnt vmcnt(20)
  s_add_u32 m0, s33, 8192
  s_add_u32 s30, s32, 4718592
  buffer_load_dwordx4 v52, s[20:23], s30 offen nt lds
  s_add_u32 m0, s33, 9216
  s_add_u32 s30, s32, 4915200
  buffer_load_dwordx4 v52, s[20:23], s30 offen nt lds
  s_add_u32 m0, s33, 10240
  s_add_u32 s30, s32, 4767744
  buffer_load_dwordx4 v52, s[20:23], s30 offen nt lds
  s_add_u32 m0, s33, 11264
  s_add_u32 s30, s32, 4964352
  buffer_load_dwordx4 v52, s[20:23], s30 offen nt lds
  ds_read_b64_tr_b16 v[216:217], v112 offset:24576
  ds_read_b64_tr_b16 v[218:219], v112 offset:26624
  ds_read_b64_tr_b16 a[40:41], v113 offset:24576
  ds_read_b64_tr_b16 a[42:43], v113 offset:26624
  ds_read_b64_tr_b16 a[120:121], v114 offset:24576
  ds_read_b64_tr_b16 a[122:123], v114 offset:26624
  ds_read_b64_tr_b16 a[200:201], v115 offset:24576
  ds_read_b64_tr_b16 a[202:203], v115 offset:26624
  s_waitcnt lgkmcnt(8)
  s_waitcnt vmcnt(20)
  s_add_u32 m0, s33, 12288
  s_add_u32 s30, s32, 5111808
  buffer_load_dwordx4 v52, s[20:23], s30 offen nt lds
  s_add_u32 m0, s33, 13312
  s_add_u32 s30, s32, 5308416
  buffer_load_dwordx4 v52, s[20:23], s30 offen nt lds
  s_add_u32 m0, s33, 14336
  s_add_u32 s30, s32, 5160960
  buffer_load_dwordx4 v52, s[20:23], s30 offen nt lds
  s_add_u32 m0, s33, 15360
  s_add_u32 s30, s32, 5357568
  buffer_load_dwordx4 v52, s[20:23], s30 offen nt lds
  ds_read_b64_tr_b16 v[220:221], v112 offset:28672
  ds_read_b64_tr_b16 v[222:223], v112 offset:30720
  ds_read_b64_tr_b16 a[44:45], v113 offset:28672
  ds_read_b64_tr_b16 a[46:47], v113 offset:30720
  ds_read_b64_tr_b16 a[124:125], v114 offset:28672
  ds_read_b64_tr_b16 a[126:127], v114 offset:30720
  ds_read_b64_tr_b16 a[204:205], v115 offset:28672
  ds_read_b64_tr_b16 a[206:207], v115 offset:30720
  s_waitcnt lgkmcnt(8)
  s_waitcnt vmcnt(20)
  s_add_u32 m0, s33, 16384
  s_add_u32 s30, s32, 5505024
  buffer_load_dwordx4 v52, s[20:23], s30 offen nt lds
  s_add_u32 m0, s33, 17408
  s_add_u32 s30, s32, 5701632
  buffer_load_dwordx4 v52, s[20:23], s30 offen nt lds
  s_add_u32 m0, s33, 18432
  s_add_u32 s30, s32, 5554176
  buffer_load_dwordx4 v52, s[20:23], s30 offen nt lds
  s_add_u32 m0, s33, 19456
  s_add_u32 s30, s32, 5750784
  buffer_load_dwordx4 v52, s[20:23], s30 offen nt lds
  ds_read_b64_tr_b16 v[224:225], v112 offset:32768
  ds_read_b64_tr_b16 v[226:227], v112 offset:34816
  ds_read_b64_tr_b16 a[48:49], v113 offset:32768
  ds_read_b64_tr_b16 a[50:51], v113 offset:34816
  ds_read_b64_tr_b16 a[128:129], v114 offset:32768
  ds_read_b64_tr_b16 a[130:131], v114 offset:34816
  ds_read_b64_tr_b16 a[208:209], v115 offset:32768
  ds_read_b64_tr_b16 a[210:211], v115 offset:34816
  s_waitcnt lgkmcnt(8)
  s_waitcnt vmcnt(20)
  s_add_u32 m0, s33, 20480
  s_add_u32 s30, s32, 5898240
  buffer_load_dwordx4 v52, s[20:23], s30 offen nt lds
  s_add_u32 m0, s33, 21504
  s_add_u32 s30, s32, 6094848
  buffer_load_dwordx4 v52, s[20:23], s30 offen nt lds
  s_add_u32 m0, s33, 22528
  s_add_u32 s30, s32, 5947392
  buffer_load_dwordx4 v52, s[20:23], s30 offen nt lds
  s_add_u32 m0, s33, 23552
  s_add_u32 s30, s32, 6144000
  buffer_load_dwordx4 v52, s[20:23], s30 offen nt lds
  ds_read_b64_tr_b16 v[228:229], v112 offset:36864
  ds_read_b64_tr_b16 v[230:231], v112 offset:38912
  ds_read_b64_tr_b16 a[52:53], v113 offset:36864
  ds_read_b64_tr_b16 a[54:55], v113 offset:38912
  ds_read_b64_tr_b16 a[132:133], v114 offset:36864
  ds_read_b64_tr_b16 a[134:135], v114 offset:38912
  ds_read_b64_tr_b16 a[212:213], v115 offset:36864
  ds_read_b64_tr_b16 a[214:215], v115 offset:38912
  s_waitcnt lgkmcnt(8)
  s_waitcnt vmcnt(20)
  s_add_u32 m0, s33, 24576
  s_add_u32 s30, s32, 6291456
  buffer_load_dwordx4 v52, s[20:23], s30 offen nt lds
  s_add_u32 m0, s33, 25600
  s_add_u32 s30, s32, 6488064
  buffer_load_dwordx4 v52, s[20:23], s30 offen nt lds
  s_add_u32 m0, s33, 26624
  s_add_u32 s30, s32, 6340608
  buffer_load_dwordx4 v52, s[20:23], s30 offen nt lds
  s_add_u32 m0, s33, 27648
  s_add_u32 s30, s32, 6537216
  buffer_load_dwordx4 v52, s[20:23], s30 offen nt lds
  ds_read_b64_tr_b16 v[232:233], v112 offset:0
  ds_read_b64_tr_b16 v[234:235], v112 offset:2048
  ds_read_b64_tr_b16 a[56:57], v113 offset:0
  ds_read_b64_tr_b16 a[58:59], v113 offset:2048
  ds_read_b64_tr_b16 a[136:137], v114 offset:0
  ds_read_b64_tr_b16 a[138:139], v114 offset:2048
  ds_read_b64_tr_b16 a[216:217], v115 offset:0
  ds_read_b64_tr_b16 a[218:219], v115 offset:2048
  s_waitcnt lgkmcnt(8)
  s_waitcnt vmcnt(20)
  s_add_u32 m0, s33, 28672
  s_add_u32 s30, s32, 6684672
  buffer_load_dwordx4 v52, s[20:23], s30 offen nt lds
  s_add_u32 m0, s33, 29696
  s_add_u32 s30, s32, 6881280
  buffer_load_dwordx4 v52, s[20:23], s30 offen nt lds
  s_add_u32 m0, s33, 30720
  s_add_u32 s30, s32, 6733824
  buffer_load_dwordx4 v52, s[20:23], s30 offen nt lds
  s_add_u32 m0, s33, 31744
  s_add_u32 s30, s32, 6930432
  buffer_load_dwordx4 v52, s[20:23], s30 offen nt lds
  ds_read_b64_tr_b16 v[236:237], v112 offset:4096
  ds_read_b64_tr_b16 v[238:239], v112 offset:6144
  ds_read_b64_tr_b16 a[60:61], v113 offset:4096
  ds_read_b64_tr_b16 a[62:63], v113 offset:6144
  ds_read_b64_tr_b16 a[140:141], v114 offset:4096
  ds_read_b64_tr_b16 a[142:143], v114 offset:6144
  ds_read_b64_tr_b16 a[220:221], v115 offset:4096
  ds_read_b64_tr_b16 a[222:223], v115 offset:6144
  s_waitcnt lgkmcnt(8)
  s_waitcnt vmcnt(20)
  s_add_u32 m0, s33, 32768
  s_add_u32 s30, s32, 7077888
  buffer_load_dwordx4 v52, s[20:23], s30 offen nt lds
  s_add_u32 m0, s33, 33792
  s_add_u32 s30, s32, 7274496
  buffer_load_dwordx4 v52, s[20:23], s30 offen nt lds
  s_add_u32 m0, s33, 34816
  s_add_u32 s30, s32, 7127040
  buffer_load_dwordx4 v52, s[20:23], s30 offen nt lds
  s_add_u32 m0, s33, 35840
  s_add_u32 s30, s32, 7323648
  buffer_load_dwordx4 v52, s[20:23], s30 offen nt lds
  ds_read_b64_tr_b16 v[240:241], v112 offset:8192
  ds_read_b64_tr_b16 v[242:243], v112 offset:10240
  ds_read_b64_tr_b16 a[64:65], v113 offset:8192
  ds_read_b64_tr_b16 a[66:67], v113 offset:10240
  ds_read_b64_tr_b16 a[144:145], v114 offset:8192
  ds_read_b64_tr_b16 a[146:147], v114 offset:10240
  ds_read_b64_tr_b16 a[224:225], v115 offset:8192
  ds_read_b64_tr_b16 a[226:227], v115 offset:10240
  s_waitcnt lgkmcnt(8)
  s_waitcnt vmcnt(20)
  s_add_u32 m0, s33, 36864
  s_add_u32 s30, s32, 7471104
  buffer_load_dwordx4 v52, s[20:23], s30 offen nt lds
  s_add_u32 m0, s33, 37888
  s_add_u32 s30, s32, 7667712
  buffer_load_dwordx4 v52, s[20:23], s30 offen nt lds
  s_add_u32 m0, s33, 38912
  s_add_u32 s30, s32, 7520256
  buffer_load_dwordx4 v52, s[20:23], s30 offen nt lds
  s_add_u32 m0, s33, 39936
  s_add_u32 s30, s32, 7716864
  buffer_load_dwordx4 v52, s[20:23], s30 offen nt lds
  ds_read_b64_tr_b16 v[244:245], v112 offset:12288
  ds_read_b64_tr_b16 v[246:247], v112 offset:14336
  ds_read_b64_tr_b16 a[68:69], v113 offset:12288
  ds_read_b64_tr_b16 a[70:71], v113 offset:14336
  ds_read_b64_tr_b16 a[148:149], v114 offset:12288
  ds_read_b64_tr_b16 a[150:151], v114 offset:14336
  ds_read_b64_tr_b16 a[228:229], v115 offset:12288
  ds_read_b64_tr_b16 a[230:231], v115 offset:14336
  s_waitcnt lgkmcnt(8)
  s_waitcnt vmcnt(20)
  ds_read_b64_tr_b16 v[248:249], v112 offset:16384
  ds_read_b64_tr_b16 v[250:251], v112 offset:18432
  ds_read_b64_tr_b16 a[72:73], v113 offset:16384
  ds_read_b64_tr_b16 a[74:75], v113 offset:18432
  ds_read_b64_tr_b16 a[152:153], v114 offset:16384
  ds_read_b64_tr_b16 a[154:155], v114 offset:18432
  ds_read_b64_tr_b16 a[232:233], v115 offset:16384
  ds_read_b64_tr_b16 a[234:235], v115 offset:18432
  s_waitcnt lgkmcnt(8)
  s_waitcnt vmcnt(16)
  ds_read_b64_tr_b16 v[252:253], v112 offset:20480
  ds_read_b64_tr_b16 v[254:255], v112 offset:22528
  ds_read_b64_tr_b16 a[76:77], v113 offset:20480
  ds_read_b64_tr_b16 a[78:79], v113 offset:22528
  ds_read_b64_tr_b16 a[156:157], v114 offset:20480
  ds_read_b64_tr_b16 a[158:159], v114 offset:22528
  ds_read_b64_tr_b16 a[236:237], v115 offset:20480
  ds_read_b64_tr_b16 a[238:239], v115 offset:22528
  s_waitcnt lgkmcnt(8)
  s_waitcnt vmcnt(12)
  ds_read_b64_tr_b16 a[0:1], v112 offset:24576
  ds_read_b64_tr_b16 a[2:3], v112 offset:26624
  ds_read_b64_tr_b16 a[80:81], v113 offset:24576
  ds_read_b64_tr_b16 a[82:83], v113 offset:26624
  ds_read_b64_tr_b16 a[160:161], v114 offset:24576
  ds_read_b64_tr_b16 a[162:163], v114 offset:26624
  ds_read_b64_tr_b16 a[240:241], v115 offset:24576
  ds_read_b64_tr_b16 a[242:243], v115 offset:26624
  s_waitcnt lgkmcnt(8)
  s_waitcnt vmcnt(8)
  ds_read_b64_tr_b16 a[4:5], v112 offset:28672
  ds_read_b64_tr_b16 a[6:7], v112 offset:30720
  ds_read_b64_tr_b16 a[84:85], v113 offset:28672
  ds_read_b64_tr_b16 a[86:87], v113 offset:30720
  ds_read_b64_tr_b16 a[164:165], v114 offset:28672
  ds_read_b64_tr_b16 a[166:167], v114 offset:30720
  ds_read_b64_tr_b16 a[244:245], v115 offset:28672
  ds_read_b64_tr_b16 a[246:247], v115 offset:30720
  s_waitcnt lgkmcnt(8)
  s_waitcnt vmcnt(4)
  ds_read_b64_tr_b16 a[8:9], v112 offset:32768
  ds_read_b64_tr_b16 a[10:11], v112 offset:34816
  ds_read_b64_tr_b16 a[88:89], v113 offset:32768
  ds_read_b64_tr_b16 a[90:91], v113 offset:34816
  ds_read_b64_tr_b16 a[168:169], v114 offset:32768
  ds_read_b64_tr_b16 a[170:171], v114 offset:34816
  ds_read_b64_tr_b16 a[248:249], v115 offset:32768
  ds_read_b64_tr_b16 a[250:251], v115 offset:34816
  s_waitcnt lgkmcnt(8)
  s_waitcnt vmcnt(0)
  ds_read_b64_tr_b16 a[12:13], v112 offset:36864
  ds_read_b64_tr_b16 a[14:15], v112 offset:38912
  ds_read_b64_tr_b16 a[92:93], v113 offset:36864
  ds_read_b64_tr_b16 a[94:95], v113 offset:38912
  ds_read_b64_tr_b16 a[172:173], v114 offset:36864
  ds_read_b64_tr_b16 a[174:175], v114 offset:38912
  ds_read_b64_tr_b16 a[252:253], v115 offset:36864
  ds_read_b64_tr_b16 a[254:255], v115 offset:38912
  s_waitcnt lgkmcnt(8)
  s_waitcnt lgkmcnt(0)
  v_lshlrev_b32 v100, 4, v1
  s_mul_i32 s37, s17, 10240
  v_mov_b32 v103, v100
  s_mul_i32 s34, s16, 2621440
  s_add_u32 s34, s34, 247463936
  s_add_u32 s34, s34, s37
  s_lshl_b32 s30, s16, 8
  v_lshl_add_u32 v105, v1, 2, s30
  v_add_u32 v105, 8192, v105
  v_add_u32 v107, 4032, v105
  v_cmp_gt_u32 vcc, 16, v1
  s_nop 1
  v_cndmask_b32 v105, v107, v105, vcc
  v_cndmask_b32 v102, 1, 2, vcc
  v_cndmask_b32 v101, -8, 2, vcc
  s_lshl_b32 s31, s24, 2
  s_add_u32 s30, s30, s31
  s_add_u32 s30, s30, 0
  v_mov_b32 v104, s30
  s_mov_b32 s28, 0
  s_mov_b32 s36, 2
  v_mov_b32 v109, 0
  s_barrier
  s_lshl_b32 s29, s16, 2
  s_add_u32 s29, s29, 32
  v_mov_b32 v107, s29
  s_mov_b32 s29, 0
  s_mov_b64 exec, 1
gw_3:
  buffer_load_dword v108, v107, s[12:15], 0 offen sc1
  s_add_u32 s29, s29, 1
  s_cmp_gt_u32 s29, 65536
  s_cbranch_scc1 role_abort
  s_waitcnt vmcnt(0)
  v_cmp_gt_u32 vcc, 2, v108
  s_cbranch_vccz gk_4
  s_sleep 4
  s_branch gw_3
gk_4:
  s_mov_b64 exec, -1
  s_mov_b32 s29, 0
pw_5:
  buffer_load_dword v106, v105, s[8:11], 0 offen sc1
  s_add_u32 s29, s29, 1
  s_cmp_gt_u32 s29, 65536
  s_cbranch_scc1 role_abort
  s_waitcnt vmcnt(0)
pc_7:
  v_cmp_gt_u32 vcc, s36, v106
  s_nop 0
  s_and_b32 vcc_lo, vcc_lo, 0xffff
  s_and_b32 vcc_hi, vcc_hi, 0x0
  s_cmp_eq_u64 vcc, 0
  s_cbranch_scc1 po_6
  s_sleep 2
  s_branch pw_5
po_6:
  s_add_u32 m0, s37, 0
  s_add_u32 s30, s34, 0
  buffer_load_dwordx4 v100, s[8:11], s30 offen offset:0 sc1 lds
  buffer_load_dwordx4 v100, s[8:11], s30 offen offset:1024 sc1 lds
  buffer_load_dwordx4 v100, s[8:11], s30 offen offset:2048 sc1 lds
  buffer_load_dwordx4 v100, s[8:11], s30 offen offset:3072 sc1 lds
  s_add_u32 m0, s37, 4096
  s_add_u32 s30, s34, 4096
  buffer_load_dwordx4 v100, s[8:11], s30 offen offset:0 sc1 lds
  buffer_load_dwordx4 v100, s[8:11], s30 offen offset:1024 sc1 lds
  buffer_load_dwordx4 v100, s[8:11], s30 offen offset:2048 sc1 lds
  buffer_load_dwordx4 v100, s[8:11], s30 offen offset:3072 sc1 lds
  s_add_u32 m0, s37, 8192
  s_add_u32 s30, s34, 8192
  buffer_load_dwordx4 v100, s[8:11], s30 offen offset:0 sc1 lds
  buffer_load_dwordx4 v100, s[8:11], s30 offen offset:1024 sc1 lds
  s_xor_b32 s37, s37, 0x10000
  s_waitcnt vmcnt(0)
  s_barrier
p_loop:
  s_waitcnt lgkmcnt(0)
  v_add_u32 v101, v101, v102
  v_min_i32 v101, 128, v101
  ds_read_b128 v[36:39], v103 offset:0
  ds_read_b128 v[40:43], v103 offset:1024
  ds_read_b128 v[44:47], v103 offset:2048
  s_mov_b32 s29, 0
  s_branch pc_10
pw_8:
  buffer_load_dword v106, v105, s[8:11], 0 offen sc1
  s_add_u32 s29, s29, 1
  s_cmp_gt_u32 s29, 65536
  s_cbranch_scc1 role_abort
  s_waitcnt vmcnt(0)
pc_10:
  v_cmp_gt_i32 vcc, v101, v106
  s_nop 0
  s_and_b32 vcc_lo, vcc_lo, 0xffffff
  s_and_b32 vcc_hi, vcc_hi, 0x0
  s_cmp_eq_u64 vcc, 0
  s_cbranch_scc1 po_9
  s_sleep 8
  s_branch pw_8
po_9:
  s_cmp_lt_u32 s28, 63
  s_cselect_b32 s30, 40960, 0
  s_add_u32 s34, s34, s30
  s_add_u32 s32, s35, 6144
  s_and_b32 s30, s28, 7
  s_mul_i32 s30, s30, 147456
  s_add_u32 s35, s38, s30
  v_max_u32 v109, s28, v109
  s_add_u32 s39, s28, 2
  s_and_b32 s39, s39, 7
  s_mul_i32 s39, s39, 147456
  s_add_u32 s39, s39, s38
  s_waitcnt lgkmcnt(2)
  v_mfma_f32_16x16x32_bf16 v[4:7], v[192:195], v[36:39], 0
  ds_read_b128 v[48:51], v103 offset:3072
  v_mfma_f32_16x16x32_bf16 v[8:11], a[16:19], v[36:39], 0
  v_mfma_f32_16x16x32_bf16 v[12:15], a[96:99], v[36:39], 0
  v_mfma_f32_16x16x32_bf16 v[16:19], a[176:179], v[36:39], 0
  s_waitcnt lgkmcnt(2)
  v_mfma_f32_16x16x32_bf16 v[4:7], v[196:199], v[40:43], v[4:7]
  ds_read_b128 v[36:39], v103 offset:4096
  v_mfma_f32_16x16x32_bf16 v[8:11], a[20:23], v[40:43], v[8:11]
  v_cvt_pk_bf16_f32 v92, v20, v21
  v_mfma_f32_16x16x32_bf16 v[12:15], a[100:103], v[40:43], v[12:15]
  v_cvt_pk_bf16_f32 v93, v22, v23
  v_mfma_f32_16x16x32_bf16 v[16:19], a[180:183], v[40:43], v[16:19]
  s_waitcnt lgkmcnt(2)
  v_mfma_f32_16x16x32_bf16 v[4:7], v[200:203], v[44:47], v[4:7]
  ds_read_b128 v[40:43], v103 offset:5120
  v_mfma_f32_16x16x32_bf16 v[8:11], a[24:27], v[44:47], v[8:11]
  v_cvt_pk_bf16_f32 v94, v24, v25
  v_mfma_f32_16x16x32_bf16 v[12:15], a[104:107], v[44:47], v[12:15]
  v_cvt_pk_bf16_f32 v95, v26, v27
  v_mfma_f32_16x16x32_bf16 v[16:19], a[184:187], v[44:47], v[16:19]
  s_waitcnt lgkmcnt(2)
  v_mfma_f32_16x16x32_bf16 v[4:7], v[204:207], v[48:51], v[4:7]
  ds_read_b128 v[44:47], v103 offset:6144
  v_mfma_f32_16x16x32_bf16 v[8:11], a[28:31], v[48:51], v[8:11]
  buffer_store_dwordx4 v[92:95], v100, s[8:11], s32 offen offset:0
  v_mfma_f32_16x16x32_bf16 v[12:15], a[108:111], v[48:51], v[12:15]
  v_cvt_pk_bf16_f32 v96, v28, v29
  v_mfma_f32_16x16x32_bf16 v[16:19], a[188:191], v[48:51], v[16:19]
  s_waitcnt lgkmcnt(2)
  v_mfma_f32_16x16x32_bf16 v[4:7], v[208:211], v[36:39], v[4:7]
  ds_read_b128 v[48:51], v103 offset:7168
  v_mfma_f32_16x16x32_bf16 v[8:11], a[32:35], v[36:39], v[8:11]
  v_cvt_pk_bf16_f32 v97, v30, v31
  v_mfma_f32_16x16x32_bf16 v[12:15], a[112:115], v[36:39], v[12:15]
  v_cvt_pk_bf16_f32 v98, v32, v33
  v_mfma_f32_16x16x32_bf16 v[16:19], a[192:195], v[36:39], v[16:19]
  s_waitcnt lgkmcnt(2)
  v_mfma_f32_16x16x32_bf16 v[4:7], v[212:215], v[40:43], v[4:7]
  ds_read_b128 v[36:39], v103 offset:8192
  v_mfma_f32_16x16x32_bf16 v[8:11], a[36:39], v[40:43], v[8:11]
  v_cvt_pk_bf16_f32 v99, v34, v35
  v_mfma_f32_16x16x32_bf16 v[12:15], a[116:119], v[40:43], v[12:15]
  buffer_store_dwordx4 v[96:99], v100, s[8:11], s32 offen offset:1024
  v_mfma_f32_16x16x32_bf16 v[16:19], a[196:199], v[40:43], v[16:19]
  s_waitcnt lgkmcnt(2)
  v_mfma_f32_16x16x32_bf16 v[4:7], v[216:219], v[44:47], v[4:7]
  ds_read_b128 v[40:43], v103 offset:9216
  v_mfma_f32_16x16x32_bf16 v[8:11], a[40:43], v[44:47], v[8:11]
  s_add_u32 m0, s37, 0
  s_add_u32 s30, s34, 0
  buffer_load_dwordx4 v100, s[8:11], s30 offen offset:0 sc1 lds
  v_mfma_f32_16x16x32_bf16 v[12:15], a[120:123], v[44:47], v[12:15]
  v_mfma_f32_16x16x32_bf16 v[16:19], a[200:203], v[44:47], v[16:19]
  s_waitcnt lgkmcnt(2)
  v_mfma_f32_16x16x32_bf16 v[4:7], v[220:223], v[48:51], v[4:7]
  ds_read_b128 v[44:47], v103 offset:10240
  v_mfma_f32_16x16x32_bf16 v[8:11], a[44:47], v[48:51], v[8:11]
  buffer_load_dwordx4 v100, s[8:11], s30 offen offset:1024 sc1 lds
  v_mfma_f32_16x16x32_bf16 v[12:15], a[124:127], v[48:51], v[12:15]
  v_mfma_f32_16x16x32_bf16 v[16:19], a[204:207], v[48:51], v[16:19]
  s_waitcnt lgkmcnt(2)
  v_mfma_f32_16x16x32_bf16 v[4:7], v[224:227], v[36:39], v[4:7]
  ds_read_b128 v[48:51], v103 offset:11264
  v_mfma_f32_16x16x32_bf16 v[8:11], a[48:51], v[36:39], v[8:11]
  buffer_load_dwordx4 v100, s[8:11], s30 offen offset:2048 sc1 lds
  v_mfma_f32_16x16x32_bf16 v[12:15], a[128:131], v[36:39], v[12:15]
  v_mfma_f32_16x16x32_bf16 v[16:19], a[208:211], v[36:39], v[16:19]
  s_waitcnt lgkmcnt(2)
  v_mfma_f32_16x16x32_bf16 v[4:7], v[228:231], v[40:43], v[4:7]
  ds_read_b128 v[36:39], v103 offset:12288
  v_mfma_f32_16x16x32_bf16 v[8:11], a[52:55], v[40:43], v[8:11]
  buffer_load_dwordx4 v100, s[8:11], s30 offen offset:3072 sc1 lds
  v_mfma_f32_16x16x32_bf16 v[12:15], a[132:135], v[40:43], v[12:15]
  v_mfma_f32_16x16x32_bf16 v[16:19], a[212:215], v[40:43], v[16:19]
  s_waitcnt lgkmcnt(2)
  v_mfma_f32_16x16x32_bf16 v[4:7], v[232:235], v[44:47], v[4:7]
  ds_read_b128 v[40:43], v103 offset:13312
  v_mfma_f32_16x16x32_bf16 v[8:11], a[56:59], v[44:47], v[8:11]
  s_add_u32 m0, s37, 4096
  s_add_u32 s30, s34, 4096
  buffer_load_dwordx4 v100, s[8:11], s30 offen offset:0 sc1 lds
  v_mfma_f32_16x16x32_bf16 v[12:15], a[136:139], v[44:47], v[12:15]
  v_mfma_f32_16x16x32_bf16 v[16:19], a[216:219], v[44:47], v[16:19]
  s_waitcnt lgkmcnt(2)
  v_mfma_f32_16x16x32_bf16 v[4:7], v[236:239], v[48:51], v[4:7]
  ds_read_b128 v[44:47], v103 offset:14336
  v_mfma_f32_16x16x32_bf16 v[8:11], a[60:63], v[48:51], v[8:11]
  buffer_load_dwordx4 v100, s[8:11], s30 offen offset:1024 sc1 lds
  v_mfma_f32_16x16x32_bf16 v[12:15], a[140:143], v[48:51], v[12:15]
  v_mfma_f32_16x16x32_bf16 v[16:19], a[220:223], v[48:51], v[16:19]
  s_waitcnt lgkmcnt(2)
  v_mfma_f32_16x16x32_bf16 v[4:7], v[240:243], v[36:39], v[4:7]
  ds_read_b128 v[48:51], v103 offset:15360
  v_mfma_f32_16x16x32_bf16 v[8:11], a[64:67], v[36:39], v[8:11]
  buffer_load_dwordx4 v100, s[8:11], s30 offen offset:2048 sc1 lds
  v_mfma_f32_16x16x32_bf16 v[12:15], a[144:147], v[36:39], v[12:15]
  v_mfma_f32_16x16x32_bf16 v[16:19], a[224:227], v[36:39], v[16:19]
  s_waitcnt lgkmcnt(2)
  v_mfma_f32_16x16x32_bf16 v[4:7], v[244:247], v[40:43], v[4:7]
  ds_read_b128 v[36:39], v103 offset:16384
  v_mfma_f32_16x16x32_bf16 v[8:11], a[68:71], v[40:43], v[8:11]
  buffer_load_dwordx4 v100, s[8:11], s30 offen offset:3072 sc1 lds
  v_mfma_f32_16x16x32_bf16 v[12:15], a[148:151], v[40:43], v[12:15]
  v_mfma_f32_16x16x32_bf16 v[16:19], a[228:231], v[40:43], v[16:19]
  s_waitcnt lgkmcnt(2)
  v_mfma_f32_16x16x32_bf16 v[4:7], v[248:251], v[44:47], v[4:7]
  ds_read_b128 v[40:43], v103 offset:17408
  v_mfma_f32_16x16x32_bf16 v[8:11], a[72:75], v[44:47], v[8:11]
  s_add_u32 m0, s37, 8192
  s_add_u32 s30, s34, 8192
  buffer_load_dwordx4 v100, s[8:11], s30 offen offset:0 sc1 lds
  v_mfma_f32_16x16x32_bf16 v[12:15], a[152:155], v[44:47], v[12:15]
  v_mfma_f32_16x16x32_bf16 v[16:19], a[232:235], v[44:47], v[16:19]
  s_waitcnt lgkmcnt(2)
  v_mfma_f32_16x16x32_bf16 v[4:7], v[252:255], v[48:51], v[4:7]
  ds_read_b128 v[44:47], v103 offset:18432
  v_mfma_f32_16x16x32_bf16 v[8:11], a[76:79], v[48:51], v[8:11]
  buffer_load_dwordx4 v100, s[8:11], s30 offen offset:1024 sc1 lds
  v_mfma_f32_16x16x32_bf16 v[12:15], a[156:159], v[48:51], v[12:15]
  v_mfma_f32_16x16x32_bf16 v[16:19], a[236:239], v[48:51], v[16:19]
  s_waitcnt lgkmcnt(2)
  v_mfma_f32_16x16x32_bf16 v[4:7], a[0:3], v[36:39], v[4:7]
  ds_read_b128 v[48:51], v103 offset:19456
  v_mfma_f32_16x16x32_bf16 v[8:11], a[80:83], v[36:39], v[8:11]
  s_waitcnt vmcnt(10)
  v_mfma_f32_16x16x32_bf16 v[12:15], a[160:163], v[36:39], v[12:15]
  buffer_store_dword v109, v104, s[8:11], 0 offen
  v_mfma_f32_16x16x32_bf16 v[16:19], a[240:243], v[36:39], v[16:19]
  s_waitcnt lgkmcnt(2)
  v_mfma_f32_16x16x32_bf16 v[4:7], a[4:7], v[40:43], v[4:7]
  ds_read_b128 v[36:39], v103 offset:20480
  v_mfma_f32_16x16x32_bf16 v[8:11], a[84:87], v[40:43], v[8:11]
  buffer_load_dword v106, v105, s[8:11], 0 offen sc1
  v_mfma_f32_16x16x32_bf16 v[12:15], a[164:167], v[40:43], v[12:15]
  buffer_load_dword v111, v110, s[8:11], s39 offen sc1
  v_mfma_f32_16x16x32_bf16 v[16:19], a[244:247], v[40:43], v[16:19]
  s_waitcnt lgkmcnt(2)
  v_mfma_f32_16x16x32_bf16 v[4:7], a[8:11], v[44:47], v[4:7]
  ds_read_b128 v[40:43], v103 offset:21504
  v_mfma_f32_16x16x32_bf16 v[8:11], a[88:91], v[44:47], v[8:11]
  v_mfma_f32_16x16x32_bf16 v[12:15], a[168:171], v[44:47], v[12:15]
  v_mfma_f32_16x16x32_bf16 v[16:19], a[248:251], v[44:47], v[16:19]
  s_waitcnt lgkmcnt(2)
  v_mfma_f32_16x16x32_bf16 v[4:7], a[12:15], v[48:51], v[4:7]
  ds_read_b128 v[44:47], v103 offset:22528
  v_mfma_f32_16x16x32_bf16 v[8:11], a[92:95], v[48:51], v[8:11]
  v_mfma_f32_16x16x32_bf16 v[12:15], a[172:175], v[48:51], v[12:15]
  v_mfma_f32_16x16x32_bf16 v[16:19], a[252:255], v[48:51], v[16:19]
  s_waitcnt lgkmcnt(2)
  v_mfma_f32_16x16x32_bf16 v[20:23], v[192:195], v[36:39], 0
  ds_read_b128 v[48:51], v103 offset:23552
  v_mfma_f32_16x16x32_bf16 v[24:27], a[16:19], v[36:39], 0
  v_mfma_f32_16x16x32_bf16 v[28:31], a[96:99], v[36:39], 0
  v_mfma_f32_16x16x32_bf16 v[32:35], a[176:179], v[36:39], 0
  s_waitcnt lgkmcnt(2)
  v_mfma_f32_16x16x32_bf16 v[20:23], v[196:199], v[40:43], v[20:23]
  ds_read_b128 v[36:39], v103 offset:24576
  v_mfma_f32_16x16x32_bf16 v[24:27], a[20:23], v[40:43], v[24:27]
  v_cvt_pk_bf16_f32 v92, v4, v5
  v_mfma_f32_16x16x32_bf16 v[28:31], a[100:103], v[40:43], v[28:31]
  v_cvt_pk_bf16_f32 v93, v6, v7
  v_mfma_f32_16x16x32_bf16 v[32:35], a[180:183], v[40:43], v[32:35]
  s_waitcnt lgkmcnt(2)
  v_mfma_f32_16x16x32_bf16 v[20:23], v[200:203], v[44:47], v[20:23]
  ds_read_b128 v[40:43], v103 offset:25600
  v_mfma_f32_16x16x32_bf16 v[24:27], a[24:27], v[44:47], v[24:27]
  v_cvt_pk_bf16_f32 v94, v8, v9
  v_mfma_f32_16x16x32_bf16 v[28:31], a[104:107], v[44:47], v[28:31]
  v_cvt_pk_bf16_f32 v95, v10, v11
  v_mfma_f32_16x16x32_bf16 v[32:35], a[184:187], v[44:47], v[32:35]
  s_waitcnt lgkmcnt(2)
  v_mfma_f32_16x16x32_bf16 v[20:23], v[204:207], v[48:51], v[20:23]
  ds_read_b128 v[44:47], v103 offset:26624
  v_mfma_f32_16x16x32_bf16 v[24:27], a[28:31], v[48:51], v[24:27]
  buffer_store_dwordx4 v[92:95], v100, s[8:11], s35 offen offset:0
  v_mfma_f32_16x16x32_bf16 v[28:31], a[108:111], v[48:51], v[28:31]
  v_cvt_pk_bf16_f32 v96, v12, v13
  v_mfma_f32_16x16x32_bf16 v[32:35], a[188:191], v[48:51], v[32:35]
  s_waitcnt lgkmcnt(2)
  v_mfma_f32_16x16x32_bf16 v[20:23], v[208:211], v[36:39], v[20:23]
  ds_read_b128 v[48:51], v103 offset:27648
  v_mfma_f32_16x16x32_bf16 v[24:27], a[32:35], v[36:39], v[24:27]
  v_cvt_pk_bf16_f32 v97, v14, v15
  v_mfma_f32_16x16x32_bf16 v[28:31], a[112:115], v[36:39], v[28:31]
  v_cvt_pk_bf16_f32 v98, v16, v17
  v_mfma_f32_16x16x32_bf16 v[32:35], a[192:195], v[36:39], v[32:35]
  s_waitcnt lgkmcnt(2)
  v_mfma_f32_16x16x32_bf16 v[20:23], v[212:215], v[40:43], v[20:23]
  ds_read_b128 v[36:39], v103 offset:28672
  v_mfma_f32_16x16x32_bf16 v[24:27], a[36:39], v[40:43], v[24:27]
  v_cvt_pk_bf16_f32 v99, v18, v19
  v_mfma_f32_16x16x32_bf16 v[28:31], a[116:119], v[40:43], v[28:31]
  buffer_store_dwordx4 v[96:99], v100, s[8:11], s35 offen offset:1024
  v_mfma_f32_16x16x32_bf16 v[32:35], a[196:199], v[40:43], v[32:35]
  s_waitcnt lgkmcnt(2)
  v_mfma_f32_16x16x32_bf16 v[20:23], v[216:219], v[44:47], v[20:23]
  ds_read_b128 v[40:43], v103 offset:29696
  v_mfma_f32_16x16x32_bf16 v[24:27], a[40:43], v[44:47], v[24:27]
  v_mfma_f32_16x16x32_bf16 v[28:31], a[120:123], v[44:47], v[28:31]
  v_mfma_f32_16x16x32_bf16 v[32:35], a[200:203], v[44:47], v[32:35]
  s_waitcnt lgkmcnt(2)
  v_mfma_f32_16x16x32_bf16 v[20:23], v[220:223], v[48:51], v[20:23]
  ds_read_b128 v[44:47], v103 offset:30720
  v_mfma_f32_16x16x32_bf16 v[24:27], a[44:47], v[48:51], v[24:27]
  v_mfma_f32_16x16x32_bf16 v[28:31], a[124:127], v[48:51], v[28:31]
  v_mfma_f32_16x16x32_bf16 v[32:35], a[204:207], v[48:51], v[32:35]
  s_waitcnt lgkmcnt(2)
  v_mfma_f32_16x16x32_bf16 v[20:23], v[224:227], v[36:39], v[20:23]
  ds_read_b128 v[48:51], v103 offset:31744
  v_mfma_f32_16x16x32_bf16 v[24:27], a[48:51], v[36:39], v[24:27]
  v_mfma_f32_16x16x32_bf16 v[28:31], a[128:131], v[36:39], v[28:31]
  v_mfma_f32_16x16x32_bf16 v[32:35], a[208:211], v[36:39], v[32:35]
  s_waitcnt lgkmcnt(2)
  v_mfma_f32_16x16x32_bf16 v[20:23], v[228:231], v[40:43], v[20:23]
  ds_read_b128 v[36:39], v103 offset:32768
  v_mfma_f32_16x16x32_bf16 v[24:27], a[52:55], v[40:43], v[24:27]
  v_mfma_f32_16x16x32_bf16 v[28:31], a[132:135], v[40:43], v[28:31]
  v_mfma_f32_16x16x32_bf16 v[32:35], a[212:215], v[40:43], v[32:35]
  s_waitcnt lgkmcnt(2)
  v_mfma_f32_16x16x32_bf16 v[20:23], v[232:235], v[44:47], v[20:23]
  ds_read_b128 v[40:43], v103 offset:33792
  v_mfma_f32_16x16x32_bf16 v[24:27], a[56:59], v[44:47], v[24:27]
  v_mfma_f32_16x16x32_bf16 v[28:31], a[136:139], v[44:47], v[28:31]
  v_mfma_f32_16x16x32_bf16 v[32:35], a[216:219], v[44:47], v[32:35]
  s_waitcnt lgkmcnt(2)
  v_mfma_f32_16x16x32_bf16 v[20:23], v[236:239], v[48:51], v[20:23]
  ds_read_b128 v[44:47], v103 offset:34816
  v_mfma_f32_16x16x32_bf16 v[24:27], a[60:63], v[48:51], v[24:27]
  v_mfma_f32_16x16x32_bf16 v[28:31], a[140:143], v[48:51], v[28:31]
  v_mfma_f32_16x16x32_bf16 v[32:35], a[220:223], v[48:51], v[32:35]
  s_waitcnt lgkmcnt(2)
  v_mfma_f32_16x16x32_bf16 v[20:23], v[240:243], v[36:39], v[20:23]
  ds_read_b128 v[48:51], v103 offset:35840
  v_mfma_f32_16x16x32_bf16 v[24:27], a[64:67], v[36:39], v[24:27]
  v_mfma_f32_16x16x32_bf16 v[28:31], a[144:147], v[36:39], v[28:31]
  v_mfma_f32_16x16x32_bf16 v[32:35], a[224:227], v[36:39], v[32:35]
  s_waitcnt lgkmcnt(2)
  v_mfma_f32_16x16x32_bf16 v[20:23], v[244:247], v[40:43], v[20:23]
  ds_read_b128 v[36:39], v103 offset:36864
  v_mfma_f32_16x16x32_bf16 v[24:27], a[68:71], v[40:43], v[24:27]
  v_mfma_f32_16x16x32_bf16 v[28:31], a[148:151], v[40:43], v[28:31]
  v_mfma_f32_16x16x32_bf16 v[32:35], a[228:231], v[40:43], v[32:35]
  s_waitcnt lgkmcnt(2)
  v_mfma_f32_16x16x32_bf16 v[20:23], v[248:251], v[44:47], v[20:23]
  ds_read_b128 v[40:43], v103 offset:37888
  v_mfma_f32_16x16x32_bf16 v[24:27], a[72:75], v[44:47], v[24:27]
  v_mfma_f32_16x16x32_bf16 v[28:31], a[152:155], v[44:47], v[28:31]
  v_mfma_f32_16x16x32_bf16 v[32:35], a[232:235], v[44:47], v[32:35]
  s_waitcnt lgkmcnt(2)
  v_mfma_f32_16x16x32_bf16 v[20:23], v[252:255], v[48:51], v[20:23]
  ds_read_b128 v[44:47], v103 offset:38912
  v_mfma_f32_16x16x32_bf16 v[24:27], a[76:79], v[48:51], v[24:27]
  v_mfma_f32_16x16x32_bf16 v[28:31], a[156:159], v[48:51], v[28:31]
  v_mfma_f32_16x16x32_bf16 v[32:35], a[236:239], v[48:51], v[32:35]
  s_waitcnt lgkmcnt(2)
  v_mfma_f32_16x16x32_bf16 v[20:23], a[0:3], v[36:39], v[20:23]
  ds_read_b128 v[48:51], v103 offset:39936
  v_mfma_f32_16x16x32_bf16 v[24:27], a[80:83], v[36:39], v[24:27]
  v_mfma_f32_16x16x32_bf16 v[28:31], a[160:163], v[36:39], v[28:31]
  v_mfma_f32_16x16x32_bf16 v[32:35], a[240:243], v[36:39], v[32:35]
  s_waitcnt lgkmcnt(2)
  v_mfma_f32_16x16x32_bf16 v[20:23], a[4:7], v[40:43], v[20:23]
  v_mfma_f32_16x16x32_bf16 v[24:27], a[84:87], v[40:43], v[24:27]
  v_mfma_f32_16x16x32_bf16 v[28:31], a[164:167], v[40:43], v[28:31]
  v_mfma_f32_16x16x32_bf16 v[32:35], a[244:247], v[40:43], v[32:35]
  s_waitcnt lgkmcnt(1)
  v_mfma_f32_16x16x32_bf16 v[20:23], a[8:11], v[44:47], v[20:23]
  v_mfma_f32_16x16x32_bf16 v[24:27], a[88:91], v[44:47], v[24:27]
  v_mfma_f32_16x16x32_bf16 v[28:31], a[168:171], v[44:47], v[28:31]
  v_mfma_f32_16x16x32_bf16 v[32:35], a[248:251], v[44:47], v[32:35]
  s_waitcnt lgkmcnt(0)
  v_mfma_f32_16x16x32_bf16 v[20:23], a[12:15], v[48:51], v[20:23]
  v_mfma_f32_16x16x32_bf16 v[24:27], a[92:95], v[48:51], v[24:27]
  v_mfma_f32_16x16x32_bf16 v[28:31], a[172:175], v[48:51], v[28:31]
  v_mfma_f32_16x16x32_bf16 v[32:35], a[252:255], v[48:51], v[32:35]
  s_xor_b32 s37, s37, 0x10000
  v_xor_b32 v103, 0x10000, v103
  s_add_u32 s28, s28, 1
  s_sub_u32 s30, s28, 3
  s_cmp_lt_u32 s30, 61
  s_cbranch_scc0 p_now
  s_waitcnt vmcnt(2) lgkmcnt(0)
  s_barrier
  s_branch p_loop
p_now:
  s_add_u32 s32, s35, 6144
  v_cvt_pk_bf16_f32 v92, v20, v21
  v_cvt_pk_bf16_f32 v93, v22, v23
  v_cvt_pk_bf16_f32 v94, v24, v25
  v_cvt_pk_bf16_f32 v95, v26, v27
  buffer_store_dwordx4 v[92:95], v100, s[8:11], s32 offen offset:0
  v_cvt_pk_bf16_f32 v96, v28, v29
  v_cvt_pk_bf16_f32 v97, v30, v31
  v_cvt_pk_bf16_f32 v98, v32, v33
  v_cvt_pk_bf16_f32 v99, v34, v35
  buffer_store_dwordx4 v[96:99], v100, s[8:11], s32 offen offset:1024
  v_mov_b32 v109, s28
  s_waitcnt vmcnt(0)
  buffer_store_dword v109, v104, s[8:11], 0 offen
  s_cmp_lt_u32 s28, 64
  s_barrier
  s_cbranch_scc1 p_loop
  s_endpgm
role_ua:
  s_load_dwordx2 s[20:21], s[0:1], 40
  s_mov_b32 s22, 7864320
  s_mov_b32 s23, 0x00020000
  s_load_dwordx2 s[88:89], s[0:1], 96
  s_mov_b32 s90, 1280
  s_mov_b32 s91, 0x00020000
  s_load_dwordx2 s[92:93], s[0:1], 104
  s_mov_b32 s94, 4915200
  s_mov_b32 s95, 0x00020000
  s_mul_i32 s24, s16, 5
  s_add_u32 s24, s24, s18
  s_sub_u32 s24, s24, 21
  s_cmp_ge_u32 s24, 20
  s_cbranch_scc1 ua_nm
  s_waitcnt lgkmcnt(0)
  v_lshlrev_b32 v12, 2, v0
  buffer_load_dword v13, v12, s[88:91], 0 offen
  buffer_load_dword v14, v12, s[88:91], 0 offen offset:1024
  v_lshrrev_b32 v20, 3, v0
  v_and_b32 v21, 7, v0
  v_mul_u32_u24 v22, 153600, v20
  v_lshl_add_u32 v22, v21, 4, v22
  s_lshl_b32 s6, s24, 7
  buffer_load_dwordx4 v[28:31], v22, s[92:95], s6 offen nt
  s_add_u32 s6, s6, 7680
  buffer_load_dwordx4 v[32:35], v22, s[92:95], s6 offen nt
  s_add_u32 s6, s6, 7680
  buffer_load_dwordx4 v[36:39], v22, s[92:95], s6 offen nt
  s_add_u32 s6, s6, 7680
  buffer_load_dwordx4 v[40:43], v22, s[92:95], s6 offen nt
  s_add_u32 s6, s6, 7680
  buffer_load_dwordx4 v[44:47], v22, s[92:95], s6 offen nt
  s_add_u32 s6, s6, 7680
  buffer_load_dwordx4 v[48:51], v22, s[92:95], s6 offen nt
  s_add_u32 s6, s6, 7680
  buffer_load_dwordx4 v[52:55], v22, s[92:95], s6 offen nt
  s_add_u32 s6, s6, 7680
  buffer_load_dwordx4 v[56:59], v22, s[92:95], s6 offen nt
  s_add_u32 s6, s6, 7680
  buffer_load_dwordx4 v[60:63], v22, s[92:95], s6 offen nt
  s_add_u32 s6, s6, 7680
  buffer_load_dwordx4 v[64:67], v22, s[92:95], s6 offen nt
  s_add_u32 s6, s6, 7680
  buffer_load_dwordx4 v[68:71], v22, s[92:95], s6 offen nt
  s_add_u32 s6, s6, 7680
  buffer_load_dwordx4 v[72:75], v22, s[92:95], s6 offen nt
  s_add_u32 s6, s6, 7680
  buffer_load_dwordx4 v[76:79], v22, s[92:95], s6 offen nt
  s_add_u32 s6, s6, 7680
  buffer_load_dwordx4 v[80:83], v22, s[92:95], s6 offen nt
  s_add_u32 s6, s6, 7680
  buffer_load_dwordx4 v[84:87], v22, s[92:95], s6 offen nt
  s_add_u32 s6, s6, 7680
  buffer_load_dwordx4 v[88:91], v22, s[92:95], s6 offen nt
  s_add_u32 s6, s6, 7680
  buffer_load_dwordx4 v[92:95], v22, s[92:95], s6 offen nt
  s_add_u32 s6, s6, 7680
  buffer_load_dwordx4 v[96:99], v22, s[92:95], s6 offen nt
  s_add_u32 s6, s6, 7680
  buffer_load_dwordx4 v[100:103], v22, s[92:95], s6 offen nt
  s_add_u32 s6, s6, 7680
  buffer_load_dwordx4 v[104:107], v22, s[92:95], s6 offen nt
  s_add_u32 s6, s6, 7680
  s_waitcnt vmcnt(20)
  v_lshlrev_b32 v24, 16, v13
  v_and_b32 v25, 0xffff0000, v13
  v_mul_f32 v16, 0xbfb8aa3b, v24
  v_mul_f32 v17, 0xbfb8aa3b, v25
  v_exp_f32 v16, v16
  v_exp_f32 v17, v17
  v_add_f32 v16, 1.0, v16
  v_add_f32 v17, 1.0, v17
  v_rcp_f32 v16, v16
  v_rcp_f32 v17, v17
  v_mul_f32 v24, v24, v16
  v_mul_f32 v25, v25, v17
  v_cvt_pk_bf16_f32 v16, v24, v25
  v_lshlrev_b32 v24, 16, v16
  v_and_b32 v25, 0xffff0000, v16
  v_lshlrev_b32 v26, 16, v14
  v_and_b32 v27, 0xffff0000, v14
  v_mul_f32 v16, 0xbfb8aa3b, v26
  v_mul_f32 v17, 0xbfb8aa3b, v27
  v_exp_f32 v16, v16
  v_exp_f32 v17, v17
  v_add_f32 v16, 1.0, v16
  v_add_f32 v17, 1.0, v17
  v_rcp_f32 v16, v16
  v_rcp_f32 v17, v17
  v_mul_f32 v26, v26, v16
  v_mul_f32 v27, v27, v17
  v_cvt_pk_bf16_f32 v16, v26, v27
  v_lshlrev_b32 v26, 16, v16
  v_and_b32 v27, 0xffff0000, v16
  v_lshlrev_b32 v12, 3, v0
  ds_write_b64 v12, v[24:25]
  ds_write_b64 v12, v[26:27] offset:2048
  v_mul_u32_u24 v12, 80, v20
  s_waitcnt lgkmcnt(0)
  s_barrier
  ds_read_b128 v[108:111], v12 offset:0
  ds_read_b128 v[112:115], v12 offset:16
  ds_read_b128 v[116:119], v12 offset:32
  ds_read_b128 v[120:123], v12 offset:48
  ds_read_b128 v[124:127], v12 offset:64
  v_mov_b32 v148, 0
  v_mov_b32 v149, 0
  v_mov_b32 v150, 0
  v_mov_b32 v151, 0
  v_mov_b32 v152, 0
  v_mov_b32 v153, 0
  v_mov_b32 v154, 0
  v_mov_b32 v155, 0
  s_waitcnt lgkmcnt(0)
  v_lshrrev_b32 v128, 16, v108
  v_lshrrev_b32 v129, 16, v109
  v_lshrrev_b32 v130, 16, v110
  v_lshrrev_b32 v131, 16, v111
  v_lshrrev_b32 v132, 16, v112
  v_lshrrev_b32 v133, 16, v113
  v_lshrrev_b32 v134, 16, v114
  v_lshrrev_b32 v135, 16, v115
  v_lshrrev_b32 v136, 16, v116
  v_lshrrev_b32 v137, 16, v117
  v_lshrrev_b32 v138, 16, v118
  v_lshrrev_b32 v139, 16, v119
  v_lshrrev_b32 v140, 16, v120
  v_lshrrev_b32 v141, 16, v121
  v_lshrrev_b32 v142, 16, v122
  v_lshrrev_b32 v143, 16, v123
  v_lshrrev_b32 v144, 16, v124
  v_lshrrev_b32 v145, 16, v125
  v_lshrrev_b32 v146, 16, v126
  v_lshrrev_b32 v147, 16, v127
  s_waitcnt vmcnt(18)
  v_dot2c_f32_bf16 v148, v28, v128
  v_dot2c_f32_bf16 v149, v28, v108
  v_dot2c_f32_bf16 v150, v29, v128
  v_dot2c_f32_bf16 v151, v29, v108
  v_dot2c_f32_bf16 v152, v30, v128
  v_dot2c_f32_bf16 v153, v30, v108
  v_dot2c_f32_bf16 v154, v31, v128
  v_dot2c_f32_bf16 v155, v31, v108
  v_dot2c_f32_bf16 v148, v32, v129
  v_dot2c_f32_bf16 v149, v32, v109
  v_dot2c_f32_bf16 v150, v33, v129
  v_dot2c_f32_bf16 v151, v33, v109
  v_dot2c_f32_bf16 v152, v34, v129
  v_dot2c_f32_bf16 v153, v34, v109
  v_dot2c_f32_bf16 v154, v35, v129
  v_dot2c_f32_bf16 v155, v35, v109
  s_waitcnt vmcnt(16)
  v_dot2c_f32_bf16 v148, v36, v130
  v_dot2c_f32_bf16 v149, v36, v110
  v_dot2c_f32_bf16 v150, v37, v130
  v_dot2c_f32_bf16 v151, v37, v110
  v_dot2c_f32_bf16 v152, v38, v130
  v_dot2c_f32_bf16 v153, v38, v110
  v_dot2c_f32_bf16 v154, v39, v130
  v_dot2c_f32_bf16 v155, v39, v110
  v_dot2c_f32_bf16 v148, v40, v131
  v_dot2c_f32_bf16 v149, v40, v111
  v_dot2c_f32_bf16 v150, v41, v131
  v_dot2c_f32_bf16 v151, v41, v111
  v_dot2c_f32_bf16 v152, v42, v131
  v_dot2c_f32_bf16 v153, v42, v111
  v_dot2c_f32_bf16 v154, v43, v131
  v_dot2c_f32_bf16 v155, v43, v111
  s_waitcnt vmcnt(14)
  v_dot2c_f32_bf16 v148, v44, v132
  v_dot2c_f32_bf16 v149, v44, v112
  v_dot2c_f32_bf16 v150, v45, v132
  v_dot2c_f32_bf16 v151, v45, v112
  v_dot2c_f32_bf16 v152, v46, v132
  v_dot2c_f32_bf16 v153, v46, v112
  v_dot2c_f32_bf16 v154, v47, v132
  v_dot2c_f32_bf16 v155, v47, v112
  v_dot2c_f32_bf16 v148, v48, v133
  v_dot2c_f32_bf16 v149, v48, v113
  v_dot2c_f32_bf16 v150, v49, v133
  v_dot2c_f32_bf16 v151, v49, v113
  v_dot2c_f32_bf16 v152, v50, v133
  v_dot2c_f32_bf16 v153, v50, v113
  v_dot2c_f32_bf16 v154, v51, v133
  v_dot2c_f32_bf16 v155, v51, v113
  s_waitcnt vmcnt(12)
  v_dot2c_f32_bf16 v148, v52, v134
  v_dot2c_f32_bf16 v149, v52, v114
  v_dot2c_f32_bf16 v150, v53, v134
  v_dot2c_f32_bf16 v151, v53, v114
  v_dot2c_f32_bf16 v152, v54, v134
  v_dot2c_f32_bf16 v153, v54, v114
  v_dot2c_f32_bf16 v154, v55, v134
  v_dot2c_f32_bf16 v155, v55, v114
  v_dot2c_f32_bf16 v148, v56, v135
  v_dot2c_f32_bf16 v149, v56, v115
  v_dot2c_f32_bf16 v150, v57, v135
  v_dot2c_f32_bf16 v151, v57, v115
  v_dot2c_f32_bf16 v152, v58, v135
  v_dot2c_f32_bf16 v153, v58, v115
  v_dot2c_f32_bf16 v154, v59, v135
  v_dot2c_f32_bf16 v155, v59, v115
  s_waitcnt vmcnt(10)
  v_dot2c_f32_bf16 v148, v60, v136
  v_dot2c_f32_bf16 v149, v60, v116
  v_dot2c_f32_bf16 v150, v61, v136
  v_dot2c_f32_bf16 v151, v61, v116
  v_dot2c_f32_bf16 v152, v62, v136
  v_dot2c_f32_bf16 v153, v62, v116
  v_dot2c_f32_bf16 v154, v63, v136
  v_dot2c_f32_bf16 v155, v63, v116
  v_dot2c_f32_bf16 v148, v64, v137
  v_dot2c_f32_bf16 v149, v64, v117
  v_dot2c_f32_bf16 v150, v65, v137
  v_dot2c_f32_bf16 v151, v65, v117
  v_dot2c_f32_bf16 v152, v66, v137
  v_dot2c_f32_bf16 v153, v66, v117
  v_dot2c_f32_bf16 v154, v67, v137
  v_dot2c_f32_bf16 v155, v67, v117
  s_waitcnt vmcnt(8)
  v_dot2c_f32_bf16 v148, v68, v138
  v_dot2c_f32_bf16 v149, v68, v118
  v_dot2c_f32_bf16 v150, v69, v138
  v_dot2c_f32_bf16 v151, v69, v118
  v_dot2c_f32_bf16 v152, v70, v138
  v_dot2c_f32_bf16 v153, v70, v118
  v_dot2c_f32_bf16 v154, v71, v138
  v_dot2c_f32_bf16 v155, v71, v118
  v_dot2c_f32_bf16 v148, v72, v139
  v_dot2c_f32_bf16 v149, v72, v119
  v_dot2c_f32_bf16 v150, v73, v139
  v_dot2c_f32_bf16 v151, v73, v119
  v_dot2c_f32_bf16 v152, v74, v139
  v_dot2c_f32_bf16 v153, v74, v119
  v_dot2c_f32_bf16 v154, v75, v139
  v_dot2c_f32_bf16 v155, v75, v119
  s_waitcnt vmcnt(6)
  v_dot2c_f32_bf16 v148, v76, v140
  v_dot2c_f32_bf16 v149, v76, v120
  v_dot2c_f32_bf16 v150, v77, v140
  v_dot2c_f32_bf16 v151, v77, v120
  v_dot2c_f32_bf16 v152, v78, v140
  v_dot2c_f32_bf16 v153, v78, v120
  v_dot2c_f32_bf16 v154, v79, v140
  v_dot2c_f32_bf16 v155, v79, v120
  v_dot2c_f32_bf16 v148, v80, v141
  v_dot2c_f32_bf16 v149, v80, v121
  v_dot2c_f32_bf16 v150, v81, v141
  v_dot2c_f32_bf16 v151, v81, v121
  v_dot2c_f32_bf16 v152, v82, v141
  v_dot2c_f32_bf16 v153, v82, v121
  v_dot2c_f32_bf16 v154, v83, v141
  v_dot2c_f32_bf16 v155, v83, v121
  s_waitcnt vmcnt(4)
  v_dot2c_f32_bf16 v148, v84, v142
  v_dot2c_f32_bf16 v149, v84, v122
  v_dot2c_f32_bf16 v150, v85, v142
  v_dot2c_f32_bf16 v151, v85, v122
  v_dot2c_f32_bf16 v152, v86, v142
  v_dot2c_f32_bf16 v153, v86, v122
  v_dot2c_f32_bf16 v154, v87, v142
  v_dot2c_f32_bf16 v155, v87, v122
  v_dot2c_f32_bf16 v148, v88, v143
  v_dot2c_f32_bf16 v149, v88, v123
  v_dot2c_f32_bf16 v150, v89, v143
  v_dot2c_f32_bf16 v151, v89, v123
  v_dot2c_f32_bf16 v152, v90, v143
  v_dot2c_f32_bf16 v153, v90, v123
  v_dot2c_f32_bf16 v154, v91, v143
  v_dot2c_f32_bf16 v155, v91, v123
  s_waitcnt vmcnt(2)
  v_dot2c_f32_bf16 v148, v92, v144
  v_dot2c_f32_bf16 v149, v92, v124
  v_dot2c_f32_bf16 v150, v93, v144
  v_dot2c_f32_bf16 v151, v93, v124
  v_dot2c_f32_bf16 v152, v94, v144
  v_dot2c_f32_bf16 v153, v94, v124
  v_dot2c_f32_bf16 v154, v95, v144
  v_dot2c_f32_bf16 v155, v95, v124
  v_dot2c_f32_bf16 v148, v96, v145
  v_dot2c_f32_bf16 v149, v96, v125
  v_dot2c_f32_bf16 v150, v97, v145
  v_dot2c_f32_bf16 v151, v97, v125
  v_dot2c_f32_bf16 v152, v98, v145
  v_dot2c_f32_bf16 v153, v98, v125
  v_dot2c_f32_bf16 v154, v99, v145
  v_dot2c_f32_bf16 v155, v99, v125
  s_waitcnt vmcnt(0)
  v_dot2c_f32_bf16 v148, v100, v146
  v_dot2c_f32_bf16 v149, v100, v126
  v_dot2c_f32_bf16 v150, v101, v146
  v_dot2c_f32_bf16 v151, v101, v126
  v_dot2c_f32_bf16 v152, v102, v146
  v_dot2c_f32_bf16 v153, v102, v126
  v_dot2c_f32_bf16 v154, v103, v146
  v_dot2c_f32_bf16 v155, v103, v126
  v_dot2c_f32_bf16 v148, v104, v147
  v_dot2c_f32_bf16 v149, v104, v127
  v_dot2c_f32_bf16 v150, v105, v147
  v_dot2c_f32_bf16 v151, v105, v127
  v_dot2c_f32_bf16 v152, v106, v147
  v_dot2c_f32_bf16 v153, v106, v127
  v_dot2c_f32_bf16 v154, v107, v147
  v_dot2c_f32_bf16 v155, v107, v127
  v_lshlrev_b32 v12, 5, v0
  ds_write_b128 v12, v[148:151] offset:4096
  s_nop 0
  ds_write_b128 v12, v[152:155] offset:4112
  v_lshlrev_b32 v12, 2, v0
  s_waitcnt lgkmcnt(0)
  s_barrier
  s_cmp_lg_u32 s17, 0
  s_cbranch_scc1 mod_enda
  ds_read2st64_b32 v[28:29], v12 offset0:16 offset1:17
  ds_read2st64_b32 v[30:31], v12 offset0:18 offset1:19
  ds_read2st64_b32 v[32:33], v12 offset0:20 offset1:21
  ds_read2st64_b32 v[34:35], v12 offset0:22 offset1:23
  ds_read2st64_b32 v[36:37], v12 offset0:24 offset1:25
  ds_read2st64_b32 v[38:39], v12 offset0:26 offset1:27
  ds_read2st64_b32 v[40:41], v12 offset0:28 offset1:29
  ds_read2st64_b32 v[42:43], v12 offset0:30 offset1:31
  ds_read2st64_b32 v[44:45], v12 offset0:32 offset1:33
  ds_read2st64_b32 v[46:47], v12 offset0:34 offset1:35
  ds_read2st64_b32 v[48:49], v12 offset0:36 offset1:37
  ds_read2st64_b32 v[50:51], v12 offset0:38 offset1:39
  ds_read2st64_b32 v[52:53], v12 offset0:40 offset1:41
  ds_read2st64_b32 v[54:55], v12 offset0:42 offset1:43
  ds_read2st64_b32 v[56:57], v12 offset0:44 offset1:45
  ds_read2st64_b32 v[58:59], v12 offset0:46 offset1:47
  s_waitcnt lgkmcnt(11)
  v_pk_add_f32 v[28:29], v[28:29], v[30:31]
  v_pk_add_f32 v[28:29], v[28:29], v[32:33]
  v_pk_add_f32 v[28:29], v[28:29], v[34:35]
  v_pk_add_f32 v[28:29], v[28:29], v[36:37]
  s_waitcnt lgkmcnt(7)
  v_pk_add_f32 v[28:29], v[28:29], v[38:39]
  v_pk_add_f32 v[28:29], v[28:29], v[40:41]
  v_pk_add_f32 v[28:29], v[28:29], v[42:43]
  v_pk_add_f32 v[28:29], v[28:29], v[44:45]
  s_waitcnt lgkmcnt(3)
  v_pk_add_f32 v[28:29], v[28:29], v[46:47]
  v_pk_add_f32 v[28:29], v[28:29], v[48:49]
  v_pk_add_f32 v[28:29], v[28:29], v[50:51]
  v_pk_add_f32 v[28:29], v[28:29], v[52:53]
  s_waitcnt lgkmcnt(0)
  v_pk_add_f32 v[28:29], v[28:29], v[54:55]
  v_pk_add_f32 v[28:29], v[28:29], v[56:57]
  v_pk_add_f32 v[28:29], v[28:29], v[58:59]
  v_add_f32 v28, v28, v29
  v_cvt_pk_bf16_f32 v28, v28, v28
  v_lshlrev_b32 v28, 16, v28
  s_lshl_b32 s6, s24, 8
  s_add_u32 s6, s6, 65536
  buffer_store_dword v28, v12, s[8:11], s6 offen sc1
  v_mov_b32 v16, 200
  v_mov_b32 v17, 1
  s_waitcnt vmcnt(0)
  s_mov_b64 exec, 1
  buffer_atomic_add v17, v16, s[12:15], 0 offen sc1
  s_mov_b64 exec, -1
mod_enda:
  s_barrier
  s_branch ua_md
ua_nm:
ua_md:
  s_sub_u32 s24, s18, 21
  s_lshl_b32 s25, s16, 2
  s_add_u32 s25, s25, s17
  s_lshl_b32 s35, s24, 2
  s_add_u32 s35, s35, s17
  s_lshl_b32 s30, s16, 22
  s_mul_i32 s51, s17, 40960
  s_lshl_b32 s28, s24, 13
  s_add_u32 s51, s51, s28
  s_add_u32 s51, s51, s30
  s_add_u32 s51, s51, 68288512
  s_add_u32 s28, s51, 227328
  v_lshlrev_b32 v209, 7, v1
  v_lshrrev_b32 v206, 4, v1
  v_and_b32 v206, 3, v206
  v_lshlrev_b32 v206, 1, v206
  v_and_b32 v4, 7, v1
  v_xor_b32 v4, v4, v206
  v_lshlrev_b32 v4, 4, v4
  v_lshrrev_b32 v206, 3, v1
  v_mul_u32_u24 v206, 1280, v206
  v_add_u32 v4, v4, v206
  s_mul_i32 s31, s17, 40960
  v_lshrrev_b32 v206, 2, v1
  v_lshrrev_b32 v207, 1, v206
  v_and_b32 v207, 3, v207
  v_lshlrev_b32 v207, 1, v207
  v_bfe_u32 v220, v1, 1, 1
  v_add_u32 v220, 0, v220
  v_xor_b32 v220, v220, v207
  v_lshlrev_b32 v220, 4, v220
  v_lshlrev_b32 v206, 7, v206
  v_add_u32 v220, v220, v206
  v_and_b32 v206, 1, v1
  v_lshlrev_b32 v206, 3, v206
  v_add_u32 v220, v220, v206
  v_add_u32 v220, s31, v220
  v_lshrrev_b32 v206, 2, v1
  v_lshrrev_b32 v207, 1, v206
  v_and_b32 v207, 3, v207
  v_lshlrev_b32 v207, 1, v207
  v_bfe_u32 v221, v1, 1, 1
  v_add_u32 v221, 2, v221
  v_xor_b32 v221, v221, v207
  v_lshlrev_b32 v221, 4, v221
  v_lshlrev_b32 v206, 7, v206
  v_add_u32 v221, v221, v206
  v_and_b32 v206, 1, v1
  v_lshlrev_b32 v206, 3, v206
  v_add_u32 v221, v221, v206
  v_add_u32 v221, s31, v221
  v_lshrrev_b32 v206, 2, v1
  v_lshrrev_b32 v207, 1, v206
  v_and_b32 v207, 3, v207
  v_lshlrev_b32 v207, 1, v207
  v_bfe_u32 v222, v1, 1, 1
  v_add_u32 v222, 4, v222
  v_xor_b32 v222, v222, v207
  v_lshlrev_b32 v222, 4, v222
  v_lshlrev_b32 v206, 7, v206
  v_add_u32 v222, v222, v206
  v_and_b32 v206, 1, v1
  v_lshlrev_b32 v206, 3, v206
  v_add_u32 v222, v222, v206
  v_add_u32 v222, s31, v222
  v_lshrrev_b32 v206, 2, v1
  v_lshrrev_b32 v207, 1, v206
  v_and_b32 v207, 3, v207
  v_lshlrev_b32 v207, 1, v207
  v_bfe_u32 v223, v1, 1, 1
  v_add_u32 v223, 6, v223
  v_xor_b32 v223, v223, v207
  v_lshlrev_b32 v223, 4, v223
  v_lshlrev_b32 v206, 7, v206
  v_add_u32 v223, v223, v206
  v_and_b32 v206, 1, v1
  v_lshlrev_b32 v206, 3, v206
  v_add_u32 v223, v223, v206
  v_add_u32 v223, s31, v223
  s_mul_i32 s30, s25, 245760
  s_lshl_b32 s28, s24, 8
  s_add_u32 s30, s30, s28
  s_waitcnt lgkmcnt(0)
  s_add_u32 m0, s31, 0
  s_add_u32 s28, s30, 0
  buffer_load_dwordx4 v4, s[20:23], s28 offen nt lds
  s_add_u32 m0, s31, 1024
  s_add_u32 s28, s30, 10240
  buffer_load_dwordx4 v4, s[20:23], s28 offen nt lds
  s_add_u32 m0, s31, 2048
  s_add_u32 s28, s30, 20480
  buffer_load_dwordx4 v4, s[20:23], s28 offen nt lds
  s_add_u32 m0, s31, 3072
  s_add_u32 s28, s30, 30720
  buffer_load_dwordx4 v4, s[20:23], s28 offen nt lds
  s_add_u32 m0, s31, 4096
  s_add_u32 s28, s30, 40960
  buffer_load_dwordx4 v4, s[20:23], s28 offen nt lds
  s_add_u32 m0, s31, 5120
  s_add_u32 s28, s30, 51200
  buffer_load_dwordx4 v4, s[20:23], s28 offen nt lds
  s_add_u32 m0, s31, 6144
  s_add_u32 s28, s30, 61440
  buffer_load_dwordx4 v4, s[20:23], s28 offen nt lds
  s_add_u32 m0, s31, 7168
  s_add_u32 s28, s30, 71680
  buffer_load_dwordx4 v4, s[20:23], s28 offen nt lds
  s_add_u32 m0, s31, 8192
  s_add_u32 s28, s30, 81920
  buffer_load_dwordx4 v4, s[20:23], s28 offen nt lds
  s_add_u32 m0, s31, 9216
  s_add_u32 s28, s30, 92160
  buffer_load_dwordx4 v4, s[20:23], s28 offen nt lds
  s_add_u32 m0, s31, 10240
  s_add_u32 s28, s30, 102400
  buffer_load_dwordx4 v4, s[20:23], s28 offen nt lds
  s_add_u32 m0, s31, 11264
  s_add_u32 s28, s30, 112640
  buffer_load_dwordx4 v4, s[20:23], s28 offen nt lds
  s_add_u32 m0, s31, 12288
  s_add_u32 s28, s30, 122880
  buffer_load_dwordx4 v4, s[20:23], s28 offen nt lds
  s_add_u32 m0, s31, 13312
  s_add_u32 s28, s30, 133120
  buffer_load_dwordx4 v4, s[20:23], s28 offen nt lds
  s_add_u32 m0, s31, 14336
  s_add_u32 s28, s30, 143360
  buffer_load_dwordx4 v4, s[20:23], s28 offen nt lds
  s_add_u32 m0, s31, 15360
  s_add_u32 s28, s30, 153600
  buffer_load_dwordx4 v4, s[20:23], s28 offen nt lds
  s_waitcnt vmcnt(12)
  s_add_u32 m0, s31, 16384
  s_add_u32 s28, s30, 163840
  buffer_load_dwordx4 v4, s[20:23], s28 offen nt lds
  s_add_u32 m0, s31, 17408
  s_add_u32 s28, s30, 174080
  buffer_load_dwordx4 v4, s[20:23], s28 offen nt lds
  s_add_u32 m0, s31, 18432
  s_add_u32 s28, s30, 184320
  buffer_load_dwordx4 v4, s[20:23], s28 offen nt lds
  s_add_u32 m0, s31, 19456
  s_add_u32 s28, s30, 194560
  buffer_load_dwordx4 v4, s[20:23], s28 offen nt lds
  ds_read_b64_tr_b16 a[0:1], v220 offset:0
  ds_read_b64_tr_b16 a[2:3], v220 offset:2048
  ds_read_b64_tr_b16 a[24:25], v221 offset:0
  ds_read_b64_tr_b16 a[26:27], v221 offset:2048
  ds_read_b64_tr_b16 a[48:49], v222 offset:0
  ds_read_b64_tr_b16 a[50:51], v222 offset:2048
  ds_read_b64_tr_b16 a[72:73], v223 offset:0
  ds_read_b64_tr_b16 a[74:75], v223 offset:2048
  s_waitcnt lgkmcnt(8)
  s_waitcnt vmcnt(12)
  s_add_u32 m0, s31, 20480
  s_add_u32 s28, s30, 204800
  buffer_load_dwordx4 v4, s[20:23], s28 offen nt lds
  s_add_u32 m0, s31, 21504
  s_add_u32 s28, s30, 215040
  buffer_load_dwordx4 v4, s[20:23], s28 offen nt lds
  s_add_u32 m0, s31, 22528
  s_add_u32 s28, s30, 225280
  buffer_load_dwordx4 v4, s[20:23], s28 offen nt lds
  s_add_u32 m0, s31, 23552
  s_add_u32 s28, s30, 235520
  buffer_load_dwordx4 v4, s[20:23], s28 offen nt lds
  ds_read_b64_tr_b16 a[4:5], v220 offset:4096
  ds_read_b64_tr_b16 a[6:7], v220 offset:6144
  ds_read_b64_tr_b16 a[28:29], v221 offset:4096
  ds_read_b64_tr_b16 a[30:31], v221 offset:6144
  ds_read_b64_tr_b16 a[52:53], v222 offset:4096
  ds_read_b64_tr_b16 a[54:55], v222 offset:6144
  ds_read_b64_tr_b16 a[76:77], v223 offset:4096
  ds_read_b64_tr_b16 a[78:79], v223 offset:6144
  s_waitcnt lgkmcnt(8)
  s_waitcnt vmcnt(12)
  s_add_u32 m0, s31, 24576
  s_add_u32 s28, s30, 128
  buffer_load_dwordx4 v4, s[20:23], s28 offen nt lds
  s_add_u32 m0, s31, 25600
  s_add_u32 s28, s30, 10368
  buffer_load_dwordx4 v4, s[20:23], s28 offen nt lds
  s_add_u32 m0, s31, 26624
  s_add_u32 s28, s30, 20608
  buffer_load_dwordx4 v4, s[20:23], s28 offen nt lds
  s_add_u32 m0, s31, 27648
  s_add_u32 s28, s30, 30848
  buffer_load_dwordx4 v4, s[20:23], s28 offen nt lds
  ds_read_b64_tr_b16 a[8:9], v220 offset:8192
  ds_read_b64_tr_b16 a[10:11], v220 offset:10240
  ds_read_b64_tr_b16 a[32:33], v221 offset:8192
  ds_read_b64_tr_b16 a[34:35], v221 offset:10240
  ds_read_b64_tr_b16 a[56:57], v222 offset:8192
  ds_read_b64_tr_b16 a[58:59], v222 offset:10240
  ds_read_b64_tr_b16 a[80:81], v223 offset:8192
  ds_read_b64_tr_b16 a[82:83], v223 offset:10240
  s_waitcnt lgkmcnt(8)
  s_waitcnt vmcnt(12)
  s_add_u32 m0, s31, 28672
  s_add_u32 s28, s30, 41088
  buffer_load_dwordx4 v4, s[20:23], s28 offen nt lds
  s_add_u32 m0, s31, 29696
  s_add_u32 s28, s30, 51328
  buffer_load_dwordx4 v4, s[20:23], s28 offen nt lds
  s_add_u32 m0, s31, 30720
  s_add_u32 s28, s30, 61568
  buffer_load_dwordx4 v4, s[20:23], s28 offen nt lds
  s_add_u32 m0, s31, 31744
  s_add_u32 s28, s30, 71808
  buffer_load_dwordx4 v4, s[20:23], s28 offen nt lds
  ds_read_b64_tr_b16 a[12:13], v220 offset:12288
  ds_read_b64_tr_b16 a[14:15], v220 offset:14336
  ds_read_b64_tr_b16 a[36:37], v221 offset:12288
  ds_read_b64_tr_b16 a[38:39], v221 offset:14336
  ds_read_b64_tr_b16 a[60:61], v222 offset:12288
  ds_read_b64_tr_b16 a[62:63], v222 offset:14336
  ds_read_b64_tr_b16 a[84:85], v223 offset:12288
  ds_read_b64_tr_b16 a[86:87], v223 offset:14336
  s_waitcnt lgkmcnt(8)
  s_waitcnt vmcnt(12)
  s_add_u32 m0, s31, 32768
  s_add_u32 s28, s30, 82048
  buffer_load_dwordx4 v4, s[20:23], s28 offen nt lds
  s_add_u32 m0, s31, 33792
  s_add_u32 s28, s30, 92288
  buffer_load_dwordx4 v4, s[20:23], s28 offen nt lds
  s_add_u32 m0, s31, 34816
  s_add_u32 s28, s30, 102528
  buffer_load_dwordx4 v4, s[20:23], s28 offen nt lds
  s_add_u32 m0, s31, 35840
  s_add_u32 s28, s30, 112768
  buffer_load_dwordx4 v4, s[20:23], s28 offen nt lds
  ds_read_b64_tr_b16 a[16:17], v220 offset:16384
  ds_read_b64_tr_b16 a[18:19], v220 offset:18432
  ds_read_b64_tr_b16 a[40:41], v221 offset:16384
  ds_read_b64_tr_b16 a[42:43], v221 offset:18432
  ds_read_b64_tr_b16 a[64:65], v222 offset:16384
  ds_read_b64_tr_b16 a[66:67], v222 offset:18432
  ds_read_b64_tr_b16 a[88:89], v223 offset:16384
  ds_read_b64_tr_b16 a[90:91], v223 offset:18432
  s_waitcnt lgkmcnt(8)
  s_waitcnt vmcnt(12)
  s_add_u32 m0, s31, 36864
  s_add_u32 s28, s30, 123008
  buffer_load_dwordx4 v4, s[20:23], s28 offen nt lds
  s_add_u32 m0, s31, 37888
  s_add_u32 s28, s30, 133248
  buffer_load_dwordx4 v4, s[20:23], s28 offen nt lds
  s_add_u32 m0, s31, 38912
  s_add_u32 s28, s30, 143488
  buffer_load_dwordx4 v4, s[20:23], s28 offen nt lds
  s_add_u32 m0, s31, 39936
  s_add_u32 s28, s30, 153728
  buffer_load_dwordx4 v4, s[20:23], s28 offen nt lds
  ds_read_b64_tr_b16 a[20:21], v220 offset:20480
  ds_read_b64_tr_b16 a[22:23], v220 offset:22528
  ds_read_b64_tr_b16 a[44:45], v221 offset:20480
  ds_read_b64_tr_b16 a[46:47], v221 offset:22528
  ds_read_b64_tr_b16 a[68:69], v222 offset:20480
  ds_read_b64_tr_b16 a[70:71], v222 offset:22528
  ds_read_b64_tr_b16 a[92:93], v223 offset:20480
  ds_read_b64_tr_b16 a[94:95], v223 offset:22528
  s_waitcnt lgkmcnt(8)
  s_waitcnt vmcnt(12)
  s_add_u32 m0, s31, 0
  s_add_u32 s28, s30, 163968
  buffer_load_dwordx4 v4, s[20:23], s28 offen nt lds
  s_add_u32 m0, s31, 1024
  s_add_u32 s28, s30, 174208
  buffer_load_dwordx4 v4, s[20:23], s28 offen nt lds
  s_add_u32 m0, s31, 2048
  s_add_u32 s28, s30, 184448
  buffer_load_dwordx4 v4, s[20:23], s28 offen nt lds
  s_add_u32 m0, s31, 3072
  s_add_u32 s28, s30, 194688
  buffer_load_dwordx4 v4, s[20:23], s28 offen nt lds
  ds_read_b64_tr_b16 a[96:97], v220 offset:24576
  ds_read_b64_tr_b16 a[98:99], v220 offset:26624
  ds_read_b64_tr_b16 a[120:121], v221 offset:24576
  ds_read_b64_tr_b16 a[122:123], v221 offset:26624
  ds_read_b64_tr_b16 a[144:145], v222 offset:24576
  ds_read_b64_tr_b16 a[146:147], v222 offset:26624
  ds_read_b64_tr_b16 a[168:169], v223 offset:24576
  ds_read_b64_tr_b16 a[170:171], v223 offset:26624
  s_waitcnt lgkmcnt(8)
  s_waitcnt vmcnt(12)
  s_add_u32 m0, s31, 4096
  s_add_u32 s28, s30, 204928
  buffer_load_dwordx4 v4, s[20:23], s28 offen nt lds
  s_add_u32 m0, s31, 5120
  s_add_u32 s28, s30, 215168
  buffer_load_dwordx4 v4, s[20:23], s28 offen nt lds
  s_add_u32 m0, s31, 6144
  s_add_u32 s28, s30, 225408
  buffer_load_dwordx4 v4, s[20:23], s28 offen nt lds
  s_add_u32 m0, s31, 7168
  s_add_u32 s28, s30, 235648
  buffer_load_dwordx4 v4, s[20:23], s28 offen nt lds
  ds_read_b64_tr_b16 a[100:101], v220 offset:28672
  ds_read_b64_tr_b16 a[102:103], v220 offset:30720
  ds_read_b64_tr_b16 a[124:125], v221 offset:28672
  ds_read_b64_tr_b16 a[126:127], v221 offset:30720
  ds_read_b64_tr_b16 a[148:149], v222 offset:28672
  ds_read_b64_tr_b16 a[150:151], v222 offset:30720
  ds_read_b64_tr_b16 a[172:173], v223 offset:28672
  ds_read_b64_tr_b16 a[174:175], v223 offset:30720
  s_waitcnt lgkmcnt(8)
  s_waitcnt vmcnt(12)
  ds_read_b64_tr_b16 a[104:105], v220 offset:32768
  ds_read_b64_tr_b16 a[106:107], v220 offset:34816
  ds_read_b64_tr_b16 a[128:129], v221 offset:32768
  ds_read_b64_tr_b16 a[130:131], v221 offset:34816
  ds_read_b64_tr_b16 a[152:153], v222 offset:32768
  ds_read_b64_tr_b16 a[154:155], v222 offset:34816
  ds_read_b64_tr_b16 a[176:177], v223 offset:32768
  ds_read_b64_tr_b16 a[178:179], v223 offset:34816
  s_waitcnt lgkmcnt(8)
  s_waitcnt vmcnt(8)
  ds_read_b64_tr_b16 a[108:109], v220 offset:36864
  ds_read_b64_tr_b16 a[110:111], v220 offset:38912
  ds_read_b64_tr_b16 a[132:133], v221 offset:36864
  ds_read_b64_tr_b16 a[134:135], v221 offset:38912
  ds_read_b64_tr_b16 a[156:157], v222 offset:36864
  ds_read_b64_tr_b16 a[158:159], v222 offset:38912
  ds_read_b64_tr_b16 a[180:181], v223 offset:36864
  ds_read_b64_tr_b16 a[182:183], v223 offset:38912
  s_waitcnt lgkmcnt(8)
  s_waitcnt vmcnt(4)
  ds_read_b64_tr_b16 a[112:113], v220 offset:0
  ds_read_b64_tr_b16 a[114:115], v220 offset:2048
  ds_read_b64_tr_b16 a[136:137], v221 offset:0
  ds_read_b64_tr_b16 a[138:139], v221 offset:2048
  ds_read_b64_tr_b16 a[160:161], v222 offset:0
  ds_read_b64_tr_b16 a[162:163], v222 offset:2048
  ds_read_b64_tr_b16 a[184:185], v223 offset:0
  ds_read_b64_tr_b16 a[186:187], v223 offset:2048
  s_waitcnt lgkmcnt(8)
  s_waitcnt vmcnt(0)
  ds_read_b64_tr_b16 a[116:117], v220 offset:4096
  ds_read_b64_tr_b16 a[118:119], v220 offset:6144
  ds_read_b64_tr_b16 a[140:141], v221 offset:4096
  ds_read_b64_tr_b16 a[142:143], v221 offset:6144
  ds_read_b64_tr_b16 a[164:165], v222 offset:4096
  ds_read_b64_tr_b16 a[166:167], v222 offset:6144
  ds_read_b64_tr_b16 a[188:189], v223 offset:4096
  ds_read_b64_tr_b16 a[190:191], v223 offset:6144
  s_waitcnt lgkmcnt(8)
  s_waitcnt lgkmcnt(0)
  s_barrier
  v_lshlrev_b32 v196, 4, v1
  v_add_u32 v205, 131072, v196
  v_bfe_u32 v206, v1, 2, 1
  v_and_b32 v207, 3, v1
  v_lshl_add_u32 v206, v206, 3, v207
  v_lshrrev_b32 v207, 4, v1
  v_lshl_add_u32 v206, v207, 4, v206
  v_lshlrev_b32 v206, 4, v206
  v_bfe_u32 v207, v1, 3, 1
  v_mul_u32_u24 v208, 1088, v207
  s_lshl_b32 s28, s17, 11
  v_add3_u32 v216, v206, v208, s28
  v_xor_b32 v217, 64, v216
  s_lshl_b32 s28, s17, 13
  v_add_u32 v218, s28, v196
  v_xor_b32 v219, 64, v218
  s_lshr_b32 s28, s17, 1
  s_lshl_b32 s28, s28, 10
  s_and_b32 s29, s17, 1
  s_lshl_b32 s30, s29, 3
  s_add_u32 s28, s28, s30
  s_add_u32 s28, s28, 141312
  v_lshl_add_u32 v206, v207, 2, v206
  v_add_u32 v197, s28, v206
  s_lshl_b32 s28, s17, 11
  s_add_u32 s42, s28, 131072
  s_add_u32 s44, s28, 141312
  s_lshl_b32 s29, s29, 10
  s_add_u32 s43, s29, 139264
  s_lshl_b32 s30, s16, 22
  s_add_u32 s30, s30, 67108864
  s_add_u32 s47, s30, s29
  s_add_u32 s47, s47, 1404928
  s_add_u32 s48, s30, s28
  s_add_u32 s48, s48, 1396736
  s_mul_i32 s49, s17, 10240
  s_lshl_b32 s28, s24, 11
  s_add_u32 s49, s49, s28
  s_add_u32 s49, s49, s30
  s_add_u32 s49, s49, 1343488
  s_mul_i32 s50, s17, 12288
  s_add_u32 s50, s50, s30
  s_add_u32 s50, s50, 98304
  s_mov_b32 s32, s50
  v_and_b32 v206, 15, v1
  v_mul_u32_u24 v206, 1280, v206
  v_lshrrev_b32 v207, 4, v1
  v_lshl_add_u32 v198, v207, 4, v206
  s_lshl_b32 s28, s16, 8
  v_lshl_add_u32 v201, v1, 2, s28
  v_add_u32 v202, 12288, v201
  s_mul_i32 s29, s17, 12
  s_add_u32 s29, s29, 96
  v_add_u32 v201, s29, v201
  s_lshl_b32 s29, s35, 2
  s_add_u32 s28, s28, s29
  s_add_u32 s28, s28, 144
  v_mov_b32 v199, s28
  s_lshl_b32 s28, s16, 7
  s_add_u32 s28, s28, s29
  s_add_u32 s40, s28, 2162688
  s_add_u32 s28, s28, 2293760
  v_mov_b32 v200, s28
  s_mul_i32 s39, s16, 40960
  s_lshl_b32 s28, s35, 6
  s_add_u32 s39, s39, s28
  s_add_u32 s39, s39, 226492416
  s_mov_b32 s26, 0
  s_mov_b32 s34, 1
  s_add_u32 s28, s51, 227328
  s_add_u32 s28, s51, 454656
  s_add_u32 s29, s51, 681984
  s_lshl_b32 s27, s16, 2
  s_add_u32 s27, s27, 32
  v_mov_b32 v206, s27
  s_mov_b32 s27, 0
  s_mov_b64 exec, 1
gw_11:
  buffer_load_dword v207, v206, s[12:15], 0 offen sc1
  s_add_u32 s27, s27, 1
  s_cmp_gt_u32 s27, 65536
  s_cbranch_scc1 role_abort
  s_waitcnt vmcnt(0)
  v_cmp_gt_u32 vcc, 2, v207
  s_cbranch_vccz gk_12
  s_sleep 4
  s_branch gw_11
gk_12:
  s_mov_b64 exec, -1
  s_mov_b32 s27, 0
pw_13:
  buffer_load_dword v203, v201, s[8:11], 0 offen sc1
  s_add_u32 s27, s27, 1
  s_cmp_gt_u32 s27, 65536
  s_cbranch_scc1 role_abort
  s_waitcnt vmcnt(0)
pc_15:
  v_cmp_gt_u32 vcc, s34, v203
  s_nop 0
  s_and_b32 vcc_lo, vcc_lo, 0x7
  s_and_b32 vcc_hi, vcc_hi, 0x0
  s_cmp_eq_u64 vcc, 0
  s_cbranch_scc1 po_14
  s_sleep 2
  s_branch pw_13
po_14:
  s_add_u32 s45, s32, 4096
  s_add_u32 s46, s32, 8192
  buffer_load_dwordx4 v[4:7], v196, s[8:11], s32 offen offset:0 sc1
  buffer_load_dwordx4 v[8:11], v196, s[8:11], s32 offen offset:1024 sc1
  buffer_load_dwordx4 v[12:15], v196, s[8:11], s32 offen offset:2048 sc1
  buffer_load_dwordx4 v[16:19], v196, s[8:11], s32 offen offset:3072 sc1
  buffer_load_dwordx4 v[20:23], v196, s[8:11], s45 offen offset:0 sc1
  buffer_load_dwordx4 v[24:27], v196, s[8:11], s45 offen offset:1024 sc1
  buffer_load_dwordx4 v[28:31], v196, s[8:11], s45 offen offset:2048 sc1
  buffer_load_dwordx4 v[32:35], v196, s[8:11], s45 offen offset:3072 sc1
  buffer_load_dwordx4 v[36:39], v196, s[8:11], s46 offen offset:0 sc1
  buffer_load_dwordx4 v[40:43], v196, s[8:11], s46 offen offset:1024 sc1
  buffer_load_dwordx4 v[44:47], v196, s[8:11], s46 offen offset:2048 sc1
  buffer_load_dwordx4 v[48:51], v196, s[8:11], s46 offen offset:3072 sc1
ua_loop0:
  s_and_b32 s41, s26, 3
  s_mul_i32 s28, s41, 227328
  s_add_u32 s38, s47, s28
  s_add_u32 s36, s48, s28
  s_add_u32 s37, s49, s28
  s_add_u32 s33, s51, s28
  s_lshl_b32 s41, s41, 15
  v_add_u32 v212, s41, v216
  v_add_u32 v213, s41, v217
  v_add_u32 v214, s41, v218
  v_add_u32 v215, s41, v219
  s_cmp_ge_u32 s26, 4
  s_cbranch_scc1 ua_ao0
  s_waitcnt vmcnt(0)
  s_branch ua_u0
ua_ao0:
  s_sub_u32 s34, s26, 3
  ds_read_b128 v[92:95], v212 offset:0
  ds_read_b128 v[96:99], v213 offset:0
  ds_read_b128 v[100:103], v212 offset:8192
  ds_read_b128 v[104:107], v213 offset:8192
  ds_read_b128 v[108:111], v212 offset:16384
  ds_read_b128 v[112:115], v213 offset:16384
  ds_read_b128 v[116:119], v212 offset:24576
  ds_read_b128 v[120:123], v213 offset:24576
  s_mov_b32 s27, 0
pw_16:
  buffer_load_dword v204, v202, s[8:11], 0 offen sc1
  s_add_u32 s27, s27, 1
  s_cmp_gt_u32 s27, 65536
  s_cbranch_scc1 role_abort
  s_waitcnt vmcnt(0)
pc_18:
  v_cmp_gt_u32 vcc, s34, v204
  s_nop 0
  s_and_b32 vcc_lo, vcc_lo, 0xff
  s_and_b32 vcc_hi, vcc_hi, 0x0
  s_cmp_eq_u64 vcc, 0
  s_cbranch_scc1 po_17
  s_sleep 2
  s_branch pw_16
po_17:
  s_mov_b32 m0, s42
  v_mov_b32 v200, s40
  buffer_load_dwordx4 v196, s[8:11], s36 offen sc1 lds
  buffer_load_dwordx4 v196, s[8:11], s36 offen offset:1024 sc1 lds
  s_mov_b32 m0, s44
  s_nop 0
  buffer_load_dwordx4 v196, s[8:11], s37 offen sc1 lds
  buffer_load_dwordx4 v196, s[8:11], s37 offen offset:1024 sc1 lds
  s_mov_b32 m0, s43
  s_nop 0
  buffer_load_dwordx4 v196, s[8:11], s38 offen sc1 lds
  s_add_u32 s40, s40, 1024
  s_add_u32 s28, s39, 20480
  s_waitcnt vmcnt(0) lgkmcnt(0)
  s_barrier
  ds_read_b128 v[124:127], v205 offset:0
  ds_read_b128 v[128:131], v205 offset:1024
  ds_read_b128 v[132:135], v205 offset:2048
  ds_read_b128 v[136:139], v205 offset:3072
  ds_read_b128 v[140:143], v205 offset:4096
  ds_read_b128 v[144:147], v205 offset:5120
  ds_read_b128 v[148:151], v205 offset:6144
  ds_read_b128 v[152:155], v205 offset:7168
  s_waitcnt lgkmcnt(6)
  v_mfma_f32_16x16x32_bf16 v[172:175], v[92:95], v[124:127], 0
  ds_read_b128 v[164:167], v205 offset:8192
  v_mfma_f32_16x16x32_bf16 v[176:179], v[96:99], v[124:127], 0
  ds_read_b128 v[168:171], v205 offset:9216
  v_mfma_f32_16x16x32_bf16 v[180:183], v[92:95], v[128:131], 0
  ds_read_b32 v156, v197 offset:0
  v_mfma_f32_16x16x32_bf16 v[184:187], v[96:99], v[128:131], 0
  ds_read_b32 v157, v197 offset:2048
  s_waitcnt lgkmcnt(8)
  v_mfma_f32_16x16x32_bf16 v[172:175], v[100:103], v[132:135], v[172:175]
  ds_read_b32 v158, v197 offset:4096
  v_mfma_f32_16x16x32_bf16 v[176:179], v[104:107], v[132:135], v[176:179]
  ds_read_b32 v159, v197 offset:6144
  v_mfma_f32_16x16x32_bf16 v[180:183], v[100:103], v[136:139], v[180:183]
  ds_read_b32 v160, v197 offset:64
  v_mfma_f32_16x16x32_bf16 v[184:187], v[104:107], v[136:139], v[184:187]
  ds_read_b32 v161, v197 offset:2112
  s_waitcnt lgkmcnt(10)
  v_mfma_f32_16x16x32_bf16 v[172:175], v[108:111], v[140:143], v[172:175]
  ds_read_b32 v162, v197 offset:4160
  v_mfma_f32_16x16x32_bf16 v[176:179], v[112:115], v[140:143], v[176:179]
  ds_read_b32 v163, v197 offset:6208
  v_mfma_f32_16x16x32_bf16 v[180:183], v[108:111], v[144:147], v[180:183]
  v_mfma_f32_16x16x32_bf16 v[184:187], v[112:115], v[144:147], v[184:187]
  s_waitcnt lgkmcnt(10)
  v_mfma_f32_16x16x32_bf16 v[172:175], v[116:119], v[148:151], v[172:175]
  v_mfma_f32_16x16x32_bf16 v[176:179], v[120:123], v[148:151], v[176:179]
  v_mfma_f32_16x16x32_bf16 v[180:183], v[116:119], v[152:155], v[180:183]
  v_mfma_f32_16x16x32_bf16 v[184:187], v[120:123], v[152:155], v[184:187]
  s_waitcnt lgkmcnt(0)
  v_mfma_f32_16x16x32_bf16 v[172:175], v[156:159], v[164:167], v[172:175]
  v_mfma_f32_16x16x32_bf16 v[176:179], v[160:163], v[164:167], v[176:179]
  v_mfma_f32_16x16x32_bf16 v[180:183], v[156:159], v[168:171], v[180:183]
  v_mfma_f32_16x16x32_bf16 v[184:187], v[160:163], v[168:171], v[184:187]
  s_barrier
  s_nop 3
  v_cvt_pk_bf16_f32 v188, v172, v173
  v_cvt_pk_bf16_f32 v189, v174, v175
  v_cvt_pk_bf16_f32 v190, v176, v177
  v_cvt_pk_bf16_f32 v191, v178, v179
  buffer_store_dwordx4 v[188:191], v198, s[8:11], s39 offen sc1
  v_cvt_pk_bf16_f32 v192, v180, v181
  v_cvt_pk_bf16_f32 v193, v182, v183
  v_cvt_pk_bf16_f32 v194, v184, v185
  v_cvt_pk_bf16_f32 v195, v186, v187
  buffer_store_dwordx4 v[192:195], v198, s[8:11], s28 offen sc1
  s_add_u32 s39, s39, 327680
  s_cmp_lt_u32 s26, 64
  s_cbranch_scc1 ua_u0
  s_waitcnt vmcnt(0)
  s_mov_b64 exec, 1
  buffer_store_dword v208, v200, s[8:11], 0 offen sc1
  s_mov_b64 exec, -1
  s_add_u32 s26, s26, 1
  s_cmp_ge_u32 s26, 68
  s_cbranch_scc1 ua_end
  s_branch ua_loop0
ua_u0:
  s_add_u32 s34, s26, 2
  s_min_u32 s34, s34, 64
  s_cmp_lt_u32 s26, 2
  s_cselect_b32 s34, 0, s34
  s_mov_b32 s27, 0
  s_branch pc_21
pw_19:
  buffer_load_dword v203, v201, s[8:11], 0 offen sc1
  s_add_u32 s27, s27, 1
  s_cmp_gt_u32 s27, 65536
  s_cbranch_scc1 role_abort
  s_waitcnt vmcnt(0)
pc_21:
  v_cmp_gt_u32 vcc, s34, v203
  s_nop 0
  s_and_b32 vcc_lo, vcc_lo, 0x7
  s_and_b32 vcc_hi, vcc_hi, 0x0
  s_cmp_eq_u64 vcc, 0
  s_cbranch_scc1 po_20
  s_sleep 4
  s_branch pw_19
po_20:
  s_add_u32 s26, s26, 1
  s_and_b32 s28, s26, 7
  s_mul_i32 s28, s28, 147456
  s_add_u32 s32, s50, s28
  v_mov_b32 v208, s26
  s_add_u32 s30, s33, 4096
  s_add_u32 s45, s32, 4096
  s_add_u32 s46, s32, 8192
  v_mfma_f32_16x16x32_bf16 v[52:55], v[4:7], a[0:3], 0
  v_mfma_f32_16x16x32_bf16 v[56:59], v[28:31], a[0:3], 0
  v_mfma_f32_16x16x32_bf16 v[60:63], v[4:7], a[24:27], 0
  v_mfma_f32_16x16x32_bf16 v[64:67], v[28:31], a[24:27], 0
  buffer_load_dwordx4 a[192:195], v196, s[8:11], s32 offen offset:0 sc1
  v_mfma_f32_16x16x32_bf16 v[52:55], v[8:11], a[4:7], v[52:55]
  v_mfma_f32_16x16x32_bf16 v[56:59], v[32:35], a[4:7], v[56:59]
  v_mfma_f32_16x16x32_bf16 v[60:63], v[8:11], a[28:31], v[60:63]
  v_mfma_f32_16x16x32_bf16 v[64:67], v[32:35], a[28:31], v[64:67]
  buffer_load_dwordx4 a[196:199], v196, s[8:11], s32 offen offset:1024 sc1
  v_mfma_f32_16x16x32_bf16 v[52:55], v[12:15], a[8:11], v[52:55]
  v_mfma_f32_16x16x32_bf16 v[56:59], v[36:39], a[8:11], v[56:59]
  v_mfma_f32_16x16x32_bf16 v[60:63], v[12:15], a[32:35], v[60:63]
  v_mfma_f32_16x16x32_bf16 v[64:67], v[36:39], a[32:35], v[64:67]
  buffer_load_dwordx4 a[200:203], v196, s[8:11], s32 offen offset:2048 sc1
  v_mfma_f32_16x16x32_bf16 v[52:55], v[16:19], a[12:15], v[52:55]
  v_mfma_f32_16x16x32_bf16 v[56:59], v[40:43], a[12:15], v[56:59]
  v_mfma_f32_16x16x32_bf16 v[60:63], v[16:19], a[36:39], v[60:63]
  v_mfma_f32_16x16x32_bf16 v[64:67], v[40:43], a[36:39], v[64:67]
  buffer_load_dwordx4 a[204:207], v196, s[8:11], s32 offen offset:3072 sc1
  v_mfma_f32_16x16x32_bf16 v[52:55], v[20:23], a[16:19], v[52:55]
  v_mfma_f32_16x16x32_bf16 v[56:59], v[44:47], a[16:19], v[56:59]
  v_mfma_f32_16x16x32_bf16 v[60:63], v[20:23], a[40:43], v[60:63]
  v_mfma_f32_16x16x32_bf16 v[64:67], v[44:47], a[40:43], v[64:67]
  buffer_load_dwordx4 a[208:211], v196, s[8:11], s45 offen offset:0 sc1
  v_mfma_f32_16x16x32_bf16 v[52:55], v[24:27], a[20:23], v[52:55]
  v_mfma_f32_16x16x32_bf16 v[56:59], v[48:51], a[20:23], v[56:59]
  v_mfma_f32_16x16x32_bf16 v[60:63], v[24:27], a[44:47], v[60:63]
  v_mfma_f32_16x16x32_bf16 v[64:67], v[48:51], a[44:47], v[64:67]
  buffer_load_dwordx4 a[212:215], v196, s[8:11], s45 offen offset:1024 sc1
  v_mfma_f32_16x16x32_bf16 v[68:71], v[4:7], a[48:51], 0
  v_mfma_f32_16x16x32_bf16 v[72:75], v[28:31], a[48:51], 0
  v_mfma_f32_16x16x32_bf16 v[76:79], v[4:7], a[72:75], 0
  v_mfma_f32_16x16x32_bf16 v[80:83], v[28:31], a[72:75], 0
  buffer_load_dwordx4 a[216:219], v196, s[8:11], s45 offen offset:2048 sc1
  v_mfma_f32_16x16x32_bf16 v[68:71], v[8:11], a[52:55], v[68:71]
  v_cvt_pk_bf16_f32 v84, v52, v53
  v_mfma_f32_16x16x32_bf16 v[72:75], v[32:35], a[52:55], v[72:75]
  v_cvt_pk_bf16_f32 v85, v54, v55
  v_mfma_f32_16x16x32_bf16 v[76:79], v[8:11], a[76:79], v[76:79]
  v_cvt_pk_bf16_f32 v86, v56, v57
  v_mfma_f32_16x16x32_bf16 v[80:83], v[32:35], a[76:79], v[80:83]
  buffer_load_dwordx4 a[220:223], v196, s[8:11], s45 offen offset:3072 sc1
  v_mfma_f32_16x16x32_bf16 v[68:71], v[12:15], a[56:59], v[68:71]
  v_cvt_pk_bf16_f32 v87, v58, v59
  v_mfma_f32_16x16x32_bf16 v[72:75], v[36:39], a[56:59], v[72:75]
  buffer_store_dwordx4 v[84:87], v196, s[8:11], s33 offen offset:0
  v_mfma_f32_16x16x32_bf16 v[76:79], v[12:15], a[80:83], v[76:79]
  ds_write_b128 v214, v[84:87] offset:0
  v_mfma_f32_16x16x32_bf16 v[80:83], v[36:39], a[80:83], v[80:83]
  buffer_load_dwordx4 a[224:227], v196, s[8:11], s46 offen offset:0 sc1
  v_mfma_f32_16x16x32_bf16 v[68:71], v[16:19], a[60:63], v[68:71]
  v_cvt_pk_bf16_f32 v88, v60, v61
  v_mfma_f32_16x16x32_bf16 v[72:75], v[40:43], a[60:63], v[72:75]
  v_cvt_pk_bf16_f32 v89, v62, v63
  v_mfma_f32_16x16x32_bf16 v[76:79], v[16:19], a[84:87], v[76:79]
  v_cvt_pk_bf16_f32 v90, v64, v65
  v_mfma_f32_16x16x32_bf16 v[80:83], v[40:43], a[84:87], v[80:83]
  buffer_load_dwordx4 a[228:231], v196, s[8:11], s46 offen offset:1024 sc1
  v_mfma_f32_16x16x32_bf16 v[68:71], v[20:23], a[64:67], v[68:71]
  v_cvt_pk_bf16_f32 v91, v66, v67
  v_mfma_f32_16x16x32_bf16 v[72:75], v[44:47], a[64:67], v[72:75]
  buffer_store_dwordx4 v[88:91], v196, s[8:11], s33 offen offset:1024
  v_mfma_f32_16x16x32_bf16 v[76:79], v[20:23], a[88:91], v[76:79]
  ds_write_b128 v215, v[88:91] offset:1024
  v_mfma_f32_16x16x32_bf16 v[80:83], v[44:47], a[88:91], v[80:83]
  buffer_load_dwordx4 a[232:235], v196, s[8:11], s46 offen offset:2048 sc1
  v_mfma_f32_16x16x32_bf16 v[68:71], v[24:27], a[68:71], v[68:71]
  v_mfma_f32_16x16x32_bf16 v[72:75], v[48:51], a[68:71], v[72:75]
  v_mfma_f32_16x16x32_bf16 v[76:79], v[24:27], a[92:95], v[76:79]
  v_mfma_f32_16x16x32_bf16 v[80:83], v[48:51], a[92:95], v[80:83]
  buffer_load_dwordx4 a[236:239], v196, s[8:11], s46 offen offset:3072 sc1
  s_waitcnt vmcnt(14)
  s_mov_b64 exec, 1
  buffer_store_dword v208, v200, s[8:11], 0 offen sc1
  s_mov_b64 exec, -1
  v_mfma_f32_16x16x32_bf16 v[52:55], v[4:7], a[96:99], 0
  v_mfma_f32_16x16x32_bf16 v[56:59], v[28:31], a[96:99], 0
  v_mfma_f32_16x16x32_bf16 v[60:63], v[4:7], a[120:123], 0
  v_mfma_f32_16x16x32_bf16 v[64:67], v[28:31], a[120:123], 0
  v_mfma_f32_16x16x32_bf16 v[52:55], v[8:11], a[100:103], v[52:55]
  v_cvt_pk_bf16_f32 v84, v68, v69
  v_mfma_f32_16x16x32_bf16 v[56:59], v[32:35], a[100:103], v[56:59]
  v_cvt_pk_bf16_f32 v85, v70, v71
  v_mfma_f32_16x16x32_bf16 v[60:63], v[8:11], a[124:127], v[60:63]
  v_cvt_pk_bf16_f32 v86, v72, v73
  v_mfma_f32_16x16x32_bf16 v[64:67], v[32:35], a[124:127], v[64:67]
  v_cvt_pk_bf16_f32 v87, v74, v75
  v_mfma_f32_16x16x32_bf16 v[52:55], v[12:15], a[104:107], v[52:55]
  buffer_store_dwordx4 v[84:87], v196, s[8:11], s33 offen offset:2048
  v_mfma_f32_16x16x32_bf16 v[56:59], v[36:39], a[104:107], v[56:59]
  ds_write_b128 v214, v[84:87] offset:2048
  v_mfma_f32_16x16x32_bf16 v[60:63], v[12:15], a[128:131], v[60:63]
  v_cvt_pk_bf16_f32 v88, v76, v77
  v_mfma_f32_16x16x32_bf16 v[64:67], v[36:39], a[128:131], v[64:67]
  v_cvt_pk_bf16_f32 v89, v78, v79
  v_mfma_f32_16x16x32_bf16 v[52:55], v[16:19], a[108:111], v[52:55]
  v_cvt_pk_bf16_f32 v90, v80, v81
  v_mfma_f32_16x16x32_bf16 v[56:59], v[40:43], a[108:111], v[56:59]
  v_cvt_pk_bf16_f32 v91, v82, v83
  v_mfma_f32_16x16x32_bf16 v[60:63], v[16:19], a[132:135], v[60:63]
  buffer_store_dwordx4 v[88:91], v196, s[8:11], s33 offen offset:3072
  v_mfma_f32_16x16x32_bf16 v[64:67], v[40:43], a[132:135], v[64:67]
  ds_write_b128 v215, v[88:91] offset:3072
  v_mfma_f32_16x16x32_bf16 v[52:55], v[20:23], a[112:115], v[52:55]
  v_mfma_f32_16x16x32_bf16 v[56:59], v[44:47], a[112:115], v[56:59]
  v_mfma_f32_16x16x32_bf16 v[60:63], v[20:23], a[136:139], v[60:63]
  v_mfma_f32_16x16x32_bf16 v[64:67], v[44:47], a[136:139], v[64:67]
  v_mfma_f32_16x16x32_bf16 v[52:55], v[24:27], a[116:119], v[52:55]
  v_mfma_f32_16x16x32_bf16 v[56:59], v[48:51], a[116:119], v[56:59]
  v_mfma_f32_16x16x32_bf16 v[60:63], v[24:27], a[140:143], v[60:63]
  v_mfma_f32_16x16x32_bf16 v[64:67], v[48:51], a[140:143], v[64:67]
  v_mfma_f32_16x16x32_bf16 v[68:71], v[4:7], a[144:147], 0
  v_mfma_f32_16x16x32_bf16 v[72:75], v[28:31], a[144:147], 0
  v_mfma_f32_16x16x32_bf16 v[76:79], v[4:7], a[168:171], 0
  v_mfma_f32_16x16x32_bf16 v[80:83], v[28:31], a[168:171], 0
  v_mfma_f32_16x16x32_bf16 v[68:71], v[8:11], a[148:151], v[68:71]
  v_cvt_pk_bf16_f32 v84, v52, v53
  v_mfma_f32_16x16x32_bf16 v[72:75], v[32:35], a[148:151], v[72:75]
  v_cvt_pk_bf16_f32 v85, v54, v55
  v_mfma_f32_16x16x32_bf16 v[76:79], v[8:11], a[172:175], v[76:79]
  v_cvt_pk_bf16_f32 v86, v56, v57
  v_mfma_f32_16x16x32_bf16 v[80:83], v[32:35], a[172:175], v[80:83]
  v_cvt_pk_bf16_f32 v87, v58, v59
  v_mfma_f32_16x16x32_bf16 v[68:71], v[12:15], a[152:155], v[68:71]
  buffer_store_dwordx4 v[84:87], v196, s[8:11], s30 offen offset:0
  v_mfma_f32_16x16x32_bf16 v[72:75], v[36:39], a[152:155], v[72:75]
  ds_write_b128 v214, v[84:87] offset:4096
  v_mfma_f32_16x16x32_bf16 v[76:79], v[12:15], a[176:179], v[76:79]
  v_cvt_pk_bf16_f32 v88, v60, v61
  v_mfma_f32_16x16x32_bf16 v[80:83], v[36:39], a[176:179], v[80:83]
  v_cvt_pk_bf16_f32 v89, v62, v63
  v_mfma_f32_16x16x32_bf16 v[68:71], v[16:19], a[156:159], v[68:71]
  v_cvt_pk_bf16_f32 v90, v64, v65
  v_mfma_f32_16x16x32_bf16 v[72:75], v[40:43], a[156:159], v[72:75]
  v_cvt_pk_bf16_f32 v91, v66, v67
  v_mfma_f32_16x16x32_bf16 v[76:79], v[16:19], a[180:183], v[76:79]
  buffer_store_dwordx4 v[88:91], v196, s[8:11], s30 offen offset:1024
  v_mfma_f32_16x16x32_bf16 v[80:83], v[40:43], a[180:183], v[80:83]
  ds_write_b128 v215, v[88:91] offset:5120
  v_mfma_f32_16x16x32_bf16 v[68:71], v[20:23], a[160:163], v[68:71]
  v_mfma_f32_16x16x32_bf16 v[72:75], v[44:47], a[160:163], v[72:75]
  v_mfma_f32_16x16x32_bf16 v[76:79], v[20:23], a[184:187], v[76:79]
  v_mfma_f32_16x16x32_bf16 v[80:83], v[44:47], a[184:187], v[80:83]
  v_mfma_f32_16x16x32_bf16 v[68:71], v[24:27], a[164:167], v[68:71]
  v_mfma_f32_16x16x32_bf16 v[72:75], v[48:51], a[164:167], v[72:75]
  v_mfma_f32_16x16x32_bf16 v[76:79], v[24:27], a[188:191], v[76:79]
  v_mfma_f32_16x16x32_bf16 v[80:83], v[48:51], a[188:191], v[80:83]
  s_nop 4
  v_cvt_pk_bf16_f32 v84, v68, v69
  v_cvt_pk_bf16_f32 v85, v70, v71
  v_cvt_pk_bf16_f32 v86, v72, v73
  v_cvt_pk_bf16_f32 v87, v74, v75
  buffer_store_dwordx4 v[84:87], v196, s[8:11], s30 offen offset:2048
  ds_write_b128 v214, v[84:87] offset:6144
  v_cvt_pk_bf16_f32 v88, v76, v77
  v_cvt_pk_bf16_f32 v89, v78, v79
  v_cvt_pk_bf16_f32 v90, v80, v81
  v_cvt_pk_bf16_f32 v91, v82, v83
  buffer_store_dwordx4 v[88:91], v196, s[8:11], s30 offen offset:3072
  ds_write_b128 v215, v[88:91] offset:7168
  buffer_load_dword v203, v201, s[8:11], 0 offen sc1
  s_waitcnt vmcnt(0) lgkmcnt(0)
  buffer_store_dword v208, v199, s[8:11], 0 offen
  s_cmp_gt_u32 s26, 4
  s_cbranch_scc1 ua_nb0
  s_cmp_gt_u32 s26, 2
  s_cbranch_scc1 ua_nr0
  s_add_u32 s34, s26, 1
  s_mov_b32 s27, 0
  s_branch pc_24
pw_22:
  buffer_load_dword v203, v201, s[8:11], 0 offen sc1
  s_add_u32 s27, s27, 1
  s_cmp_gt_u32 s27, 65536
  s_cbranch_scc1 role_abort
  s_waitcnt vmcnt(0)
pc_24:
  v_cmp_gt_u32 vcc, s34, v203
  s_nop 0
  s_and_b32 vcc_lo, vcc_lo, 0x7
  s_and_b32 vcc_hi, vcc_hi, 0x0
  s_cmp_eq_u64 vcc, 0
  s_cbranch_scc1 po_23
  s_sleep 2
  s_branch pw_22
po_23:
  s_add_u32 s45, s32, 4096
  s_add_u32 s46, s32, 8192
  buffer_load_dwordx4 a[192:195], v196, s[8:11], s32 offen offset:0 sc1
  buffer_load_dwordx4 a[196:199], v196, s[8:11], s32 offen offset:1024 sc1
  buffer_load_dwordx4 a[200:203], v196, s[8:11], s32 offen offset:2048 sc1
  buffer_load_dwordx4 a[204:207], v196, s[8:11], s32 offen offset:3072 sc1
  buffer_load_dwordx4 a[208:211], v196, s[8:11], s45 offen offset:0 sc1
  buffer_load_dwordx4 a[212:215], v196, s[8:11], s45 offen offset:1024 sc1
  buffer_load_dwordx4 a[216:219], v196, s[8:11], s45 offen offset:2048 sc1
  buffer_load_dwordx4 a[220:223], v196, s[8:11], s45 offen offset:3072 sc1
  buffer_load_dwordx4 a[224:227], v196, s[8:11], s46 offen offset:0 sc1
  buffer_load_dwordx4 a[228:231], v196, s[8:11], s46 offen offset:1024 sc1
  buffer_load_dwordx4 a[232:235], v196, s[8:11], s46 offen offset:2048 sc1
  buffer_load_dwordx4 a[236:239], v196, s[8:11], s46 offen offset:3072 sc1
ua_nr0:
  s_cmp_eq_u32 s26, 4
  s_cbranch_scc0 ua_nb0
  s_barrier
ua_nb0:
ua_loop1:
  s_and_b32 s41, s26, 3
  s_mul_i32 s28, s41, 227328
  s_add_u32 s38, s47, s28
  s_add_u32 s36, s48, s28
  s_add_u32 s37, s49, s28
  s_add_u32 s33, s51, s28
  s_lshl_b32 s41, s41, 15
  v_add_u32 v212, s41, v216
  v_add_u32 v213, s41, v217
  v_add_u32 v214, s41, v218
  v_add_u32 v215, s41, v219
  s_cmp_ge_u32 s26, 4
  s_cbranch_scc1 ua_ao1
  s_waitcnt vmcnt(0)
  s_branch ua_u1
ua_ao1:
  s_sub_u32 s34, s26, 3
  ds_read_b128 v[92:95], v212 offset:0
  ds_read_b128 v[96:99], v213 offset:0
  ds_read_b128 v[100:103], v212 offset:8192
  ds_read_b128 v[104:107], v213 offset:8192
  ds_read_b128 v[108:111], v212 offset:16384
  ds_read_b128 v[112:115], v213 offset:16384
  ds_read_b128 v[116:119], v212 offset:24576
  ds_read_b128 v[120:123], v213 offset:24576
  s_mov_b32 s27, 0
pw_25:
  buffer_load_dword v204, v202, s[8:11], 0 offen sc1
  s_add_u32 s27, s27, 1
  s_cmp_gt_u32 s27, 65536
  s_cbranch_scc1 role_abort
  s_waitcnt vmcnt(0)
pc_27:
  v_cmp_gt_u32 vcc, s34, v204
  s_nop 0
  s_and_b32 vcc_lo, vcc_lo, 0xff
  s_and_b32 vcc_hi, vcc_hi, 0x0
  s_cmp_eq_u64 vcc, 0
  s_cbranch_scc1 po_26
  s_sleep 2
  s_branch pw_25
po_26:
  s_mov_b32 m0, s42
  v_mov_b32 v200, s40
  buffer_load_dwordx4 v196, s[8:11], s36 offen sc1 lds
  buffer_load_dwordx4 v196, s[8:11], s36 offen offset:1024 sc1 lds
  s_mov_b32 m0, s44
  s_nop 0
  buffer_load_dwordx4 v196, s[8:11], s37 offen sc1 lds
  buffer_load_dwordx4 v196, s[8:11], s37 offen offset:1024 sc1 lds
  s_mov_b32 m0, s43
  s_nop 0
  buffer_load_dwordx4 v196, s[8:11], s38 offen sc1 lds
  s_add_u32 s40, s40, 1024
  s_add_u32 s28, s39, 20480
  s_waitcnt vmcnt(0) lgkmcnt(0)
  s_barrier
  ds_read_b128 v[124:127], v205 offset:0
  ds_read_b128 v[128:131], v205 offset:1024
  ds_read_b128 v[132:135], v205 offset:2048
  ds_read_b128 v[136:139], v205 offset:3072
  ds_read_b128 v[140:143], v205 offset:4096
  ds_read_b128 v[144:147], v205 offset:5120
  ds_read_b128 v[148:151], v205 offset:6144
  ds_read_b128 v[152:155], v205 offset:7168
  s_waitcnt lgkmcnt(6)
  v_mfma_f32_16x16x32_bf16 v[172:175], v[92:95], v[124:127], 0
  ds_read_b128 v[164:167], v205 offset:8192
  v_mfma_f32_16x16x32_bf16 v[176:179], v[96:99], v[124:127], 0
  ds_read_b128 v[168:171], v205 offset:9216
  v_mfma_f32_16x16x32_bf16 v[180:183], v[92:95], v[128:131], 0
  ds_read_b32 v156, v197 offset:0
  v_mfma_f32_16x16x32_bf16 v[184:187], v[96:99], v[128:131], 0
  ds_read_b32 v157, v197 offset:2048
  s_waitcnt lgkmcnt(8)
  v_mfma_f32_16x16x32_bf16 v[172:175], v[100:103], v[132:135], v[172:175]
  ds_read_b32 v158, v197 offset:4096
  v_mfma_f32_16x16x32_bf16 v[176:179], v[104:107], v[132:135], v[176:179]
  ds_read_b32 v159, v197 offset:6144
  v_mfma_f32_16x16x32_bf16 v[180:183], v[100:103], v[136:139], v[180:183]
  ds_read_b32 v160, v197 offset:64
  v_mfma_f32_16x16x32_bf16 v[184:187], v[104:107], v[136:139], v[184:187]
  ds_read_b32 v161, v197 offset:2112
  s_waitcnt lgkmcnt(10)
  v_mfma_f32_16x16x32_bf16 v[172:175], v[108:111], v[140:143], v[172:175]
  ds_read_b32 v162, v197 offset:4160
  v_mfma_f32_16x16x32_bf16 v[176:179], v[112:115], v[140:143], v[176:179]
  ds_read_b32 v163, v197 offset:6208
  v_mfma_f32_16x16x32_bf16 v[180:183], v[108:111], v[144:147], v[180:183]
  v_mfma_f32_16x16x32_bf16 v[184:187], v[112:115], v[144:147], v[184:187]
  s_waitcnt lgkmcnt(10)
  v_mfma_f32_16x16x32_bf16 v[172:175], v[116:119], v[148:151], v[172:175]
  v_mfma_f32_16x16x32_bf16 v[176:179], v[120:123], v[148:151], v[176:179]
  v_mfma_f32_16x16x32_bf16 v[180:183], v[116:119], v[152:155], v[180:183]
  v_mfma_f32_16x16x32_bf16 v[184:187], v[120:123], v[152:155], v[184:187]
  s_waitcnt lgkmcnt(0)
  v_mfma_f32_16x16x32_bf16 v[172:175], v[156:159], v[164:167], v[172:175]
  v_mfma_f32_16x16x32_bf16 v[176:179], v[160:163], v[164:167], v[176:179]
  v_mfma_f32_16x16x32_bf16 v[180:183], v[156:159], v[168:171], v[180:183]
  v_mfma_f32_16x16x32_bf16 v[184:187], v[160:163], v[168:171], v[184:187]
  s_barrier
  s_nop 3
  v_cvt_pk_bf16_f32 v188, v172, v173
  v_cvt_pk_bf16_f32 v189, v174, v175
  v_cvt_pk_bf16_f32 v190, v176, v177
  v_cvt_pk_bf16_f32 v191, v178, v179
  buffer_store_dwordx4 v[188:191], v198, s[8:11], s39 offen sc1
  v_cvt_pk_bf16_f32 v192, v180, v181
  v_cvt_pk_bf16_f32 v193, v182, v183
  v_cvt_pk_bf16_f32 v194, v184, v185
  v_cvt_pk_bf16_f32 v195, v186, v187
  buffer_store_dwordx4 v[192:195], v198, s[8:11], s28 offen sc1
  s_add_u32 s39, s39, 327680
  s_cmp_lt_u32 s26, 64
  s_cbranch_scc1 ua_u1
  s_waitcnt vmcnt(0)
  s_mov_b64 exec, 1
  buffer_store_dword v208, v200, s[8:11], 0 offen sc1
  s_mov_b64 exec, -1
  s_add_u32 s26, s26, 1
  s_cmp_ge_u32 s26, 68
  s_cbranch_scc1 ua_end
  s_branch ua_loop1
ua_u1:
  s_add_u32 s34, s26, 2
  s_min_u32 s34, s34, 64
  s_cmp_lt_u32 s26, 2
  s_cselect_b32 s34, 0, s34
  s_mov_b32 s27, 0
  s_branch pc_30
pw_28:
  buffer_load_dword v203, v201, s[8:11], 0 offen sc1
  s_add_u32 s27, s27, 1
  s_cmp_gt_u32 s27, 65536
  s_cbranch_scc1 role_abort
  s_waitcnt vmcnt(0)
pc_30:
  v_cmp_gt_u32 vcc, s34, v203
  s_nop 0
  s_and_b32 vcc_lo, vcc_lo, 0x7
  s_and_b32 vcc_hi, vcc_hi, 0x0
  s_cmp_eq_u64 vcc, 0
  s_cbranch_scc1 po_29
  s_sleep 4
  s_branch pw_28
po_29:
  s_add_u32 s26, s26, 1
  s_and_b32 s28, s26, 7
  s_mul_i32 s28, s28, 147456
  s_add_u32 s32, s50, s28
  v_mov_b32 v208, s26
  s_add_u32 s30, s33, 4096
  s_add_u32 s45, s32, 4096
  s_add_u32 s46, s32, 8192
  v_mfma_f32_16x16x32_bf16 v[52:55], a[192:195], a[0:3], 0
  v_mfma_f32_16x16x32_bf16 v[56:59], a[216:219], a[0:3], 0
  v_mfma_f32_16x16x32_bf16 v[60:63], a[192:195], a[24:27], 0
  v_mfma_f32_16x16x32_bf16 v[64:67], a[216:219], a[24:27], 0
  buffer_load_dwordx4 v[4:7], v196, s[8:11], s32 offen offset:0 sc1
  v_mfma_f32_16x16x32_bf16 v[52:55], a[196:199], a[4:7], v[52:55]
  v_mfma_f32_16x16x32_bf16 v[56:59], a[220:223], a[4:7], v[56:59]
  v_mfma_f32_16x16x32_bf16 v[60:63], a[196:199], a[28:31], v[60:63]
  v_mfma_f32_16x16x32_bf16 v[64:67], a[220:223], a[28:31], v[64:67]
  buffer_load_dwordx4 v[8:11], v196, s[8:11], s32 offen offset:1024 sc1
  v_mfma_f32_16x16x32_bf16 v[52:55], a[200:203], a[8:11], v[52:55]
  v_mfma_f32_16x16x32_bf16 v[56:59], a[224:227], a[8:11], v[56:59]
  v_mfma_f32_16x16x32_bf16 v[60:63], a[200:203], a[32:35], v[60:63]
  v_mfma_f32_16x16x32_bf16 v[64:67], a[224:227], a[32:35], v[64:67]
  buffer_load_dwordx4 v[12:15], v196, s[8:11], s32 offen offset:2048 sc1
  v_mfma_f32_16x16x32_bf16 v[52:55], a[204:207], a[12:15], v[52:55]
  v_mfma_f32_16x16x32_bf16 v[56:59], a[228:231], a[12:15], v[56:59]
  v_mfma_f32_16x16x32_bf16 v[60:63], a[204:207], a[36:39], v[60:63]
  v_mfma_f32_16x16x32_bf16 v[64:67], a[228:231], a[36:39], v[64:67]
  buffer_load_dwordx4 v[16:19], v196, s[8:11], s32 offen offset:3072 sc1
  v_mfma_f32_16x16x32_bf16 v[52:55], a[208:211], a[16:19], v[52:55]
  v_mfma_f32_16x16x32_bf16 v[56:59], a[232:235], a[16:19], v[56:59]
  v_mfma_f32_16x16x32_bf16 v[60:63], a[208:211], a[40:43], v[60:63]
  v_mfma_f32_16x16x32_bf16 v[64:67], a[232:235], a[40:43], v[64:67]
  buffer_load_dwordx4 v[20:23], v196, s[8:11], s45 offen offset:0 sc1
  v_mfma_f32_16x16x32_bf16 v[52:55], a[212:215], a[20:23], v[52:55]
  v_mfma_f32_16x16x32_bf16 v[56:59], a[236:239], a[20:23], v[56:59]
  v_mfma_f32_16x16x32_bf16 v[60:63], a[212:215], a[44:47], v[60:63]
  v_mfma_f32_16x16x32_bf16 v[64:67], a[236:239], a[44:47], v[64:67]
  buffer_load_dwordx4 v[24:27], v196, s[8:11], s45 offen offset:1024 sc1
  v_mfma_f32_16x16x32_bf16 v[68:71], a[192:195], a[48:51], 0
  v_mfma_f32_16x16x32_bf16 v[72:75], a[216:219], a[48:51], 0
  v_mfma_f32_16x16x32_bf16 v[76:79], a[192:195], a[72:75], 0
  v_mfma_f32_16x16x32_bf16 v[80:83], a[216:219], a[72:75], 0
  buffer_load_dwordx4 v[28:31], v196, s[8:11], s45 offen offset:2048 sc1
  v_mfma_f32_16x16x32_bf16 v[68:71], a[196:199], a[52:55], v[68:71]
  v_cvt_pk_bf16_f32 v84, v52, v53
  v_mfma_f32_16x16x32_bf16 v[72:75], a[220:223], a[52:55], v[72:75]
  v_cvt_pk_bf16_f32 v85, v54, v55
  v_mfma_f32_16x16x32_bf16 v[76:79], a[196:199], a[76:79], v[76:79]
  v_cvt_pk_bf16_f32 v86, v56, v57
  v_mfma_f32_16x16x32_bf16 v[80:83], a[220:223], a[76:79], v[80:83]
  buffer_load_dwordx4 v[32:35], v196, s[8:11], s45 offen offset:3072 sc1
  v_mfma_f32_16x16x32_bf16 v[68:71], a[200:203], a[56:59], v[68:71]
  v_cvt_pk_bf16_f32 v87, v58, v59
  v_mfma_f32_16x16x32_bf16 v[72:75], a[224:227], a[56:59], v[72:75]
  buffer_store_dwordx4 v[84:87], v196, s[8:11], s33 offen offset:0
  v_mfma_f32_16x16x32_bf16 v[76:79], a[200:203], a[80:83], v[76:79]
  ds_write_b128 v214, v[84:87] offset:0
  v_mfma_f32_16x16x32_bf16 v[80:83], a[224:227], a[80:83], v[80:83]
  buffer_load_dwordx4 v[36:39], v196, s[8:11], s46 offen offset:0 sc1
  v_mfma_f32_16x16x32_bf16 v[68:71], a[204:207], a[60:63], v[68:71]
  v_cvt_pk_bf16_f32 v88, v60, v61
  v_mfma_f32_16x16x32_bf16 v[72:75], a[228:231], a[60:63], v[72:75]
  v_cvt_pk_bf16_f32 v89, v62, v63
  v_mfma_f32_16x16x32_bf16 v[76:79], a[204:207], a[84:87], v[76:79]
  v_cvt_pk_bf16_f32 v90, v64, v65
  v_mfma_f32_16x16x32_bf16 v[80:83], a[228:231], a[84:87], v[80:83]
  buffer_load_dwordx4 v[40:43], v196, s[8:11], s46 offen offset:1024 sc1
  v_mfma_f32_16x16x32_bf16 v[68:71], a[208:211], a[64:67], v[68:71]
  v_cvt_pk_bf16_f32 v91, v66, v67
  v_mfma_f32_16x16x32_bf16 v[72:75], a[232:235], a[64:67], v[72:75]
  buffer_store_dwordx4 v[88:91], v196, s[8:11], s33 offen offset:1024
  v_mfma_f32_16x16x32_bf16 v[76:79], a[208:211], a[88:91], v[76:79]
  ds_write_b128 v215, v[88:91] offset:1024
  v_mfma_f32_16x16x32_bf16 v[80:83], a[232:235], a[88:91], v[80:83]
  buffer_load_dwordx4 v[44:47], v196, s[8:11], s46 offen offset:2048 sc1
  v_mfma_f32_16x16x32_bf16 v[68:71], a[212:215], a[68:71], v[68:71]
  v_mfma_f32_16x16x32_bf16 v[72:75], a[236:239], a[68:71], v[72:75]
  v_mfma_f32_16x16x32_bf16 v[76:79], a[212:215], a[92:95], v[76:79]
  v_mfma_f32_16x16x32_bf16 v[80:83], a[236:239], a[92:95], v[80:83]
  buffer_load_dwordx4 v[48:51], v196, s[8:11], s46 offen offset:3072 sc1
  s_waitcnt vmcnt(14)
  s_mov_b64 exec, 1
  buffer_store_dword v208, v200, s[8:11], 0 offen sc1
  s_mov_b64 exec, -1
  v_mfma_f32_16x16x32_bf16 v[52:55], a[192:195], a[96:99], 0
  v_mfma_f32_16x16x32_bf16 v[56:59], a[216:219], a[96:99], 0
  v_mfma_f32_16x16x32_bf16 v[60:63], a[192:195], a[120:123], 0
  v_mfma_f32_16x16x32_bf16 v[64:67], a[216:219], a[120:123], 0
  v_mfma_f32_16x16x32_bf16 v[52:55], a[196:199], a[100:103], v[52:55]
  v_cvt_pk_bf16_f32 v84, v68, v69
  v_mfma_f32_16x16x32_bf16 v[56:59], a[220:223], a[100:103], v[56:59]
  v_cvt_pk_bf16_f32 v85, v70, v71
  v_mfma_f32_16x16x32_bf16 v[60:63], a[196:199], a[124:127], v[60:63]
  v_cvt_pk_bf16_f32 v86, v72, v73
  v_mfma_f32_16x16x32_bf16 v[64:67], a[220:223], a[124:127], v[64:67]
  v_cvt_pk_bf16_f32 v87, v74, v75
  v_mfma_f32_16x16x32_bf16 v[52:55], a[200:203], a[104:107], v[52:55]
  buffer_store_dwordx4 v[84:87], v196, s[8:11], s33 offen offset:2048
  v_mfma_f32_16x16x32_bf16 v[56:59], a[224:227], a[104:107], v[56:59]
  ds_write_b128 v214, v[84:87] offset:2048
  v_mfma_f32_16x16x32_bf16 v[60:63], a[200:203], a[128:131], v[60:63]
  v_cvt_pk_bf16_f32 v88, v76, v77
  v_mfma_f32_16x16x32_bf16 v[64:67], a[224:227], a[128:131], v[64:67]
  v_cvt_pk_bf16_f32 v89, v78, v79
  v_mfma_f32_16x16x32_bf16 v[52:55], a[204:207], a[108:111], v[52:55]
  v_cvt_pk_bf16_f32 v90, v80, v81
  v_mfma_f32_16x16x32_bf16 v[56:59], a[228:231], a[108:111], v[56:59]
  v_cvt_pk_bf16_f32 v91, v82, v83
  v_mfma_f32_16x16x32_bf16 v[60:63], a[204:207], a[132:135], v[60:63]
  buffer_store_dwordx4 v[88:91], v196, s[8:11], s33 offen offset:3072
  v_mfma_f32_16x16x32_bf16 v[64:67], a[228:231], a[132:135], v[64:67]
  ds_write_b128 v215, v[88:91] offset:3072
  v_mfma_f32_16x16x32_bf16 v[52:55], a[208:211], a[112:115], v[52:55]
  v_mfma_f32_16x16x32_bf16 v[56:59], a[232:235], a[112:115], v[56:59]
  v_mfma_f32_16x16x32_bf16 v[60:63], a[208:211], a[136:139], v[60:63]
  v_mfma_f32_16x16x32_bf16 v[64:67], a[232:235], a[136:139], v[64:67]
  v_mfma_f32_16x16x32_bf16 v[52:55], a[212:215], a[116:119], v[52:55]
  v_mfma_f32_16x16x32_bf16 v[56:59], a[236:239], a[116:119], v[56:59]
  v_mfma_f32_16x16x32_bf16 v[60:63], a[212:215], a[140:143], v[60:63]
  v_mfma_f32_16x16x32_bf16 v[64:67], a[236:239], a[140:143], v[64:67]
  v_mfma_f32_16x16x32_bf16 v[68:71], a[192:195], a[144:147], 0
  v_mfma_f32_16x16x32_bf16 v[72:75], a[216:219], a[144:147], 0
  v_mfma_f32_16x16x32_bf16 v[76:79], a[192:195], a[168:171], 0
  v_mfma_f32_16x16x32_bf16 v[80:83], a[216:219], a[168:171], 0
  v_mfma_f32_16x16x32_bf16 v[68:71], a[196:199], a[148:151], v[68:71]
  v_cvt_pk_bf16_f32 v84, v52, v53
  v_mfma_f32_16x16x32_bf16 v[72:75], a[220:223], a[148:151], v[72:75]
  v_cvt_pk_bf16_f32 v85, v54, v55
  v_mfma_f32_16x16x32_bf16 v[76:79], a[196:199], a[172:175], v[76:79]
  v_cvt_pk_bf16_f32 v86, v56, v57
  v_mfma_f32_16x16x32_bf16 v[80:83], a[220:223], a[172:175], v[80:83]
  v_cvt_pk_bf16_f32 v87, v58, v59
  v_mfma_f32_16x16x32_bf16 v[68:71], a[200:203], a[152:155], v[68:71]
  buffer_store_dwordx4 v[84:87], v196, s[8:11], s30 offen offset:0
  v_mfma_f32_16x16x32_bf16 v[72:75], a[224:227], a[152:155], v[72:75]
  ds_write_b128 v214, v[84:87] offset:4096
  v_mfma_f32_16x16x32_bf16 v[76:79], a[200:203], a[176:179], v[76:79]
  v_cvt_pk_bf16_f32 v88, v60, v61
  v_mfma_f32_16x16x32_bf16 v[80:83], a[224:227], a[176:179], v[80:83]
  v_cvt_pk_bf16_f32 v89, v62, v63
  v_mfma_f32_16x16x32_bf16 v[68:71], a[204:207], a[156:159], v[68:71]
  v_cvt_pk_bf16_f32 v90, v64, v65
  v_mfma_f32_16x16x32_bf16 v[72:75], a[228:231], a[156:159], v[72:75]
  v_cvt_pk_bf16_f32 v91, v66, v67
  v_mfma_f32_16x16x32_bf16 v[76:79], a[204:207], a[180:183], v[76:79]
  buffer_store_dwordx4 v[88:91], v196, s[8:11], s30 offen offset:1024
  v_mfma_f32_16x16x32_bf16 v[80:83], a[228:231], a[180:183], v[80:83]
  ds_write_b128 v215, v[88:91] offset:5120
  v_mfma_f32_16x16x32_bf16 v[68:71], a[208:211], a[160:163], v[68:71]
  v_mfma_f32_16x16x32_bf16 v[72:75], a[232:235], a[160:163], v[72:75]
  v_mfma_f32_16x16x32_bf16 v[76:79], a[208:211], a[184:187], v[76:79]
  v_mfma_f32_16x16x32_bf16 v[80:83], a[232:235], a[184:187], v[80:83]
  v_mfma_f32_16x16x32_bf16 v[68:71], a[212:215], a[164:167], v[68:71]
  v_mfma_f32_16x16x32_bf16 v[72:75], a[236:239], a[164:167], v[72:75]
  v_mfma_f32_16x16x32_bf16 v[76:79], a[212:215], a[188:191], v[76:79]
  v_mfma_f32_16x16x32_bf16 v[80:83], a[236:239], a[188:191], v[80:83]
  s_nop 4
  v_cvt_pk_bf16_f32 v84, v68, v69
  v_cvt_pk_bf16_f32 v85, v70, v71
  v_cvt_pk_bf16_f32 v86, v72, v73
  v_cvt_pk_bf16_f32 v87, v74, v75
  buffer_store_dwordx4 v[84:87], v196, s[8:11], s30 offen offset:2048
  ds_write_b128 v214, v[84:87] offset:6144
  v_cvt_pk_bf16_f32 v88, v76, v77
  v_cvt_pk_bf16_f32 v89, v78, v79
  v_cvt_pk_bf16_f32 v90, v80, v81
  v_cvt_pk_bf16_f32 v91, v82, v83
  buffer_store_dwordx4 v[88:91], v196, s[8:11], s30 offen offset:3072
  ds_write_b128 v215, v[88:91] offset:7168
  buffer_load_dword v203, v201, s[8:11], 0 offen sc1
  s_waitcnt vmcnt(0) lgkmcnt(0)
  buffer_store_dword v208, v199, s[8:11], 0 offen
  s_cmp_gt_u32 s26, 4
  s_cbranch_scc1 ua_nb1
  s_cmp_gt_u32 s26, 2
  s_cbranch_scc1 ua_nr1
  s_add_u32 s34, s26, 1
  s_mov_b32 s27, 0
  s_branch pc_33
pw_31:
  buffer_load_dword v203, v201, s[8:11], 0 offen sc1
  s_add_u32 s27, s27, 1
  s_cmp_gt_u32 s27, 65536
  s_cbranch_scc1 role_abort
  s_waitcnt vmcnt(0)
pc_33:
  v_cmp_gt_u32 vcc, s34, v203
  s_nop 0
  s_and_b32 vcc_lo, vcc_lo, 0x7
  s_and_b32 vcc_hi, vcc_hi, 0x0
  s_cmp_eq_u64 vcc, 0
  s_cbranch_scc1 po_32
  s_sleep 2
  s_branch pw_31
po_32:
  s_add_u32 s45, s32, 4096
  s_add_u32 s46, s32, 8192
  buffer_load_dwordx4 v[4:7], v196, s[8:11], s32 offen offset:0 sc1
  buffer_load_dwordx4 v[8:11], v196, s[8:11], s32 offen offset:1024 sc1
  buffer_load_dwordx4 v[12:15], v196, s[8:11], s32 offen offset:2048 sc1
  buffer_load_dwordx4 v[16:19], v196, s[8:11], s32 offen offset:3072 sc1
  buffer_load_dwordx4 v[20:23], v196, s[8:11], s45 offen offset:0 sc1
  buffer_load_dwordx4 v[24:27], v196, s[8:11], s45 offen offset:1024 sc1
  buffer_load_dwordx4 v[28:31], v196, s[8:11], s45 offen offset:2048 sc1
  buffer_load_dwordx4 v[32:35], v196, s[8:11], s45 offen offset:3072 sc1
  buffer_load_dwordx4 v[36:39], v196, s[8:11], s46 offen offset:0 sc1
  buffer_load_dwordx4 v[40:43], v196, s[8:11], s46 offen offset:1024 sc1
  buffer_load_dwordx4 v[44:47], v196, s[8:11], s46 offen offset:2048 sc1
  buffer_load_dwordx4 v[48:51], v196, s[8:11], s46 offen offset:3072 sc1
ua_nr1:
  s_cmp_eq_u32 s26, 4
  s_cbranch_scc0 ua_nb1
  s_barrier
ua_nb1:
  s_branch ua_loop0
ua_end:
  s_endpgm
role_sm:
  s_sub_u32 s20, s18, 26
  s_lshl_b32 s20, s20, 2
  s_add_u32 s20, s20, s17
  s_load_dwordx2 s[24:25], s[0:1], 8
  s_mov_b32 s26, 10240
  s_mov_b32 s27, 0x00020000
  v_lshlrev_b32 v2, 4, v1
  v_lshlrev_b32 v3, 7, v1
  v_mov_b32 v4, -1
  v_mov_b32 v5, -1
  v_mov_b32 v6, -1
  v_mov_b32 v7, -1
  v_mov_b32 v8, 0
  v_mov_b32 v9, 0
  v_mov_b32 v10, 0
  v_mov_b32 v11, 0
  v_lshrrev_b32 v12, 4, v1
  v_and_b32 v13, 15, v1
  v_lshlrev_b32 v13, 4, v13
  v_lshl_add_u32 v14, v12, 12, v13
  v_lshl_add_u32 v15, v12, 11, v13
  s_lshl_b32 s28, s16, 8
  s_cmp_lg_u32 s20, 4
  s_cbranch_scc1 boot_nf
  buffer_load_dwordx4 v[40:43], v14, s[8:11], s28 offen sc1
  s_waitcnt vmcnt(0)
  buffer_store_dwordx4 v[8:11], v14, s[8:11], s28 offen
  s_lshl_b32 s30, s16, 2
  s_add_u32 s30, s30, 32
  v_mov_b32 v16, s30
  v_mov_b32 v17, 1
  s_waitcnt vmcnt(0)
  s_mov_b64 exec, 1
  buffer_atomic_add v17, v16, s[12:15], 0 offen
  s_mov_b64 exec, -1
boot_nf:
  s_lshl_b32 s29, s16, 17
  s_lshl_b32 s30, s20, 14
  s_add_u32 s29, s29, s30
  s_add_u32 s29, s29, 393216
  buffer_load_dword v44, v3, s[8:11], s29 offen sc1
  s_add_u32 s30, s29, 8192
  buffer_load_dword v45, v3, s[8:11], s30 offen sc1
  v_bfe_u32 v13, v1, 5, 1
  v_lshlrev_b32 v12, 6, v13
  v_bfe_u32 v13, v1, 4, 1
  v_lshl_add_u32 v12, v13, 4, v12
  v_bfe_u32 v13, v1, 1, 1
  v_lshl_add_u32 v12, v13, 2, v12
  v_bfe_u32 v13, v1, 2, 2
  v_lshlrev_b32 v13, 1, v13
  v_and_b32 v18, 1, v1
  v_add_u32 v13, v13, v18
  v_mul_u32_u24 v13, 1280, v13
  v_add_u32 v12, v12, v13
  s_waitcnt lgkmcnt(0)
  s_mov_b32 s31, s20
  s_lshl_b32 s30, s31, 7
  buffer_load_dword v20, v12, s[24:27], s30 offen
  buffer_load_dword v21, v12, s[24:27], s30 offen offset:32
  buffer_load_dword v22, v12, s[24:27], s30 offen offset:8
  buffer_load_dword v23, v12, s[24:27], s30 offen offset:40
  s_lshl_b32 s31, s31, 10
  s_mul_i32 s30, s16, 10240
  s_add_u32 s32, s31, s30
  s_add_u32 s32, s32, 131072
  s_add_u32 s33, s32, 81920
  buffer_load_dwordx4 v[46:49], v2, s[8:11], s32 offen sc1
  buffer_load_dwordx4 v[50:53], v2, s[8:11], s33 offen sc1
  s_add_u32 s31, s20, 8
  s_min_u32 s31, s31, 9
  s_lshl_b32 s30, s31, 7
  buffer_load_dword v24, v12, s[24:27], s30 offen
  buffer_load_dword v25, v12, s[24:27], s30 offen offset:32
  buffer_load_dword v26, v12, s[24:27], s30 offen offset:8
  buffer_load_dword v27, v12, s[24:27], s30 offen offset:40
  s_lshl_b32 s31, s31, 10
  s_mul_i32 s30, s16, 10240
  s_add_u32 s34, s31, s30
  s_add_u32 s34, s34, 131072
  s_add_u32 s35, s34, 81920
  buffer_load_dwordx4 v[46:49], v2, s[8:11], s34 offen sc1
  buffer_load_dwordx4 v[50:53], v2, s[8:11], s35 offen sc1
  s_waitcnt vmcnt(0)
  buffer_store_dwordx4 v[20:23], v2, s[8:11], s32 offen
  buffer_store_dwordx4 v[4:7], v2, s[8:11], s33 offen
  buffer_store_dwordx4 v[24:27], v2, s[8:11], s34 offen
  buffer_store_dwordx4 v[4:7], v2, s[8:11], s35 offen
  buffer_store_dwordx4 v[4:7], v2, s[8:11], s29 offen offset:0
  buffer_store_dwordx4 v[4:7], v2, s[8:11], s29 offen offset:1024
  buffer_store_dwordx4 v[4:7], v2, s[8:11], s29 offen offset:2048
  buffer_store_dwordx4 v[4:7], v2, s[8:11], s29 offen offset:3072
  s_add_u32 s29, s29, 4096
  buffer_store_dwordx4 v[4:7], v2, s[8:11], s29 offen offset:0
  buffer_store_dwordx4 v[4:7], v2, s[8:11], s29 offen offset:1024
  buffer_store_dwordx4 v[4:7], v2, s[8:11], s29 offen offset:2048
  buffer_store_dwordx4 v[4:7], v2, s[8:11], s29 offen offset:3072
  s_add_u32 s29, s29, 4096
  buffer_store_dwordx4 v[4:7], v2, s[8:11], s29 offen offset:0
  buffer_store_dwordx4 v[4:7], v2, s[8:11], s29 offen offset:1024
  buffer_store_dwordx4 v[4:7], v2, s[8:11], s29 offen offset:2048
  buffer_store_dwordx4 v[4:7], v2, s[8:11], s29 offen offset:3072
  s_add_u32 s29, s29, 4096
  buffer_store_dwordx4 v[4:7], v2, s[8:11], s29 offen offset:0
  buffer_store_dwordx4 v[4:7], v2, s[8:11], s29 offen offset:1024
  buffer_store_dwordx4 v[4:7], v2, s[8:11], s29 offen offset:2048
  buffer_store_dwordx4 v[4:7], v2, s[8:11], s29 offen offset:3072
  s_add_u32 s29, s29, 4096
  s_mul_i32 s30, s20, 81920
  s_add_u32 s30, s30, s28
  s_add_u32 s30, s30, 1441792
  buffer_store_dwordx4 v[4:7], v15, s[8:11], s30 offen sc1
  s_add_u32 s30, s30, 8192
  buffer_store_dwordx4 v[4:7], v15, s[8:11], s30 offen sc1
  s_add_u32 s30, s30, 8192
  buffer_store_dwordx4 v[4:7], v15, s[8:11], s30 offen sc1
  s_add_u32 s30, s30, 8192
  buffer_store_dwordx4 v[4:7], v15, s[8:11], s30 offen sc1
  s_add_u32 s30, s30, 8192
  buffer_store_dwordx4 v[4:7], v15, s[8:11], s30 offen sc1
  s_add_u32 s30, s30, 8192
  buffer_store_dwordx4 v[4:7], v15, s[8:11], s30 offen sc1
  s_add_u32 s30, s30, 8192
  buffer_store_dwordx4 v[4:7], v15, s[8:11], s30 offen sc1
  s_add_u32 s30, s30, 8192
  buffer_store_dwordx4 v[4:7], v15, s[8:11], s30 offen sc1
  s_add_u32 s30, s30, 8192
  buffer_store_dwordx4 v[4:7], v15, s[8:11], s30 offen sc1
  s_add_u32 s30, s30, 8192
  buffer_store_dwordx4 v[4:7], v15, s[8:11], s30 offen sc1
  s_add_u32 s30, s30, 8192
  v_lshrrev_b32 v12, 3, v1
  v_and_b32 v13, 7, v1
  v_lshlrev_b32 v13, 4, v13
  v_lshl_add_u32 v12, v12, 10, v13
  s_lshl_b32 s30, s20, 13
  s_lshl_b32 s31, s16, 7
  s_add_u32 s30, s30, s31
  s_add_u32 s30, s30, 2162688
  buffer_store_dwordx4 v[4:7], v12, s[8:11], s30 offen sc1
  s_waitcnt vmcnt(0)
  s_barrier
  s_cmp_lg_u32 s17, 0
  s_cbranch_scc1 boot_ng
  v_mov_b32 v16, 192
  v_mov_b32 v17, 1
  s_waitcnt vmcnt(0)
  s_mov_b64 exec, 1
  buffer_atomic_add v17, v16, s[12:15], 0 offen sc1
  s_mov_b64 exec, -1
boot_ng:
  s_lshl_b32 s28, s16, 22
  s_lshl_b32 s29, s20, 13
  s_add_u32 s28, s28, s29
  s_add_u32 s28, s28, 67108864
  s_add_u32 s29, s28, 0
  buffer_load_dword v20, v3, s[8:11], s29 offen sc1
  s_add_u32 s29, s28, 2023424
  buffer_load_dword v21, v3, s[8:11], s29 offen sc1
  s_waitcnt vmcnt(2)
  s_add_u32 s29, s28, 147456
  buffer_load_dword v22, v3, s[8:11], s29 offen sc1
  s_add_u32 s29, s28, 1341440
  buffer_load_dword v23, v3, s[8:11], s29 offen sc1
  s_waitcnt vmcnt(2)
  s_add_u32 s29, s28, 344064
  buffer_load_dword v24, v3, s[8:11], s29 offen sc1
  s_add_u32 s29, s28, 376832
  buffer_load_dword v25, v3, s[8:11], s29 offen sc1
  s_waitcnt vmcnt(2)
  s_add_u32 s29, s28, 1634304
  buffer_load_dword v26, v3, s[8:11], s29 offen sc1
  s_add_u32 s29, s28, 1699840
  buffer_load_dword v27, v3, s[8:11], s29 offen sc1
  s_waitcnt vmcnt(2)
  s_add_u32 s29, s28, 1732608
  buffer_load_dword v28, v3, s[8:11], s29 offen sc1
  s_add_u32 s29, s28, 294912
  buffer_load_dword v29, v3, s[8:11], s29 offen sc1
  s_waitcnt vmcnt(2)
  s_add_u32 s29, s28, 1568768
  buffer_load_dword v30, v3, s[8:11], s29 offen sc1
  s_add_u32 s29, s28, 491520
  buffer_load_dword v31, v3, s[8:11], s29 offen sc1
  s_waitcnt vmcnt(2)
  s_add_u32 s29, s28, 524288
  buffer_load_dword v32, v3, s[8:11], s29 offen sc1
  s_add_u32 s29, s28, 1861632
  buffer_load_dword v33, v3, s[8:11], s29 offen sc1
  s_waitcnt vmcnt(2)
  s_add_u32 s29, s28, 1927168
  buffer_load_dword v34, v3, s[8:11], s29 offen sc1
  s_add_u32 s29, s28, 1959936
  buffer_load_dword v35, v3, s[8:11], s29 offen sc1
  s_waitcnt vmcnt(2)
  s_add_u32 s29, s28, 442368
  buffer_load_dword v36, v3, s[8:11], s29 offen sc1
  s_add_u32 s29, s28, 1796096
  buffer_load_dword v37, v3, s[8:11], s29 offen sc1
  s_waitcnt vmcnt(2)
  s_lshr_b32 s21, s20, 1
  s_and_b32 s22, s20, 1
  s_lshl_b32 s23, s16, 2
  s_add_u32 s23, s23, s21
  v_lshlrev_b32 v128, 4, v1
  v_bfe_u32 v135, v1, 2, 2
  v_and_b32 v136, 1, v1
  v_lshl_add_u32 v135, v135, 1, v136
  v_lshrrev_b32 v136, 4, v1
  v_lshl_add_u32 v135, v136, 3, v135
  v_lshlrev_b32 v129, 4, v135
  v_and_b32 v135, 15, v1
  s_lshl_b32 s26, s22, 4
  v_add_u32 v135, s26, v135
  v_lshlrev_b32 v136, 2, v136
  v_sub_u32 v135, v135, v136
  v_mov_b32 v136, 0
  v_mov_b32 v137, 0xf149f2ca
  v_cmp_le_i32 vcc, 0, v135
  s_nop 1
  v_cndmask_b32 v112, v137, v136, vcc
  v_cmp_le_i32 vcc, 1, v135
  s_nop 1
  v_cndmask_b32 v113, v137, v136, vcc
  v_cmp_le_i32 vcc, 2, v135
  s_nop 1
  v_cndmask_b32 v114, v137, v136, vcc
  v_cmp_le_i32 vcc, 3, v135
  s_nop 1
  v_cndmask_b32 v115, v137, v136, vcc
  v_cmp_le_i32 vcc, 16, v135
  s_nop 1
  v_cndmask_b32 v116, v137, v136, vcc
  v_cmp_le_i32 vcc, 17, v135
  s_nop 1
  v_cndmask_b32 v117, v137, v136, vcc
  v_cmp_le_i32 vcc, 18, v135
  s_nop 1
  v_cndmask_b32 v118, v137, v136, vcc
  v_cmp_le_i32 vcc, 19, v135
  s_nop 1
  v_cndmask_b32 v119, v137, v136, vcc
  v_mov_b32 v124, 0x3d93cd3a
  v_mov_b32 v125, 0x3d93cd3a
  s_lshl_b32 s26, s16, 8
  v_lshl_add_u32 v130, v1, 2, s26
  v_add_u32 v131, 4096, v130
  s_mul_i32 s27, s21, 12
  v_add_u32 v130, s27, v130
  s_lshl_b32 s27, s20, 2
  s_add_u32 s26, s26, s27
  s_add_u32 s26, s26, 12288
  v_mov_b32 v132, s26
  s_lshl_b32 s28, s16, 22
  s_add_u32 s28, s28, 67108864
  s_mul_i32 s35, s21, 12288
  s_add_u32 s35, s35, s28
  s_mul_i32 s26, s22, 6144
  s_add_u32 s36, s35, s26
  s_add_u32 s35, s35, 49152
  s_mul_i32 s37, s21, 3072
  s_add_u32 s37, s37, s28
  s_add_u32 s37, s37, 1384448
  s_lshl_b32 s26, s22, 10
  s_add_u32 s28, s28, s26
  s_lshl_b32 s38, s21, 11
  s_add_u32 s38, s38, s28
  s_add_u32 s38, s38, 1396736
  s_lshl_b32 s39, s21, 2
  s_add_u32 s39, s39, s28
  s_add_u32 s39, s39, 1404928
  s_mov_b32 s34, 1
  v_mov_b32 v133, 0
  s_waitcnt vmcnt(0)
  s_lshl_b32 s25, s16, 2
  s_add_u32 s25, s25, 32
  v_mov_b32 v135, s25
  s_mov_b32 s25, 0
  s_mov_b64 exec, 1
gw_34:
  buffer_load_dword v136, v135, s[12:15], 0 offen sc1
  s_add_u32 s25, s25, 1
  s_cmp_gt_u32 s25, 65536
  s_cbranch_scc1 role_abort
  s_waitcnt vmcnt(0)
  v_cmp_gt_u32 vcc, 2, v136
  s_cbranch_vccz gk_35
  s_sleep 8
  s_branch gw_34
gk_35:
  s_mov_b64 exec, -1
sm_loop:
  s_sub_u32 s24, s34, 1
  s_and_b32 s26, s24, 7
  s_mul_i32 s26, s26, 147456
  s_add_u32 s30, s35, s26
  s_add_u32 s29, s36, s26
  s_and_b32 s26, s24, 3
  s_mul_i32 s26, s26, 227328
  s_add_u32 s31, s37, s26
  s_add_u32 s32, s38, s26
  s_add_u32 s33, s39, s26
  s_mov_b32 s25, 0
  s_branch pc_38
pw_36:
  buffer_load_dword v133, v130, s[8:11], 0 offen sc1
  s_add_u32 s25, s25, 1
  s_cmp_gt_u32 s25, 65536
  s_cbranch_scc1 role_abort
  s_waitcnt vmcnt(0)
pc_38:
  v_cmp_gt_u32 vcc, s34, v133
  s_nop 0
  s_and_b32 vcc_lo, vcc_lo, 0x7007
  s_and_b32 vcc_hi, vcc_hi, 0x0
  s_cmp_eq_u64 vcc, 0
  s_cbranch_scc1 po_37
  s_sleep 4
  s_branch pw_36
po_37:
  s_add_u32 s26, s30, 4096
  s_add_u32 s27, s30, 8192
  s_add_u32 s28, s29, 4096
  buffer_load_dwordx4 v[4:7], v128, s[8:11], s29 offen offset:0 sc1
  buffer_load_dwordx4 v[28:31], v128, s[8:11], s30 offen offset:0 sc1
  buffer_load_dwordx4 v[52:55], v128, s[8:11], s26 offen offset:2048 sc1
  buffer_load_dwordx4 v[8:11], v128, s[8:11], s29 offen offset:1024 sc1
  buffer_load_dwordx4 v[32:35], v128, s[8:11], s30 offen offset:1024 sc1
  buffer_load_dwordx4 v[56:59], v128, s[8:11], s26 offen offset:3072 sc1
  buffer_load_dwordx4 v[12:15], v128, s[8:11], s29 offen offset:2048 sc1
  buffer_load_dwordx4 v[36:39], v128, s[8:11], s30 offen offset:2048 sc1
  buffer_load_dwordx4 v[60:63], v128, s[8:11], s27 offen offset:0 sc1
  buffer_load_dwordx4 v[16:19], v128, s[8:11], s29 offen offset:3072 sc1
  buffer_load_dwordx4 v[40:43], v128, s[8:11], s30 offen offset:3072 sc1
  buffer_load_dwordx4 v[64:67], v128, s[8:11], s27 offen offset:1024 sc1
  buffer_load_dwordx4 v[20:23], v128, s[8:11], s28 offen offset:0 sc1
  buffer_load_dwordx4 v[44:47], v128, s[8:11], s26 offen offset:0 sc1
  buffer_load_dwordx4 v[68:71], v128, s[8:11], s27 offen offset:2048 sc1
  buffer_load_dwordx4 v[24:27], v128, s[8:11], s28 offen offset:1024 sc1
  buffer_load_dwordx4 v[48:51], v128, s[8:11], s26 offen offset:1024 sc1
  buffer_load_dwordx4 v[72:75], v128, s[8:11], s27 offen offset:3072 sc1
  buffer_load_dword v133, v130, s[8:11], 0 offen sc1
  s_waitcnt vmcnt(16)
  v_mfma_f32_16x16x32_bf16 v[100:103], v[28:31], v[4:7], 0
  v_mfma_f32_16x16x32_bf16 v[104:107], v[52:55], v[4:7], 0
  s_waitcnt vmcnt(13)
  v_mfma_f32_16x16x32_bf16 v[100:103], v[32:35], v[8:11], v[100:103]
  v_mfma_f32_16x16x32_bf16 v[104:107], v[56:59], v[8:11], v[104:107]
  s_waitcnt vmcnt(10)
  v_mfma_f32_16x16x32_bf16 v[100:103], v[36:39], v[12:15], v[100:103]
  v_mfma_f32_16x16x32_bf16 v[104:107], v[60:63], v[12:15], v[104:107]
  s_waitcnt vmcnt(7)
  v_mfma_f32_16x16x32_bf16 v[100:103], v[40:43], v[16:19], v[100:103]
  v_mfma_f32_16x16x32_bf16 v[104:107], v[64:67], v[16:19], v[104:107]
  s_waitcnt vmcnt(4)
  v_mfma_f32_16x16x32_bf16 v[100:103], v[44:47], v[20:23], v[100:103]
  v_mfma_f32_16x16x32_bf16 v[104:107], v[68:71], v[20:23], v[104:107]
  s_waitcnt vmcnt(1)
  v_mfma_f32_16x16x32_bf16 v[100:103], v[48:51], v[24:27], v[100:103]
  v_mfma_f32_16x16x32_bf16 v[104:107], v[72:75], v[24:27], v[104:107]
  s_nop 6
  v_cvt_pk_bf16_f32 v135, v100, v101
  v_lshlrev_b32 v100, 16, v135
  v_and_b32 v101, 0xffff0000, v135
  v_cvt_pk_bf16_f32 v135, v102, v103
  v_lshlrev_b32 v102, 16, v135
  v_and_b32 v103, 0xffff0000, v135
  v_cvt_pk_bf16_f32 v135, v104, v105
  v_lshlrev_b32 v104, 16, v135
  v_and_b32 v105, 0xffff0000, v135
  v_cvt_pk_bf16_f32 v135, v106, v107
  v_lshlrev_b32 v106, 16, v135
  v_and_b32 v107, 0xffff0000, v135
  v_pk_fma_f32 v[100:101], v[100:101], v[124:125], v[112:113]
  v_cvt_pk_bf16_f32 v135, v100, v101
  v_lshlrev_b32 v100, 16, v135
  v_and_b32 v101, 0xffff0000, v135
  v_pk_fma_f32 v[102:103], v[102:103], v[124:125], v[114:115]
  v_cvt_pk_bf16_f32 v135, v102, v103
  v_lshlrev_b32 v102, 16, v135
  v_and_b32 v103, 0xffff0000, v135
  v_pk_fma_f32 v[104:105], v[104:105], v[124:125], v[116:117]
  v_cvt_pk_bf16_f32 v135, v104, v105
  v_lshlrev_b32 v104, 16, v135
  v_and_b32 v105, 0xffff0000, v135
  v_pk_fma_f32 v[106:107], v[106:107], v[124:125], v[118:119]
  v_cvt_pk_bf16_f32 v135, v106, v107
  v_lshlrev_b32 v106, 16, v135
  v_and_b32 v107, 0xffff0000, v135
  v_max3_f32 v137, v100, v101, v102
  v_max3_f32 v137, v137, v103, v104
  v_max3_f32 v137, v137, v105, v106
  v_max_f32 v137, v137, v107
  s_cmp_eq_u32 s34, 6
  s_cbranch_scc1 sm_boot2
sm_b2r:
  s_mov_b32 s25, 0
pw_39:
  buffer_load_dword v134, v131, s[8:11], 0 offen sc1
  s_add_u32 s25, s25, 1
  s_cmp_gt_u32 s25, 65536
  s_cbranch_scc1 role_abort
  s_waitcnt vmcnt(0)
pc_41:
  v_cmp_gt_u32 vcc, s34, v134
  s_nop 0
  s_and_b32 vcc_lo, vcc_lo, 0xffffffff
  s_and_b32 vcc_hi, vcc_hi, 0xffff
  s_cmp_eq_u64 vcc, 0
  s_cbranch_scc1 po_40
  s_sleep 2
  s_branch pw_39
po_40:
  buffer_load_dwordx4 v[76:79], v129, s[8:11], s31 offen offset:0 sc1
  buffer_load_dwordx4 v[80:83], v129, s[8:11], s31 offen offset:512 sc1
  buffer_load_dwordx4 v[84:87], v129, s[8:11], s31 offen offset:1024 sc1
  buffer_load_dwordx4 v[88:91], v129, s[8:11], s31 offen offset:1536 sc1
  buffer_load_dwordx4 v[92:95], v129, s[8:11], s31 offen offset:2048 sc1
  buffer_load_dwordx4 v[96:99], v129, s[8:11], s31 offen offset:2560 sc1
  s_waitcnt vmcnt(5)
  v_mfma_f32_16x16x32_bf16 v[108:111], v[76:79], v[4:7], 0
  s_waitcnt vmcnt(4)
  v_mfma_f32_16x16x32_bf16 v[108:111], v[80:83], v[8:11], v[108:111]
  s_waitcnt vmcnt(3)
  v_mfma_f32_16x16x32_bf16 v[108:111], v[84:87], v[12:15], v[108:111]
  s_waitcnt vmcnt(2)
  v_mfma_f32_16x16x32_bf16 v[108:111], v[88:91], v[16:19], v[108:111]
  s_waitcnt vmcnt(1)
  v_mfma_f32_16x16x32_bf16 v[108:111], v[92:95], v[20:23], v[108:111]
  s_waitcnt vmcnt(0)
  v_mfma_f32_16x16x32_bf16 v[108:111], v[96:99], v[24:27], v[108:111]
  s_nop 7
  v_cvt_pk_bf16_f32 v135, v108, v109
  v_lshlrev_b32 v108, 16, v135
  v_and_b32 v109, 0xffff0000, v135
  v_pk_mul_f32 v[108:109], v[108:109], v[124:125]
  v_cvt_pk_bf16_f32 v135, v108, v109
  v_lshlrev_b32 v108, 16, v135
  v_and_b32 v109, 0xffff0000, v135
  v_max3_f32 v137, v137, v108, v109
  v_mov_b32 v136, v137
  s_nop 1
  v_permlane16_swap_b32 v137, v136
  v_max_f32 v137, v137, v136
  v_mov_b32 v136, v137
  s_nop 1
  v_permlane32_swap_b32 v137, v136
  v_max_f32 v137, v137, v136
  v_sub_f32 v100, v100, v137
  v_sub_f32 v101, v101, v137
  v_sub_f32 v102, v102, v137
  v_sub_f32 v103, v103, v137
  v_sub_f32 v104, v104, v137
  v_sub_f32 v105, v105, v137
  v_sub_f32 v106, v106, v137
  v_sub_f32 v107, v107, v137
  v_sub_f32 v108, v108, v137
  v_sub_f32 v109, v109, v137
  v_mul_f32 v100, 0x3fb8aa3b, v100
  v_mul_f32 v101, 0x3fb8aa3b, v101
  v_mul_f32 v102, 0x3fb8aa3b, v102
  v_mul_f32 v103, 0x3fb8aa3b, v103
  v_mul_f32 v104, 0x3fb8aa3b, v104
  v_mul_f32 v105, 0x3fb8aa3b, v105
  v_mul_f32 v106, 0x3fb8aa3b, v106
  v_mul_f32 v107, 0x3fb8aa3b, v107
  v_mul_f32 v108, 0x3fb8aa3b, v108
  v_mul_f32 v109, 0x3fb8aa3b, v109
  v_exp_f32 v100, v100
  v_exp_f32 v101, v101
  v_exp_f32 v102, v102
  v_exp_f32 v103, v103
  v_exp_f32 v104, v104
  v_exp_f32 v105, v105
  v_exp_f32 v106, v106
  v_exp_f32 v107, v107
  v_exp_f32 v108, v108
  v_exp_f32 v109, v109
  v_pk_add_f32 v[126:127], v[100:101], v[102:103]
  v_pk_add_f32 v[110:111], v[104:105], v[106:107]
  v_pk_add_f32 v[126:127], v[126:127], v[108:109]
  v_pk_add_f32 v[126:127], v[126:127], v[110:111]
  v_add_f32 v137, v126, v127
  v_mov_b32 v136, v137
  s_nop 1
  v_permlane16_swap_b32 v137, v136
  v_add_f32 v137, v137, v136
  v_mov_b32 v136, v137
  s_nop 1
  v_permlane32_swap_b32 v137, v136
  v_add_f32 v137, v137, v136
  v_rcp_f32 v126, v137
  s_nop 0
  v_mov_b32 v127, v126
  v_pk_mul_f32 v[100:101], v[100:101], v[126:127]
  v_cvt_pk_bf16_f32 v120, v100, v101
  v_pk_mul_f32 v[102:103], v[102:103], v[126:127]
  v_cvt_pk_bf16_f32 v121, v102, v103
  v_pk_mul_f32 v[104:105], v[104:105], v[126:127]
  v_cvt_pk_bf16_f32 v122, v104, v105
  v_pk_mul_f32 v[106:107], v[106:107], v[126:127]
  v_cvt_pk_bf16_f32 v123, v106, v107
  v_pk_mul_f32 v[108:109], v[108:109], v[126:127]
  buffer_store_dwordx4 v[120:123], v128, s[8:11], s32 offen
  v_cvt_pk_bf16_f32 v138, v108, v109
  buffer_store_dword v138, v128, s[8:11], s33 offen
  v_mov_b32 v137, s34
  s_add_u32 s34, s34, 1
  s_waitcnt vmcnt(0)
  buffer_store_dword v137, v132, s[8:11], 0 offen
  s_cmp_le_u32 s34, 64
  s_cbranch_scc1 sm_loop
  s_endpgm
sm_boot2:
  v_mov_b32 v76, -1
  v_mov_b32 v77, -1
  v_mov_b32 v78, -1
  v_mov_b32 v79, -1
  s_lshl_b32 s27, s16, 3
  s_add_u32 s27, s27, s20
  s_lshl_b32 s26, s27, 10
  s_add_u32 s26, s26, 2097152
  buffer_store_dwordx4 v[76:79], v128, s[8:11], s26 offen sc1
  s_mul_i32 s26, s27, 15360
  s_add_u32 s26, s26, 2326528
  buffer_store_dwordx4 v[76:79], v128, s[8:11], s26 offen sc1
  s_add_u32 s26, s26, 1024
  buffer_store_dwordx4 v[76:79], v128, s[8:11], s26 offen sc1
  s_add_u32 s26, s26, 1024
  buffer_store_dwordx4 v[76:79], v128, s[8:11], s26 offen sc1
  s_add_u32 s26, s26, 1024
  buffer_store_dwordx4 v[76:79], v128, s[8:11], s26 offen sc1
  s_add_u32 s26, s26, 1024
  buffer_store_dwordx4 v[76:79], v128, s[8:11], s26 offen sc1
  s_add_u32 s26, s26, 1024
  buffer_store_dwordx4 v[76:79], v128, s[8:11], s26 offen sc1
  s_add_u32 s26, s26, 1024
  buffer_store_dwordx4 v[76:79], v128, s[8:11], s26 offen sc1
  s_add_u32 s26, s26, 1024
  buffer_store_dwordx4 v[76:79], v128, s[8:11], s26 offen sc1
  s_add_u32 s26, s26, 1024
  buffer_store_dwordx4 v[76:79], v128, s[8:11], s26 offen sc1
  s_add_u32 s26, s26, 1024
  buffer_store_dwordx4 v[76:79], v128, s[8:11], s26 offen sc1
  s_add_u32 s26, s26, 1024
  buffer_store_dwordx4 v[76:79], v128, s[8:11], s26 offen sc1
  s_add_u32 s26, s26, 1024
  buffer_store_dwordx4 v[76:79], v128, s[8:11], s26 offen sc1
  s_add_u32 s26, s26, 1024
  buffer_store_dwordx4 v[76:79], v128, s[8:11], s26 offen sc1
  s_add_u32 s26, s26, 1024
  buffer_store_dwordx4 v[76:79], v128, s[8:11], s26 offen sc1
  s_add_u32 s26, s26, 1024
  buffer_store_dwordx4 v[76:79], v128, s[8:11], s26 offen sc1
  s_add_u32 s26, s26, 1024
  v_mov_b32 v135, 196
  v_mov_b32 v136, 1
  s_waitcnt vmcnt(0)
  s_mov_b64 exec, 1
  buffer_atomic_add v136, v135, s[12:15], 0 offen sc1
  s_mov_b64 exec, -1
  s_branch sm_b2r
role_r:
  s_load_dwordx2 s[20:21], s[0:1], 0
  s_mov_b32 s22, 2621440
  s_mov_b32 s23, 0x00020000
  s_load_dwordx2 s[24:25], s[0:1], 112
  s_mov_b32 s26, 2621440
  s_mov_b32 s27, 0x00020000
  s_load_dwordx2 s[28:29], s[0:1], 64
  s_mov_b32 s30, 1280
  s_mov_b32 s31, 0x00020000
  s_load_dwordx2 s[44:45], s[0:1], 96
  s_mov_b32 s46, 1280
  s_mov_b32 s47, 0x00020000
  s_load_dwordx2 s[48:49], s[0:1], 104
  s_mov_b32 s50, 4915200
  s_mov_b32 s51, 0x00020000
  s_sub_u32 s32, s18, 28
  s_sub_u32 s52, 3, s32
  s_lshl_b32 s52, s52, 3
  s_add_u32 s52, s52, s16
  s_lshl_b32 s32, s32, 2
  s_add_u32 s32, s32, s17
  s_mul_i32 s38, s16, 2621440
  s_lshl_b32 s35, s32, 13
  s_add_u32 s35, s35, s38
  s_add_u32 s35, s35, 247463936
  v_lshlrev_b32 v2, 7, v1
  buffer_load_dword v3, v2, s[8:11], s35 offen sc1
  s_waitcnt lgkmcnt(0)
  v_lshlrev_b32 v226, 2, v1
  s_mul_i32 s37, s32, 1280
  buffer_load_dword a0, v226, s[20:23], s37 offen offset:0
  buffer_load_dword a1, v226, s[20:23], s37 offen offset:256
  buffer_load_dword a2, v226, s[20:23], s37 offen offset:512
  buffer_load_dword a3, v226, s[20:23], s37 offen offset:768
  buffer_load_dword a4, v226, s[20:23], s37 offen offset:1024
  s_add_u32 s37, s37, 20480
  buffer_load_dword a5, v226, s[20:23], s37 offen offset:0
  buffer_load_dword a6, v226, s[20:23], s37 offen offset:256
  buffer_load_dword a7, v226, s[20:23], s37 offen offset:512
  buffer_load_dword a8, v226, s[20:23], s37 offen offset:768
  buffer_load_dword a9, v226, s[20:23], s37 offen offset:1024
  s_add_u32 s37, s37, 20480
  buffer_load_dword a10, v226, s[20:23], s37 offen offset:0
  buffer_load_dword a11, v226, s[20:23], s37 offen offset:256
  buffer_load_dword a12, v226, s[20:23], s37 offen offset:512
  buffer_load_dword a13, v226, s[20:23], s37 offen offset:768
  buffer_load_dword a14, v226, s[20:23], s37 offen offset:1024
  s_add_u32 s37, s37, 20480
  buffer_load_dword a15, v226, s[20:23], s37 offen offset:0
  buffer_load_dword a16, v226, s[20:23], s37 offen offset:256
  buffer_load_dword a17, v226, s[20:23], s37 offen offset:512
  buffer_load_dword a18, v226, s[20:23], s37 offen offset:768
  buffer_load_dword a19, v226, s[20:23], s37 offen offset:1024
  s_add_u32 s37, s37, 20480
  buffer_load_dword a20, v226, s[20:23], s37 offen offset:0
  buffer_load_dword a21, v226, s[20:23], s37 offen offset:256
  buffer_load_dword a22, v226, s[20:23], s37 offen offset:512
  buffer_load_dword a23, v226, s[20:23], s37 offen offset:768
  buffer_load_dword a24, v226, s[20:23], s37 offen offset:1024
  s_add_u32 s37, s37, 20480
  buffer_load_dword a25, v226, s[20:23], s37 offen offset:0
  buffer_load_dword a26, v226, s[20:23], s37 offen offset:256
  buffer_load_dword a27, v226, s[20:23], s37 offen offset:512
  buffer_load_dword a28, v226, s[20:23], s37 offen offset:768
  buffer_load_dword a29, v226, s[20:23], s37 offen offset:1024
  s_add_u32 s37, s37, 20480
  s_lshl_b32 s35, s16, 22
  s_lshl_b32 s36, s32, 13
  s_add_u32 s35, s35, s36
  s_add_u32 s35, s35, 68288512
  s_mov_b32 s36, 131072
  s_mov_b32 s53, 227328
  s_cmp_lt_u32 s32, 4
  s_cselect_b32 s36, s36, 4293804032
  s_cselect_b32 s53, s53, 147456
  s_add_u32 s36, s36, s35
  buffer_load_dword a100, v2, s[8:11], s36 offen sc1
  buffer_load_dword a100, v2, s[8:11], s35 offen sc1
  s_add_u32 s35, s35, 227328
  s_add_u32 s36, s36, s53
  buffer_load_dword a100, v2, s[8:11], s36 offen sc1
  buffer_load_dword a100, v2, s[8:11], s35 offen sc1
  s_add_u32 s35, s35, 227328
  s_add_u32 s36, s36, s53
  v_lshlrev_b32 v227, 3, v1
  s_lshl_b32 s35, s16, 8
  s_lshl_b32 s36, s32, 2
  s_add_u32 s35, s35, s36
  s_add_u32 s35, s35, 8192
  v_mov_b32 v228, s35
  v_mov_b32 v230, 0x00003f80
  v_mov_b32 v231, 0x3f800000
  s_mul_i32 s38, s16, 2621440
  s_add_u32 s38, s38, 247463936
  s_lshl_b32 s35, s32, 4
  s_add_u32 s38, s38, s35
  v_lshrrev_b32 v90, 2, v1
  v_and_b32 v91, 3, v1
  v_lshlrev_b32 v91, 2, v91
  v_lshl_add_u32 v46, v90, 8, v91
  v_add_u32 v47, 4096, v46
  v_add_u32 v48, 8192, v46
  v_add_u32 v49, 12288, v46
  v_add_u32 v50, 16384, v46
  s_waitcnt lgkmcnt(0)
  buffer_load_dword v22, v226, s[20:23], s37 offen offset:0
  buffer_load_dword v23, v226, s[20:23], s37 offen offset:256
  buffer_load_dword v24, v226, s[20:23], s37 offen offset:512
  buffer_load_dword v25, v226, s[20:23], s37 offen offset:768
  buffer_load_dword v26, v226, s[20:23], s37 offen offset:1024
  s_waitcnt vmcnt(34)
  v_accvgpr_read_b32 v28, a0
  v_accvgpr_read_b32 v29, a1
  v_accvgpr_read_b32 v30, a2
  v_accvgpr_read_b32 v31, a3
  v_accvgpr_read_b32 v32, a4
  v_lshlrev_b32 v2, 16, v28
  v_and_b32 v3, 0xffff0000, v28
  v_lshlrev_b32 v4, 16, v29
  v_and_b32 v5, 0xffff0000, v29
  v_lshlrev_b32 v6, 16, v30
  v_and_b32 v7, 0xffff0000, v30
  v_lshlrev_b32 v8, 16, v31
  v_and_b32 v9, 0xffff0000, v31
  v_lshlrev_b32 v10, 16, v32
  v_and_b32 v11, 0xffff0000, v32
  v_pk_add_f32 v[86:87], v[2:3], v[4:5]
  v_pk_add_f32 v[88:89], v[6:7], v[8:9]
  v_pk_add_f32 v[86:87], v[86:87], v[10:11]
  v_pk_add_f32 v[86:87], v[86:87], v[88:89]
  v_add_f32 v86, v86, v87
  s_nop 1
  v_add_f32_dpp v86, v86, v86 row_ror:8 row_mask:0xf bank_mask:0xf
  s_nop 1
  v_add_f32_dpp v86, v86, v86 row_ror:4 row_mask:0xf bank_mask:0xf
  s_nop 1
  v_add_f32_dpp v86, v86, v86 row_ror:2 row_mask:0xf bank_mask:0xf
  s_nop 1
  v_add_f32_dpp v86, v86, v86 row_ror:1 row_mask:0xf bank_mask:0xf
  v_mov_b32 v90, v86
  s_nop 1
  v_permlane16_swap_b32 v86, v90
  v_add_f32 v86, v86, v90
  v_mov_b32 v90, v86
  s_nop 1
  v_permlane32_swap_b32 v86, v90
  v_add_f32 v86, v86, v90
  v_mul_f32 v88, 0xbacccccd, v86
  v_mul_f32 v89, 0xbacccccd, v86
  v_pk_add_f32 v[12:13], v[2:3], v[88:89]
  v_pk_add_f32 v[14:15], v[4:5], v[88:89]
  v_pk_add_f32 v[16:17], v[6:7], v[88:89]
  v_pk_add_f32 v[18:19], v[8:9], v[88:89]
  v_pk_add_f32 v[20:21], v[10:11], v[88:89]
  v_pk_mul_f32 v[86:87], v[12:13], v[12:13]
  v_pk_fma_f32 v[86:87], v[14:15], v[14:15], v[86:87]
  v_pk_fma_f32 v[86:87], v[16:17], v[16:17], v[86:87]
  v_pk_fma_f32 v[86:87], v[18:19], v[18:19], v[86:87]
  v_pk_fma_f32 v[86:87], v[20:21], v[20:21], v[86:87]
  v_add_f32 v86, v86, v87
  v_cvt_pk_bf16_f32 v91, v88, v89
  v_lshlrev_b32 v88, 16, v91
  v_and_b32 v89, 0xffff0000, v91
  v_add_f32_dpp v86, v86, v86 row_ror:8 row_mask:0xf bank_mask:0xf
  s_nop 1
  v_add_f32_dpp v86, v86, v86 row_ror:4 row_mask:0xf bank_mask:0xf
  s_nop 1
  v_add_f32_dpp v86, v86, v86 row_ror:2 row_mask:0xf bank_mask:0xf
  s_nop 1
  v_add_f32_dpp v86, v86, v86 row_ror:1 row_mask:0xf bank_mask:0xf
  v_mov_b32 v90, v86
  s_nop 1
  v_permlane16_swap_b32 v86, v90
  v_add_f32 v86, v86, v90
  v_mov_b32 v90, v86
  s_nop 1
  v_permlane32_swap_b32 v86, v90
  v_add_f32 v86, v86, v90
  v_pk_add_f32 v[12:13], v[2:3], v[88:89]
  v_pk_add_f32 v[14:15], v[4:5], v[88:89]
  v_pk_add_f32 v[16:17], v[6:7], v[88:89]
  v_pk_add_f32 v[18:19], v[8:9], v[88:89]
  v_pk_add_f32 v[20:21], v[10:11], v[88:89]
  v_mul_f32 v86, 0x3acccccd, v86
  v_cvt_pk_bf16_f32 v86, v86, v86
  v_lshlrev_b32 v86, 16, v86
  v_add_f32 v86, 0x3727c5ac, v86
  v_cvt_pk_bf16_f32 v86, v86, v86
  v_lshlrev_b32 v86, 16, v86
  v_sqrt_f32 v86, v86
  v_cvt_pk_bf16_f32 v90, v12, v13
  v_lshlrev_b32 v12, 16, v90
  v_and_b32 v13, 0xffff0000, v90
  v_cvt_pk_bf16_f32 v86, v86, v86
  v_lshlrev_b32 v86, 16, v86
  v_rcp_f32 v86, v86
  v_cvt_pk_bf16_f32 v90, v14, v15
  v_lshlrev_b32 v14, 16, v90
  v_and_b32 v15, 0xffff0000, v90
  v_cvt_pk_bf16_f32 v90, v16, v17
  v_lshlrev_b32 v16, 16, v90
  v_and_b32 v17, 0xffff0000, v90
  v_cvt_pk_bf16_f32 v90, v18, v19
  v_lshlrev_b32 v18, 16, v90
  v_and_b32 v19, 0xffff0000, v90
  v_cvt_pk_bf16_f32 v90, v20, v21
  v_lshlrev_b32 v20, 16, v90
  v_and_b32 v21, 0xffff0000, v90
  v_mov_b32 v87, v86
  v_pk_mul_f32 v[12:13], v[12:13], v[86:87]
  v_cvt_pk_bf16_f32 v100, v12, v13
  v_pk_mul_f32 v[14:15], v[14:15], v[86:87]
  v_cvt_pk_bf16_f32 v101, v14, v15
  v_pk_mul_f32 v[16:17], v[16:17], v[86:87]
  v_cvt_pk_bf16_f32 v102, v16, v17
  v_pk_mul_f32 v[18:19], v[18:19], v[86:87]
  v_cvt_pk_bf16_f32 v103, v18, v19
  v_pk_mul_f32 v[20:21], v[20:21], v[86:87]
  v_cvt_pk_bf16_f32 v104, v20, v21
  s_waitcnt vmcnt(29)
  v_accvgpr_read_b32 v28, a5
  v_accvgpr_read_b32 v29, a6
  v_accvgpr_read_b32 v30, a7
  v_accvgpr_read_b32 v31, a8
  v_accvgpr_read_b32 v32, a9
  v_lshlrev_b32 v2, 16, v28
  v_and_b32 v3, 0xffff0000, v28
  v_lshlrev_b32 v4, 16, v29
  v_and_b32 v5, 0xffff0000, v29
  v_lshlrev_b32 v6, 16, v30
  v_and_b32 v7, 0xffff0000, v30
  v_lshlrev_b32 v8, 16, v31
  v_and_b32 v9, 0xffff0000, v31
  v_lshlrev_b32 v10, 16, v32
  v_and_b32 v11, 0xffff0000, v32
  v_pk_add_f32 v[86:87], v[2:3], v[4:5]
  v_pk_add_f32 v[88:89], v[6:7], v[8:9]
  v_pk_add_f32 v[86:87], v[86:87], v[10:11]
  v_pk_add_f32 v[86:87], v[86:87], v[88:89]
  v_add_f32 v86, v86, v87
  s_nop 1
  v_add_f32_dpp v86, v86, v86 row_ror:8 row_mask:0xf bank_mask:0xf
  s_nop 1
  v_add_f32_dpp v86, v86, v86 row_ror:4 row_mask:0xf bank_mask:0xf
  s_nop 1
  v_add_f32_dpp v86, v86, v86 row_ror:2 row_mask:0xf bank_mask:0xf
  s_nop 1
  v_add_f32_dpp v86, v86, v86 row_ror:1 row_mask:0xf bank_mask:0xf
  v_mov_b32 v90, v86
  s_nop 1
  v_permlane16_swap_b32 v86, v90
  v_add_f32 v86, v86, v90
  v_mov_b32 v90, v86
  s_nop 1
  v_permlane32_swap_b32 v86, v90
  v_add_f32 v86, v86, v90
  v_mul_f32 v88, 0xbacccccd, v86
  v_mul_f32 v89, 0xbacccccd, v86
  v_pk_add_f32 v[12:13], v[2:3], v[88:89]
  v_pk_add_f32 v[14:15], v[4:5], v[88:89]
  v_pk_add_f32 v[16:17], v[6:7], v[88:89]
  v_pk_add_f32 v[18:19], v[8:9], v[88:89]
  v_pk_add_f32 v[20:21], v[10:11], v[88:89]
  v_pk_mul_f32 v[86:87], v[12:13], v[12:13]
  v_pk_fma_f32 v[86:87], v[14:15], v[14:15], v[86:87]
  v_pk_fma_f32 v[86:87], v[16:17], v[16:17], v[86:87]
  v_pk_fma_f32 v[86:87], v[18:19], v[18:19], v[86:87]
  v_pk_fma_f32 v[86:87], v[20:21], v[20:21], v[86:87]
  v_add_f32 v86, v86, v87
  v_cvt_pk_bf16_f32 v91, v88, v89
  v_lshlrev_b32 v88, 16, v91
  v_and_b32 v89, 0xffff0000, v91
  v_add_f32_dpp v86, v86, v86 row_ror:8 row_mask:0xf bank_mask:0xf
  s_nop 1
  v_add_f32_dpp v86, v86, v86 row_ror:4 row_mask:0xf bank_mask:0xf
  s_nop 1
  v_add_f32_dpp v86, v86, v86 row_ror:2 row_mask:0xf bank_mask:0xf
  s_nop 1
  v_add_f32_dpp v86, v86, v86 row_ror:1 row_mask:0xf bank_mask:0xf
  v_mov_b32 v90, v86
  s_nop 1
  v_permlane16_swap_b32 v86, v90
  v_add_f32 v86, v86, v90
  v_mov_b32 v90, v86
  s_nop 1
  v_permlane32_swap_b32 v86, v90
  v_add_f32 v86, v86, v90
  v_pk_add_f32 v[12:13], v[2:3], v[88:89]
  v_pk_add_f32 v[14:15], v[4:5], v[88:89]
  v_pk_add_f32 v[16:17], v[6:7], v[88:89]
  v_pk_add_f32 v[18:19], v[8:9], v[88:89]
  v_pk_add_f32 v[20:21], v[10:11], v[88:89]
  v_mul_f32 v86, 0x3acccccd, v86
  v_cvt_pk_bf16_f32 v86, v86, v86
  v_lshlrev_b32 v86, 16, v86
  v_add_f32 v86, 0x3727c5ac, v86
  v_cvt_pk_bf16_f32 v86, v86, v86
  v_lshlrev_b32 v86, 16, v86
  v_sqrt_f32 v86, v86
  v_cvt_pk_bf16_f32 v90, v12, v13
  v_lshlrev_b32 v12, 16, v90
  v_and_b32 v13, 0xffff0000, v90
  v_cvt_pk_bf16_f32 v86, v86, v86
  v_lshlrev_b32 v86, 16, v86
  v_rcp_f32 v86, v86
  v_cvt_pk_bf16_f32 v90, v14, v15
  v_lshlrev_b32 v14, 16, v90
  v_and_b32 v15, 0xffff0000, v90
  v_cvt_pk_bf16_f32 v90, v16, v17
  v_lshlrev_b32 v16, 16, v90
  v_and_b32 v17, 0xffff0000, v90
  v_cvt_pk_bf16_f32 v90, v18, v19
  v_lshlrev_b32 v18, 16, v90
  v_and_b32 v19, 0xffff0000, v90
  v_cvt_pk_bf16_f32 v90, v20, v21
  v_lshlrev_b32 v20, 16, v90
  v_and_b32 v21, 0xffff0000, v90
  v_mov_b32 v87, v86
  v_pk_mul_f32 v[12:13], v[12:13], v[86:87]
  v_cvt_pk_bf16_f32 v105, v12, v13
  v_pk_mul_f32 v[14:15], v[14:15], v[86:87]
  v_cvt_pk_bf16_f32 v106, v14, v15
  v_pk_mul_f32 v[16:17], v[16:17], v[86:87]
  v_cvt_pk_bf16_f32 v107, v16, v17
  v_pk_mul_f32 v[18:19], v[18:19], v[86:87]
  v_cvt_pk_bf16_f32 v108, v18, v19
  v_pk_mul_f32 v[20:21], v[20:21], v[86:87]
  v_cvt_pk_bf16_f32 v109, v20, v21
  s_waitcnt vmcnt(24)
  v_accvgpr_read_b32 v28, a10
  v_accvgpr_read_b32 v29, a11
  v_accvgpr_read_b32 v30, a12
  v_accvgpr_read_b32 v31, a13
  v_accvgpr_read_b32 v32, a14
  v_lshlrev_b32 v2, 16, v28
  v_and_b32 v3, 0xffff0000, v28
  v_lshlrev_b32 v4, 16, v29
  v_and_b32 v5, 0xffff0000, v29
  v_lshlrev_b32 v6, 16, v30
  v_and_b32 v7, 0xffff0000, v30
  v_lshlrev_b32 v8, 16, v31
  v_and_b32 v9, 0xffff0000, v31
  v_lshlrev_b32 v10, 16, v32
  v_and_b32 v11, 0xffff0000, v32
  v_pk_add_f32 v[86:87], v[2:3], v[4:5]
  v_pk_add_f32 v[88:89], v[6:7], v[8:9]
  v_pk_add_f32 v[86:87], v[86:87], v[10:11]
  v_pk_add_f32 v[86:87], v[86:87], v[88:89]
  v_add_f32 v86, v86, v87
  s_nop 1
  v_add_f32_dpp v86, v86, v86 row_ror:8 row_mask:0xf bank_mask:0xf
  s_nop 1
  v_add_f32_dpp v86, v86, v86 row_ror:4 row_mask:0xf bank_mask:0xf
  s_nop 1
  v_add_f32_dpp v86, v86, v86 row_ror:2 row_mask:0xf bank_mask:0xf
  s_nop 1
  v_add_f32_dpp v86, v86, v86 row_ror:1 row_mask:0xf bank_mask:0xf
  v_mov_b32 v90, v86
  s_nop 1
  v_permlane16_swap_b32 v86, v90
  v_add_f32 v86, v86, v90
  v_mov_b32 v90, v86
  s_nop 1
  v_permlane32_swap_b32 v86, v90
  v_add_f32 v86, v86, v90
  v_mul_f32 v88, 0xbacccccd, v86
  v_mul_f32 v89, 0xbacccccd, v86
  v_pk_add_f32 v[12:13], v[2:3], v[88:89]
  v_pk_add_f32 v[14:15], v[4:5], v[88:89]
  v_pk_add_f32 v[16:17], v[6:7], v[88:89]
  v_pk_add_f32 v[18:19], v[8:9], v[88:89]
  v_pk_add_f32 v[20:21], v[10:11], v[88:89]
  v_pk_mul_f32 v[86:87], v[12:13], v[12:13]
  v_pk_fma_f32 v[86:87], v[14:15], v[14:15], v[86:87]
  v_pk_fma_f32 v[86:87], v[16:17], v[16:17], v[86:87]
  v_pk_fma_f32 v[86:87], v[18:19], v[18:19], v[86:87]
  v_pk_fma_f32 v[86:87], v[20:21], v[20:21], v[86:87]
  v_add_f32 v86, v86, v87
  v_cvt_pk_bf16_f32 v91, v88, v89
  v_lshlrev_b32 v88, 16, v91
  v_and_b32 v89, 0xffff0000, v91
  v_add_f32_dpp v86, v86, v86 row_ror:8 row_mask:0xf bank_mask:0xf
  s_nop 1
  v_add_f32_dpp v86, v86, v86 row_ror:4 row_mask:0xf bank_mask:0xf
  s_nop 1
  v_add_f32_dpp v86, v86, v86 row_ror:2 row_mask:0xf bank_mask:0xf
  s_nop 1
  v_add_f32_dpp v86, v86, v86 row_ror:1 row_mask:0xf bank_mask:0xf
  v_mov_b32 v90, v86
  s_nop 1
  v_permlane16_swap_b32 v86, v90
  v_add_f32 v86, v86, v90
  v_mov_b32 v90, v86
  s_nop 1
  v_permlane32_swap_b32 v86, v90
  v_add_f32 v86, v86, v90
  v_pk_add_f32 v[12:13], v[2:3], v[88:89]
  v_pk_add_f32 v[14:15], v[4:5], v[88:89]
  v_pk_add_f32 v[16:17], v[6:7], v[88:89]
  v_pk_add_f32 v[18:19], v[8:9], v[88:89]
  v_pk_add_f32 v[20:21], v[10:11], v[88:89]
  v_mul_f32 v86, 0x3acccccd, v86
  v_cvt_pk_bf16_f32 v86, v86, v86
  v_lshlrev_b32 v86, 16, v86
  v_add_f32 v86, 0x3727c5ac, v86
  v_cvt_pk_bf16_f32 v86, v86, v86
  v_lshlrev_b32 v86, 16, v86
  v_sqrt_f32 v86, v86
  v_cvt_pk_bf16_f32 v90, v12, v13
  v_lshlrev_b32 v12, 16, v90
  v_and_b32 v13, 0xffff0000, v90
  v_cvt_pk_bf16_f32 v86, v86, v86
  v_lshlrev_b32 v86, 16, v86
  v_rcp_f32 v86, v86
  v_cvt_pk_bf16_f32 v90, v14, v15
  v_lshlrev_b32 v14, 16, v90
  v_and_b32 v15, 0xffff0000, v90
  v_cvt_pk_bf16_f32 v90, v16, v17
  v_lshlrev_b32 v16, 16, v90
  v_and_b32 v17, 0xffff0000, v90
  v_cvt_pk_bf16_f32 v90, v18, v19
  v_lshlrev_b32 v18, 16, v90
  v_and_b32 v19, 0xffff0000, v90
  v_cvt_pk_bf16_f32 v90, v20, v21
  v_lshlrev_b32 v20, 16, v90
  v_and_b32 v21, 0xffff0000, v90
  v_mov_b32 v87, v86
  v_pk_mul_f32 v[12:13], v[12:13], v[86:87]
  v_cvt_pk_bf16_f32 v110, v12, v13
  v_pk_mul_f32 v[14:15], v[14:15], v[86:87]
  v_cvt_pk_bf16_f32 v111, v14, v15
  v_pk_mul_f32 v[16:17], v[16:17], v[86:87]
  v_cvt_pk_bf16_f32 v112, v16, v17
  v_pk_mul_f32 v[18:19], v[18:19], v[86:87]
  v_cvt_pk_bf16_f32 v113, v18, v19
  v_pk_mul_f32 v[20:21], v[20:21], v[86:87]
  v_cvt_pk_bf16_f32 v114, v20, v21
  s_waitcnt vmcnt(19)
  v_accvgpr_read_b32 v28, a15
  v_accvgpr_read_b32 v29, a16
  v_accvgpr_read_b32 v30, a17
  v_accvgpr_read_b32 v31, a18
  v_accvgpr_read_b32 v32, a19
  v_lshlrev_b32 v2, 16, v28
  v_and_b32 v3, 0xffff0000, v28
  v_lshlrev_b32 v4, 16, v29
  v_and_b32 v5, 0xffff0000, v29
  v_lshlrev_b32 v6, 16, v30
  v_and_b32 v7, 0xffff0000, v30
  v_lshlrev_b32 v8, 16, v31
  v_and_b32 v9, 0xffff0000, v31
  v_lshlrev_b32 v10, 16, v32
  v_and_b32 v11, 0xffff0000, v32
  v_pk_add_f32 v[86:87], v[2:3], v[4:5]
  v_pk_add_f32 v[88:89], v[6:7], v[8:9]
  v_pk_add_f32 v[86:87], v[86:87], v[10:11]
  v_pk_add_f32 v[86:87], v[86:87], v[88:89]
  v_add_f32 v86, v86, v87
  s_nop 1
  v_add_f32_dpp v86, v86, v86 row_ror:8 row_mask:0xf bank_mask:0xf
  s_nop 1
  v_add_f32_dpp v86, v86, v86 row_ror:4 row_mask:0xf bank_mask:0xf
  s_nop 1
  v_add_f32_dpp v86, v86, v86 row_ror:2 row_mask:0xf bank_mask:0xf
  s_nop 1
  v_add_f32_dpp v86, v86, v86 row_ror:1 row_mask:0xf bank_mask:0xf
  v_mov_b32 v90, v86
  s_nop 1
  v_permlane16_swap_b32 v86, v90
  v_add_f32 v86, v86, v90
  v_mov_b32 v90, v86
  s_nop 1
  v_permlane32_swap_b32 v86, v90
  v_add_f32 v86, v86, v90
  v_mul_f32 v88, 0xbacccccd, v86
  v_mul_f32 v89, 0xbacccccd, v86
  v_pk_add_f32 v[12:13], v[2:3], v[88:89]
  v_pk_add_f32 v[14:15], v[4:5], v[88:89]
  v_pk_add_f32 v[16:17], v[6:7], v[88:89]
  v_pk_add_f32 v[18:19], v[8:9], v[88:89]
  v_pk_add_f32 v[20:21], v[10:11], v[88:89]
  v_pk_mul_f32 v[86:87], v[12:13], v[12:13]
  v_pk_fma_f32 v[86:87], v[14:15], v[14:15], v[86:87]
  v_pk_fma_f32 v[86:87], v[16:17], v[16:17], v[86:87]
  v_pk_fma_f32 v[86:87], v[18:19], v[18:19], v[86:87]
  v_pk_fma_f32 v[86:87], v[20:21], v[20:21], v[86:87]
  v_add_f32 v86, v86, v87
  v_cvt_pk_bf16_f32 v91, v88, v89
  v_lshlrev_b32 v88, 16, v91
  v_and_b32 v89, 0xffff0000, v91
  v_add_f32_dpp v86, v86, v86 row_ror:8 row_mask:0xf bank_mask:0xf
  s_nop 1
  v_add_f32_dpp v86, v86, v86 row_ror:4 row_mask:0xf bank_mask:0xf
  s_nop 1
  v_add_f32_dpp v86, v86, v86 row_ror:2 row_mask:0xf bank_mask:0xf
  s_nop 1
  v_add_f32_dpp v86, v86, v86 row_ror:1 row_mask:0xf bank_mask:0xf
  v_mov_b32 v90, v86
  s_nop 1
  v_permlane16_swap_b32 v86, v90
  v_add_f32 v86, v86, v90
  v_mov_b32 v90, v86
  s_nop 1
  v_permlane32_swap_b32 v86, v90
  v_add_f32 v86, v86, v90
  v_pk_add_f32 v[12:13], v[2:3], v[88:89]
  v_pk_add_f32 v[14:15], v[4:5], v[88:89]
  v_pk_add_f32 v[16:17], v[6:7], v[88:89]
  v_pk_add_f32 v[18:19], v[8:9], v[88:89]
  v_pk_add_f32 v[20:21], v[10:11], v[88:89]
  v_mul_f32 v86, 0x3acccccd, v86
  v_cvt_pk_bf16_f32 v86, v86, v86
  v_lshlrev_b32 v86, 16, v86
  v_add_f32 v86, 0x3727c5ac, v86
  v_cvt_pk_bf16_f32 v86, v86, v86
  v_lshlrev_b32 v86, 16, v86
  v_sqrt_f32 v86, v86
  v_cvt_pk_bf16_f32 v90, v12, v13
  v_lshlrev_b32 v12, 16, v90
  v_and_b32 v13, 0xffff0000, v90
  v_cvt_pk_bf16_f32 v86, v86, v86
  v_lshlrev_b32 v86, 16, v86
  v_rcp_f32 v86, v86
  v_cvt_pk_bf16_f32 v90, v14, v15
  v_lshlrev_b32 v14, 16, v90
  v_and_b32 v15, 0xffff0000, v90
  v_cvt_pk_bf16_f32 v90, v16, v17
  v_lshlrev_b32 v16, 16, v90
  v_and_b32 v17, 0xffff0000, v90
  v_cvt_pk_bf16_f32 v90, v18, v19
  v_lshlrev_b32 v18, 16, v90
  v_and_b32 v19, 0xffff0000, v90
  v_cvt_pk_bf16_f32 v90, v20, v21
  v_lshlrev_b32 v20, 16, v90
  v_and_b32 v21, 0xffff0000, v90
  v_mov_b32 v87, v86
  v_pk_mul_f32 v[12:13], v[12:13], v[86:87]
  v_cvt_pk_bf16_f32 v115, v12, v13
  v_pk_mul_f32 v[14:15], v[14:15], v[86:87]
  v_cvt_pk_bf16_f32 v116, v14, v15
  v_pk_mul_f32 v[16:17], v[16:17], v[86:87]
  v_cvt_pk_bf16_f32 v117, v16, v17
  v_pk_mul_f32 v[18:19], v[18:19], v[86:87]
  v_cvt_pk_bf16_f32 v118, v18, v19
  v_pk_mul_f32 v[20:21], v[20:21], v[86:87]
  v_cvt_pk_bf16_f32 v119, v20, v21
  s_waitcnt vmcnt(14)
  v_accvgpr_read_b32 v28, a20
  v_accvgpr_read_b32 v29, a21
  v_accvgpr_read_b32 v30, a22
  v_accvgpr_read_b32 v31, a23
  v_accvgpr_read_b32 v32, a24
  v_lshlrev_b32 v2, 16, v28
  v_and_b32 v3, 0xffff0000, v28
  v_lshlrev_b32 v4, 16, v29
  v_and_b32 v5, 0xffff0000, v29
  v_lshlrev_b32 v6, 16, v30
  v_and_b32 v7, 0xffff0000, v30
  v_lshlrev_b32 v8, 16, v31
  v_and_b32 v9, 0xffff0000, v31
  v_lshlrev_b32 v10, 16, v32
  v_and_b32 v11, 0xffff0000, v32
  v_pk_add_f32 v[86:87], v[2:3], v[4:5]
  v_pk_add_f32 v[88:89], v[6:7], v[8:9]
  v_pk_add_f32 v[86:87], v[86:87], v[10:11]
  v_pk_add_f32 v[86:87], v[86:87], v[88:89]
  v_add_f32 v86, v86, v87
  s_nop 1
  v_add_f32_dpp v86, v86, v86 row_ror:8 row_mask:0xf bank_mask:0xf
  s_nop 1
  v_add_f32_dpp v86, v86, v86 row_ror:4 row_mask:0xf bank_mask:0xf
  s_nop 1
  v_add_f32_dpp v86, v86, v86 row_ror:2 row_mask:0xf bank_mask:0xf
  s_nop 1
  v_add_f32_dpp v86, v86, v86 row_ror:1 row_mask:0xf bank_mask:0xf
  v_mov_b32 v90, v86
  s_nop 1
  v_permlane16_swap_b32 v86, v90
  v_add_f32 v86, v86, v90
  v_mov_b32 v90, v86
  s_nop 1
  v_permlane32_swap_b32 v86, v90
  v_add_f32 v86, v86, v90
  v_mul_f32 v88, 0xbacccccd, v86
  v_mul_f32 v89, 0xbacccccd, v86
  v_pk_add_f32 v[12:13], v[2:3], v[88:89]
  v_pk_add_f32 v[14:15], v[4:5], v[88:89]
  v_pk_add_f32 v[16:17], v[6:7], v[88:89]
  v_pk_add_f32 v[18:19], v[8:9], v[88:89]
  v_pk_add_f32 v[20:21], v[10:11], v[88:89]
  v_pk_mul_f32 v[86:87], v[12:13], v[12:13]
  v_pk_fma_f32 v[86:87], v[14:15], v[14:15], v[86:87]
  v_pk_fma_f32 v[86:87], v[16:17], v[16:17], v[86:87]
  v_pk_fma_f32 v[86:87], v[18:19], v[18:19], v[86:87]
  v_pk_fma_f32 v[86:87], v[20:21], v[20:21], v[86:87]
  v_add_f32 v86, v86, v87
  v_cvt_pk_bf16_f32 v91, v88, v89
  v_lshlrev_b32 v88, 16, v91
  v_and_b32 v89, 0xffff0000, v91
  v_add_f32_dpp v86, v86, v86 row_ror:8 row_mask:0xf bank_mask:0xf
  s_nop 1
  v_add_f32_dpp v86, v86, v86 row_ror:4 row_mask:0xf bank_mask:0xf
  s_nop 1
  v_add_f32_dpp v86, v86, v86 row_ror:2 row_mask:0xf bank_mask:0xf
  s_nop 1
  v_add_f32_dpp v86, v86, v86 row_ror:1 row_mask:0xf bank_mask:0xf
  v_mov_b32 v90, v86
  s_nop 1
  v_permlane16_swap_b32 v86, v90
  v_add_f32 v86, v86, v90
  v_mov_b32 v90, v86
  s_nop 1
  v_permlane32_swap_b32 v86, v90
  v_add_f32 v86, v86, v90
  v_pk_add_f32 v[12:13], v[2:3], v[88:89]
  v_pk_add_f32 v[14:15], v[4:5], v[88:89]
  v_pk_add_f32 v[16:17], v[6:7], v[88:89]
  v_pk_add_f32 v[18:19], v[8:9], v[88:89]
  v_pk_add_f32 v[20:21], v[10:11], v[88:89]
  v_mul_f32 v86, 0x3acccccd, v86
  v_cvt_pk_bf16_f32 v86, v86, v86
  v_lshlrev_b32 v86, 16, v86
  v_add_f32 v86, 0x3727c5ac, v86
  v_cvt_pk_bf16_f32 v86, v86, v86
  v_lshlrev_b32 v86, 16, v86
  v_sqrt_f32 v86, v86
  v_cvt_pk_bf16_f32 v90, v12, v13
  v_lshlrev_b32 v12, 16, v90
  v_and_b32 v13, 0xffff0000, v90
  v_cvt_pk_bf16_f32 v86, v86, v86
  v_lshlrev_b32 v86, 16, v86
  v_rcp_f32 v86, v86
  v_cvt_pk_bf16_f32 v90, v14, v15
  v_lshlrev_b32 v14, 16, v90
  v_and_b32 v15, 0xffff0000, v90
  v_cvt_pk_bf16_f32 v90, v16, v17
  v_lshlrev_b32 v16, 16, v90
  v_and_b32 v17, 0xffff0000, v90
  v_cvt_pk_bf16_f32 v90, v18, v19
  v_lshlrev_b32 v18, 16, v90
  v_and_b32 v19, 0xffff0000, v90
  v_cvt_pk_bf16_f32 v90, v20, v21
  v_lshlrev_b32 v20, 16, v90
  v_and_b32 v21, 0xffff0000, v90
  v_mov_b32 v87, v86
  v_pk_mul_f32 v[12:13], v[12:13], v[86:87]
  v_cvt_pk_bf16_f32 v120, v12, v13
  v_pk_mul_f32 v[14:15], v[14:15], v[86:87]
  v_cvt_pk_bf16_f32 v121, v14, v15
  v_pk_mul_f32 v[16:17], v[16:17], v[86:87]
  v_cvt_pk_bf16_f32 v122, v16, v17
  v_pk_mul_f32 v[18:19], v[18:19], v[86:87]
  v_cvt_pk_bf16_f32 v123, v18, v19
  v_pk_mul_f32 v[20:21], v[20:21], v[86:87]
  v_cvt_pk_bf16_f32 v124, v20, v21
  s_waitcnt vmcnt(9)
  v_accvgpr_read_b32 v28, a25
  v_accvgpr_read_b32 v29, a26
  v_accvgpr_read_b32 v30, a27
  v_accvgpr_read_b32 v31, a28
  v_accvgpr_read_b32 v32, a29
  v_lshlrev_b32 v2, 16, v28
  v_and_b32 v3, 0xffff0000, v28
  v_lshlrev_b32 v4, 16, v29
  v_and_b32 v5, 0xffff0000, v29
  v_lshlrev_b32 v6, 16, v30
  v_and_b32 v7, 0xffff0000, v30
  v_lshlrev_b32 v8, 16, v31
  v_and_b32 v9, 0xffff0000, v31
  v_lshlrev_b32 v10, 16, v32
  v_and_b32 v11, 0xffff0000, v32
  v_pk_add_f32 v[86:87], v[2:3], v[4:5]
  v_pk_add_f32 v[88:89], v[6:7], v[8:9]
  v_pk_add_f32 v[86:87], v[86:87], v[10:11]
  v_pk_add_f32 v[86:87], v[86:87], v[88:89]
  v_add_f32 v86, v86, v87
  s_nop 1
  v_add_f32_dpp v86, v86, v86 row_ror:8 row_mask:0xf bank_mask:0xf
  s_nop 1
  v_add_f32_dpp v86, v86, v86 row_ror:4 row_mask:0xf bank_mask:0xf
  s_nop 1
  v_add_f32_dpp v86, v86, v86 row_ror:2 row_mask:0xf bank_mask:0xf
  s_nop 1
  v_add_f32_dpp v86, v86, v86 row_ror:1 row_mask:0xf bank_mask:0xf
  v_mov_b32 v90, v86
  s_nop 1
  v_permlane16_swap_b32 v86, v90
  v_add_f32 v86, v86, v90
  v_mov_b32 v90, v86
  s_nop 1
  v_permlane32_swap_b32 v86, v90
  v_add_f32 v86, v86, v90
  v_mul_f32 v88, 0xbacccccd, v86
  v_mul_f32 v89, 0xbacccccd, v86
  v_pk_add_f32 v[12:13], v[2:3], v[88:89]
  v_pk_add_f32 v[14:15], v[4:5], v[88:89]
  v_pk_add_f32 v[16:17], v[6:7], v[88:89]
  v_pk_add_f32 v[18:19], v[8:9], v[88:89]
  v_pk_add_f32 v[20:21], v[10:11], v[88:89]
  v_pk_mul_f32 v[86:87], v[12:13], v[12:13]
  v_pk_fma_f32 v[86:87], v[14:15], v[14:15], v[86:87]
  v_pk_fma_f32 v[86:87], v[16:17], v[16:17], v[86:87]
  v_pk_fma_f32 v[86:87], v[18:19], v[18:19], v[86:87]
  v_pk_fma_f32 v[86:87], v[20:21], v[20:21], v[86:87]
  v_add_f32 v86, v86, v87
  v_cvt_pk_bf16_f32 v91, v88, v89
  v_lshlrev_b32 v88, 16, v91
  v_and_b32 v89, 0xffff0000, v91
  v_add_f32_dpp v86, v86, v86 row_ror:8 row_mask:0xf bank_mask:0xf
  s_nop 1
  v_add_f32_dpp v86, v86, v86 row_ror:4 row_mask:0xf bank_mask:0xf
  s_nop 1
  v_add_f32_dpp v86, v86, v86 row_ror:2 row_mask:0xf bank_mask:0xf
  s_nop 1
  v_add_f32_dpp v86, v86, v86 row_ror:1 row_mask:0xf bank_mask:0xf
  v_mov_b32 v90, v86
  s_nop 1
  v_permlane16_swap_b32 v86, v90
  v_add_f32 v86, v86, v90
  v_mov_b32 v90, v86
  s_nop 1
  v_permlane32_swap_b32 v86, v90
  v_add_f32 v86, v86, v90
  v_pk_add_f32 v[12:13], v[2:3], v[88:89]
  v_pk_add_f32 v[14:15], v[4:5], v[88:89]
  v_pk_add_f32 v[16:17], v[6:7], v[88:89]
  v_pk_add_f32 v[18:19], v[8:9], v[88:89]
  v_pk_add_f32 v[20:21], v[10:11], v[88:89]
  v_mul_f32 v86, 0x3acccccd, v86
  v_cvt_pk_bf16_f32 v86, v86, v86
  v_lshlrev_b32 v86, 16, v86
  v_add_f32 v86, 0x3727c5ac, v86
  v_cvt_pk_bf16_f32 v86, v86, v86
  v_lshlrev_b32 v86, 16, v86
  v_sqrt_f32 v86, v86
  v_cvt_pk_bf16_f32 v90, v12, v13
  v_lshlrev_b32 v12, 16, v90
  v_and_b32 v13, 0xffff0000, v90
  v_cvt_pk_bf16_f32 v86, v86, v86
  v_lshlrev_b32 v86, 16, v86
  v_rcp_f32 v86, v86
  v_cvt_pk_bf16_f32 v90, v14, v15
  v_lshlrev_b32 v14, 16, v90
  v_and_b32 v15, 0xffff0000, v90
  v_cvt_pk_bf16_f32 v90, v16, v17
  v_lshlrev_b32 v16, 16, v90
  v_and_b32 v17, 0xffff0000, v90
  v_cvt_pk_bf16_f32 v90, v18, v19
  v_lshlrev_b32 v18, 16, v90
  v_and_b32 v19, 0xffff0000, v90
  v_cvt_pk_bf16_f32 v90, v20, v21
  v_lshlrev_b32 v20, 16, v90
  v_and_b32 v21, 0xffff0000, v90
  v_mov_b32 v87, v86
  v_pk_mul_f32 v[12:13], v[12:13], v[86:87]
  v_cvt_pk_bf16_f32 v125, v12, v13
  v_pk_mul_f32 v[14:15], v[14:15], v[86:87]
  v_cvt_pk_bf16_f32 v126, v14, v15
  v_pk_mul_f32 v[16:17], v[16:17], v[86:87]
  v_cvt_pk_bf16_f32 v127, v16, v17
  v_pk_mul_f32 v[18:19], v[18:19], v[86:87]
  v_cvt_pk_bf16_f32 v128, v18, v19
  v_pk_mul_f32 v[20:21], v[20:21], v[86:87]
  v_cvt_pk_bf16_f32 v129, v20, v21
  s_cmp_lg_u32 s17, 0
  s_cbranch_scc1 r_g1
  s_cmp_lg_u32 s18, 31
  s_cbranch_scc1 r_g0
  v_mov_b32 v90, 200
  s_mov_b32 s34, 0
gw_42:
  buffer_load_dword v91, v90, s[12:15], 0 offen sc1
  s_add_u32 s34, s34, 1
  s_cmp_gt_u32 s34, 65536
  s_cbranch_scc1 role_abort
  s_waitcnt vmcnt(0)
  v_cmp_gt_u32 vcc, 20, v91
  s_cbranch_vccz gk_43
  s_sleep 4
  s_branch gw_42
gk_43:
  s_lshl_b32 s35, s16, 2
  s_add_u32 s35, s35, 32
  v_mov_b32 v90, s35
  v_mov_b32 v91, 1
  s_waitcnt vmcnt(0)
  s_mov_b64 exec, 1
  buffer_atomic_add v91, v90, s[12:15], 0 offen
  s_mov_b64 exec, -1
r_g0:
  s_lshl_b32 s34, s16, 2
  s_add_u32 s34, s34, 32
  v_mov_b32 v90, s34
  s_mov_b32 s34, 0
  s_mov_b64 exec, 1
gw_44:
  buffer_load_dword v91, v90, s[12:15], 0 offen sc1
  s_add_u32 s34, s34, 1
  s_cmp_gt_u32 s34, 65536
  s_cbranch_scc1 role_abort
  s_waitcnt vmcnt(0)
  v_cmp_gt_u32 vcc, 2, v91
  s_cbranch_vccz gk_45
  s_sleep 2
  s_branch gw_44
gk_45:
  s_mov_b64 exec, -1
r_g1:
  s_barrier
  s_mov_b32 s35, 65536
  buffer_load_dwordx2 v[186:187], v227, s[8:11], s35 offen offset:0 sc1
  buffer_load_dwordx2 v[188:189], v227, s[8:11], s35 offen offset:512 sc1
  buffer_load_dwordx2 v[190:191], v227, s[8:11], s35 offen offset:1024 sc1
  buffer_load_dwordx2 v[192:193], v227, s[8:11], s35 offen offset:1536 sc1
  buffer_load_dwordx2 v[194:195], v227, s[8:11], s35 offen offset:2048 sc1
  s_mov_b32 s35, 68096
  buffer_load_dwordx2 v[176:177], v227, s[8:11], s35 offen offset:0 sc1
  buffer_load_dwordx2 v[178:179], v227, s[8:11], s35 offen offset:512 sc1
  buffer_load_dwordx2 v[180:181], v227, s[8:11], s35 offen offset:1024 sc1
  buffer_load_dwordx2 v[182:183], v227, s[8:11], s35 offen offset:1536 sc1
  buffer_load_dwordx2 v[184:185], v227, s[8:11], s35 offen offset:2048 sc1
  s_waitcnt vmcnt(0)
  v_add_f32 v176, 1.0, v176
  v_add_f32 v177, 1.0, v177
  v_cvt_pk_bf16_f32 v90, v176, v177
  v_lshlrev_b32 v176, 16, v90
  v_and_b32 v177, 0xffff0000, v90
  v_add_f32 v178, 1.0, v178
  v_add_f32 v179, 1.0, v179
  v_cvt_pk_bf16_f32 v90, v178, v179
  v_lshlrev_b32 v178, 16, v90
  v_and_b32 v179, 0xffff0000, v90
  v_add_f32 v180, 1.0, v180
  v_add_f32 v181, 1.0, v181
  v_cvt_pk_bf16_f32 v90, v180, v181
  v_lshlrev_b32 v180, 16, v90
  v_and_b32 v181, 0xffff0000, v90
  v_add_f32 v182, 1.0, v182
  v_add_f32 v183, 1.0, v183
  v_cvt_pk_bf16_f32 v90, v182, v183
  v_lshlrev_b32 v182, 16, v90
  v_and_b32 v183, 0xffff0000, v90
  v_add_f32 v184, 1.0, v184
  v_add_f32 v185, 1.0, v185
  v_cvt_pk_bf16_f32 v90, v184, v185
  v_lshlrev_b32 v184, 16, v90
  v_and_b32 v185, 0xffff0000, v90
  v_lshlrev_b32 v12, 16, v100
  v_and_b32 v13, 0xffff0000, v100
  v_lshlrev_b32 v14, 16, v101
  v_and_b32 v15, 0xffff0000, v101
  v_lshlrev_b32 v16, 16, v102
  v_and_b32 v17, 0xffff0000, v102
  v_lshlrev_b32 v18, 16, v103
  v_and_b32 v19, 0xffff0000, v103
  v_lshlrev_b32 v20, 16, v104
  v_and_b32 v21, 0xffff0000, v104
  v_pk_mul_f32 v[12:13], v[12:13], v[176:177]
  v_cvt_pk_bf16_f32 v90, v12, v13
  v_lshlrev_b32 v12, 16, v90
  v_and_b32 v13, 0xffff0000, v90
  v_pk_mul_f32 v[14:15], v[14:15], v[178:179]
  v_cvt_pk_bf16_f32 v90, v14, v15
  v_lshlrev_b32 v14, 16, v90
  v_and_b32 v15, 0xffff0000, v90
  v_pk_mul_f32 v[16:17], v[16:17], v[180:181]
  v_cvt_pk_bf16_f32 v90, v16, v17
  v_lshlrev_b32 v16, 16, v90
  v_and_b32 v17, 0xffff0000, v90
  v_pk_mul_f32 v[18:19], v[18:19], v[182:183]
  v_cvt_pk_bf16_f32 v90, v18, v19
  v_lshlrev_b32 v18, 16, v90
  v_and_b32 v19, 0xffff0000, v90
  v_pk_mul_f32 v[20:21], v[20:21], v[184:185]
  v_cvt_pk_bf16_f32 v90, v20, v21
  v_lshlrev_b32 v20, 16, v90
  v_and_b32 v21, 0xffff0000, v90
  v_pk_add_f32 v[12:13], v[12:13], v[186:187]
  v_cvt_pk_bf16_f32 v100, v12, v13
  v_pk_add_f32 v[14:15], v[14:15], v[188:189]
  v_cvt_pk_bf16_f32 v101, v14, v15
  v_pk_add_f32 v[16:17], v[16:17], v[190:191]
  v_cvt_pk_bf16_f32 v102, v16, v17
  v_pk_add_f32 v[18:19], v[18:19], v[192:193]
  v_cvt_pk_bf16_f32 v103, v18, v19
  v_pk_add_f32 v[20:21], v[20:21], v[194:195]
  v_cvt_pk_bf16_f32 v104, v20, v21
  buffer_store_dword v100, v46, s[8:11], s38 offen
  buffer_store_dword v101, v47, s[8:11], s38 offen
  buffer_store_dword v102, v48, s[8:11], s38 offen
  buffer_store_dword v103, v49, s[8:11], s38 offen
  buffer_store_dword v104, v50, s[8:11], s38 offen
  s_add_u32 s38, s38, 20480
  v_lshlrev_b32 v12, 16, v105
  v_and_b32 v13, 0xffff0000, v105
  v_lshlrev_b32 v14, 16, v106
  v_and_b32 v15, 0xffff0000, v106
  v_lshlrev_b32 v16, 16, v107
  v_and_b32 v17, 0xffff0000, v107
  v_lshlrev_b32 v18, 16, v108
  v_and_b32 v19, 0xffff0000, v108
  v_lshlrev_b32 v20, 16, v109
  v_and_b32 v21, 0xffff0000, v109
  v_pk_mul_f32 v[12:13], v[12:13], v[176:177]
  v_cvt_pk_bf16_f32 v90, v12, v13
  v_lshlrev_b32 v12, 16, v90
  v_and_b32 v13, 0xffff0000, v90
  v_pk_mul_f32 v[14:15], v[14:15], v[178:179]
  v_cvt_pk_bf16_f32 v90, v14, v15
  v_lshlrev_b32 v14, 16, v90
  v_and_b32 v15, 0xffff0000, v90
  v_pk_mul_f32 v[16:17], v[16:17], v[180:181]
  v_cvt_pk_bf16_f32 v90, v16, v17
  v_lshlrev_b32 v16, 16, v90
  v_and_b32 v17, 0xffff0000, v90
  v_pk_mul_f32 v[18:19], v[18:19], v[182:183]
  v_cvt_pk_bf16_f32 v90, v18, v19
  v_lshlrev_b32 v18, 16, v90
  v_and_b32 v19, 0xffff0000, v90
  v_pk_mul_f32 v[20:21], v[20:21], v[184:185]
  v_cvt_pk_bf16_f32 v90, v20, v21
  v_lshlrev_b32 v20, 16, v90
  v_and_b32 v21, 0xffff0000, v90
  v_pk_add_f32 v[12:13], v[12:13], v[186:187]
  v_cvt_pk_bf16_f32 v105, v12, v13
  v_pk_add_f32 v[14:15], v[14:15], v[188:189]
  v_cvt_pk_bf16_f32 v106, v14, v15
  v_pk_add_f32 v[16:17], v[16:17], v[190:191]
  v_cvt_pk_bf16_f32 v107, v16, v17
  v_pk_add_f32 v[18:19], v[18:19], v[192:193]
  v_cvt_pk_bf16_f32 v108, v18, v19
  v_pk_add_f32 v[20:21], v[20:21], v[194:195]
  v_cvt_pk_bf16_f32 v109, v20, v21
  buffer_store_dword v105, v46, s[8:11], s38 offen
  buffer_store_dword v106, v47, s[8:11], s38 offen
  buffer_store_dword v107, v48, s[8:11], s38 offen
  buffer_store_dword v108, v49, s[8:11], s38 offen
  buffer_store_dword v109, v50, s[8:11], s38 offen
  s_add_u32 s38, s38, 20480
  v_lshlrev_b32 v12, 16, v110
  v_and_b32 v13, 0xffff0000, v110
  v_lshlrev_b32 v14, 16, v111
  v_and_b32 v15, 0xffff0000, v111
  v_lshlrev_b32 v16, 16, v112
  v_and_b32 v17, 0xffff0000, v112
  v_lshlrev_b32 v18, 16, v113
  v_and_b32 v19, 0xffff0000, v113
  v_lshlrev_b32 v20, 16, v114
  v_and_b32 v21, 0xffff0000, v114
  v_pk_mul_f32 v[12:13], v[12:13], v[176:177]
  v_cvt_pk_bf16_f32 v90, v12, v13
  v_lshlrev_b32 v12, 16, v90
  v_and_b32 v13, 0xffff0000, v90
  v_pk_mul_f32 v[14:15], v[14:15], v[178:179]
  v_cvt_pk_bf16_f32 v90, v14, v15
  v_lshlrev_b32 v14, 16, v90
  v_and_b32 v15, 0xffff0000, v90
  v_pk_mul_f32 v[16:17], v[16:17], v[180:181]
  v_cvt_pk_bf16_f32 v90, v16, v17
  v_lshlrev_b32 v16, 16, v90
  v_and_b32 v17, 0xffff0000, v90
  v_pk_mul_f32 v[18:19], v[18:19], v[182:183]
  v_cvt_pk_bf16_f32 v90, v18, v19
  v_lshlrev_b32 v18, 16, v90
  v_and_b32 v19, 0xffff0000, v90
  v_pk_mul_f32 v[20:21], v[20:21], v[184:185]
  v_cvt_pk_bf16_f32 v90, v20, v21
  v_lshlrev_b32 v20, 16, v90
  v_and_b32 v21, 0xffff0000, v90
  v_pk_add_f32 v[12:13], v[12:13], v[186:187]
  v_cvt_pk_bf16_f32 v110, v12, v13
  v_pk_add_f32 v[14:15], v[14:15], v[188:189]
  v_cvt_pk_bf16_f32 v111, v14, v15
  v_pk_add_f32 v[16:17], v[16:17], v[190:191]
  v_cvt_pk_bf16_f32 v112, v16, v17
  v_pk_add_f32 v[18:19], v[18:19], v[192:193]
  v_cvt_pk_bf16_f32 v113, v18, v19
  v_pk_add_f32 v[20:21], v[20:21], v[194:195]
  v_cvt_pk_bf16_f32 v114, v20, v21
  buffer_store_dword v110, v46, s[8:11], s38 offen
  buffer_store_dword v111, v47, s[8:11], s38 offen
  buffer_store_dword v112, v48, s[8:11], s38 offen
  buffer_store_dword v113, v49, s[8:11], s38 offen
  buffer_store_dword v114, v50, s[8:11], s38 offen
  s_add_u32 s38, s38, 20480
  v_mov_b32 v92, 2
  s_waitcnt vmcnt(5)
  buffer_store_dword v92, v228, s[8:11], 0 offen
  v_lshlrev_b32 v12, 16, v115
  v_and_b32 v13, 0xffff0000, v115
  v_lshlrev_b32 v14, 16, v116
  v_and_b32 v15, 0xffff0000, v116
  v_lshlrev_b32 v16, 16, v117
  v_and_b32 v17, 0xffff0000, v117
  v_lshlrev_b32 v18, 16, v118
  v_and_b32 v19, 0xffff0000, v118
  v_lshlrev_b32 v20, 16, v119
  v_and_b32 v21, 0xffff0000, v119
  v_pk_mul_f32 v[12:13], v[12:13], v[176:177]
  v_cvt_pk_bf16_f32 v90, v12, v13
  v_lshlrev_b32 v12, 16, v90
  v_and_b32 v13, 0xffff0000, v90
  v_pk_mul_f32 v[14:15], v[14:15], v[178:179]
  v_cvt_pk_bf16_f32 v90, v14, v15
  v_lshlrev_b32 v14, 16, v90
  v_and_b32 v15, 0xffff0000, v90
  v_pk_mul_f32 v[16:17], v[16:17], v[180:181]
  v_cvt_pk_bf16_f32 v90, v16, v17
  v_lshlrev_b32 v16, 16, v90
  v_and_b32 v17, 0xffff0000, v90
  v_pk_mul_f32 v[18:19], v[18:19], v[182:183]
  v_cvt_pk_bf16_f32 v90, v18, v19
  v_lshlrev_b32 v18, 16, v90
  v_and_b32 v19, 0xffff0000, v90
  v_pk_mul_f32 v[20:21], v[20:21], v[184:185]
  v_cvt_pk_bf16_f32 v90, v20, v21
  v_lshlrev_b32 v20, 16, v90
  v_and_b32 v21, 0xffff0000, v90
  v_pk_add_f32 v[12:13], v[12:13], v[186:187]
  v_cvt_pk_bf16_f32 v115, v12, v13
  v_pk_add_f32 v[14:15], v[14:15], v[188:189]
  v_cvt_pk_bf16_f32 v116, v14, v15
  v_pk_add_f32 v[16:17], v[16:17], v[190:191]
  v_cvt_pk_bf16_f32 v117, v16, v17
  v_pk_add_f32 v[18:19], v[18:19], v[192:193]
  v_cvt_pk_bf16_f32 v118, v18, v19
  v_pk_add_f32 v[20:21], v[20:21], v[194:195]
  v_cvt_pk_bf16_f32 v119, v20, v21
  buffer_store_dword v115, v46, s[8:11], s38 offen
  buffer_store_dword v116, v47, s[8:11], s38 offen
  buffer_store_dword v117, v48, s[8:11], s38 offen
  buffer_store_dword v118, v49, s[8:11], s38 offen
  buffer_store_dword v119, v50, s[8:11], s38 offen
  s_add_u32 s38, s38, 20480
  v_lshlrev_b32 v12, 16, v120
  v_and_b32 v13, 0xffff0000, v120
  v_lshlrev_b32 v14, 16, v121
  v_and_b32 v15, 0xffff0000, v121
  v_lshlrev_b32 v16, 16, v122
  v_and_b32 v17, 0xffff0000, v122
  v_lshlrev_b32 v18, 16, v123
  v_and_b32 v19, 0xffff0000, v123
  v_lshlrev_b32 v20, 16, v124
  v_and_b32 v21, 0xffff0000, v124
  v_pk_mul_f32 v[12:13], v[12:13], v[176:177]
  v_cvt_pk_bf16_f32 v90, v12, v13
  v_lshlrev_b32 v12, 16, v90
  v_and_b32 v13, 0xffff0000, v90
  v_pk_mul_f32 v[14:15], v[14:15], v[178:179]
  v_cvt_pk_bf16_f32 v90, v14, v15
  v_lshlrev_b32 v14, 16, v90
  v_and_b32 v15, 0xffff0000, v90
  v_pk_mul_f32 v[16:17], v[16:17], v[180:181]
  v_cvt_pk_bf16_f32 v90, v16, v17
  v_lshlrev_b32 v16, 16, v90
  v_and_b32 v17, 0xffff0000, v90
  v_pk_mul_f32 v[18:19], v[18:19], v[182:183]
  v_cvt_pk_bf16_f32 v90, v18, v19
  v_lshlrev_b32 v18, 16, v90
  v_and_b32 v19, 0xffff0000, v90
  v_pk_mul_f32 v[20:21], v[20:21], v[184:185]
  v_cvt_pk_bf16_f32 v90, v20, v21
  v_lshlrev_b32 v20, 16, v90
  v_and_b32 v21, 0xffff0000, v90
  v_pk_add_f32 v[12:13], v[12:13], v[186:187]
  v_cvt_pk_bf16_f32 v120, v12, v13
  v_pk_add_f32 v[14:15], v[14:15], v[188:189]
  v_cvt_pk_bf16_f32 v121, v14, v15
  v_pk_add_f32 v[16:17], v[16:17], v[190:191]
  v_cvt_pk_bf16_f32 v122, v16, v17
  v_pk_add_f32 v[18:19], v[18:19], v[192:193]
  v_cvt_pk_bf16_f32 v123, v18, v19
  v_pk_add_f32 v[20:21], v[20:21], v[194:195]
  v_cvt_pk_bf16_f32 v124, v20, v21
  buffer_store_dword v120, v46, s[8:11], s38 offen
  buffer_store_dword v121, v47, s[8:11], s38 offen
  buffer_store_dword v122, v48, s[8:11], s38 offen
  buffer_store_dword v123, v49, s[8:11], s38 offen
  buffer_store_dword v124, v50, s[8:11], s38 offen
  s_add_u32 s38, s38, 20480
  v_mov_b32 v92, 4
  s_waitcnt vmcnt(5)
  buffer_store_dword v92, v228, s[8:11], 0 offen
  v_lshlrev_b32 v12, 16, v125
  v_and_b32 v13, 0xffff0000, v125
  v_lshlrev_b32 v14, 16, v126
  v_and_b32 v15, 0xffff0000, v126
  v_lshlrev_b32 v16, 16, v127
  v_and_b32 v17, 0xffff0000, v127
  v_lshlrev_b32 v18, 16, v128
  v_and_b32 v19, 0xffff0000, v128
  v_lshlrev_b32 v20, 16, v129
  v_and_b32 v21, 0xffff0000, v129
  v_pk_mul_f32 v[12:13], v[12:13], v[176:177]
  v_cvt_pk_bf16_f32 v90, v12, v13
  v_lshlrev_b32 v12, 16, v90
  v_and_b32 v13, 0xffff0000, v90
  v_pk_mul_f32 v[14:15], v[14:15], v[178:179]
  v_cvt_pk_bf16_f32 v90, v14, v15
  v_lshlrev_b32 v14, 16, v90
  v_and_b32 v15, 0xffff0000, v90
  v_pk_mul_f32 v[16:17], v[16:17], v[180:181]
  v_cvt_pk_bf16_f32 v90, v16, v17
  v_lshlrev_b32 v16, 16, v90
  v_and_b32 v17, 0xffff0000, v90
  v_pk_mul_f32 v[18:19], v[18:19], v[182:183]
  v_cvt_pk_bf16_f32 v90, v18, v19
  v_lshlrev_b32 v18, 16, v90
  v_and_b32 v19, 0xffff0000, v90
  v_pk_mul_f32 v[20:21], v[20:21], v[184:185]
  v_cvt_pk_bf16_f32 v90, v20, v21
  v_lshlrev_b32 v20, 16, v90
  v_and_b32 v21, 0xffff0000, v90
  v_pk_add_f32 v[12:13], v[12:13], v[186:187]
  v_cvt_pk_bf16_f32 v125, v12, v13
  v_pk_add_f32 v[14:15], v[14:15], v[188:189]
  v_cvt_pk_bf16_f32 v126, v14, v15
  v_pk_add_f32 v[16:17], v[16:17], v[190:191]
  v_cvt_pk_bf16_f32 v127, v16, v17
  v_pk_add_f32 v[18:19], v[18:19], v[192:193]
  v_cvt_pk_bf16_f32 v128, v18, v19
  v_pk_add_f32 v[20:21], v[20:21], v[194:195]
  v_cvt_pk_bf16_f32 v129, v20, v21
  buffer_store_dword v125, v46, s[8:11], s38 offen
  buffer_store_dword v126, v47, s[8:11], s38 offen
  buffer_store_dword v127, v48, s[8:11], s38 offen
  buffer_store_dword v128, v49, s[8:11], s38 offen
  buffer_store_dword v129, v50, s[8:11], s38 offen
  s_add_u32 s38, s38, 20480
  s_mov_b32 s33, 6
r_ln1:
  s_waitcnt vmcnt(6)
  v_lshlrev_b32 v2, 16, v22
  v_and_b32 v3, 0xffff0000, v22
  v_lshlrev_b32 v4, 16, v23
  v_and_b32 v5, 0xffff0000, v23
  v_lshlrev_b32 v6, 16, v24
  v_and_b32 v7, 0xffff0000, v24
  v_lshlrev_b32 v8, 16, v25
  v_and_b32 v9, 0xffff0000, v25
  v_lshlrev_b32 v10, 16, v26
  v_and_b32 v11, 0xffff0000, v26
  s_add_u32 s37, s37, 20480
  s_min_u32 s37, s37, 2620160
  buffer_load_dword v22, v226, s[20:23], s37 offen offset:0
  buffer_load_dword v23, v226, s[20:23], s37 offen offset:256
  buffer_load_dword v24, v226, s[20:23], s37 offen offset:512
  buffer_load_dword v25, v226, s[20:23], s37 offen offset:768
  buffer_load_dword v26, v226, s[20:23], s37 offen offset:1024
  v_pk_add_f32 v[86:87], v[2:3], v[4:5]
  v_pk_add_f32 v[88:89], v[6:7], v[8:9]
  v_pk_add_f32 v[86:87], v[86:87], v[10:11]
  v_pk_add_f32 v[86:87], v[86:87], v[88:89]
  v_add_f32 v86, v86, v87
  s_nop 1
  v_add_f32_dpp v86, v86, v86 row_ror:8 row_mask:0xf bank_mask:0xf
  s_nop 1
  v_add_f32_dpp v86, v86, v86 row_ror:4 row_mask:0xf bank_mask:0xf
  s_nop 1
  v_add_f32_dpp v86, v86, v86 row_ror:2 row_mask:0xf bank_mask:0xf
  s_nop 1
  v_add_f32_dpp v86, v86, v86 row_ror:1 row_mask:0xf bank_mask:0xf
  v_mov_b32 v90, v86
  s_nop 1
  v_permlane16_swap_b32 v86, v90
  v_add_f32 v86, v86, v90
  v_mov_b32 v90, v86
  s_nop 1
  v_permlane32_swap_b32 v86, v90
  v_add_f32 v86, v86, v90
  v_mul_f32 v88, 0xbacccccd, v86
  v_mul_f32 v89, 0xbacccccd, v86
  v_pk_add_f32 v[12:13], v[2:3], v[88:89]
  v_pk_add_f32 v[14:15], v[4:5], v[88:89]
  v_pk_add_f32 v[16:17], v[6:7], v[88:89]
  v_pk_add_f32 v[18:19], v[8:9], v[88:89]
  v_pk_add_f32 v[20:21], v[10:11], v[88:89]
  v_pk_mul_f32 v[86:87], v[12:13], v[12:13]
  v_pk_fma_f32 v[86:87], v[14:15], v[14:15], v[86:87]
  v_pk_fma_f32 v[86:87], v[16:17], v[16:17], v[86:87]
  v_pk_fma_f32 v[86:87], v[18:19], v[18:19], v[86:87]
  v_pk_fma_f32 v[86:87], v[20:21], v[20:21], v[86:87]
  v_add_f32 v86, v86, v87
  v_cvt_pk_bf16_f32 v91, v88, v89
  v_lshlrev_b32 v88, 16, v91
  v_and_b32 v89, 0xffff0000, v91
  v_add_f32_dpp v86, v86, v86 row_ror:8 row_mask:0xf bank_mask:0xf
  s_nop 1
  v_add_f32_dpp v86, v86, v86 row_ror:4 row_mask:0xf bank_mask:0xf
  s_nop 1
  v_add_f32_dpp v86, v86, v86 row_ror:2 row_mask:0xf bank_mask:0xf
  s_nop 1
  v_add_f32_dpp v86, v86, v86 row_ror:1 row_mask:0xf bank_mask:0xf
  v_mov_b32 v90, v86
  s_nop 1
  v_permlane16_swap_b32 v86, v90
  v_add_f32 v86, v86, v90
  v_mov_b32 v90, v86
  s_nop 1
  v_permlane32_swap_b32 v86, v90
  v_add_f32 v86, v86, v90
  v_pk_add_f32 v[12:13], v[2:3], v[88:89]
  v_pk_add_f32 v[14:15], v[4:5], v[88:89]
  v_pk_add_f32 v[16:17], v[6:7], v[88:89]
  v_pk_add_f32 v[18:19], v[8:9], v[88:89]
  v_pk_add_f32 v[20:21], v[10:11], v[88:89]
  v_mul_f32 v86, 0x3acccccd, v86
  v_cvt_pk_bf16_f32 v86, v86, v86
  v_lshlrev_b32 v86, 16, v86
  v_add_f32 v86, 0x3727c5ac, v86
  v_cvt_pk_bf16_f32 v86, v86, v86
  v_lshlrev_b32 v86, 16, v86
  v_sqrt_f32 v86, v86
  v_cvt_pk_bf16_f32 v90, v12, v13
  v_lshlrev_b32 v12, 16, v90
  v_and_b32 v13, 0xffff0000, v90
  v_cvt_pk_bf16_f32 v86, v86, v86
  v_lshlrev_b32 v86, 16, v86
  v_rcp_f32 v86, v86
  v_cvt_pk_bf16_f32 v90, v14, v15
  v_lshlrev_b32 v14, 16, v90
  v_and_b32 v15, 0xffff0000, v90
  v_cvt_pk_bf16_f32 v90, v16, v17
  v_lshlrev_b32 v16, 16, v90
  v_and_b32 v17, 0xffff0000, v90
  v_cvt_pk_bf16_f32 v90, v18, v19
  v_lshlrev_b32 v18, 16, v90
  v_and_b32 v19, 0xffff0000, v90
  v_cvt_pk_bf16_f32 v90, v20, v21
  v_lshlrev_b32 v20, 16, v90
  v_and_b32 v21, 0xffff0000, v90
  v_mov_b32 v87, v86
  v_pk_mul_f32 v[12:13], v[12:13], v[86:87]
  v_cvt_pk_bf16_f32 v90, v12, v13
  v_lshlrev_b32 v12, 16, v90
  v_and_b32 v13, 0xffff0000, v90
  v_pk_mul_f32 v[14:15], v[14:15], v[86:87]
  v_cvt_pk_bf16_f32 v90, v14, v15
  v_lshlrev_b32 v14, 16, v90
  v_and_b32 v15, 0xffff0000, v90
  v_pk_mul_f32 v[16:17], v[16:17], v[86:87]
  v_cvt_pk_bf16_f32 v90, v16, v17
  v_lshlrev_b32 v16, 16, v90
  v_and_b32 v17, 0xffff0000, v90
  v_pk_mul_f32 v[18:19], v[18:19], v[86:87]
  v_cvt_pk_bf16_f32 v90, v18, v19
  v_lshlrev_b32 v18, 16, v90
  v_and_b32 v19, 0xffff0000, v90
  v_pk_mul_f32 v[20:21], v[20:21], v[86:87]
  v_cvt_pk_bf16_f32 v90, v20, v21
  v_lshlrev_b32 v20, 16, v90
  v_and_b32 v21, 0xffff0000, v90
  v_pk_mul_f32 v[12:13], v[12:13], v[176:177]
  v_cvt_pk_bf16_f32 v90, v12, v13
  v_lshlrev_b32 v12, 16, v90
  v_and_b32 v13, 0xffff0000, v90
  v_pk_mul_f32 v[14:15], v[14:15], v[178:179]
  v_cvt_pk_bf16_f32 v90, v14, v15
  v_lshlrev_b32 v14, 16, v90
  v_and_b32 v15, 0xffff0000, v90
  v_pk_mul_f32 v[16:17], v[16:17], v[180:181]
  v_cvt_pk_bf16_f32 v90, v16, v17
  v_lshlrev_b32 v16, 16, v90
  v_and_b32 v17, 0xffff0000, v90
  v_pk_mul_f32 v[18:19], v[18:19], v[182:183]
  v_cvt_pk_bf16_f32 v90, v18, v19
  v_lshlrev_b32 v18, 16, v90
  v_and_b32 v19, 0xffff0000, v90
  v_pk_mul_f32 v[20:21], v[20:21], v[184:185]
  v_cvt_pk_bf16_f32 v90, v20, v21
  v_lshlrev_b32 v20, 16, v90
  v_and_b32 v21, 0xffff0000, v90
  v_pk_add_f32 v[12:13], v[12:13], v[186:187]
  v_cvt_pk_bf16_f32 v28, v12, v13
  v_pk_add_f32 v[14:15], v[14:15], v[188:189]
  v_cvt_pk_bf16_f32 v29, v14, v15
  v_pk_add_f32 v[16:17], v[16:17], v[190:191]
  v_cvt_pk_bf16_f32 v30, v16, v17
  v_pk_add_f32 v[18:19], v[18:19], v[192:193]
  v_cvt_pk_bf16_f32 v31, v18, v19
  v_pk_add_f32 v[20:21], v[20:21], v[194:195]
  v_cvt_pk_bf16_f32 v32, v20, v21
  v_mov_b32 v92, s33
  s_waitcnt vmcnt(5)
  buffer_store_dword v92, v228, s[8:11], 0 offen
  buffer_store_dword v28, v46, s[8:11], s38 offen
  buffer_store_dword v29, v47, s[8:11], s38 offen
  buffer_store_dword v30, v48, s[8:11], s38 offen
  buffer_store_dword v31, v49, s[8:11], s38 offen
  buffer_store_dword v32, v50, s[8:11], s38 offen
  s_add_u32 s38, s38, 20480
  s_add_u32 s33, s33, 1
  s_cmp_lt_u32 s33, 128
  s_cbranch_scc1 r_ln1
  v_mov_b32 v92, s33
  s_waitcnt vmcnt(0)
  buffer_store_dword v92, v228, s[8:11], 0 offen
  s_add_u32 s52, s52, 20
r_mod2:
  v_lshlrev_b32 v12, 2, v0
  buffer_load_dword v13, v12, s[44:47], 0 offen
  buffer_load_dword v14, v12, s[44:47], 0 offen offset:1024
  v_lshrrev_b32 v20, 3, v0
  v_and_b32 v21, 7, v0
  v_mul_u32_u24 v22, 153600, v20
  v_lshl_add_u32 v22, v21, 4, v22
  s_lshl_b32 s6, s52, 7
  buffer_load_dwordx4 v[28:31], v22, s[48:51], s6 offen nt
  s_add_u32 s6, s6, 7680
  buffer_load_dwordx4 v[32:35], v22, s[48:51], s6 offen nt
  s_add_u32 s6, s6, 7680
  buffer_load_dwordx4 v[36:39], v22, s[48:51], s6 offen nt
  s_add_u32 s6, s6, 7680
  buffer_load_dwordx4 v[40:43], v22, s[48:51], s6 offen nt
  s_add_u32 s6, s6, 7680
  buffer_load_dwordx4 v[44:47], v22, s[48:51], s6 offen nt
  s_add_u32 s6, s6, 7680
  buffer_load_dwordx4 v[48:51], v22, s[48:51], s6 offen nt
  s_add_u32 s6, s6, 7680
  buffer_load_dwordx4 v[52:55], v22, s[48:51], s6 offen nt
  s_add_u32 s6, s6, 7680
  buffer_load_dwordx4 v[56:59], v22, s[48:51], s6 offen nt
  s_add_u32 s6, s6, 7680
  buffer_load_dwordx4 v[60:63], v22, s[48:51], s6 offen nt
  s_add_u32 s6, s6, 7680
  buffer_load_dwordx4 v[64:67], v22, s[48:51], s6 offen nt
  s_add_u32 s6, s6, 7680
  buffer_load_dwordx4 v[68:71], v22, s[48:51], s6 offen nt
  s_add_u32 s6, s6, 7680
  buffer_load_dwordx4 v[72:75], v22, s[48:51], s6 offen nt
  s_add_u32 s6, s6, 7680
  buffer_load_dwordx4 v[76:79], v22, s[48:51], s6 offen nt
  s_add_u32 s6, s6, 7680
  buffer_load_dwordx4 v[80:83], v22, s[48:51], s6 offen nt
  s_add_u32 s6, s6, 7680
  buffer_load_dwordx4 v[84:87], v22, s[48:51], s6 offen nt
  s_add_u32 s6, s6, 7680
  buffer_load_dwordx4 v[88:91], v22, s[48:51], s6 offen nt
  s_add_u32 s6, s6, 7680
  buffer_load_dwordx4 v[92:95], v22, s[48:51], s6 offen nt
  s_add_u32 s6, s6, 7680
  buffer_load_dwordx4 v[96:99], v22, s[48:51], s6 offen nt
  s_add_u32 s6, s6, 7680
  buffer_load_dwordx4 v[100:103], v22, s[48:51], s6 offen nt
  s_add_u32 s6, s6, 7680
  buffer_load_dwordx4 v[104:107], v22, s[48:51], s6 offen nt
  s_add_u32 s6, s6, 7680
  s_waitcnt vmcnt(20)
  v_lshlrev_b32 v24, 16, v13
  v_and_b32 v25, 0xffff0000, v13
  v_mul_f32 v16, 0xbfb8aa3b, v24
  v_mul_f32 v17, 0xbfb8aa3b, v25
  v_exp_f32 v16, v16
  v_exp_f32 v17, v17
  v_add_f32 v16, 1.0, v16
  v_add_f32 v17, 1.0, v17
  v_rcp_f32 v16, v16
  v_rcp_f32 v17, v17
  v_mul_f32 v24, v24, v16
  v_mul_f32 v25, v25, v17
  v_cvt_pk_bf16_f32 v16, v24, v25
  v_lshlrev_b32 v24, 16, v16
  v_and_b32 v25, 0xffff0000, v16
  v_lshlrev_b32 v26, 16, v14
  v_and_b32 v27, 0xffff0000, v14
  v_mul_f32 v16, 0xbfb8aa3b, v26
  v_mul_f32 v17, 0xbfb8aa3b, v27
  v_exp_f32 v16, v16
  v_exp_f32 v17, v17
  v_add_f32 v16, 1.0, v16
  v_add_f32 v17, 1.0, v17
  v_rcp_f32 v16, v16
  v_rcp_f32 v17, v17
  v_mul_f32 v26, v26, v16
  v_mul_f32 v27, v27, v17
  v_cvt_pk_bf16_f32 v16, v26, v27
  v_lshlrev_b32 v26, 16, v16
  v_and_b32 v27, 0xffff0000, v16
  v_lshlrev_b32 v12, 3, v0
  ds_write_b64 v12, v[24:25]
  ds_write_b64 v12, v[26:27] offset:2048
  v_mul_u32_u24 v12, 80, v20
  s_waitcnt lgkmcnt(0)
  s_barrier
  ds_read_b128 v[108:111], v12 offset:0
  ds_read_b128 v[112:115], v12 offset:16
  ds_read_b128 v[116:119], v12 offset:32
  ds_read_b128 v[120:123], v12 offset:48
  ds_read_b128 v[124:127], v12 offset:64
  v_mov_b32 v148, 0
  v_mov_b32 v149, 0
  v_mov_b32 v150, 0
  v_mov_b32 v151, 0
  v_mov_b32 v152, 0
  v_mov_b32 v153, 0
  v_mov_b32 v154, 0
  v_mov_b32 v155, 0
  s_waitcnt lgkmcnt(0)
  v_lshrrev_b32 v128, 16, v108
  v_lshrrev_b32 v129, 16, v109
  v_lshrrev_b32 v130, 16, v110
  v_lshrrev_b32 v131, 16, v111
  v_lshrrev_b32 v132, 16, v112
  v_lshrrev_b32 v133, 16, v113
  v_lshrrev_b32 v134, 16, v114
  v_lshrrev_b32 v135, 16, v115
  v_lshrrev_b32 v136, 16, v116
  v_lshrrev_b32 v137, 16, v117
  v_lshrrev_b32 v138, 16, v118
  v_lshrrev_b32 v139, 16, v119
  v_lshrrev_b32 v140, 16, v120
  v_lshrrev_b32 v141, 16, v121
  v_lshrrev_b32 v142, 16, v122
  v_lshrrev_b32 v143, 16, v123
  v_lshrrev_b32 v144, 16, v124
  v_lshrrev_b32 v145, 16, v125
  v_lshrrev_b32 v146, 16, v126
  v_lshrrev_b32 v147, 16, v127
  s_waitcnt vmcnt(18)
  v_dot2c_f32_bf16 v148, v28, v128
  v_dot2c_f32_bf16 v149, v28, v108
  v_dot2c_f32_bf16 v150, v29, v128
  v_dot2c_f32_bf16 v151, v29, v108
  v_dot2c_f32_bf16 v152, v30, v128
  v_dot2c_f32_bf16 v153, v30, v108
  v_dot2c_f32_bf16 v154, v31, v128
  v_dot2c_f32_bf16 v155, v31, v108
  v_dot2c_f32_bf16 v148, v32, v129
  v_dot2c_f32_bf16 v149, v32, v109
  v_dot2c_f32_bf16 v150, v33, v129
  v_dot2c_f32_bf16 v151, v33, v109
  v_dot2c_f32_bf16 v152, v34, v129
  v_dot2c_f32_bf16 v153, v34, v109
  v_dot2c_f32_bf16 v154, v35, v129
  v_dot2c_f32_bf16 v155, v35, v109
  s_waitcnt vmcnt(16)
  v_dot2c_f32_bf16 v148, v36, v130
  v_dot2c_f32_bf16 v149, v36, v110
  v_dot2c_f32_bf16 v150, v37, v130
  v_dot2c_f32_bf16 v151, v37, v110
  v_dot2c_f32_bf16 v152, v38, v130
  v_dot2c_f32_bf16 v153, v38, v110
  v_dot2c_f32_bf16 v154, v39, v130
  v_dot2c_f32_bf16 v155, v39, v110
  v_dot2c_f32_bf16 v148, v40, v131
  v_dot2c_f32_bf16 v149, v40, v111
  v_dot2c_f32_bf16 v150, v41, v131
  v_dot2c_f32_bf16 v151, v41, v111
  v_dot2c_f32_bf16 v152, v42, v131
  v_dot2c_f32_bf16 v153, v42, v111
  v_dot2c_f32_bf16 v154, v43, v131
  v_dot2c_f32_bf16 v155, v43, v111
  s_waitcnt vmcnt(14)
  v_dot2c_f32_bf16 v148, v44, v132
  v_dot2c_f32_bf16 v149, v44, v112
  v_dot2c_f32_bf16 v150, v45, v132
  v_dot2c_f32_bf16 v151, v45, v112
  v_dot2c_f32_bf16 v152, v46, v132
  v_dot2c_f32_bf16 v153, v46, v112
  v_dot2c_f32_bf16 v154, v47, v132
  v_dot2c_f32_bf16 v155, v47, v112
  v_dot2c_f32_bf16 v148, v48, v133
  v_dot2c_f32_bf16 v149, v48, v113
  v_dot2c_f32_bf16 v150, v49, v133
  v_dot2c_f32_bf16 v151, v49, v113
  v_dot2c_f32_bf16 v152, v50, v133
  v_dot2c_f32_bf16 v153, v50, v113
  v_dot2c_f32_bf16 v154, v51, v133
  v_dot2c_f32_bf16 v155, v51, v113
  s_waitcnt vmcnt(12)
  v_dot2c_f32_bf16 v148, v52, v134
  v_dot2c_f32_bf16 v149, v52, v114
  v_dot2c_f32_bf16 v150, v53, v134
  v_dot2c_f32_bf16 v151, v53, v114
  v_dot2c_f32_bf16 v152, v54, v134
  v_dot2c_f32_bf16 v153, v54, v114
  v_dot2c_f32_bf16 v154, v55, v134
  v_dot2c_f32_bf16 v155, v55, v114
  v_dot2c_f32_bf16 v148, v56, v135
  v_dot2c_f32_bf16 v149, v56, v115
  v_dot2c_f32_bf16 v150, v57, v135
  v_dot2c_f32_bf16 v151, v57, v115
  v_dot2c_f32_bf16 v152, v58, v135
  v_dot2c_f32_bf16 v153, v58, v115
  v_dot2c_f32_bf16 v154, v59, v135
  v_dot2c_f32_bf16 v155, v59, v115
  s_waitcnt vmcnt(10)
  v_dot2c_f32_bf16 v148, v60, v136
  v_dot2c_f32_bf16 v149, v60, v116
  v_dot2c_f32_bf16 v150, v61, v136
  v_dot2c_f32_bf16 v151, v61, v116
  v_dot2c_f32_bf16 v152, v62, v136
  v_dot2c_f32_bf16 v153, v62, v116
  v_dot2c_f32_bf16 v154, v63, v136
  v_dot2c_f32_bf16 v155, v63, v116
  v_dot2c_f32_bf16 v148, v64, v137
  v_dot2c_f32_bf16 v149, v64, v117
  v_dot2c_f32_bf16 v150, v65, v137
  v_dot2c_f32_bf16 v151, v65, v117
  v_dot2c_f32_bf16 v152, v66, v137
  v_dot2c_f32_bf16 v153, v66, v117
  v_dot2c_f32_bf16 v154, v67, v137
  v_dot2c_f32_bf16 v155, v67, v117
  s_waitcnt vmcnt(8)
  v_dot2c_f32_bf16 v148, v68, v138
  v_dot2c_f32_bf16 v149, v68, v118
  v_dot2c_f32_bf16 v150, v69, v138
  v_dot2c_f32_bf16 v151, v69, v118
  v_dot2c_f32_bf16 v152, v70, v138
  v_dot2c_f32_bf16 v153, v70, v118
  v_dot2c_f32_bf16 v154, v71, v138
  v_dot2c_f32_bf16 v155, v71, v118
  v_dot2c_f32_bf16 v148, v72, v139
  v_dot2c_f32_bf16 v149, v72, v119
  v_dot2c_f32_bf16 v150, v73, v139
  v_dot2c_f32_bf16 v151, v73, v119
  v_dot2c_f32_bf16 v152, v74, v139
  v_dot2c_f32_bf16 v153, v74, v119
  v_dot2c_f32_bf16 v154, v75, v139
  v_dot2c_f32_bf16 v155, v75, v119
  s_waitcnt vmcnt(6)
  v_dot2c_f32_bf16 v148, v76, v140
  v_dot2c_f32_bf16 v149, v76, v120
  v_dot2c_f32_bf16 v150, v77, v140
  v_dot2c_f32_bf16 v151, v77, v120
  v_dot2c_f32_bf16 v152, v78, v140
  v_dot2c_f32_bf16 v153, v78, v120
  v_dot2c_f32_bf16 v154, v79, v140
  v_dot2c_f32_bf16 v155, v79, v120
  v_dot2c_f32_bf16 v148, v80, v141
  v_dot2c_f32_bf16 v149, v80, v121
  v_dot2c_f32_bf16 v150, v81, v141
  v_dot2c_f32_bf16 v151, v81, v121
  v_dot2c_f32_bf16 v152, v82, v141
  v_dot2c_f32_bf16 v153, v82, v121
  v_dot2c_f32_bf16 v154, v83, v141
  v_dot2c_f32_bf16 v155, v83, v121
  s_waitcnt vmcnt(4)
  v_dot2c_f32_bf16 v148, v84, v142
  v_dot2c_f32_bf16 v149, v84, v122
  v_dot2c_f32_bf16 v150, v85, v142
  v_dot2c_f32_bf16 v151, v85, v122
  v_dot2c_f32_bf16 v152, v86, v142
  v_dot2c_f32_bf16 v153, v86, v122
  v_dot2c_f32_bf16 v154, v87, v142
  v_dot2c_f32_bf16 v155, v87, v122
  v_dot2c_f32_bf16 v148, v88, v143
  v_dot2c_f32_bf16 v149, v88, v123
  v_dot2c_f32_bf16 v150, v89, v143
  v_dot2c_f32_bf16 v151, v89, v123
  v_dot2c_f32_bf16 v152, v90, v143
  v_dot2c_f32_bf16 v153, v90, v123
  v_dot2c_f32_bf16 v154, v91, v143
  v_dot2c_f32_bf16 v155, v91, v123
  s_waitcnt vmcnt(2)
  v_dot2c_f32_bf16 v148, v92, v144
  v_dot2c_f32_bf16 v149, v92, v124
  v_dot2c_f32_bf16 v150, v93, v144
  v_dot2c_f32_bf16 v151, v93, v124
  v_dot2c_f32_bf16 v152, v94, v144
  v_dot2c_f32_bf16 v153, v94, v124
  v_dot2c_f32_bf16 v154, v95, v144
  v_dot2c_f32_bf16 v155, v95, v124
  v_dot2c_f32_bf16 v148, v96, v145
  v_dot2c_f32_bf16 v149, v96, v125
  v_dot2c_f32_bf16 v150, v97, v145
  v_dot2c_f32_bf16 v151, v97, v125
  v_dot2c_f32_bf16 v152, v98, v145
  v_dot2c_f32_bf16 v153, v98, v125
  v_dot2c_f32_bf16 v154, v99, v145
  v_dot2c_f32_bf16 v155, v99, v125
  s_waitcnt vmcnt(0)
  v_dot2c_f32_bf16 v148, v100, v146
  v_dot2c_f32_bf16 v149, v100, v126
  v_dot2c_f32_bf16 v150, v101, v146
  v_dot2c_f32_bf16 v151, v101, v126
  v_dot2c_f32_bf16 v152, v102, v146
  v_dot2c_f32_bf16 v153, v102, v126
  v_dot2c_f32_bf16 v154, v103, v146
  v_dot2c_f32_bf16 v155, v103, v126
  v_dot2c_f32_bf16 v148, v104, v147
  v_dot2c_f32_bf16 v149, v104, v127
  v_dot2c_f32_bf16 v150, v105, v147
  v_dot2c_f32_bf16 v151, v105, v127
  v_dot2c_f32_bf16 v152, v106, v147
  v_dot2c_f32_bf16 v153, v106, v127
  v_dot2c_f32_bf16 v154, v107, v147
  v_dot2c_f32_bf16 v155, v107, v127
  v_lshlrev_b32 v12, 5, v0
  ds_write_b128 v12, v[148:151] offset:4096
  s_nop 0
  ds_write_b128 v12, v[152:155] offset:4112
  v_lshlrev_b32 v12, 2, v0
  s_waitcnt lgkmcnt(0)
  s_barrier
  s_cmp_lg_u32 s17, 0
  s_cbranch_scc1 mod_endb
  ds_read2st64_b32 v[28:29], v12 offset0:16 offset1:17
  ds_read2st64_b32 v[30:31], v12 offset0:18 offset1:19
  ds_read2st64_b32 v[32:33], v12 offset0:20 offset1:21
  ds_read2st64_b32 v[34:35], v12 offset0:22 offset1:23
  ds_read2st64_b32 v[36:37], v12 offset0:24 offset1:25
  ds_read2st64_b32 v[38:39], v12 offset0:26 offset1:27
  ds_read2st64_b32 v[40:41], v12 offset0:28 offset1:29
  ds_read2st64_b32 v[42:43], v12 offset0:30 offset1:31
  ds_read2st64_b32 v[44:45], v12 offset0:32 offset1:33
  ds_read2st64_b32 v[46:47], v12 offset0:34 offset1:35
  ds_read2st64_b32 v[48:49], v12 offset0:36 offset1:37
  ds_read2st64_b32 v[50:51], v12 offset0:38 offset1:39
  ds_read2st64_b32 v[52:53], v12 offset0:40 offset1:41
  ds_read2st64_b32 v[54:55], v12 offset0:42 offset1:43
  ds_read2st64_b32 v[56:57], v12 offset0:44 offset1:45
  ds_read2st64_b32 v[58:59], v12 offset0:46 offset1:47
  s_waitcnt lgkmcnt(11)
  v_pk_add_f32 v[28:29], v[28:29], v[30:31]
  v_pk_add_f32 v[28:29], v[28:29], v[32:33]
  v_pk_add_f32 v[28:29], v[28:29], v[34:35]
  v_pk_add_f32 v[28:29], v[28:29], v[36:37]
  s_waitcnt lgkmcnt(7)
  v_pk_add_f32 v[28:29], v[28:29], v[38:39]
  v_pk_add_f32 v[28:29], v[28:29], v[40:41]
  v_pk_add_f32 v[28:29], v[28:29], v[42:43]
  v_pk_add_f32 v[28:29], v[28:29], v[44:45]
  s_waitcnt lgkmcnt(3)
  v_pk_add_f32 v[28:29], v[28:29], v[46:47]
  v_pk_add_f32 v[28:29], v[28:29], v[48:49]
  v_pk_add_f32 v[28:29], v[28:29], v[50:51]
  v_pk_add_f32 v[28:29], v[28:29], v[52:53]
  s_waitcnt lgkmcnt(0)
  v_pk_add_f32 v[28:29], v[28:29], v[54:55]
  v_pk_add_f32 v[28:29], v[28:29], v[56:57]
  v_pk_add_f32 v[28:29], v[28:29], v[58:59]
  v_add_f32 v28, v28, v29
  v_cvt_pk_bf16_f32 v28, v28, v28
  v_lshlrev_b32 v28, 16, v28
  s_lshl_b32 s6, s52, 8
  s_add_u32 s6, s6, 65536
  buffer_store_dword v28, v12, s[8:11], s6 offen sc1
  v_mov_b32 v16, 196
  v_mov_b32 v17, 1
  s_waitcnt vmcnt(0)
  s_mov_b64 exec, 1
  buffer_atomic_add v17, v16, s[12:15], 0 offen sc1
  s_mov_b64 exec, -1
mod_endb:
  s_barrier
  s_add_u32 s52, s52, 32
  s_cmp_lt_u32 s52, 60
  s_cbranch_scc1 r_mod2
  v_mov_b32 v233, 0
  v_mov_b32 v234, 0
  v_mov_b32 v235, 0
  v_mov_b32 v236, 0
  v_mov_b32 v237, 0
  s_cmp_eq_u32 s18, 31
  s_cbranch_scc1 r_now
  s_load_dwordx2 s[56:57], s[0:1], 72
  s_mov_b32 s58, 1966080
  s_mov_b32 s59, 0x00020000
  s_load_dwordx2 s[60:61], s[0:1], 80
  s_mov_b32 s62, 1966080
  s_mov_b32 s63, 0x00020000
  s_load_dwordx2 s[64:65], s[0:1], 88
  s_mov_b32 s66, 1966080
  s_mov_b32 s67, 0x00020000
  s_mul_i32 s68, s16, 3
  s_add_u32 s68, s68, s18
  s_sub_u32 s68, s68, 28
  s_mul_i32 s73, s17, 40960
  v_lshrrev_b32 v124, 4, v1
  v_and_b32 v124, 3, v124
  v_lshlrev_b32 v124, 1, v124
  v_and_b32 v4, 7, v1
  v_xor_b32 v4, v4, v124
  v_lshlrev_b32 v4, 4, v4
  v_lshrrev_b32 v124, 3, v1
  v_mul_u32_u24 v124, 0, v124
  v_add_u32 v4, v4, v124
  v_lshrrev_b32 v124, 4, v1
  v_and_b32 v124, 3, v124
  v_lshlrev_b32 v124, 1, v124
  v_and_b32 v5, 7, v1
  v_xor_b32 v5, v5, v124
  v_lshlrev_b32 v5, 4, v5
  v_lshrrev_b32 v124, 3, v1
  v_mul_u32_u24 v124, 1280, v124
  v_add_u32 v5, v5, v124
  v_bfe_u32 v124, v1, 3, 2
  v_bfe_u32 v125, v1, 5, 1
  v_lshl_add_u32 v124, v125, 3, v124
  v_mul_u32_u24 v124, 3072, v124
  v_add_u32 v4, v4, v124
  v_lshrrev_b32 v124, 2, v1
  v_lshrrev_b32 v125, 1, v124
  v_and_b32 v125, 3, v125
  v_lshlrev_b32 v125, 1, v125
  v_bfe_u32 v144, v1, 1, 1
  v_add_u32 v144, 0, v144
  v_xor_b32 v144, v144, v125
  v_lshlrev_b32 v144, 4, v144
  v_lshlrev_b32 v124, 7, v124
  v_add_u32 v144, v144, v124
  v_and_b32 v124, 1, v1
  v_lshlrev_b32 v124, 3, v124
  v_add_u32 v144, v144, v124
  v_add_u32 v144, s73, v144
  v_lshrrev_b32 v124, 2, v1
  v_lshrrev_b32 v125, 1, v124
  v_and_b32 v125, 3, v125
  v_lshlrev_b32 v125, 1, v125
  v_bfe_u32 v145, v1, 1, 1
  v_add_u32 v145, 2, v145
  v_xor_b32 v145, v145, v125
  v_lshlrev_b32 v145, 4, v145
  v_lshlrev_b32 v124, 7, v124
  v_add_u32 v145, v145, v124
  v_and_b32 v124, 1, v1
  v_lshlrev_b32 v124, 3, v124
  v_add_u32 v145, v145, v124
  v_add_u32 v145, s73, v145
  v_lshrrev_b32 v124, 2, v1
  v_lshrrev_b32 v125, 1, v124
  v_and_b32 v125, 3, v125
  v_lshlrev_b32 v125, 1, v125
  v_bfe_u32 v146, v1, 1, 1
  v_add_u32 v146, 4, v146
  v_xor_b32 v146, v146, v125
  v_lshlrev_b32 v146, 4, v146
  v_lshlrev_b32 v124, 7, v124
  v_add_u32 v146, v146, v124
  v_and_b32 v124, 1, v1
  v_lshlrev_b32 v124, 3, v124
  v_add_u32 v146, v146, v124
  v_add_u32 v146, s73, v146
  v_lshrrev_b32 v124, 2, v1
  v_lshrrev_b32 v125, 1, v124
  v_and_b32 v125, 3, v125
  v_lshlrev_b32 v125, 1, v125
  v_bfe_u32 v147, v1, 1, 1
  v_add_u32 v147, 6, v147
  v_xor_b32 v147, v147, v125
  v_lshlrev_b32 v147, 4, v147
  v_lshlrev_b32 v124, 7, v124
  v_add_u32 v147, v147, v124
  v_and_b32 v124, 1, v1
  v_lshlrev_b32 v124, 3, v124
  v_add_u32 v147, v147, v124
  v_add_u32 v147, s73, v147
  s_mul_i32 s72, s17, 491520
  s_lshl_b32 s70, s68, 7
  s_add_u32 s72, s72, s70
  s_waitcnt lgkmcnt(0)
  s_barrier
  s_add_u32 m0, s73, 0
  s_add_u32 s70, s72, 0
  buffer_load_dwordx4 v4, s[56:59], s70 offen nt lds
  s_add_u32 m0, s73, 1024
  s_add_u32 s70, s72, 49152
  buffer_load_dwordx4 v4, s[56:59], s70 offen nt lds
  s_add_u32 m0, s73, 2048
  s_add_u32 s70, s72, 12288
  buffer_load_dwordx4 v4, s[56:59], s70 offen nt lds
  s_add_u32 m0, s73, 3072
  s_add_u32 s70, s72, 61440
  buffer_load_dwordx4 v4, s[56:59], s70 offen nt lds
  s_add_u32 m0, s73, 4096
  s_add_u32 s70, s72, 98304
  buffer_load_dwordx4 v4, s[56:59], s70 offen nt lds
  s_add_u32 m0, s73, 5120
  s_add_u32 s70, s72, 147456
  buffer_load_dwordx4 v4, s[56:59], s70 offen nt lds
  s_add_u32 m0, s73, 6144
  s_add_u32 s70, s72, 110592
  buffer_load_dwordx4 v4, s[56:59], s70 offen nt lds
  s_add_u32 m0, s73, 7168
  s_add_u32 s70, s72, 159744
  buffer_load_dwordx4 v4, s[56:59], s70 offen nt lds
  s_add_u32 m0, s73, 8192
  s_add_u32 s70, s72, 196608
  buffer_load_dwordx4 v4, s[56:59], s70 offen nt lds
  s_add_u32 m0, s73, 9216
  s_add_u32 s70, s72, 245760
  buffer_load_dwordx4 v4, s[56:59], s70 offen nt lds
  s_add_u32 m0, s73, 10240
  s_add_u32 s70, s72, 208896
  buffer_load_dwordx4 v4, s[56:59], s70 offen nt lds
  s_add_u32 m0, s73, 11264
  s_add_u32 s70, s72, 258048
  buffer_load_dwordx4 v4, s[56:59], s70 offen nt lds
  s_add_u32 m0, s73, 12288
  s_add_u32 s70, s72, 294912
  buffer_load_dwordx4 v4, s[56:59], s70 offen nt lds
  s_add_u32 m0, s73, 13312
  s_add_u32 s70, s72, 344064
  buffer_load_dwordx4 v4, s[56:59], s70 offen nt lds
  s_add_u32 m0, s73, 14336
  s_add_u32 s70, s72, 307200
  buffer_load_dwordx4 v4, s[56:59], s70 offen nt lds
  s_add_u32 m0, s73, 15360
  s_add_u32 s70, s72, 356352
  buffer_load_dwordx4 v4, s[56:59], s70 offen nt lds
  s_add_u32 m0, s73, 16384
  s_add_u32 s70, s72, 393216
  buffer_load_dwordx4 v4, s[56:59], s70 offen nt lds
  s_add_u32 m0, s73, 17408
  s_add_u32 s70, s72, 442368
  buffer_load_dwordx4 v4, s[56:59], s70 offen nt lds
  s_add_u32 m0, s73, 18432
  s_add_u32 s70, s72, 405504
  buffer_load_dwordx4 v4, s[56:59], s70 offen nt lds
  s_add_u32 m0, s73, 19456
  s_add_u32 s70, s72, 454656
  buffer_load_dwordx4 v4, s[56:59], s70 offen nt lds
  s_add_u32 m0, s73, 20480
  s_add_u32 s70, s72, 0
  buffer_load_dwordx4 v4, s[60:63], s70 offen nt lds
  s_add_u32 m0, s73, 21504
  s_add_u32 s70, s72, 49152
  buffer_load_dwordx4 v4, s[60:63], s70 offen nt lds
  s_add_u32 m0, s73, 22528
  s_add_u32 s70, s72, 12288
  buffer_load_dwordx4 v4, s[60:63], s70 offen nt lds
  s_add_u32 m0, s73, 23552
  s_add_u32 s70, s72, 61440
  buffer_load_dwordx4 v4, s[60:63], s70 offen nt lds
  s_add_u32 m0, s73, 24576
  s_add_u32 s70, s72, 98304
  buffer_load_dwordx4 v4, s[60:63], s70 offen nt lds
  s_add_u32 m0, s73, 25600
  s_add_u32 s70, s72, 147456
  buffer_load_dwordx4 v4, s[60:63], s70 offen nt lds
  s_add_u32 m0, s73, 26624
  s_add_u32 s70, s72, 110592
  buffer_load_dwordx4 v4, s[60:63], s70 offen nt lds
  s_add_u32 m0, s73, 27648
  s_add_u32 s70, s72, 159744
  buffer_load_dwordx4 v4, s[60:63], s70 offen nt lds
  s_add_u32 m0, s73, 28672
  s_add_u32 s70, s72, 196608
  buffer_load_dwordx4 v4, s[60:63], s70 offen nt lds
  s_add_u32 m0, s73, 29696
  s_add_u32 s70, s72, 245760
  buffer_load_dwordx4 v4, s[60:63], s70 offen nt lds
  s_add_u32 m0, s73, 30720
  s_add_u32 s70, s72, 208896
  buffer_load_dwordx4 v4, s[60:63], s70 offen nt lds
  s_add_u32 m0, s73, 31744
  s_add_u32 s70, s72, 258048
  buffer_load_dwordx4 v4, s[60:63], s70 offen nt lds
  s_add_u32 m0, s73, 32768
  s_add_u32 s70, s72, 294912
  buffer_load_dwordx4 v4, s[60:63], s70 offen nt lds
  s_add_u32 m0, s73, 33792
  s_add_u32 s70, s72, 344064
  buffer_load_dwordx4 v4, s[60:63], s70 offen nt lds
  s_add_u32 m0, s73, 34816
  s_add_u32 s70, s72, 307200
  buffer_load_dwordx4 v4, s[60:63], s70 offen nt lds
  s_add_u32 m0, s73, 35840
  s_add_u32 s70, s72, 356352
  buffer_load_dwordx4 v4, s[60:63], s70 offen nt lds
  s_add_u32 m0, s73, 36864
  s_add_u32 s70, s72, 393216
  buffer_load_dwordx4 v4, s[60:63], s70 offen nt lds
  s_add_u32 m0, s73, 37888
  s_add_u32 s70, s72, 442368
  buffer_load_dwordx4 v4, s[60:63], s70 offen nt lds
  s_add_u32 m0, s73, 38912
  s_add_u32 s70, s72, 405504
  buffer_load_dwordx4 v4, s[60:63], s70 offen nt lds
  s_add_u32 m0, s73, 39936
  s_add_u32 s70, s72, 454656
  buffer_load_dwordx4 v4, s[60:63], s70 offen nt lds
  s_waitcnt vmcnt(36)
  ds_read_b64_tr_b16 a[0:1], v144 offset:0
  ds_read_b64_tr_b16 a[2:3], v144 offset:2048
  ds_read_b64_tr_b16 a[20:21], v145 offset:0
  ds_read_b64_tr_b16 a[22:23], v145 offset:2048
  ds_read_b64_tr_b16 a[40:41], v146 offset:0
  ds_read_b64_tr_b16 a[42:43], v146 offset:2048
  ds_read_b64_tr_b16 a[60:61], v147 offset:0
  ds_read_b64_tr_b16 a[62:63], v147 offset:2048
  s_waitcnt vmcnt(32)
  ds_read_b64_tr_b16 a[4:5], v144 offset:4096
  ds_read_b64_tr_b16 a[6:7], v144 offset:6144
  ds_read_b64_tr_b16 a[24:25], v145 offset:4096
  ds_read_b64_tr_b16 a[26:27], v145 offset:6144
  ds_read_b64_tr_b16 a[44:45], v146 offset:4096
  ds_read_b64_tr_b16 a[46:47], v146 offset:6144
  ds_read_b64_tr_b16 a[64:65], v147 offset:4096
  ds_read_b64_tr_b16 a[66:67], v147 offset:6144
  s_waitcnt lgkmcnt(0)
  s_waitcnt vmcnt(28)
  ds_read_b64_tr_b16 a[8:9], v144 offset:8192
  ds_read_b64_tr_b16 a[10:11], v144 offset:10240
  ds_read_b64_tr_b16 a[28:29], v145 offset:8192
  ds_read_b64_tr_b16 a[30:31], v145 offset:10240
  ds_read_b64_tr_b16 a[48:49], v146 offset:8192
  ds_read_b64_tr_b16 a[50:51], v146 offset:10240
  ds_read_b64_tr_b16 a[68:69], v147 offset:8192
  ds_read_b64_tr_b16 a[70:71], v147 offset:10240
  s_waitcnt vmcnt(24)
  ds_read_b64_tr_b16 a[12:13], v144 offset:12288
  ds_read_b64_tr_b16 a[14:15], v144 offset:14336
  ds_read_b64_tr_b16 a[32:33], v145 offset:12288
  ds_read_b64_tr_b16 a[34:35], v145 offset:14336
  ds_read_b64_tr_b16 a[52:53], v146 offset:12288
  ds_read_b64_tr_b16 a[54:55], v146 offset:14336
  ds_read_b64_tr_b16 a[72:73], v147 offset:12288
  ds_read_b64_tr_b16 a[74:75], v147 offset:14336
  s_waitcnt lgkmcnt(0)
  s_waitcnt vmcnt(20)
  ds_read_b64_tr_b16 a[16:17], v144 offset:16384
  ds_read_b64_tr_b16 a[18:19], v144 offset:18432
  ds_read_b64_tr_b16 a[36:37], v145 offset:16384
  ds_read_b64_tr_b16 a[38:39], v145 offset:18432
  ds_read_b64_tr_b16 a[56:57], v146 offset:16384
  ds_read_b64_tr_b16 a[58:59], v146 offset:18432
  ds_read_b64_tr_b16 a[76:77], v147 offset:16384
  ds_read_b64_tr_b16 a[78:79], v147 offset:18432
  s_waitcnt vmcnt(16)
  ds_read_b64_tr_b16 a[80:81], v144 offset:20480
  ds_read_b64_tr_b16 a[82:83], v144 offset:22528
  ds_read_b64_tr_b16 a[100:101], v145 offset:20480
  ds_read_b64_tr_b16 a[102:103], v145 offset:22528
  ds_read_b64_tr_b16 a[120:121], v146 offset:20480
  ds_read_b64_tr_b16 a[122:123], v146 offset:22528
  ds_read_b64_tr_b16 a[140:141], v147 offset:20480
  ds_read_b64_tr_b16 a[142:143], v147 offset:22528
  s_waitcnt lgkmcnt(0)
  s_waitcnt vmcnt(12)
  ds_read_b64_tr_b16 a[84:85], v144 offset:24576
  ds_read_b64_tr_b16 a[86:87], v144 offset:26624
  ds_read_b64_tr_b16 a[104:105], v145 offset:24576
  ds_read_b64_tr_b16 a[106:107], v145 offset:26624
  ds_read_b64_tr_b16 a[124:125], v146 offset:24576
  ds_read_b64_tr_b16 a[126:127], v146 offset:26624
  ds_read_b64_tr_b16 a[144:145], v147 offset:24576
  ds_read_b64_tr_b16 a[146:147], v147 offset:26624
  s_waitcnt vmcnt(8)
  ds_read_b64_tr_b16 a[88:89], v144 offset:28672
  ds_read_b64_tr_b16 a[90:91], v144 offset:30720
  ds_read_b64_tr_b16 a[108:109], v145 offset:28672
  ds_read_b64_tr_b16 a[110:111], v145 offset:30720
  ds_read_b64_tr_b16 a[128:129], v146 offset:28672
  ds_read_b64_tr_b16 a[130:131], v146 offset:30720
  ds_read_b64_tr_b16 a[148:149], v147 offset:28672
  ds_read_b64_tr_b16 a[150:151], v147 offset:30720
  s_waitcnt lgkmcnt(0)
  s_waitcnt vmcnt(4)
  ds_read_b64_tr_b16 a[92:93], v144 offset:32768
  ds_read_b64_tr_b16 a[94:95], v144 offset:34816
  ds_read_b64_tr_b16 a[112:113], v145 offset:32768
  ds_read_b64_tr_b16 a[114:115], v145 offset:34816
  ds_read_b64_tr_b16 a[132:133], v146 offset:32768
  ds_read_b64_tr_b16 a[134:135], v146 offset:34816
  ds_read_b64_tr_b16 a[152:153], v147 offset:32768
  ds_read_b64_tr_b16 a[154:155], v147 offset:34816
  s_waitcnt vmcnt(0)
  ds_read_b64_tr_b16 a[96:97], v144 offset:36864
  ds_read_b64_tr_b16 a[98:99], v144 offset:38912
  ds_read_b64_tr_b16 a[116:117], v145 offset:36864
  ds_read_b64_tr_b16 a[118:119], v145 offset:38912
  ds_read_b64_tr_b16 a[136:137], v146 offset:36864
  ds_read_b64_tr_b16 a[138:139], v146 offset:38912
  ds_read_b64_tr_b16 a[156:157], v147 offset:36864
  ds_read_b64_tr_b16 a[158:159], v147 offset:38912
  s_waitcnt lgkmcnt(0)
  s_mul_i32 s72, s68, 81920
  s_mul_i32 s70, s17, 320
  s_add_u32 s72, s72, s70
  s_add_u32 m0, s73, 0
  s_add_u32 s70, s72, 0
  buffer_load_dwordx4 v5, s[64:67], s70 offen nt lds
  s_add_u32 m0, s73, 1024
  s_add_u32 s70, s72, 10240
  buffer_load_dwordx4 v5, s[64:67], s70 offen nt lds
  s_add_u32 m0, s73, 2048
  s_add_u32 s70, s72, 20480
  buffer_load_dwordx4 v5, s[64:67], s70 offen nt lds
  s_add_u32 m0, s73, 3072
  s_add_u32 s70, s72, 30720
  buffer_load_dwordx4 v5, s[64:67], s70 offen nt lds
  s_add_u32 m0, s73, 4096
  s_add_u32 s70, s72, 40960
  buffer_load_dwordx4 v5, s[64:67], s70 offen nt lds
  s_add_u32 m0, s73, 5120
  s_add_u32 s70, s72, 51200
  buffer_load_dwordx4 v5, s[64:67], s70 offen nt lds
  s_add_u32 m0, s73, 6144
  s_add_u32 s70, s72, 61440
  buffer_load_dwordx4 v5, s[64:67], s70 offen nt lds
  s_add_u32 m0, s73, 7168
  s_add_u32 s70, s72, 71680
  buffer_load_dwordx4 v5, s[64:67], s70 offen nt lds
  s_add_u32 m0, s73, 8192
  s_add_u32 s70, s72, 128
  buffer_load_dwordx4 v5, s[64:67], s70 offen nt lds
  s_add_u32 m0, s73, 9216
  s_add_u32 s70, s72, 10368
  buffer_load_dwordx4 v5, s[64:67], s70 offen nt lds
  s_add_u32 m0, s73, 10240
  s_add_u32 s70, s72, 20608
  buffer_load_dwordx4 v5, s[64:67], s70 offen nt lds
  s_add_u32 m0, s73, 11264
  s_add_u32 s70, s72, 30848
  buffer_load_dwordx4 v5, s[64:67], s70 offen nt lds
  s_add_u32 m0, s73, 12288
  s_add_u32 s70, s72, 41088
  buffer_load_dwordx4 v5, s[64:67], s70 offen nt lds
  s_add_u32 m0, s73, 13312
  s_add_u32 s70, s72, 51328
  buffer_load_dwordx4 v5, s[64:67], s70 offen nt lds
  s_add_u32 m0, s73, 14336
  s_add_u32 s70, s72, 61568
  buffer_load_dwordx4 v5, s[64:67], s70 offen nt lds
  s_add_u32 m0, s73, 15360
  s_add_u32 s70, s72, 71808
  buffer_load_dwordx4 v5, s[64:67], s70 offen nt lds
  s_add_u32 m0, s73, 16384
  s_add_u32 s70, s72, 256
  buffer_load_dwordx4 v5, s[64:67], s70 offen nt lds
  s_add_u32 m0, s73, 17408
  s_add_u32 s70, s72, 10496
  buffer_load_dwordx4 v5, s[64:67], s70 offen nt lds
  s_add_u32 m0, s73, 18432
  s_add_u32 s70, s72, 20736
  buffer_load_dwordx4 v5, s[64:67], s70 offen nt lds
  s_add_u32 m0, s73, 19456
  s_add_u32 s70, s72, 30976
  buffer_load_dwordx4 v5, s[64:67], s70 offen nt lds
  s_add_u32 m0, s73, 20480
  s_add_u32 s70, s72, 41216
  buffer_load_dwordx4 v5, s[64:67], s70 offen nt lds
  s_add_u32 m0, s73, 21504
  s_add_u32 s70, s72, 51456
  buffer_load_dwordx4 v5, s[64:67], s70 offen nt lds
  s_add_u32 m0, s73, 22528
  s_add_u32 s70, s72, 61696
  buffer_load_dwordx4 v5, s[64:67], s70 offen nt lds
  s_add_u32 m0, s73, 23552
  s_add_u32 s70, s72, 71936
  buffer_load_dwordx4 v5, s[64:67], s70 offen nt lds
  s_waitcnt vmcnt(0)
  ds_read_b64_tr_b16 a[160:161], v144 offset:0
  ds_read_b64_tr_b16 a[162:163], v144 offset:2048
  ds_read_b64_tr_b16 a[164:165], v144 offset:4096
  ds_read_b64_tr_b16 a[166:167], v144 offset:6144
  ds_read_b64_tr_b16 a[168:169], v145 offset:0
  ds_read_b64_tr_b16 a[170:171], v145 offset:2048
  ds_read_b64_tr_b16 a[172:173], v145 offset:4096
  ds_read_b64_tr_b16 a[174:175], v145 offset:6144
  ds_read_b64_tr_b16 a[176:177], v146 offset:0
  ds_read_b64_tr_b16 a[178:179], v146 offset:2048
  ds_read_b64_tr_b16 a[180:181], v146 offset:4096
  ds_read_b64_tr_b16 a[182:183], v146 offset:6144
  s_waitcnt lgkmcnt(0)
  ds_read_b64_tr_b16 a[184:185], v147 offset:0
  ds_read_b64_tr_b16 a[186:187], v147 offset:2048
  ds_read_b64_tr_b16 a[188:189], v147 offset:4096
  ds_read_b64_tr_b16 a[190:191], v147 offset:6144
  ds_read_b64_tr_b16 a[192:193], v144 offset:8192
  ds_read_b64_tr_b16 a[194:195], v144 offset:10240
  ds_read_b64_tr_b16 a[196:197], v144 offset:12288
  ds_read_b64_tr_b16 a[198:199], v144 offset:14336
  ds_read_b64_tr_b16 a[200:201], v145 offset:8192
  ds_read_b64_tr_b16 a[202:203], v145 offset:10240
  ds_read_b64_tr_b16 a[204:205], v145 offset:12288
  ds_read_b64_tr_b16 a[206:207], v145 offset:14336
  s_waitcnt lgkmcnt(0)
  ds_read_b64_tr_b16 a[208:209], v146 offset:8192
  ds_read_b64_tr_b16 a[210:211], v146 offset:10240
  ds_read_b64_tr_b16 a[212:213], v146 offset:12288
  ds_read_b64_tr_b16 a[214:215], v146 offset:14336
  ds_read_b64_tr_b16 a[216:217], v147 offset:8192
  ds_read_b64_tr_b16 a[218:219], v147 offset:10240
  ds_read_b64_tr_b16 a[220:221], v147 offset:12288
  ds_read_b64_tr_b16 a[222:223], v147 offset:14336
  ds_read_b64_tr_b16 a[224:225], v144 offset:16384
  ds_read_b64_tr_b16 a[226:227], v144 offset:18432
  ds_read_b64_tr_b16 a[228:229], v144 offset:20480
  ds_read_b64_tr_b16 a[230:231], v144 offset:22528
  s_waitcnt lgkmcnt(0)
  ds_read_b64_tr_b16 a[232:233], v145 offset:16384
  ds_read_b64_tr_b16 a[234:235], v145 offset:18432
  ds_read_b64_tr_b16 a[236:237], v145 offset:20480
  ds_read_b64_tr_b16 a[238:239], v145 offset:22528
  v_lshlrev_b32 v233, 4, v1
  v_lshrrev_b32 v124, 2, v1
  v_and_b32 v125, 3, v1
  v_lshlrev_b32 v125, 2, v125
  v_lshl_add_u32 v234, v124, 7, v125
  v_lshrrev_b32 v124, 4, v1
  v_and_b32 v125, 7, v1
  v_lshlrev_b32 v125, 4, v125
  v_lshl_add_u32 v236, v124, 7, v125
  v_lshrrev_b32 v124, 5, v1
  v_mul_u32_u24 v124, 20480, v124
  v_and_b32 v125, 31, v1
  v_lshl_add_u32 v237, v125, 4, v124
  s_mul_i32 s78, s17, 24
  s_add_u32 s78, s78, s68
  s_mov_b32 s74, 0
  s_mov_b32 s75, 2097152
  s_waitcnt lgkmcnt(0)
  s_barrier
  s_mov_b32 s79, 0
  s_mov_b32 s80, 0
  s_mov_b32 s81, 0
  s_mov_b32 s82, 0
  s_mov_b32 s83, 0
  s_mov_b32 s84, 0
  s_mov_b32 s85, 0
  s_mov_b32 s86, 0
r_now:
  v_mov_b32 v90, 196
  s_mov_b32 s34, 0
gw_46:
  buffer_load_dword v91, v90, s[12:15], 0 offen sc1
  s_add_u32 s34, s34, 1
  s_cmp_gt_u32 s34, 65536
  s_cbranch_scc1 role_abort
  s_waitcnt vmcnt(0)
  v_cmp_gt_u32 vcc, 104, v91
  s_cbranch_vccz gk_47
  s_sleep 8
  s_branch gw_46
gk_47:
  s_mov_b32 s35, 70656
  buffer_load_dwordx2 v[196:197], v227, s[8:11], s35 offen offset:0 sc1
  buffer_load_dwordx2 v[198:199], v227, s[8:11], s35 offen offset:512 sc1
  buffer_load_dwordx2 v[200:201], v227, s[8:11], s35 offen offset:1024 sc1
  buffer_load_dwordx2 v[202:203], v227, s[8:11], s35 offen offset:1536 sc1
  buffer_load_dwordx2 v[204:205], v227, s[8:11], s35 offen offset:2048 sc1
  s_mov_b32 s35, 73216
  buffer_load_dwordx2 v[186:187], v227, s[8:11], s35 offen offset:0 sc1
  buffer_load_dwordx2 v[188:189], v227, s[8:11], s35 offen offset:512 sc1
  buffer_load_dwordx2 v[190:191], v227, s[8:11], s35 offen offset:1024 sc1
  buffer_load_dwordx2 v[192:193], v227, s[8:11], s35 offen offset:1536 sc1
  buffer_load_dwordx2 v[194:195], v227, s[8:11], s35 offen offset:2048 sc1
  s_mov_b32 s35, 75776
  buffer_load_dwordx2 v[176:177], v227, s[8:11], s35 offen offset:0 sc1
  buffer_load_dwordx2 v[178:179], v227, s[8:11], s35 offen offset:512 sc1
  buffer_load_dwordx2 v[180:181], v227, s[8:11], s35 offen offset:1024 sc1
  buffer_load_dwordx2 v[182:183], v227, s[8:11], s35 offen offset:1536 sc1
  buffer_load_dwordx2 v[184:185], v227, s[8:11], s35 offen offset:2048 sc1
  s_mov_b32 s35, 78336
  buffer_load_dwordx2 v[206:207], v227, s[8:11], s35 offen offset:0 sc1
  buffer_load_dwordx2 v[208:209], v227, s[8:11], s35 offen offset:512 sc1
  buffer_load_dwordx2 v[210:211], v227, s[8:11], s35 offen offset:1024 sc1
  buffer_load_dwordx2 v[212:213], v227, s[8:11], s35 offen offset:1536 sc1
  buffer_load_dwordx2 v[214:215], v227, s[8:11], s35 offen offset:2048 sc1
  buffer_load_dword v22, v226, s[28:31], 0 offen offset:0
  buffer_load_dword v23, v226, s[28:31], 0 offen offset:256
  buffer_load_dword v24, v226, s[28:31], 0 offen offset:512
  buffer_load_dword v25, v226, s[28:31], 0 offen offset:768
  buffer_load_dword v26, v226, s[28:31], 0 offen offset:1024
  v_lshlrev_b32 v229, 4, v1
  s_lshl_b32 s35, s16, 8
  s_add_u32 s35, s35, 12288
  v_and_b32 v90, 7, v1
  v_lshl_add_u32 v232, v90, 2, s35
  s_waitcnt vmcnt(0)
  v_add_f32 v176, 1.0, v176
  v_add_f32 v177, 1.0, v177
  v_cvt_pk_bf16_f32 v90, v176, v177
  v_lshlrev_b32 v176, 16, v90
  v_and_b32 v177, 0xffff0000, v90
  v_add_f32 v178, 1.0, v178
  v_add_f32 v179, 1.0, v179
  v_cvt_pk_bf16_f32 v90, v178, v179
  v_lshlrev_b32 v178, 16, v90
  v_and_b32 v179, 0xffff0000, v90
  v_add_f32 v180, 1.0, v180
  v_add_f32 v181, 1.0, v181
  v_cvt_pk_bf16_f32 v90, v180, v181
  v_lshlrev_b32 v180, 16, v90
  v_and_b32 v181, 0xffff0000, v90
  v_add_f32 v182, 1.0, v182
  v_add_f32 v183, 1.0, v183
  v_cvt_pk_bf16_f32 v90, v182, v183
  v_lshlrev_b32 v182, 16, v90
  v_and_b32 v183, 0xffff0000, v90
  v_add_f32 v184, 1.0, v184
  v_add_f32 v185, 1.0, v185
  v_cvt_pk_bf16_f32 v90, v184, v185
  v_lshlrev_b32 v184, 16, v90
  v_and_b32 v185, 0xffff0000, v90
  v_lshlrev_b32 v216, 16, v22
  v_and_b32 v217, 0xffff0000, v22
  v_lshlrev_b32 v218, 16, v23
  v_and_b32 v219, 0xffff0000, v23
  v_lshlrev_b32 v220, 16, v24
  v_and_b32 v221, 0xffff0000, v24
  v_lshlrev_b32 v222, 16, v25
  v_and_b32 v223, 0xffff0000, v25
  v_lshlrev_b32 v224, 16, v26
  v_and_b32 v225, 0xffff0000, v26
  s_mov_b32 s33, s16
r_loop:
  s_lshl_b32 s40, s33, 4
  s_add_u32 s40, s40, s32
  s_mul_i32 s37, s40, 1280
  s_lshr_b32 s39, s33, 1
  s_mul_i32 s38, s39, 327680
  s_and_b32 s35, s40, 31
  s_mul_i32 s35, s35, 1280
  s_add_u32 s38, s38, s35
  s_add_u32 s38, s38, 226492416
  s_add_u32 s41, s39, 2
  s_min_u32 s41, s41, 64
  s_lshl_b32 s36, s39, 10
  s_add_u32 s36, s36, 2162688
  buffer_load_dword v22, v226, s[20:23], s37 offen offset:0
  buffer_load_dword v23, v226, s[20:23], s37 offen offset:256
  buffer_load_dword v24, v226, s[20:23], s37 offen offset:512
  buffer_load_dword v25, v226, s[20:23], s37 offen offset:768
  buffer_load_dword v26, v226, s[20:23], s37 offen offset:1024
  s_mov_b32 s34, 0
pw_48:
  buffer_load_dword v93, v232, s[8:11], 0 offen sc1
  s_add_u32 s34, s34, 1
  s_cmp_gt_u32 s34, 65536
  s_cbranch_scc1 role_abort
  s_waitcnt vmcnt(0)
pc_50:
  v_cmp_gt_u32 vcc, s41, v93
  s_nop 0
  s_and_b32 vcc_lo, vcc_lo, 0xff
  s_and_b32 vcc_hi, vcc_hi, 0x0
  s_cmp_eq_u64 vcc, 0
  s_cbranch_scc1 po_49
  s_sleep 8
  s_branch pw_48
po_49:
  s_cmp_lt_u32 s39, 63
  s_cbranch_scc1 r_p0
  s_sleep 16
r_p0:
  s_mov_b32 s34, 0
r_poll:
  buffer_load_dwordx4 v[96:99], v229, s[8:11], s36 offen sc1
  s_add_u32 s34, s34, 1
  s_cmp_gt_u32 s34, 65536
  s_cbranch_scc1 role_abort
  s_waitcnt vmcnt(0)
  v_max3_u32 v90, v96, v97, v98
  v_max_u32 v90, v90, v99
  v_cmp_eq_u32 vcc, -1, v90
  s_nop 0
  s_and_b32 vcc_lo, vcc_lo, 0x1f1f1f1f
  s_and_b32 vcc_hi, vcc_hi, 0x1f1f1f1f
  s_cmp_eq_u64 vcc, 0
  s_cbranch_scc1 r_go
  s_sleep 4
  s_branch r_poll
r_go:
  buffer_load_dword v46, v226, s[8:11], s38 offen offset:0 sc1
  buffer_load_dword v47, v226, s[8:11], s38 offen offset:256 sc1
  buffer_load_dword v48, v226, s[8:11], s38 offen offset:512 sc1
  buffer_load_dword v49, v226, s[8:11], s38 offen offset:768 sc1
  buffer_load_dword v50, v226, s[8:11], s38 offen offset:1024 sc1
  s_add_u32 s38, s38, 40960
  buffer_load_dword v51, v226, s[8:11], s38 offen offset:0 sc1
  buffer_load_dword v52, v226, s[8:11], s38 offen offset:256 sc1
  buffer_load_dword v53, v226, s[8:11], s38 offen offset:512 sc1
  buffer_load_dword v54, v226, s[8:11], s38 offen offset:768 sc1
  buffer_load_dword v55, v226, s[8:11], s38 offen offset:1024 sc1
  s_add_u32 s38, s38, 40960
  buffer_load_dword v56, v226, s[8:11], s38 offen offset:0 sc1
  buffer_load_dword v57, v226, s[8:11], s38 offen offset:256 sc1
  buffer_load_dword v58, v226, s[8:11], s38 offen offset:512 sc1
  buffer_load_dword v59, v226, s[8:11], s38 offen offset:768 sc1
  buffer_load_dword v60, v226, s[8:11], s38 offen offset:1024 sc1
  s_add_u32 s38, s38, 40960
  buffer_load_dword v61, v226, s[8:11], s38 offen offset:0 sc1
  buffer_load_dword v62, v226, s[8:11], s38 offen offset:256 sc1
  buffer_load_dword v63, v226, s[8:11], s38 offen offset:512 sc1
  buffer_load_dword v64, v226, s[8:11], s38 offen offset:768 sc1
  buffer_load_dword v65, v226, s[8:11], s38 offen offset:1024 sc1
  s_add_u32 s38, s38, 40960
  buffer_load_dword v66, v226, s[8:11], s38 offen offset:0 sc1
  buffer_load_dword v67, v226, s[8:11], s38 offen offset:256 sc1
  buffer_load_dword v68, v226, s[8:11], s38 offen offset:512 sc1
  buffer_load_dword v69, v226, s[8:11], s38 offen offset:768 sc1
  buffer_load_dword v70, v226, s[8:11], s38 offen offset:1024 sc1
  s_add_u32 s38, s38, 40960
  buffer_load_dword v71, v226, s[8:11], s38 offen offset:0 sc1
  buffer_load_dword v72, v226, s[8:11], s38 offen offset:256 sc1
  buffer_load_dword v73, v226, s[8:11], s38 offen offset:512 sc1
  buffer_load_dword v74, v226, s[8:11], s38 offen offset:768 sc1
  buffer_load_dword v75, v226, s[8:11], s38 offen offset:1024 sc1
  s_add_u32 s38, s38, 40960
  buffer_load_dword v76, v226, s[8:11], s38 offen offset:0 sc1
  buffer_load_dword v77, v226, s[8:11], s38 offen offset:256 sc1
  buffer_load_dword v78, v226, s[8:11], s38 offen offset:512 sc1
  buffer_load_dword v79, v226, s[8:11], s38 offen offset:768 sc1
  buffer_load_dword v80, v226, s[8:11], s38 offen offset:1024 sc1
  s_add_u32 s38, s38, 40960
  buffer_load_dword v81, v226, s[8:11], s38 offen offset:0 sc1
  buffer_load_dword v82, v226, s[8:11], s38 offen offset:256 sc1
  buffer_load_dword v83, v226, s[8:11], s38 offen offset:512 sc1
  buffer_load_dword v84, v226, s[8:11], s38 offen offset:768 sc1
  buffer_load_dword v85, v226, s[8:11], s38 offen offset:1024 sc1
  s_add_u32 s38, s38, 40960
  v_lshlrev_b32 v2, 16, v22
  v_and_b32 v3, 0xffff0000, v22
  v_lshlrev_b32 v4, 16, v23
  v_and_b32 v5, 0xffff0000, v23
  v_lshlrev_b32 v6, 16, v24
  v_and_b32 v7, 0xffff0000, v24
  v_lshlrev_b32 v8, 16, v25
  v_and_b32 v9, 0xffff0000, v25
  v_lshlrev_b32 v10, 16, v26
  v_and_b32 v11, 0xffff0000, v26
  s_waitcnt vmcnt(35)
  v_lshlrev_b32 v12, 16, v46
  v_and_b32 v13, 0xffff0000, v46
  v_lshlrev_b32 v14, 16, v47
  v_and_b32 v15, 0xffff0000, v47
  v_lshlrev_b32 v16, 16, v48
  v_and_b32 v17, 0xffff0000, v48
  v_lshlrev_b32 v18, 16, v49
  v_and_b32 v19, 0xffff0000, v49
  v_lshlrev_b32 v20, 16, v50
  v_and_b32 v21, 0xffff0000, v50
  s_waitcnt vmcnt(30)
  v_dot2c_f32_bf16 v12, v51, v230
  v_dot2c_f32_bf16 v13, v51, v231
  v_dot2c_f32_bf16 v14, v52, v230
  v_dot2c_f32_bf16 v15, v52, v231
  v_dot2c_f32_bf16 v16, v53, v230
  v_dot2c_f32_bf16 v17, v53, v231
  v_dot2c_f32_bf16 v18, v54, v230
  v_dot2c_f32_bf16 v19, v54, v231
  v_dot2c_f32_bf16 v20, v55, v230
  v_dot2c_f32_bf16 v21, v55, v231
  s_waitcnt vmcnt(25)
  v_dot2c_f32_bf16 v12, v56, v230
  v_dot2c_f32_bf16 v13, v56, v231
  v_dot2c_f32_bf16 v14, v57, v230
  v_dot2c_f32_bf16 v15, v57, v231
  v_dot2c_f32_bf16 v16, v58, v230
  v_dot2c_f32_bf16 v17, v58, v231
  v_dot2c_f32_bf16 v18, v59, v230
  v_dot2c_f32_bf16 v19, v59, v231
  v_dot2c_f32_bf16 v20, v60, v230
  v_dot2c_f32_bf16 v21, v60, v231
  s_waitcnt vmcnt(20)
  v_dot2c_f32_bf16 v12, v61, v230
  v_dot2c_f32_bf16 v13, v61, v231
  v_dot2c_f32_bf16 v14, v62, v230
  v_dot2c_f32_bf16 v15, v62, v231
  v_dot2c_f32_bf16 v16, v63, v230
  v_dot2c_f32_bf16 v17, v63, v231
  v_dot2c_f32_bf16 v18, v64, v230
  v_dot2c_f32_bf16 v19, v64, v231
  v_dot2c_f32_bf16 v20, v65, v230
  v_dot2c_f32_bf16 v21, v65, v231
  s_waitcnt vmcnt(15)
  v_dot2c_f32_bf16 v12, v66, v230
  v_dot2c_f32_bf16 v13, v66, v231
  v_dot2c_f32_bf16 v14, v67, v230
  v_dot2c_f32_bf16 v15, v67, v231
  v_dot2c_f32_bf16 v16, v68, v230
  v_dot2c_f32_bf16 v17, v68, v231
  v_dot2c_f32_bf16 v18, v69, v230
  v_dot2c_f32_bf16 v19, v69, v231
  v_dot2c_f32_bf16 v20, v70, v230
  v_dot2c_f32_bf16 v21, v70, v231
  s_waitcnt vmcnt(10)
  v_dot2c_f32_bf16 v12, v71, v230
  v_dot2c_f32_bf16 v13, v71, v231
  v_dot2c_f32_bf16 v14, v72, v230
  v_dot2c_f32_bf16 v15, v72, v231
  v_dot2c_f32_bf16 v16, v73, v230
  v_dot2c_f32_bf16 v17, v73, v231
  v_dot2c_f32_bf16 v18, v74, v230
  v_dot2c_f32_bf16 v19, v74, v231
  v_dot2c_f32_bf16 v20, v75, v230
  v_dot2c_f32_bf16 v21, v75, v231
  s_waitcnt vmcnt(5)
  v_dot2c_f32_bf16 v12, v76, v230
  v_dot2c_f32_bf16 v13, v76, v231
  v_dot2c_f32_bf16 v14, v77, v230
  v_dot2c_f32_bf16 v15, v77, v231
  v_dot2c_f32_bf16 v16, v78, v230
  v_dot2c_f32_bf16 v17, v78, v231
  v_dot2c_f32_bf16 v18, v79, v230
  v_dot2c_f32_bf16 v19, v79, v231
  v_dot2c_f32_bf16 v20, v80, v230
  v_dot2c_f32_bf16 v21, v80, v231
  s_waitcnt vmcnt(0)
  v_dot2c_f32_bf16 v12, v81, v230
  v_dot2c_f32_bf16 v13, v81, v231
  v_dot2c_f32_bf16 v14, v82, v230
  v_dot2c_f32_bf16 v15, v82, v231
  v_dot2c_f32_bf16 v16, v83, v230
  v_dot2c_f32_bf16 v17, v83, v231
  v_dot2c_f32_bf16 v18, v84, v230
  v_dot2c_f32_bf16 v19, v84, v231
  v_dot2c_f32_bf16 v20, v85, v230
  v_dot2c_f32_bf16 v21, v85, v231
  v_cvt_pk_bf16_f32 v90, v12, v13
  v_lshlrev_b32 v12, 16, v90
  v_and_b32 v13, 0xffff0000, v90
  v_cvt_pk_bf16_f32 v90, v14, v15
  v_lshlrev_b32 v14, 16, v90
  v_and_b32 v15, 0xffff0000, v90
  v_cvt_pk_bf16_f32 v90, v16, v17
  v_lshlrev_b32 v16, 16, v90
  v_and_b32 v17, 0xffff0000, v90
  v_cvt_pk_bf16_f32 v90, v18, v19
  v_lshlrev_b32 v18, 16, v90
  v_and_b32 v19, 0xffff0000, v90
  v_cvt_pk_bf16_f32 v90, v20, v21
  v_lshlrev_b32 v20, 16, v90
  v_and_b32 v21, 0xffff0000, v90
  v_pk_mul_f32 v[12:13], v[12:13], v[196:197]
  v_cvt_pk_bf16_f32 v90, v12, v13
  v_lshlrev_b32 v12, 16, v90
  v_and_b32 v13, 0xffff0000, v90
  v_pk_mul_f32 v[14:15], v[14:15], v[198:199]
  v_cvt_pk_bf16_f32 v90, v14, v15
  v_lshlrev_b32 v14, 16, v90
  v_and_b32 v15, 0xffff0000, v90
  v_pk_mul_f32 v[16:17], v[16:17], v[200:201]
  v_cvt_pk_bf16_f32 v90, v16, v17
  v_lshlrev_b32 v16, 16, v90
  v_and_b32 v17, 0xffff0000, v90
  v_pk_mul_f32 v[18:19], v[18:19], v[202:203]
  v_cvt_pk_bf16_f32 v90, v18, v19
  v_lshlrev_b32 v18, 16, v90
  v_and_b32 v19, 0xffff0000, v90
  v_pk_mul_f32 v[20:21], v[20:21], v[204:205]
  v_cvt_pk_bf16_f32 v90, v20, v21
  v_lshlrev_b32 v20, 16, v90
  v_and_b32 v21, 0xffff0000, v90
  v_pk_add_f32 v[2:3], v[2:3], v[12:13]
  v_cvt_pk_bf16_f32 v34, v2, v3
  v_lshlrev_b32 v2, 16, v34
  v_and_b32 v3, 0xffff0000, v34
  v_pk_add_f32 v[4:5], v[4:5], v[14:15]
  v_cvt_pk_bf16_f32 v35, v4, v5
  v_lshlrev_b32 v4, 16, v35
  v_and_b32 v5, 0xffff0000, v35
  v_pk_add_f32 v[6:7], v[6:7], v[16:17]
  v_cvt_pk_bf16_f32 v36, v6, v7
  v_lshlrev_b32 v6, 16, v36
  v_and_b32 v7, 0xffff0000, v36
  v_pk_add_f32 v[8:9], v[8:9], v[18:19]
  v_cvt_pk_bf16_f32 v37, v8, v9
  v_lshlrev_b32 v8, 16, v37
  v_and_b32 v9, 0xffff0000, v37
  v_pk_add_f32 v[10:11], v[10:11], v[20:21]
  v_cvt_pk_bf16_f32 v38, v10, v11
  v_lshlrev_b32 v10, 16, v38
  v_and_b32 v11, 0xffff0000, v38
  s_add_u32 s35, s37, 5242880
  buffer_store_dword v34, v226, s[8:11], s35 offen offset:0 sc1
  buffer_store_dword v35, v226, s[8:11], s35 offen offset:256 sc1
  buffer_store_dword v36, v226, s[8:11], s35 offen offset:512 sc1
  buffer_store_dword v37, v226, s[8:11], s35 offen offset:768 sc1
  buffer_store_dword v38, v226, s[8:11], s35 offen offset:1024 sc1
  v_pk_add_f32 v[86:87], v[2:3], v[4:5]
  v_pk_add_f32 v[88:89], v[6:7], v[8:9]
  v_pk_add_f32 v[86:87], v[86:87], v[10:11]
  v_pk_add_f32 v[86:87], v[86:87], v[88:89]
  v_add_f32 v86, v86, v87
  s_nop 1
  v_add_f32_dpp v86, v86, v86 row_ror:8 row_mask:0xf bank_mask:0xf
  s_nop 1
  v_add_f32_dpp v86, v86, v86 row_ror:4 row_mask:0xf bank_mask:0xf
  s_nop 1
  v_add_f32_dpp v86, v86, v86 row_ror:2 row_mask:0xf bank_mask:0xf
  s_nop 1
  v_add_f32_dpp v86, v86, v86 row_ror:1 row_mask:0xf bank_mask:0xf
  v_mov_b32 v90, v86
  s_nop 1
  v_permlane16_swap_b32 v86, v90
  v_add_f32 v86, v86, v90
  v_mov_b32 v90, v86
  s_nop 1
  v_permlane32_swap_b32 v86, v90
  v_add_f32 v86, v86, v90
  v_mul_f32 v88, 0xbacccccd, v86
  v_mul_f32 v89, 0xbacccccd, v86
  v_pk_add_f32 v[12:13], v[2:3], v[88:89]
  v_pk_add_f32 v[14:15], v[4:5], v[88:89]
  v_pk_add_f32 v[16:17], v[6:7], v[88:89]
  v_pk_add_f32 v[18:19], v[8:9], v[88:89]
  v_pk_add_f32 v[20:21], v[10:11], v[88:89]
  v_pk_mul_f32 v[86:87], v[12:13], v[12:13]
  v_pk_fma_f32 v[86:87], v[14:15], v[14:15], v[86:87]
  v_pk_fma_f32 v[86:87], v[16:17], v[16:17], v[86:87]
  v_pk_fma_f32 v[86:87], v[18:19], v[18:19], v[86:87]
  v_pk_fma_f32 v[86:87], v[20:21], v[20:21], v[86:87]
  v_add_f32 v86, v86, v87
  v_cvt_pk_bf16_f32 v91, v88, v89
  v_lshlrev_b32 v88, 16, v91
  v_and_b32 v89, 0xffff0000, v91
  v_add_f32_dpp v86, v86, v86 row_ror:8 row_mask:0xf bank_mask:0xf
  s_nop 1
  v_add_f32_dpp v86, v86, v86 row_ror:4 row_mask:0xf bank_mask:0xf
  s_nop 1
  v_add_f32_dpp v86, v86, v86 row_ror:2 row_mask:0xf bank_mask:0xf
  s_nop 1
  v_add_f32_dpp v86, v86, v86 row_ror:1 row_mask:0xf bank_mask:0xf
  v_mov_b32 v90, v86
  s_nop 1
  v_permlane16_swap_b32 v86, v90
  v_add_f32 v86, v86, v90
  v_mov_b32 v90, v86
  s_nop 1
  v_permlane32_swap_b32 v86, v90
  v_add_f32 v86, v86, v90
  v_pk_add_f32 v[12:13], v[2:3], v[88:89]
  v_pk_add_f32 v[14:15], v[4:5], v[88:89]
  v_pk_add_f32 v[16:17], v[6:7], v[88:89]
  v_pk_add_f32 v[18:19], v[8:9], v[88:89]
  v_pk_add_f32 v[20:21], v[10:11], v[88:89]
  v_mul_f32 v86, 0x3acccccd, v86
  v_cvt_pk_bf16_f32 v86, v86, v86
  v_lshlrev_b32 v86, 16, v86
  v_add_f32 v86, 0x3727c5ac, v86
  v_cvt_pk_bf16_f32 v86, v86, v86
  v_lshlrev_b32 v86, 16, v86
  v_sqrt_f32 v86, v86
  v_cvt_pk_bf16_f32 v90, v12, v13
  v_lshlrev_b32 v12, 16, v90
  v_and_b32 v13, 0xffff0000, v90
  v_cvt_pk_bf16_f32 v86, v86, v86
  v_lshlrev_b32 v86, 16, v86
  v_rcp_f32 v86, v86
  v_cvt_pk_bf16_f32 v90, v14, v15
  v_lshlrev_b32 v14, 16, v90
  v_and_b32 v15, 0xffff0000, v90
  v_cvt_pk_bf16_f32 v90, v16, v17
  v_lshlrev_b32 v16, 16, v90
  v_and_b32 v17, 0xffff0000, v90
  v_cvt_pk_bf16_f32 v90, v18, v19
  v_lshlrev_b32 v18, 16, v90
  v_and_b32 v19, 0xffff0000, v90
  v_cvt_pk_bf16_f32 v90, v20, v21
  v_lshlrev_b32 v20, 16, v90
  v_and_b32 v21, 0xffff0000, v90
  v_mov_b32 v87, v86
  v_pk_mul_f32 v[12:13], v[12:13], v[86:87]
  v_cvt_pk_bf16_f32 v90, v12, v13
  v_lshlrev_b32 v12, 16, v90
  v_and_b32 v13, 0xffff0000, v90
  v_pk_mul_f32 v[14:15], v[14:15], v[86:87]
  v_cvt_pk_bf16_f32 v90, v14, v15
  v_lshlrev_b32 v14, 16, v90
  v_and_b32 v15, 0xffff0000, v90
  v_pk_mul_f32 v[16:17], v[16:17], v[86:87]
  v_cvt_pk_bf16_f32 v90, v16, v17
  v_lshlrev_b32 v16, 16, v90
  v_and_b32 v17, 0xffff0000, v90
  v_pk_mul_f32 v[18:19], v[18:19], v[86:87]
  v_cvt_pk_bf16_f32 v90, v18, v19
  v_lshlrev_b32 v18, 16, v90
  v_and_b32 v19, 0xffff0000, v90
  v_pk_mul_f32 v[20:21], v[20:21], v[86:87]
  v_cvt_pk_bf16_f32 v90, v20, v21
  v_lshlrev_b32 v20, 16, v90
  v_and_b32 v21, 0xffff0000, v90
  v_pk_mul_f32 v[12:13], v[12:13], v[176:177]
  v_cvt_pk_bf16_f32 v90, v12, v13
  v_lshlrev_b32 v12, 16, v90
  v_and_b32 v13, 0xffff0000, v90
  v_pk_mul_f32 v[14:15], v[14:15], v[178:179]
  v_cvt_pk_bf16_f32 v90, v14, v15
  v_lshlrev_b32 v14, 16, v90
  v_and_b32 v15, 0xffff0000, v90
  v_pk_mul_f32 v[16:17], v[16:17], v[180:181]
  v_cvt_pk_bf16_f32 v90, v16, v17
  v_lshlrev_b32 v16, 16, v90
  v_and_b32 v17, 0xffff0000, v90
  v_pk_mul_f32 v[18:19], v[18:19], v[182:183]
  v_cvt_pk_bf16_f32 v90, v18, v19
  v_lshlrev_b32 v18, 16, v90
  v_and_b32 v19, 0xffff0000, v90
  v_pk_mul_f32 v[20:21], v[20:21], v[184:185]
  v_cvt_pk_bf16_f32 v90, v20, v21
  v_lshlrev_b32 v20, 16, v90
  v_and_b32 v21, 0xffff0000, v90
  v_pk_add_f32 v[12:13], v[12:13], v[186:187]
  v_cvt_pk_bf16_f32 v28, v12, v13
  v_pk_add_f32 v[14:15], v[14:15], v[188:189]
  v_cvt_pk_bf16_f32 v29, v14, v15
  v_pk_add_f32 v[16:17], v[16:17], v[190:191]
  v_cvt_pk_bf16_f32 v30, v16, v17
  v_pk_add_f32 v[18:19], v[18:19], v[192:193]
  v_cvt_pk_bf16_f32 v31, v18, v19
  v_pk_add_f32 v[20:21], v[20:21], v[194:195]
  v_cvt_pk_bf16_f32 v32, v20, v21
  s_add_u32 s35, s37, 8388608
  buffer_store_dword v28, v226, s[8:11], s35 offen offset:0 sc1
  buffer_store_dword v29, v226, s[8:11], s35 offen offset:256 sc1
  buffer_store_dword v30, v226, s[8:11], s35 offen offset:512 sc1
  buffer_store_dword v31, v226, s[8:11], s35 offen offset:768 sc1
  buffer_store_dword v32, v226, s[8:11], s35 offen offset:1024 sc1
  v_lshlrev_b32 v12, 16, v28
  v_and_b32 v13, 0xffff0000, v28
  v_lshlrev_b32 v14, 16, v29
  v_and_b32 v15, 0xffff0000, v29
  v_lshlrev_b32 v16, 16, v30
  v_and_b32 v17, 0xffff0000, v30
  v_lshlrev_b32 v18, 16, v31
  v_and_b32 v19, 0xffff0000, v31
  v_lshlrev_b32 v20, 16, v32
  v_and_b32 v21, 0xffff0000, v32
  v_pk_mul_f32 v[86:87], v[12:13], v[216:217]
  v_pk_fma_f32 v[86:87], v[14:15], v[218:219], v[86:87]
  v_pk_fma_f32 v[86:87], v[16:17], v[220:221], v[86:87]
  v_pk_fma_f32 v[86:87], v[18:19], v[222:223], v[86:87]
  v_pk_fma_f32 v[86:87], v[20:21], v[224:225], v[86:87]
  v_add_f32 v86, v86, v87
  v_pk_mul_f32 v[12:13], v[12:13], v[206:207]
  v_cvt_pk_bf16_f32 v90, v12, v13
  v_lshlrev_b32 v12, 16, v90
  v_and_b32 v13, 0xffff0000, v90
  v_pk_mul_f32 v[14:15], v[14:15], v[208:209]
  v_cvt_pk_bf16_f32 v90, v14, v15
  v_lshlrev_b32 v14, 16, v90
  v_and_b32 v15, 0xffff0000, v90
  v_pk_mul_f32 v[16:17], v[16:17], v[210:211]
  v_cvt_pk_bf16_f32 v90, v16, v17
  v_lshlrev_b32 v16, 16, v90
  v_and_b32 v17, 0xffff0000, v90
  v_pk_mul_f32 v[18:19], v[18:19], v[212:213]
  v_cvt_pk_bf16_f32 v90, v18, v19
  v_lshlrev_b32 v18, 16, v90
  v_and_b32 v19, 0xffff0000, v90
  v_pk_mul_f32 v[20:21], v[20:21], v[214:215]
  v_cvt_pk_bf16_f32 v90, v20, v21
  v_lshlrev_b32 v20, 16, v90
  v_and_b32 v21, 0xffff0000, v90
  v_pk_add_f32 v[12:13], v[12:13], v[2:3]
  v_cvt_pk_bf16_f32 v40, v12, v13
  v_pk_add_f32 v[14:15], v[14:15], v[4:5]
  v_cvt_pk_bf16_f32 v41, v14, v15
  v_pk_add_f32 v[16:17], v[16:17], v[6:7]
  v_cvt_pk_bf16_f32 v42, v16, v17
  v_pk_add_f32 v[18:19], v[18:19], v[8:9]
  v_cvt_pk_bf16_f32 v43, v18, v19
  v_pk_add_f32 v[20:21], v[20:21], v[10:11]
  v_cvt_pk_bf16_f32 v44, v20, v21
  buffer_store_dword v40, v226, s[24:27], s37 offen offset:0 sc1
  buffer_store_dword v41, v226, s[24:27], s37 offen offset:256 sc1
  buffer_store_dword v42, v226, s[24:27], s37 offen offset:512 sc1
  buffer_store_dword v43, v226, s[24:27], s37 offen offset:768 sc1
  buffer_store_dword v44, v226, s[24:27], s37 offen offset:1024 sc1
  v_add_f32_dpp v86, v86, v86 row_ror:8 row_mask:0xf bank_mask:0xf
  s_nop 1
  v_add_f32_dpp v86, v86, v86 row_ror:4 row_mask:0xf bank_mask:0xf
  s_nop 1
  v_add_f32_dpp v86, v86, v86 row_ror:2 row_mask:0xf bank_mask:0xf
  s_nop 1
  v_add_f32_dpp v86, v86, v86 row_ror:1 row_mask:0xf bank_mask:0xf
  v_mov_b32 v90, v86
  s_nop 1
  v_permlane16_swap_b32 v86, v90
  v_add_f32 v86, v86, v90
  v_mov_b32 v90, v86
  s_nop 1
  v_permlane32_swap_b32 v86, v90
  v_add_f32 v86, v86, v90
  v_cvt_pk_bf16_f32 v86, v86, v86
  v_lshlrev_b32 v86, 16, v86
  v_ashrrev_i32 v90, 31, v86
  v_or_b32 v90, 0x80000000, v90
  v_xor_b32 v86, v86, v90
  v_and_b32 v86, 0xffff0000, v86
  s_sub_u32 s35, 2047, s40
  v_or_b32 v86, s35, v86
  s_lshr_b32 s35, s40, 2
  s_lshl_b32 s35, s35, 7
  s_lshl_b32 s36, s17, 2
  s_add_u32 s35, s35, s36
  s_add_u32 s35, s35, 2097152
  v_mov_b32 v91, s35
  s_waitcnt vmcnt(0)
  s_mov_b64 exec, 1
  buffer_store_dword v86, v91, s[8:11], 0 offen sc1
  s_mov_b64 exec, -1
  s_cmp_eq_u32 s18, 31
  s_cbranch_scc1 r_nc
  s_lshr_b32 s53, s33, 3
  s_lshl_b32 s53, s53, 1
  s_sub_u32 s53, s53, 1
mc_51_chunk:
  s_cmp_ge_i32 s74, s53
  s_cbranch_scc1 mc_51_done
  s_mov_b32 s69, 0
mc_51_kp:
  buffer_load_dword v235, v234, s[8:11], s75 offen sc1
  s_add_u32 s69, s69, 1
  s_cmp_gt_u32 s69, 65536
  s_cbranch_scc1 role_abort
  s_waitcnt vmcnt(0)
  v_cmp_eq_u32 vcc, -1, v235
  s_cbranch_vccz mc_51_ins
  s_sleep 4
  s_branch mc_51_kp
mc_51_ins:
  v_cmp_lt_u32 vcc, s86, v235
  s_cbranch_vccz mc_51_nx
  s_ff1_i32_b64 s70, vcc
  v_readlane_b32 s76, v235, s70
  v_writelane_b32 v235, 0, s70
  s_min_u32 s77, s79, s76
  s_max_u32 s79, s79, s76
  s_min_u32 s76, s80, s77
  s_max_u32 s80, s80, s77
  s_min_u32 s77, s81, s76
  s_max_u32 s81, s81, s76
  s_min_u32 s76, s82, s77
  s_max_u32 s82, s82, s77
  s_min_u32 s77, s83, s76
  s_max_u32 s83, s83, s76
  s_min_u32 s76, s84, s77
  s_max_u32 s84, s84, s77
  s_min_u32 s77, s85, s76
  s_max_u32 s85, s85, s76
  s_min_u32 s76, s86, s77
  s_max_u32 s86, s86, s77
  s_branch mc_51_ins
mc_51_nx:
  s_add_u32 s75, s75, 2048
  s_add_u32 s74, s74, 1
  s_branch mc_51_chunk
mc_51_done:
r_nc:
  s_add_u32 s33, s33, 8
  s_cmp_lt_u32 s33, 128
  s_cbranch_scc1 r_loop
  s_cmp_eq_u32 s18, 31
  s_cbranch_scc1 moe_end
mc_52_chunk:
  s_cmp_ge_i32 s74, 30
  s_cbranch_scc1 mc_52_done
  s_mov_b32 s69, 0
mc_52_kp:
  buffer_load_dword v235, v234, s[8:11], s75 offen sc1
  s_add_u32 s69, s69, 1
  s_cmp_gt_u32 s69, 65536
  s_cbranch_scc1 role_abort
  s_waitcnt vmcnt(0)
  v_cmp_eq_u32 vcc, -1, v235
  s_cbranch_vccz mc_52_ins
  s_sleep 4
  s_branch mc_52_kp
mc_52_ins:
  v_cmp_lt_u32 vcc, s86, v235
  s_cbranch_vccz mc_52_nx
  s_ff1_i32_b64 s70, vcc
  v_readlane_b32 s76, v235, s70
  v_writelane_b32 v235, 0, s70
  s_min_u32 s77, s79, s76
  s_max_u32 s79, s79, s76
  s_min_u32 s76, s80, s77
  s_max_u32 s80, s80, s77
  s_min_u32 s77, s81, s76
  s_max_u32 s81, s81, s76
  s_min_u32 s76, s82, s77
  s_max_u32 s82, s82, s77
  s_min_u32 s77, s83, s76
  s_max_u32 s83, s83, s76
  s_min_u32 s76, s84, s77
  s_max_u32 s84, s84, s77
  s_min_u32 s77, s85, s76
  s_max_u32 s85, s85, s76
  s_min_u32 s76, s86, s77
  s_max_u32 s86, s86, s77
  s_branch mc_52_ins
mc_52_nx:
  s_add_u32 s75, s75, 2048
  s_add_u32 s74, s74, 1
  s_branch mc_52_chunk
mc_52_done:
  s_mov_b32 s41, 64
  s_mov_b32 s34, 0
pw_53:
  buffer_load_dword v93, v232, s[8:11], 0 offen sc1
  s_add_u32 s34, s34, 1
  s_cmp_gt_u32 s34, 65536
  s_cbranch_scc1 role_abort
  s_waitcnt vmcnt(0)
pc_55:
  v_cmp_gt_u32 vcc, s41, v93
  s_nop 0
  s_and_b32 vcc_lo, vcc_lo, 0xff
  s_and_b32 vcc_hi, vcc_hi, 0x0
  s_cmp_eq_u64 vcc, 0
  s_cbranch_scc1 po_54
  s_sleep 4
  s_branch pw_53
po_54:
mc_56_chunk:
  s_cmp_ge_i32 s74, 31
  s_cbranch_scc1 mc_56_done
  s_mov_b32 s69, 0
mc_56_kp:
  buffer_load_dword v235, v234, s[8:11], s75 offen sc1
  s_add_u32 s69, s69, 1
  s_cmp_gt_u32 s69, 65536
  s_cbranch_scc1 role_abort
  s_waitcnt vmcnt(0)
  v_cmp_eq_u32 vcc, -1, v235
  s_cbranch_vccz mc_56_ins
  s_sleep 4
  s_branch mc_56_kp
mc_56_ins:
  v_cmp_lt_u32 vcc, s86, v235
  s_cbranch_vccz mc_56_nx
  s_ff1_i32_b64 s70, vcc
  v_readlane_b32 s76, v235, s70
  v_writelane_b32 v235, 0, s70
  s_min_u32 s77, s79, s76
  s_max_u32 s79, s79, s76
  s_min_u32 s76, s80, s77
  s_max_u32 s80, s80, s77
  s_min_u32 s77, s81, s76
  s_max_u32 s81, s81, s76
  s_min_u32 s76, s82, s77
  s_max_u32 s82, s82, s77
  s_min_u32 s77, s83, s76
  s_max_u32 s83, s83, s76
  s_min_u32 s76, s84, s77
  s_max_u32 s84, s84, s77
  s_min_u32 s77, s85, s76
  s_max_u32 s85, s85, s76
  s_min_u32 s76, s86, s77
  s_max_u32 s86, s86, s77
  s_branch mc_56_ins
mc_56_nx:
  s_add_u32 s75, s75, 2048
  s_add_u32 s74, s74, 1
  s_branch mc_56_chunk
mc_56_done:
  s_cmp_ge_u32 s16, 4
  s_cbranch_scc1 r_c31
  s_sleep 32
r_c31:
mc_57_chunk:
  s_cmp_ge_i32 s74, 32
  s_cbranch_scc1 mc_57_done
  s_mov_b32 s69, 0
mc_57_kp:
  buffer_load_dword v235, v234, s[8:11], s75 offen sc1
  s_add_u32 s69, s69, 1
  s_cmp_gt_u32 s69, 65536
  s_cbranch_scc1 role_abort
  s_waitcnt vmcnt(0)
  v_cmp_eq_u32 vcc, -1, v235
  s_cbranch_vccz mc_57_ins
  s_sleep 4
  s_branch mc_57_kp
mc_57_ins:
  v_cmp_lt_u32 vcc, s86, v235
  s_cbranch_vccz mc_57_nx
  s_ff1_i32_b64 s70, vcc
  v_readlane_b32 s76, v235, s70
  v_writelane_b32 v235, 0, s70
  s_min_u32 s77, s79, s76
  s_max_u32 s79, s79, s76
  s_min_u32 s76, s80, s77
  s_max_u32 s80, s80, s77
  s_min_u32 s77, s81, s76
  s_max_u32 s81, s81, s76
  s_min_u32 s76, s82, s77
  s_max_u32 s82, s82, s77
  s_min_u32 s77, s83, s76
  s_max_u32 s83, s83, s76
  s_min_u32 s76, s84, s77
  s_max_u32 s84, s84, s77
  s_min_u32 s77, s85, s76
  s_max_u32 s85, s85, s76
  s_min_u32 s76, s86, s77
  s_max_u32 s86, s86, s77
  s_branch mc_57_ins
mc_57_nx:
  s_add_u32 s75, s75, 2048
  s_add_u32 s74, s74, 1
  s_branch mc_57_chunk
mc_57_done:
  s_mov_b32 exec_lo, 0x1010101
  s_mov_b32 exec_hi, 0x1010101
  v_mov_b32 v120, s79
  s_mov_b32 exec_lo, 0x2020202
  s_mov_b32 exec_hi, 0x2020202
  v_mov_b32 v120, s80
  s_mov_b32 exec_lo, 0x4040404
  s_mov_b32 exec_hi, 0x4040404
  v_mov_b32 v120, s81
  s_mov_b32 exec_lo, 0x8080808
  s_mov_b32 exec_hi, 0x8080808
  v_mov_b32 v120, s82
  s_mov_b32 exec_lo, 0x10101010
  s_mov_b32 exec_hi, 0x10101010
  v_mov_b32 v120, s83
  s_mov_b32 exec_lo, 0x20202020
  s_mov_b32 exec_hi, 0x20202020
  v_mov_b32 v120, s84
  s_mov_b32 exec_lo, 0x40404040
  s_mov_b32 exec_hi, 0x40404040
  v_mov_b32 v120, s85
  s_mov_b32 exec_lo, 0x80808080
  s_mov_b32 exec_hi, 0x80808080
  v_mov_b32 v120, s86
  s_mov_b64 exec, -1
  v_and_b32 v124, 0x7ff, v120
  v_sub_u32 v124, 2047, v124
  v_mul_u32_u24 v122, 1280, v124
  v_lshrrev_b32 v125, 4, v1
  v_lshl_add_u32 v121, v125, 4, v122
  s_mul_i32 s70, s17, 320
  s_add_u32 s70, s70, 8388608
  buffer_load_dwordx4 v[4:7], v121, s[8:11], s70 offen offset:0 sc1
  buffer_load_dwordx4 v[8:11], v121, s[8:11], s70 offen offset:64 sc1
  buffer_load_dwordx4 v[12:15], v121, s[8:11], s70 offen offset:128 sc1
  buffer_load_dwordx4 v[16:19], v121, s[8:11], s70 offen offset:192 sc1
  buffer_load_dwordx4 v[20:23], v121, s[8:11], s70 offen offset:256 sc1
  v_bfe_u32 v125, v1, 3, 2
  s_min_u32 s72, s78, 39
  s_lshl_b32 s71, s72, 5
  v_lshl_add_u32 v126, v125, 3, s71
  v_add_u32 v122, v122, v126
  v_lshlrev_b32 v126, 1, v126
  s_mov_b32 s70, 5242880
  s_mov_b32 s71, 8388608
  s_mov_b32 s76, 78336
  buffer_load_dwordx2 v[128:129], v122, s[8:11], s70 offen sc1
  buffer_load_dwordx2 v[130:131], v122, s[8:11], s71 offen sc1
  buffer_load_dwordx4 v[132:135], v126, s[8:11], s76 offen sc1
  v_and_b32 v124, 0xffff0000, v120
  v_ashrrev_i32 v125, 31, v124
  v_not_b32 v125, v125
  v_or_b32 v125, 0x80000000, v125
  v_and_b32 v125, 0xffff0000, v125
  v_xor_b32 v124, v124, v125
  v_mul_f32 v124, 0xbfb8aa3b, v124
  v_exp_f32 v124, v124
  s_nop 0
  v_add_f32 v124, 1.0, v124
  v_rcp_f32 v124, v124
  s_nop 0
  v_cvt_pk_bf16_f32 v124, v124, v124
  v_lshlrev_b32 v123, 16, v124
  s_lshl_b32 s70, s17, 13
  v_add_u32 v126, s70, v233
  s_lshl_b32 s70, s17, 10
  v_add_u32 v127, s70, v233
  s_waitcnt vmcnt(7)
  v_mfma_f32_16x16x32_bf16 v[24:27], a[0:3], v[4:7], 0
  v_mfma_f32_16x16x32_bf16 v[28:31], a[20:23], v[4:7], 0
  v_mfma_f32_16x16x32_bf16 v[32:35], a[40:43], v[4:7], 0
  v_mfma_f32_16x16x32_bf16 v[36:39], a[60:63], v[4:7], 0
  v_mfma_f32_16x16x32_bf16 v[40:43], a[80:83], v[4:7], 0
  v_mfma_f32_16x16x32_bf16 v[44:47], a[100:103], v[4:7], 0
  v_mfma_f32_16x16x32_bf16 v[48:51], a[120:123], v[4:7], 0
  v_mfma_f32_16x16x32_bf16 v[52:55], a[140:143], v[4:7], 0
  s_waitcnt vmcnt(6)
  v_mfma_f32_16x16x32_bf16 v[24:27], a[4:7], v[8:11], v[24:27]
  v_mfma_f32_16x16x32_bf16 v[28:31], a[24:27], v[8:11], v[28:31]
  v_mfma_f32_16x16x32_bf16 v[32:35], a[44:47], v[8:11], v[32:35]
  v_mfma_f32_16x16x32_bf16 v[36:39], a[64:67], v[8:11], v[36:39]
  v_mfma_f32_16x16x32_bf16 v[40:43], a[84:87], v[8:11], v[40:43]
  v_mfma_f32_16x16x32_bf16 v[44:47], a[104:107], v[8:11], v[44:47]
  v_mfma_f32_16x16x32_bf16 v[48:51], a[124:127], v[8:11], v[48:51]
  v_mfma_f32_16x16x32_bf16 v[52:55], a[144:147], v[8:11], v[52:55]
  s_waitcnt vmcnt(5)
  v_mfma_f32_16x16x32_bf16 v[24:27], a[8:11], v[12:15], v[24:27]
  v_mfma_f32_16x16x32_bf16 v[28:31], a[28:31], v[12:15], v[28:31]
  v_mfma_f32_16x16x32_bf16 v[32:35], a[48:51], v[12:15], v[32:35]
  v_mfma_f32_16x16x32_bf16 v[36:39], a[68:71], v[12:15], v[36:39]
  v_mfma_f32_16x16x32_bf16 v[40:43], a[88:91], v[12:15], v[40:43]
  v_mfma_f32_16x16x32_bf16 v[44:47], a[108:111], v[12:15], v[44:47]
  v_mfma_f32_16x16x32_bf16 v[48:51], a[128:131], v[12:15], v[48:51]
  v_mfma_f32_16x16x32_bf16 v[52:55], a[148:151], v[12:15], v[52:55]
  s_waitcnt vmcnt(4)
  v_mfma_f32_16x16x32_bf16 v[24:27], a[12:15], v[16:19], v[24:27]
  v_mfma_f32_16x16x32_bf16 v[28:31], a[32:35], v[16:19], v[28:31]
  v_mfma_f32_16x16x32_bf16 v[32:35], a[52:55], v[16:19], v[32:35]
  v_mfma_f32_16x16x32_bf16 v[36:39], a[72:75], v[16:19], v[36:39]
  v_mfma_f32_16x16x32_bf16 v[40:43], a[92:95], v[16:19], v[40:43]
  v_mfma_f32_16x16x32_bf16 v[44:47], a[112:115], v[16:19], v[44:47]
  v_mfma_f32_16x16x32_bf16 v[48:51], a[132:135], v[16:19], v[48:51]
  v_mfma_f32_16x16x32_bf16 v[52:55], a[152:155], v[16:19], v[52:55]
  s_waitcnt vmcnt(3)
  v_mfma_f32_16x16x32_bf16 v[24:27], a[16:19], v[20:23], v[24:27]
  v_mfma_f32_16x16x32_bf16 v[28:31], a[36:39], v[20:23], v[28:31]
  v_mfma_f32_16x16x32_bf16 v[32:35], a[56:59], v[20:23], v[32:35]
  v_mfma_f32_16x16x32_bf16 v[36:39], a[76:79], v[20:23], v[36:39]
  v_mfma_f32_16x16x32_bf16 v[40:43], a[96:99], v[20:23], v[40:43]
  v_mfma_f32_16x16x32_bf16 v[44:47], a[116:119], v[20:23], v[44:47]
  v_mfma_f32_16x16x32_bf16 v[48:51], a[136:139], v[20:23], v[48:51]
  v_mfma_f32_16x16x32_bf16 v[52:55], a[156:159], v[20:23], v[52:55]
  s_nop 0
  ds_write_b128 v126, v[24:27] offset:0
  ds_write_b128 v126, v[28:31] offset:1024
  ds_write_b128 v126, v[32:35] offset:2048
  ds_write_b128 v126, v[36:39] offset:3072
  ds_write_b128 v126, v[40:43] offset:4096
  ds_write_b128 v126, v[44:47] offset:5120
  ds_write_b128 v126, v[48:51] offset:6144
  ds_write_b128 v126, v[52:55] offset:7168
  s_waitcnt lgkmcnt(0)
  s_barrier
  ds_read_b128 v[64:67], v127 offset:0
  ds_read_b128 v[80:83], v127 offset:4096
  ds_read_b128 v[68:71], v127 offset:8192
  ds_read_b128 v[84:87], v127 offset:12288
  ds_read_b128 v[72:75], v127 offset:16384
  ds_read_b128 v[88:91], v127 offset:20480
  ds_read_b128 v[76:79], v127 offset:24576
  ds_read_b128 v[92:95], v127 offset:28672
  s_waitcnt lgkmcnt(0)
  v_pk_add_f32 v[64:65], v[64:65], v[68:69]
  v_pk_add_f32 v[72:73], v[72:73], v[76:77]
  v_pk_add_f32 v[66:67], v[66:67], v[70:71]
  v_pk_add_f32 v[74:75], v[74:75], v[78:79]
  v_pk_add_f32 v[64:65], v[64:65], v[72:73]
  v_cvt_pk_bf16_f32 v124, v64, v65
  v_lshlrev_b32 v64, 16, v124
  v_and_b32 v65, 0xffff0000, v124
  v_pk_add_f32 v[66:67], v[66:67], v[74:75]
  v_cvt_pk_bf16_f32 v124, v66, v67
  v_lshlrev_b32 v66, 16, v124
  v_and_b32 v67, 0xffff0000, v124
  v_pk_add_f32 v[80:81], v[80:81], v[84:85]
  v_pk_add_f32 v[88:89], v[88:89], v[92:93]
  v_pk_add_f32 v[82:83], v[82:83], v[86:87]
  v_pk_add_f32 v[90:91], v[90:91], v[94:95]
  v_pk_add_f32 v[80:81], v[80:81], v[88:89]
  v_cvt_pk_bf16_f32 v124, v80, v81
  v_lshlrev_b32 v80, 16, v124
  v_and_b32 v81, 0xffff0000, v124
  v_pk_add_f32 v[82:83], v[82:83], v[90:91]
  v_cvt_pk_bf16_f32 v124, v82, v83
  v_lshlrev_b32 v82, 16, v124
  v_and_b32 v83, 0xffff0000, v124
  v_mul_f32 v140, 0xbfb8aa3b, v64
  v_mul_f32 v141, 0xbfb8aa3b, v65
  v_mul_f32 v142, 0xbfb8aa3b, v66
  v_mul_f32 v143, 0xbfb8aa3b, v67
  v_exp_f32 v140, v140
  v_exp_f32 v141, v141
  v_exp_f32 v142, v142
  v_exp_f32 v143, v143
  v_add_f32 v140, 1.0, v140
  v_add_f32 v141, 1.0, v141
  v_add_f32 v142, 1.0, v142
  v_add_f32 v143, 1.0, v143
  v_rcp_f32 v140, v140
  v_rcp_f32 v141, v141
  v_rcp_f32 v142, v142
  v_rcp_f32 v143, v143
  v_pk_mul_f32 v[64:65], v[64:65], v[140:141]
  v_cvt_pk_bf16_f32 v124, v64, v65
  v_lshlrev_b32 v64, 16, v124
  v_and_b32 v65, 0xffff0000, v124
  v_pk_mul_f32 v[64:65], v[64:65], v[80:81]
  v_cvt_pk_bf16_f32 v140, v64, v65
  v_pk_mul_f32 v[66:67], v[66:67], v[142:143]
  v_cvt_pk_bf16_f32 v124, v66, v67
  v_lshlrev_b32 v66, 16, v124
  v_and_b32 v67, 0xffff0000, v124
  v_pk_mul_f32 v[66:67], v[66:67], v[82:83]
  v_cvt_pk_bf16_f32 v141, v66, v67
  s_lshr_b32 s70, s17, 1
  s_lshl_b32 s70, s70, 10
  s_and_b32 s71, s17, 1
  s_lshl_b32 s71, s71, 3
  s_add_u32 s70, s70, s71
  v_add_u32 v126, s70, v233
  ds_write_b64 v126, v[140:141] offset:32768
  s_waitcnt lgkmcnt(0)
  s_barrier
  ds_read_b128 v[112:115], v233 offset:32768
  ds_read_b128 v[116:119], v233 offset:33792
  s_mul_i32 s70, s68, 20480
  s_mul_i32 s71, s17, 5120
  s_add_u32 s70, s70, s71
  s_add_u32 s70, s70, 2326528
  s_add_u32 s71, s70, 4096
  s_waitcnt lgkmcnt(0)
  v_mfma_f32_16x16x32_bf16 v[24:27], a[160:163], v[112:115], 0
  v_mfma_f32_16x16x32_bf16 v[28:31], a[168:171], v[112:115], 0
  v_mfma_f32_16x16x32_bf16 v[32:35], a[176:179], v[112:115], 0
  v_mfma_f32_16x16x32_bf16 v[36:39], a[184:187], v[112:115], 0
  v_mfma_f32_16x16x32_bf16 v[40:43], a[192:195], v[112:115], 0
  v_mfma_f32_16x16x32_bf16 v[44:47], a[200:203], v[112:115], 0
  v_mfma_f32_16x16x32_bf16 v[48:51], a[208:211], v[112:115], 0
  v_mfma_f32_16x16x32_bf16 v[52:55], a[216:219], v[112:115], 0
  v_mfma_f32_16x16x32_bf16 v[56:59], a[224:227], v[112:115], 0
  v_mfma_f32_16x16x32_bf16 v[60:63], a[232:235], v[112:115], 0
  v_mfma_f32_16x16x32_bf16 v[24:27], a[164:167], v[116:119], v[24:27]
  v_mfma_f32_16x16x32_bf16 v[28:31], a[172:175], v[116:119], v[28:31]
  v_mfma_f32_16x16x32_bf16 v[32:35], a[180:183], v[116:119], v[32:35]
  v_mfma_f32_16x16x32_bf16 v[36:39], a[188:191], v[116:119], v[36:39]
  v_mfma_f32_16x16x32_bf16 v[40:43], a[196:199], v[116:119], v[40:43]
  v_mfma_f32_16x16x32_bf16 v[44:47], a[204:207], v[116:119], v[44:47]
  v_mfma_f32_16x16x32_bf16 v[48:51], a[212:215], v[116:119], v[48:51]
  v_mfma_f32_16x16x32_bf16 v[52:55], a[220:223], v[116:119], v[52:55]
  v_mfma_f32_16x16x32_bf16 v[56:59], a[228:231], v[116:119], v[56:59]
  v_mfma_f32_16x16x32_bf16 v[60:63], a[236:239], v[116:119], v[60:63]
  s_mov_b32 exec_lo, 0x00ff00ff
  s_mov_b32 exec_hi, 0x00ff00ff
  buffer_store_dwordx4 v[24:27], v236, s[8:11], s70 offen offset:0 sc1
  buffer_store_dwordx4 v[28:31], v236, s[8:11], s70 offen offset:512 sc1
  buffer_store_dwordx4 v[32:35], v236, s[8:11], s70 offen offset:1024 sc1
  buffer_store_dwordx4 v[36:39], v236, s[8:11], s70 offen offset:1536 sc1
  buffer_store_dwordx4 v[40:43], v236, s[8:11], s70 offen offset:2048 sc1
  buffer_store_dwordx4 v[44:47], v236, s[8:11], s70 offen offset:2560 sc1
  buffer_store_dwordx4 v[48:51], v236, s[8:11], s70 offen offset:3072 sc1
  buffer_store_dwordx4 v[52:55], v236, s[8:11], s70 offen offset:3584 sc1
  buffer_store_dwordx4 v[56:59], v236, s[8:11], s71 offen offset:0 sc1
  buffer_store_dwordx4 v[60:63], v236, s[8:11], s71 offen offset:512 sc1
  s_mov_b64 exec, -1
  s_cmp_ge_u32 s78, 40
  s_cbranch_scc1 moe_end
  s_lshl_b32 s72, s78, 9
  s_add_u32 s72, s72, 2326528
  s_sleep 8
  s_mov_b32 s69, 0
moe_yp:
  s_mov_b32 s70, s72
  buffer_load_dwordx4 v[64:67], v237, s[8:11], s70 offen sc1
  s_add_u32 s70, s70, 40960
  buffer_load_dwordx4 v[68:71], v237, s[8:11], s70 offen sc1
  s_add_u32 s70, s70, 40960
  buffer_load_dwordx4 v[72:75], v237, s[8:11], s70 offen sc1
  s_add_u32 s70, s70, 40960
  buffer_load_dwordx4 v[76:79], v237, s[8:11], s70 offen sc1
  s_add_u32 s70, s70, 40960
  buffer_load_dwordx4 v[80:83], v237, s[8:11], s70 offen sc1
  s_add_u32 s70, s70, 40960
  buffer_load_dwordx4 v[84:87], v237, s[8:11], s70 offen sc1
  s_add_u32 s70, s70, 40960
  buffer_load_dwordx4 v[88:91], v237, s[8:11], s70 offen sc1
  s_add_u32 s70, s70, 40960
  buffer_load_dwordx4 v[92:95], v237, s[8:11], s70 offen sc1
  s_add_u32 s70, s70, 40960
  buffer_load_dwordx4 v[96:99], v237, s[8:11], s70 offen sc1
  s_add_u32 s70, s70, 40960
  buffer_load_dwordx4 v[100:103], v237, s[8:11], s70 offen sc1
  s_add_u32 s70, s70, 40960
  buffer_load_dwordx4 v[104:107], v237, s[8:11], s70 offen sc1
  s_add_u32 s70, s70, 40960
  buffer_load_dwordx4 v[108:111], v237, s[8:11], s70 offen sc1
  s_add_u32 s70, s70, 40960
  s_add_u32 s69, s69, 1
  s_cmp_gt_u32 s69, 65536
  s_cbranch_scc1 role_abort
  s_waitcnt vmcnt(10)
  v_pk_add_f32 v[136:137], v[64:65], v[68:69]
  v_pk_add_f32 v[138:139], v[66:67], v[70:71]
  s_waitcnt vmcnt(9)
  v_pk_add_f32 v[136:137], v[136:137], v[72:73]
  v_pk_add_f32 v[138:139], v[138:139], v[74:75]
  s_waitcnt vmcnt(8)
  v_pk_add_f32 v[136:137], v[136:137], v[76:77]
  v_pk_add_f32 v[138:139], v[138:139], v[78:79]
  s_waitcnt vmcnt(7)
  v_pk_add_f32 v[136:137], v[136:137], v[80:81]
  v_pk_add_f32 v[138:139], v[138:139], v[82:83]
  s_waitcnt vmcnt(6)
  v_pk_add_f32 v[136:137], v[136:137], v[84:85]
  v_pk_add_f32 v[138:139], v[138:139], v[86:87]
  s_waitcnt vmcnt(5)
  v_pk_add_f32 v[136:137], v[136:137], v[88:89]
  v_pk_add_f32 v[138:139], v[138:139], v[90:91]
  s_waitcnt vmcnt(4)
  v_pk_add_f32 v[136:137], v[136:137], v[92:93]
  v_pk_add_f32 v[138:139], v[138:139], v[94:95]
  s_waitcnt vmcnt(3)
  v_pk_add_f32 v[136:137], v[136:137], v[96:97]
  v_pk_add_f32 v[138:139], v[138:139], v[98:99]
  s_waitcnt vmcnt(2)
  v_pk_add_f32 v[136:137], v[136:137], v[100:101]
  v_pk_add_f32 v[138:139], v[138:139], v[102:103]
  s_waitcnt vmcnt(1)
  v_pk_add_f32 v[136:137], v[136:137], v[104:105]
  v_pk_add_f32 v[138:139], v[138:139], v[106:107]
  s_waitcnt vmcnt(0)
  v_pk_add_f32 v[136:137], v[136:137], v[108:109]
  v_pk_add_f32 v[138:139], v[138:139], v[110:111]
  v_add_f32 v124, v136, v137
  v_add_f32 v125, v138, v139
  v_cmp_u_f32 vcc, v124, v125
  s_cbranch_vccz moe_yok
  s_sleep 2
  s_branch moe_yp
moe_yok:
  v_mov_b32 v140, v136
  v_mov_b32 v141, v137
  v_mov_b32 v142, v138
  v_mov_b32 v143, v139
  v_permlane32_swap_b32 v136, v140
  v_permlane32_swap_b32 v137, v141
  v_permlane32_swap_b32 v138, v142
  v_permlane32_swap_b32 v139, v143
  v_lshlrev_b32 v64, 16, v128
  v_and_b32 v65, 0xffff0000, v128
  v_lshlrev_b32 v68, 16, v130
  v_and_b32 v69, 0xffff0000, v130
  v_lshlrev_b32 v66, 16, v129
  v_and_b32 v67, 0xffff0000, v129
  v_lshlrev_b32 v70, 16, v131
  v_and_b32 v71, 0xffff0000, v131
  v_pk_add_f32 v[136:137], v[136:137], v[140:141]
  v_cvt_pk_bf16_f32 v124, v136, v137
  v_lshlrev_b32 v136, 16, v124
  v_and_b32 v137, 0xffff0000, v124
  v_mul_f32 v136, v136, v123
  v_mul_f32 v137, v137, v123
  v_cvt_pk_bf16_f32 v124, v136, v137
  v_lshlrev_b32 v136, 16, v124
  v_and_b32 v137, 0xffff0000, v124
  v_pk_add_f32 v[136:137], v[136:137], v[68:69]
  v_cvt_pk_bf16_f32 v124, v136, v137
  v_lshlrev_b32 v136, 16, v124
  v_and_b32 v137, 0xffff0000, v124
  v_pk_mul_f32 v[136:137], v[136:137], v[132:133]
  v_cvt_pk_bf16_f32 v124, v136, v137
  v_lshlrev_b32 v136, 16, v124
  v_and_b32 v137, 0xffff0000, v124
  v_pk_add_f32 v[136:137], v[136:137], v[64:65]
  v_cvt_pk_bf16_f32 v140, v136, v137
  v_pk_add_f32 v[138:139], v[138:139], v[142:143]
  v_cvt_pk_bf16_f32 v124, v138, v139
  v_lshlrev_b32 v138, 16, v124
  v_and_b32 v139, 0xffff0000, v124
  v_mul_f32 v138, v138, v123
  v_mul_f32 v139, v139, v123
  v_cvt_pk_bf16_f32 v124, v138, v139
  v_lshlrev_b32 v138, 16, v124
  v_and_b32 v139, 0xffff0000, v124
  v_pk_add_f32 v[138:139], v[138:139], v[70:71]
  v_cvt_pk_bf16_f32 v124, v138, v139
  v_lshlrev_b32 v138, 16, v124
  v_and_b32 v139, 0xffff0000, v124
  v_pk_mul_f32 v[138:139], v[138:139], v[134:135]
  v_cvt_pk_bf16_f32 v124, v138, v139
  v_lshlrev_b32 v138, 16, v124
  v_and_b32 v139, 0xffff0000, v124
  v_pk_add_f32 v[138:139], v[138:139], v[66:67]
  v_cvt_pk_bf16_f32 v141, v138, v139
  s_mov_b32 exec_hi, 0
  buffer_store_dwordx2 v[140:141], v122, s[24:27], 0 offen sc1
moe_end:
  s_endpgm
role_chain:
  s_load_dwordx2 s[20:21], s[0:1], 16
  s_mov_b32 s22, 7864320
  s_mov_b32 s23, 0x00020000
  s_load_dwordx2 s[24:25], s[0:1], 24
  s_mov_b32 s26, 7864320
  s_mov_b32 s27, 0x00020000
  s_load_dwordx2 s[28:29], s[0:1], 32
  s_mov_b32 s30, 7864320
  s_mov_b32 s31, 0x00020000
  s_load_dwordx2 s[32:33], s[0:1], 40
  s_mov_b32 s34, 7864320
  s_mov_b32 s35, 0x00020000
  s_mov_b32 s36, s18
  s_mul_i32 s37, s36, 43
  s_lshr_b32 s37, s37, 7
  s_mul_i32 s42, s37, 3
  s_sub_u32 s38, s36, s42
  s_lshl_b32 s39, s16, 2
  s_add_u32 s39, s39, s37
  v_lshrrev_b32 v140, 4, v1
  v_and_b32 v140, 3, v140
  v_lshlrev_b32 v140, 1, v140
  v_and_b32 v4, 7, v1
  v_xor_b32 v4, v4, v140
  v_lshlrev_b32 v4, 4, v4
  v_lshrrev_b32 v140, 3, v1
  v_mul_u32_u24 v140, 12288, v140
  v_add_u32 v4, v4, v140
  s_lshl_b32 s42, s17, 1
  v_lshrrev_b32 v140, 2, v1
  v_lshrrev_b32 v141, 1, v140
  v_and_b32 v141, 3, v141
  v_lshlrev_b32 v141, 1, v141
  v_bfe_u32 v6, v1, 1, 1
  v_add_u32 v6, s42, v6
  v_xor_b32 v6, v6, v141
  v_lshlrev_b32 v6, 4, v6
  v_lshlrev_b32 v140, 7, v140
  v_add_u32 v6, v6, v140
  v_and_b32 v140, 1, v1
  v_lshlrev_b32 v140, 3, v140
  v_add_u32 v6, v6, v140
  v_add_u32 v7, 40960, v6
  v_add_u32 v8, 81920, v6
  v_add_u32 v9, 122880, v6
  v_lshrrev_b32 v140, 4, v1
  v_and_b32 v140, 3, v140
  v_lshlrev_b32 v140, 1, v140
  v_and_b32 v5, 7, v1
  v_xor_b32 v5, v5, v140
  v_lshlrev_b32 v5, 4, v5
  v_lshrrev_b32 v140, 3, v1
  v_mul_u32_u24 v140, 0, v140
  v_add_u32 v5, v5, v140
  v_bfe_u32 v140, v1, 3, 2
  v_lshlrev_b32 v140, 2, v140
  v_bfe_u32 v141, v1, 5, 1
  v_lshl_add_u32 v140, v141, 1, v140
  v_mul_u32_u24 v140, 1280, v140
  v_add_u32 v5, v5, v140
  s_mul_i32 s45, s17, 10240
  v_lshrrev_b32 v140, 2, v1
  v_lshrrev_b32 v141, 1, v140
  v_and_b32 v141, 3, v141
  v_lshlrev_b32 v141, 1, v141
  v_bfe_u32 v10, v1, 1, 1
  v_add_u32 v10, 0, v10
  v_xor_b32 v10, v10, v141
  v_lshlrev_b32 v10, 4, v10
  v_lshlrev_b32 v140, 7, v140
  v_add_u32 v10, v10, v140
  v_and_b32 v140, 1, v1
  v_lshlrev_b32 v140, 3, v140
  v_add_u32 v10, v10, v140
  v_add_u32 v10, s45, v10
  v_lshrrev_b32 v140, 2, v1
  v_lshrrev_b32 v141, 1, v140
  v_and_b32 v141, 3, v141
  v_lshlrev_b32 v141, 1, v141
  v_bfe_u32 v11, v1, 1, 1
  v_add_u32 v11, 2, v11
  v_xor_b32 v11, v11, v141
  v_lshlrev_b32 v11, 4, v11
  v_lshlrev_b32 v140, 7, v140
  v_add_u32 v11, v11, v140
  v_and_b32 v140, 1, v1
  v_lshlrev_b32 v140, 3, v140
  v_add_u32 v11, v11, v140
  v_add_u32 v11, s45, v11
  v_lshrrev_b32 v140, 2, v1
  v_lshrrev_b32 v141, 1, v140
  v_and_b32 v141, 3, v141
  v_lshlrev_b32 v141, 1, v141
  v_bfe_u32 v12, v1, 1, 1
  v_add_u32 v12, 4, v12
  v_xor_b32 v12, v12, v141
  v_lshlrev_b32 v12, 4, v12
  v_lshlrev_b32 v140, 7, v140
  v_add_u32 v12, v12, v140
  v_and_b32 v140, 1, v1
  v_lshlrev_b32 v140, 3, v140
  v_add_u32 v12, v12, v140
  v_add_u32 v12, s45, v12
  v_lshrrev_b32 v140, 2, v1
  v_lshrrev_b32 v141, 1, v140
  v_and_b32 v141, 3, v141
  v_lshlrev_b32 v141, 1, v141
  v_bfe_u32 v13, v1, 1, 1
  v_add_u32 v13, 6, v13
  v_xor_b32 v13, v13, v141
  v_lshlrev_b32 v13, 4, v13
  v_lshlrev_b32 v140, 7, v140
  v_add_u32 v13, v13, v140
  v_and_b32 v140, 1, v1
  v_lshlrev_b32 v140, 3, v140
  v_add_u32 v13, v13, v140
  v_add_u32 v13, s45, v13
  s_mul_i32 s43, s39, 384
  s_lshl_b32 s42, s38, 7
  s_add_u32 s43, s43, s42
  s_mul_i32 s42, s17, 983040
  s_add_u32 s43, s43, s42
  s_lshl_b32 s42, s16, 2
  s_add_u32 s42, s42, s17
  s_mul_i32 s44, s42, 245760
  s_min_u32 s42, s36, 9
  s_lshl_b32 s42, s42, 7
  s_add_u32 s44, s44, s42
  s_waitcnt lgkmcnt(0)
  s_add_u32 m0, s45, 0
  s_add_u32 s42, s43, 3932160
  buffer_load_dwordx4 v4, s[28:31], s42 offen nt lds
  s_add_u32 m0, s45, 1024
  s_add_u32 s42, s43, 4030464
  buffer_load_dwordx4 v4, s[28:31], s42 offen nt lds
  s_add_u32 m0, s45, 2048
  s_add_u32 s42, s43, 4128768
  buffer_load_dwordx4 v4, s[28:31], s42 offen nt lds
  s_add_u32 m0, s45, 3072
  s_add_u32 s42, s43, 4227072
  buffer_load_dwordx4 v4, s[28:31], s42 offen nt lds
  s_add_u32 m0, s45, 4096
  s_add_u32 s42, s43, 4325376
  buffer_load_dwordx4 v4, s[28:31], s42 offen nt lds
  s_add_u32 m0, s45, 5120
  s_add_u32 s42, s43, 4423680
  buffer_load_dwordx4 v4, s[28:31], s42 offen nt lds
  s_add_u32 m0, s45, 6144
  s_add_u32 s42, s43, 4521984
  buffer_load_dwordx4 v4, s[28:31], s42 offen nt lds
  s_add_u32 m0, s45, 7168
  s_add_u32 s42, s43, 4620288
  buffer_load_dwordx4 v4, s[28:31], s42 offen nt lds
  s_add_u32 m0, s45, 8192
  s_add_u32 s42, s43, 4718592
  buffer_load_dwordx4 v4, s[28:31], s42 offen nt lds
  s_add_u32 m0, s45, 9216
  s_add_u32 s42, s43, 4816896
  buffer_load_dwordx4 v4, s[28:31], s42 offen nt lds
  s_add_u32 m0, s45, 40960
  s_add_u32 s42, s43, 3932160
  buffer_load_dwordx4 v4, s[24:27], s42 offen nt lds
  s_add_u32 m0, s45, 41984
  s_add_u32 s42, s43, 4030464
  buffer_load_dwordx4 v4, s[24:27], s42 offen nt lds
  s_add_u32 m0, s45, 43008
  s_add_u32 s42, s43, 4128768
  buffer_load_dwordx4 v4, s[24:27], s42 offen nt lds
  s_add_u32 m0, s45, 44032
  s_add_u32 s42, s43, 4227072
  buffer_load_dwordx4 v4, s[24:27], s42 offen nt lds
  s_add_u32 m0, s45, 45056
  s_add_u32 s42, s43, 4325376
  buffer_load_dwordx4 v4, s[24:27], s42 offen nt lds
  s_add_u32 m0, s45, 46080
  s_add_u32 s42, s43, 4423680
  buffer_load_dwordx4 v4, s[24:27], s42 offen nt lds
  s_add_u32 m0, s45, 47104
  s_add_u32 s42, s43, 4521984
  buffer_load_dwordx4 v4, s[24:27], s42 offen nt lds
  s_add_u32 m0, s45, 48128
  s_add_u32 s42, s43, 4620288
  buffer_load_dwordx4 v4, s[24:27], s42 offen nt lds
  s_add_u32 m0, s45, 49152
  s_add_u32 s42, s43, 4718592
  buffer_load_dwordx4 v4, s[24:27], s42 offen nt lds
  s_add_u32 m0, s45, 50176
  s_add_u32 s42, s43, 4816896
  buffer_load_dwordx4 v4, s[24:27], s42 offen nt lds
  s_waitcnt vmcnt(10)
  s_add_u32 m0, s45, 81920
  s_add_u32 s42, s43, 3932160
  buffer_load_dwordx4 v4, s[20:23], s42 offen nt lds
  s_add_u32 m0, s45, 82944
  s_add_u32 s42, s43, 4030464
  buffer_load_dwordx4 v4, s[20:23], s42 offen nt lds
  s_add_u32 m0, s45, 83968
  s_add_u32 s42, s43, 4128768
  buffer_load_dwordx4 v4, s[20:23], s42 offen nt lds
  s_add_u32 m0, s45, 84992
  s_add_u32 s42, s43, 4227072
  buffer_load_dwordx4 v4, s[20:23], s42 offen nt lds
  s_add_u32 m0, s45, 86016
  s_add_u32 s42, s43, 4325376
  buffer_load_dwordx4 v4, s[20:23], s42 offen nt lds
  s_add_u32 m0, s45, 87040
  s_add_u32 s42, s43, 4423680
  buffer_load_dwordx4 v4, s[20:23], s42 offen nt lds
  s_add_u32 m0, s45, 88064
  s_add_u32 s42, s43, 4521984
  buffer_load_dwordx4 v4, s[20:23], s42 offen nt lds
  s_add_u32 m0, s45, 89088
  s_add_u32 s42, s43, 4620288
  buffer_load_dwordx4 v4, s[20:23], s42 offen nt lds
  s_add_u32 m0, s45, 90112
  s_add_u32 s42, s43, 4718592
  buffer_load_dwordx4 v4, s[20:23], s42 offen nt lds
  s_add_u32 m0, s45, 91136
  s_add_u32 s42, s43, 4816896
  buffer_load_dwordx4 v4, s[20:23], s42 offen nt lds
  s_barrier
  ds_read_b64_tr_b16 a[200:201], v6 offset:0
  ds_read_b64_tr_b16 a[202:203], v6 offset:2048
  ds_read_b64_tr_b16 a[204:205], v6 offset:4096
  ds_read_b64_tr_b16 a[206:207], v6 offset:6144
  ds_read_b64_tr_b16 a[208:209], v6 offset:8192
  ds_read_b64_tr_b16 a[210:211], v6 offset:10240
  ds_read_b64_tr_b16 a[212:213], v6 offset:12288
  ds_read_b64_tr_b16 a[214:215], v6 offset:14336
  ds_read_b64_tr_b16 a[216:217], v6 offset:16384
  ds_read_b64_tr_b16 a[218:219], v6 offset:18432
  ds_read_b64_tr_b16 a[220:221], v6 offset:20480
  ds_read_b64_tr_b16 a[222:223], v6 offset:22528
  ds_read_b64_tr_b16 a[224:225], v6 offset:24576
  ds_read_b64_tr_b16 a[226:227], v6 offset:26624
  ds_read_b64_tr_b16 a[228:229], v6 offset:28672
  ds_read_b64_tr_b16 a[230:231], v6 offset:30720
  ds_read_b64_tr_b16 a[232:233], v6 offset:32768
  ds_read_b64_tr_b16 a[234:235], v6 offset:34816
  ds_read_b64_tr_b16 a[236:237], v6 offset:36864
  ds_read_b64_tr_b16 a[238:239], v6 offset:38912
  s_waitcnt lgkmcnt(0)
  s_barrier
  s_waitcnt vmcnt(10)
  s_add_u32 m0, s45, 122880
  s_add_u32 s42, s43, 0
  buffer_load_dwordx4 v4, s[28:31], s42 offen nt lds
  s_add_u32 m0, s45, 123904
  s_add_u32 s42, s43, 98304
  buffer_load_dwordx4 v4, s[28:31], s42 offen nt lds
  s_add_u32 m0, s45, 124928
  s_add_u32 s42, s43, 196608
  buffer_load_dwordx4 v4, s[28:31], s42 offen nt lds
  s_add_u32 m0, s45, 125952
  s_add_u32 s42, s43, 294912
  buffer_load_dwordx4 v4, s[28:31], s42 offen nt lds
  s_add_u32 m0, s45, 126976
  s_add_u32 s42, s43, 393216
  buffer_load_dwordx4 v4, s[28:31], s42 offen nt lds
  s_add_u32 m0, s45, 128000
  s_add_u32 s42, s43, 491520
  buffer_load_dwordx4 v4, s[28:31], s42 offen nt lds
  s_add_u32 m0, s45, 129024
  s_add_u32 s42, s43, 589824
  buffer_load_dwordx4 v4, s[28:31], s42 offen nt lds
  s_add_u32 m0, s45, 130048
  s_add_u32 s42, s43, 688128
  buffer_load_dwordx4 v4, s[28:31], s42 offen nt lds
  s_add_u32 m0, s45, 131072
  s_add_u32 s42, s43, 786432
  buffer_load_dwordx4 v4, s[28:31], s42 offen nt lds
  s_add_u32 m0, s45, 132096
  s_add_u32 s42, s43, 884736
  buffer_load_dwordx4 v4, s[28:31], s42 offen nt lds
  s_barrier
  ds_read_b64_tr_b16 a[120:121], v7 offset:0
  ds_read_b64_tr_b16 a[122:123], v7 offset:2048
  ds_read_b64_tr_b16 a[124:125], v7 offset:4096
  ds_read_b64_tr_b16 a[126:127], v7 offset:6144
  ds_read_b64_tr_b16 a[128:129], v7 offset:8192
  ds_read_b64_tr_b16 a[130:131], v7 offset:10240
  ds_read_b64_tr_b16 a[132:133], v7 offset:12288
  ds_read_b64_tr_b16 a[134:135], v7 offset:14336
  ds_read_b64_tr_b16 a[136:137], v7 offset:16384
  ds_read_b64_tr_b16 a[138:139], v7 offset:18432
  ds_read_b64_tr_b16 a[140:141], v7 offset:20480
  ds_read_b64_tr_b16 a[142:143], v7 offset:22528
  ds_read_b64_tr_b16 a[144:145], v7 offset:24576
  ds_read_b64_tr_b16 a[146:147], v7 offset:26624
  ds_read_b64_tr_b16 a[148:149], v7 offset:28672
  ds_read_b64_tr_b16 a[150:151], v7 offset:30720
  ds_read_b64_tr_b16 a[152:153], v7 offset:32768
  ds_read_b64_tr_b16 a[154:155], v7 offset:34816
  ds_read_b64_tr_b16 a[156:157], v7 offset:36864
  ds_read_b64_tr_b16 a[158:159], v7 offset:38912
  s_waitcnt lgkmcnt(0)
  s_barrier
  s_waitcnt vmcnt(10)
  s_add_u32 m0, s45, 0
  s_add_u32 s42, s43, 0
  buffer_load_dwordx4 v4, s[24:27], s42 offen nt lds
  s_add_u32 m0, s45, 1024
  s_add_u32 s42, s43, 98304
  buffer_load_dwordx4 v4, s[24:27], s42 offen nt lds
  s_add_u32 m0, s45, 2048
  s_add_u32 s42, s43, 196608
  buffer_load_dwordx4 v4, s[24:27], s42 offen nt lds
  s_add_u32 m0, s45, 3072
  s_add_u32 s42, s43, 294912
  buffer_load_dwordx4 v4, s[24:27], s42 offen nt lds
  s_add_u32 m0, s45, 4096
  s_add_u32 s42, s43, 393216
  buffer_load_dwordx4 v4, s[24:27], s42 offen nt lds
  s_add_u32 m0, s45, 5120
  s_add_u32 s42, s43, 491520
  buffer_load_dwordx4 v4, s[24:27], s42 offen nt lds
  s_add_u32 m0, s45, 6144
  s_add_u32 s42, s43, 589824
  buffer_load_dwordx4 v4, s[24:27], s42 offen nt lds
  s_add_u32 m0, s45, 7168
  s_add_u32 s42, s43, 688128
  buffer_load_dwordx4 v4, s[24:27], s42 offen nt lds
  s_add_u32 m0, s45, 8192
  s_add_u32 s42, s43, 786432
  buffer_load_dwordx4 v4, s[24:27], s42 offen nt lds
  s_add_u32 m0, s45, 9216
  s_add_u32 s42, s43, 884736
  buffer_load_dwordx4 v4, s[24:27], s42 offen nt lds
  s_barrier
  ds_read_b64_tr_b16 a[40:41], v8 offset:0
  ds_read_b64_tr_b16 a[42:43], v8 offset:2048
  ds_read_b64_tr_b16 a[44:45], v8 offset:4096
  ds_read_b64_tr_b16 a[46:47], v8 offset:6144
  ds_read_b64_tr_b16 a[48:49], v8 offset:8192
  ds_read_b64_tr_b16 a[50:51], v8 offset:10240
  ds_read_b64_tr_b16 a[52:53], v8 offset:12288
  ds_read_b64_tr_b16 a[54:55], v8 offset:14336
  ds_read_b64_tr_b16 a[56:57], v8 offset:16384
  ds_read_b64_tr_b16 a[58:59], v8 offset:18432
  ds_read_b64_tr_b16 a[60:61], v8 offset:20480
  ds_read_b64_tr_b16 a[62:63], v8 offset:22528
  ds_read_b64_tr_b16 a[64:65], v8 offset:24576
  ds_read_b64_tr_b16 a[66:67], v8 offset:26624
  ds_read_b64_tr_b16 a[68:69], v8 offset:28672
  ds_read_b64_tr_b16 a[70:71], v8 offset:30720
  ds_read_b64_tr_b16 a[72:73], v8 offset:32768
  ds_read_b64_tr_b16 a[74:75], v8 offset:34816
  ds_read_b64_tr_b16 a[76:77], v8 offset:36864
  ds_read_b64_tr_b16 a[78:79], v8 offset:38912
  s_waitcnt lgkmcnt(0)
  s_barrier
  s_waitcnt vmcnt(10)
  s_add_u32 m0, s45, 40960
  s_add_u32 s42, s43, 0
  buffer_load_dwordx4 v4, s[20:23], s42 offen nt lds
  s_add_u32 m0, s45, 41984
  s_add_u32 s42, s43, 98304
  buffer_load_dwordx4 v4, s[20:23], s42 offen nt lds
  s_add_u32 m0, s45, 43008
  s_add_u32 s42, s43, 196608
  buffer_load_dwordx4 v4, s[20:23], s42 offen nt lds
  s_add_u32 m0, s45, 44032
  s_add_u32 s42, s43, 294912
  buffer_load_dwordx4 v4, s[20:23], s42 offen nt lds
  s_add_u32 m0, s45, 45056
  s_add_u32 s42, s43, 393216
  buffer_load_dwordx4 v4, s[20:23], s42 offen nt lds
  s_add_u32 m0, s45, 46080
  s_add_u32 s42, s43, 491520
  buffer_load_dwordx4 v4, s[20:23], s42 offen nt lds
  s_add_u32 m0, s45, 47104
  s_add_u32 s42, s43, 589824
  buffer_load_dwordx4 v4, s[20:23], s42 offen nt lds
  s_add_u32 m0, s45, 48128
  s_add_u32 s42, s43, 688128
  buffer_load_dwordx4 v4, s[20:23], s42 offen nt lds
  s_add_u32 m0, s45, 49152
  s_add_u32 s42, s43, 786432
  buffer_load_dwordx4 v4, s[20:23], s42 offen nt lds
  s_add_u32 m0, s45, 50176
  s_add_u32 s42, s43, 884736
  buffer_load_dwordx4 v4, s[20:23], s42 offen nt lds
  s_barrier
  ds_read_b64_tr_b16 a[160:161], v9 offset:0
  ds_read_b64_tr_b16 a[162:163], v9 offset:2048
  ds_read_b64_tr_b16 a[164:165], v9 offset:4096
  ds_read_b64_tr_b16 a[166:167], v9 offset:6144
  ds_read_b64_tr_b16 a[168:169], v9 offset:8192
  ds_read_b64_tr_b16 a[170:171], v9 offset:10240
  ds_read_b64_tr_b16 a[172:173], v9 offset:12288
  ds_read_b64_tr_b16 a[174:175], v9 offset:14336
  ds_read_b64_tr_b16 a[176:177], v9 offset:16384
  ds_read_b64_tr_b16 a[178:179], v9 offset:18432
  ds_read_b64_tr_b16 a[180:181], v9 offset:20480
  ds_read_b64_tr_b16 a[182:183], v9 offset:22528
  ds_read_b64_tr_b16 a[184:185], v9 offset:24576
  ds_read_b64_tr_b16 a[186:187], v9 offset:26624
  ds_read_b64_tr_b16 a[188:189], v9 offset:28672
  ds_read_b64_tr_b16 a[190:191], v9 offset:30720
  ds_read_b64_tr_b16 a[192:193], v9 offset:32768
  ds_read_b64_tr_b16 a[194:195], v9 offset:34816
  ds_read_b64_tr_b16 a[196:197], v9 offset:36864
  ds_read_b64_tr_b16 a[198:199], v9 offset:38912
  s_waitcnt lgkmcnt(0)
  s_barrier
  s_waitcnt vmcnt(10)
  s_add_u32 m0, s45, 81920
  s_add_u32 s42, s44, 163840
  buffer_load_dwordx4 v5, s[32:35], s42 offen nt lds
  s_add_u32 m0, s45, 82944
  s_add_u32 s42, s44, 184320
  buffer_load_dwordx4 v5, s[32:35], s42 offen nt lds
  s_add_u32 m0, s45, 83968
  s_add_u32 s42, s44, 165120
  buffer_load_dwordx4 v5, s[32:35], s42 offen nt lds
  s_add_u32 m0, s45, 84992
  s_add_u32 s42, s44, 185600
  buffer_load_dwordx4 v5, s[32:35], s42 offen nt lds
  s_add_u32 m0, s45, 86016
  s_add_u32 s42, s44, 204800
  buffer_load_dwordx4 v5, s[32:35], s42 offen nt lds
  s_add_u32 m0, s45, 87040
  s_add_u32 s42, s44, 225280
  buffer_load_dwordx4 v5, s[32:35], s42 offen nt lds
  s_add_u32 m0, s45, 88064
  s_add_u32 s42, s44, 206080
  buffer_load_dwordx4 v5, s[32:35], s42 offen nt lds
  s_add_u32 m0, s45, 89088
  s_add_u32 s42, s44, 226560
  buffer_load_dwordx4 v5, s[32:35], s42 offen nt lds
  s_barrier
  ds_read_b64_tr_b16 a[80:81], v6 offset:0
  ds_read_b64_tr_b16 a[82:83], v6 offset:2048
  ds_read_b64_tr_b16 a[84:85], v6 offset:4096
  ds_read_b64_tr_b16 a[86:87], v6 offset:6144
  ds_read_b64_tr_b16 a[88:89], v6 offset:8192
  ds_read_b64_tr_b16 a[90:91], v6 offset:10240
  ds_read_b64_tr_b16 a[92:93], v6 offset:12288
  ds_read_b64_tr_b16 a[94:95], v6 offset:14336
  ds_read_b64_tr_b16 a[96:97], v6 offset:16384
  ds_read_b64_tr_b16 a[98:99], v6 offset:18432
  ds_read_b64_tr_b16 a[100:101], v6 offset:20480
  ds_read_b64_tr_b16 a[102:103], v6 offset:22528
  ds_read_b64_tr_b16 a[104:105], v6 offset:24576
  ds_read_b64_tr_b16 a[106:107], v6 offset:26624
  ds_read_b64_tr_b16 a[108:109], v6 offset:28672
  ds_read_b64_tr_b16 a[110:111], v6 offset:30720
  ds_read_b64_tr_b16 a[112:113], v6 offset:32768
  ds_read_b64_tr_b16 a[114:115], v6 offset:34816
  ds_read_b64_tr_b16 a[116:117], v6 offset:36864
  ds_read_b64_tr_b16 a[118:119], v6 offset:38912
  s_waitcnt lgkmcnt(0)
  s_barrier
  s_waitcnt vmcnt(8)
  s_add_u32 m0, s45, 122880
  s_add_u32 s42, s44, 81920
  buffer_load_dwordx4 v5, s[32:35], s42 offen nt lds
  s_add_u32 m0, s45, 123904
  s_add_u32 s42, s44, 102400
  buffer_load_dwordx4 v5, s[32:35], s42 offen nt lds
  s_add_u32 m0, s45, 124928
  s_add_u32 s42, s44, 83200
  buffer_load_dwordx4 v5, s[32:35], s42 offen nt lds
  s_add_u32 m0, s45, 125952
  s_add_u32 s42, s44, 103680
  buffer_load_dwordx4 v5, s[32:35], s42 offen nt lds
  s_add_u32 m0, s45, 126976
  s_add_u32 s42, s44, 122880
  buffer_load_dwordx4 v5, s[32:35], s42 offen nt lds
  s_add_u32 m0, s45, 128000
  s_add_u32 s42, s44, 143360
  buffer_load_dwordx4 v5, s[32:35], s42 offen nt lds
  s_add_u32 m0, s45, 129024
  s_add_u32 s42, s44, 124160
  buffer_load_dwordx4 v5, s[32:35], s42 offen nt lds
  s_add_u32 m0, s45, 130048
  s_add_u32 s42, s44, 144640
  buffer_load_dwordx4 v5, s[32:35], s42 offen nt lds
  s_barrier
  ds_read_b64_tr_b16 a[0:1], v7 offset:0
  ds_read_b64_tr_b16 a[2:3], v7 offset:2048
  ds_read_b64_tr_b16 a[4:5], v7 offset:4096
  ds_read_b64_tr_b16 a[6:7], v7 offset:6144
  ds_read_b64_tr_b16 a[8:9], v7 offset:8192
  ds_read_b64_tr_b16 a[10:11], v7 offset:10240
  ds_read_b64_tr_b16 a[12:13], v7 offset:12288
  ds_read_b64_tr_b16 a[14:15], v7 offset:14336
  ds_read_b64_tr_b16 a[16:17], v7 offset:16384
  ds_read_b64_tr_b16 a[18:19], v7 offset:18432
  ds_read_b64_tr_b16 a[20:21], v7 offset:20480
  ds_read_b64_tr_b16 a[22:23], v7 offset:22528
  ds_read_b64_tr_b16 a[24:25], v7 offset:24576
  ds_read_b64_tr_b16 a[26:27], v7 offset:26624
  ds_read_b64_tr_b16 a[28:29], v7 offset:28672
  ds_read_b64_tr_b16 a[30:31], v7 offset:30720
  ds_read_b64_tr_b16 a[32:33], v7 offset:32768
  ds_read_b64_tr_b16 a[34:35], v7 offset:34816
  ds_read_b64_tr_b16 a[36:37], v7 offset:36864
  ds_read_b64_tr_b16 a[38:39], v7 offset:38912
  s_waitcnt lgkmcnt(0)
  s_barrier
  s_waitcnt vmcnt(8)
  s_add_u32 m0, s45, 0
  s_add_u32 s42, s44, 0
  buffer_load_dwordx4 v5, s[32:35], s42 offen nt lds
  s_add_u32 m0, s45, 1024
  s_add_u32 s42, s44, 20480
  buffer_load_dwordx4 v5, s[32:35], s42 offen nt lds
  s_add_u32 m0, s45, 2048
  s_add_u32 s42, s44, 1280
  buffer_load_dwordx4 v5, s[32:35], s42 offen nt lds
  s_add_u32 m0, s45, 3072
  s_add_u32 s42, s44, 21760
  buffer_load_dwordx4 v5, s[32:35], s42 offen nt lds
  s_add_u32 m0, s45, 4096
  s_add_u32 s42, s44, 40960
  buffer_load_dwordx4 v5, s[32:35], s42 offen nt lds
  s_add_u32 m0, s45, 5120
  s_add_u32 s42, s44, 61440
  buffer_load_dwordx4 v5, s[32:35], s42 offen nt lds
  s_add_u32 m0, s45, 6144
  s_add_u32 s42, s44, 42240
  buffer_load_dwordx4 v5, s[32:35], s42 offen nt lds
  s_add_u32 m0, s45, 7168
  s_add_u32 s42, s44, 62720
  buffer_load_dwordx4 v5, s[32:35], s42 offen nt lds
  v_add_u32 v140, 81920, v10
  ds_read_b64_tr_b16 v[192:193], v140 offset:0
  ds_read_b64_tr_b16 v[194:195], v140 offset:2048
  ds_read_b64_tr_b16 v[196:197], v140 offset:4096
  ds_read_b64_tr_b16 v[198:199], v140 offset:6144
  v_add_u32 v140, 81920, v11
  ds_read_b64_tr_b16 v[216:217], v140 offset:0
  ds_read_b64_tr_b16 v[218:219], v140 offset:2048
  ds_read_b64_tr_b16 v[220:221], v140 offset:4096
  ds_read_b64_tr_b16 v[222:223], v140 offset:6144
  v_add_u32 v140, 81920, v12
  ds_read_b64_tr_b16 v[240:241], v140 offset:0
  ds_read_b64_tr_b16 v[242:243], v140 offset:2048
  ds_read_b64_tr_b16 v[244:245], v140 offset:4096
  ds_read_b64_tr_b16 v[246:247], v140 offset:6144
  v_add_u32 v140, 81920, v13
  ds_read_b64_tr_b16 a[248:249], v140 offset:0
  ds_read_b64_tr_b16 a[250:251], v140 offset:2048
  ds_read_b64_tr_b16 a[252:253], v140 offset:4096
  ds_read_b64_tr_b16 a[254:255], v140 offset:6144
  s_waitcnt lgkmcnt(0)
  s_waitcnt vmcnt(8)
  v_add_u32 v140, 122880, v10
  ds_read_b64_tr_b16 v[184:185], v140 offset:0
  ds_read_b64_tr_b16 v[186:187], v140 offset:2048
  ds_read_b64_tr_b16 v[188:189], v140 offset:4096
  ds_read_b64_tr_b16 v[190:191], v140 offset:6144
  v_add_u32 v140, 122880, v11
  ds_read_b64_tr_b16 v[208:209], v140 offset:0
  ds_read_b64_tr_b16 v[210:211], v140 offset:2048
  ds_read_b64_tr_b16 v[212:213], v140 offset:4096
  ds_read_b64_tr_b16 v[214:215], v140 offset:6144
  v_add_u32 v140, 122880, v12
  ds_read_b64_tr_b16 v[232:233], v140 offset:0
  ds_read_b64_tr_b16 v[234:235], v140 offset:2048
  ds_read_b64_tr_b16 v[236:237], v140 offset:4096
  ds_read_b64_tr_b16 v[238:239], v140 offset:6144
  v_add_u32 v140, 122880, v13
  ds_read_b64_tr_b16 a[240:241], v140 offset:0
  ds_read_b64_tr_b16 a[242:243], v140 offset:2048
  ds_read_b64_tr_b16 a[244:245], v140 offset:4096
  ds_read_b64_tr_b16 a[246:247], v140 offset:6144
  s_waitcnt lgkmcnt(0)
  s_waitcnt vmcnt(0)
  v_add_u32 v140, 0, v10
  ds_read_b64_tr_b16 v[176:177], v140 offset:0
  ds_read_b64_tr_b16 v[178:179], v140 offset:2048
  ds_read_b64_tr_b16 v[180:181], v140 offset:4096
  ds_read_b64_tr_b16 v[182:183], v140 offset:6144
  v_add_u32 v140, 0, v11
  ds_read_b64_tr_b16 v[200:201], v140 offset:0
  ds_read_b64_tr_b16 v[202:203], v140 offset:2048
  ds_read_b64_tr_b16 v[204:205], v140 offset:4096
  ds_read_b64_tr_b16 v[206:207], v140 offset:6144
  v_add_u32 v140, 0, v12
  ds_read_b64_tr_b16 v[224:225], v140 offset:0
  ds_read_b64_tr_b16 v[226:227], v140 offset:2048
  ds_read_b64_tr_b16 v[228:229], v140 offset:4096
  ds_read_b64_tr_b16 v[230:231], v140 offset:6144
  v_add_u32 v140, 0, v13
  ds_read_b64_tr_b16 v[248:249], v140 offset:0
  ds_read_b64_tr_b16 v[250:251], v140 offset:2048
  ds_read_b64_tr_b16 v[252:253], v140 offset:4096
  ds_read_b64_tr_b16 v[254:255], v140 offset:6144
  s_waitcnt lgkmcnt(0)
  s_barrier
  v_mov_b32 v84, -1
  v_mov_b32 v88, 0x3f803f80
  v_mov_b32 v85, -1
  v_mov_b32 v89, 0x3f803f80
  v_mov_b32 v86, -1
  v_mov_b32 v90, 0x3f803f80
  v_mov_b32 v87, -1
  v_mov_b32 v91, 0x3f803f80
  v_lshlrev_b32 v124, 4, v1
  v_lshlrev_b32 v125, 3, v1
  s_mul_i32 s42, s17, 2560
  v_add_u32 v126, s42, v124
  s_add_u32 s42, s42, 2048
  v_add_u32 v127, s42, v125
  v_lshrrev_b32 v4, 4, v1
  v_and_b32 v5, 7, v1
  v_bfe_u32 v6, v1, 3, 1
  v_and_b32 v7, 15, v1
  v_bfe_u32 v140, v1, 1, 1
  v_mul_u32_u24 v140, 0xaaaa, v140
  v_add_u32 v136, 0x4444, v140
  v_bfe_u32 v140, v1, 2, 1
  v_mov_b32 v137, 0x05040100
  v_mov_b32 v141, 0x03020706
  v_cmp_eq_u32 vcc, 1, v140
  s_nop 1
  v_cndmask_b32 v137, v137, v141, vcc
  s_lshl_b32 s42, s17, 9
  s_add_u32 s42, s42, 10240
  v_lshlrev_b32 v140, 5, v7
  v_lshl_add_u32 v140, v4, 2, v140
  v_add_u32 v128, s42, v140
  v_lshl_add_u32 v129, v4, 2, v128
  v_add_u32 v129, 2048, v129
  s_lshl_b32 s42, s17, 8
  v_lshl_add_u32 v130, v1, 2, s42
  s_lshl_b32 s42, s36, 10
  v_add_u32 v133, s42, v130
  s_lshl_b32 s42, s38, 10
  s_lshl_b32 s43, s38, 2
  s_add_u32 s43, s43, 3072
  s_cmp_lt_u32 s17, 2
  s_cselect_b32 s56, s42, s43
  s_add_u32 s43, s42, 4096
  s_cmp_eq_u32 s17, 0
  s_cselect_b32 s79, s42, s43
  s_cmp_eq_u32 s17, 2
  s_cselect_b32 s79, 3072, s79
  v_bfe_u32 v140, v1, 2, 2
  v_lshlrev_b32 v140, 1, v140
  v_and_b32 v141, 1, v1
  v_add_u32 v140, v140, v141
  v_lshl_add_u32 v140, v4, 3, v140
  v_lshlrev_b32 v140, 4, v140
  v_add_u32 v138, s42, v140
  v_lshl_add_u32 v142, v4, 3, v5
  v_lshlrev_b32 v142, 4, v142
  s_lshl_b32 s42, s17, 11
  s_add_u32 s42, s42, 14336
  v_add_u32 v131, s42, v142
  s_lshr_b32 s42, s17, 1
  s_lshl_b32 s42, s42, 10
  s_and_b32 s43, s17, 1
  s_lshl_b32 s43, s43, 8
  s_add_u32 s42, s42, s43
  s_add_u32 s42, s42, 14336
  v_and_b32 v140, 3, v1
  v_lshlrev_b32 v140, 5, v140
  v_bfe_u32 v141, v1, 4, 1
  v_lshl_add_u32 v140, v141, 4, v140
  v_bfe_u32 v141, v1, 5, 1
  v_lshl_add_u32 v140, v141, 3, v140
  v_bfe_u32 v141, v1, 2, 1
  v_lshl_add_u32 v140, v141, 9, v140
  v_bfe_u32 v141, v1, 3, 1
  v_lshl_add_u32 v140, v141, 7, v140
  v_add_u32 v132, s42, v140
  s_mov_b32 s66, 0x00ff00ff
  s_mov_b32 s67, 0x00ff00ff
  s_mov_b32 s68, 0xff00ff00
  s_mov_b32 s69, 0xff00ff00
  s_cmp_eq_u32 s17, 0
  s_cselect_b64 s[70:71], s[66:67], s[68:69]
  s_mul_i32 s46, s16, 10240
  s_add_u32 s46, s46, 131072
  s_add_u32 s47, s46, 81920
  s_lshl_b32 s42, s16, 17
  s_add_u32 s42, s42, 393216
  s_lshl_b32 s43, s37, 13
  s_add_u32 s48, s42, s43
  s_lshl_b32 s43, s17, 13
  s_add_u32 s49, s42, s43
  s_lshl_b32 s44, s16, 22
  s_add_u32 s44, s44, 67108864
  s_mul_i32 s24, s37, 3072
  s_add_u32 s24, s24, s44
  s_add_u32 s24, s24, 1384448
  s_mul_i32 s59, s37, 12288
  s_add_u32 s59, s59, s44
  s_add_u32 s59, s59, 49152
  s_and_b32 s42, s17, 1
  s_mul_i32 s42, s42, 6144
  s_add_u32 s59, s59, s42
  s_lshl_b32 s42, s38, 11
  s_add_u32 s59, s59, s42
  s_mul_i32 s26, s17, 40960
  s_add_u32 s26, s26, s44
  s_add_u32 s26, s26, 1179648
  s_lshl_b32 s43, s36, 12
  s_add_u32 s26, s26, s43
  s_mul_i32 s25, s17, 10240
  s_add_u32 s25, s25, s44
  s_add_u32 s25, s25, 1343488
  s_lshl_b32 s43, s36, 10
  s_add_u32 s25, s25, s43
  s_lshl_b32 s64, s36, 14
  s_lshl_b32 s42, s17, 11
  s_add_u32 s64, s64, s42
  s_add_u32 s64, s64, 1441792
  s_lshl_b32 s42, s16, 8
  v_lshlrev_b32 v134, 2, v1
  v_add_u32 v134, s42, v134
  s_lshl_b32 s43, s36, 4
  s_add_u32 s42, s42, s43
  s_lshl_b32 s43, s17, 2
  s_add_u32 s42, s42, s43
  s_add_u32 s42, s42, 4096
  v_mov_b32 v135, s42
  v_mov_b32 v139, 0
  s_mov_b32 s40, 0
  v_bfe_u32 v140, v1, 3, 2
  v_mul_u32_u24 v140, 227328, v140
  v_and_b32 v141, 7, v1
  v_lshl_add_u32 v140, v141, 7, v140
  s_lshl_b32 s42, s38, 10
  s_add_u32 s42, s42, s24
  s_lshl_b32 s41, s16, 2
  s_add_u32 s41, s41, 32
  v_mov_b32 v140, s41
  s_mov_b32 s41, 0
  s_mov_b64 exec, 1
gw_58:
  buffer_load_dword v141, v140, s[12:15], 0 offen sc1
  s_add_u32 s41, s41, 1
  s_cmp_gt_u32 s41, 65536
  s_cbranch_scc1 chain_abort
  s_waitcnt vmcnt(0)
  v_cmp_gt_u32 vcc, 2, v141
  s_cbranch_vccz gk_59
  s_sleep 4
  s_branch gw_58
gk_59:
  s_mov_b64 exec, -1
  v_and_b32 v140, 15, v1
  v_lshlrev_b32 v170, 2, v1
  v_and_b32 v141, 3, v1
  v_mov_b32 v142, 0
  v_mov_b32 v143, 0x3f80
  v_cmp_eq_u32 vcc, 0, v141
  s_nop 1
  v_cndmask_b32 v142, v142, v143, vcc
  v_mov_b32 v143, 0x3f800000
  v_cmp_eq_u32 vcc, 1, v141
  s_nop 1
  v_cndmask_b32 v142, v142, v143, vcc
  v_lshrrev_b32 v140, 2, v140
  v_mov_b32 v143, 0
  v_cmp_eq_u32 vcc, 0, v140
  s_nop 1
  v_cndmask_b32 v172, v143, v142, vcc
  v_cmp_eq_u32 vcc, 1, v140
  s_nop 1
  v_cndmask_b32 v173, v143, v142, vcc
  v_cmp_eq_u32 vcc, 2, v140
  s_nop 1
  v_cndmask_b32 v174, v143, v142, vcc
  v_cmp_eq_u32 vcc, 3, v140
  s_nop 1
  v_cndmask_b32 v175, v143, v142, vcc
  v_mov_b32 v168, 0x3f803f80
  v_mov_b32 v169, 0
  s_cmp_lt_u32 s36, 10
  s_cbranch_scc0 chain_nw
  s_cmp_lt_u32 s17, 2
  s_cbranch_scc1 chain_pro_c0w
  s_cmp_eq_u32 s17, 2
  s_cbranch_scc1 chain_pro_c1w
  s_branch chain_pro_c2w
chain_nw:
  s_cmp_lt_u32 s17, 2
  s_cbranch_scc1 chain_pro_c0n
  s_cmp_eq_u32 s17, 2
  s_cbranch_scc1 chain_pro_c1n
  s_branch chain_pro_c2n
chain_pro_c0w:
  s_mov_b32 s78, 1
  v_mov_b32 v143, 0
  s_mov_b32 s41, 0
cpw_60:
  v_cmp_gt_u32 vcc, s78, v139
  s_nop 0
  s_and_b32 vcc_lo, vcc_lo, 0xfff000
  s_and_b32 vcc_hi, vcc_hi, 0x10fffff0
  s_cmp_eq_u64 vcc, 0
  s_cbranch_scc1 cpo_61
  s_sleep 1
  buffer_load_dword v139, v134, s[8:11], 0 offen sc1
  s_add_u32 s41, s41, 1
  s_cmp_gt_u32 s41, 65536
  s_cbranch_scc1 chain_abort
  s_waitcnt vmcnt(0)
  s_branch cpw_60
cpo_61:
  v_readlane_b32 s42, v139, 60
  s_nop 0
  s_sub_u32 s42, s42, 1
  s_lshl_b32 s42, s42, 13
  s_add_u32 s64, s64, s42
  s_sub_u32 s42, s78, 1
  s_and_b32 s42, s42, 7
  s_mul_i32 s42, s42, 147456
  s_add_u32 s42, s42, s59
  buffer_load_dwordx4 v[60:63], v124, s[8:11], s42 offen offset:0 sc1
  buffer_load_dwordx4 v[64:67], v124, s[8:11], s42 offen offset:1024 sc1
  s_add_u32 s55, s48, 98304
  s_sub_u32 s43, s40, 1
  s_and_b32 s43, s43, 3
  s_mul_i32 s43, s43, 227328
  s_add_u32 s57, s24, s43
  s_add_u32 s58, s25, s43
  s_add_u32 s54, s55, s79
  s_and_b32 s42, s40, 3
  s_lshl_b32 s43, s42, 15
  s_add_u32 s52, s49, s43
  s_add_u32 s53, s52, 4096
  s_add_u32 s55, s48, s43
  s_add_u32 s50, s55, s56
  s_lshl_b32 s44, s38, 10
  s_add_u32 s51, s55, s44
  s_add_u32 s51, s51, 4096
  s_mul_i32 s60, s42, 227328
  s_add_u32 s60, s60, s26
  s_mul_i32 s62, s42, 163840
  s_add_u32 s62, s62, s64
  s_lshl_b32 s43, s16, 8
  s_add_u32 s61, s62, s43
  s_xor_b32 s63, s61, 8192
  v_mov_b32 v92, 0
  v_mov_b32 v93, 0
  v_mov_b32 v94, 0
  v_mov_b32 v95, 0
  v_mov_b32 v96, 0
  v_mov_b32 v97, 0
  v_mov_b32 v98, 0
  v_mov_b32 v99, 0
  v_mov_b32 v100, 0
  v_mov_b32 v101, 0
  v_mov_b32 v102, 0
  v_mov_b32 v103, 0
  v_mov_b32 v104, 0
  v_mov_b32 v105, 0
  v_mov_b32 v106, 0
  v_mov_b32 v107, 0
  v_mov_b32 v68, 0
  v_mov_b32 v69, 0
  v_mov_b32 v70, 0
  v_mov_b32 v71, 0
  v_mov_b32 v72, 0
  v_mov_b32 v73, 0
  v_mov_b32 v74, 0
  v_mov_b32 v75, 0
  v_mov_b32 v76, 0
  v_mov_b32 v77, 0
  v_mov_b32 v78, 0
  v_mov_b32 v79, 0
chain_loop_c0w:
  s_mov_b32 s41, 0
  buffer_load_dwordx4 v[152:155], v126, s[8:11], s46 offen sc1
  buffer_load_dwordx4 v[156:159], v126, s[8:11], s46 offen offset:1024 sc1
  buffer_load_dwordx2 v[160:161], v127, s[8:11], s46 offen sc1
  s_sleep 2
mq_62:
  buffer_load_dwordx4 v[162:165], v126, s[8:11], s46 offen sc1
  buffer_load_dwordx4 v[108:111], v126, s[8:11], s46 offen offset:1024 sc1
  buffer_load_dwordx2 v[112:113], v127, s[8:11], s46 offen sc1
  s_waitcnt vmcnt(3)
  v_max3_u32 v140, v152, v153, v154
  v_max3_u32 v141, v155, v156, v157
  v_max3_u32 v140, v140, v158, v159
  v_max3_u32 v141, v141, v160, v161
  v_max_u32 v140, v140, v141
  v_cmp_eq_u32 vcc, -1, v140
  s_cbranch_vccz mq_62_a
  buffer_load_dwordx4 v[152:155], v126, s[8:11], s46 offen sc1
  buffer_load_dwordx4 v[156:159], v126, s[8:11], s46 offen offset:1024 sc1
  buffer_load_dwordx2 v[160:161], v127, s[8:11], s46 offen sc1
  s_add_u32 s41, s41, 1
  s_cmp_gt_u32 s41, 65536
  s_cbranch_scc1 chain_abort
  s_waitcnt vmcnt(3)
  v_max3_u32 v140, v162, v163, v164
  v_max3_u32 v141, v165, v108, v109
  v_max3_u32 v140, v140, v110, v111
  v_max3_u32 v141, v141, v112, v113
  v_max_u32 v140, v140, v141
  v_cmp_eq_u32 vcc, -1, v140
  s_cbranch_vccnz mq_62
  ds_write_b128 v126, v[162:165]
  ds_write_b128 v126, v[108:111] offset:1024
  ds_write_b64 v127, v[112:113]
  s_branch mq_62_ok
mq_62_a:
  ds_write_b128 v126, v[152:155]
  ds_write_b128 v126, v[156:159] offset:1024
  ds_write_b64 v127, v[160:161]
mq_62_ok:
  s_waitcnt lgkmcnt(0)
  s_barrier
  ds_read_b128 v[4:7], v124 offset:0
  ds_read_b128 v[8:11], v124 offset:1024
  ds_read_b128 v[12:15], v124 offset:2048
  ds_read_b128 v[16:19], v124 offset:3072
  ds_read_b128 v[20:23], v124 offset:4096
  ds_read_b128 v[24:27], v124 offset:5120
  ds_read_b128 v[28:31], v124 offset:6144
  ds_read_b128 v[32:35], v124 offset:7168
  ds_read_b128 v[36:39], v124 offset:8192
  ds_read_b128 v[40:43], v124 offset:9216
  s_waitcnt lgkmcnt(9)
  v_smfmac_f32_16x16x64_bf16 v[68:71], v[4:7], a[0:7], v136
  v_smfmac_f32_16x16x64_bf16 v[72:75], v[4:7], a[80:87], v136
  buffer_load_dwordx4 v[44:47], v124, s[8:11], s60 offen offset:0 sc1
  s_waitcnt lgkmcnt(8)
  v_smfmac_f32_16x16x64_bf16 v[68:71], v[8:11], a[8:15], v136
  v_smfmac_f32_16x16x64_bf16 v[72:75], v[8:11], a[88:95], v136
  buffer_load_dwordx4 v[48:51], v124, s[8:11], s60 offen offset:1024 sc1
  s_waitcnt lgkmcnt(7)
  v_smfmac_f32_16x16x64_bf16 v[68:71], v[12:15], a[16:23], v136
  v_smfmac_f32_16x16x64_bf16 v[72:75], v[12:15], a[96:103], v136
  buffer_load_dwordx4 v[52:55], v124, s[8:11], s60 offen offset:2048 sc1
  s_waitcnt lgkmcnt(6)
  v_smfmac_f32_16x16x64_bf16 v[68:71], v[16:19], a[24:31], v136
  v_smfmac_f32_16x16x64_bf16 v[72:75], v[16:19], a[104:111], v136
  buffer_load_dwordx4 v[56:59], v124, s[8:11], s60 offen offset:3072 sc1
  s_waitcnt lgkmcnt(5)
  v_smfmac_f32_16x16x64_bf16 v[68:71], v[20:23], a[32:39], v136
  v_smfmac_f32_16x16x64_bf16 v[72:75], v[20:23], a[112:119], v136
  buffer_store_dwordx4 v[80:83], v124, s[8:11], s58 offen
  s_waitcnt lgkmcnt(4)
  v_smfmac_f32_16x16x64_bf16 v[68:71], v[24:27], a[40:47], v136
  v_smfmac_f32_16x16x64_bf16 v[72:75], v[24:27], a[120:127], v136
  buffer_store_dwordx4 v[84:87], v124, s[8:11], s54 offen
  s_waitcnt lgkmcnt(3)
  v_smfmac_f32_16x16x64_bf16 v[68:71], v[28:31], a[48:55], v136
  v_smfmac_f32_16x16x64_bf16 v[72:75], v[28:31], a[128:135], v136
  buffer_load_dword v139, v134, s[8:11], 0 offen sc1
  s_waitcnt lgkmcnt(2)
  v_smfmac_f32_16x16x64_bf16 v[68:71], v[32:35], a[56:63], v136
  v_smfmac_f32_16x16x64_bf16 v[72:75], v[32:35], a[136:143], v136
  s_waitcnt lgkmcnt(1)
  v_smfmac_f32_16x16x64_bf16 v[68:71], v[36:39], a[64:71], v136
  v_smfmac_f32_16x16x64_bf16 v[72:75], v[36:39], a[144:151], v136
  s_waitcnt lgkmcnt(0)
  v_smfmac_f32_16x16x64_bf16 v[68:71], v[40:43], a[72:79], v136
  v_smfmac_f32_16x16x64_bf16 v[72:75], v[40:43], a[152:159], v136
  v_smfmac_f32_16x16x64_bf16 v[76:79], v[4:7], a[160:167], v136
  v_smfmac_f32_16x16x64_bf16 v[76:79], v[8:11], a[168:175], v136
  s_nop 4
  v_add_f32 v68, v68, v70
  v_add_f32 v69, v69, v71
  v_add_f32 v72, v72, v74
  v_add_f32 v73, v73, v75
  v_smfmac_f32_16x16x64_bf16 v[76:79], v[12:15], a[176:183], v136
  v_cvt_pk_bf16_f32 v122, v68, v69
  v_cvt_pk_bf16_f32 v123, v72, v73
  ds_write2_b32 v128, v122, v122 offset0:0 offset1:4
  ds_write2_b32 v129, v123, v123 offset0:0 offset1:1
  v_smfmac_f32_16x16x64_bf16 v[76:79], v[16:19], a[184:191], v136
  v_smfmac_f32_16x16x64_bf16 v[76:79], v[20:23], a[192:199], v136
  s_waitcnt lgkmcnt(0)
  s_barrier
  ds_read_b64_tr_b16 v[144:145], v125 offset:10240
  ds_read_b64_tr_b16 v[146:147], v125 offset:10752
  ds_read_b64_tr_b16 v[148:149], v125 offset:11264
  ds_read_b64_tr_b16 v[150:151], v125 offset:11776
  v_smfmac_f32_16x16x64_bf16 v[76:79], v[24:27], a[200:207], v136
  v_smfmac_f32_16x16x64_bf16 v[76:79], v[28:31], a[208:215], v136
  v_smfmac_f32_16x16x64_bf16 v[76:79], v[32:35], a[216:223], v136
  s_waitcnt lgkmcnt(2)
  v_mfma_f32_16x16x32_bf16 v[80:83], v[60:63], v[144:147], 0
  s_waitcnt lgkmcnt(0)
  v_mfma_f32_16x16x32_bf16 v[80:83], v[64:67], v[148:151], v[80:83]
  v_smfmac_f32_16x16x64_bf16 v[76:79], v[36:39], a[224:231], v136
  v_smfmac_f32_16x16x64_bf16 v[76:79], v[40:43], a[232:239], v136
  s_mov_b64 exec, s[70:71]
  s_nop 4
  buffer_store_dwordx4 v[80:83], v124, s[8:11], s50 offen
  s_mov_b64 exec, -1
  v_add_f32 v76, v76, v78
  v_add_f32 v77, v77, v79
  v_cvt_pk_bf16_f32 v140, v76, v77
  s_nop 1
  v_mov_b32_dpp v141, v140 row_ror:4 row_mask:0xf bank_mask:0xa
  s_nop 1
  v_mov_b32_dpp v141, v140 row_ror:12 row_mask:0xf bank_mask:0x5
  v_perm_b32 v140, v141, v140, v137
  buffer_store_dword v140, v130, s[8:11], s51 offen
  s_sleep 2
  s_nop 3
  s_nop 3
  buffer_load_dwordx4 v[4:7], v124, s[8:11], s52 offen offset:0 sc1
  buffer_load_dwordx4 v[8:11], v124, s[8:11], s52 offen offset:1024 sc1
  buffer_load_dwordx4 v[12:15], v124, s[8:11], s52 offen offset:2048 sc1
  buffer_load_dwordx3 v[16:18], v124, s[8:11], s52 offen offset:3072 sc1
  buffer_load_dwordx4 v[20:23], v124, s[8:11], s53 offen offset:0 sc1
  buffer_load_dwordx4 v[24:27], v124, s[8:11], s53 offen offset:1024 sc1
  buffer_load_dwordx4 v[28:31], v124, s[8:11], s53 offen offset:2048 sc1
  s_mov_b32 s41, 0
  s_waitcnt vmcnt(3)
gs_63_in:
  v_pk_add_f32 v[152:153], v[4:5], v[8:9]
  v_pk_add_f32 v[154:155], v[6:7], v[10:11]
  v_add_f32 v156, v16, v17
  v_pk_add_f32 v[152:153], v[152:153], v[12:13]
  v_pk_add_f32 v[154:155], v[154:155], v[14:15]
  v_add_f32 v156, v156, v18
  v_cmp_u_f32 s[76:77], v152, v153
  v_cmp_u_f32 s[72:73], v154, v155
  v_cmp_u_f32 s[74:75], v156, v156
  v_max3_f32 v140, v152, v153, v154
  s_or_b64 s[72:73], s[76:77], s[72:73]
  v_max3_f32 v140, v140, v155, v156
  s_or_b64 s[72:73], s[72:73], s[74:75]
  s_waitcnt vmcnt(0)
  v_max3_u32 v142, v20, v21, v22
  v_max3_u32 v143, v23, v24, v25
  v_max3_u32 v142, v142, v26, v27
  v_max3_u32 v143, v143, v28, v29
  v_max3_u32 v142, v142, v30, v31
  v_max_u32 v142, v142, v143
  v_cmp_eq_u32 vcc, -1, v142
  s_nop 0
  s_or_b64 vcc, vcc, s[72:73]
  s_cbranch_vccnz gs_63
  v_smfmac_f32_16x16x64_bf16 v[92:95], v[20:23], v[176:183], v136
  v_max_f32_dpp v140, v140, v140 row_ror:8 row_mask:0xf bank_mask:0xf
  v_mov_b32 v141, v140
  v_smfmac_f32_16x16x64_bf16 v[96:99], v[20:23], v[200:207], v136
  v_mul_f32 v152, 0x3dd53b95, v152
  v_mul_f32 v153, 0x3dd53b95, v153
  v_smfmac_f32_16x16x64_bf16 v[100:103], v[20:23], v[224:231], v136
  v_permlane16_swap_b32 v140, v141
  v_max_f32 v140, v140, v141
  v_smfmac_f32_16x16x64_bf16 v[104:107], v[20:23], v[248:255], v136
  v_mov_b32 v141, v140
  v_mul_f32 v154, 0x3dd53b95, v154
  v_smfmac_f32_16x16x64_bf16 v[92:95], v[24:27], v[184:191], v136
  v_mul_f32 v155, 0x3dd53b95, v155
  v_permlane32_swap_b32 v140, v141
  v_smfmac_f32_16x16x64_bf16 v[96:99], v[24:27], v[208:215], v136
  v_max_f32 v140, v140, v141
  v_mul_f32 v156, 0x3dd53b95, v156
  v_smfmac_f32_16x16x64_bf16 v[100:103], v[24:27], v[232:239], v136
  v_mul_f32 v140, 0x3dd53b95, v140
  v_sub_f32 v156, v156, v140
  v_smfmac_f32_16x16x64_bf16 v[104:107], v[24:27], a[240:247], v136
  v_sub_f32 v152, v152, v140
  v_sub_f32 v153, v153, v140
  v_smfmac_f32_16x16x64_bf16 v[92:95], v[28:31], v[192:199], v136
  v_sub_f32 v154, v154, v140
  v_sub_f32 v155, v155, v140
  v_smfmac_f32_16x16x64_bf16 v[96:99], v[28:31], v[216:223], v136
  v_exp_f32 v156, v156
  v_exp_f32 v152, v152
  v_smfmac_f32_16x16x64_bf16 v[100:103], v[28:31], v[240:247], v136
  v_exp_f32 v153, v153
  v_exp_f32 v154, v154
  v_smfmac_f32_16x16x64_bf16 v[104:107], v[28:31], a[248:255], v136
  v_exp_f32 v155, v155
  v_mov_b32_dpp v157, v156 row_ror:8 row_mask:0xf bank_mask:0xf
  v_cvt_pk_bf16_f32 v116, v152, v153
  v_cvt_pk_bf16_f32 v117, v154, v155
  v_cvt_pk_bf16_f32 v120, v156, v157
  v_mov_b32_dpp v118, v116 row_ror:8 row_mask:0xf bank_mask:0xf
  v_mov_b32_dpp v119, v117 row_ror:8 row_mask:0xf bank_mask:0xf
  v_mov_b32 v121, v120
  s_nop 0
  v_mfma_f32_16x16x32_bf16 v[80:83], v[88:91], v[116:119], 0
  v_cvt_pk_bf16_f32 v108, v92, v93
  v_cvt_pk_bf16_f32 v109, v94, v95
  v_mfma_f32_16x16x32_bf16 v[152:155], v[44:47], v[116:119], 0
  v_cvt_pk_bf16_f32 v110, v96, v97
  v_cvt_pk_bf16_f32 v111, v98, v99
  v_mfma_f32_16x16x32_bf16 v[156:159], v[48:51], v[116:119], 0
  v_mfma_f32_16x16x16_bf16 v[80:83], v[168:169], v[120:121], v[80:83]
  v_cvt_pk_bf16_f32 v112, v100, v101
  v_cvt_pk_bf16_f32 v113, v102, v103
  v_mfma_f32_16x16x32_bf16 v[160:163], v[52:55], v[116:119], 0
  v_cvt_pk_bf16_f32 v114, v104, v105
  v_cvt_pk_bf16_f32 v115, v106, v107
  v_mfma_f32_16x16x32_bf16 v[164:167], v[56:59], v[116:119], 0
  s_add_u32 s40, s40, 1
  v_mfma_f32_16x16x16_bf16 v[152:155], v[108:109], v[120:121], v[152:155]
  v_mfma_f32_16x16x16_bf16 v[156:159], v[110:111], v[120:121], v[156:159]
  v_rcp_f32 v122, v80
  v_mfma_f32_16x16x16_bf16 v[160:163], v[112:113], v[120:121], v[160:163]
  s_nop 0
  v_mfma_f32_16x16x16_bf16 v[164:167], v[114:115], v[120:121], v[164:167]
  v_mov_b32 v123, v122
  s_cmp_eq_u32 s40, 64
  s_cbranch_scc1 chain_last_c0w
  s_mov_b64 exec, s[66:67]
  v_pk_mul_f32 v[152:153], v[122:123], v[152:153]
  v_pk_mul_f32 v[154:155], v[122:123], v[154:155]
  ds_write_b128 v131, v[152:155] offset:0
  v_pk_mul_f32 v[156:157], v[122:123], v[156:157]
  v_pk_mul_f32 v[158:159], v[122:123], v[158:159]
  ds_write_b128 v131, v[156:159] offset:512
  v_pk_mul_f32 v[160:161], v[122:123], v[160:161]
  v_pk_mul_f32 v[162:163], v[122:123], v[162:163]
  ds_write_b128 v131, v[160:163] offset:1024
  v_pk_mul_f32 v[164:165], v[122:123], v[164:165]
  v_pk_mul_f32 v[166:167], v[122:123], v[166:167]
  ds_write_b128 v131, v[164:167] offset:1536
  s_mov_b64 exec, -1
  s_waitcnt lgkmcnt(0)
  s_barrier
  ds_read_b64 v[144:145], v132 offset:0
  ds_read_b64 v[146:147], v132 offset:2048
  ds_read_b64 v[148:149], v132 offset:4096
  ds_read_b64 v[150:151], v132 offset:6144
  s_mov_b32 s45, s62
  s_waitcnt lgkmcnt(2)
  v_pk_add_f32 v[144:145], v[144:145], v[146:147]
  s_waitcnt lgkmcnt(0)
  v_pk_add_f32 v[148:149], v[148:149], v[150:151]
  v_pk_add_f32 v[122:123], v[144:145], v[148:149]
  v_cvt_pk_bf16_f32 v122, v122, v123
  buffer_store_dword v122, v170, s[8:11], s63 offen sc1
  buffer_store_dword v122, v170, s[8:11], s61 offen sc1
  s_add_u32 s78, s40, 1
  s_sub_u32 s42, s40, 1
  v_mov_b32 v143, s42
  buffer_store_dword v84, v133, s[8:11], s46 offen
  buffer_store_dword v143, v135, s[8:11], 0 offen
  s_mov_b32 s41, 0
cpw_65:
  v_cmp_gt_u32 vcc, s78, v139
  s_nop 0
  s_and_b32 vcc_lo, vcc_lo, 0xfff000
  s_and_b32 vcc_hi, vcc_hi, 0xfffff0
  s_cmp_eq_u64 vcc, 0
  s_cbranch_scc1 cpo_66
  s_sleep 1
  buffer_load_dword v139, v134, s[8:11], 0 offen sc1
  s_add_u32 s41, s41, 1
  s_cmp_gt_u32 s41, 65536
  s_cbranch_scc1 chain_abort
  s_waitcnt vmcnt(0)
  s_branch cpw_65
cpo_66:
  s_sub_u32 s42, s78, 1
  s_and_b32 s42, s42, 7
  s_mul_i32 s42, s42, 147456
  s_add_u32 s42, s42, s59
  buffer_load_dwordx4 v[60:63], v124, s[8:11], s42 offen offset:0 sc1
  buffer_load_dwordx4 v[64:67], v124, s[8:11], s42 offen offset:1024 sc1
  v_add_f32 v92, v92, v94
  v_add_f32 v93, v93, v95
  v_cvt_pk_bf16_f32 v80, v92, v93
  v_add_f32 v96, v96, v98
  v_add_f32 v97, v97, v99
  v_cvt_pk_bf16_f32 v81, v96, v97
  v_add_f32 v100, v100, v102
  v_add_f32 v101, v101, v103
  v_cvt_pk_bf16_f32 v82, v100, v101
  v_add_f32 v104, v104, v106
  v_add_f32 v105, v105, v107
  v_cvt_pk_bf16_f32 v83, v104, v105
  s_mov_b32 s42, s46
  s_mov_b32 s46, s47
  s_mov_b32 s47, s42
  s_sub_u32 s43, s40, 1
  s_and_b32 s43, s43, 3
  s_mul_i32 s43, s43, 227328
  s_add_u32 s57, s24, s43
  s_add_u32 s58, s25, s43
  s_add_u32 s54, s55, s79
  s_and_b32 s42, s40, 3
  s_lshl_b32 s43, s42, 15
  s_add_u32 s52, s49, s43
  s_add_u32 s53, s52, 4096
  s_add_u32 s55, s48, s43
  s_add_u32 s50, s55, s56
  s_lshl_b32 s44, s38, 10
  s_add_u32 s51, s55, s44
  s_add_u32 s51, s51, 4096
  s_mul_i32 s60, s42, 227328
  s_add_u32 s60, s60, s26
  s_mul_i32 s62, s42, 163840
  s_add_u32 s62, s62, s64
  s_lshl_b32 s43, s16, 8
  s_add_u32 s61, s62, s43
  s_xor_b32 s63, s61, 8192
  v_mov_b32 v92, 0
  v_mov_b32 v93, 0
  v_mov_b32 v94, 0
  v_mov_b32 v95, 0
  v_mov_b32 v96, 0
  v_mov_b32 v97, 0
  v_mov_b32 v98, 0
  v_mov_b32 v99, 0
  v_mov_b32 v100, 0
  v_mov_b32 v101, 0
  v_mov_b32 v102, 0
  v_mov_b32 v103, 0
  v_mov_b32 v104, 0
  v_mov_b32 v105, 0
  v_mov_b32 v106, 0
  v_mov_b32 v107, 0
  v_mov_b32 v68, 0
  v_mov_b32 v69, 0
  v_mov_b32 v70, 0
  v_mov_b32 v71, 0
  v_mov_b32 v72, 0
  v_mov_b32 v73, 0
  v_mov_b32 v74, 0
  v_mov_b32 v75, 0
  v_mov_b32 v76, 0
  v_mov_b32 v77, 0
  v_mov_b32 v78, 0
  v_mov_b32 v79, 0
  s_sleep 2
  buffer_load_dwordx4 v[4:7], v124, s[8:11], s45 offen offset:0 sc1
  buffer_load_dwordx4 v[8:11], v124, s[8:11], s45 offen offset:1024 sc1
  s_mov_b32 s41, 0
xp_67:
  s_waitcnt vmcnt(0)
  v_mfma_f32_16x16x32_bf16 v[36:39], v[172:175], v[4:7], 0
  v_mfma_f32_16x16x32_bf16 v[36:39], v[172:175], v[8:11], v[36:39]
  s_nop 7
  v_cmp_u_f32 vcc, v36, v37
  v_cvt_pk_bf16_f32 v141, v36, v37
  s_cbranch_vccnz xp_67_r
  buffer_store_dword v141, v133, s[8:11], s46 offen
  s_branch chain_loop_c0w
gs_63:
  v_max3_u32 v142, v4, v5, v6
  v_max_u32 v142, v142, v7
  v_cmp_eq_u32 vcc, -1, v142
  s_cbranch_vccz gs_63_s0
  s_mov_b64 exec, vcc
  buffer_load_dwordx4 v[4:7], v124, s[8:11], s52 offen offset:0 sc1
  s_mov_b64 exec, -1
gs_63_s0:
  v_max3_u32 v142, v8, v9, v10
  v_max_u32 v142, v142, v11
  v_cmp_eq_u32 vcc, -1, v142
  s_cbranch_vccz gs_63_s1
  s_mov_b64 exec, vcc
  buffer_load_dwordx4 v[8:11], v124, s[8:11], s52 offen offset:1024 sc1
  s_mov_b64 exec, -1
gs_63_s1:
  v_max3_u32 v142, v12, v13, v14
  v_max_u32 v142, v142, v15
  v_cmp_eq_u32 vcc, -1, v142
  s_cbranch_vccz gs_63_s2
  s_mov_b64 exec, vcc
  buffer_load_dwordx4 v[12:15], v124, s[8:11], s52 offen offset:2048 sc1
  s_mov_b64 exec, -1
gs_63_s2:
  v_max3_u32 v142, v16, v17, v18
  v_cmp_eq_u32 vcc, -1, v142
  s_cbranch_vccz gs_63_s3
  s_mov_b64 exec, vcc
  buffer_load_dwordx3 v[16:18], v124, s[8:11], s52 offen offset:3072 sc1
  s_mov_b64 exec, -1
gs_63_s3:
  v_max3_u32 v142, v20, v21, v22
  v_max_u32 v142, v142, v23
  v_cmp_eq_u32 vcc, -1, v142
  s_cbranch_vccz gs_63_s4
  s_mov_b64 exec, vcc
  buffer_load_dwordx4 v[20:23], v124, s[8:11], s53 offen offset:0 sc1
  s_mov_b64 exec, -1
gs_63_s4:
  v_max3_u32 v142, v24, v25, v26
  v_max_u32 v142, v142, v27
  v_cmp_eq_u32 vcc, -1, v142
  s_cbranch_vccz gs_63_s5
  s_mov_b64 exec, vcc
  buffer_load_dwordx4 v[24:27], v124, s[8:11], s53 offen offset:1024 sc1
  s_mov_b64 exec, -1
gs_63_s5:
  v_max3_u32 v142, v28, v29, v30
  v_max_u32 v142, v142, v31
  v_cmp_eq_u32 vcc, -1, v142
  s_cbranch_vccz gs_63_s6
  s_mov_b64 exec, vcc
  buffer_load_dwordx4 v[28:31], v124, s[8:11], s53 offen offset:2048 sc1
  s_mov_b64 exec, -1
gs_63_s6:
  s_add_u32 s41, s41, 1
  s_cmp_gt_u32 s41, 65536
  s_cbranch_scc1 chain_abort
  s_waitcnt vmcnt(0)
  s_branch gs_63_in
xp_67_r:
  v_max3_u32 v140, v4, v5, v6
  v_max_u32 v140, v140, v7
  v_cmp_eq_u32 vcc, -1, v140
  s_cbranch_vccz xp_67_s0
  s_mov_b64 exec, vcc
  buffer_load_dwordx4 v[4:7], v124, s[8:11], s45 offen offset:0 sc1
  s_mov_b64 exec, -1
xp_67_s0:
  v_max3_u32 v140, v8, v9, v10
  v_max_u32 v140, v140, v11
  v_cmp_eq_u32 vcc, -1, v140
  s_cbranch_vccz xp_67_s1
  s_mov_b64 exec, vcc
  buffer_load_dwordx4 v[8:11], v124, s[8:11], s45 offen offset:1024 sc1
  s_mov_b64 exec, -1
xp_67_s1:
  s_add_u32 s41, s41, 1
  s_cmp_gt_u32 s41, 65536
  s_cbranch_scc1 chain_abort
  s_branch xp_67
chain_last_c0w:
  s_sub_u32 s43, s40, 1
  s_and_b32 s43, s43, 3
  s_mul_i32 s43, s43, 227328
  s_add_u32 s57, s24, s43
  s_add_u32 s58, s25, s43
  v_add_f32 v92, v92, v94
  v_add_f32 v93, v93, v95
  v_cvt_pk_bf16_f32 v80, v92, v93
  v_add_f32 v96, v96, v98
  v_add_f32 v97, v97, v99
  v_cvt_pk_bf16_f32 v81, v96, v97
  v_add_f32 v100, v100, v102
  v_add_f32 v101, v101, v103
  v_cvt_pk_bf16_f32 v82, v100, v101
  v_add_f32 v104, v104, v106
  v_add_f32 v105, v105, v107
  v_cvt_pk_bf16_f32 v83, v104, v105
  buffer_store_dwordx4 v[80:83], v124, s[8:11], s58 offen
  v_mov_b32 v143, s40
  s_branch chain_fin
chain_pro_c1w:
  s_mov_b32 s78, 1
  v_mov_b32 v143, 0
  s_mov_b32 s41, 0
cpw_68:
  v_cmp_gt_u32 vcc, s78, v139
  s_nop 0
  s_and_b32 vcc_lo, vcc_lo, 0xfff000
  s_and_b32 vcc_hi, vcc_hi, 0x10fffff0
  s_cmp_eq_u64 vcc, 0
  s_cbranch_scc1 cpo_69
  s_sleep 1
  buffer_load_dword v139, v134, s[8:11], 0 offen sc1
  s_add_u32 s41, s41, 1
  s_cmp_gt_u32 s41, 65536
  s_cbranch_scc1 chain_abort
  s_waitcnt vmcnt(0)
  s_branch cpw_68
cpo_69:
  v_readlane_b32 s42, v139, 60
  s_nop 0
  s_sub_u32 s42, s42, 1
  s_lshl_b32 s42, s42, 13
  s_add_u32 s64, s64, s42
  s_add_u32 s55, s48, 98304
  s_sub_u32 s43, s40, 1
  s_and_b32 s43, s43, 3
  s_mul_i32 s43, s43, 227328
  s_add_u32 s57, s24, s43
  s_add_u32 s58, s25, s43
  s_add_u32 s54, s55, s79
  s_and_b32 s42, s40, 3
  s_lshl_b32 s43, s42, 15
  s_add_u32 s52, s49, s43
  s_add_u32 s53, s52, 4096
  s_add_u32 s55, s48, s43
  s_add_u32 s50, s55, s56
  s_lshl_b32 s44, s38, 10
  s_add_u32 s51, s55, s44
  s_add_u32 s51, s51, 4096
  s_mul_i32 s60, s42, 227328
  s_add_u32 s60, s60, s26
  s_mul_i32 s62, s42, 163840
  s_add_u32 s62, s62, s64
  s_lshl_b32 s43, s16, 8
  s_add_u32 s61, s62, s43
  s_xor_b32 s63, s61, 8192
  v_mov_b32 v92, 0
  v_mov_b32 v93, 0
  v_mov_b32 v94, 0
  v_mov_b32 v95, 0
  v_mov_b32 v96, 0
  v_mov_b32 v97, 0
  v_mov_b32 v98, 0
  v_mov_b32 v99, 0
  v_mov_b32 v100, 0
  v_mov_b32 v101, 0
  v_mov_b32 v102, 0
  v_mov_b32 v103, 0
  v_mov_b32 v104, 0
  v_mov_b32 v105, 0
  v_mov_b32 v106, 0
  v_mov_b32 v107, 0
  v_mov_b32 v68, 0
  v_mov_b32 v69, 0
  v_mov_b32 v70, 0
  v_mov_b32 v71, 0
  v_mov_b32 v72, 0
  v_mov_b32 v73, 0
  v_mov_b32 v74, 0
  v_mov_b32 v75, 0
  v_mov_b32 v76, 0
  v_mov_b32 v77, 0
  v_mov_b32 v78, 0
  v_mov_b32 v79, 0
chain_loop_c1w:
  s_mov_b32 s41, 0
  buffer_load_dwordx4 v[152:155], v126, s[8:11], s46 offen sc1
  buffer_load_dwordx4 v[156:159], v126, s[8:11], s46 offen offset:1024 sc1
  buffer_load_dwordx2 v[160:161], v127, s[8:11], s46 offen sc1
  s_sleep 2
mq_70:
  buffer_load_dwordx4 v[162:165], v126, s[8:11], s46 offen sc1
  buffer_load_dwordx4 v[108:111], v126, s[8:11], s46 offen offset:1024 sc1
  buffer_load_dwordx2 v[112:113], v127, s[8:11], s46 offen sc1
  s_waitcnt vmcnt(3)
  v_max3_u32 v140, v152, v153, v154
  v_max3_u32 v141, v155, v156, v157
  v_max3_u32 v140, v140, v158, v159
  v_max3_u32 v141, v141, v160, v161
  v_max_u32 v140, v140, v141
  v_cmp_eq_u32 vcc, -1, v140
  s_cbranch_vccz mq_70_a
  buffer_load_dwordx4 v[152:155], v126, s[8:11], s46 offen sc1
  buffer_load_dwordx4 v[156:159], v126, s[8:11], s46 offen offset:1024 sc1
  buffer_load_dwordx2 v[160:161], v127, s[8:11], s46 offen sc1
  s_add_u32 s41, s41, 1
  s_cmp_gt_u32 s41, 65536
  s_cbranch_scc1 chain_abort
  s_waitcnt vmcnt(3)
  v_max3_u32 v140, v162, v163, v164
  v_max3_u32 v141, v165, v108, v109
  v_max3_u32 v140, v140, v110, v111
  v_max3_u32 v141, v141, v112, v113
  v_max_u32 v140, v140, v141
  v_cmp_eq_u32 vcc, -1, v140
  s_cbranch_vccnz mq_70
  ds_write_b128 v126, v[162:165]
  ds_write_b128 v126, v[108:111] offset:1024
  ds_write_b64 v127, v[112:113]
  s_branch mq_70_ok
mq_70_a:
  ds_write_b128 v126, v[152:155]
  ds_write_b128 v126, v[156:159] offset:1024
  ds_write_b64 v127, v[160:161]
mq_70_ok:
  s_waitcnt lgkmcnt(0)
  s_barrier
  ds_read_b128 v[4:7], v124 offset:0
  ds_read_b128 v[8:11], v124 offset:1024
  ds_read_b128 v[12:15], v124 offset:2048
  ds_read_b128 v[16:19], v124 offset:3072
  ds_read_b128 v[20:23], v124 offset:4096
  ds_read_b128 v[24:27], v124 offset:5120
  ds_read_b128 v[28:31], v124 offset:6144
  ds_read_b128 v[32:35], v124 offset:7168
  ds_read_b128 v[36:39], v124 offset:8192
  ds_read_b128 v[40:43], v124 offset:9216
  s_waitcnt lgkmcnt(9)
  v_smfmac_f32_16x16x64_bf16 v[68:71], v[4:7], a[0:7], v136
  v_smfmac_f32_16x16x64_bf16 v[72:75], v[4:7], a[80:87], v136
  buffer_load_dwordx4 v[44:47], v124, s[8:11], s60 offen offset:0 sc1
  s_waitcnt lgkmcnt(8)
  v_smfmac_f32_16x16x64_bf16 v[68:71], v[8:11], a[8:15], v136
  v_smfmac_f32_16x16x64_bf16 v[72:75], v[8:11], a[88:95], v136
  buffer_load_dwordx4 v[48:51], v124, s[8:11], s60 offen offset:1024 sc1
  s_waitcnt lgkmcnt(7)
  v_smfmac_f32_16x16x64_bf16 v[68:71], v[12:15], a[16:23], v136
  v_smfmac_f32_16x16x64_bf16 v[72:75], v[12:15], a[96:103], v136
  buffer_load_dwordx4 v[52:55], v124, s[8:11], s60 offen offset:2048 sc1
  s_waitcnt lgkmcnt(6)
  v_smfmac_f32_16x16x64_bf16 v[68:71], v[16:19], a[24:31], v136
  v_smfmac_f32_16x16x64_bf16 v[72:75], v[16:19], a[104:111], v136
  buffer_load_dwordx4 v[56:59], v124, s[8:11], s60 offen offset:3072 sc1
  s_waitcnt lgkmcnt(5)
  v_smfmac_f32_16x16x64_bf16 v[68:71], v[20:23], a[32:39], v136
  v_smfmac_f32_16x16x64_bf16 v[72:75], v[20:23], a[112:119], v136
  buffer_store_dwordx4 v[80:83], v124, s[8:11], s58 offen
  s_waitcnt lgkmcnt(4)
  v_smfmac_f32_16x16x64_bf16 v[68:71], v[24:27], a[40:47], v136
  v_smfmac_f32_16x16x64_bf16 v[72:75], v[24:27], a[120:127], v136
  buffer_store_dwordx4 v[84:87], v124, s[8:11], s54 offen
  s_waitcnt lgkmcnt(3)
  v_smfmac_f32_16x16x64_bf16 v[68:71], v[28:31], a[48:55], v136
  v_smfmac_f32_16x16x64_bf16 v[72:75], v[28:31], a[128:135], v136
  buffer_load_dword v139, v134, s[8:11], 0 offen sc1
  s_waitcnt lgkmcnt(2)
  v_smfmac_f32_16x16x64_bf16 v[68:71], v[32:35], a[56:63], v136
  v_smfmac_f32_16x16x64_bf16 v[72:75], v[32:35], a[136:143], v136
  s_waitcnt lgkmcnt(1)
  v_smfmac_f32_16x16x64_bf16 v[68:71], v[36:39], a[64:71], v136
  v_smfmac_f32_16x16x64_bf16 v[72:75], v[36:39], a[144:151], v136
  s_waitcnt lgkmcnt(0)
  v_smfmac_f32_16x16x64_bf16 v[68:71], v[40:43], a[72:79], v136
  v_smfmac_f32_16x16x64_bf16 v[72:75], v[40:43], a[152:159], v136
  v_smfmac_f32_16x16x64_bf16 v[76:79], v[4:7], a[160:167], v136
  v_smfmac_f32_16x16x64_bf16 v[76:79], v[8:11], a[168:175], v136
  s_nop 4
  v_add_f32 v68, v68, v70
  v_add_f32 v69, v69, v71
  v_add_f32 v72, v72, v74
  v_add_f32 v73, v73, v75
  v_smfmac_f32_16x16x64_bf16 v[76:79], v[12:15], a[176:183], v136
  v_cvt_pk_bf16_f32 v122, v68, v69
  v_cvt_pk_bf16_f32 v123, v72, v73
  ds_write2_b32 v128, v122, v122 offset0:0 offset1:4
  ds_write2_b32 v129, v123, v123 offset0:0 offset1:1
  v_smfmac_f32_16x16x64_bf16 v[76:79], v[16:19], a[184:191], v136
  v_smfmac_f32_16x16x64_bf16 v[76:79], v[20:23], a[192:199], v136
  s_waitcnt lgkmcnt(0)
  s_barrier
  ds_read_b64_tr_b16 v[144:145], v125 offset:10240
  ds_read_b64_tr_b16 v[60:61], v125 offset:12288
  ds_read_b64_tr_b16 v[146:147], v125 offset:10752
  ds_read_b64_tr_b16 v[62:63], v125 offset:12800
  ds_read_b64_tr_b16 v[148:149], v125 offset:11264
  ds_read_b64_tr_b16 v[64:65], v125 offset:13312
  ds_read_b64_tr_b16 v[150:151], v125 offset:11776
  ds_read_b64_tr_b16 v[66:67], v125 offset:13824
  v_smfmac_f32_16x16x64_bf16 v[76:79], v[24:27], a[200:207], v136
  v_smfmac_f32_16x16x64_bf16 v[76:79], v[28:31], a[208:215], v136
  v_smfmac_f32_16x16x64_bf16 v[76:79], v[32:35], a[216:223], v136
  s_waitcnt lgkmcnt(4)
  v_mfma_f32_16x16x32_bf16 v[80:83], v[60:63], v[144:147], 0
  s_waitcnt lgkmcnt(0)
  v_mfma_f32_16x16x32_bf16 v[80:83], v[64:67], v[148:151], v[80:83]
  v_smfmac_f32_16x16x64_bf16 v[76:79], v[36:39], a[224:231], v136
  v_smfmac_f32_16x16x64_bf16 v[76:79], v[40:43], a[232:239], v136
  s_nop 5
  v_cndmask_b32 v80, v80, v81, s[68:69]
  buffer_store_dword v80, v124, s[8:11], s50 offen
  v_add_f32 v76, v76, v78
  v_add_f32 v77, v77, v79
  v_cvt_pk_bf16_f32 v140, v76, v77
  s_nop 1
  v_mov_b32_dpp v141, v140 row_ror:4 row_mask:0xf bank_mask:0xa
  s_nop 1
  v_mov_b32_dpp v141, v140 row_ror:12 row_mask:0xf bank_mask:0x5
  v_perm_b32 v140, v141, v140, v137
  buffer_store_dword v140, v130, s[8:11], s51 offen
  s_sleep 2
  s_nop 3
  s_nop 3
  buffer_load_dwordx4 v[4:7], v124, s[8:11], s52 offen offset:0 sc1
  buffer_load_dwordx4 v[8:11], v124, s[8:11], s52 offen offset:1024 sc1
  buffer_load_dwordx4 v[12:15], v124, s[8:11], s52 offen offset:2048 sc1
  buffer_load_dwordx3 v[16:18], v124, s[8:11], s52 offen offset:3072 sc1
  buffer_load_dwordx4 v[20:23], v124, s[8:11], s53 offen offset:0 sc1
  buffer_load_dwordx4 v[24:27], v124, s[8:11], s53 offen offset:1024 sc1
  buffer_load_dwordx4 v[28:31], v124, s[8:11], s53 offen offset:2048 sc1
  s_mov_b32 s41, 0
  s_waitcnt vmcnt(3)
gs_71_in:
  v_pk_add_f32 v[152:153], v[4:5], v[8:9]
  v_pk_add_f32 v[154:155], v[6:7], v[10:11]
  v_add_f32 v156, v16, v17
  v_pk_add_f32 v[152:153], v[152:153], v[12:13]
  v_pk_add_f32 v[154:155], v[154:155], v[14:15]
  v_add_f32 v156, v156, v18
  v_cmp_u_f32 s[76:77], v152, v153
  v_cmp_u_f32 s[72:73], v154, v155
  v_cmp_u_f32 s[74:75], v156, v156
  v_max3_f32 v140, v152, v153, v154
  s_or_b64 s[72:73], s[76:77], s[72:73]
  v_max3_f32 v140, v140, v155, v156
  s_or_b64 s[72:73], s[72:73], s[74:75]
  s_waitcnt vmcnt(0)
  v_max3_u32 v142, v20, v21, v22
  v_max3_u32 v143, v23, v24, v25
  v_max3_u32 v142, v142, v26, v27
  v_max3_u32 v143, v143, v28, v29
  v_max3_u32 v142, v142, v30, v31
  v_max_u32 v142, v142, v143
  v_cmp_eq_u32 vcc, -1, v142
  s_nop 0
  s_or_b64 vcc, vcc, s[72:73]
  s_cbranch_vccnz gs_71
  v_smfmac_f32_16x16x64_bf16 v[92:95], v[20:23], v[176:183], v136
  v_max_f32_dpp v140, v140, v140 row_ror:8 row_mask:0xf bank_mask:0xf
  v_mov_b32 v141, v140
  v_smfmac_f32_16x16x64_bf16 v[96:99], v[20:23], v[200:207], v136
  v_mul_f32 v152, 0x3dd53b95, v152
  v_mul_f32 v153, 0x3dd53b95, v153
  v_smfmac_f32_16x16x64_bf16 v[100:103], v[20:23], v[224:231], v136
  v_permlane16_swap_b32 v140, v141
  v_max_f32 v140, v140, v141
  v_smfmac_f32_16x16x64_bf16 v[104:107], v[20:23], v[248:255], v136
  v_mov_b32 v141, v140
  v_mul_f32 v154, 0x3dd53b95, v154
  v_smfmac_f32_16x16x64_bf16 v[92:95], v[24:27], v[184:191], v136
  v_mul_f32 v155, 0x3dd53b95, v155
  v_permlane32_swap_b32 v140, v141
  v_smfmac_f32_16x16x64_bf16 v[96:99], v[24:27], v[208:215], v136
  v_max_f32 v140, v140, v141
  v_mul_f32 v156, 0x3dd53b95, v156
  v_smfmac_f32_16x16x64_bf16 v[100:103], v[24:27], v[232:239], v136
  v_mul_f32 v140, 0x3dd53b95, v140
  v_sub_f32 v156, v156, v140
  v_smfmac_f32_16x16x64_bf16 v[104:107], v[24:27], a[240:247], v136
  v_sub_f32 v152, v152, v140
  v_sub_f32 v153, v153, v140
  v_smfmac_f32_16x16x64_bf16 v[92:95], v[28:31], v[192:199], v136
  v_sub_f32 v154, v154, v140
  v_sub_f32 v155, v155, v140
  v_smfmac_f32_16x16x64_bf16 v[96:99], v[28:31], v[216:223], v136
  v_exp_f32 v156, v156
  v_exp_f32 v152, v152
  v_smfmac_f32_16x16x64_bf16 v[100:103], v[28:31], v[240:247], v136
  v_exp_f32 v153, v153
  v_exp_f32 v154, v154
  v_smfmac_f32_16x16x64_bf16 v[104:107], v[28:31], a[248:255], v136
  v_exp_f32 v155, v155
  v_mov_b32_dpp v157, v156 row_ror:8 row_mask:0xf bank_mask:0xf
  v_cvt_pk_bf16_f32 v116, v152, v153
  v_cvt_pk_bf16_f32 v117, v154, v155
  v_cvt_pk_bf16_f32 v120, v156, v157
  v_mov_b32_dpp v118, v116 row_ror:8 row_mask:0xf bank_mask:0xf
  v_mov_b32_dpp v119, v117 row_ror:8 row_mask:0xf bank_mask:0xf
  v_mov_b32 v121, v120
  s_nop 0
  v_mfma_f32_16x16x32_bf16 v[80:83], v[88:91], v[116:119], 0
  v_cvt_pk_bf16_f32 v108, v92, v93
  v_cvt_pk_bf16_f32 v109, v94, v95
  v_mfma_f32_16x16x32_bf16 v[152:155], v[44:47], v[116:119], 0
  v_cvt_pk_bf16_f32 v110, v96, v97
  v_cvt_pk_bf16_f32 v111, v98, v99
  v_mfma_f32_16x16x32_bf16 v[156:159], v[48:51], v[116:119], 0
  v_mfma_f32_16x16x16_bf16 v[80:83], v[168:169], v[120:121], v[80:83]
  v_cvt_pk_bf16_f32 v112, v100, v101
  v_cvt_pk_bf16_f32 v113, v102, v103
  v_mfma_f32_16x16x32_bf16 v[160:163], v[52:55], v[116:119], 0
  v_cvt_pk_bf16_f32 v114, v104, v105
  v_cvt_pk_bf16_f32 v115, v106, v107
  v_mfma_f32_16x16x32_bf16 v[164:167], v[56:59], v[116:119], 0
  s_add_u32 s40, s40, 1
  v_mfma_f32_16x16x16_bf16 v[152:155], v[108:109], v[120:121], v[152:155]
  v_mfma_f32_16x16x16_bf16 v[156:159], v[110:111], v[120:121], v[156:159]
  v_rcp_f32 v122, v80
  v_mfma_f32_16x16x16_bf16 v[160:163], v[112:113], v[120:121], v[160:163]
  s_nop 0
  v_mfma_f32_16x16x16_bf16 v[164:167], v[114:115], v[120:121], v[164:167]
  v_mov_b32 v123, v122
  s_cmp_eq_u32 s40, 64
  s_cbranch_scc1 chain_last_c1w
  s_mov_b64 exec, s[66:67]
  v_pk_mul_f32 v[152:153], v[122:123], v[152:153]
  v_pk_mul_f32 v[154:155], v[122:123], v[154:155]
  ds_write_b128 v131, v[152:155] offset:0
  v_pk_mul_f32 v[156:157], v[122:123], v[156:157]
  v_pk_mul_f32 v[158:159], v[122:123], v[158:159]
  ds_write_b128 v131, v[156:159] offset:512
  v_pk_mul_f32 v[160:161], v[122:123], v[160:161]
  v_pk_mul_f32 v[162:163], v[122:123], v[162:163]
  ds_write_b128 v131, v[160:163] offset:1024
  v_pk_mul_f32 v[164:165], v[122:123], v[164:165]
  v_pk_mul_f32 v[166:167], v[122:123], v[166:167]
  ds_write_b128 v131, v[164:167] offset:1536
  s_mov_b64 exec, -1
  s_waitcnt lgkmcnt(0)
  s_barrier
  ds_read_b64 v[144:145], v132 offset:0
  ds_read_b64 v[146:147], v132 offset:2048
  ds_read_b64 v[148:149], v132 offset:4096
  ds_read_b64 v[150:151], v132 offset:6144
  s_mov_b32 s45, s62
  s_waitcnt lgkmcnt(2)
  v_pk_add_f32 v[144:145], v[144:145], v[146:147]
  s_waitcnt lgkmcnt(0)
  v_pk_add_f32 v[148:149], v[148:149], v[150:151]
  v_pk_add_f32 v[122:123], v[144:145], v[148:149]
  v_cvt_pk_bf16_f32 v122, v122, v123
  buffer_store_dword v122, v170, s[8:11], s63 offen sc1
  buffer_store_dword v122, v170, s[8:11], s61 offen sc1
  s_add_u32 s78, s40, 1
  s_sub_u32 s42, s40, 1
  v_mov_b32 v143, s42
  buffer_store_dword v84, v133, s[8:11], s46 offen
  buffer_store_dword v143, v135, s[8:11], 0 offen
  s_mov_b32 s41, 0
cpw_73:
  v_cmp_gt_u32 vcc, s78, v139
  s_nop 0
  s_and_b32 vcc_lo, vcc_lo, 0xfff000
  s_and_b32 vcc_hi, vcc_hi, 0xfffff0
  s_cmp_eq_u64 vcc, 0
  s_cbranch_scc1 cpo_74
  s_sleep 1
  buffer_load_dword v139, v134, s[8:11], 0 offen sc1
  s_add_u32 s41, s41, 1
  s_cmp_gt_u32 s41, 65536
  s_cbranch_scc1 chain_abort
  s_waitcnt vmcnt(0)
  s_branch cpw_73
cpo_74:
  v_add_f32 v92, v92, v94
  v_add_f32 v93, v93, v95
  v_cvt_pk_bf16_f32 v80, v92, v93
  v_add_f32 v96, v96, v98
  v_add_f32 v97, v97, v99
  v_cvt_pk_bf16_f32 v81, v96, v97
  v_add_f32 v100, v100, v102
  v_add_f32 v101, v101, v103
  v_cvt_pk_bf16_f32 v82, v100, v101
  v_add_f32 v104, v104, v106
  v_add_f32 v105, v105, v107
  v_cvt_pk_bf16_f32 v83, v104, v105
  s_mov_b32 s42, s46
  s_mov_b32 s46, s47
  s_mov_b32 s47, s42
  s_sub_u32 s43, s40, 1
  s_and_b32 s43, s43, 3
  s_mul_i32 s43, s43, 227328
  s_add_u32 s57, s24, s43
  s_add_u32 s58, s25, s43
  s_add_u32 s54, s55, s79
  s_and_b32 s42, s40, 3
  s_lshl_b32 s43, s42, 15
  s_add_u32 s52, s49, s43
  s_add_u32 s53, s52, 4096
  s_add_u32 s55, s48, s43
  s_add_u32 s50, s55, s56
  s_lshl_b32 s44, s38, 10
  s_add_u32 s51, s55, s44
  s_add_u32 s51, s51, 4096
  s_mul_i32 s60, s42, 227328
  s_add_u32 s60, s60, s26
  s_mul_i32 s62, s42, 163840
  s_add_u32 s62, s62, s64
  s_lshl_b32 s43, s16, 8
  s_add_u32 s61, s62, s43
  s_xor_b32 s63, s61, 8192
  v_mov_b32 v92, 0
  v_mov_b32 v93, 0
  v_mov_b32 v94, 0
  v_mov_b32 v95, 0
  v_mov_b32 v96, 0
  v_mov_b32 v97, 0
  v_mov_b32 v98, 0
  v_mov_b32 v99, 0
  v_mov_b32 v100, 0
  v_mov_b32 v101, 0
  v_mov_b32 v102, 0
  v_mov_b32 v103, 0
  v_mov_b32 v104, 0
  v_mov_b32 v105, 0
  v_mov_b32 v106, 0
  v_mov_b32 v107, 0
  v_mov_b32 v68, 0
  v_mov_b32 v69, 0
  v_mov_b32 v70, 0
  v_mov_b32 v71, 0
  v_mov_b32 v72, 0
  v_mov_b32 v73, 0
  v_mov_b32 v74, 0
  v_mov_b32 v75, 0
  v_mov_b32 v76, 0
  v_mov_b32 v77, 0
  v_mov_b32 v78, 0
  v_mov_b32 v79, 0
  s_sleep 2
  buffer_load_dwordx4 v[4:7], v124, s[8:11], s45 offen offset:0 sc1
  buffer_load_dwordx4 v[8:11], v124, s[8:11], s45 offen offset:1024 sc1
  s_mov_b32 s41, 0
xp_75:
  s_waitcnt vmcnt(0)
  v_mfma_f32_16x16x32_bf16 v[36:39], v[172:175], v[4:7], 0
  v_mfma_f32_16x16x32_bf16 v[36:39], v[172:175], v[8:11], v[36:39]
  s_nop 7
  v_cmp_u_f32 vcc, v36, v37
  v_cvt_pk_bf16_f32 v141, v36, v37
  s_cbranch_vccnz xp_75_r
  buffer_store_dword v141, v133, s[8:11], s46 offen
  s_branch chain_loop_c1w
gs_71:
  v_max3_u32 v142, v4, v5, v6
  v_max_u32 v142, v142, v7
  v_cmp_eq_u32 vcc, -1, v142
  s_cbranch_vccz gs_71_s0
  s_mov_b64 exec, vcc
  buffer_load_dwordx4 v[4:7], v124, s[8:11], s52 offen offset:0 sc1
  s_mov_b64 exec, -1
gs_71_s0:
  v_max3_u32 v142, v8, v9, v10
  v_max_u32 v142, v142, v11
  v_cmp_eq_u32 vcc, -1, v142
  s_cbranch_vccz gs_71_s1
  s_mov_b64 exec, vcc
  buffer_load_dwordx4 v[8:11], v124, s[8:11], s52 offen offset:1024 sc1
  s_mov_b64 exec, -1
gs_71_s1:
  v_max3_u32 v142, v12, v13, v14
  v_max_u32 v142, v142, v15
  v_cmp_eq_u32 vcc, -1, v142
  s_cbranch_vccz gs_71_s2
  s_mov_b64 exec, vcc
  buffer_load_dwordx4 v[12:15], v124, s[8:11], s52 offen offset:2048 sc1
  s_mov_b64 exec, -1
gs_71_s2:
  v_max3_u32 v142, v16, v17, v18
  v_cmp_eq_u32 vcc, -1, v142
  s_cbranch_vccz gs_71_s3
  s_mov_b64 exec, vcc
  buffer_load_dwordx3 v[16:18], v124, s[8:11], s52 offen offset:3072 sc1
  s_mov_b64 exec, -1
gs_71_s3:
  v_max3_u32 v142, v20, v21, v22
  v_max_u32 v142, v142, v23
  v_cmp_eq_u32 vcc, -1, v142
  s_cbranch_vccz gs_71_s4
  s_mov_b64 exec, vcc
  buffer_load_dwordx4 v[20:23], v124, s[8:11], s53 offen offset:0 sc1
  s_mov_b64 exec, -1
gs_71_s4:
  v_max3_u32 v142, v24, v25, v26
  v_max_u32 v142, v142, v27
  v_cmp_eq_u32 vcc, -1, v142
  s_cbranch_vccz gs_71_s5
  s_mov_b64 exec, vcc
  buffer_load_dwordx4 v[24:27], v124, s[8:11], s53 offen offset:1024 sc1
  s_mov_b64 exec, -1
gs_71_s5:
  v_max3_u32 v142, v28, v29, v30
  v_max_u32 v142, v142, v31
  v_cmp_eq_u32 vcc, -1, v142
  s_cbranch_vccz gs_71_s6
  s_mov_b64 exec, vcc
  buffer_load_dwordx4 v[28:31], v124, s[8:11], s53 offen offset:2048 sc1
  s_mov_b64 exec, -1
gs_71_s6:
  s_add_u32 s41, s41, 1
  s_cmp_gt_u32 s41, 65536
  s_cbranch_scc1 chain_abort
  s_waitcnt vmcnt(0)
  s_branch gs_71_in
xp_75_r:
  v_max3_u32 v140, v4, v5, v6
  v_max_u32 v140, v140, v7
  v_cmp_eq_u32 vcc, -1, v140
  s_cbranch_vccz xp_75_s0
  s_mov_b64 exec, vcc
  buffer_load_dwordx4 v[4:7], v124, s[8:11], s45 offen offset:0 sc1
  s_mov_b64 exec, -1
xp_75_s0:
  v_max3_u32 v140, v8, v9, v10
  v_max_u32 v140, v140, v11
  v_cmp_eq_u32 vcc, -1, v140
  s_cbranch_vccz xp_75_s1
  s_mov_b64 exec, vcc
  buffer_load_dwordx4 v[8:11], v124, s[8:11], s45 offen offset:1024 sc1
  s_mov_b64 exec, -1
xp_75_s1:
  s_add_u32 s41, s41, 1
  s_cmp_gt_u32 s41, 65536
  s_cbranch_scc1 chain_abort
  s_branch xp_75
chain_last_c1w:
  s_sub_u32 s43, s40, 1
  s_and_b32 s43, s43, 3
  s_mul_i32 s43, s43, 227328
  s_add_u32 s57, s24, s43
  s_add_u32 s58, s25, s43
  v_add_f32 v92, v92, v94
  v_add_f32 v93, v93, v95
  v_cvt_pk_bf16_f32 v80, v92, v93
  v_add_f32 v96, v96, v98
  v_add_f32 v97, v97, v99
  v_cvt_pk_bf16_f32 v81, v96, v97
  v_add_f32 v100, v100, v102
  v_add_f32 v101, v101, v103
  v_cvt_pk_bf16_f32 v82, v100, v101
  v_add_f32 v104, v104, v106
  v_add_f32 v105, v105, v107
  v_cvt_pk_bf16_f32 v83, v104, v105
  buffer_store_dwordx4 v[80:83], v124, s[8:11], s58 offen
  v_mov_b32 v143, s40
  s_branch chain_fin
chain_pro_c2w:
  s_mov_b32 s78, 1
  v_mov_b32 v143, 0
  s_mov_b32 s41, 0
cpw_76:
  v_cmp_gt_u32 vcc, s78, v139
  s_nop 0
  s_and_b32 vcc_lo, vcc_lo, 0xfff000
  s_and_b32 vcc_hi, vcc_hi, 0x10fffff0
  s_cmp_eq_u64 vcc, 0
  s_cbranch_scc1 cpo_77
  s_sleep 1
  buffer_load_dword v139, v134, s[8:11], 0 offen sc1
  s_add_u32 s41, s41, 1
  s_cmp_gt_u32 s41, 65536
  s_cbranch_scc1 chain_abort
  s_waitcnt vmcnt(0)
  s_branch cpw_76
cpo_77:
  v_readlane_b32 s42, v139, 60
  s_nop 0
  s_sub_u32 s42, s42, 1
  s_lshl_b32 s42, s42, 13
  s_add_u32 s64, s64, s42
  s_add_u32 s55, s48, 98304
  s_sub_u32 s43, s40, 1
  s_and_b32 s43, s43, 3
  s_mul_i32 s43, s43, 227328
  s_add_u32 s57, s24, s43
  s_add_u32 s58, s25, s43
  s_add_u32 s54, s55, s79
  s_and_b32 s42, s40, 3
  s_lshl_b32 s43, s42, 15
  s_add_u32 s52, s49, s43
  s_add_u32 s53, s52, 4096
  s_add_u32 s55, s48, s43
  s_add_u32 s50, s55, s56
  s_lshl_b32 s44, s38, 10
  s_add_u32 s51, s55, s44
  s_add_u32 s51, s51, 4096
  s_mul_i32 s60, s42, 227328
  s_add_u32 s60, s60, s26
  s_mul_i32 s62, s42, 163840
  s_add_u32 s62, s62, s64
  s_lshl_b32 s43, s16, 8
  s_add_u32 s61, s62, s43
  s_xor_b32 s63, s61, 8192
  v_mov_b32 v92, 0
  v_mov_b32 v93, 0
  v_mov_b32 v94, 0
  v_mov_b32 v95, 0
  v_mov_b32 v96, 0
  v_mov_b32 v97, 0
  v_mov_b32 v98, 0
  v_mov_b32 v99, 0
  v_mov_b32 v100, 0
  v_mov_b32 v101, 0
  v_mov_b32 v102, 0
  v_mov_b32 v103, 0
  v_mov_b32 v104, 0
  v_mov_b32 v105, 0
  v_mov_b32 v106, 0
  v_mov_b32 v107, 0
  v_mov_b32 v68, 0
  v_mov_b32 v69, 0
  v_mov_b32 v70, 0
  v_mov_b32 v71, 0
  v_mov_b32 v72, 0
  v_mov_b32 v73, 0
  v_mov_b32 v74, 0
  v_mov_b32 v75, 0
  v_mov_b32 v76, 0
  v_mov_b32 v77, 0
  v_mov_b32 v78, 0
  v_mov_b32 v79, 0
chain_loop_c2w:
  s_mov_b32 s41, 0
  buffer_load_dwordx4 v[152:155], v126, s[8:11], s46 offen sc1
  buffer_load_dwordx4 v[156:159], v126, s[8:11], s46 offen offset:1024 sc1
  buffer_load_dwordx2 v[160:161], v127, s[8:11], s46 offen sc1
  s_sleep 2
mq_78:
  buffer_load_dwordx4 v[162:165], v126, s[8:11], s46 offen sc1
  buffer_load_dwordx4 v[108:111], v126, s[8:11], s46 offen offset:1024 sc1
  buffer_load_dwordx2 v[112:113], v127, s[8:11], s46 offen sc1
  s_waitcnt vmcnt(3)
  v_max3_u32 v140, v152, v153, v154
  v_max3_u32 v141, v155, v156, v157
  v_max3_u32 v140, v140, v158, v159
  v_max3_u32 v141, v141, v160, v161
  v_max_u32 v140, v140, v141
  v_cmp_eq_u32 vcc, -1, v140
  s_cbranch_vccz mq_78_a
  buffer_load_dwordx4 v[152:155], v126, s[8:11], s46 offen sc1
  buffer_load_dwordx4 v[156:159], v126, s[8:11], s46 offen offset:1024 sc1
  buffer_load_dwordx2 v[160:161], v127, s[8:11], s46 offen sc1
  s_add_u32 s41, s41, 1
  s_cmp_gt_u32 s41, 65536
  s_cbranch_scc1 chain_abort
  s_waitcnt vmcnt(3)
  v_max3_u32 v140, v162, v163, v164
  v_max3_u32 v141, v165, v108, v109
  v_max3_u32 v140, v140, v110, v111
  v_max3_u32 v141, v141, v112, v113
  v_max_u32 v140, v140, v141
  v_cmp_eq_u32 vcc, -1, v140
  s_cbranch_vccnz mq_78
  ds_write_b128 v126, v[162:165]
  ds_write_b128 v126, v[108:111] offset:1024
  ds_write_b64 v127, v[112:113]
  s_branch mq_78_ok
mq_78_a:
  ds_write_b128 v126, v[152:155]
  ds_write_b128 v126, v[156:159] offset:1024
  ds_write_b64 v127, v[160:161]
mq_78_ok:
  s_waitcnt lgkmcnt(0)
  s_barrier
  ds_read_b128 v[4:7], v124 offset:0
  ds_read_b128 v[8:11], v124 offset:1024
  ds_read_b128 v[12:15], v124 offset:2048
  ds_read_b128 v[16:19], v124 offset:3072
  ds_read_b128 v[20:23], v124 offset:4096
  ds_read_b128 v[24:27], v124 offset:5120
  ds_read_b128 v[28:31], v124 offset:6144
  ds_read_b128 v[32:35], v124 offset:7168
  ds_read_b128 v[36:39], v124 offset:8192
  ds_read_b128 v[40:43], v124 offset:9216
  s_waitcnt lgkmcnt(9)
  v_smfmac_f32_16x16x64_bf16 v[68:71], v[4:7], a[0:7], v136
  v_smfmac_f32_16x16x64_bf16 v[72:75], v[4:7], a[80:87], v136
  buffer_load_dwordx4 v[44:47], v124, s[8:11], s60 offen offset:0 sc1
  s_waitcnt lgkmcnt(8)
  v_smfmac_f32_16x16x64_bf16 v[68:71], v[8:11], a[8:15], v136
  v_smfmac_f32_16x16x64_bf16 v[72:75], v[8:11], a[88:95], v136
  buffer_load_dwordx4 v[48:51], v124, s[8:11], s60 offen offset:1024 sc1
  s_waitcnt lgkmcnt(7)
  v_smfmac_f32_16x16x64_bf16 v[68:71], v[12:15], a[16:23], v136
  v_smfmac_f32_16x16x64_bf16 v[72:75], v[12:15], a[96:103], v136
  buffer_load_dwordx4 v[52:55], v124, s[8:11], s60 offen offset:2048 sc1
  s_waitcnt lgkmcnt(6)
  v_smfmac_f32_16x16x64_bf16 v[68:71], v[16:19], a[24:31], v136
  v_smfmac_f32_16x16x64_bf16 v[72:75], v[16:19], a[104:111], v136
  buffer_load_dwordx4 v[56:59], v124, s[8:11], s60 offen offset:3072 sc1
  s_waitcnt lgkmcnt(5)
  v_smfmac_f32_16x16x64_bf16 v[68:71], v[20:23], a[32:39], v136
  v_smfmac_f32_16x16x64_bf16 v[72:75], v[20:23], a[112:119], v136
  buffer_store_dwordx4 v[80:83], v124, s[8:11], s58 offen
  s_waitcnt lgkmcnt(4)
  v_smfmac_f32_16x16x64_bf16 v[68:71], v[24:27], a[40:47], v136
  v_smfmac_f32_16x16x64_bf16 v[72:75], v[24:27], a[120:127], v136
  buffer_store_dwordx4 v[60:63], v138, s[8:11], s57 offen
  s_waitcnt lgkmcnt(3)
  v_smfmac_f32_16x16x64_bf16 v[68:71], v[28:31], a[48:55], v136
  v_smfmac_f32_16x16x64_bf16 v[72:75], v[28:31], a[128:135], v136
  buffer_store_dwordx4 v[64:67], v138, s[8:11], s57 offen offset:512
  s_waitcnt lgkmcnt(2)
  v_smfmac_f32_16x16x64_bf16 v[68:71], v[32:35], a[56:63], v136
  v_smfmac_f32_16x16x64_bf16 v[72:75], v[32:35], a[136:143], v136
  buffer_load_dword v139, v134, s[8:11], 0 offen sc1
  s_waitcnt lgkmcnt(1)
  v_smfmac_f32_16x16x64_bf16 v[68:71], v[36:39], a[64:71], v136
  v_smfmac_f32_16x16x64_bf16 v[72:75], v[36:39], a[144:151], v136
  s_waitcnt lgkmcnt(0)
  v_smfmac_f32_16x16x64_bf16 v[68:71], v[40:43], a[72:79], v136
  v_smfmac_f32_16x16x64_bf16 v[72:75], v[40:43], a[152:159], v136
  v_smfmac_f32_16x16x64_bf16 v[76:79], v[4:7], a[160:167], v136
  v_smfmac_f32_16x16x64_bf16 v[76:79], v[8:11], a[168:175], v136
  s_nop 4
  v_add_f32 v68, v68, v70
  v_add_f32 v69, v69, v71
  v_add_f32 v72, v72, v74
  v_add_f32 v73, v73, v75
  v_smfmac_f32_16x16x64_bf16 v[76:79], v[12:15], a[176:183], v136
  v_cvt_pk_bf16_f32 v122, v68, v69
  v_cvt_pk_bf16_f32 v123, v72, v73
  ds_write2_b32 v128, v122, v122 offset0:0 offset1:4
  ds_write2_b32 v129, v123, v123 offset0:0 offset1:1
  v_smfmac_f32_16x16x64_bf16 v[76:79], v[16:19], a[184:191], v136
  v_smfmac_f32_16x16x64_bf16 v[76:79], v[20:23], a[192:199], v136
  s_waitcnt lgkmcnt(0)
  s_barrier
  ds_read_b64_tr_b16 v[60:61], v125 offset:12288
  ds_read_b64_tr_b16 v[62:63], v125 offset:12800
  ds_read_b64_tr_b16 v[64:65], v125 offset:13312
  ds_read_b64_tr_b16 v[66:67], v125 offset:13824
  v_smfmac_f32_16x16x64_bf16 v[76:79], v[24:27], a[200:207], v136
  v_smfmac_f32_16x16x64_bf16 v[76:79], v[28:31], a[208:215], v136
  v_smfmac_f32_16x16x64_bf16 v[76:79], v[32:35], a[216:223], v136
  v_smfmac_f32_16x16x64_bf16 v[76:79], v[36:39], a[224:231], v136
  v_smfmac_f32_16x16x64_bf16 v[76:79], v[40:43], a[232:239], v136
  s_nop 7
  v_add_f32 v76, v76, v78
  v_add_f32 v77, v77, v79
  v_cvt_pk_bf16_f32 v140, v76, v77
  s_nop 1
  v_mov_b32_dpp v141, v140 row_ror:4 row_mask:0xf bank_mask:0xa
  s_nop 1
  v_mov_b32_dpp v141, v140 row_ror:12 row_mask:0xf bank_mask:0x5
  v_perm_b32 v140, v141, v140, v137
  buffer_store_dword v140, v130, s[8:11], s51 offen
  s_sleep 4
  buffer_load_dwordx4 v[4:7], v124, s[8:11], s52 offen offset:0 sc1
  buffer_load_dwordx4 v[8:11], v124, s[8:11], s52 offen offset:1024 sc1
  buffer_load_dwordx4 v[12:15], v124, s[8:11], s52 offen offset:2048 sc1
  buffer_load_dwordx3 v[16:18], v124, s[8:11], s52 offen offset:3072 sc1
  buffer_load_dwordx4 v[20:23], v124, s[8:11], s53 offen offset:0 sc1
  buffer_load_dwordx4 v[24:27], v124, s[8:11], s53 offen offset:1024 sc1
  buffer_load_dwordx4 v[28:31], v124, s[8:11], s53 offen offset:2048 sc1
  s_mov_b32 s41, 0
  s_waitcnt vmcnt(3)
gs_79_in:
  v_pk_add_f32 v[152:153], v[4:5], v[8:9]
  v_pk_add_f32 v[154:155], v[6:7], v[10:11]
  v_add_f32 v156, v16, v17
  v_pk_add_f32 v[152:153], v[152:153], v[12:13]
  v_pk_add_f32 v[154:155], v[154:155], v[14:15]
  v_add_f32 v156, v156, v18
  v_cmp_u_f32 s[76:77], v152, v153
  v_cmp_u_f32 s[72:73], v154, v155
  v_cmp_u_f32 s[74:75], v156, v156
  v_max3_f32 v140, v152, v153, v154
  s_or_b64 s[72:73], s[76:77], s[72:73]
  v_max3_f32 v140, v140, v155, v156
  s_or_b64 s[72:73], s[72:73], s[74:75]
  s_waitcnt vmcnt(0)
  v_max3_u32 v142, v20, v21, v22
  v_max3_u32 v143, v23, v24, v25
  v_max3_u32 v142, v142, v26, v27
  v_max3_u32 v143, v143, v28, v29
  v_max3_u32 v142, v142, v30, v31
  v_max_u32 v142, v142, v143
  v_cmp_eq_u32 vcc, -1, v142
  s_nop 0
  s_or_b64 vcc, vcc, s[72:73]
  s_cbranch_vccnz gs_79
  v_smfmac_f32_16x16x64_bf16 v[92:95], v[20:23], v[176:183], v136
  v_max_f32_dpp v140, v140, v140 row_ror:8 row_mask:0xf bank_mask:0xf
  v_mov_b32 v141, v140
  v_smfmac_f32_16x16x64_bf16 v[96:99], v[20:23], v[200:207], v136
  v_mul_f32 v152, 0x3dd53b95, v152
  v_mul_f32 v153, 0x3dd53b95, v153
  v_smfmac_f32_16x16x64_bf16 v[100:103], v[20:23], v[224:231], v136
  v_permlane16_swap_b32 v140, v141
  v_max_f32 v140, v140, v141
  v_smfmac_f32_16x16x64_bf16 v[104:107], v[20:23], v[248:255], v136
  v_mov_b32 v141, v140
  v_mul_f32 v154, 0x3dd53b95, v154
  v_smfmac_f32_16x16x64_bf16 v[92:95], v[24:27], v[184:191], v136
  v_mul_f32 v155, 0x3dd53b95, v155
  v_permlane32_swap_b32 v140, v141
  v_smfmac_f32_16x16x64_bf16 v[96:99], v[24:27], v[208:215], v136
  v_max_f32 v140, v140, v141
  v_mul_f32 v156, 0x3dd53b95, v156
  v_smfmac_f32_16x16x64_bf16 v[100:103], v[24:27], v[232:239], v136
  v_mul_f32 v140, 0x3dd53b95, v140
  v_sub_f32 v156, v156, v140
  v_smfmac_f32_16x16x64_bf16 v[104:107], v[24:27], a[240:247], v136
  v_sub_f32 v152, v152, v140
  v_sub_f32 v153, v153, v140
  v_smfmac_f32_16x16x64_bf16 v[92:95], v[28:31], v[192:199], v136
  v_sub_f32 v154, v154, v140
  v_sub_f32 v155, v155, v140
  v_smfmac_f32_16x16x64_bf16 v[96:99], v[28:31], v[216:223], v136
  v_exp_f32 v156, v156
  v_exp_f32 v152, v152
  v_smfmac_f32_16x16x64_bf16 v[100:103], v[28:31], v[240:247], v136
  v_exp_f32 v153, v153
  v_exp_f32 v154, v154
  v_smfmac_f32_16x16x64_bf16 v[104:107], v[28:31], a[248:255], v136
  v_exp_f32 v155, v155
  v_mov_b32_dpp v157, v156 row_ror:8 row_mask:0xf bank_mask:0xf
  v_cvt_pk_bf16_f32 v116, v152, v153
  v_cvt_pk_bf16_f32 v117, v154, v155
  v_cvt_pk_bf16_f32 v120, v156, v157
  v_mov_b32_dpp v118, v116 row_ror:8 row_mask:0xf bank_mask:0xf
  v_mov_b32_dpp v119, v117 row_ror:8 row_mask:0xf bank_mask:0xf
  v_mov_b32 v121, v120
  s_nop 0
  v_mfma_f32_16x16x32_bf16 v[80:83], v[88:91], v[116:119], 0
  v_cvt_pk_bf16_f32 v108, v92, v93
  v_cvt_pk_bf16_f32 v109, v94, v95
  v_mfma_f32_16x16x32_bf16 v[152:155], v[44:47], v[116:119], 0
  v_cvt_pk_bf16_f32 v110, v96, v97
  v_cvt_pk_bf16_f32 v111, v98, v99
  v_mfma_f32_16x16x32_bf16 v[156:159], v[48:51], v[116:119], 0
  v_mfma_f32_16x16x16_bf16 v[80:83], v[168:169], v[120:121], v[80:83]
  v_cvt_pk_bf16_f32 v112, v100, v101
  v_cvt_pk_bf16_f32 v113, v102, v103
  v_mfma_f32_16x16x32_bf16 v[160:163], v[52:55], v[116:119], 0
  v_cvt_pk_bf16_f32 v114, v104, v105
  v_cvt_pk_bf16_f32 v115, v106, v107
  v_mfma_f32_16x16x32_bf16 v[164:167], v[56:59], v[116:119], 0
  s_add_u32 s40, s40, 1
  v_mfma_f32_16x16x16_bf16 v[152:155], v[108:109], v[120:121], v[152:155]
  v_mfma_f32_16x16x16_bf16 v[156:159], v[110:111], v[120:121], v[156:159]
  v_rcp_f32 v122, v80
  v_mfma_f32_16x16x16_bf16 v[160:163], v[112:113], v[120:121], v[160:163]
  s_nop 0
  v_mfma_f32_16x16x16_bf16 v[164:167], v[114:115], v[120:121], v[164:167]
  v_mov_b32 v123, v122
  s_cmp_eq_u32 s40, 64
  s_cbranch_scc1 chain_last_c2w
  s_mov_b64 exec, s[66:67]
  v_pk_mul_f32 v[152:153], v[122:123], v[152:153]
  v_pk_mul_f32 v[154:155], v[122:123], v[154:155]
  ds_write_b128 v131, v[152:155] offset:0
  v_pk_mul_f32 v[156:157], v[122:123], v[156:157]
  v_pk_mul_f32 v[158:159], v[122:123], v[158:159]
  ds_write_b128 v131, v[156:159] offset:512
  v_pk_mul_f32 v[160:161], v[122:123], v[160:161]
  v_pk_mul_f32 v[162:163], v[122:123], v[162:163]
  ds_write_b128 v131, v[160:163] offset:1024
  v_pk_mul_f32 v[164:165], v[122:123], v[164:165]
  v_pk_mul_f32 v[166:167], v[122:123], v[166:167]
  ds_write_b128 v131, v[164:167] offset:1536
  s_mov_b64 exec, -1
  s_waitcnt lgkmcnt(0)
  s_barrier
  ds_read_b64 v[144:145], v132 offset:0
  ds_read_b64 v[146:147], v132 offset:2048
  ds_read_b64 v[148:149], v132 offset:4096
  ds_read_b64 v[150:151], v132 offset:6144
  s_mov_b32 s45, s62
  s_waitcnt lgkmcnt(2)
  v_pk_add_f32 v[144:145], v[144:145], v[146:147]
  s_waitcnt lgkmcnt(0)
  v_pk_add_f32 v[148:149], v[148:149], v[150:151]
  v_pk_add_f32 v[122:123], v[144:145], v[148:149]
  v_cvt_pk_bf16_f32 v122, v122, v123
  buffer_store_dword v122, v170, s[8:11], s63 offen sc1
  buffer_store_dword v122, v170, s[8:11], s61 offen sc1
  s_add_u32 s78, s40, 1
  s_sub_u32 s42, s40, 1
  v_mov_b32 v143, s42
  buffer_store_dword v84, v133, s[8:11], s46 offen
  buffer_store_dword v143, v135, s[8:11], 0 offen
  s_mov_b32 s41, 0
cpw_81:
  v_cmp_gt_u32 vcc, s78, v139
  s_nop 0
  s_and_b32 vcc_lo, vcc_lo, 0xfff000
  s_and_b32 vcc_hi, vcc_hi, 0xfffff0
  s_cmp_eq_u64 vcc, 0
  s_cbranch_scc1 cpo_82
  s_sleep 1
  buffer_load_dword v139, v134, s[8:11], 0 offen sc1
  s_add_u32 s41, s41, 1
  s_cmp_gt_u32 s41, 65536
  s_cbranch_scc1 chain_abort
  s_waitcnt vmcnt(0)
  s_branch cpw_81
cpo_82:
  v_add_f32 v92, v92, v94
  v_add_f32 v93, v93, v95
  v_cvt_pk_bf16_f32 v80, v92, v93
  v_add_f32 v96, v96, v98
  v_add_f32 v97, v97, v99
  v_cvt_pk_bf16_f32 v81, v96, v97
  v_add_f32 v100, v100, v102
  v_add_f32 v101, v101, v103
  v_cvt_pk_bf16_f32 v82, v100, v101
  v_add_f32 v104, v104, v106
  v_add_f32 v105, v105, v107
  v_cvt_pk_bf16_f32 v83, v104, v105
  s_mov_b32 s42, s46
  s_mov_b32 s46, s47
  s_mov_b32 s47, s42
  s_sub_u32 s43, s40, 1
  s_and_b32 s43, s43, 3
  s_mul_i32 s43, s43, 227328
  s_add_u32 s57, s24, s43
  s_add_u32 s58, s25, s43
  s_add_u32 s54, s55, s79
  s_and_b32 s42, s40, 3
  s_lshl_b32 s43, s42, 15
  s_add_u32 s52, s49, s43
  s_add_u32 s53, s52, 4096
  s_add_u32 s55, s48, s43
  s_add_u32 s50, s55, s56
  s_lshl_b32 s44, s38, 10
  s_add_u32 s51, s55, s44
  s_add_u32 s51, s51, 4096
  s_mul_i32 s60, s42, 227328
  s_add_u32 s60, s60, s26
  s_mul_i32 s62, s42, 163840
  s_add_u32 s62, s62, s64
  s_lshl_b32 s43, s16, 8
  s_add_u32 s61, s62, s43
  s_xor_b32 s63, s61, 8192
  v_mov_b32 v92, 0
  v_mov_b32 v93, 0
  v_mov_b32 v94, 0
  v_mov_b32 v95, 0
  v_mov_b32 v96, 0
  v_mov_b32 v97, 0
  v_mov_b32 v98, 0
  v_mov_b32 v99, 0
  v_mov_b32 v100, 0
  v_mov_b32 v101, 0
  v_mov_b32 v102, 0
  v_mov_b32 v103, 0
  v_mov_b32 v104, 0
  v_mov_b32 v105, 0
  v_mov_b32 v106, 0
  v_mov_b32 v107, 0
  v_mov_b32 v68, 0
  v_mov_b32 v69, 0
  v_mov_b32 v70, 0
  v_mov_b32 v71, 0
  v_mov_b32 v72, 0
  v_mov_b32 v73, 0
  v_mov_b32 v74, 0
  v_mov_b32 v75, 0
  v_mov_b32 v76, 0
  v_mov_b32 v77, 0
  v_mov_b32 v78, 0
  v_mov_b32 v79, 0
  s_sleep 2
  buffer_load_dwordx4 v[4:7], v124, s[8:11], s45 offen offset:0 sc1
  buffer_load_dwordx4 v[8:11], v124, s[8:11], s45 offen offset:1024 sc1
  s_mov_b32 s41, 0
xp_83:
  s_waitcnt vmcnt(0)
  v_mfma_f32_16x16x32_bf16 v[36:39], v[172:175], v[4:7], 0
  v_mfma_f32_16x16x32_bf16 v[36:39], v[172:175], v[8:11], v[36:39]
  s_nop 7
  v_cmp_u_f32 vcc, v36, v37
  v_cvt_pk_bf16_f32 v141, v36, v37
  s_cbranch_vccnz xp_83_r
  buffer_store_dword v141, v133, s[8:11], s46 offen
  s_branch chain_loop_c2w
gs_79:
  v_max3_u32 v142, v4, v5, v6
  v_max_u32 v142, v142, v7
  v_cmp_eq_u32 vcc, -1, v142
  s_cbranch_vccz gs_79_s0
  s_mov_b64 exec, vcc
  buffer_load_dwordx4 v[4:7], v124, s[8:11], s52 offen offset:0 sc1
  s_mov_b64 exec, -1
gs_79_s0:
  v_max3_u32 v142, v8, v9, v10
  v_max_u32 v142, v142, v11
  v_cmp_eq_u32 vcc, -1, v142
  s_cbranch_vccz gs_79_s1
  s_mov_b64 exec, vcc
  buffer_load_dwordx4 v[8:11], v124, s[8:11], s52 offen offset:1024 sc1
  s_mov_b64 exec, -1
gs_79_s1:
  v_max3_u32 v142, v12, v13, v14
  v_max_u32 v142, v142, v15
  v_cmp_eq_u32 vcc, -1, v142
  s_cbranch_vccz gs_79_s2
  s_mov_b64 exec, vcc
  buffer_load_dwordx4 v[12:15], v124, s[8:11], s52 offen offset:2048 sc1
  s_mov_b64 exec, -1
gs_79_s2:
  v_max3_u32 v142, v16, v17, v18
  v_cmp_eq_u32 vcc, -1, v142
  s_cbranch_vccz gs_79_s3
  s_mov_b64 exec, vcc
  buffer_load_dwordx3 v[16:18], v124, s[8:11], s52 offen offset:3072 sc1
  s_mov_b64 exec, -1
gs_79_s3:
  v_max3_u32 v142, v20, v21, v22
  v_max_u32 v142, v142, v23
  v_cmp_eq_u32 vcc, -1, v142
  s_cbranch_vccz gs_79_s4
  s_mov_b64 exec, vcc
  buffer_load_dwordx4 v[20:23], v124, s[8:11], s53 offen offset:0 sc1
  s_mov_b64 exec, -1
gs_79_s4:
  v_max3_u32 v142, v24, v25, v26
  v_max_u32 v142, v142, v27
  v_cmp_eq_u32 vcc, -1, v142
  s_cbranch_vccz gs_79_s5
  s_mov_b64 exec, vcc
  buffer_load_dwordx4 v[24:27], v124, s[8:11], s53 offen offset:1024 sc1
  s_mov_b64 exec, -1
gs_79_s5:
  v_max3_u32 v142, v28, v29, v30
  v_max_u32 v142, v142, v31
  v_cmp_eq_u32 vcc, -1, v142
  s_cbranch_vccz gs_79_s6
  s_mov_b64 exec, vcc
  buffer_load_dwordx4 v[28:31], v124, s[8:11], s53 offen offset:2048 sc1
  s_mov_b64 exec, -1
gs_79_s6:
  s_add_u32 s41, s41, 1
  s_cmp_gt_u32 s41, 65536
  s_cbranch_scc1 chain_abort
  s_waitcnt vmcnt(0)
  s_branch gs_79_in
xp_83_r:
  v_max3_u32 v140, v4, v5, v6
  v_max_u32 v140, v140, v7
  v_cmp_eq_u32 vcc, -1, v140
  s_cbranch_vccz xp_83_s0
  s_mov_b64 exec, vcc
  buffer_load_dwordx4 v[4:7], v124, s[8:11], s45 offen offset:0 sc1
  s_mov_b64 exec, -1
xp_83_s0:
  v_max3_u32 v140, v8, v9, v10
  v_max_u32 v140, v140, v11
  v_cmp_eq_u32 vcc, -1, v140
  s_cbranch_vccz xp_83_s1
  s_mov_b64 exec, vcc
  buffer_load_dwordx4 v[8:11], v124, s[8:11], s45 offen offset:1024 sc1
  s_mov_b64 exec, -1
xp_83_s1:
  s_add_u32 s41, s41, 1
  s_cmp_gt_u32 s41, 65536
  s_cbranch_scc1 chain_abort
  s_branch xp_83
chain_last_c2w:
  s_sub_u32 s43, s40, 1
  s_and_b32 s43, s43, 3
  s_mul_i32 s43, s43, 227328
  s_add_u32 s57, s24, s43
  s_add_u32 s58, s25, s43
  v_add_f32 v92, v92, v94
  v_add_f32 v93, v93, v95
  v_cvt_pk_bf16_f32 v80, v92, v93
  v_add_f32 v96, v96, v98
  v_add_f32 v97, v97, v99
  v_cvt_pk_bf16_f32 v81, v96, v97
  v_add_f32 v100, v100, v102
  v_add_f32 v101, v101, v103
  v_cvt_pk_bf16_f32 v82, v100, v101
  v_add_f32 v104, v104, v106
  v_add_f32 v105, v105, v107
  v_cvt_pk_bf16_f32 v83, v104, v105
  buffer_store_dwordx4 v[60:63], v138, s[8:11], s57 offen
  buffer_store_dwordx4 v[64:67], v138, s[8:11], s57 offen offset:512
  buffer_store_dwordx4 v[80:83], v124, s[8:11], s58 offen
  v_mov_b32 v143, s40
  s_branch chain_fin
chain_pro_c0n:
  s_sub_u32 s42, s36, 10
  s_lshl_b32 s42, s42, 2
  s_add_u32 s42, s42, s17
  s_cmp_lt_u32 s42, 4
  s_cselect_b32 s63, 16, 8
  s_lshl_b32 s63, s63, 13
  s_lshl_b32 s64, s42, 13
  s_lshl_b32 s42, s16, 8
  s_add_u32 s64, s64, s42
  s_add_u32 s64, s64, 1441792
  v_lshrrev_b32 v140, 4, v1
  v_lshlrev_b32 v140, 11, v140
  v_and_b32 v141, 15, v1
  v_lshl_add_u32 v131, v141, 4, v140
  s_mov_b32 s78, 1
  v_mov_b32 v143, 0
  s_mov_b32 s41, 0
cpw_84:
  v_cmp_gt_u32 vcc, s78, v139
  s_nop 0
  s_and_b32 vcc_lo, vcc_lo, 0xfff000
  s_and_b32 vcc_hi, vcc_hi, 0x10fffff0
  s_cmp_eq_u64 vcc, 0
  s_cbranch_scc1 cpo_85
  s_sleep 1
  buffer_load_dword v139, v134, s[8:11], 0 offen sc1
  s_add_u32 s41, s41, 1
  s_cmp_gt_u32 s41, 65536
  s_cbranch_scc1 chain_abort
  s_waitcnt vmcnt(0)
  s_branch cpw_84
cpo_85:
  s_sub_u32 s42, s78, 1
  s_and_b32 s42, s42, 7
  s_mul_i32 s42, s42, 147456
  s_add_u32 s42, s42, s59
  buffer_load_dwordx4 v[60:63], v124, s[8:11], s42 offen offset:0 sc1
  buffer_load_dwordx4 v[64:67], v124, s[8:11], s42 offen offset:1024 sc1
  s_add_u32 s55, s48, 98304
  s_sub_u32 s43, s40, 1
  s_and_b32 s43, s43, 3
  s_mul_i32 s43, s43, 227328
  s_add_u32 s57, s24, s43
  s_add_u32 s54, s55, s79
  s_and_b32 s42, s40, 3
  s_lshl_b32 s43, s42, 15
  s_add_u32 s52, s49, s43
  s_add_u32 s53, s52, 4096
  s_add_u32 s55, s48, s43
  s_add_u32 s50, s55, s56
  s_lshl_b32 s44, s38, 10
  s_add_u32 s51, s55, s44
  s_add_u32 s51, s51, 4096
  v_mov_b32 v68, 0
  v_mov_b32 v69, 0
  v_mov_b32 v70, 0
  v_mov_b32 v71, 0
  v_mov_b32 v72, 0
  v_mov_b32 v73, 0
  v_mov_b32 v74, 0
  v_mov_b32 v75, 0
  v_mov_b32 v76, 0
  v_mov_b32 v77, 0
  v_mov_b32 v78, 0
  v_mov_b32 v79, 0
chain_loop_c0n:
  s_mov_b32 s41, 0
  buffer_load_dwordx4 v[152:155], v126, s[8:11], s46 offen sc1
  buffer_load_dwordx4 v[156:159], v126, s[8:11], s46 offen offset:1024 sc1
  buffer_load_dwordx2 v[160:161], v127, s[8:11], s46 offen sc1
  s_sleep 2
mq_86:
  buffer_load_dwordx4 v[162:165], v126, s[8:11], s46 offen sc1
  buffer_load_dwordx4 v[108:111], v126, s[8:11], s46 offen offset:1024 sc1
  buffer_load_dwordx2 v[112:113], v127, s[8:11], s46 offen sc1
  s_waitcnt vmcnt(3)
  v_max3_u32 v140, v152, v153, v154
  v_max3_u32 v141, v155, v156, v157
  v_max3_u32 v140, v140, v158, v159
  v_max3_u32 v141, v141, v160, v161
  v_max_u32 v140, v140, v141
  v_cmp_eq_u32 vcc, -1, v140
  s_cbranch_vccz mq_86_a
  buffer_load_dwordx4 v[152:155], v126, s[8:11], s46 offen sc1
  buffer_load_dwordx4 v[156:159], v126, s[8:11], s46 offen offset:1024 sc1
  buffer_load_dwordx2 v[160:161], v127, s[8:11], s46 offen sc1
  s_add_u32 s41, s41, 1
  s_cmp_gt_u32 s41, 65536
  s_cbranch_scc1 chain_abort
  s_waitcnt vmcnt(3)
  v_max3_u32 v140, v162, v163, v164
  v_max3_u32 v141, v165, v108, v109
  v_max3_u32 v140, v140, v110, v111
  v_max3_u32 v141, v141, v112, v113
  v_max_u32 v140, v140, v141
  v_cmp_eq_u32 vcc, -1, v140
  s_cbranch_vccnz mq_86
  ds_write_b128 v126, v[162:165]
  ds_write_b128 v126, v[108:111] offset:1024
  ds_write_b64 v127, v[112:113]
  s_branch mq_86_ok
mq_86_a:
  ds_write_b128 v126, v[152:155]
  ds_write_b128 v126, v[156:159] offset:1024
  ds_write_b64 v127, v[160:161]
mq_86_ok:
  s_waitcnt lgkmcnt(0)
  s_barrier
  ds_read_b128 v[4:7], v124 offset:0
  ds_read_b128 v[8:11], v124 offset:1024
  ds_read_b128 v[12:15], v124 offset:2048
  ds_read_b128 v[16:19], v124 offset:3072
  ds_read_b128 v[20:23], v124 offset:4096
  ds_read_b128 v[24:27], v124 offset:5120
  ds_read_b128 v[28:31], v124 offset:6144
  ds_read_b128 v[32:35], v124 offset:7168
  ds_read_b128 v[36:39], v124 offset:8192
  ds_read_b128 v[40:43], v124 offset:9216
  s_waitcnt lgkmcnt(9)
  v_smfmac_f32_16x16x64_bf16 v[68:71], v[4:7], a[0:7], v136
  v_smfmac_f32_16x16x64_bf16 v[72:75], v[4:7], a[80:87], v136
  buffer_store_dwordx4 v[84:87], v124, s[8:11], s54 offen
  s_waitcnt lgkmcnt(8)
  v_smfmac_f32_16x16x64_bf16 v[68:71], v[8:11], a[8:15], v136
  v_smfmac_f32_16x16x64_bf16 v[72:75], v[8:11], a[88:95], v136
  buffer_load_dword v139, v134, s[8:11], 0 offen sc1
  s_waitcnt lgkmcnt(7)
  v_smfmac_f32_16x16x64_bf16 v[68:71], v[12:15], a[16:23], v136
  v_smfmac_f32_16x16x64_bf16 v[72:75], v[12:15], a[96:103], v136
  s_waitcnt lgkmcnt(6)
  v_smfmac_f32_16x16x64_bf16 v[68:71], v[16:19], a[24:31], v136
  v_smfmac_f32_16x16x64_bf16 v[72:75], v[16:19], a[104:111], v136
  s_waitcnt lgkmcnt(5)
  v_smfmac_f32_16x16x64_bf16 v[68:71], v[20:23], a[32:39], v136
  v_smfmac_f32_16x16x64_bf16 v[72:75], v[20:23], a[112:119], v136
  s_waitcnt lgkmcnt(4)
  v_smfmac_f32_16x16x64_bf16 v[68:71], v[24:27], a[40:47], v136
  v_smfmac_f32_16x16x64_bf16 v[72:75], v[24:27], a[120:127], v136
  s_waitcnt lgkmcnt(3)
  v_smfmac_f32_16x16x64_bf16 v[68:71], v[28:31], a[48:55], v136
  v_smfmac_f32_16x16x64_bf16 v[72:75], v[28:31], a[128:135], v136
  s_waitcnt lgkmcnt(2)
  v_smfmac_f32_16x16x64_bf16 v[68:71], v[32:35], a[56:63], v136
  v_smfmac_f32_16x16x64_bf16 v[72:75], v[32:35], a[136:143], v136
  s_waitcnt lgkmcnt(1)
  v_smfmac_f32_16x16x64_bf16 v[68:71], v[36:39], a[64:71], v136
  v_smfmac_f32_16x16x64_bf16 v[72:75], v[36:39], a[144:151], v136
  s_waitcnt lgkmcnt(0)
  v_smfmac_f32_16x16x64_bf16 v[68:71], v[40:43], a[72:79], v136
  v_smfmac_f32_16x16x64_bf16 v[72:75], v[40:43], a[152:159], v136
  v_smfmac_f32_16x16x64_bf16 v[76:79], v[4:7], a[160:167], v136
  v_smfmac_f32_16x16x64_bf16 v[76:79], v[8:11], a[168:175], v136
  s_nop 4
  v_add_f32 v68, v68, v70
  v_add_f32 v69, v69, v71
  v_add_f32 v72, v72, v74
  v_add_f32 v73, v73, v75
  v_smfmac_f32_16x16x64_bf16 v[76:79], v[12:15], a[176:183], v136
  v_cvt_pk_bf16_f32 v122, v68, v69
  v_cvt_pk_bf16_f32 v123, v72, v73
  ds_write2_b32 v128, v122, v122 offset0:0 offset1:4
  ds_write2_b32 v129, v123, v123 offset0:0 offset1:1
  v_smfmac_f32_16x16x64_bf16 v[76:79], v[16:19], a[184:191], v136
  v_smfmac_f32_16x16x64_bf16 v[76:79], v[20:23], a[192:199], v136
  s_waitcnt lgkmcnt(0)
  s_barrier
  ds_read_b64_tr_b16 v[144:145], v125 offset:10240
  ds_read_b64_tr_b16 v[146:147], v125 offset:10752
  ds_read_b64_tr_b16 v[148:149], v125 offset:11264
  ds_read_b64_tr_b16 v[150:151], v125 offset:11776
  v_smfmac_f32_16x16x64_bf16 v[76:79], v[24:27], a[200:207], v136
  v_smfmac_f32_16x16x64_bf16 v[76:79], v[28:31], a[208:215], v136
  v_smfmac_f32_16x16x64_bf16 v[76:79], v[32:35], a[216:223], v136
  s_waitcnt lgkmcnt(2)
  v_mfma_f32_16x16x32_bf16 v[80:83], v[60:63], v[144:147], 0
  s_waitcnt lgkmcnt(0)
  v_mfma_f32_16x16x32_bf16 v[80:83], v[64:67], v[148:151], v[80:83]
  v_smfmac_f32_16x16x64_bf16 v[76:79], v[36:39], a[224:231], v136
  v_smfmac_f32_16x16x64_bf16 v[76:79], v[40:43], a[232:239], v136
  s_mov_b64 exec, s[70:71]
  s_nop 4
  buffer_store_dwordx4 v[80:83], v124, s[8:11], s50 offen
  s_mov_b64 exec, -1
  v_add_f32 v76, v76, v78
  v_add_f32 v77, v77, v79
  v_cvt_pk_bf16_f32 v140, v76, v77
  s_nop 1
  v_mov_b32_dpp v141, v140 row_ror:4 row_mask:0xf bank_mask:0xa
  s_nop 1
  v_mov_b32_dpp v141, v140 row_ror:12 row_mask:0xf bank_mask:0x5
  v_perm_b32 v140, v141, v140, v137
  buffer_store_dword v140, v130, s[8:11], s51 offen
  s_and_b32 s42, s40, 3
  s_xor_b32 s42, s42, 2
  s_mul_i32 s42, s42, 163840
  s_add_u32 s42, s42, s64
  s_add_u32 s43, s42, 65536
  s_add_u32 s44, s42, s63
  s_waitcnt vmcnt(0)
  s_barrier
  buffer_store_dwordx4 v[84:87], v131, s[8:11], s42 offen sc1
  buffer_store_dwordx4 v[84:87], v131, s[8:11], s43 offen sc1
  buffer_store_dwordx4 v[84:87], v131, s[8:11], s44 offen sc1
  v_mov_b32 v143, s40
  s_add_u32 s40, s40, 1
  s_cmp_eq_u32 s40, 64
  s_cbranch_scc1 chain_last_c0n
  s_add_u32 s78, s40, 1
  s_waitcnt vmcnt(0)
  buffer_store_dword v143, v135, s[8:11], 0 offen
  s_mov_b32 s41, 0
cpw_87:
  v_cmp_gt_u32 vcc, s78, v139
  s_nop 0
  s_and_b32 vcc_lo, vcc_lo, 0xfff000
  s_and_b32 vcc_hi, vcc_hi, 0xfffff0
  s_cmp_eq_u64 vcc, 0
  s_cbranch_scc1 cpo_88
  s_sleep 1
  buffer_load_dword v139, v134, s[8:11], 0 offen sc1
  s_add_u32 s41, s41, 1
  s_cmp_gt_u32 s41, 65536
  s_cbranch_scc1 chain_abort
  s_waitcnt vmcnt(0)
  s_branch cpw_87
cpo_88:
  s_sub_u32 s42, s78, 1
  s_and_b32 s42, s42, 7
  s_mul_i32 s42, s42, 147456
  s_add_u32 s42, s42, s59
  buffer_load_dwordx4 v[60:63], v124, s[8:11], s42 offen offset:0 sc1
  buffer_load_dwordx4 v[64:67], v124, s[8:11], s42 offen offset:1024 sc1
  s_mov_b32 s42, s46
  s_mov_b32 s46, s47
  s_mov_b32 s47, s42
  s_sub_u32 s43, s40, 1
  s_and_b32 s43, s43, 3
  s_mul_i32 s43, s43, 227328
  s_add_u32 s57, s24, s43
  s_add_u32 s54, s55, s79
  s_and_b32 s42, s40, 3
  s_lshl_b32 s43, s42, 15
  s_add_u32 s52, s49, s43
  s_add_u32 s53, s52, 4096
  s_add_u32 s55, s48, s43
  s_add_u32 s50, s55, s56
  s_lshl_b32 s44, s38, 10
  s_add_u32 s51, s55, s44
  s_add_u32 s51, s51, 4096
  v_mov_b32 v68, 0
  v_mov_b32 v69, 0
  v_mov_b32 v70, 0
  v_mov_b32 v71, 0
  v_mov_b32 v72, 0
  v_mov_b32 v73, 0
  v_mov_b32 v74, 0
  v_mov_b32 v75, 0
  v_mov_b32 v76, 0
  v_mov_b32 v77, 0
  v_mov_b32 v78, 0
  v_mov_b32 v79, 0
  s_sleep 16
  s_branch chain_loop_c0n
chain_last_c0n:
  s_sub_u32 s43, s40, 1
  s_and_b32 s43, s43, 3
  s_mul_i32 s43, s43, 227328
  s_add_u32 s57, s24, s43
  s_waitcnt lgkmcnt(0)
  v_mov_b32 v143, s40
  s_branch chain_fin
chain_pro_c1n:
  s_sub_u32 s42, s36, 10
  s_lshl_b32 s42, s42, 2
  s_add_u32 s42, s42, s17
  s_cmp_lt_u32 s42, 4
  s_cselect_b32 s63, 16, 8
  s_lshl_b32 s63, s63, 13
  s_lshl_b32 s64, s42, 13
  s_lshl_b32 s42, s16, 8
  s_add_u32 s64, s64, s42
  s_add_u32 s64, s64, 1441792
  v_lshrrev_b32 v140, 4, v1
  v_lshlrev_b32 v140, 11, v140
  v_and_b32 v141, 15, v1
  v_lshl_add_u32 v131, v141, 4, v140
  s_mov_b32 s78, 1
  v_mov_b32 v143, 0
  s_mov_b32 s41, 0
cpw_89:
  v_cmp_gt_u32 vcc, s78, v139
  s_nop 0
  s_and_b32 vcc_lo, vcc_lo, 0xfff000
  s_and_b32 vcc_hi, vcc_hi, 0x10fffff0
  s_cmp_eq_u64 vcc, 0
  s_cbranch_scc1 cpo_90
  s_sleep 1
  buffer_load_dword v139, v134, s[8:11], 0 offen sc1
  s_add_u32 s41, s41, 1
  s_cmp_gt_u32 s41, 65536
  s_cbranch_scc1 chain_abort
  s_waitcnt vmcnt(0)
  s_branch cpw_89
cpo_90:
  s_add_u32 s55, s48, 98304
  s_sub_u32 s43, s40, 1
  s_and_b32 s43, s43, 3
  s_mul_i32 s43, s43, 227328
  s_add_u32 s57, s24, s43
  s_add_u32 s54, s55, s79
  s_and_b32 s42, s40, 3
  s_lshl_b32 s43, s42, 15
  s_add_u32 s52, s49, s43
  s_add_u32 s53, s52, 4096
  s_add_u32 s55, s48, s43
  s_add_u32 s50, s55, s56
  s_lshl_b32 s44, s38, 10
  s_add_u32 s51, s55, s44
  s_add_u32 s51, s51, 4096
  v_mov_b32 v68, 0
  v_mov_b32 v69, 0
  v_mov_b32 v70, 0
  v_mov_b32 v71, 0
  v_mov_b32 v72, 0
  v_mov_b32 v73, 0
  v_mov_b32 v74, 0
  v_mov_b32 v75, 0
  v_mov_b32 v76, 0
  v_mov_b32 v77, 0
  v_mov_b32 v78, 0
  v_mov_b32 v79, 0
chain_loop_c1n:
  s_mov_b32 s41, 0
  buffer_load_dwordx4 v[152:155], v126, s[8:11], s46 offen sc1
  buffer_load_dwordx4 v[156:159], v126, s[8:11], s46 offen offset:1024 sc1
  buffer_load_dwordx2 v[160:161], v127, s[8:11], s46 offen sc1
  s_sleep 2
mq_91:
  buffer_load_dwordx4 v[162:165], v126, s[8:11], s46 offen sc1
  buffer_load_dwordx4 v[108:111], v126, s[8:11], s46 offen offset:1024 sc1
  buffer_load_dwordx2 v[112:113], v127, s[8:11], s46 offen sc1
  s_waitcnt vmcnt(3)
  v_max3_u32 v140, v152, v153, v154
  v_max3_u32 v141, v155, v156, v157
  v_max3_u32 v140, v140, v158, v159
  v_max3_u32 v141, v141, v160, v161
  v_max_u32 v140, v140, v141
  v_cmp_eq_u32 vcc, -1, v140
  s_cbranch_vccz mq_91_a
  buffer_load_dwordx4 v[152:155], v126, s[8:11], s46 offen sc1
  buffer_load_dwordx4 v[156:159], v126, s[8:11], s46 offen offset:1024 sc1
  buffer_load_dwordx2 v[160:161], v127, s[8:11], s46 offen sc1
  s_add_u32 s41, s41, 1
  s_cmp_gt_u32 s41, 65536
  s_cbranch_scc1 chain_abort
  s_waitcnt vmcnt(3)
  v_max3_u32 v140, v162, v163, v164
  v_max3_u32 v141, v165, v108, v109
  v_max3_u32 v140, v140, v110, v111
  v_max3_u32 v141, v141, v112, v113
  v_max_u32 v140, v140, v141
  v_cmp_eq_u32 vcc, -1, v140
  s_cbranch_vccnz mq_91
  ds_write_b128 v126, v[162:165]
  ds_write_b128 v126, v[108:111] offset:1024
  ds_write_b64 v127, v[112:113]
  s_branch mq_91_ok
mq_91_a:
  ds_write_b128 v126, v[152:155]
  ds_write_b128 v126, v[156:159] offset:1024
  ds_write_b64 v127, v[160:161]
mq_91_ok:
  s_waitcnt lgkmcnt(0)
  s_barrier
  ds_read_b128 v[4:7], v124 offset:0
  ds_read_b128 v[8:11], v124 offset:1024
  ds_read_b128 v[12:15], v124 offset:2048
  ds_read_b128 v[16:19], v124 offset:3072
  ds_read_b128 v[20:23], v124 offset:4096
  ds_read_b128 v[24:27], v124 offset:5120
  ds_read_b128 v[28:31], v124 offset:6144
  ds_read_b128 v[32:35], v124 offset:7168
  ds_read_b128 v[36:39], v124 offset:8192
  ds_read_b128 v[40:43], v124 offset:9216
  s_waitcnt lgkmcnt(9)
  v_smfmac_f32_16x16x64_bf16 v[68:71], v[4:7], a[0:7], v136
  v_smfmac_f32_16x16x64_bf16 v[72:75], v[4:7], a[80:87], v136
  buffer_store_dwordx4 v[84:87], v124, s[8:11], s54 offen
  s_waitcnt lgkmcnt(8)
  v_smfmac_f32_16x16x64_bf16 v[68:71], v[8:11], a[8:15], v136
  v_smfmac_f32_16x16x64_bf16 v[72:75], v[8:11], a[88:95], v136
  buffer_load_dword v139, v134, s[8:11], 0 offen sc1
  s_waitcnt lgkmcnt(7)
  v_smfmac_f32_16x16x64_bf16 v[68:71], v[12:15], a[16:23], v136
  v_smfmac_f32_16x16x64_bf16 v[72:75], v[12:15], a[96:103], v136
  s_waitcnt lgkmcnt(6)
  v_smfmac_f32_16x16x64_bf16 v[68:71], v[16:19], a[24:31], v136
  v_smfmac_f32_16x16x64_bf16 v[72:75], v[16:19], a[104:111], v136
  s_waitcnt lgkmcnt(5)
  v_smfmac_f32_16x16x64_bf16 v[68:71], v[20:23], a[32:39], v136
  v_smfmac_f32_16x16x64_bf16 v[72:75], v[20:23], a[112:119], v136
  s_waitcnt lgkmcnt(4)
  v_smfmac_f32_16x16x64_bf16 v[68:71], v[24:27], a[40:47], v136
  v_smfmac_f32_16x16x64_bf16 v[72:75], v[24:27], a[120:127], v136
  s_waitcnt lgkmcnt(3)
  v_smfmac_f32_16x16x64_bf16 v[68:71], v[28:31], a[48:55], v136
  v_smfmac_f32_16x16x64_bf16 v[72:75], v[28:31], a[128:135], v136
  s_waitcnt lgkmcnt(2)
  v_smfmac_f32_16x16x64_bf16 v[68:71], v[32:35], a[56:63], v136
  v_smfmac_f32_16x16x64_bf16 v[72:75], v[32:35], a[136:143], v136
  s_waitcnt lgkmcnt(1)
  v_smfmac_f32_16x16x64_bf16 v[68:71], v[36:39], a[64:71], v136
  v_smfmac_f32_16x16x64_bf16 v[72:75], v[36:39], a[144:151], v136
  s_waitcnt lgkmcnt(0)
  v_smfmac_f32_16x16x64_bf16 v[68:71], v[40:43], a[72:79], v136
  v_smfmac_f32_16x16x64_bf16 v[72:75], v[40:43], a[152:159], v136
  v_smfmac_f32_16x16x64_bf16 v[76:79], v[4:7], a[160:167], v136
  v_smfmac_f32_16x16x64_bf16 v[76:79], v[8:11], a[168:175], v136
  s_nop 4
  v_add_f32 v68, v68, v70
  v_add_f32 v69, v69, v71
  v_add_f32 v72, v72, v74
  v_add_f32 v73, v73, v75
  v_smfmac_f32_16x16x64_bf16 v[76:79], v[12:15], a[176:183], v136
  v_cvt_pk_bf16_f32 v122, v68, v69
  v_cvt_pk_bf16_f32 v123, v72, v73
  ds_write2_b32 v128, v122, v122 offset0:0 offset1:4
  ds_write2_b32 v129, v123, v123 offset0:0 offset1:1
  v_smfmac_f32_16x16x64_bf16 v[76:79], v[16:19], a[184:191], v136
  v_smfmac_f32_16x16x64_bf16 v[76:79], v[20:23], a[192:199], v136
  s_waitcnt lgkmcnt(0)
  s_barrier
  ds_read_b64_tr_b16 v[144:145], v125 offset:10240
  ds_read_b64_tr_b16 v[60:61], v125 offset:12288
  ds_read_b64_tr_b16 v[146:147], v125 offset:10752
  ds_read_b64_tr_b16 v[62:63], v125 offset:12800
  ds_read_b64_tr_b16 v[148:149], v125 offset:11264
  ds_read_b64_tr_b16 v[64:65], v125 offset:13312
  ds_read_b64_tr_b16 v[150:151], v125 offset:11776
  ds_read_b64_tr_b16 v[66:67], v125 offset:13824
  v_smfmac_f32_16x16x64_bf16 v[76:79], v[24:27], a[200:207], v136
  v_smfmac_f32_16x16x64_bf16 v[76:79], v[28:31], a[208:215], v136
  v_smfmac_f32_16x16x64_bf16 v[76:79], v[32:35], a[216:223], v136
  s_waitcnt lgkmcnt(4)
  v_mfma_f32_16x16x32_bf16 v[80:83], v[60:63], v[144:147], 0
  s_waitcnt lgkmcnt(0)
  v_mfma_f32_16x16x32_bf16 v[80:83], v[64:67], v[148:151], v[80:83]
  v_smfmac_f32_16x16x64_bf16 v[76:79], v[36:39], a[224:231], v136
  v_smfmac_f32_16x16x64_bf16 v[76:79], v[40:43], a[232:239], v136
  s_nop 5
  v_cndmask_b32 v80, v80, v81, s[68:69]
  buffer_store_dword v80, v124, s[8:11], s50 offen
  v_add_f32 v76, v76, v78
  v_add_f32 v77, v77, v79
  v_cvt_pk_bf16_f32 v140, v76, v77
  s_nop 1
  v_mov_b32_dpp v141, v140 row_ror:4 row_mask:0xf bank_mask:0xa
  s_nop 1
  v_mov_b32_dpp v141, v140 row_ror:12 row_mask:0xf bank_mask:0x5
  v_perm_b32 v140, v141, v140, v137
  buffer_store_dword v140, v130, s[8:11], s51 offen
  s_and_b32 s42, s40, 3
  s_xor_b32 s42, s42, 2
  s_mul_i32 s42, s42, 163840
  s_add_u32 s42, s42, s64
  s_add_u32 s43, s42, 65536
  s_add_u32 s44, s42, s63
  s_waitcnt vmcnt(0)
  s_barrier
  buffer_store_dwordx4 v[84:87], v131, s[8:11], s42 offen sc1
  buffer_store_dwordx4 v[84:87], v131, s[8:11], s43 offen sc1
  buffer_store_dwordx4 v[84:87], v131, s[8:11], s44 offen sc1
  v_mov_b32 v143, s40
  s_add_u32 s40, s40, 1
  s_cmp_eq_u32 s40, 64
  s_cbranch_scc1 chain_last_c1n
  s_add_u32 s78, s40, 1
  s_waitcnt vmcnt(0)
  buffer_store_dword v143, v135, s[8:11], 0 offen
  s_mov_b32 s41, 0
cpw_92:
  v_cmp_gt_u32 vcc, s78, v139
  s_nop 0
  s_and_b32 vcc_lo, vcc_lo, 0xfff000
  s_and_b32 vcc_hi, vcc_hi, 0xfffff0
  s_cmp_eq_u64 vcc, 0
  s_cbranch_scc1 cpo_93
  s_sleep 1
  buffer_load_dword v139, v134, s[8:11], 0 offen sc1
  s_add_u32 s41, s41, 1
  s_cmp_gt_u32 s41, 65536
  s_cbranch_scc1 chain_abort
  s_waitcnt vmcnt(0)
  s_branch cpw_92
cpo_93:
  s_mov_b32 s42, s46
  s_mov_b32 s46, s47
  s_mov_b32 s47, s42
  s_sub_u32 s43, s40, 1
  s_and_b32 s43, s43, 3
  s_mul_i32 s43, s43, 227328
  s_add_u32 s57, s24, s43
  s_add_u32 s54, s55, s79
  s_and_b32 s42, s40, 3
  s_lshl_b32 s43, s42, 15
  s_add_u32 s52, s49, s43
  s_add_u32 s53, s52, 4096
  s_add_u32 s55, s48, s43
  s_add_u32 s50, s55, s56
  s_lshl_b32 s44, s38, 10
  s_add_u32 s51, s55, s44
  s_add_u32 s51, s51, 4096
  v_mov_b32 v68, 0
  v_mov_b32 v69, 0
  v_mov_b32 v70, 0
  v_mov_b32 v71, 0
  v_mov_b32 v72, 0
  v_mov_b32 v73, 0
  v_mov_b32 v74, 0
  v_mov_b32 v75, 0
  v_mov_b32 v76, 0
  v_mov_b32 v77, 0
  v_mov_b32 v78, 0
  v_mov_b32 v79, 0
  s_sleep 16
  s_branch chain_loop_c1n
chain_last_c1n:
  s_sub_u32 s43, s40, 1
  s_and_b32 s43, s43, 3
  s_mul_i32 s43, s43, 227328
  s_add_u32 s57, s24, s43
  s_waitcnt lgkmcnt(0)
  v_mov_b32 v143, s40
  s_branch chain_fin
chain_pro_c2n:
  s_sub_u32 s42, s36, 10
  s_lshl_b32 s42, s42, 2
  s_add_u32 s42, s42, s17
  s_cmp_lt_u32 s42, 4
  s_cselect_b32 s63, 16, 8
  s_lshl_b32 s63, s63, 13
  s_lshl_b32 s64, s42, 13
  s_lshl_b32 s42, s16, 8
  s_add_u32 s64, s64, s42
  s_add_u32 s64, s64, 1441792
  v_lshrrev_b32 v140, 4, v1
  v_lshlrev_b32 v140, 11, v140
  v_and_b32 v141, 15, v1
  v_lshl_add_u32 v131, v141, 4, v140
  s_mov_b32 s78, 1
  v_mov_b32 v143, 0
  s_mov_b32 s41, 0
cpw_94:
  v_cmp_gt_u32 vcc, s78, v139
  s_nop 0
  s_and_b32 vcc_lo, vcc_lo, 0xfff000
  s_and_b32 vcc_hi, vcc_hi, 0x10fffff0
  s_cmp_eq_u64 vcc, 0
  s_cbranch_scc1 cpo_95
  s_sleep 1
  buffer_load_dword v139, v134, s[8:11], 0 offen sc1
  s_add_u32 s41, s41, 1
  s_cmp_gt_u32 s41, 65536
  s_cbranch_scc1 chain_abort
  s_waitcnt vmcnt(0)
  s_branch cpw_94
cpo_95:
  s_add_u32 s55, s48, 98304
  s_sub_u32 s43, s40, 1
  s_and_b32 s43, s43, 3
  s_mul_i32 s43, s43, 227328
  s_add_u32 s57, s24, s43
  s_add_u32 s54, s55, s79
  s_and_b32 s42, s40, 3
  s_lshl_b32 s43, s42, 15
  s_add_u32 s52, s49, s43
  s_add_u32 s53, s52, 4096
  s_add_u32 s55, s48, s43
  s_add_u32 s50, s55, s56
  s_lshl_b32 s44, s38, 10
  s_add_u32 s51, s55, s44
  s_add_u32 s51, s51, 4096
  v_mov_b32 v68, 0
  v_mov_b32 v69, 0
  v_mov_b32 v70, 0
  v_mov_b32 v71, 0
  v_mov_b32 v72, 0
  v_mov_b32 v73, 0
  v_mov_b32 v74, 0
  v_mov_b32 v75, 0
  v_mov_b32 v76, 0
  v_mov_b32 v77, 0
  v_mov_b32 v78, 0
  v_mov_b32 v79, 0
chain_loop_c2n:
  s_mov_b32 s41, 0
  buffer_load_dwordx4 v[152:155], v126, s[8:11], s46 offen sc1
  buffer_load_dwordx4 v[156:159], v126, s[8:11], s46 offen offset:1024 sc1
  buffer_load_dwordx2 v[160:161], v127, s[8:11], s46 offen sc1
  s_sleep 2
mq_96:
  buffer_load_dwordx4 v[162:165], v126, s[8:11], s46 offen sc1
  buffer_load_dwordx4 v[108:111], v126, s[8:11], s46 offen offset:1024 sc1
  buffer_load_dwordx2 v[112:113], v127, s[8:11], s46 offen sc1
  s_waitcnt vmcnt(3)
  v_max3_u32 v140, v152, v153, v154
  v_max3_u32 v141, v155, v156, v157
  v_max3_u32 v140, v140, v158, v159
  v_max3_u32 v141, v141, v160, v161
  v_max_u32 v140, v140, v141
  v_cmp_eq_u32 vcc, -1, v140
  s_cbranch_vccz mq_96_a
  buffer_load_dwordx4 v[152:155], v126, s[8:11], s46 offen sc1
  buffer_load_dwordx4 v[156:159], v126, s[8:11], s46 offen offset:1024 sc1
  buffer_load_dwordx2 v[160:161], v127, s[8:11], s46 offen sc1
  s_add_u32 s41, s41, 1
  s_cmp_gt_u32 s41, 65536
  s_cbranch_scc1 chain_abort
  s_waitcnt vmcnt(3)
  v_max3_u32 v140, v162, v163, v164
  v_max3_u32 v141, v165, v108, v109
  v_max3_u32 v140, v140, v110, v111
  v_max3_u32 v141, v141, v112, v113
  v_max_u32 v140, v140, v141
  v_cmp_eq_u32 vcc, -1, v140
  s_cbranch_vccnz mq_96
  ds_write_b128 v126, v[162:165]
  ds_write_b128 v126, v[108:111] offset:1024
  ds_write_b64 v127, v[112:113]
  s_branch mq_96_ok
mq_96_a:
  ds_write_b128 v126, v[152:155]
  ds_write_b128 v126, v[156:159] offset:1024
  ds_write_b64 v127, v[160:161]
mq_96_ok:
  s_waitcnt lgkmcnt(0)
  s_barrier
  ds_read_b128 v[4:7], v124 offset:0
  ds_read_b128 v[8:11], v124 offset:1024
  ds_read_b128 v[12:15], v124 offset:2048
  ds_read_b128 v[16:19], v124 offset:3072
  ds_read_b128 v[20:23], v124 offset:4096
  ds_read_b128 v[24:27], v124 offset:5120
  ds_read_b128 v[28:31], v124 offset:6144
  ds_read_b128 v[32:35], v124 offset:7168
  ds_read_b128 v[36:39], v124 offset:8192
  ds_read_b128 v[40:43], v124 offset:9216
  s_waitcnt lgkmcnt(9)
  v_smfmac_f32_16x16x64_bf16 v[68:71], v[4:7], a[0:7], v136
  v_smfmac_f32_16x16x64_bf16 v[72:75], v[4:7], a[80:87], v136
  buffer_store_dwordx4 v[60:63], v138, s[8:11], s57 offen
  s_waitcnt lgkmcnt(8)
  v_smfmac_f32_16x16x64_bf16 v[68:71], v[8:11], a[8:15], v136
  v_smfmac_f32_16x16x64_bf16 v[72:75], v[8:11], a[88:95], v136
  buffer_store_dwordx4 v[64:67], v138, s[8:11], s57 offen offset:512
  s_waitcnt lgkmcnt(7)
  v_smfmac_f32_16x16x64_bf16 v[68:71], v[12:15], a[16:23], v136
  v_smfmac_f32_16x16x64_bf16 v[72:75], v[12:15], a[96:103], v136
  buffer_load_dword v139, v134, s[8:11], 0 offen sc1
  s_waitcnt lgkmcnt(6)
  v_smfmac_f32_16x16x64_bf16 v[68:71], v[16:19], a[24:31], v136
  v_smfmac_f32_16x16x64_bf16 v[72:75], v[16:19], a[104:111], v136
  s_waitcnt lgkmcnt(5)
  v_smfmac_f32_16x16x64_bf16 v[68:71], v[20:23], a[32:39], v136
  v_smfmac_f32_16x16x64_bf16 v[72:75], v[20:23], a[112:119], v136
  s_waitcnt lgkmcnt(4)
  v_smfmac_f32_16x16x64_bf16 v[68:71], v[24:27], a[40:47], v136
  v_smfmac_f32_16x16x64_bf16 v[72:75], v[24:27], a[120:127], v136
  s_waitcnt lgkmcnt(3)
  v_smfmac_f32_16x16x64_bf16 v[68:71], v[28:31], a[48:55], v136
  v_smfmac_f32_16x16x64_bf16 v[72:75], v[28:31], a[128:135], v136
  s_waitcnt lgkmcnt(2)
  v_smfmac_f32_16x16x64_bf16 v[68:71], v[32:35], a[56:63], v136
  v_smfmac_f32_16x16x64_bf16 v[72:75], v[32:35], a[136:143], v136
  s_waitcnt lgkmcnt(1)
  v_smfmac_f32_16x16x64_bf16 v[68:71], v[36:39], a[64:71], v136
  v_smfmac_f32_16x16x64_bf16 v[72:75], v[36:39], a[144:151], v136
  s_waitcnt lgkmcnt(0)
  v_smfmac_f32_16x16x64_bf16 v[68:71], v[40:43], a[72:79], v136
  v_smfmac_f32_16x16x64_bf16 v[72:75], v[40:43], a[152:159], v136
  v_smfmac_f32_16x16x64_bf16 v[76:79], v[4:7], a[160:167], v136
  v_smfmac_f32_16x16x64_bf16 v[76:79], v[8:11], a[168:175], v136
  s_nop 4
  v_add_f32 v68, v68, v70
  v_add_f32 v69, v69, v71
  v_add_f32 v72, v72, v74
  v_add_f32 v73, v73, v75
  v_smfmac_f32_16x16x64_bf16 v[76:79], v[12:15], a[176:183], v136
  v_cvt_pk_bf16_f32 v122, v68, v69
  v_cvt_pk_bf16_f32 v123, v72, v73
  ds_write2_b32 v128, v122, v122 offset0:0 offset1:4
  ds_write2_b32 v129, v123, v123 offset0:0 offset1:1
  v_smfmac_f32_16x16x64_bf16 v[76:79], v[16:19], a[184:191], v136
  v_smfmac_f32_16x16x64_bf16 v[76:79], v[20:23], a[192:199], v136
  s_waitcnt lgkmcnt(0)
  s_barrier
  ds_read_b64_tr_b16 v[60:61], v125 offset:12288
  ds_read_b64_tr_b16 v[62:63], v125 offset:12800
  ds_read_b64_tr_b16 v[64:65], v125 offset:13312
  ds_read_b64_tr_b16 v[66:67], v125 offset:13824
  v_smfmac_f32_16x16x64_bf16 v[76:79], v[24:27], a[200:207], v136
  v_smfmac_f32_16x16x64_bf16 v[76:79], v[28:31], a[208:215], v136
  v_smfmac_f32_16x16x64_bf16 v[76:79], v[32:35], a[216:223], v136
  v_smfmac_f32_16x16x64_bf16 v[76:79], v[36:39], a[224:231], v136
  v_smfmac_f32_16x16x64_bf16 v[76:79], v[40:43], a[232:239], v136
  s_nop 7
  v_add_f32 v76, v76, v78
  v_add_f32 v77, v77, v79
  v_cvt_pk_bf16_f32 v140, v76, v77
  s_nop 1
  v_mov_b32_dpp v141, v140 row_ror:4 row_mask:0xf bank_mask:0xa
  s_nop 1
  v_mov_b32_dpp v141, v140 row_ror:12 row_mask:0xf bank_mask:0x5
  v_perm_b32 v140, v141, v140, v137
  buffer_store_dword v140, v130, s[8:11], s51 offen
  s_and_b32 s42, s40, 3
  s_xor_b32 s42, s42, 2
  s_mul_i32 s42, s42, 163840
  s_add_u32 s42, s42, s64
  s_add_u32 s43, s42, 65536
  s_add_u32 s44, s42, s63
  s_waitcnt vmcnt(0)
  s_barrier
  buffer_store_dwordx4 v[84:87], v131, s[8:11], s42 offen sc1
  buffer_store_dwordx4 v[84:87], v131, s[8:11], s43 offen sc1
  buffer_store_dwordx4 v[84:87], v131, s[8:11], s44 offen sc1
  v_mov_b32 v143, s40
  s_add_u32 s40, s40, 1
  s_cmp_eq_u32 s40, 64
  s_cbranch_scc1 chain_last_c2n
  s_add_u32 s78, s40, 1
  s_waitcnt vmcnt(0)
  buffer_store_dword v143, v135, s[8:11], 0 offen
  s_mov_b32 s41, 0
cpw_97:
  v_cmp_gt_u32 vcc, s78, v139
  s_nop 0
  s_and_b32 vcc_lo, vcc_lo, 0xfff000
  s_and_b32 vcc_hi, vcc_hi, 0xfffff0
  s_cmp_eq_u64 vcc, 0
  s_cbranch_scc1 cpo_98
  s_sleep 1
  buffer_load_dword v139, v134, s[8:11], 0 offen sc1
  s_add_u32 s41, s41, 1
  s_cmp_gt_u32 s41, 65536
  s_cbranch_scc1 chain_abort
  s_waitcnt vmcnt(0)
  s_branch cpw_97
cpo_98:
  s_mov_b32 s42, s46
  s_mov_b32 s46, s47
  s_mov_b32 s47, s42
  s_sub_u32 s43, s40, 1
  s_and_b32 s43, s43, 3
  s_mul_i32 s43, s43, 227328
  s_add_u32 s57, s24, s43
  s_add_u32 s54, s55, s79
  s_and_b32 s42, s40, 3
  s_lshl_b32 s43, s42, 15
  s_add_u32 s52, s49, s43
  s_add_u32 s53, s52, 4096
  s_add_u32 s55, s48, s43
  s_add_u32 s50, s55, s56
  s_lshl_b32 s44, s38, 10
  s_add_u32 s51, s55, s44
  s_add_u32 s51, s51, 4096
  v_mov_b32 v68, 0
  v_mov_b32 v69, 0
  v_mov_b32 v70, 0
  v_mov_b32 v71, 0
  v_mov_b32 v72, 0
  v_mov_b32 v73, 0
  v_mov_b32 v74, 0
  v_mov_b32 v75, 0
  v_mov_b32 v76, 0
  v_mov_b32 v77, 0
  v_mov_b32 v78, 0
  v_mov_b32 v79, 0
  s_sleep 16
  s_branch chain_loop_c2n
chain_last_c2n:
  s_sub_u32 s43, s40, 1
  s_and_b32 s43, s43, 3
  s_mul_i32 s43, s43, 227328
  s_add_u32 s57, s24, s43
  s_waitcnt lgkmcnt(0)
  buffer_store_dwordx4 v[60:63], v138, s[8:11], s57 offen
  buffer_store_dwordx4 v[64:67], v138, s[8:11], s57 offen offset:512
  v_mov_b32 v143, s40
  s_branch chain_fin
chain_fin:
  s_waitcnt vmcnt(0)
  buffer_store_dword v143, v135, s[8:11], 0 offen
  s_endpgm
chain_abort:
  v_mov_b32 v140, 128
  v_mov_b32 v141, 1
  s_mov_b64 exec, 1
  buffer_atomic_add v141, v140, s[12:15], 0 offen
  s_endpgm
.section .rodata,"a"
.p2align 6
.amdhsa_kernel main_kernel
  .amdhsa_next_free_vgpr 512
  .amdhsa_next_free_sgpr 102
  .amdhsa_accum_offset 256
  .amdhsa_group_segment_fixed_size 0
  .amdhsa_kernarg_size 136
  .amdhsa_user_sgpr_count 2
  .amdhsa_user_sgpr_kernarg_segment_ptr 1
  .amdhsa_system_sgpr_workgroup_id_x 1
.end_amdhsa_kernel
```

```asm
; @launch kernel=main_kernel grid=(256,1,1) block=(256,1,1) lds=163840
.amdgcn_target "amdgcn-amd-amdhsa--gfx950"
.text
.globl main_kernel
.p2align 8
.type main_kernel,@function
main_kernel:
  s_load_dwordx2 s[8:9], s[0:1], 128
  s_mov_b32 s10, 268435456
  s_mov_b32 s11, 0x00020000
  s_load_dwordx2 s[12:13], s[0:1], 120
  s_mov_b32 s14, 256
  s_mov_b32 s15, 0x00020000
  s_load_dword s4, s[0:1], 0
  s_load_dword s5, s[0:1], 64
  s_getreg_b32 s16, hwreg(HW_REG_XCC_ID)
  s_and_b32 s16, s16, 7
  v_and_b32 v1, 63, v0
  v_lshrrev_b32 v2, 6, v0
  s_nop 0
  v_readfirstlane_b32 s17, v2
  v_mov_b32 v3, 1
  s_lshl_b32 s3, s16, 2
  v_mov_b32 v4, s3
  v_mov_b32 v5, 0
  s_waitcnt lgkmcnt(0)
  v_cmp_eq_u32 vcc, 0, v0
  s_nop 0
  s_and_b64 exec, exec, vcc
  s_cbranch_execz main_tk
  buffer_atomic_add v3, v4, s[12:15], 0 offen sc0
  s_waitcnt vmcnt(0)
  ds_write_b32 v5, v3
  s_waitcnt lgkmcnt(0)
main_tk:
  s_mov_b64 exec, -1
  s_barrier
  ds_read_b32 v3, v5
  s_waitcnt lgkmcnt(0)
  v_readfirstlane_b32 s18, v3
  s_barrier
  s_cmp_ge_u32 s18, 32
  s_cbranch_scc1 role_none
  s_sub_u32 s18, 31, s18
  s_cmp_lt_u32 s18, 12
  s_cbranch_scc1 role_chain
  s_cmp_lt_u32 s18, 21
  s_cbranch_scc1 role_p
  s_cmp_lt_u32 s18, 26
  s_cbranch_scc1 role_ua
  s_cmp_lt_u32 s18, 28
  s_cbranch_scc1 role_sm
  s_cmp_lt_u32 s18, 32
  s_cbranch_scc1 role_r
role_none:
  s_endpgm
role_abort:
  v_mov_b32 v2, 132
  v_mov_b32 v3, 1
  s_mov_b64 exec, 1
  buffer_atomic_add v3, v2, s[12:15], 0 offen
  s_endpgm
role_p:
  s_sub_u32 s24, s18, 12
  s_lshl_b32 s24, s24, 2
  s_add_u32 s24, s24, s17
  s_mul_i32 s25, s24, 43
  s_lshr_b32 s25, s25, 9
  s_mul_i32 s30, s25, 12
  s_sub_u32 s30, s24, s30
  s_mul_i32 s26, s30, 43
  s_lshr_b32 s26, s26, 7
  s_mul_i32 s31, s26, 3
  s_sub_u32 s27, s30, s31
  s_load_dwordx2 s[20:21], s[0:1], 16
  s_load_dwordx2 s[4:5], s[0:1], 24
  s_load_dwordx2 s[6:7], s[0:1], 32
  s_mov_b32 s22, 7864320
  s_mov_b32 s23, 0x00020000
  s_waitcnt lgkmcnt(0)
  s_cmp_eq_u32 s25, 1
  s_cselect_b64 s[20:21], s[4:5], s[20:21]
  s_cmp_eq_u32 s25, 2
  s_cselect_b64 s[20:21], s[6:7], s[20:21]
  v_lshrrev_b32 v107, 4, v1
  v_and_b32 v107, 3, v107
  v_lshlrev_b32 v107, 1, v107
  v_and_b32 v52, 7, v1
  v_xor_b32 v52, v52, v107
  v_lshlrev_b32 v52, 4, v52
  v_lshrrev_b32 v107, 3, v1
  v_mul_u32_u24 v107, 0, v107
  v_add_u32 v52, v52, v107
  v_bfe_u32 v107, v1, 3, 2
  v_bfe_u32 v108, v1, 5, 1
  v_lshl_add_u32 v107, v108, 3, v107
  v_mul_u32_u24 v107, 12288, v107
  v_add_u32 v52, v52, v107
  s_mul_i32 s33, s17, 40960
  v_lshrrev_b32 v107, 2, v1
  v_lshrrev_b32 v108, 1, v107
  v_and_b32 v108, 3, v108
  v_lshlrev_b32 v108, 1, v108
  v_bfe_u32 v112, v1, 1, 1
  v_add_u32 v112, 0, v112
  v_xor_b32 v112, v112, v108
  v_lshlrev_b32 v112, 4, v112
  v_lshlrev_b32 v107, 7, v107
  v_add_u32 v112, v112, v107
  v_and_b32 v107, 1, v1
  v_lshlrev_b32 v107, 3, v107
  v_add_u32 v112, v112, v107
  v_add_u32 v112, s33, v112
  v_lshrrev_b32 v107, 2, v1
  v_lshrrev_b32 v108, 1, v107
  v_and_b32 v108, 3, v108
  v_lshlrev_b32 v108, 1, v108
  v_bfe_u32 v113, v1, 1, 1
  v_add_u32 v113, 2, v113
  v_xor_b32 v113, v113, v108
  v_lshlrev_b32 v113, 4, v113
  v_lshlrev_b32 v107, 7, v107
  v_add_u32 v113, v113, v107
  v_and_b32 v107, 1, v1
  v_lshlrev_b32 v107, 3, v107
  v_add_u32 v113, v113, v107
  v_add_u32 v113, s33, v113
  v_lshrrev_b32 v107, 2, v1
  v_lshrrev_b32 v108, 1, v107
  v_and_b32 v108, 3, v108
  v_lshlrev_b32 v108, 1, v108
  v_bfe_u32 v114, v1, 1, 1
  v_add_u32 v114, 4, v114
  v_xor_b32 v114, v114, v108
  v_lshlrev_b32 v114, 4, v114
  v_lshlrev_b32 v107, 7, v107
  v_add_u32 v114, v114, v107
  v_and_b32 v107, 1, v1
  v_lshlrev_b32 v107, 3, v107
  v_add_u32 v114, v114, v107
  v_add_u32 v114, s33, v114
  v_lshrrev_b32 v107, 2, v1
  v_lshrrev_b32 v108, 1, v107
  v_and_b32 v108, 3, v108
  v_lshlrev_b32 v108, 1, v108
  v_bfe_u32 v115, v1, 1, 1
  v_add_u32 v115, 6, v115
  v_xor_b32 v115, v115, v108
  v_lshlrev_b32 v115, 4, v115
  v_lshlrev_b32 v107, 7, v107
  v_add_u32 v115, v115, v107
  v_and_b32 v107, 1, v1
  v_lshlrev_b32 v107, 3, v107
  v_add_u32 v115, v115, v107
  v_add_u32 v115, s33, v115
  s_lshl_b32 s30, s16, 2
  s_add_u32 s30, s30, s26
  s_mul_i32 s32, s30, 384
  s_lshl_b32 s31, s27, 7
  s_add_u32 s32, s32, s31
  s_lshl_b32 s38, s16, 22
  s_mul_i32 s30, s26, 12288
  s_add_u32 s38, s38, s30
  s_mul_i32 s30, s25, 49152
  s_add_u32 s38, s38, s30
  s_lshl_b32 s31, s27, 11
  s_add_u32 s38, s38, s31
  s_add_u32 s38, s38, 67108864
  s_mov_b32 s35, s38
  s_mov_b32 s39, 6144
  s_cmp_lg_u32 s24, 8
  s_cbranch_scc1 p_nc
  s_lshl_b32 s92, s16, 8
  s_add_u32 s92, s92, 17268736
  s_mov_b32 s93, 0
  s_mov_b32 s94, -1
  s_mov_b32 s95, -1
  v_lshlrev_b32 v92, 2, v1
  v_mov_b32 v93, -1
  s_waitcnt vmcnt(0)
boot_cal:
  s_memtime s[88:89]
  s_waitcnt lgkmcnt(0)
  buffer_store_dword v93, v92, s[8:11], s92 offen sc1
  s_waitcnt vmcnt(0)
  s_memtime s[90:91]
  s_waitcnt lgkmcnt(0)
  s_sub_u32 s88, s90, s88
  s_min_u32 s88, s88, s94
  s_mov_b32 s94, s95
  s_mov_b32 s95, s88
  s_xor_b32 s92, s92, 8192
  s_add_u32 s93, s93, 1
  s_cmp_lt_u32 s93, 10
  s_cbranch_scc1 boot_cal
  v_mov_b32 v92, 192
  s_mov_b32 s93, 0
gw_1:
  buffer_load_dword v93, v92, s[12:15], 0 offen sc1
  s_add_u32 s93, s93, 1
  s_cmp_gt_u32 s93, 65536
  s_cbranch_scc1 role_abort
  s_waitcnt vmcnt(0)
  v_cmp_gt_u32 vcc, 16, v93
  s_cbranch_vccz gk_2
  s_sleep 8
  s_branch gw_1
gk_2:
  s_cmp_lt_u32 s94, s95
  s_cselect_b32 s93, 1, 2
  s_lshl_b32 s92, s16, 8
  v_mov_b32 v92, s93
  v_mov_b32 v93, s92
  s_mov_b64 exec, 1
  buffer_store_dword v92, v93, s[8:11], 0 offen offset:240
  s_mov_b64 exec, -1
  s_branch p_go
p_nc:
  s_cmp_lg_u32 s25, 0
  s_cbranch_scc1 p_go
p_go:
  v_and_b32 v110, 15, v1
  v_lshlrev_b32 v110, 7, v110
  v_bfe_u32 v107, v1, 4, 1
  v_mad_u32_u24 v110, v107, s39, v110
  v_lshrrev_b32 v107, 5, v1
  v_mul_u32_u24 v107, 147456, v107
  v_add_u32 v109, v107, v110
  s_add_u32 s39, s38, 294912
  s_add_u32 m0, s33, 0
  s_add_u32 s30, s32, 0
  buffer_load_dwordx4 v52, s[20:23], s30 offen nt lds
  s_add_u32 m0, s33, 1024
  s_add_u32 s30, s32, 196608
  buffer_load_dwordx4 v52, s[20:23], s30 offen nt lds
  s_add_u32 m0, s33, 2048
  s_add_u32 s30, s32, 49152
  buffer_load_dwordx4 v52, s[20:23], s30 offen nt lds
  s_add_u32 m0, s33, 3072
  s_add_u32 s30, s32, 245760
  buffer_load_dwordx4 v52, s[20:23], s30 offen nt lds
  s_add_u32 m0, s33, 4096
  s_add_u32 s30, s32, 393216
  buffer_load_dwordx4 v52, s[20:23], s30 offen nt lds
  s_add_u32 m0, s33, 5120
  s_add_u32 s30, s32, 589824
  buffer_load_dwordx4 v52, s[20:23], s30 offen nt lds
  s_add_u32 m0, s33, 6144
  s_add_u32 s30, s32, 442368
  buffer_load_dwordx4 v52, s[20:23], s30 offen nt lds
  s_add_u32 m0, s33, 7168
  s_add_u32 s30, s32, 638976
  buffer_load_dwordx4 v52, s[20:23], s30 offen nt lds
  s_add_u32 m0, s33, 8192
  s_add_u32 s30, s32, 786432
  buffer_load_dwordx4 v52, s[20:23], s30 offen nt lds
  s_add_u32 m0, s33, 9216
  s_add_u32 s30, s32, 983040
  buffer_load_dwordx4 v52, s[20:23], s30 offen nt lds
  s_add_u32 m0, s33, 10240
  s_add_u32 s30, s32, 835584
  buffer_load_dwordx4 v52, s[20:23], s30 offen nt lds
  s_add_u32 m0, s33, 11264
  s_add_u32 s30, s32, 1032192
  buffer_load_dwordx4 v52, s[20:23], s30 offen nt lds
  s_add_u32 m0, s33, 12288
  s_add_u32 s30, s32, 1179648
  buffer_load_dwordx4 v52, s[20:23], s30 offen nt lds
  s_add_u32 m0, s33, 13312
  s_add_u32 s30, s32, 1376256
  buffer_load_dwordx4 v52, s[20:23], s30 offen nt lds
  s_add_u32 m0, s33, 14336
  s_add_u32 s30, s32, 1228800
  buffer_load_dwordx4 v52, s[20:23], s30 offen nt lds
  s_add_u32 m0, s33, 15360
  s_add_u32 s30, s32, 1425408
  buffer_load_dwordx4 v52, s[20:23], s30 offen nt lds
  s_add_u32 m0, s33, 16384
  s_add_u32 s30, s32, 1572864
  buffer_load_dwordx4 v52, s[20:23], s30 offen nt lds
  s_add_u32 m0, s33, 17408
  s_add_u32 s30, s32, 1769472
  buffer_load_dwordx4 v52, s[20:23], s30 offen nt lds
  s_add_u32 m0, s33, 18432
  s_add_u32 s30, s32, 1622016
  buffer_load_dwordx4 v52, s[20:23], s30 offen nt lds
  s_add_u32 m0, s33, 19456
  s_add_u32 s30, s32, 1818624
  buffer_load_dwordx4 v52, s[20:23], s30 offen nt lds
  s_add_u32 m0, s33, 20480
  s_add_u32 s30, s32, 1966080
  buffer_load_dwordx4 v52, s[20:23], s30 offen nt lds
  s_add_u32 m0, s33, 21504
  s_add_u32 s30, s32, 2162688
  buffer_load_dwordx4 v52, s[20:23], s30 offen nt lds
  s_add_u32 m0, s33, 22528
  s_add_u32 s30, s32, 2015232
  buffer_load_dwordx4 v52, s[20:23], s30 offen nt lds
  s_add_u32 m0, s33, 23552
  s_add_u32 s30, s32, 2211840
  buffer_load_dwordx4 v52, s[20:23], s30 offen nt lds
  s_waitcnt vmcnt(20)
  s_add_u32 m0, s33, 24576
  s_add_u32 s30, s32, 2359296
  buffer_load_dwordx4 v52, s[20:23], s30 offen nt lds
  s_add_u32 m0, s33, 25600
  s_add_u32 s30, s32, 2555904
  buffer_load_dwordx4 v52, s[20:23], s30 offen nt lds
  s_add_u32 m0, s33, 26624
  s_add_u32 s30, s32, 2408448
  buffer_load_dwordx4 v52, s[20:23], s30 offen nt lds
  s_add_u32 m0, s33, 27648
  s_add_u32 s30, s32, 2605056
  buffer_load_dwordx4 v52, s[20:23], s30 offen nt lds
  ds_read_b64_tr_b16 v[192:193], v112 offset:0
  ds_read_b64_tr_b16 v[194:195], v112 offset:2048
  ds_read_b64_tr_b16 a[16:17], v113 offset:0
  ds_read_b64_tr_b16 a[18:19], v113 offset:2048
  ds_read_b64_tr_b16 a[96:97], v114 offset:0
  ds_read_b64_tr_b16 a[98:99], v114 offset:2048
  ds_read_b64_tr_b16 a[176:177], v115 offset:0
  ds_read_b64_tr_b16 a[178:179], v115 offset:2048
  s_waitcnt lgkmcnt(8)
  s_waitcnt vmcnt(20)
  s_add_u32 m0, s33, 28672
  s_add_u32 s30, s32, 2752512
  buffer_load_dwordx4 v52, s[20:23], s30 offen nt lds
  s_add_u32 m0, s33, 29696
  s_add_u32 s30, s32, 2949120
  buffer_load_dwordx4 v52, s[20:23], s30 offen nt lds
  s_add_u32 m0, s33, 30720
  s_add_u32 s30, s32, 2801664
  buffer_load_dwordx4 v52, s[20:23], s30 offen nt lds
  s_add_u32 m0, s33, 31744
  s_add_u32 s30, s32, 2998272
  buffer_load_dwordx4 v52, s[20:23], s30 offen nt lds
  ds_read_b64_tr_b16 v[196:197], v112 offset:4096
  ds_read_b64_tr_b16 v[198:199], v112 offset:6144
  ds_read_b64_tr_b16 a[20:21], v113 offset:4096
  ds_read_b64_tr_b16 a[22:23], v113 offset:6144
  ds_read_b64_tr_b16 a[100:101], v114 offset:4096
  ds_read_b64_tr_b16 a[102:103], v114 offset:6144
  ds_read_b64_tr_b16 a[180:181], v115 offset:4096
  ds_read_b64_tr_b16 a[182:183], v115 offset:6144
  s_waitcnt lgkmcnt(8)
  s_waitcnt vmcnt(20)
  s_add_u32 m0, s33, 32768
  s_add_u32 s30, s32, 3145728
  buffer_load_dwordx4 v52, s[20:23], s30 offen nt lds
  s_add_u32 m0, s33, 33792
  s_add_u32 s30, s32, 3342336
  buffer_load_dwordx4 v52, s[20:23], s30 offen nt lds
  s_add_u32 m0, s33, 34816
  s_add_u32 s30, s32, 3194880
  buffer_load_dwordx4 v52, s[20:23], s30 offen nt lds
  s_add_u32 m0, s33, 35840
  s_add_u32 s30, s32, 3391488
  buffer_load_dwordx4 v52, s[20:23], s30 offen nt lds
  ds_read_b64_tr_b16 v[200:201], v112 offset:8192
  ds_read_b64_tr_b16 v[202:203], v112 offset:10240
  ds_read_b64_tr_b16 a[24:25], v113 offset:8192
  ds_read_b64_tr_b16 a[26:27], v113 offset:10240
  ds_read_b64_tr_b16 a[104:105], v114 offset:8192
  ds_read_b64_tr_b16 a[106:107], v114 offset:10240
  ds_read_b64_tr_b16 a[184:185], v115 offset:8192
  ds_read_b64_tr_b16 a[186:187], v115 offset:10240
  s_waitcnt lgkmcnt(8)
  s_waitcnt vmcnt(20)
  s_add_u32 m0, s33, 36864
  s_add_u32 s30, s32, 3538944
  buffer_load_dwordx4 v52, s[20:23], s30 offen nt lds
  s_add_u32 m0, s33, 37888
  s_add_u32 s30, s32, 3735552
  buffer_load_dwordx4 v52, s[20:23], s30 offen nt lds
  s_add_u32 m0, s33, 38912
  s_add_u32 s30, s32, 3588096
  buffer_load_dwordx4 v52, s[20:23], s30 offen nt lds
  s_add_u32 m0, s33, 39936
  s_add_u32 s30, s32, 3784704
  buffer_load_dwordx4 v52, s[20:23], s30 offen nt lds
  ds_read_b64_tr_b16 v[204:205], v112 offset:12288
  ds_read_b64_tr_b16 v[206:207], v112 offset:14336
  ds_read_b64_tr_b16 a[28:29], v113 offset:12288
  ds_read_b64_tr_b16 a[30:31], v113 offset:14336
  ds_read_b64_tr_b16 a[108:109], v114 offset:12288
  ds_read_b64_tr_b16 a[110:111], v114 offset:14336
  ds_read_b64_tr_b16 a[188:189], v115 offset:12288
  ds_read_b64_tr_b16 a[190:191], v115 offset:14336
  s_waitcnt lgkmcnt(8)
  s_waitcnt vmcnt(20)
  s_add_u32 m0, s33, 0
  s_add_u32 s30, s32, 3932160
  buffer_load_dwordx4 v52, s[20:23], s30 offen nt lds
  s_add_u32 m0, s33, 1024
  s_add_u32 s30, s32, 4128768
  buffer_load_dwordx4 v52, s[20:23], s30 offen nt lds
  s_add_u32 m0, s33, 2048
  s_add_u32 s30, s32, 3981312
  buffer_load_dwordx4 v52, s[20:23], s30 offen nt lds
  s_add_u32 m0, s33, 3072
  s_add_u32 s30, s32, 4177920
  buffer_load_dwordx4 v52, s[20:23], s30 offen nt lds
  ds_read_b64_tr_b16 v[208:209], v112 offset:16384
  ds_read_b64_tr_b16 v[210:211], v112 offset:18432
  ds_read_b64_tr_b16 a[32:33], v113 offset:16384
  ds_read_b64_tr_b16 a[34:35], v113 offset:18432
  ds_read_b64_tr_b16 a[112:113], v114 offset:16384
  ds_read_b64_tr_b16 a[114:115], v114 offset:18432
  ds_read_b64_tr_b16 a[192:193], v115 offset:16384
  ds_read_b64_tr_b16 a[194:195], v115 offset:18432
  s_waitcnt lgkmcnt(8)
  s_waitcnt vmcnt(20)
  s_add_u32 m0, s33, 4096
  s_add_u32 s30, s32, 4325376
  buffer_load_dwordx4 v52, s[20:23], s30 offen nt lds
  s_add_u32 m0, s33, 5120
  s_add_u32 s30, s32, 4521984
  buffer_load_dwordx4 v52, s[20:23], s30 offen nt lds
  s_add_u32 m0, s33, 6144
  s_add_u32 s30, s32, 4374528
  buffer_load_dwordx4 v52, s[20:23], s30 offen nt lds
  s_add_u32 m0, s33, 7168
  s_add_u32 s30, s32, 4571136
  buffer_load_dwordx4 v52, s[20:23], s30 offen nt lds
  ds_read_b64_tr_b16 v[212:213], v112 offset:20480
  ds_read_b64_tr_b16 v[214:215], v112 offset:22528
  ds_read_b64_tr_b16 a[36:37], v113 offset:20480
  ds_read_b64_tr_b16 a[38:39], v113 offset:22528
  ds_read_b64_tr_b16 a[116:117], v114 offset:20480
  ds_read_b64_tr_b16 a[118:119], v114 offset:22528
  ds_read_b64_tr_b16 a[196:197], v115 offset:20480
  ds_read_b64_tr_b16 a[198:199], v115 offset:22528
  s_waitcnt lgkmcnt(8)
  s_waitcnt vmcnt(20)
  s_add_u32 m0, s33, 8192
  s_add_u32 s30, s32, 4718592
  buffer_load_dwordx4 v52, s[20:23], s30 offen nt lds
  s_add_u32 m0, s33, 9216
  s_add_u32 s30, s32, 4915200
  buffer_load_dwordx4 v52, s[20:23], s30 offen nt lds
  s_add_u32 m0, s33, 10240
  s_add_u32 s30, s32, 4767744
  buffer_load_dwordx4 v52, s[20:23], s30 offen nt lds
  s_add_u32 m0, s33, 11264
  s_add_u32 s30, s32, 4964352
  buffer_load_dwordx4 v52, s[20:23], s30 offen nt lds
  ds_read_b64_tr_b16 v[216:217], v112 offset:24576
  ds_read_b64_tr_b16 v[218:219], v112 offset:26624
  ds_read_b64_tr_b16 a[40:41], v113 offset:24576
  ds_read_b64_tr_b16 a[42:43], v113 offset:26624
  ds_read_b64_tr_b16 a[120:121], v114 offset:24576
  ds_read_b64_tr_b16 a[122:123], v114 offset:26624
  ds_read_b64_tr_b16 a[200:201], v115 offset:24576
  ds_read_b64_tr_b16 a[202:203], v115 offset:26624
  s_waitcnt lgkmcnt(8)
  s_waitcnt vmcnt(20)
  s_add_u32 m0, s33, 12288
  s_add_u32 s30, s32, 5111808
  buffer_load_dwordx4 v52, s[20:23], s30 offen nt lds
  s_add_u32 m0, s33, 13312
  s_add_u32 s30, s32, 5308416
  buffer_load_dwordx4 v52, s[20:23], s30 offen nt lds
  s_add_u32 m0, s33, 14336
  s_add_u32 s30, s32, 5160960
  buffer_load_dwordx4 v52, s[20:23], s30 offen nt lds
  s_add_u32 m0, s33, 15360
  s_add_u32 s30, s32, 5357568
  buffer_load_dwordx4 v52, s[20:23], s30 offen nt lds
  ds_read_b64_tr_b16 v[220:221], v112 offset:28672
  ds_read_b64_tr_b16 v[222:223], v112 offset:30720
  ds_read_b64_tr_b16 a[44:45], v113 offset:28672
  ds_read_b64_tr_b16 a[46:47], v113 offset:30720
  ds_read_b64_tr_b16 a[124:125], v114 offset:28672
  ds_read_b64_tr_b16 a[126:127], v114 offset:30720
  ds_read_b64_tr_b16 a[204:205], v115 offset:28672
  ds_read_b64_tr_b16 a[206:207], v115 offset:30720
  s_waitcnt lgkmcnt(8)
  s_waitcnt vmcnt(20)
  s_add_u32 m0, s33, 16384
  s_add_u32 s30, s32, 5505024
  buffer_load_dwordx4 v52, s[20:23], s30 offen nt lds
  s_add_u32 m0, s33, 17408
  s_add_u32 s30, s32, 5701632
  buffer_load_dwordx4 v52, s[20:23], s30 offen nt lds
  s_add_u32 m0, s33, 18432
  s_add_u32 s30, s32, 5554176
  buffer_load_dwordx4 v52, s[20:23], s30 offen nt lds
  s_add_u32 m0, s33, 19456
  s_add_u32 s30, s32, 5750784
  buffer_load_dwordx4 v52, s[20:23], s30 offen nt lds
  ds_read_b64_tr_b16 v[224:225], v112 offset:32768
  ds_read_b64_tr_b16 v[226:227], v112 offset:34816
  ds_read_b64_tr_b16 a[48:49], v113 offset:32768
  ds_read_b64_tr_b16 a[50:51], v113 offset:34816
  ds_read_b64_tr_b16 a[128:129], v114 offset:32768
  ds_read_b64_tr_b16 a[130:131], v114 offset:34816
  ds_read_b64_tr_b16 a[208:209], v115 offset:32768
  ds_read_b64_tr_b16 a[210:211], v115 offset:34816
  s_waitcnt lgkmcnt(8)
  s_waitcnt vmcnt(20)
  s_add_u32 m0, s33, 20480
  s_add_u32 s30, s32, 5898240
  buffer_load_dwordx4 v52, s[20:23], s30 offen nt lds
  s_add_u32 m0, s33, 21504
  s_add_u32 s30, s32, 6094848
  buffer_load_dwordx4 v52, s[20:23], s30 offen nt lds
  s_add_u32 m0, s33, 22528
  s_add_u32 s30, s32, 5947392
  buffer_load_dwordx4 v52, s[20:23], s30 offen nt lds
  s_add_u32 m0, s33, 23552
  s_add_u32 s30, s32, 6144000
  buffer_load_dwordx4 v52, s[20:23], s30 offen nt lds
  ds_read_b64_tr_b16 v[228:229], v112 offset:36864
  ds_read_b64_tr_b16 v[230:231], v112 offset:38912
  ds_read_b64_tr_b16 a[52:53], v113 offset:36864
  ds_read_b64_tr_b16 a[54:55], v113 offset:38912
  ds_read_b64_tr_b16 a[132:133], v114 offset:36864
  ds_read_b64_tr_b16 a[134:135], v114 offset:38912
  ds_read_b64_tr_b16 a[212:213], v115 offset:36864
  ds_read_b64_tr_b16 a[214:215], v115 offset:38912
  s_waitcnt lgkmcnt(8)
  s_waitcnt vmcnt(20)
  s_add_u32 m0, s33, 24576
  s_add_u32 s30, s32, 6291456
  buffer_load_dwordx4 v52, s[20:23], s30 offen nt lds
  s_add_u32 m0, s33, 25600
  s_add_u32 s30, s32, 6488064
  buffer_load_dwordx4 v52, s[20:23], s30 offen nt lds
  s_add_u32 m0, s33, 26624
  s_add_u32 s30, s32, 6340608
  buffer_load_dwordx4 v52, s[20:23], s30 offen nt lds
  s_add_u32 m0, s33, 27648
  s_add_u32 s30, s32, 6537216
  buffer_load_dwordx4 v52, s[20:23], s30 offen nt lds
  ds_read_b64_tr_b16 v[232:233], v112 offset:0
  ds_read_b64_tr_b16 v[234:235], v112 offset:2048
  ds_read_b64_tr_b16 a[56:57], v113 offset:0
  ds_read_b64_tr_b16 a[58:59], v113 offset:2048
  ds_read_b64_tr_b16 a[136:137], v114 offset:0
  ds_read_b64_tr_b16 a[138:139], v114 offset:2048
  ds_read_b64_tr_b16 a[216:217], v115 offset:0
  ds_read_b64_tr_b16 a[218:219], v115 offset:2048
  s_waitcnt lgkmcnt(8)
  s_waitcnt vmcnt(20)
  s_add_u32 m0, s33, 28672
  s_add_u32 s30, s32, 6684672
  buffer_load_dwordx4 v52, s[20:23], s30 offen nt lds
  s_add_u32 m0, s33, 29696
  s_add_u32 s30, s32, 6881280
  buffer_load_dwordx4 v52, s[20:23], s30 offen nt lds
  s_add_u32 m0, s33, 30720
  s_add_u32 s30, s32, 6733824
  buffer_load_dwordx4 v52, s[20:23], s30 offen nt lds
  s_add_u32 m0, s33, 31744
  s_add_u32 s30, s32, 6930432
  buffer_load_dwordx4 v52, s[20:23], s30 offen nt lds
  ds_read_b64_tr_b16 v[236:237], v112 offset:4096
  ds_read_b64_tr_b16 v[238:239], v112 offset:6144
  ds_read_b64_tr_b16 a[60:61], v113 offset:4096
  ds_read_b64_tr_b16 a[62:63], v113 offset:6144
  ds_read_b64_tr_b16 a[140:141], v114 offset:4096
  ds_read_b64_tr_b16 a[142:143], v114 offset:6144
  ds_read_b64_tr_b16 a[220:221], v115 offset:4096
  ds_read_b64_tr_b16 a[222:223], v115 offset:6144
  s_waitcnt lgkmcnt(8)
  s_waitcnt vmcnt(20)
  s_add_u32 m0, s33, 32768
  s_add_u32 s30, s32, 7077888
  buffer_load_dwordx4 v52, s[20:23], s30 offen nt lds
  s_add_u32 m0, s33, 33792
  s_add_u32 s30, s32, 7274496
  buffer_load_dwordx4 v52, s[20:23], s30 offen nt lds
  s_add_u32 m0, s33, 34816
  s_add_u32 s30, s32, 7127040
  buffer_load_dwordx4 v52, s[20:23], s30 offen nt lds
  s_add_u32 m0, s33, 35840
  s_add_u32 s30, s32, 7323648
  buffer_load_dwordx4 v52, s[20:23], s30 offen nt lds
  ds_read_b64_tr_b16 v[240:241], v112 offset:8192
  ds_read_b64_tr_b16 v[242:243], v112 offset:10240
  ds_read_b64_tr_b16 a[64:65], v113 offset:8192
  ds_read_b64_tr_b16 a[66:67], v113 offset:10240
  ds_read_b64_tr_b16 a[144:145], v114 offset:8192
  ds_read_b64_tr_b16 a[146:147], v114 offset:10240
  ds_read_b64_tr_b16 a[224:225], v115 offset:8192
  ds_read_b64_tr_b16 a[226:227], v115 offset:10240
  s_waitcnt lgkmcnt(8)
  s_waitcnt vmcnt(20)
  s_add_u32 m0, s33, 36864
  s_add_u32 s30, s32, 7471104
  buffer_load_dwordx4 v52, s[20:23], s30 offen nt lds
  s_add_u32 m0, s33, 37888
  s_add_u32 s30, s32, 7667712
  buffer_load_dwordx4 v52, s[20:23], s30 offen nt lds
  s_add_u32 m0, s33, 38912
  s_add_u32 s30, s32, 7520256
  buffer_load_dwordx4 v52, s[20:23], s30 offen nt lds
  s_add_u32 m0, s33, 39936
  s_add_u32 s30, s32, 7716864
  buffer_load_dwordx4 v52, s[20:23], s30 offen nt lds
  ds_read_b64_tr_b16 v[244:245], v112 offset:12288
  ds_read_b64_tr_b16 v[246:247], v112 offset:14336
  ds_read_b64_tr_b16 a[68:69], v113 offset:12288
  ds_read_b64_tr_b16 a[70:71], v113 offset:14336
  ds_read_b64_tr_b16 a[148:149], v114 offset:12288
  ds_read_b64_tr_b16 a[150:151], v114 offset:14336
  ds_read_b64_tr_b16 a[228:229], v115 offset:12288
  ds_read_b64_tr_b16 a[230:231], v115 offset:14336
  s_waitcnt lgkmcnt(8)
  s_waitcnt vmcnt(20)
  ds_read_b64_tr_b16 v[248:249], v112 offset:16384
  ds_read_b64_tr_b16 v[250:251], v112 offset:18432
  ds_read_b64_tr_b16 a[72:73], v113 offset:16384
  ds_read_b64_tr_b16 a[74:75], v113 offset:18432
  ds_read_b64_tr_b16 a[152:153], v114 offset:16384
  ds_read_b64_tr_b16 a[154:155], v114 offset:18432
  ds_read_b64_tr_b16 a[232:233], v115 offset:16384
  ds_read_b64_tr_b16 a[234:235], v115 offset:18432
  s_waitcnt lgkmcnt(8)
  s_waitcnt vmcnt(16)
  ds_read_b64_tr_b16 v[252:253], v112 offset:20480
  ds_read_b64_tr_b16 v[254:255], v112 offset:22528
  ds_read_b64_tr_b16 a[76:77], v113 offset:20480
  ds_read_b64_tr_b16 a[78:79], v113 offset:22528
  ds_read_b64_tr_b16 a[156:157], v114 offset:20480
  ds_read_b64_tr_b16 a[158:159], v114 offset:22528
  ds_read_b64_tr_b16 a[236:237], v115 offset:20480
  ds_read_b64_tr_b16 a[238:239], v115 offset:22528
  s_waitcnt lgkmcnt(8)
  s_waitcnt vmcnt(12)
  ds_read_b64_tr_b16 a[0:1], v112 offset:24576
  ds_read_b64_tr_b16 a[2:3], v112 offset:26624
  ds_read_b64_tr_b16 a[80:81], v113 offset:24576
  ds_read_b64_tr_b16 a[82:83], v113 offset:26624
  ds_read_b64_tr_b16 a[160:161], v114 offset:24576
  ds_read_b64_tr_b16 a[162:163], v114 offset:26624
  ds_read_b64_tr_b16 a[240:241], v115 offset:24576
  ds_read_b64_tr_b16 a[242:243], v115 offset:26624
  s_waitcnt lgkmcnt(8)
  s_waitcnt vmcnt(8)
  ds_read_b64_tr_b16 a[4:5], v112 offset:28672
  ds_read_b64_tr_b16 a[6:7], v112 offset:30720
  ds_read_b64_tr_b16 a[84:85], v113 offset:28672
  ds_read_b64_tr_b16 a[86:87], v113 offset:30720
  ds_read_b64_tr_b16 a[164:165], v114 offset:28672
  ds_read_b64_tr_b16 a[166:167], v114 offset:30720
  ds_read_b64_tr_b16 a[244:245], v115 offset:28672
  ds_read_b64_tr_b16 a[246:247], v115 offset:30720
  s_waitcnt lgkmcnt(8)
  s_waitcnt vmcnt(4)
  ds_read_b64_tr_b16 a[8:9], v112 offset:32768
  ds_read_b64_tr_b16 a[10:11], v112 offset:34816
  ds_read_b64_tr_b16 a[88:89], v113 offset:32768
  ds_read_b64_tr_b16 a[90:91], v113 offset:34816
  ds_read_b64_tr_b16 a[168:169], v114 offset:32768
  ds_read_b64_tr_b16 a[170:171], v114 offset:34816
  ds_read_b64_tr_b16 a[248:249], v115 offset:32768
  ds_read_b64_tr_b16 a[250:251], v115 offset:34816
  s_waitcnt lgkmcnt(8)
  s_waitcnt vmcnt(0)
  ds_read_b64_tr_b16 a[12:13], v112 offset:36864
  ds_read_b64_tr_b16 a[14:15], v112 offset:38912
  ds_read_b64_tr_b16 a[92:93], v113 offset:36864
  ds_read_b64_tr_b16 a[94:95], v113 offset:38912
  ds_read_b64_tr_b16 a[172:173], v114 offset:36864
  ds_read_b64_tr_b16 a[174:175], v114 offset:38912
  ds_read_b64_tr_b16 a[252:253], v115 offset:36864
  ds_read_b64_tr_b16 a[254:255], v115 offset:38912
  s_waitcnt lgkmcnt(8)
  s_waitcnt lgkmcnt(0)
  v_lshlrev_b32 v100, 4, v1
  s_mul_i32 s37, s17, 10240
  v_mov_b32 v103, v100
  s_mul_i32 s34, s16, 2621440
  s_add_u32 s34, s34, 247463936
  s_add_u32 s34, s34, s37
  s_lshl_b32 s30, s16, 8
  v_lshl_add_u32 v105, v1, 2, s30
  v_add_u32 v105, 8192, v105
  v_add_u32 v107, 4032, v105
  v_cmp_gt_u32 vcc, 16, v1
  s_nop 1
  v_cndmask_b32 v105, v107, v105, vcc
  v_cndmask_b32 v102, 1, 2, vcc
  v_cndmask_b32 v101, -8, 2, vcc
  s_lshl_b32 s31, s24, 2
  s_add_u32 s30, s30, s31
  s_add_u32 s30, s30, 0
  v_mov_b32 v104, s30
  s_mov_b32 s28, 0
  s_mov_b32 s36, 2
  v_mov_b32 v109, 0
  s_barrier
  s_lshl_b32 s29, s16, 2
  s_add_u32 s29, s29, 32
  v_mov_b32 v107, s29
  s_mov_b32 s29, 0
  s_mov_b64 exec, 1
gw_3:
  buffer_load_dword v108, v107, s[12:15], 0 offen sc1
  s_add_u32 s29, s29, 1
  s_cmp_gt_u32 s29, 65536
  s_cbranch_scc1 role_abort
  s_waitcnt vmcnt(0)
  v_cmp_gt_u32 vcc, 2, v108
  s_cbranch_vccz gk_4
  s_sleep 4
  s_branch gw_3
gk_4:
  s_mov_b64 exec, -1
  s_mov_b32 s29, 0
pw_5:
  buffer_load_dword v106, v105, s[8:11], 0 offen sc1
  s_add_u32 s29, s29, 1
  s_cmp_gt_u32 s29, 65536
  s_cbranch_scc1 role_abort
  s_waitcnt vmcnt(0)
pc_7:
  v_cmp_gt_u32 vcc, s36, v106
  s_nop 0
  s_and_b32 vcc_lo, vcc_lo, 0xffff
  s_and_b32 vcc_hi, vcc_hi, 0x0
  s_cmp_eq_u64 vcc, 0
  s_cbranch_scc1 po_6
  s_sleep 2
  s_branch pw_5
po_6:
  s_add_u32 m0, s37, 0
  s_add_u32 s30, s34, 0
  buffer_load_dwordx4 v100, s[8:11], s30 offen offset:0 sc1 lds
  buffer_load_dwordx4 v100, s[8:11], s30 offen offset:1024 sc1 lds
  buffer_load_dwordx4 v100, s[8:11], s30 offen offset:2048 sc1 lds
  buffer_load_dwordx4 v100, s[8:11], s30 offen offset:3072 sc1 lds
  s_add_u32 m0, s37, 4096
  s_add_u32 s30, s34, 4096
  buffer_load_dwordx4 v100, s[8:11], s30 offen offset:0 sc1 lds
  buffer_load_dwordx4 v100, s[8:11], s30 offen offset:1024 sc1 lds
  buffer_load_dwordx4 v100, s[8:11], s30 offen offset:2048 sc1 lds
  buffer_load_dwordx4 v100, s[8:11], s30 offen offset:3072 sc1 lds
  s_add_u32 m0, s37, 8192
  s_add_u32 s30, s34, 8192
  buffer_load_dwordx4 v100, s[8:11], s30 offen offset:0 sc1 lds
  buffer_load_dwordx4 v100, s[8:11], s30 offen offset:1024 sc1 lds
  s_xor_b32 s37, s37, 0x10000
  s_waitcnt vmcnt(0)
  s_barrier
p_loop:
  s_waitcnt lgkmcnt(0)
  v_add_u32 v101, v101, v102
  v_min_i32 v101, 128, v101
  ds_read_b128 v[36:39], v103 offset:0
  ds_read_b128 v[40:43], v103 offset:1024
  ds_read_b128 v[44:47], v103 offset:2048
  s_mov_b32 s29, 0
  s_branch pc_10
pw_8:
  buffer_load_dword v106, v105, s[8:11], 0 offen sc1
  s_add_u32 s29, s29, 1
  s_cmp_gt_u32 s29, 65536
  s_cbranch_scc1 role_abort
  s_waitcnt vmcnt(0)
pc_10:
  v_cmp_gt_i32 vcc, v101, v106
  s_nop 0
  s_and_b32 vcc_lo, vcc_lo, 0xffffff
  s_and_b32 vcc_hi, vcc_hi, 0x0
  s_cmp_eq_u64 vcc, 0
  s_cbranch_scc1 po_9
  s_sleep 8
  s_branch pw_8
po_9:
  s_cmp_lt_u32 s28, 63
  s_cselect_b32 s30, 40960, 0
  s_add_u32 s34, s34, s30
  s_add_u32 s32, s35, 6144
  s_and_b32 s30, s28, 7
  s_mul_i32 s30, s30, 147456
  s_add_u32 s35, s38, s30
  v_max_u32 v109, s28, v109
  s_add_u32 s39, s28, 2
  s_and_b32 s39, s39, 7
  s_mul_i32 s39, s39, 147456
  s_add_u32 s39, s39, s38
  s_waitcnt lgkmcnt(2)
  v_mfma_f32_16x16x32_bf16 v[4:7], v[192:195], v[36:39], 0
  ds_read_b128 v[48:51], v103 offset:3072
  v_mfma_f32_16x16x32_bf16 v[8:11], a[16:19], v[36:39], 0
  v_mfma_f32_16x16x32_bf16 v[12:15], a[96:99], v[36:39], 0
  v_mfma_f32_16x16x32_bf16 v[16:19], a[176:179], v[36:39], 0
  s_waitcnt lgkmcnt(2)
  v_mfma_f32_16x16x32_bf16 v[4:7], v[196:199], v[40:43], v[4:7]
  ds_read_b128 v[36:39], v103 offset:4096
  v_mfma_f32_16x16x32_bf16 v[8:11], a[20:23], v[40:43], v[8:11]
  v_cvt_pk_bf16_f32 v92, v20, v21
  v_mfma_f32_16x16x32_bf16 v[12:15], a[100:103], v[40:43], v[12:15]
  v_cvt_pk_bf16_f32 v93, v22, v23
  v_mfma_f32_16x16x32_bf16 v[16:19], a[180:183], v[40:43], v[16:19]
  s_waitcnt lgkmcnt(2)
  v_mfma_f32_16x16x32_bf16 v[4:7], v[200:203], v[44:47], v[4:7]
  ds_read_b128 v[40:43], v103 offset:5120
  v_mfma_f32_16x16x32_bf16 v[8:11], a[24:27], v[44:47], v[8:11]
  v_cvt_pk_bf16_f32 v94, v24, v25
  v_mfma_f32_16x16x32_bf16 v[12:15], a[104:107], v[44:47], v[12:15]
  v_cvt_pk_bf16_f32 v95, v26, v27
  v_mfma_f32_16x16x32_bf16 v[16:19], a[184:187], v[44:47], v[16:19]
  s_waitcnt lgkmcnt(2)
  v_mfma_f32_16x16x32_bf16 v[4:7], v[204:207], v[48:51], v[4:7]
  ds_read_b128 v[44:47], v103 offset:6144
  v_mfma_f32_16x16x32_bf16 v[8:11], a[28:31], v[48:51], v[8:11]
  buffer_store_dwordx4 v[92:95], v100, s[8:11], s32 offen offset:0
  v_mfma_f32_16x16x32_bf16 v[12:15], a[108:111], v[48:51], v[12:15]
  v_cvt_pk_bf16_f32 v96, v28, v29
  v_mfma_f32_16x16x32_bf16 v[16:19], a[188:191], v[48:51], v[16:19]
  s_waitcnt lgkmcnt(2)
  v_mfma_f32_16x16x32_bf16 v[4:7], v[208:211], v[36:39], v[4:7]
  ds_read_b128 v[48:51], v103 offset:7168
  v_mfma_f32_16x16x32_bf16 v[8:11], a[32:35], v[36:39], v[8:11]
  v_cvt_pk_bf16_f32 v97, v30, v31
  v_mfma_f32_16x16x32_bf16 v[12:15], a[112:115], v[36:39], v[12:15]
  v_cvt_pk_bf16_f32 v98, v32, v33
  v_mfma_f32_16x16x32_bf16 v[16:19], a[192:195], v[36:39], v[16:19]
  s_waitcnt lgkmcnt(2)
  v_mfma_f32_16x16x32_bf16 v[4:7], v[212:215], v[40:43], v[4:7]
  ds_read_b128 v[36:39], v103 offset:8192
  v_mfma_f32_16x16x32_bf16 v[8:11], a[36:39], v[40:43], v[8:11]
  v_cvt_pk_bf16_f32 v99, v34, v35
  v_mfma_f32_16x16x32_bf16 v[12:15], a[116:119], v[40:43], v[12:15]
  buffer_store_dwordx4 v[96:99], v100, s[8:11], s32 offen offset:1024
  v_mfma_f32_16x16x32_bf16 v[16:19], a[196:199], v[40:43], v[16:19]
  s_waitcnt lgkmcnt(2)
  v_mfma_f32_16x16x32_bf16 v[4:7], v[216:219], v[44:47], v[4:7]
  ds_read_b128 v[40:43], v103 offset:9216
  v_mfma_f32_16x16x32_bf16 v[8:11], a[40:43], v[44:47], v[8:11]
  s_add_u32 m0, s37, 0
  s_add_u32 s30, s34, 0
  buffer_load_dwordx4 v100, s[8:11], s30 offen offset:0 sc1 lds
  v_mfma_f32_16x16x32_bf16 v[12:15], a[120:123], v[44:47], v[12:15]
  v_mfma_f32_16x16x32_bf16 v[16:19], a[200:203], v[44:47], v[16:19]
  s_waitcnt lgkmcnt(2)
  v_mfma_f32_16x16x32_bf16 v[4:7], v[220:223], v[48:51], v[4:7]
  ds_read_b128 v[44:47], v103 offset:10240
  v_mfma_f32_16x16x32_bf16 v[8:11], a[44:47], v[48:51], v[8:11]
  buffer_load_dwordx4 v100, s[8:11], s30 offen offset:1024 sc1 lds
  v_mfma_f32_16x16x32_bf16 v[12:15], a[124:127], v[48:51], v[12:15]
  v_mfma_f32_16x16x32_bf16 v[16:19], a[204:207], v[48:51], v[16:19]
  s_waitcnt lgkmcnt(2)
  v_mfma_f32_16x16x32_bf16 v[4:7], v[224:227], v[36:39], v[4:7]
  ds_read_b128 v[48:51], v103 offset:11264
  v_mfma_f32_16x16x32_bf16 v[8:11], a[48:51], v[36:39], v[8:11]
  buffer_load_dwordx4 v100, s[8:11], s30 offen offset:2048 sc1 lds
  v_mfma_f32_16x16x32_bf16 v[12:15], a[128:131], v[36:39], v[12:15]
  v_mfma_f32_16x16x32_bf16 v[16:19], a[208:211], v[36:39], v[16:19]
  s_waitcnt lgkmcnt(2)
  v_mfma_f32_16x16x32_bf16 v[4:7], v[228:231], v[40:43], v[4:7]
  ds_read_b128 v[36:39], v103 offset:12288
  v_mfma_f32_16x16x32_bf16 v[8:11], a[52:55], v[40:43], v[8:11]
  buffer_load_dwordx4 v100, s[8:11], s30 offen offset:3072 sc1 lds
  v_mfma_f32_16x16x32_bf16 v[12:15], a[132:135], v[40:43], v[12:15]
  v_mfma_f32_16x16x32_bf16 v[16:19], a[212:215], v[40:43], v[16:19]
  s_waitcnt lgkmcnt(2)
  v_mfma_f32_16x16x32_bf16 v[4:7], v[232:235], v[44:47], v[4:7]
  ds_read_b128 v[40:43], v103 offset:13312
  v_mfma_f32_16x16x32_bf16 v[8:11], a[56:59], v[44:47], v[8:11]
  s_add_u32 m0, s37, 4096
  s_add_u32 s30, s34, 4096
  buffer_load_dwordx4 v100, s[8:11], s30 offen offset:0 sc1 lds
  v_mfma_f32_16x16x32_bf16 v[12:15], a[136:139], v[44:47], v[12:15]
  v_mfma_f32_16x16x32_bf16 v[16:19], a[216:219], v[44:47], v[16:19]
  s_waitcnt lgkmcnt(2)
  v_mfma_f32_16x16x32_bf16 v[4:7], v[236:239], v[48:51], v[4:7]
  ds_read_b128 v[44:47], v103 offset:14336
  v_mfma_f32_16x16x32_bf16 v[8:11], a[60:63], v[48:51], v[8:11]
  buffer_load_dwordx4 v100, s[8:11], s30 offen offset:1024 sc1 lds
  v_mfma_f32_16x16x32_bf16 v[12:15], a[140:143], v[48:51], v[12:15]
  v_mfma_f32_16x16x32_bf16 v[16:19], a[220:223], v[48:51], v[16:19]
  s_waitcnt lgkmcnt(2)
  v_mfma_f32_16x16x32_bf16 v[4:7], v[240:243], v[36:39], v[4:7]
  ds_read_b128 v[48:51], v103 offset:15360
  v_mfma_f32_16x16x32_bf16 v[8:11], a[64:67], v[36:39], v[8:11]
  buffer_load_dwordx4 v100, s[8:11], s30 offen offset:2048 sc1 lds
  v_mfma_f32_16x16x32_bf16 v[12:15], a[144:147], v[36:39], v[12:15]
  v_mfma_f32_16x16x32_bf16 v[16:19], a[224:227], v[36:39], v[16:19]
  s_waitcnt lgkmcnt(2)
  v_mfma_f32_16x16x32_bf16 v[4:7], v[244:247], v[40:43], v[4:7]
  ds_read_b128 v[36:39], v103 offset:16384
  v_mfma_f32_16x16x32_bf16 v[8:11], a[68:71], v[40:43], v[8:11]
  buffer_load_dwordx4 v100, s[8:11], s30 offen offset:3072 sc1 lds
  v_mfma_f32_16x16x32_bf16 v[12:15], a[148:151], v[40:43], v[12:15]
  v_mfma_f32_16x16x32_bf16 v[16:19], a[228:231], v[40:43], v[16:19]
  s_waitcnt lgkmcnt(2)
  v_mfma_f32_16x16x32_bf16 v[4:7], v[248:251], v[44:47], v[4:7]
  ds_read_b128 v[40:43], v103 offset:17408
  v_mfma_f32_16x16x32_bf16 v[8:11], a[72:75], v[44:47], v[8:11]
  s_add_u32 m0, s37, 8192
  s_add_u32 s30, s34, 8192
  buffer_load_dwordx4 v100, s[8:11], s30 offen offset:0 sc1 lds
  v_mfma_f32_16x16x32_bf16 v[12:15], a[152:155], v[44:47], v[12:15]
  v_mfma_f32_16x16x32_bf16 v[16:19], a[232:235], v[44:47], v[16:19]
  s_waitcnt lgkmcnt(2)
  v_mfma_f32_16x16x32_bf16 v[4:7], v[252:255], v[48:51], v[4:7]
  ds_read_b128 v[44:47], v103 offset:18432
  v_mfma_f32_16x16x32_bf16 v[8:11], a[76:79], v[48:51], v[8:11]
  buffer_load_dwordx4 v100, s[8:11], s30 offen offset:1024 sc1 lds
  v_mfma_f32_16x16x32_bf16 v[12:15], a[156:159], v[48:51], v[12:15]
  v_mfma_f32_16x16x32_bf16 v[16:19], a[236:239], v[48:51], v[16:19]
  s_waitcnt lgkmcnt(2)
  v_mfma_f32_16x16x32_bf16 v[4:7], a[0:3], v[36:39], v[4:7]
  ds_read_b128 v[48:51], v103 offset:19456
  v_mfma_f32_16x16x32_bf16 v[8:11], a[80:83], v[36:39], v[8:11]
  s_waitcnt vmcnt(10)
  v_mfma_f32_16x16x32_bf16 v[12:15], a[160:163], v[36:39], v[12:15]
  buffer_store_dword v109, v104, s[8:11], 0 offen
  v_mfma_f32_16x16x32_bf16 v[16:19], a[240:243], v[36:39], v[16:19]
  s_waitcnt lgkmcnt(2)
  v_mfma_f32_16x16x32_bf16 v[4:7], a[4:7], v[40:43], v[4:7]
  ds_read_b128 v[36:39], v103 offset:20480
  v_mfma_f32_16x16x32_bf16 v[8:11], a[84:87], v[40:43], v[8:11]
  buffer_load_dword v106, v105, s[8:11], 0 offen sc1
  v_mfma_f32_16x16x32_bf16 v[12:15], a[164:167], v[40:43], v[12:15]
  buffer_load_dword v111, v110, s[8:11], s39 offen sc1
  v_mfma_f32_16x16x32_bf16 v[16:19], a[244:247], v[40:43], v[16:19]
  s_waitcnt lgkmcnt(2)
  v_mfma_f32_16x16x32_bf16 v[4:7], a[8:11], v[44:47], v[4:7]
  ds_read_b128 v[40:43], v103 offset:21504
  v_mfma_f32_16x16x32_bf16 v[8:11], a[88:91], v[44:47], v[8:11]
  v_mfma_f32_16x16x32_bf16 v[12:15], a[168:171], v[44:47], v[12:15]
  v_mfma_f32_16x16x32_bf16 v[16:19], a[248:251], v[44:47], v[16:19]
  s_waitcnt lgkmcnt(2)
  v_mfma_f32_16x16x32_bf16 v[4:7], a[12:15], v[48:51], v[4:7]
  ds_read_b128 v[44:47], v103 offset:22528
  v_mfma_f32_16x16x32_bf16 v[8:11], a[92:95], v[48:51], v[8:11]
  v_mfma_f32_16x16x32_bf16 v[12:15], a[172:175], v[48:51], v[12:15]
  v_mfma_f32_16x16x32_bf16 v[16:19], a[252:255], v[48:51], v[16:19]
  s_waitcnt lgkmcnt(2)
  v_mfma_f32_16x16x32_bf16 v[20:23], v[192:195], v[36:39], 0
  ds_read_b128 v[48:51], v103 offset:23552
  v_mfma_f32_16x16x32_bf16 v[24:27], a[16:19], v[36:39], 0
  v_mfma_f32_16x16x32_bf16 v[28:31], a[96:99], v[36:39], 0
  v_mfma_f32_16x16x32_bf16 v[32:35], a[176:179], v[36:39], 0
  s_waitcnt lgkmcnt(2)
  v_mfma_f32_16x16x32_bf16 v[20:23], v[196:199], v[40:43], v[20:23]
  ds_read_b128 v[36:39], v103 offset:24576
  v_mfma_f32_16x16x32_bf16 v[24:27], a[20:23], v[40:43], v[24:27]
  v_cvt_pk_bf16_f32 v92, v4, v5
  v_mfma_f32_16x16x32_bf16 v[28:31], a[100:103], v[40:43], v[28:31]
  v_cvt_pk_bf16_f32 v93, v6, v7
  v_mfma_f32_16x16x32_bf16 v[32:35], a[180:183], v[40:43], v[32:35]
  s_waitcnt lgkmcnt(2)
  v_mfma_f32_16x16x32_bf16 v[20:23], v[200:203], v[44:47], v[20:23]
  ds_read_b128 v[40:43], v103 offset:25600
  v_mfma_f32_16x16x32_bf16 v[24:27], a[24:27], v[44:47], v[24:27]
  v_cvt_pk_bf16_f32 v94, v8, v9
  v_mfma_f32_16x16x32_bf16 v[28:31], a[104:107], v[44:47], v[28:31]
  v_cvt_pk_bf16_f32 v95, v10, v11
  v_mfma_f32_16x16x32_bf16 v[32:35], a[184:187], v[44:47], v[32:35]
  s_waitcnt lgkmcnt(2)
  v_mfma_f32_16x16x32_bf16 v[20:23], v[204:207], v[48:51], v[20:23]
  ds_read_b128 v[44:47], v103 offset:26624
  v_mfma_f32_16x16x32_bf16 v[24:27], a[28:31], v[48:51], v[24:27]
  buffer_store_dwordx4 v[92:95], v100, s[8:11], s35 offen offset:0
  v_mfma_f32_16x16x32_bf16 v[28:31], a[108:111], v[48:51], v[28:31]
  v_cvt_pk_bf16_f32 v96, v12, v13
  v_mfma_f32_16x16x32_bf16 v[32:35], a[188:191], v[48:51], v[32:35]
  s_waitcnt lgkmcnt(2)
  v_mfma_f32_16x16x32_bf16 v[20:23], v[208:211], v[36:39], v[20:23]
  ds_read_b128 v[48:51], v103 offset:27648
  v_mfma_f32_16x16x32_bf16 v[24:27], a[32:35], v[36:39], v[24:27]
  v_cvt_pk_bf16_f32 v97, v14, v15
  v_mfma_f32_16x16x32_bf16 v[28:31], a[112:115], v[36:39], v[28:31]
  v_cvt_pk_bf16_f32 v98, v16, v17
  v_mfma_f32_16x16x32_bf16 v[32:35], a[192:195], v[36:39], v[32:35]
  s_waitcnt lgkmcnt(2)
  v_mfma_f32_16x16x32_bf16 v[20:23], v[212:215], v[40:43], v[20:23]
  ds_read_b128 v[36:39], v103 offset:28672
  v_mfma_f32_16x16x32_bf16 v[24:27], a[36:39], v[40:43], v[24:27]
  v_cvt_pk_bf16_f32 v99, v18, v19
  v_mfma_f32_16x16x32_bf16 v[28:31], a[116:119], v[40:43], v[28:31]
  buffer_store_dwordx4 v[96:99], v100, s[8:11], s35 offen offset:1024
  v_mfma_f32_16x16x32_bf16 v[32:35], a[196:199], v[40:43], v[32:35]
  s_waitcnt lgkmcnt(2)
  v_mfma_f32_16x16x32_bf16 v[20:23], v[216:219], v[44:47], v[20:23]
  ds_read_b128 v[40:43], v103 offset:29696
  v_mfma_f32_16x16x32_bf16 v[24:27], a[40:43], v[44:47], v[24:27]
  v_mfma_f32_16x16x32_bf16 v[28:31], a[120:123], v[44:47], v[28:31]
  v_mfma_f32_16x16x32_bf16 v[32:35], a[200:203], v[44:47], v[32:35]
  s_waitcnt lgkmcnt(2)
  v_mfma_f32_16x16x32_bf16 v[20:23], v[220:223], v[48:51], v[20:23]
  ds_read_b128 v[44:47], v103 offset:30720
  v_mfma_f32_16x16x32_bf16 v[24:27], a[44:47], v[48:51], v[24:27]
  v_mfma_f32_16x16x32_bf16 v[28:31], a[124:127], v[48:51], v[28:31]
  v_mfma_f32_16x16x32_bf16 v[32:35], a[204:207], v[48:51], v[32:35]
  s_waitcnt lgkmcnt(2)
  v_mfma_f32_16x16x32_bf16 v[20:23], v[224:227], v[36:39], v[20:23]
  ds_read_b128 v[48:51], v103 offset:31744
  v_mfma_f32_16x16x32_bf16 v[24:27], a[48:51], v[36:39], v[24:27]
  v_mfma_f32_16x16x32_bf16 v[28:31], a[128:131], v[36:39], v[28:31]
  v_mfma_f32_16x16x32_bf16 v[32:35], a[208:211], v[36:39], v[32:35]
  s_waitcnt lgkmcnt(2)
  v_mfma_f32_16x16x32_bf16 v[20:23], v[228:231], v[40:43], v[20:23]
  ds_read_b128 v[36:39], v103 offset:32768
  v_mfma_f32_16x16x32_bf16 v[24:27], a[52:55], v[40:43], v[24:27]
  v_mfma_f32_16x16x32_bf16 v[28:31], a[132:135], v[40:43], v[28:31]
  v_mfma_f32_16x16x32_bf16 v[32:35], a[212:215], v[40:43], v[32:35]
  s_waitcnt lgkmcnt(2)
  v_mfma_f32_16x16x32_bf16 v[20:23], v[232:235], v[44:47], v[20:23]
  ds_read_b128 v[40:43], v103 offset:33792
  v_mfma_f32_16x16x32_bf16 v[24:27], a[56:59], v[44:47], v[24:27]
  v_mfma_f32_16x16x32_bf16 v[28:31], a[136:139], v[44:47], v[28:31]
  v_mfma_f32_16x16x32_bf16 v[32:35], a[216:219], v[44:47], v[32:35]
  s_waitcnt lgkmcnt(2)
  v_mfma_f32_16x16x32_bf16 v[20:23], v[236:239], v[48:51], v[20:23]
  ds_read_b128 v[44:47], v103 offset:34816
  v_mfma_f32_16x16x32_bf16 v[24:27], a[60:63], v[48:51], v[24:27]
  v_mfma_f32_16x16x32_bf16 v[28:31], a[140:143], v[48:51], v[28:31]
  v_mfma_f32_16x16x32_bf16 v[32:35], a[220:223], v[48:51], v[32:35]
  s_waitcnt lgkmcnt(2)
  v_mfma_f32_16x16x32_bf16 v[20:23], v[240:243], v[36:39], v[20:23]
  ds_read_b128 v[48:51], v103 offset:35840
  v_mfma_f32_16x16x32_bf16 v[24:27], a[64:67], v[36:39], v[24:27]
  v_mfma_f32_16x16x32_bf16 v[28:31], a[144:147], v[36:39], v[28:31]
  v_mfma_f32_16x16x32_bf16 v[32:35], a[224:227], v[36:39], v[32:35]
  s_waitcnt lgkmcnt(2)
  v_mfma_f32_16x16x32_bf16 v[20:23], v[244:247], v[40:43], v[20:23]
  ds_read_b128 v[36:39], v103 offset:36864
  v_mfma_f32_16x16x32_bf16 v[24:27], a[68:71], v[40:43], v[24:27]
  v_mfma_f32_16x16x32_bf16 v[28:31], a[148:151], v[40:43], v[28:31]
  v_mfma_f32_16x16x32_bf16 v[32:35], a[228:231], v[40:43], v[32:35]
  s_waitcnt lgkmcnt(2)
  v_mfma_f32_16x16x32_bf16 v[20:23], v[248:251], v[44:47], v[20:23]
  ds_read_b128 v[40:43], v103 offset:37888
  v_mfma_f32_16x16x32_bf16 v[24:27], a[72:75], v[44:47], v[24:27]
  v_mfma_f32_16x16x32_bf16 v[28:31], a[152:155], v[44:47], v[28:31]
  v_mfma_f32_16x16x32_bf16 v[32:35], a[232:235], v[44:47], v[32:35]
  s_waitcnt lgkmcnt(2)
  v_mfma_f32_16x16x32_bf16 v[20:23], v[252:255], v[48:51], v[20:23]
  ds_read_b128 v[44:47], v103 offset:38912
  v_mfma_f32_16x16x32_bf16 v[24:27], a[76:79], v[48:51], v[24:27]
  v_mfma_f32_16x16x32_bf16 v[28:31], a[156:159], v[48:51], v[28:31]
  v_mfma_f32_16x16x32_bf16 v[32:35], a[236:239], v[48:51], v[32:35]
  s_waitcnt lgkmcnt(2)
  v_mfma_f32_16x16x32_bf16 v[20:23], a[0:3], v[36:39], v[20:23]
  ds_read_b128 v[48:51], v103 offset:39936
  v_mfma_f32_16x16x32_bf16 v[24:27], a[80:83], v[36:39], v[24:27]
  v_mfma_f32_16x16x32_bf16 v[28:31], a[160:163], v[36:39], v[28:31]
  v_mfma_f32_16x16x32_bf16 v[32:35], a[240:243], v[36:39], v[32:35]
  s_waitcnt lgkmcnt(2)
  v_mfma_f32_16x16x32_bf16 v[20:23], a[4:7], v[40:43], v[20:23]
  v_mfma_f32_16x16x32_bf16 v[24:27], a[84:87], v[40:43], v[24:27]
  v_mfma_f32_16x16x32_bf16 v[28:31], a[164:167], v[40:43], v[28:31]
  v_mfma_f32_16x16x32_bf16 v[32:35], a[244:247], v[40:43], v[32:35]
  s_waitcnt lgkmcnt(1)
  v_mfma_f32_16x16x32_bf16 v[20:23], a[8:11], v[44:47], v[20:23]
  v_mfma_f32_16x16x32_bf16 v[24:27], a[88:91], v[44:47], v[24:27]
  v_mfma_f32_16x16x32_bf16 v[28:31], a[168:171], v[44:47], v[28:31]
  v_mfma_f32_16x16x32_bf16 v[32:35], a[248:251], v[44:47], v[32:35]
  s_waitcnt lgkmcnt(0)
  v_mfma_f32_16x16x32_bf16 v[20:23], a[12:15], v[48:51], v[20:23]
  v_mfma_f32_16x16x32_bf16 v[24:27], a[92:95], v[48:51], v[24:27]
  v_mfma_f32_16x16x32_bf16 v[28:31], a[172:175], v[48:51], v[28:31]
  v_mfma_f32_16x16x32_bf16 v[32:35], a[252:255], v[48:51], v[32:35]
  s_xor_b32 s37, s37, 0x10000
  v_xor_b32 v103, 0x10000, v103
  s_add_u32 s28, s28, 1
  s_sub_u32 s30, s28, 3
  s_cmp_lt_u32 s30, 61
  s_cbranch_scc0 p_now
  s_waitcnt vmcnt(2) lgkmcnt(0)
  s_barrier
  s_branch p_loop
p_now:
  s_add_u32 s32, s35, 6144
  v_cvt_pk_bf16_f32 v92, v20, v21
  v_cvt_pk_bf16_f32 v93, v22, v23
  v_cvt_pk_bf16_f32 v94, v24, v25
  v_cvt_pk_bf16_f32 v95, v26, v27
  buffer_store_dwordx4 v[92:95], v100, s[8:11], s32 offen offset:0
  v_cvt_pk_bf16_f32 v96, v28, v29
  v_cvt_pk_bf16_f32 v97, v30, v31
  v_cvt_pk_bf16_f32 v98, v32, v33
  v_cvt_pk_bf16_f32 v99, v34, v35
  buffer_store_dwordx4 v[96:99], v100, s[8:11], s32 offen offset:1024
  v_mov_b32 v109, s28
  s_waitcnt vmcnt(0)
  buffer_store_dword v109, v104, s[8:11], 0 offen
  s_cmp_lt_u32 s28, 64
  s_barrier
  s_cbranch_scc1 p_loop
  s_endpgm
role_ua:
  s_load_dwordx2 s[20:21], s[0:1], 40
  s_mov_b32 s22, 7864320
  s_mov_b32 s23, 0x00020000
  s_load_dwordx2 s[88:89], s[0:1], 96
  s_mov_b32 s90, 1280
  s_mov_b32 s91, 0x00020000
  s_load_dwordx2 s[92:93], s[0:1], 104
  s_mov_b32 s94, 4915200
  s_mov_b32 s95, 0x00020000
  s_mul_i32 s24, s16, 5
  s_add_u32 s24, s24, s18
  s_sub_u32 s24, s24, 21
  s_cmp_ge_u32 s24, 20
  s_cbranch_scc1 ua_nm
  s_waitcnt lgkmcnt(0)
  v_lshlrev_b32 v12, 2, v0
  buffer_load_dword v13, v12, s[88:91], 0 offen
  buffer_load_dword v14, v12, s[88:91], 0 offen offset:1024
  v_lshrrev_b32 v20, 3, v0
  v_and_b32 v21, 7, v0
  v_mul_u32_u24 v22, 153600, v20
  v_lshl_add_u32 v22, v21, 4, v22
  s_lshl_b32 s6, s24, 7
  buffer_load_dwordx4 v[28:31], v22, s[92:95], s6 offen nt
  s_add_u32 s6, s6, 7680
  buffer_load_dwordx4 v[32:35], v22, s[92:95], s6 offen nt
  s_add_u32 s6, s6, 7680
  buffer_load_dwordx4 v[36:39], v22, s[92:95], s6 offen nt
  s_add_u32 s6, s6, 7680
  buffer_load_dwordx4 v[40:43], v22, s[92:95], s6 offen nt
  s_add_u32 s6, s6, 7680
  buffer_load_dwordx4 v[44:47], v22, s[92:95], s6 offen nt
  s_add_u32 s6, s6, 7680
  buffer_load_dwordx4 v[48:51], v22, s[92:95], s6 offen nt
  s_add_u32 s6, s6, 7680
  buffer_load_dwordx4 v[52:55], v22, s[92:95], s6 offen nt
  s_add_u32 s6, s6, 7680
  buffer_load_dwordx4 v[56:59], v22, s[92:95], s6 offen nt
  s_add_u32 s6, s6, 7680
  buffer_load_dwordx4 v[60:63], v22, s[92:95], s6 offen nt
  s_add_u32 s6, s6, 7680
  buffer_load_dwordx4 v[64:67], v22, s[92:95], s6 offen nt
  s_add_u32 s6, s6, 7680
  buffer_load_dwordx4 v[68:71], v22, s[92:95], s6 offen nt
  s_add_u32 s6, s6, 7680
  buffer_load_dwordx4 v[72:75], v22, s[92:95], s6 offen nt
  s_add_u32 s6, s6, 7680
  buffer_load_dwordx4 v[76:79], v22, s[92:95], s6 offen nt
  s_add_u32 s6, s6, 7680
  buffer_load_dwordx4 v[80:83], v22, s[92:95], s6 offen nt
  s_add_u32 s6, s6, 7680
  buffer_load_dwordx4 v[84:87], v22, s[92:95], s6 offen nt
  s_add_u32 s6, s6, 7680
  buffer_load_dwordx4 v[88:91], v22, s[92:95], s6 offen nt
  s_add_u32 s6, s6, 7680
  buffer_load_dwordx4 v[92:95], v22, s[92:95], s6 offen nt
  s_add_u32 s6, s6, 7680
  buffer_load_dwordx4 v[96:99], v22, s[92:95], s6 offen nt
  s_add_u32 s6, s6, 7680
  buffer_load_dwordx4 v[100:103], v22, s[92:95], s6 offen nt
  s_add_u32 s6, s6, 7680
  buffer_load_dwordx4 v[104:107], v22, s[92:95], s6 offen nt
  s_add_u32 s6, s6, 7680
  s_waitcnt vmcnt(20)
  v_lshlrev_b32 v24, 16, v13
  v_and_b32 v25, 0xffff0000, v13
  v_mul_f32 v16, 0xbfb8aa3b, v24
  v_mul_f32 v17, 0xbfb8aa3b, v25
  v_exp_f32 v16, v16
  v_exp_f32 v17, v17
  v_add_f32 v16, 1.0, v16
  v_add_f32 v17, 1.0, v17
  v_rcp_f32 v16, v16
  v_rcp_f32 v17, v17
  v_mul_f32 v24, v24, v16
  v_mul_f32 v25, v25, v17
  v_cvt_pk_bf16_f32 v16, v24, v25
  v_lshlrev_b32 v24, 16, v16
  v_and_b32 v25, 0xffff0000, v16
  v_lshlrev_b32 v26, 16, v14
  v_and_b32 v27, 0xffff0000, v14
  v_mul_f32 v16, 0xbfb8aa3b, v26
  v_mul_f32 v17, 0xbfb8aa3b, v27
  v_exp_f32 v16, v16
  v_exp_f32 v17, v17
  v_add_f32 v16, 1.0, v16
  v_add_f32 v17, 1.0, v17
  v_rcp_f32 v16, v16
  v_rcp_f32 v17, v17
  v_mul_f32 v26, v26, v16
  v_mul_f32 v27, v27, v17
  v_cvt_pk_bf16_f32 v16, v26, v27
  v_lshlrev_b32 v26, 16, v16
  v_and_b32 v27, 0xffff0000, v16
  v_lshlrev_b32 v12, 3, v0
  ds_write_b64 v12, v[24:25]
  ds_write_b64 v12, v[26:27] offset:2048
  v_mul_u32_u24 v12, 80, v20
  s_waitcnt lgkmcnt(0)
  s_barrier
  ds_read_b128 v[108:111], v12 offset:0
  ds_read_b128 v[112:115], v12 offset:16
  ds_read_b128 v[116:119], v12 offset:32
  ds_read_b128 v[120:123], v12 offset:48
  ds_read_b128 v[124:127], v12 offset:64
  v_mov_b32 v148, 0
  v_mov_b32 v149, 0
  v_mov_b32 v150, 0
  v_mov_b32 v151, 0
  v_mov_b32 v152, 0
  v_mov_b32 v153, 0
  v_mov_b32 v154, 0
  v_mov_b32 v155, 0
  s_waitcnt lgkmcnt(0)
  v_lshrrev_b32 v128, 16, v108
  v_lshrrev_b32 v129, 16, v109
  v_lshrrev_b32 v130, 16, v110
  v_lshrrev_b32 v131, 16, v111
  v_lshrrev_b32 v132, 16, v112
  v_lshrrev_b32 v133, 16, v113
  v_lshrrev_b32 v134, 16, v114
  v_lshrrev_b32 v135, 16, v115
  v_lshrrev_b32 v136, 16, v116
  v_lshrrev_b32 v137, 16, v117
  v_lshrrev_b32 v138, 16, v118
  v_lshrrev_b32 v139, 16, v119
  v_lshrrev_b32 v140, 16, v120
  v_lshrrev_b32 v141, 16, v121
  v_lshrrev_b32 v142, 16, v122
  v_lshrrev_b32 v143, 16, v123
  v_lshrrev_b32 v144, 16, v124
  v_lshrrev_b32 v145, 16, v125
  v_lshrrev_b32 v146, 16, v126
  v_lshrrev_b32 v147, 16, v127
  s_waitcnt vmcnt(18)
  v_dot2c_f32_bf16 v148, v28, v128
  v_dot2c_f32_bf16 v149, v28, v108
  v_dot2c_f32_bf16 v150, v29, v128
  v_dot2c_f32_bf16 v151, v29, v108
  v_dot2c_f32_bf16 v152, v30, v128
  v_dot2c_f32_bf16 v153, v30, v108
  v_dot2c_f32_bf16 v154, v31, v128
  v_dot2c_f32_bf16 v155, v31, v108
  v_dot2c_f32_bf16 v148, v32, v129
  v_dot2c_f32_bf16 v149, v32, v109
  v_dot2c_f32_bf16 v150, v33, v129
  v_dot2c_f32_bf16 v151, v33, v109
  v_dot2c_f32_bf16 v152, v34, v129
  v_dot2c_f32_bf16 v153, v34, v109
  v_dot2c_f32_bf16 v154, v35, v129
  v_dot2c_f32_bf16 v155, v35, v109
  s_waitcnt vmcnt(16)
  v_dot2c_f32_bf16 v148, v36, v130
  v_dot2c_f32_bf16 v149, v36, v110
  v_dot2c_f32_bf16 v150, v37, v130
  v_dot2c_f32_bf16 v151, v37, v110
  v_dot2c_f32_bf16 v152, v38, v130
  v_dot2c_f32_bf16 v153, v38, v110
  v_dot2c_f32_bf16 v154, v39, v130
  v_dot2c_f32_bf16 v155, v39, v110
  v_dot2c_f32_bf16 v148, v40, v131
  v_dot2c_f32_bf16 v149, v40, v111
  v_dot2c_f32_bf16 v150, v41, v131
  v_dot2c_f32_bf16 v151, v41, v111
  v_dot2c_f32_bf16 v152, v42, v131
  v_dot2c_f32_bf16 v153, v42, v111
  v_dot2c_f32_bf16 v154, v43, v131
  v_dot2c_f32_bf16 v155, v43, v111
  s_waitcnt vmcnt(14)
  v_dot2c_f32_bf16 v148, v44, v132
  v_dot2c_f32_bf16 v149, v44, v112
  v_dot2c_f32_bf16 v150, v45, v132
  v_dot2c_f32_bf16 v151, v45, v112
  v_dot2c_f32_bf16 v152, v46, v132
  v_dot2c_f32_bf16 v153, v46, v112
  v_dot2c_f32_bf16 v154, v47, v132
  v_dot2c_f32_bf16 v155, v47, v112
  v_dot2c_f32_bf16 v148, v48, v133
  v_dot2c_f32_bf16 v149, v48, v113
  v_dot2c_f32_bf16 v150, v49, v133
  v_dot2c_f32_bf16 v151, v49, v113
  v_dot2c_f32_bf16 v152, v50, v133
  v_dot2c_f32_bf16 v153, v50, v113
  v_dot2c_f32_bf16 v154, v51, v133
  v_dot2c_f32_bf16 v155, v51, v113
  s_waitcnt vmcnt(12)
  v_dot2c_f32_bf16 v148, v52, v134
  v_dot2c_f32_bf16 v149, v52, v114
  v_dot2c_f32_bf16 v150, v53, v134
  v_dot2c_f32_bf16 v151, v53, v114
  v_dot2c_f32_bf16 v152, v54, v134
  v_dot2c_f32_bf16 v153, v54, v114
  v_dot2c_f32_bf16 v154, v55, v134
  v_dot2c_f32_bf16 v155, v55, v114
  v_dot2c_f32_bf16 v148, v56, v135
  v_dot2c_f32_bf16 v149, v56, v115
  v_dot2c_f32_bf16 v150, v57, v135
  v_dot2c_f32_bf16 v151, v57, v115
  v_dot2c_f32_bf16 v152, v58, v135
  v_dot2c_f32_bf16 v153, v58, v115
  v_dot2c_f32_bf16 v154, v59, v135
  v_dot2c_f32_bf16 v155, v59, v115
  s_waitcnt vmcnt(10)
  v_dot2c_f32_bf16 v148, v60, v136
  v_dot2c_f32_bf16 v149, v60, v116
  v_dot2c_f32_bf16 v150, v61, v136
  v_dot2c_f32_bf16 v151, v61, v116
  v_dot2c_f32_bf16 v152, v62, v136
  v_dot2c_f32_bf16 v153, v62, v116
  v_dot2c_f32_bf16 v154, v63, v136
  v_dot2c_f32_bf16 v155, v63, v116
  v_dot2c_f32_bf16 v148, v64, v137
  v_dot2c_f32_bf16 v149, v64, v117
  v_dot2c_f32_bf16 v150, v65, v137
  v_dot2c_f32_bf16 v151, v65, v117
  v_dot2c_f32_bf16 v152, v66, v137
  v_dot2c_f32_bf16 v153, v66, v117
  v_dot2c_f32_bf16 v154, v67, v137
  v_dot2c_f32_bf16 v155, v67, v117
  s_waitcnt vmcnt(8)
  v_dot2c_f32_bf16 v148, v68, v138
  v_dot2c_f32_bf16 v149, v68, v118
  v_dot2c_f32_bf16 v150, v69, v138
  v_dot2c_f32_bf16 v151, v69, v118
  v_dot2c_f32_bf16 v152, v70, v138
  v_dot2c_f32_bf16 v153, v70, v118
  v_dot2c_f32_bf16 v154, v71, v138
  v_dot2c_f32_bf16 v155, v71, v118
  v_dot2c_f32_bf16 v148, v72, v139
  v_dot2c_f32_bf16 v149, v72, v119
  v_dot2c_f32_bf16 v150, v73, v139
  v_dot2c_f32_bf16 v151, v73, v119
  v_dot2c_f32_bf16 v152, v74, v139
  v_dot2c_f32_bf16 v153, v74, v119
  v_dot2c_f32_bf16 v154, v75, v139
  v_dot2c_f32_bf16 v155, v75, v119
  s_waitcnt vmcnt(6)
  v_dot2c_f32_bf16 v148, v76, v140
  v_dot2c_f32_bf16 v149, v76, v120
  v_dot2c_f32_bf16 v150, v77, v140
  v_dot2c_f32_bf16 v151, v77, v120
  v_dot2c_f32_bf16 v152, v78, v140
  v_dot2c_f32_bf16 v153, v78, v120
  v_dot2c_f32_bf16 v154, v79, v140
  v_dot2c_f32_bf16 v155, v79, v120
  v_dot2c_f32_bf16 v148, v80, v141
  v_dot2c_f32_bf16 v149, v80, v121
  v_dot2c_f32_bf16 v150, v81, v141
  v_dot2c_f32_bf16 v151, v81, v121
  v_dot2c_f32_bf16 v152, v82, v141
  v_dot2c_f32_bf16 v153, v82, v121
  v_dot2c_f32_bf16 v154, v83, v141
  v_dot2c_f32_bf16 v155, v83, v121
  s_waitcnt vmcnt(4)
  v_dot2c_f32_bf16 v148, v84, v142
  v_dot2c_f32_bf16 v149, v84, v122
  v_dot2c_f32_bf16 v150, v85, v142
  v_dot2c_f32_bf16 v151, v85, v122
  v_dot2c_f32_bf16 v152, v86, v142
  v_dot2c_f32_bf16 v153, v86, v122
  v_dot2c_f32_bf16 v154, v87, v142
  v_dot2c_f32_bf16 v155, v87, v122
  v_dot2c_f32_bf16 v148, v88, v143
  v_dot2c_f32_bf16 v149, v88, v123
  v_dot2c_f32_bf16 v150, v89, v143
  v_dot2c_f32_bf16 v151, v89, v123
  v_dot2c_f32_bf16 v152, v90, v143
  v_dot2c_f32_bf16 v153, v90, v123
  v_dot2c_f32_bf16 v154, v91, v143
  v_dot2c_f32_bf16 v155, v91, v123
  s_waitcnt vmcnt(2)
  v_dot2c_f32_bf16 v148, v92, v144
  v_dot2c_f32_bf16 v149, v92, v124
  v_dot2c_f32_bf16 v150, v93, v144
  v_dot2c_f32_bf16 v151, v93, v124
  v_dot2c_f32_bf16 v152, v94, v144
  v_dot2c_f32_bf16 v153, v94, v124
  v_dot2c_f32_bf16 v154, v95, v144
  v_dot2c_f32_bf16 v155, v95, v124
  v_dot2c_f32_bf16 v148, v96, v145
  v_dot2c_f32_bf16 v149, v96, v125
  v_dot2c_f32_bf16 v150, v97, v145
  v_dot2c_f32_bf16 v151, v97, v125
  v_dot2c_f32_bf16 v152, v98, v145
  v_dot2c_f32_bf16 v153, v98, v125
  v_dot2c_f32_bf16 v154, v99, v145
  v_dot2c_f32_bf16 v155, v99, v125
  s_waitcnt vmcnt(0)
  v_dot2c_f32_bf16 v148, v100, v146
  v_dot2c_f32_bf16 v149, v100, v126
  v_dot2c_f32_bf16 v150, v101, v146
  v_dot2c_f32_bf16 v151, v101, v126
  v_dot2c_f32_bf16 v152, v102, v146
  v_dot2c_f32_bf16 v153, v102, v126
  v_dot2c_f32_bf16 v154, v103, v146
  v_dot2c_f32_bf16 v155, v103, v126
  v_dot2c_f32_bf16 v148, v104, v147
  v_dot2c_f32_bf16 v149, v104, v127
  v_dot2c_f32_bf16 v150, v105, v147
  v_dot2c_f32_bf16 v151, v105, v127
  v_dot2c_f32_bf16 v152, v106, v147
  v_dot2c_f32_bf16 v153, v106, v127
  v_dot2c_f32_bf16 v154, v107, v147
  v_dot2c_f32_bf16 v155, v107, v127
  v_lshlrev_b32 v12, 5, v0
  ds_write_b128 v12, v[148:151] offset:4096
  s_nop 0
  ds_write_b128 v12, v[152:155] offset:4112
  v_lshlrev_b32 v12, 2, v0
  s_waitcnt lgkmcnt(0)
  s_barrier
  s_cmp_lg_u32 s17, 0
  s_cbranch_scc1 mod_enda
  ds_read2st64_b32 v[28:29], v12 offset0:16 offset1:17
  ds_read2st64_b32 v[30:31], v12 offset0:18 offset1:19
  ds_read2st64_b32 v[32:33], v12 offset0:20 offset1:21
  ds_read2st64_b32 v[34:35], v12 offset0:22 offset1:23
  ds_read2st64_b32 v[36:37], v12 offset0:24 offset1:25
  ds_read2st64_b32 v[38:39], v12 offset0:26 offset1:27
  ds_read2st64_b32 v[40:41], v12 offset0:28 offset1:29
  ds_read2st64_b32 v[42:43], v12 offset0:30 offset1:31
  ds_read2st64_b32 v[44:45], v12 offset0:32 offset1:33
  ds_read2st64_b32 v[46:47], v12 offset0:34 offset1:35
  ds_read2st64_b32 v[48:49], v12 offset0:36 offset1:37
  ds_read2st64_b32 v[50:51], v12 offset0:38 offset1:39
  ds_read2st64_b32 v[52:53], v12 offset0:40 offset1:41
  ds_read2st64_b32 v[54:55], v12 offset0:42 offset1:43
  ds_read2st64_b32 v[56:57], v12 offset0:44 offset1:45
  ds_read2st64_b32 v[58:59], v12 offset0:46 offset1:47
  s_waitcnt lgkmcnt(11)
  v_pk_add_f32 v[28:29], v[28:29], v[30:31]
  v_pk_add_f32 v[28:29], v[28:29], v[32:33]
  v_pk_add_f32 v[28:29], v[28:29], v[34:35]
  v_pk_add_f32 v[28:29], v[28:29], v[36:37]
  s_waitcnt lgkmcnt(7)
  v_pk_add_f32 v[28:29], v[28:29], v[38:39]
  v_pk_add_f32 v[28:29], v[28:29], v[40:41]
  v_pk_add_f32 v[28:29], v[28:29], v[42:43]
  v_pk_add_f32 v[28:29], v[28:29], v[44:45]
  s_waitcnt lgkmcnt(3)
  v_pk_add_f32 v[28:29], v[28:29], v[46:47]
  v_pk_add_f32 v[28:29], v[28:29], v[48:49]
  v_pk_add_f32 v[28:29], v[28:29], v[50:51]
  v_pk_add_f32 v[28:29], v[28:29], v[52:53]
  s_waitcnt lgkmcnt(0)
  v_pk_add_f32 v[28:29], v[28:29], v[54:55]
  v_pk_add_f32 v[28:29], v[28:29], v[56:57]
  v_pk_add_f32 v[28:29], v[28:29], v[58:59]
  v_add_f32 v28, v28, v29
  v_cvt_pk_bf16_f32 v28, v28, v28
  v_lshlrev_b32 v28, 16, v28
  s_lshl_b32 s6, s24, 8
  s_add_u32 s6, s6, 65536
  buffer_store_dword v28, v12, s[8:11], s6 offen sc1
  v_mov_b32 v16, 200
  v_mov_b32 v17, 1
  s_waitcnt vmcnt(0)
  s_mov_b64 exec, 1
  buffer_atomic_add v17, v16, s[12:15], 0 offen sc1
  s_mov_b64 exec, -1
mod_enda:
  s_barrier
  s_branch ua_md
ua_nm:
ua_md:
  s_sub_u32 s24, s18, 21
  s_lshl_b32 s25, s16, 2
  s_add_u32 s25, s25, s17
  s_lshl_b32 s35, s24, 2
  s_add_u32 s35, s35, s17
  s_lshl_b32 s30, s16, 22
  s_mul_i32 s51, s17, 40960
  s_lshl_b32 s28, s24, 13
  s_add_u32 s51, s51, s28
  s_add_u32 s51, s51, s30
  s_add_u32 s51, s51, 68288512
  s_add_u32 s28, s51, 227328
  v_lshlrev_b32 v209, 7, v1
  v_lshrrev_b32 v206, 4, v1
  v_and_b32 v206, 3, v206
  v_lshlrev_b32 v206, 1, v206
  v_and_b32 v4, 7, v1
  v_xor_b32 v4, v4, v206
  v_lshlrev_b32 v4, 4, v4
  v_lshrrev_b32 v206, 3, v1
  v_mul_u32_u24 v206, 1280, v206
  v_add_u32 v4, v4, v206
  s_mul_i32 s31, s17, 40960
  v_lshrrev_b32 v206, 2, v1
  v_lshrrev_b32 v207, 1, v206
  v_and_b32 v207, 3, v207
  v_lshlrev_b32 v207, 1, v207
  v_bfe_u32 v220, v1, 1, 1
  v_add_u32 v220, 0, v220
  v_xor_b32 v220, v220, v207
  v_lshlrev_b32 v220, 4, v220
  v_lshlrev_b32 v206, 7, v206
  v_add_u32 v220, v220, v206
  v_and_b32 v206, 1, v1
  v_lshlrev_b32 v206, 3, v206
  v_add_u32 v220, v220, v206
  v_add_u32 v220, s31, v220
  v_lshrrev_b32 v206, 2, v1
  v_lshrrev_b32 v207, 1, v206
  v_and_b32 v207, 3, v207
  v_lshlrev_b32 v207, 1, v207
  v_bfe_u32 v221, v1, 1, 1
  v_add_u32 v221, 2, v221
  v_xor_b32 v221, v221, v207
  v_lshlrev_b32 v221, 4, v221
  v_lshlrev_b32 v206, 7, v206
  v_add_u32 v221, v221, v206
  v_and_b32 v206, 1, v1
  v_lshlrev_b32 v206, 3, v206
  v_add_u32 v221, v221, v206
  v_add_u32 v221, s31, v221
  v_lshrrev_b32 v206, 2, v1
  v_lshrrev_b32 v207, 1, v206
  v_and_b32 v207, 3, v207
  v_lshlrev_b32 v207, 1, v207
  v_bfe_u32 v222, v1, 1, 1
  v_add_u32 v222, 4, v222
  v_xor_b32 v222, v222, v207
  v_lshlrev_b32 v222, 4, v222
  v_lshlrev_b32 v206, 7, v206
  v_add_u32 v222, v222, v206
  v_and_b32 v206, 1, v1
  v_lshlrev_b32 v206, 3, v206
  v_add_u32 v222, v222, v206
  v_add_u32 v222, s31, v222
  v_lshrrev_b32 v206, 2, v1
  v_lshrrev_b32 v207, 1, v206
  v_and_b32 v207, 3, v207
  v_lshlrev_b32 v207, 1, v207
  v_bfe_u32 v223, v1, 1, 1
  v_add_u32 v223, 6, v223
  v_xor_b32 v223, v223, v207
  v_lshlrev_b32 v223, 4, v223
  v_lshlrev_b32 v206, 7, v206
  v_add_u32 v223, v223, v206
  v_and_b32 v206, 1, v1
  v_lshlrev_b32 v206, 3, v206
  v_add_u32 v223, v223, v206
  v_add_u32 v223, s31, v223
  s_mul_i32 s30, s25, 245760
  s_lshl_b32 s28, s24, 8
  s_add_u32 s30, s30, s28
  s_waitcnt lgkmcnt(0)
  s_add_u32 m0, s31, 0
  s_add_u32 s28, s30, 0
  buffer_load_dwordx4 v4, s[20:23], s28 offen nt lds
  s_add_u32 m0, s31, 1024
  s_add_u32 s28, s30, 10240
  buffer_load_dwordx4 v4, s[20:23], s28 offen nt lds
  s_add_u32 m0, s31, 2048
  s_add_u32 s28, s30, 20480
  buffer_load_dwordx4 v4, s[20:23], s28 offen nt lds
  s_add_u32 m0, s31, 3072
  s_add_u32 s28, s30, 30720
  buffer_load_dwordx4 v4, s[20:23], s28 offen nt lds
  s_add_u32 m0, s31, 4096
  s_add_u32 s28, s30, 40960
  buffer_load_dwordx4 v4, s[20:23], s28 offen nt lds
  s_add_u32 m0, s31, 5120
  s_add_u32 s28, s30, 51200
  buffer_load_dwordx4 v4, s[20:23], s28 offen nt lds
  s_add_u32 m0, s31, 6144
  s_add_u32 s28, s30, 61440
  buffer_load_dwordx4 v4, s[20:23], s28 offen nt lds
  s_add_u32 m0, s31, 7168
  s_add_u32 s28, s30, 71680
  buffer_load_dwordx4 v4, s[20:23], s28 offen nt lds
  s_add_u32 m0, s31, 8192
  s_add_u32 s28, s30, 81920
  buffer_load_dwordx4 v4, s[20:23], s28 offen nt lds
  s_add_u32 m0, s31, 9216
  s_add_u32 s28, s30, 92160
  buffer_load_dwordx4 v4, s[20:23], s28 offen nt lds
  s_add_u32 m0, s31, 10240
  s_add_u32 s28, s30, 102400
  buffer_load_dwordx4 v4, s[20:23], s28 offen nt lds
  s_add_u32 m0, s31, 11264
  s_add_u32 s28, s30, 112640
  buffer_load_dwordx4 v4, s[20:23], s28 offen nt lds
  s_add_u32 m0, s31, 12288
  s_add_u32 s28, s30, 122880
  buffer_load_dwordx4 v4, s[20:23], s28 offen nt lds
  s_add_u32 m0, s31, 13312
  s_add_u32 s28, s30, 133120
  buffer_load_dwordx4 v4, s[20:23], s28 offen nt lds
  s_add_u32 m0, s31, 14336
  s_add_u32 s28, s30, 143360
  buffer_load_dwordx4 v4, s[20:23], s28 offen nt lds
  s_add_u32 m0, s31, 15360
  s_add_u32 s28, s30, 153600
  buffer_load_dwordx4 v4, s[20:23], s28 offen nt lds
  s_waitcnt vmcnt(12)
  s_add_u32 m0, s31, 16384
  s_add_u32 s28, s30, 163840
  buffer_load_dwordx4 v4, s[20:23], s28 offen nt lds
  s_add_u32 m0, s31, 17408
  s_add_u32 s28, s30, 174080
  buffer_load_dwordx4 v4, s[20:23], s28 offen nt lds
  s_add_u32 m0, s31, 18432
  s_add_u32 s28, s30, 184320
  buffer_load_dwordx4 v4, s[20:23], s28 offen nt lds
  s_add_u32 m0, s31, 19456
  s_add_u32 s28, s30, 194560
  buffer_load_dwordx4 v4, s[20:23], s28 offen nt lds
  ds_read_b64_tr_b16 a[0:1], v220 offset:0
  ds_read_b64_tr_b16 a[2:3], v220 offset:2048
  ds_read_b64_tr_b16 a[24:25], v221 offset:0
  ds_read_b64_tr_b16 a[26:27], v221 offset:2048
  ds_read_b64_tr_b16 a[48:49], v222 offset:0
  ds_read_b64_tr_b16 a[50:51], v222 offset:2048
  ds_read_b64_tr_b16 a[72:73], v223 offset:0
  ds_read_b64_tr_b16 a[74:75], v223 offset:2048
  s_waitcnt lgkmcnt(8)
  s_waitcnt vmcnt(12)
  s_add_u32 m0, s31, 20480
  s_add_u32 s28, s30, 204800
  buffer_load_dwordx4 v4, s[20:23], s28 offen nt lds
  s_add_u32 m0, s31, 21504
  s_add_u32 s28, s30, 215040
  buffer_load_dwordx4 v4, s[20:23], s28 offen nt lds
  s_add_u32 m0, s31, 22528
  s_add_u32 s28, s30, 225280
  buffer_load_dwordx4 v4, s[20:23], s28 offen nt lds
  s_add_u32 m0, s31, 23552
  s_add_u32 s28, s30, 235520
  buffer_load_dwordx4 v4, s[20:23], s28 offen nt lds
  ds_read_b64_tr_b16 a[4:5], v220 offset:4096
  ds_read_b64_tr_b16 a[6:7], v220 offset:6144
  ds_read_b64_tr_b16 a[28:29], v221 offset:4096
  ds_read_b64_tr_b16 a[30:31], v221 offset:6144
  ds_read_b64_tr_b16 a[52:53], v222 offset:4096
  ds_read_b64_tr_b16 a[54:55], v222 offset:6144
  ds_read_b64_tr_b16 a[76:77], v223 offset:4096
  ds_read_b64_tr_b16 a[78:79], v223 offset:6144
  s_waitcnt lgkmcnt(8)
  s_waitcnt vmcnt(12)
  s_add_u32 m0, s31, 24576
  s_add_u32 s28, s30, 128
  buffer_load_dwordx4 v4, s[20:23], s28 offen nt lds
  s_add_u32 m0, s31, 25600
  s_add_u32 s28, s30, 10368
  buffer_load_dwordx4 v4, s[20:23], s28 offen nt lds
  s_add_u32 m0, s31, 26624
  s_add_u32 s28, s30, 20608
  buffer_load_dwordx4 v4, s[20:23], s28 offen nt lds
  s_add_u32 m0, s31, 27648
  s_add_u32 s28, s30, 30848
  buffer_load_dwordx4 v4, s[20:23], s28 offen nt lds
  ds_read_b64_tr_b16 a[8:9], v220 offset:8192
  ds_read_b64_tr_b16 a[10:11], v220 offset:10240
  ds_read_b64_tr_b16 a[32:33], v221 offset:8192
  ds_read_b64_tr_b16 a[34:35], v221 offset:10240
  ds_read_b64_tr_b16 a[56:57], v222 offset:8192
  ds_read_b64_tr_b16 a[58:59], v222 offset:10240
  ds_read_b64_tr_b16 a[80:81], v223 offset:8192
  ds_read_b64_tr_b16 a[82:83], v223 offset:10240
  s_waitcnt lgkmcnt(8)
  s_waitcnt vmcnt(12)
  s_add_u32 m0, s31, 28672
  s_add_u32 s28, s30, 41088
  buffer_load_dwordx4 v4, s[20:23], s28 offen nt lds
  s_add_u32 m0, s31, 29696
  s_add_u32 s28, s30, 51328
  buffer_load_dwordx4 v4, s[20:23], s28 offen nt lds
  s_add_u32 m0, s31, 30720
  s_add_u32 s28, s30, 61568
  buffer_load_dwordx4 v4, s[20:23], s28 offen nt lds
  s_add_u32 m0, s31, 31744
  s_add_u32 s28, s30, 71808
  buffer_load_dwordx4 v4, s[20:23], s28 offen nt lds
  ds_read_b64_tr_b16 a[12:13], v220 offset:12288
  ds_read_b64_tr_b16 a[14:15], v220 offset:14336
  ds_read_b64_tr_b16 a[36:37], v221 offset:12288
  ds_read_b64_tr_b16 a[38:39], v221 offset:14336
  ds_read_b64_tr_b16 a[60:61], v222 offset:12288
  ds_read_b64_tr_b16 a[62:63], v222 offset:14336
  ds_read_b64_tr_b16 a[84:85], v223 offset:12288
  ds_read_b64_tr_b16 a[86:87], v223 offset:14336
  s_waitcnt lgkmcnt(8)
  s_waitcnt vmcnt(12)
  s_add_u32 m0, s31, 32768
  s_add_u32 s28, s30, 82048
  buffer_load_dwordx4 v4, s[20:23], s28 offen nt lds
  s_add_u32 m0, s31, 33792
  s_add_u32 s28, s30, 92288
  buffer_load_dwordx4 v4, s[20:23], s28 offen nt lds
  s_add_u32 m0, s31, 34816
  s_add_u32 s28, s30, 102528
  buffer_load_dwordx4 v4, s[20:23], s28 offen nt lds
  s_add_u32 m0, s31, 35840
  s_add_u32 s28, s30, 112768
  buffer_load_dwordx4 v4, s[20:23], s28 offen nt lds
  ds_read_b64_tr_b16 a[16:17], v220 offset:16384
  ds_read_b64_tr_b16 a[18:19], v220 offset:18432
  ds_read_b64_tr_b16 a[40:41], v221 offset:16384
  ds_read_b64_tr_b16 a[42:43], v221 offset:18432
  ds_read_b64_tr_b16 a[64:65], v222 offset:16384
  ds_read_b64_tr_b16 a[66:67], v222 offset:18432
  ds_read_b64_tr_b16 a[88:89], v223 offset:16384
  ds_read_b64_tr_b16 a[90:91], v223 offset:18432
  s_waitcnt lgkmcnt(8)
  s_waitcnt vmcnt(12)
  s_add_u32 m0, s31, 36864
  s_add_u32 s28, s30, 123008
  buffer_load_dwordx4 v4, s[20:23], s28 offen nt lds
  s_add_u32 m0, s31, 37888
  s_add_u32 s28, s30, 133248
  buffer_load_dwordx4 v4, s[20:23], s28 offen nt lds
  s_add_u32 m0, s31, 38912
  s_add_u32 s28, s30, 143488
  buffer_load_dwordx4 v4, s[20:23], s28 offen nt lds
  s_add_u32 m0, s31, 39936
  s_add_u32 s28, s30, 153728
  buffer_load_dwordx4 v4, s[20:23], s28 offen nt lds
  ds_read_b64_tr_b16 a[20:21], v220 offset:20480
  ds_read_b64_tr_b16 a[22:23], v220 offset:22528
  ds_read_b64_tr_b16 a[44:45], v221 offset:20480
  ds_read_b64_tr_b16 a[46:47], v221 offset:22528
  ds_read_b64_tr_b16 a[68:69], v222 offset:20480
  ds_read_b64_tr_b16 a[70:71], v222 offset:22528
  ds_read_b64_tr_b16 a[92:93], v223 offset:20480
  ds_read_b64_tr_b16 a[94:95], v223 offset:22528
  s_waitcnt lgkmcnt(8)
  s_waitcnt vmcnt(12)
  s_add_u32 m0, s31, 0
  s_add_u32 s28, s30, 163968
  buffer_load_dwordx4 v4, s[20:23], s28 offen nt lds
  s_add_u32 m0, s31, 1024
  s_add_u32 s28, s30, 174208
  buffer_load_dwordx4 v4, s[20:23], s28 offen nt lds
  s_add_u32 m0, s31, 2048
  s_add_u32 s28, s30, 184448
  buffer_load_dwordx4 v4, s[20:23], s28 offen nt lds
  s_add_u32 m0, s31, 3072
  s_add_u32 s28, s30, 194688
  buffer_load_dwordx4 v4, s[20:23], s28 offen nt lds
  ds_read_b64_tr_b16 a[96:97], v220 offset:24576
  ds_read_b64_tr_b16 a[98:99], v220 offset:26624
  ds_read_b64_tr_b16 a[120:121], v221 offset:24576
  ds_read_b64_tr_b16 a[122:123], v221 offset:26624
  ds_read_b64_tr_b16 a[144:145], v222 offset:24576
  ds_read_b64_tr_b16 a[146:147], v222 offset:26624
  ds_read_b64_tr_b16 a[168:169], v223 offset:24576
  ds_read_b64_tr_b16 a[170:171], v223 offset:26624
  s_waitcnt lgkmcnt(8)
  s_waitcnt vmcnt(12)
  s_add_u32 m0, s31, 4096
  s_add_u32 s28, s30, 204928
  buffer_load_dwordx4 v4, s[20:23], s28 offen nt lds
  s_add_u32 m0, s31, 5120
  s_add_u32 s28, s30, 215168
  buffer_load_dwordx4 v4, s[20:23], s28 offen nt lds
  s_add_u32 m0, s31, 6144
  s_add_u32 s28, s30, 225408
  buffer_load_dwordx4 v4, s[20:23], s28 offen nt lds
  s_add_u32 m0, s31, 7168
  s_add_u32 s28, s30, 235648
  buffer_load_dwordx4 v4, s[20:23], s28 offen nt lds
  ds_read_b64_tr_b16 a[100:101], v220 offset:28672
  ds_read_b64_tr_b16 a[102:103], v220 offset:30720
  ds_read_b64_tr_b16 a[124:125], v221 offset:28672
  ds_read_b64_tr_b16 a[126:127], v221 offset:30720
  ds_read_b64_tr_b16 a[148:149], v222 offset:28672
  ds_read_b64_tr_b16 a[150:151], v222 offset:30720
  ds_read_b64_tr_b16 a[172:173], v223 offset:28672
  ds_read_b64_tr_b16 a[174:175], v223 offset:30720
  s_waitcnt lgkmcnt(8)
  s_waitcnt vmcnt(12)
  ds_read_b64_tr_b16 a[104:105], v220 offset:32768
  ds_read_b64_tr_b16 a[106:107], v220 offset:34816
  ds_read_b64_tr_b16 a[128:129], v221 offset:32768
  ds_read_b64_tr_b16 a[130:131], v221 offset:34816
  ds_read_b64_tr_b16 a[152:153], v222 offset:32768
  ds_read_b64_tr_b16 a[154:155], v222 offset:34816
  ds_read_b64_tr_b16 a[176:177], v223 offset:32768
  ds_read_b64_tr_b16 a[178:179], v223 offset:34816
  s_waitcnt lgkmcnt(8)
  s_waitcnt vmcnt(8)
  ds_read_b64_tr_b16 a[108:109], v220 offset:36864
  ds_read_b64_tr_b16 a[110:111], v220 offset:38912
  ds_read_b64_tr_b16 a[132:133], v221 offset:36864
  ds_read_b64_tr_b16 a[134:135], v221 offset:38912
  ds_read_b64_tr_b16 a[156:157], v222 offset:36864
  ds_read_b64_tr_b16 a[158:159], v222 offset:38912
  ds_read_b64_tr_b16 a[180:181], v223 offset:36864
  ds_read_b64_tr_b16 a[182:183], v223 offset:38912
  s_waitcnt lgkmcnt(8)
  s_waitcnt vmcnt(4)
  ds_read_b64_tr_b16 a[112:113], v220 offset:0
  ds_read_b64_tr_b16 a[114:115], v220 offset:2048
  ds_read_b64_tr_b16 a[136:137], v221 offset:0
  ds_read_b64_tr_b16 a[138:139], v221 offset:2048
  ds_read_b64_tr_b16 a[160:161], v222 offset:0
  ds_read_b64_tr_b16 a[162:163], v222 offset:2048
  ds_read_b64_tr_b16 a[184:185], v223 offset:0
  ds_read_b64_tr_b16 a[186:187], v223 offset:2048
  s_waitcnt lgkmcnt(8)
  s_waitcnt vmcnt(0)
  ds_read_b64_tr_b16 a[116:117], v220 offset:4096
  ds_read_b64_tr_b16 a[118:119], v220 offset:6144
  ds_read_b64_tr_b16 a[140:141], v221 offset:4096
  ds_read_b64_tr_b16 a[142:143], v221 offset:6144
  ds_read_b64_tr_b16 a[164:165], v222 offset:4096
  ds_read_b64_tr_b16 a[166:167], v222 offset:6144
  ds_read_b64_tr_b16 a[188:189], v223 offset:4096
  ds_read_b64_tr_b16 a[190:191], v223 offset:6144
  s_waitcnt lgkmcnt(8)
  s_waitcnt lgkmcnt(0)
  s_barrier
  v_lshlrev_b32 v196, 4, v1
  v_add_u32 v205, 131072, v196
  v_bfe_u32 v206, v1, 2, 1
  v_and_b32 v207, 3, v1
  v_lshl_add_u32 v206, v206, 3, v207
  v_lshrrev_b32 v207, 4, v1
  v_lshl_add_u32 v206, v207, 4, v206
  v_lshlrev_b32 v206, 4, v206
  v_bfe_u32 v207, v1, 3, 1
  v_mul_u32_u24 v208, 1088, v207
  s_lshl_b32 s28, s17, 11
  v_add3_u32 v216, v206, v208, s28
  v_xor_b32 v217, 64, v216
  s_lshl_b32 s28, s17, 13
  v_add_u32 v218, s28, v196
  v_xor_b32 v219, 64, v218
  s_lshr_b32 s28, s17, 1
  s_lshl_b32 s28, s28, 10
  s_and_b32 s29, s17, 1
  s_lshl_b32 s30, s29, 3
  s_add_u32 s28, s28, s30
  s_add_u32 s28, s28, 141312
  v_lshl_add_u32 v206, v207, 2, v206
  v_add_u32 v197, s28, v206
  s_lshl_b32 s28, s17, 11
  s_add_u32 s42, s28, 131072
  s_add_u32 s44, s28, 141312
  s_lshl_b32 s29, s29, 10
  s_add_u32 s43, s29, 139264
  s_lshl_b32 s30, s16, 22
  s_add_u32 s30, s30, 67108864
  s_add_u32 s47, s30, s29
  s_add_u32 s47, s47, 1404928
  s_add_u32 s48, s30, s28
  s_add_u32 s48, s48, 1396736
  s_mul_i32 s49, s17, 10240
  s_lshl_b32 s28, s24, 11
  s_add_u32 s49, s49, s28
  s_add_u32 s49, s49, s30
  s_add_u32 s49, s49, 1343488
  s_mul_i32 s50, s17, 12288
  s_add_u32 s50, s50, s30
  s_add_u32 s50, s50, 98304
  s_mov_b32 s32, s50
  v_and_b32 v206, 15, v1
  v_mul_u32_u24 v206, 1280, v206
  v_lshrrev_b32 v207, 4, v1
  v_lshl_add_u32 v198, v207, 4, v206
  s_lshl_b32 s28, s16, 8
  v_lshl_add_u32 v201, v1, 2, s28
  v_add_u32 v202, 12288, v201
  s_mul_i32 s29, s17, 12
  s_add_u32 s29, s29, 96
  v_add_u32 v201, s29, v201
  s_lshl_b32 s29, s35, 2
  s_add_u32 s28, s28, s29
  s_add_u32 s28, s28, 144
  v_mov_b32 v199, s28
  s_lshl_b32 s28, s16, 7
  s_add_u32 s28, s28, s29
  s_add_u32 s40, s28, 2162688
  s_add_u32 s28, s28, 2293760
  v_mov_b32 v200, s28
  s_mul_i32 s39, s16, 40960
  s_lshl_b32 s28, s35, 6
  s_add_u32 s39, s39, s28
  s_add_u32 s39, s39, 226492416
  s_mov_b32 s26, 0
  s_mov_b32 s34, 1
  s_add_u32 s28, s51, 227328
  s_add_u32 s28, s51, 454656
  s_add_u32 s29, s51, 681984
  s_lshl_b32 s27, s16, 2
  s_add_u32 s27, s27, 32
  v_mov_b32 v206, s27
  s_mov_b32 s27, 0
  s_mov_b64 exec, 1
gw_11:
  buffer_load_dword v207, v206, s[12:15], 0 offen sc1
  s_add_u32 s27, s27, 1
  s_cmp_gt_u32 s27, 65536
  s_cbranch_scc1 role_abort
  s_waitcnt vmcnt(0)
  v_cmp_gt_u32 vcc, 2, v207
  s_cbranch_vccz gk_12
  s_sleep 4
  s_branch gw_11
gk_12:
  s_mov_b64 exec, -1
  s_mov_b32 s27, 0
pw_13:
  buffer_load_dword v203, v201, s[8:11], 0 offen sc1
  s_add_u32 s27, s27, 1
  s_cmp_gt_u32 s27, 65536
  s_cbranch_scc1 role_abort
  s_waitcnt vmcnt(0)
pc_15:
  v_cmp_gt_u32 vcc, s34, v203
  s_nop 0
  s_and_b32 vcc_lo, vcc_lo, 0x7
  s_and_b32 vcc_hi, vcc_hi, 0x0
  s_cmp_eq_u64 vcc, 0
  s_cbranch_scc1 po_14
  s_sleep 2
  s_branch pw_13
po_14:
  s_add_u32 s45, s32, 4096
  s_add_u32 s46, s32, 8192
  buffer_load_dwordx4 v[4:7], v196, s[8:11], s32 offen offset:0 sc1
  buffer_load_dwordx4 v[8:11], v196, s[8:11], s32 offen offset:1024 sc1
  buffer_load_dwordx4 v[12:15], v196, s[8:11], s32 offen offset:2048 sc1
  buffer_load_dwordx4 v[16:19], v196, s[8:11], s32 offen offset:3072 sc1
  buffer_load_dwordx4 v[20:23], v196, s[8:11], s45 offen offset:0 sc1
  buffer_load_dwordx4 v[24:27], v196, s[8:11], s45 offen offset:1024 sc1
  buffer_load_dwordx4 v[28:31], v196, s[8:11], s45 offen offset:2048 sc1
  buffer_load_dwordx4 v[32:35], v196, s[8:11], s45 offen offset:3072 sc1
  buffer_load_dwordx4 v[36:39], v196, s[8:11], s46 offen offset:0 sc1
  buffer_load_dwordx4 v[40:43], v196, s[8:11], s46 offen offset:1024 sc1
  buffer_load_dwordx4 v[44:47], v196, s[8:11], s46 offen offset:2048 sc1
  buffer_load_dwordx4 v[48:51], v196, s[8:11], s46 offen offset:3072 sc1
ua_loop0:
  s_and_b32 s41, s26, 3
  s_mul_i32 s28, s41, 227328
  s_add_u32 s38, s47, s28
  s_add_u32 s36, s48, s28
  s_add_u32 s37, s49, s28
  s_add_u32 s33, s51, s28
  s_lshl_b32 s41, s41, 15
  v_add_u32 v212, s41, v216
  v_add_u32 v213, s41, v217
  v_add_u32 v214, s41, v218
  v_add_u32 v215, s41, v219
  s_cmp_ge_u32 s26, 4
  s_cbranch_scc1 ua_ao0
  s_waitcnt vmcnt(0)
  s_branch ua_u0
ua_ao0:
  s_sub_u32 s34, s26, 3
  ds_read_b128 v[92:95], v212 offset:0
  ds_read_b128 v[96:99], v213 offset:0
  ds_read_b128 v[100:103], v212 offset:8192
  ds_read_b128 v[104:107], v213 offset:8192
  ds_read_b128 v[108:111], v212 offset:16384
  ds_read_b128 v[112:115], v213 offset:16384
  ds_read_b128 v[116:119], v212 offset:24576
  ds_read_b128 v[120:123], v213 offset:24576
  s_mov_b32 s27, 0
pw_16:
  buffer_load_dword v204, v202, s[8:11], 0 offen sc1
  s_add_u32 s27, s27, 1
  s_cmp_gt_u32 s27, 65536
  s_cbranch_scc1 role_abort
  s_waitcnt vmcnt(0)
pc_18:
  v_cmp_gt_u32 vcc, s34, v204
  s_nop 0
  s_and_b32 vcc_lo, vcc_lo, 0xff
  s_and_b32 vcc_hi, vcc_hi, 0x0
  s_cmp_eq_u64 vcc, 0
  s_cbranch_scc1 po_17
  s_sleep 2
  s_branch pw_16
po_17:
  s_mov_b32 m0, s42
  v_mov_b32 v200, s40
  buffer_load_dwordx4 v196, s[8:11], s36 offen sc1 lds
  buffer_load_dwordx4 v196, s[8:11], s36 offen offset:1024 sc1 lds
  s_mov_b32 m0, s44
  s_nop 0
  buffer_load_dwordx4 v196, s[8:11], s37 offen sc1 lds
  buffer_load_dwordx4 v196, s[8:11], s37 offen offset:1024 sc1 lds
  s_mov_b32 m0, s43
  s_nop 0
  buffer_load_dwordx4 v196, s[8:11], s38 offen sc1 lds
  s_add_u32 s40, s40, 1024
  s_add_u32 s28, s39, 20480
  s_waitcnt vmcnt(0) lgkmcnt(0)
  s_barrier
  ds_read_b128 v[124:127], v205 offset:0
  ds_read_b128 v[128:131], v205 offset:1024
  ds_read_b128 v[132:135], v205 offset:2048
  ds_read_b128 v[136:139], v205 offset:3072
  ds_read_b128 v[140:143], v205 offset:4096
  ds_read_b128 v[144:147], v205 offset:5120
  ds_read_b128 v[148:151], v205 offset:6144
  ds_read_b128 v[152:155], v205 offset:7168
  s_waitcnt lgkmcnt(6)
  v_mfma_f32_16x16x32_bf16 v[172:175], v[92:95], v[124:127], 0
  ds_read_b128 v[164:167], v205 offset:8192
  v_mfma_f32_16x16x32_bf16 v[176:179], v[96:99], v[124:127], 0
  ds_read_b128 v[168:171], v205 offset:9216
  v_mfma_f32_16x16x32_bf16 v[180:183], v[92:95], v[128:131], 0
  ds_read_b32 v156, v197 offset:0
  v_mfma_f32_16x16x32_bf16 v[184:187], v[96:99], v[128:131], 0
  ds_read_b32 v157, v197 offset:2048
  s_waitcnt lgkmcnt(8)
  v_mfma_f32_16x16x32_bf16 v[172:175], v[100:103], v[132:135], v[172:175]
  ds_read_b32 v158, v197 offset:4096
  v_mfma_f32_16x16x32_bf16 v[176:179], v[104:107], v[132:135], v[176:179]
  ds_read_b32 v159, v197 offset:6144
  v_mfma_f32_16x16x32_bf16 v[180:183], v[100:103], v[136:139], v[180:183]
  ds_read_b32 v160, v197 offset:64
  v_mfma_f32_16x16x32_bf16 v[184:187], v[104:107], v[136:139], v[184:187]
  ds_read_b32 v161, v197 offset:2112
  s_waitcnt lgkmcnt(10)
  v_mfma_f32_16x16x32_bf16 v[172:175], v[108:111], v[140:143], v[172:175]
  ds_read_b32 v162, v197 offset:4160
  v_mfma_f32_16x16x32_bf16 v[176:179], v[112:115], v[140:143], v[176:179]
  ds_read_b32 v163, v197 offset:6208
  v_mfma_f32_16x16x32_bf16 v[180:183], v[108:111], v[144:147], v[180:183]
  v_mfma_f32_16x16x32_bf16 v[184:187], v[112:115], v[144:147], v[184:187]
  s_waitcnt lgkmcnt(10)
  v_mfma_f32_16x16x32_bf16 v[172:175], v[116:119], v[148:151], v[172:175]
  v_mfma_f32_16x16x32_bf16 v[176:179], v[120:123], v[148:151], v[176:179]
  v_mfma_f32_16x16x32_bf16 v[180:183], v[116:119], v[152:155], v[180:183]
  v_mfma_f32_16x16x32_bf16 v[184:187], v[120:123], v[152:155], v[184:187]
  s_waitcnt lgkmcnt(0)
  v_mfma_f32_16x16x32_bf16 v[172:175], v[156:159], v[164:167], v[172:175]
  v_mfma_f32_16x16x32_bf16 v[176:179], v[160:163], v[164:167], v[176:179]
  v_mfma_f32_16x16x32_bf16 v[180:183], v[156:159], v[168:171], v[180:183]
  v_mfma_f32_16x16x32_bf16 v[184:187], v[160:163], v[168:171], v[184:187]
  s_barrier
  s_nop 3
  v_cvt_pk_bf16_f32 v188, v172, v173
  v_cvt_pk_bf16_f32 v189, v174, v175
  v_cvt_pk_bf16_f32 v190, v176, v177
  v_cvt_pk_bf16_f32 v191, v178, v179
  buffer_store_dwordx4 v[188:191], v198, s[8:11], s39 offen sc1
  v_cvt_pk_bf16_f32 v192, v180, v181
  v_cvt_pk_bf16_f32 v193, v182, v183
  v_cvt_pk_bf16_f32 v194, v184, v185
  v_cvt_pk_bf16_f32 v195, v186, v187
  buffer_store_dwordx4 v[192:195], v198, s[8:11], s28 offen sc1
  s_add_u32 s39, s39, 327680
  s_cmp_lt_u32 s26, 64
  s_cbranch_scc1 ua_u0
  s_waitcnt vmcnt(0)
  s_mov_b64 exec, 1
  buffer_store_dword v208, v200, s[8:11], 0 offen sc1
  s_mov_b64 exec, -1
  s_add_u32 s26, s26, 1
  s_cmp_ge_u32 s26, 68
  s_cbranch_scc1 ua_end
  s_branch ua_loop0
ua_u0:
  s_add_u32 s34, s26, 2
  s_min_u32 s34, s34, 64
  s_cmp_lt_u32 s26, 2
  s_cselect_b32 s34, 0, s34
  s_mov_b32 s27, 0
  s_branch pc_21
pw_19:
  buffer_load_dword v203, v201, s[8:11], 0 offen sc1
  s_add_u32 s27, s27, 1
  s_cmp_gt_u32 s27, 65536
  s_cbranch_scc1 role_abort
  s_waitcnt vmcnt(0)
pc_21:
  v_cmp_gt_u32 vcc, s34, v203
  s_nop 0
  s_and_b32 vcc_lo, vcc_lo, 0x7
  s_and_b32 vcc_hi, vcc_hi, 0x0
  s_cmp_eq_u64 vcc, 0
  s_cbranch_scc1 po_20
  s_sleep 4
  s_branch pw_19
po_20:
  s_add_u32 s26, s26, 1
  s_and_b32 s28, s26, 7
  s_mul_i32 s28, s28, 147456
  s_add_u32 s32, s50, s28
  v_mov_b32 v208, s26
  s_add_u32 s30, s33, 4096
  s_add_u32 s45, s32, 4096
  s_add_u32 s46, s32, 8192
  v_mfma_f32_16x16x32_bf16 v[52:55], v[4:7], a[0:3], 0
  v_mfma_f32_16x16x32_bf16 v[56:59], v[28:31], a[0:3], 0
  v_mfma_f32_16x16x32_bf16 v[60:63], v[4:7], a[24:27], 0
  v_mfma_f32_16x16x32_bf16 v[64:67], v[28:31], a[24:27], 0
  buffer_load_dwordx4 a[192:195], v196, s[8:11], s32 offen offset:0 sc1
  v_mfma_f32_16x16x32_bf16 v[52:55], v[8:11], a[4:7], v[52:55]
  v_mfma_f32_16x16x32_bf16 v[56:59], v[32:35], a[4:7], v[56:59]
  v_mfma_f32_16x16x32_bf16 v[60:63], v[8:11], a[28:31], v[60:63]
  v_mfma_f32_16x16x32_bf16 v[64:67], v[32:35], a[28:31], v[64:67]
  buffer_load_dwordx4 a[196:199], v196, s[8:11], s32 offen offset:1024 sc1
  v_mfma_f32_16x16x32_bf16 v[52:55], v[12:15], a[8:11], v[52:55]
  v_mfma_f32_16x16x32_bf16 v[56:59], v[36:39], a[8:11], v[56:59]
  v_mfma_f32_16x16x32_bf16 v[60:63], v[12:15], a[32:35], v[60:63]
  v_mfma_f32_16x16x32_bf16 v[64:67], v[36:39], a[32:35], v[64:67]
  buffer_load_dwordx4 a[200:203], v196, s[8:11], s32 offen offset:2048 sc1
  v_mfma_f32_16x16x32_bf16 v[52:55], v[16:19], a[12:15], v[52:55]
  v_mfma_f32_16x16x32_bf16 v[56:59], v[40:43], a[12:15], v[56:59]
  v_mfma_f32_16x16x32_bf16 v[60:63], v[16:19], a[36:39], v[60:63]
  v_mfma_f32_16x16x32_bf16 v[64:67], v[40:43], a[36:39], v[64:67]
  buffer_load_dwordx4 a[204:207], v196, s[8:11], s32 offen offset:3072 sc1
  v_mfma_f32_16x16x32_bf16 v[52:55], v[20:23], a[16:19], v[52:55]
  v_mfma_f32_16x16x32_bf16 v[56:59], v[44:47], a[16:19], v[56:59]
  v_mfma_f32_16x16x32_bf16 v[60:63], v[20:23], a[40:43], v[60:63]
  v_mfma_f32_16x16x32_bf16 v[64:67], v[44:47], a[40:43], v[64:67]
  buffer_load_dwordx4 a[208:211], v196, s[8:11], s45 offen offset:0 sc1
  v_mfma_f32_16x16x32_bf16 v[52:55], v[24:27], a[20:23], v[52:55]
  v_mfma_f32_16x16x32_bf16 v[56:59], v[48:51], a[20:23], v[56:59]
  v_mfma_f32_16x16x32_bf16 v[60:63], v[24:27], a[44:47], v[60:63]
  v_mfma_f32_16x16x32_bf16 v[64:67], v[48:51], a[44:47], v[64:67]
  buffer_load_dwordx4 a[212:215], v196, s[8:11], s45 offen offset:1024 sc1
  v_mfma_f32_16x16x32_bf16 v[68:71], v[4:7], a[48:51], 0
  v_mfma_f32_16x16x32_bf16 v[72:75], v[28:31], a[48:51], 0
  v_mfma_f32_16x16x32_bf16 v[76:79], v[4:7], a[72:75], 0
  v_mfma_f32_16x16x32_bf16 v[80:83], v[28:31], a[72:75], 0
  buffer_load_dwordx4 a[216:219], v196, s[8:11], s45 offen offset:2048 sc1
  v_mfma_f32_16x16x32_bf16 v[68:71], v[8:11], a[52:55], v[68:71]
  v_cvt_pk_bf16_f32 v84, v52, v53
  v_mfma_f32_16x16x32_bf16 v[72:75], v[32:35], a[52:55], v[72:75]
  v_cvt_pk_bf16_f32 v85, v54, v55
  v_mfma_f32_16x16x32_bf16 v[76:79], v[8:11], a[76:79], v[76:79]
  v_cvt_pk_bf16_f32 v86, v56, v57
  v_mfma_f32_16x16x32_bf16 v[80:83], v[32:35], a[76:79], v[80:83]
  buffer_load_dwordx4 a[220:223], v196, s[8:11], s45 offen offset:3072 sc1
  v_mfma_f32_16x16x32_bf16 v[68:71], v[12:15], a[56:59], v[68:71]
  v_cvt_pk_bf16_f32 v87, v58, v59
  v_mfma_f32_16x16x32_bf16 v[72:75], v[36:39], a[56:59], v[72:75]
  buffer_store_dwordx4 v[84:87], v196, s[8:11], s33 offen offset:0
  v_mfma_f32_16x16x32_bf16 v[76:79], v[12:15], a[80:83], v[76:79]
  ds_write_b128 v214, v[84:87] offset:0
  v_mfma_f32_16x16x32_bf16 v[80:83], v[36:39], a[80:83], v[80:83]
  buffer_load_dwordx4 a[224:227], v196, s[8:11], s46 offen offset:0 sc1
  v_mfma_f32_16x16x32_bf16 v[68:71], v[16:19], a[60:63], v[68:71]
  v_cvt_pk_bf16_f32 v88, v60, v61
  v_mfma_f32_16x16x32_bf16 v[72:75], v[40:43], a[60:63], v[72:75]
  v_cvt_pk_bf16_f32 v89, v62, v63
  v_mfma_f32_16x16x32_bf16 v[76:79], v[16:19], a[84:87], v[76:79]
  v_cvt_pk_bf16_f32 v90, v64, v65
  v_mfma_f32_16x16x32_bf16 v[80:83], v[40:43], a[84:87], v[80:83]
  buffer_load_dwordx4 a[228:231], v196, s[8:11], s46 offen offset:1024 sc1
  v_mfma_f32_16x16x32_bf16 v[68:71], v[20:23], a[64:67], v[68:71]
  v_cvt_pk_bf16_f32 v91, v66, v67
  v_mfma_f32_16x16x32_bf16 v[72:75], v[44:47], a[64:67], v[72:75]
  buffer_store_dwordx4 v[88:91], v196, s[8:11], s33 offen offset:1024
  v_mfma_f32_16x16x32_bf16 v[76:79], v[20:23], a[88:91], v[76:79]
  ds_write_b128 v215, v[88:91] offset:1024
  v_mfma_f32_16x16x32_bf16 v[80:83], v[44:47], a[88:91], v[80:83]
  buffer_load_dwordx4 a[232:235], v196, s[8:11], s46 offen offset:2048 sc1
  v_mfma_f32_16x16x32_bf16 v[68:71], v[24:27], a[68:71], v[68:71]
  v_mfma_f32_16x16x32_bf16 v[72:75], v[48:51], a[68:71], v[72:75]
  v_mfma_f32_16x16x32_bf16 v[76:79], v[24:27], a[92:95], v[76:79]
  v_mfma_f32_16x16x32_bf16 v[80:83], v[48:51], a[92:95], v[80:83]
  buffer_load_dwordx4 a[236:239], v196, s[8:11], s46 offen offset:3072 sc1
  s_waitcnt vmcnt(14)
  s_mov_b64 exec, 1
  buffer_store_dword v208, v200, s[8:11], 0 offen sc1
  s_mov_b64 exec, -1
  v_mfma_f32_16x16x32_bf16 v[52:55], v[4:7], a[96:99], 0
  v_mfma_f32_16x16x32_bf16 v[56:59], v[28:31], a[96:99], 0
  v_mfma_f32_16x16x32_bf16 v[60:63], v[4:7], a[120:123], 0
  v_mfma_f32_16x16x32_bf16 v[64:67], v[28:31], a[120:123], 0
  v_mfma_f32_16x16x32_bf16 v[52:55], v[8:11], a[100:103], v[52:55]
  v_cvt_pk_bf16_f32 v84, v68, v69
  v_mfma_f32_16x16x32_bf16 v[56:59], v[32:35], a[100:103], v[56:59]
  v_cvt_pk_bf16_f32 v85, v70, v71
  v_mfma_f32_16x16x32_bf16 v[60:63], v[8:11], a[124:127], v[60:63]
  v_cvt_pk_bf16_f32 v86, v72, v73
  v_mfma_f32_16x16x32_bf16 v[64:67], v[32:35], a[124:127], v[64:67]
  v_cvt_pk_bf16_f32 v87, v74, v75
  v_mfma_f32_16x16x32_bf16 v[52:55], v[12:15], a[104:107], v[52:55]
  buffer_store_dwordx4 v[84:87], v196, s[8:11], s33 offen offset:2048
  v_mfma_f32_16x16x32_bf16 v[56:59], v[36:39], a[104:107], v[56:59]
  ds_write_b128 v214, v[84:87] offset:2048
  v_mfma_f32_16x16x32_bf16 v[60:63], v[12:15], a[128:131], v[60:63]
  v_cvt_pk_bf16_f32 v88, v76, v77
  v_mfma_f32_16x16x32_bf16 v[64:67], v[36:39], a[128:131], v[64:67]
  v_cvt_pk_bf16_f32 v89, v78, v79
  v_mfma_f32_16x16x32_bf16 v[52:55], v[16:19], a[108:111], v[52:55]
  v_cvt_pk_bf16_f32 v90, v80, v81
  v_mfma_f32_16x16x32_bf16 v[56:59], v[40:43], a[108:111], v[56:59]
  v_cvt_pk_bf16_f32 v91, v82, v83
  v_mfma_f32_16x16x32_bf16 v[60:63], v[16:19], a[132:135], v[60:63]
  buffer_store_dwordx4 v[88:91], v196, s[8:11], s33 offen offset:3072
  v_mfma_f32_16x16x32_bf16 v[64:67], v[40:43], a[132:135], v[64:67]
  ds_write_b128 v215, v[88:91] offset:3072
  v_mfma_f32_16x16x32_bf16 v[52:55], v[20:23], a[112:115], v[52:55]
  v_mfma_f32_16x16x32_bf16 v[56:59], v[44:47], a[112:115], v[56:59]
  v_mfma_f32_16x16x32_bf16 v[60:63], v[20:23], a[136:139], v[60:63]
  v_mfma_f32_16x16x32_bf16 v[64:67], v[44:47], a[136:139], v[64:67]
  v_mfma_f32_16x16x32_bf16 v[52:55], v[24:27], a[116:119], v[52:55]
  v_mfma_f32_16x16x32_bf16 v[56:59], v[48:51], a[116:119], v[56:59]
  v_mfma_f32_16x16x32_bf16 v[60:63], v[24:27], a[140:143], v[60:63]
  v_mfma_f32_16x16x32_bf16 v[64:67], v[48:51], a[140:143], v[64:67]
  v_mfma_f32_16x16x32_bf16 v[68:71], v[4:7], a[144:147], 0
  v_mfma_f32_16x16x32_bf16 v[72:75], v[28:31], a[144:147], 0
  v_mfma_f32_16x16x32_bf16 v[76:79], v[4:7], a[168:171], 0
  v_mfma_f32_16x16x32_bf16 v[80:83], v[28:31], a[168:171], 0
  v_mfma_f32_16x16x32_bf16 v[68:71], v[8:11], a[148:151], v[68:71]
  v_cvt_pk_bf16_f32 v84, v52, v53
  v_mfma_f32_16x16x32_bf16 v[72:75], v[32:35], a[148:151], v[72:75]
  v_cvt_pk_bf16_f32 v85, v54, v55
  v_mfma_f32_16x16x32_bf16 v[76:79], v[8:11], a[172:175], v[76:79]
  v_cvt_pk_bf16_f32 v86, v56, v57
  v_mfma_f32_16x16x32_bf16 v[80:83], v[32:35], a[172:175], v[80:83]
  v_cvt_pk_bf16_f32 v87, v58, v59
  v_mfma_f32_16x16x32_bf16 v[68:71], v[12:15], a[152:155], v[68:71]
  buffer_store_dwordx4 v[84:87], v196, s[8:11], s30 offen offset:0
  v_mfma_f32_16x16x32_bf16 v[72:75], v[36:39], a[152:155], v[72:75]
  ds_write_b128 v214, v[84:87] offset:4096
  v_mfma_f32_16x16x32_bf16 v[76:79], v[12:15], a[176:179], v[76:79]
  v_cvt_pk_bf16_f32 v88, v60, v61
  v_mfma_f32_16x16x32_bf16 v[80:83], v[36:39], a[176:179], v[80:83]
  v_cvt_pk_bf16_f32 v89, v62, v63
  v_mfma_f32_16x16x32_bf16 v[68:71], v[16:19], a[156:159], v[68:71]
  v_cvt_pk_bf16_f32 v90, v64, v65
  v_mfma_f32_16x16x32_bf16 v[72:75], v[40:43], a[156:159], v[72:75]
  v_cvt_pk_bf16_f32 v91, v66, v67
  v_mfma_f32_16x16x32_bf16 v[76:79], v[16:19], a[180:183], v[76:79]
  buffer_store_dwordx4 v[88:91], v196, s[8:11], s30 offen offset:1024
  v_mfma_f32_16x16x32_bf16 v[80:83], v[40:43], a[180:183], v[80:83]
  ds_write_b128 v215, v[88:91] offset:5120
  v_mfma_f32_16x16x32_bf16 v[68:71], v[20:23], a[160:163], v[68:71]
  v_mfma_f32_16x16x32_bf16 v[72:75], v[44:47], a[160:163], v[72:75]
  v_mfma_f32_16x16x32_bf16 v[76:79], v[20:23], a[184:187], v[76:79]
  v_mfma_f32_16x16x32_bf16 v[80:83], v[44:47], a[184:187], v[80:83]
  v_mfma_f32_16x16x32_bf16 v[68:71], v[24:27], a[164:167], v[68:71]
  v_mfma_f32_16x16x32_bf16 v[72:75], v[48:51], a[164:167], v[72:75]
  v_mfma_f32_16x16x32_bf16 v[76:79], v[24:27], a[188:191], v[76:79]
  v_mfma_f32_16x16x32_bf16 v[80:83], v[48:51], a[188:191], v[80:83]
  s_nop 4
  v_cvt_pk_bf16_f32 v84, v68, v69
  v_cvt_pk_bf16_f32 v85, v70, v71
  v_cvt_pk_bf16_f32 v86, v72, v73
  v_cvt_pk_bf16_f32 v87, v74, v75
  buffer_store_dwordx4 v[84:87], v196, s[8:11], s30 offen offset:2048
  ds_write_b128 v214, v[84:87] offset:6144
  v_cvt_pk_bf16_f32 v88, v76, v77
  v_cvt_pk_bf16_f32 v89, v78, v79
  v_cvt_pk_bf16_f32 v90, v80, v81
  v_cvt_pk_bf16_f32 v91, v82, v83
  buffer_store_dwordx4 v[88:91], v196, s[8:11], s30 offen offset:3072
  ds_write_b128 v215, v[88:91] offset:7168
  buffer_load_dword v203, v201, s[8:11], 0 offen sc1
  s_waitcnt vmcnt(0) lgkmcnt(0)
  buffer_store_dword v208, v199, s[8:11], 0 offen
  s_cmp_gt_u32 s26, 4
  s_cbranch_scc1 ua_nb0
  s_cmp_gt_u32 s26, 2
  s_cbranch_scc1 ua_nr0
  s_add_u32 s34, s26, 1
  s_mov_b32 s27, 0
  s_branch pc_24
pw_22:
  buffer_load_dword v203, v201, s[8:11], 0 offen sc1
  s_add_u32 s27, s27, 1
  s_cmp_gt_u32 s27, 65536
  s_cbranch_scc1 role_abort
  s_waitcnt vmcnt(0)
pc_24:
  v_cmp_gt_u32 vcc, s34, v203
  s_nop 0
  s_and_b32 vcc_lo, vcc_lo, 0x7
  s_and_b32 vcc_hi, vcc_hi, 0x0
  s_cmp_eq_u64 vcc, 0
  s_cbranch_scc1 po_23
  s_sleep 2
  s_branch pw_22
po_23:
  s_add_u32 s45, s32, 4096
  s_add_u32 s46, s32, 8192
  buffer_load_dwordx4 a[192:195], v196, s[8:11], s32 offen offset:0 sc1
  buffer_load_dwordx4 a[196:199], v196, s[8:11], s32 offen offset:1024 sc1
  buffer_load_dwordx4 a[200:203], v196, s[8:11], s32 offen offset:2048 sc1
  buffer_load_dwordx4 a[204:207], v196, s[8:11], s32 offen offset:3072 sc1
  buffer_load_dwordx4 a[208:211], v196, s[8:11], s45 offen offset:0 sc1
  buffer_load_dwordx4 a[212:215], v196, s[8:11], s45 offen offset:1024 sc1
  buffer_load_dwordx4 a[216:219], v196, s[8:11], s45 offen offset:2048 sc1
  buffer_load_dwordx4 a[220:223], v196, s[8:11], s45 offen offset:3072 sc1
  buffer_load_dwordx4 a[224:227], v196, s[8:11], s46 offen offset:0 sc1
  buffer_load_dwordx4 a[228:231], v196, s[8:11], s46 offen offset:1024 sc1
  buffer_load_dwordx4 a[232:235], v196, s[8:11], s46 offen offset:2048 sc1
  buffer_load_dwordx4 a[236:239], v196, s[8:11], s46 offen offset:3072 sc1
ua_nr0:
  s_cmp_eq_u32 s26, 4
  s_cbranch_scc0 ua_nb0
  s_barrier
ua_nb0:
ua_loop1:
  s_and_b32 s41, s26, 3
  s_mul_i32 s28, s41, 227328
  s_add_u32 s38, s47, s28
  s_add_u32 s36, s48, s28
  s_add_u32 s37, s49, s28
  s_add_u32 s33, s51, s28
  s_lshl_b32 s41, s41, 15
  v_add_u32 v212, s41, v216
  v_add_u32 v213, s41, v217
  v_add_u32 v214, s41, v218
  v_add_u32 v215, s41, v219
  s_cmp_ge_u32 s26, 4
  s_cbranch_scc1 ua_ao1
  s_waitcnt vmcnt(0)
  s_branch ua_u1
ua_ao1:
  s_sub_u32 s34, s26, 3
  ds_read_b128 v[92:95], v212 offset:0
  ds_read_b128 v[96:99], v213 offset:0
  ds_read_b128 v[100:103], v212 offset:8192
  ds_read_b128 v[104:107], v213 offset:8192
  ds_read_b128 v[108:111], v212 offset:16384
  ds_read_b128 v[112:115], v213 offset:16384
  ds_read_b128 v[116:119], v212 offset:24576
  ds_read_b128 v[120:123], v213 offset:24576
  s_mov_b32 s27, 0
pw_25:
  buffer_load_dword v204, v202, s[8:11], 0 offen sc1
  s_add_u32 s27, s27, 1
  s_cmp_gt_u32 s27, 65536
  s_cbranch_scc1 role_abort
  s_waitcnt vmcnt(0)
pc_27:
  v_cmp_gt_u32 vcc, s34, v204
  s_nop 0
  s_and_b32 vcc_lo, vcc_lo, 0xff
  s_and_b32 vcc_hi, vcc_hi, 0x0
  s_cmp_eq_u64 vcc, 0
  s_cbranch_scc1 po_26
  s_sleep 2
  s_branch pw_25
po_26:
  s_mov_b32 m0, s42
  v_mov_b32 v200, s40
  buffer_load_dwordx4 v196, s[8:11], s36 offen sc1 lds
  buffer_load_dwordx4 v196, s[8:11], s36 offen offset:1024 sc1 lds
  s_mov_b32 m0, s44
  s_nop 0
  buffer_load_dwordx4 v196, s[8:11], s37 offen sc1 lds
  buffer_load_dwordx4 v196, s[8:11], s37 offen offset:1024 sc1 lds
  s_mov_b32 m0, s43
  s_nop 0
  buffer_load_dwordx4 v196, s[8:11], s38 offen sc1 lds
  s_add_u32 s40, s40, 1024
  s_add_u32 s28, s39, 20480
  s_waitcnt vmcnt(0) lgkmcnt(0)
  s_barrier
  ds_read_b128 v[124:127], v205 offset:0
  ds_read_b128 v[128:131], v205 offset:1024
  ds_read_b128 v[132:135], v205 offset:2048
  ds_read_b128 v[136:139], v205 offset:3072
  ds_read_b128 v[140:143], v205 offset:4096
  ds_read_b128 v[144:147], v205 offset:5120
  ds_read_b128 v[148:151], v205 offset:6144
  ds_read_b128 v[152:155], v205 offset:7168
  s_waitcnt lgkmcnt(6)
  v_mfma_f32_16x16x32_bf16 v[172:175], v[92:95], v[124:127], 0
  ds_read_b128 v[164:167], v205 offset:8192
  v_mfma_f32_16x16x32_bf16 v[176:179], v[96:99], v[124:127], 0
  ds_read_b128 v[168:171], v205 offset:9216
  v_mfma_f32_16x16x32_bf16 v[180:183], v[92:95], v[128:131], 0
  ds_read_b32 v156, v197 offset:0
  v_mfma_f32_16x16x32_bf16 v[184:187], v[96:99], v[128:131], 0
  ds_read_b32 v157, v197 offset:2048
  s_waitcnt lgkmcnt(8)
  v_mfma_f32_16x16x32_bf16 v[172:175], v[100:103], v[132:135], v[172:175]
  ds_read_b32 v158, v197 offset:4096
  v_mfma_f32_16x16x32_bf16 v[176:179], v[104:107], v[132:135], v[176:179]
  ds_read_b32 v159, v197 offset:6144
  v_mfma_f32_16x16x32_bf16 v[180:183], v[100:103], v[136:139], v[180:183]
  ds_read_b32 v160, v197 offset:64
  v_mfma_f32_16x16x32_bf16 v[184:187], v[104:107], v[136:139], v[184:187]
  ds_read_b32 v161, v197 offset:2112
  s_waitcnt lgkmcnt(10)
  v_mfma_f32_16x16x32_bf16 v[172:175], v[108:111], v[140:143], v[172:175]
  ds_read_b32 v162, v197 offset:4160
  v_mfma_f32_16x16x32_bf16 v[176:179], v[112:115], v[140:143], v[176:179]
  ds_read_b32 v163, v197 offset:6208
  v_mfma_f32_16x16x32_bf16 v[180:183], v[108:111], v[144:147], v[180:183]
  v_mfma_f32_16x16x32_bf16 v[184:187], v[112:115], v[144:147], v[184:187]
  s_waitcnt lgkmcnt(10)
  v_mfma_f32_16x16x32_bf16 v[172:175], v[116:119], v[148:151], v[172:175]
  v_mfma_f32_16x16x32_bf16 v[176:179], v[120:123], v[148:151], v[176:179]
  v_mfma_f32_16x16x32_bf16 v[180:183], v[116:119], v[152:155], v[180:183]
  v_mfma_f32_16x16x32_bf16 v[184:187], v[120:123], v[152:155], v[184:187]
  s_waitcnt lgkmcnt(0)
  v_mfma_f32_16x16x32_bf16 v[172:175], v[156:159], v[164:167], v[172:175]
  v_mfma_f32_16x16x32_bf16 v[176:179], v[160:163], v[164:167], v[176:179]
  v_mfma_f32_16x16x32_bf16 v[180:183], v[156:159], v[168:171], v[180:183]
  v_mfma_f32_16x16x32_bf16 v[184:187], v[160:163], v[168:171], v[184:187]
  s_barrier
  s_nop 3
  v_cvt_pk_bf16_f32 v188, v172, v173
  v_cvt_pk_bf16_f32 v189, v174, v175
  v_cvt_pk_bf16_f32 v190, v176, v177
  v_cvt_pk_bf16_f32 v191, v178, v179
  buffer_store_dwordx4 v[188:191], v198, s[8:11], s39 offen sc1
  v_cvt_pk_bf16_f32 v192, v180, v181
  v_cvt_pk_bf16_f32 v193, v182, v183
  v_cvt_pk_bf16_f32 v194, v184, v185
  v_cvt_pk_bf16_f32 v195, v186, v187
  buffer_store_dwordx4 v[192:195], v198, s[8:11], s28 offen sc1
  s_add_u32 s39, s39, 327680
  s_cmp_lt_u32 s26, 64
  s_cbranch_scc1 ua_u1
  s_waitcnt vmcnt(0)
  s_mov_b64 exec, 1
  buffer_store_dword v208, v200, s[8:11], 0 offen sc1
  s_mov_b64 exec, -1
  s_add_u32 s26, s26, 1
  s_cmp_ge_u32 s26, 68
  s_cbranch_scc1 ua_end
  s_branch ua_loop1
ua_u1:
  s_add_u32 s34, s26, 2
  s_min_u32 s34, s34, 64
  s_cmp_lt_u32 s26, 2
  s_cselect_b32 s34, 0, s34
  s_mov_b32 s27, 0
  s_branch pc_30
pw_28:
  buffer_load_dword v203, v201, s[8:11], 0 offen sc1
  s_add_u32 s27, s27, 1
  s_cmp_gt_u32 s27, 65536
  s_cbranch_scc1 role_abort
  s_waitcnt vmcnt(0)
pc_30:
  v_cmp_gt_u32 vcc, s34, v203
  s_nop 0
  s_and_b32 vcc_lo, vcc_lo, 0x7
  s_and_b32 vcc_hi, vcc_hi, 0x0
  s_cmp_eq_u64 vcc, 0
  s_cbranch_scc1 po_29
  s_sleep 4
  s_branch pw_28
po_29:
  s_add_u32 s26, s26, 1
  s_and_b32 s28, s26, 7
  s_mul_i32 s28, s28, 147456
  s_add_u32 s32, s50, s28
  v_mov_b32 v208, s26
  s_add_u32 s30, s33, 4096
  s_add_u32 s45, s32, 4096
  s_add_u32 s46, s32, 8192
  v_mfma_f32_16x16x32_bf16 v[52:55], a[192:195], a[0:3], 0
  v_mfma_f32_16x16x32_bf16 v[56:59], a[216:219], a[0:3], 0
  v_mfma_f32_16x16x32_bf16 v[60:63], a[192:195], a[24:27], 0
  v_mfma_f32_16x16x32_bf16 v[64:67], a[216:219], a[24:27], 0
  buffer_load_dwordx4 v[4:7], v196, s[8:11], s32 offen offset:0 sc1
  v_mfma_f32_16x16x32_bf16 v[52:55], a[196:199], a[4:7], v[52:55]
  v_mfma_f32_16x16x32_bf16 v[56:59], a[220:223], a[4:7], v[56:59]
  v_mfma_f32_16x16x32_bf16 v[60:63], a[196:199], a[28:31], v[60:63]
  v_mfma_f32_16x16x32_bf16 v[64:67], a[220:223], a[28:31], v[64:67]
  buffer_load_dwordx4 v[8:11], v196, s[8:11], s32 offen offset:1024 sc1
  v_mfma_f32_16x16x32_bf16 v[52:55], a[200:203], a[8:11], v[52:55]
  v_mfma_f32_16x16x32_bf16 v[56:59], a[224:227], a[8:11], v[56:59]
  v_mfma_f32_16x16x32_bf16 v[60:63], a[200:203], a[32:35], v[60:63]
  v_mfma_f32_16x16x32_bf16 v[64:67], a[224:227], a[32:35], v[64:67]
  buffer_load_dwordx4 v[12:15], v196, s[8:11], s32 offen offset:2048 sc1
  v_mfma_f32_16x16x32_bf16 v[52:55], a[204:207], a[12:15], v[52:55]
  v_mfma_f32_16x16x32_bf16 v[56:59], a[228:231], a[12:15], v[56:59]
  v_mfma_f32_16x16x32_bf16 v[60:63], a[204:207], a[36:39], v[60:63]
  v_mfma_f32_16x16x32_bf16 v[64:67], a[228:231], a[36:39], v[64:67]
  buffer_load_dwordx4 v[16:19], v196, s[8:11], s32 offen offset:3072 sc1
  v_mfma_f32_16x16x32_bf16 v[52:55], a[208:211], a[16:19], v[52:55]
  v_mfma_f32_16x16x32_bf16 v[56:59], a[232:235], a[16:19], v[56:59]
  v_mfma_f32_16x16x32_bf16 v[60:63], a[208:211], a[40:43], v[60:63]
  v_mfma_f32_16x16x32_bf16 v[64:67], a[232:235], a[40:43], v[64:67]
  buffer_load_dwordx4 v[20:23], v196, s[8:11], s45 offen offset:0 sc1
  v_mfma_f32_16x16x32_bf16 v[52:55], a[212:215], a[20:23], v[52:55]
  v_mfma_f32_16x16x32_bf16 v[56:59], a[236:239], a[20:23], v[56:59]
  v_mfma_f32_16x16x32_bf16 v[60:63], a[212:215], a[44:47], v[60:63]
  v_mfma_f32_16x16x32_bf16 v[64:67], a[236:239], a[44:47], v[64:67]
  buffer_load_dwordx4 v[24:27], v196, s[8:11], s45 offen offset:1024 sc1
  v_mfma_f32_16x16x32_bf16 v[68:71], a[192:195], a[48:51], 0
  v_mfma_f32_16x16x32_bf16 v[72:75], a[216:219], a[48:51], 0
  v_mfma_f32_16x16x32_bf16 v[76:79], a[192:195], a[72:75], 0
  v_mfma_f32_16x16x32_bf16 v[80:83], a[216:219], a[72:75], 0
  buffer_load_dwordx4 v[28:31], v196, s[8:11], s45 offen offset:2048 sc1
  v_mfma_f32_16x16x32_bf16 v[68:71], a[196:199], a[52:55], v[68:71]
  v_cvt_pk_bf16_f32 v84, v52, v53
  v_mfma_f32_16x16x32_bf16 v[72:75], a[220:223], a[52:55], v[72:75]
  v_cvt_pk_bf16_f32 v85, v54, v55
  v_mfma_f32_16x16x32_bf16 v[76:79], a[196:199], a[76:79], v[76:79]
  v_cvt_pk_bf16_f32 v86, v56, v57
  v_mfma_f32_16x16x32_bf16 v[80:83], a[220:223], a[76:79], v[80:83]
  buffer_load_dwordx4 v[32:35], v196, s[8:11], s45 offen offset:3072 sc1
  v_mfma_f32_16x16x32_bf16 v[68:71], a[200:203], a[56:59], v[68:71]
  v_cvt_pk_bf16_f32 v87, v58, v59
  v_mfma_f32_16x16x32_bf16 v[72:75], a[224:227], a[56:59], v[72:75]
  buffer_store_dwordx4 v[84:87], v196, s[8:11], s33 offen offset:0
  v_mfma_f32_16x16x32_bf16 v[76:79], a[200:203], a[80:83], v[76:79]
  ds_write_b128 v214, v[84:87] offset:0
  v_mfma_f32_16x16x32_bf16 v[80:83], a[224:227], a[80:83], v[80:83]
  buffer_load_dwordx4 v[36:39], v196, s[8:11], s46 offen offset:0 sc1
  v_mfma_f32_16x16x32_bf16 v[68:71], a[204:207], a[60:63], v[68:71]
  v_cvt_pk_bf16_f32 v88, v60, v61
  v_mfma_f32_16x16x32_bf16 v[72:75], a[228:231], a[60:63], v[72:75]
  v_cvt_pk_bf16_f32 v89, v62, v63
  v_mfma_f32_16x16x32_bf16 v[76:79], a[204:207], a[84:87], v[76:79]
  v_cvt_pk_bf16_f32 v90, v64, v65
  v_mfma_f32_16x16x32_bf16 v[80:83], a[228:231], a[84:87], v[80:83]
  buffer_load_dwordx4 v[40:43], v196, s[8:11], s46 offen offset:1024 sc1
  v_mfma_f32_16x16x32_bf16 v[68:71], a[208:211], a[64:67], v[68:71]
  v_cvt_pk_bf16_f32 v91, v66, v67
  v_mfma_f32_16x16x32_bf16 v[72:75], a[232:235], a[64:67], v[72:75]
  buffer_store_dwordx4 v[88:91], v196, s[8:11], s33 offen offset:1024
  v_mfma_f32_16x16x32_bf16 v[76:79], a[208:211], a[88:91], v[76:79]
  ds_write_b128 v215, v[88:91] offset:1024
  v_mfma_f32_16x16x32_bf16 v[80:83], a[232:235], a[88:91], v[80:83]
  buffer_load_dwordx4 v[44:47], v196, s[8:11], s46 offen offset:2048 sc1
  v_mfma_f32_16x16x32_bf16 v[68:71], a[212:215], a[68:71], v[68:71]
  v_mfma_f32_16x16x32_bf16 v[72:75], a[236:239], a[68:71], v[72:75]
  v_mfma_f32_16x16x32_bf16 v[76:79], a[212:215], a[92:95], v[76:79]
  v_mfma_f32_16x16x32_bf16 v[80:83], a[236:239], a[92:95], v[80:83]
  buffer_load_dwordx4 v[48:51], v196, s[8:11], s46 offen offset:3072 sc1
  s_waitcnt vmcnt(14)
  s_mov_b64 exec, 1
  buffer_store_dword v208, v200, s[8:11], 0 offen sc1
  s_mov_b64 exec, -1
  v_mfma_f32_16x16x32_bf16 v[52:55], a[192:195], a[96:99], 0
  v_mfma_f32_16x16x32_bf16 v[56:59], a[216:219], a[96:99], 0
  v_mfma_f32_16x16x32_bf16 v[60:63], a[192:195], a[120:123], 0
  v_mfma_f32_16x16x32_bf16 v[64:67], a[216:219], a[120:123], 0
  v_mfma_f32_16x16x32_bf16 v[52:55], a[196:199], a[100:103], v[52:55]
  v_cvt_pk_bf16_f32 v84, v68, v69
  v_mfma_f32_16x16x32_bf16 v[56:59], a[220:223], a[100:103], v[56:59]
  v_cvt_pk_bf16_f32 v85, v70, v71
  v_mfma_f32_16x16x32_bf16 v[60:63], a[196:199], a[124:127], v[60:63]
  v_cvt_pk_bf16_f32 v86, v72, v73
  v_mfma_f32_16x16x32_bf16 v[64:67], a[220:223], a[124:127], v[64:67]
  v_cvt_pk_bf16_f32 v87, v74, v75
  v_mfma_f32_16x16x32_bf16 v[52:55], a[200:203], a[104:107], v[52:55]
  buffer_store_dwordx4 v[84:87], v196, s[8:11], s33 offen offset:2048
  v_mfma_f32_16x16x32_bf16 v[56:59], a[224:227], a[104:107], v[56:59]
  ds_write_b128 v214, v[84:87] offset:2048
  v_mfma_f32_16x16x32_bf16 v[60:63], a[200:203], a[128:131], v[60:63]
  v_cvt_pk_bf16_f32 v88, v76, v77
  v_mfma_f32_16x16x32_bf16 v[64:67], a[224:227], a[128:131], v[64:67]
  v_cvt_pk_bf16_f32 v89, v78, v79
  v_mfma_f32_16x16x32_bf16 v[52:55], a[204:207], a[108:111], v[52:55]
  v_cvt_pk_bf16_f32 v90, v80, v81
  v_mfma_f32_16x16x32_bf16 v[56:59], a[228:231], a[108:111], v[56:59]
  v_cvt_pk_bf16_f32 v91, v82, v83
  v_mfma_f32_16x16x32_bf16 v[60:63], a[204:207], a[132:135], v[60:63]
  buffer_store_dwordx4 v[88:91], v196, s[8:11], s33 offen offset:3072
  v_mfma_f32_16x16x32_bf16 v[64:67], a[228:231], a[132:135], v[64:67]
  ds_write_b128 v215, v[88:91] offset:3072
  v_mfma_f32_16x16x32_bf16 v[52:55], a[208:211], a[112:115], v[52:55]
  v_mfma_f32_16x16x32_bf16 v[56:59], a[232:235], a[112:115], v[56:59]
  v_mfma_f32_16x16x32_bf16 v[60:63], a[208:211], a[136:139], v[60:63]
  v_mfma_f32_16x16x32_bf16 v[64:67], a[232:235], a[136:139], v[64:67]
  v_mfma_f32_16x16x32_bf16 v[52:55], a[212:215], a[116:119], v[52:55]
  v_mfma_f32_16x16x32_bf16 v[56:59], a[236:239], a[116:119], v[56:59]
  v_mfma_f32_16x16x32_bf16 v[60:63], a[212:215], a[140:143], v[60:63]
  v_mfma_f32_16x16x32_bf16 v[64:67], a[236:239], a[140:143], v[64:67]
  v_mfma_f32_16x16x32_bf16 v[68:71], a[192:195], a[144:147], 0
  v_mfma_f32_16x16x32_bf16 v[72:75], a[216:219], a[144:147], 0
  v_mfma_f32_16x16x32_bf16 v[76:79], a[192:195], a[168:171], 0
  v_mfma_f32_16x16x32_bf16 v[80:83], a[216:219], a[168:171], 0
  v_mfma_f32_16x16x32_bf16 v[68:71], a[196:199], a[148:151], v[68:71]
  v_cvt_pk_bf16_f32 v84, v52, v53
  v_mfma_f32_16x16x32_bf16 v[72:75], a[220:223], a[148:151], v[72:75]
  v_cvt_pk_bf16_f32 v85, v54, v55
  v_mfma_f32_16x16x32_bf16 v[76:79], a[196:199], a[172:175], v[76:79]
  v_cvt_pk_bf16_f32 v86, v56, v57
  v_mfma_f32_16x16x32_bf16 v[80:83], a[220:223], a[172:175], v[80:83]
  v_cvt_pk_bf16_f32 v87, v58, v59
  v_mfma_f32_16x16x32_bf16 v[68:71], a[200:203], a[152:155], v[68:71]
  buffer_store_dwordx4 v[84:87], v196, s[8:11], s30 offen offset:0
  v_mfma_f32_16x16x32_bf16 v[72:75], a[224:227], a[152:155], v[72:75]
  ds_write_b128 v214, v[84:87] offset:4096
  v_mfma_f32_16x16x32_bf16 v[76:79], a[200:203], a[176:179], v[76:79]
  v_cvt_pk_bf16_f32 v88, v60, v61
  v_mfma_f32_16x16x32_bf16 v[80:83], a[224:227], a[176:179], v[80:83]
  v_cvt_pk_bf16_f32 v89, v62, v63
  v_mfma_f32_16x16x32_bf16 v[68:71], a[204:207], a[156:159], v[68:71]
  v_cvt_pk_bf16_f32 v90, v64, v65
  v_mfma_f32_16x16x32_bf16 v[72:75], a[228:231], a[156:159], v[72:75]
  v_cvt_pk_bf16_f32 v91, v66, v67
  v_mfma_f32_16x16x32_bf16 v[76:79], a[204:207], a[180:183], v[76:79]
  buffer_store_dwordx4 v[88:91], v196, s[8:11], s30 offen offset:1024
  v_mfma_f32_16x16x32_bf16 v[80:83], a[228:231], a[180:183], v[80:83]
  ds_write_b128 v215, v[88:91] offset:5120
  v_mfma_f32_16x16x32_bf16 v[68:71], a[208:211], a[160:163], v[68:71]
  v_mfma_f32_16x16x32_bf16 v[72:75], a[232:235], a[160:163], v[72:75]
  v_mfma_f32_16x16x32_bf16 v[76:79], a[208:211], a[184:187], v[76:79]
  v_mfma_f32_16x16x32_bf16 v[80:83], a[232:235], a[184:187], v[80:83]
  v_mfma_f32_16x16x32_bf16 v[68:71], a[212:215], a[164:167], v[68:71]
  v_mfma_f32_16x16x32_bf16 v[72:75], a[236:239], a[164:167], v[72:75]
  v_mfma_f32_16x16x32_bf16 v[76:79], a[212:215], a[188:191], v[76:79]
  v_mfma_f32_16x16x32_bf16 v[80:83], a[236:239], a[188:191], v[80:83]
  s_nop 4
  v_cvt_pk_bf16_f32 v84, v68, v69
  v_cvt_pk_bf16_f32 v85, v70, v71
  v_cvt_pk_bf16_f32 v86, v72, v73
  v_cvt_pk_bf16_f32 v87, v74, v75
  buffer_store_dwordx4 v[84:87], v196, s[8:11], s30 offen offset:2048
  ds_write_b128 v214, v[84:87] offset:6144
  v_cvt_pk_bf16_f32 v88, v76, v77
  v_cvt_pk_bf16_f32 v89, v78, v79
  v_cvt_pk_bf16_f32 v90, v80, v81
  v_cvt_pk_bf16_f32 v91, v82, v83
  buffer_store_dwordx4 v[88:91], v196, s[8:11], s30 offen offset:3072
  ds_write_b128 v215, v[88:91] offset:7168
  buffer_load_dword v203, v201, s[8:11], 0 offen sc1
  s_waitcnt vmcnt(0) lgkmcnt(0)
  buffer_store_dword v208, v199, s[8:11], 0 offen
  s_cmp_gt_u32 s26, 4
  s_cbranch_scc1 ua_nb1
  s_cmp_gt_u32 s26, 2
  s_cbranch_scc1 ua_nr1
  s_add_u32 s34, s26, 1
  s_mov_b32 s27, 0
  s_branch pc_33
pw_31:
  buffer_load_dword v203, v201, s[8:11], 0 offen sc1
  s_add_u32 s27, s27, 1
  s_cmp_gt_u32 s27, 65536
  s_cbranch_scc1 role_abort
  s_waitcnt vmcnt(0)
pc_33:
  v_cmp_gt_u32 vcc, s34, v203
  s_nop 0
  s_and_b32 vcc_lo, vcc_lo, 0x7
  s_and_b32 vcc_hi, vcc_hi, 0x0
  s_cmp_eq_u64 vcc, 0
  s_cbranch_scc1 po_32
  s_sleep 2
  s_branch pw_31
po_32:
  s_add_u32 s45, s32, 4096
  s_add_u32 s46, s32, 8192
  buffer_load_dwordx4 v[4:7], v196, s[8:11], s32 offen offset:0 sc1
  buffer_load_dwordx4 v[8:11], v196, s[8:11], s32 offen offset:1024 sc1
  buffer_load_dwordx4 v[12:15], v196, s[8:11], s32 offen offset:2048 sc1
  buffer_load_dwordx4 v[16:19], v196, s[8:11], s32 offen offset:3072 sc1
  buffer_load_dwordx4 v[20:23], v196, s[8:11], s45 offen offset:0 sc1
  buffer_load_dwordx4 v[24:27], v196, s[8:11], s45 offen offset:1024 sc1
  buffer_load_dwordx4 v[28:31], v196, s[8:11], s45 offen offset:2048 sc1
  buffer_load_dwordx4 v[32:35], v196, s[8:11], s45 offen offset:3072 sc1
  buffer_load_dwordx4 v[36:39], v196, s[8:11], s46 offen offset:0 sc1
  buffer_load_dwordx4 v[40:43], v196, s[8:11], s46 offen offset:1024 sc1
  buffer_load_dwordx4 v[44:47], v196, s[8:11], s46 offen offset:2048 sc1
  buffer_load_dwordx4 v[48:51], v196, s[8:11], s46 offen offset:3072 sc1
ua_nr1:
  s_cmp_eq_u32 s26, 4
  s_cbranch_scc0 ua_nb1
  s_barrier
ua_nb1:
  s_branch ua_loop0
ua_end:
  s_endpgm
role_sm:
  s_sub_u32 s20, s18, 26
  s_lshl_b32 s20, s20, 2
  s_add_u32 s20, s20, s17
  s_load_dwordx2 s[24:25], s[0:1], 8
  s_mov_b32 s26, 10240
  s_mov_b32 s27, 0x00020000
  v_lshlrev_b32 v2, 4, v1
  v_lshlrev_b32 v3, 7, v1
  v_mov_b32 v4, -1
  v_mov_b32 v5, -1
  v_mov_b32 v6, -1
  v_mov_b32 v7, -1
  v_mov_b32 v8, 0
  v_mov_b32 v9, 0
  v_mov_b32 v10, 0
  v_mov_b32 v11, 0
  v_lshrrev_b32 v12, 4, v1
  v_and_b32 v13, 15, v1
  v_lshlrev_b32 v13, 4, v13
  v_lshl_add_u32 v14, v12, 12, v13
  v_lshl_add_u32 v15, v12, 11, v13
  s_lshl_b32 s28, s16, 8
  s_cmp_lg_u32 s20, 4
  s_cbranch_scc1 boot_nf
  buffer_load_dwordx4 v[40:43], v14, s[8:11], s28 offen sc1
  s_waitcnt vmcnt(0)
  buffer_store_dwordx4 v[8:11], v14, s[8:11], s28 offen
  s_lshl_b32 s30, s16, 2
  s_add_u32 s30, s30, 32
  v_mov_b32 v16, s30
  v_mov_b32 v17, 1
  s_waitcnt vmcnt(0)
  s_mov_b64 exec, 1
  buffer_atomic_add v17, v16, s[12:15], 0 offen
  s_mov_b64 exec, -1
boot_nf:
  s_lshl_b32 s29, s16, 17
  s_lshl_b32 s30, s20, 14
  s_add_u32 s29, s29, s30
  s_add_u32 s29, s29, 3407872
  buffer_load_dword v44, v3, s[8:11], s29 offen sc1
  s_add_u32 s30, s29, 8192
  buffer_load_dword v45, v3, s[8:11], s30 offen sc1
  v_bfe_u32 v13, v1, 5, 1
  v_lshlrev_b32 v12, 6, v13
  v_bfe_u32 v13, v1, 4, 1
  v_lshl_add_u32 v12, v13, 4, v12
  v_bfe_u32 v13, v1, 1, 1
  v_lshl_add_u32 v12, v13, 2, v12
  v_bfe_u32 v13, v1, 2, 2
  v_lshlrev_b32 v13, 1, v13
  v_and_b32 v18, 1, v1
  v_add_u32 v13, v13, v18
  v_mul_u32_u24 v13, 1280, v13
  v_add_u32 v12, v12, v13
  s_waitcnt lgkmcnt(0)
  s_mov_b32 s31, s20
  s_lshl_b32 s30, s31, 7
  buffer_load_dword v20, v12, s[24:27], s30 offen
  buffer_load_dword v21, v12, s[24:27], s30 offen offset:32
  buffer_load_dword v22, v12, s[24:27], s30 offen offset:8
  buffer_load_dword v23, v12, s[24:27], s30 offen offset:40
  s_lshl_b32 s31, s31, 10
  s_mul_i32 s30, s16, 10240
  s_add_u32 s32, s31, s30
  s_add_u32 s32, s32, 131072
  s_add_u32 s33, s32, 81920
  buffer_load_dwordx4 v[46:49], v2, s[8:11], s32 offen sc1
  buffer_load_dwordx4 v[50:53], v2, s[8:11], s33 offen sc1
  s_add_u32 s36, s32, 163840
  s_add_u32 s37, s32, 245760
  buffer_load_dwordx4 v[46:49], v2, s[8:11], s36 offen sc1
  buffer_load_dwordx4 v[50:53], v2, s[8:11], s37 offen sc1
  s_add_u32 s31, s20, 8
  s_min_u32 s31, s31, 9
  s_lshl_b32 s30, s31, 7
  buffer_load_dword v24, v12, s[24:27], s30 offen
  buffer_load_dword v25, v12, s[24:27], s30 offen offset:32
  buffer_load_dword v26, v12, s[24:27], s30 offen offset:8
  buffer_load_dword v27, v12, s[24:27], s30 offen offset:40
  s_lshl_b32 s31, s31, 10
  s_mul_i32 s30, s16, 10240
  s_add_u32 s34, s31, s30
  s_add_u32 s34, s34, 131072
  s_add_u32 s35, s34, 81920
  buffer_load_dwordx4 v[46:49], v2, s[8:11], s34 offen sc1
  buffer_load_dwordx4 v[50:53], v2, s[8:11], s35 offen sc1
  s_add_u32 s38, s34, 163840
  s_add_u32 s39, s34, 245760
  buffer_load_dwordx4 v[46:49], v2, s[8:11], s38 offen sc1
  buffer_load_dwordx4 v[50:53], v2, s[8:11], s39 offen sc1
  s_waitcnt vmcnt(0)
  buffer_store_dwordx4 v[20:23], v2, s[8:11], s32 offen
  buffer_store_dwordx4 v[4:7], v2, s[8:11], s33 offen
  buffer_store_dwordx4 v[4:7], v2, s[8:11], s36 offen
  buffer_store_dwordx4 v[4:7], v2, s[8:11], s37 offen
  buffer_store_dwordx4 v[24:27], v2, s[8:11], s34 offen
  buffer_store_dwordx4 v[4:7], v2, s[8:11], s35 offen
  buffer_store_dwordx4 v[4:7], v2, s[8:11], s38 offen
  buffer_store_dwordx4 v[4:7], v2, s[8:11], s39 offen
  buffer_store_dwordx4 v[4:7], v2, s[8:11], s29 offen offset:0
  buffer_store_dwordx4 v[4:7], v2, s[8:11], s29 offen offset:1024
  buffer_store_dwordx4 v[4:7], v2, s[8:11], s29 offen offset:2048
  buffer_store_dwordx4 v[4:7], v2, s[8:11], s29 offen offset:3072
  s_add_u32 s29, s29, 4096
  buffer_store_dwordx4 v[4:7], v2, s[8:11], s29 offen offset:0
  buffer_store_dwordx4 v[4:7], v2, s[8:11], s29 offen offset:1024
  buffer_store_dwordx4 v[4:7], v2, s[8:11], s29 offen offset:2048
  buffer_store_dwordx4 v[4:7], v2, s[8:11], s29 offen offset:3072
  s_add_u32 s29, s29, 4096
  buffer_store_dwordx4 v[4:7], v2, s[8:11], s29 offen offset:0
  buffer_store_dwordx4 v[4:7], v2, s[8:11], s29 offen offset:1024
  buffer_store_dwordx4 v[4:7], v2, s[8:11], s29 offen offset:2048
  buffer_store_dwordx4 v[4:7], v2, s[8:11], s29 offen offset:3072
  s_add_u32 s29, s29, 4096
  buffer_store_dwordx4 v[4:7], v2, s[8:11], s29 offen offset:0
  buffer_store_dwordx4 v[4:7], v2, s[8:11], s29 offen offset:1024
  buffer_store_dwordx4 v[4:7], v2, s[8:11], s29 offen offset:2048
  buffer_store_dwordx4 v[4:7], v2, s[8:11], s29 offen offset:3072
  s_add_u32 s29, s29, 4096
  s_mul_i32 s30, s20, 81920
  s_add_u32 s30, s30, s28
  s_add_u32 s30, s30, 16777216
  buffer_store_dwordx4 v[4:7], v15, s[8:11], s30 offen sc1
  s_add_u32 s30, s30, 8192
  buffer_store_dwordx4 v[4:7], v15, s[8:11], s30 offen sc1
  s_add_u32 s30, s30, 8192
  buffer_store_dwordx4 v[4:7], v15, s[8:11], s30 offen sc1
  s_add_u32 s30, s30, 8192
  buffer_store_dwordx4 v[4:7], v15, s[8:11], s30 offen sc1
  s_add_u32 s30, s30, 8192
  buffer_store_dwordx4 v[4:7], v15, s[8:11], s30 offen sc1
  s_add_u32 s30, s30, 8192
  buffer_store_dwordx4 v[4:7], v15, s[8:11], s30 offen sc1
  s_add_u32 s30, s30, 8192
  buffer_store_dwordx4 v[4:7], v15, s[8:11], s30 offen sc1
  s_add_u32 s30, s30, 8192
  buffer_store_dwordx4 v[4:7], v15, s[8:11], s30 offen sc1
  s_add_u32 s30, s30, 8192
  buffer_store_dwordx4 v[4:7], v15, s[8:11], s30 offen sc1
  s_add_u32 s30, s30, 8192
  buffer_store_dwordx4 v[4:7], v15, s[8:11], s30 offen sc1
  s_add_u32 s30, s30, 8192
  v_lshrrev_b32 v12, 3, v1
  v_and_b32 v13, 7, v1
  v_lshlrev_b32 v13, 4, v13
  v_lshl_add_u32 v12, v12, 10, v13
  s_lshl_b32 s30, s20, 13
  s_lshl_b32 s31, s16, 7
  s_add_u32 s30, s30, s31
  s_add_u32 s30, s30, 2162688
  buffer_store_dwordx4 v[4:7], v12, s[8:11], s30 offen sc1
  s_waitcnt vmcnt(0)
  s_barrier
  s_cmp_lg_u32 s17, 0
  s_cbranch_scc1 boot_ng
  v_mov_b32 v16, 192
  v_mov_b32 v17, 1
  s_waitcnt vmcnt(0)
  s_mov_b64 exec, 1
  buffer_atomic_add v17, v16, s[12:15], 0 offen sc1
  s_mov_b64 exec, -1
boot_ng:
  s_lshl_b32 s28, s16, 22
  s_lshl_b32 s29, s20, 13
  s_add_u32 s28, s28, s29
  s_add_u32 s28, s28, 67108864
  s_add_u32 s29, s28, 0
  buffer_load_dword v20, v3, s[8:11], s29 offen sc1
  s_add_u32 s29, s28, 2023424
  buffer_load_dword v21, v3, s[8:11], s29 offen sc1
  s_waitcnt vmcnt(2)
  s_add_u32 s29, s28, 147456
  buffer_load_dword v22, v3, s[8:11], s29 offen sc1
  s_add_u32 s29, s28, 1341440
  buffer_load_dword v23, v3, s[8:11], s29 offen sc1
  s_waitcnt vmcnt(2)
  s_add_u32 s29, s28, 344064
  buffer_load_dword v24, v3, s[8:11], s29 offen sc1
  s_add_u32 s29, s28, 376832
  buffer_load_dword v25, v3, s[8:11], s29 offen sc1
  s_waitcnt vmcnt(2)
  s_add_u32 s29, s28, 1634304
  buffer_load_dword v26, v3, s[8:11], s29 offen sc1
  s_add_u32 s29, s28, 1699840
  buffer_load_dword v27, v3, s[8:11], s29 offen sc1
  s_waitcnt vmcnt(2)
  s_add_u32 s29, s28, 1732608
  buffer_load_dword v28, v3, s[8:11], s29 offen sc1
  s_add_u32 s29, s28, 294912
  buffer_load_dword v29, v3, s[8:11], s29 offen sc1
  s_waitcnt vmcnt(2)
  s_add_u32 s29, s28, 1568768
  buffer_load_dword v30, v3, s[8:11], s29 offen sc1
  s_add_u32 s29, s28, 491520
  buffer_load_dword v31, v3, s[8:11], s29 offen sc1
  s_waitcnt vmcnt(2)
  s_add_u32 s29, s28, 524288
  buffer_load_dword v32, v3, s[8:11], s29 offen sc1
  s_add_u32 s29, s28, 1861632
  buffer_load_dword v33, v3, s[8:11], s29 offen sc1
  s_waitcnt vmcnt(2)
  s_add_u32 s29, s28, 1927168
  buffer_load_dword v34, v3, s[8:11], s29 offen sc1
  s_add_u32 s29, s28, 1959936
  buffer_load_dword v35, v3, s[8:11], s29 offen sc1
  s_waitcnt vmcnt(2)
  s_add_u32 s29, s28, 442368
  buffer_load_dword v36, v3, s[8:11], s29 offen sc1
  s_add_u32 s29, s28, 1796096
  buffer_load_dword v37, v3, s[8:11], s29 offen sc1
  s_waitcnt vmcnt(2)
  s_lshr_b32 s21, s20, 1
  s_and_b32 s22, s20, 1
  s_lshl_b32 s23, s16, 2
  s_add_u32 s23, s23, s21
  v_lshlrev_b32 v128, 4, v1
  v_bfe_u32 v135, v1, 2, 2
  v_and_b32 v136, 1, v1
  v_lshl_add_u32 v135, v135, 1, v136
  v_lshrrev_b32 v136, 4, v1
  v_lshl_add_u32 v135, v136, 3, v135
  v_lshlrev_b32 v129, 4, v135
  v_and_b32 v135, 15, v1
  s_lshl_b32 s26, s22, 4
  v_add_u32 v135, s26, v135
  v_lshlrev_b32 v136, 2, v136
  v_sub_u32 v135, v135, v136
  v_mov_b32 v136, 0
  v_mov_b32 v137, 0xf149f2ca
  v_cmp_le_i32 vcc, 0, v135
  s_nop 1
  v_cndmask_b32 v112, v137, v136, vcc
  v_cmp_le_i32 vcc, 1, v135
  s_nop 1
  v_cndmask_b32 v113, v137, v136, vcc
  v_cmp_le_i32 vcc, 2, v135
  s_nop 1
  v_cndmask_b32 v114, v137, v136, vcc
  v_cmp_le_i32 vcc, 3, v135
  s_nop 1
  v_cndmask_b32 v115, v137, v136, vcc
  v_cmp_le_i32 vcc, 16, v135
  s_nop 1
  v_cndmask_b32 v116, v137, v136, vcc
  v_cmp_le_i32 vcc, 17, v135
  s_nop 1
  v_cndmask_b32 v117, v137, v136, vcc
  v_cmp_le_i32 vcc, 18, v135
  s_nop 1
  v_cndmask_b32 v118, v137, v136, vcc
  v_cmp_le_i32 vcc, 19, v135
  s_nop 1
  v_cndmask_b32 v119, v137, v136, vcc
  v_mov_b32 v124, 0x3d93cd3a
  v_mov_b32 v125, 0x3d93cd3a
  s_lshl_b32 s26, s16, 8
  v_lshl_add_u32 v130, v1, 2, s26
  v_add_u32 v131, 4096, v130
  s_mul_i32 s27, s21, 12
  v_add_u32 v130, s27, v130
  s_lshl_b32 s27, s20, 2
  s_add_u32 s26, s26, s27
  s_add_u32 s26, s26, 12288
  v_mov_b32 v132, s26
  s_lshl_b32 s28, s16, 22
  s_add_u32 s28, s28, 67108864
  s_mul_i32 s35, s21, 12288
  s_add_u32 s35, s35, s28
  s_mul_i32 s26, s22, 6144
  s_add_u32 s36, s35, s26
  s_add_u32 s35, s35, 49152
  s_mul_i32 s37, s21, 3072
  s_add_u32 s37, s37, s28
  s_add_u32 s37, s37, 1384448
  s_lshl_b32 s26, s22, 10
  s_add_u32 s28, s28, s26
  s_lshl_b32 s38, s21, 11
  s_add_u32 s38, s38, s28
  s_add_u32 s38, s38, 1396736
  s_lshl_b32 s39, s21, 2
  s_add_u32 s39, s39, s28
  s_add_u32 s39, s39, 1404928
  s_mov_b32 s34, 1
  v_mov_b32 v133, 0
  s_waitcnt vmcnt(0)
  s_lshl_b32 s25, s16, 2
  s_add_u32 s25, s25, 32
  v_mov_b32 v135, s25
  s_mov_b32 s25, 0
  s_mov_b64 exec, 1
gw_34:
  buffer_load_dword v136, v135, s[12:15], 0 offen sc1
  s_add_u32 s25, s25, 1
  s_cmp_gt_u32 s25, 65536
  s_cbranch_scc1 role_abort
  s_waitcnt vmcnt(0)
  v_cmp_gt_u32 vcc, 2, v136
  s_cbranch_vccz gk_35
  s_sleep 8
  s_branch gw_34
gk_35:
  s_mov_b64 exec, -1
sm_loop:
  s_sub_u32 s24, s34, 1
  s_and_b32 s26, s24, 7
  s_mul_i32 s26, s26, 147456
  s_add_u32 s30, s35, s26
  s_add_u32 s29, s36, s26
  s_and_b32 s26, s24, 3
  s_mul_i32 s26, s26, 227328
  s_add_u32 s31, s37, s26
  s_add_u32 s32, s38, s26
  s_add_u32 s33, s39, s26
  s_mov_b32 s25, 0
  s_branch pc_38
pw_36:
  buffer_load_dword v133, v130, s[8:11], 0 offen sc1
  s_add_u32 s25, s25, 1
  s_cmp_gt_u32 s25, 65536
  s_cbranch_scc1 role_abort
  s_waitcnt vmcnt(0)
pc_38:
  v_cmp_gt_u32 vcc, s34, v133
  s_nop 0
  s_and_b32 vcc_lo, vcc_lo, 0x7007
  s_and_b32 vcc_hi, vcc_hi, 0x0
  s_cmp_eq_u64 vcc, 0
  s_cbranch_scc1 po_37
  s_sleep 4
  s_branch pw_36
po_37:
  s_add_u32 s26, s30, 4096
  s_add_u32 s27, s30, 8192
  s_add_u32 s28, s29, 4096
  buffer_load_dwordx4 v[4:7], v128, s[8:11], s29 offen offset:0 sc1
  buffer_load_dwordx4 v[28:31], v128, s[8:11], s30 offen offset:0 sc1
  buffer_load_dwordx4 v[52:55], v128, s[8:11], s26 offen offset:2048 sc1
  buffer_load_dwordx4 v[8:11], v128, s[8:11], s29 offen offset:1024 sc1
  buffer_load_dwordx4 v[32:35], v128, s[8:11], s30 offen offset:1024 sc1
  buffer_load_dwordx4 v[56:59], v128, s[8:11], s26 offen offset:3072 sc1
  buffer_load_dwordx4 v[12:15], v128, s[8:11], s29 offen offset:2048 sc1
  buffer_load_dwordx4 v[36:39], v128, s[8:11], s30 offen offset:2048 sc1
  buffer_load_dwordx4 v[60:63], v128, s[8:11], s27 offen offset:0 sc1
  buffer_load_dwordx4 v[16:19], v128, s[8:11], s29 offen offset:3072 sc1
  buffer_load_dwordx4 v[40:43], v128, s[8:11], s30 offen offset:3072 sc1
  buffer_load_dwordx4 v[64:67], v128, s[8:11], s27 offen offset:1024 sc1
  buffer_load_dwordx4 v[20:23], v128, s[8:11], s28 offen offset:0 sc1
  buffer_load_dwordx4 v[44:47], v128, s[8:11], s26 offen offset:0 sc1
  buffer_load_dwordx4 v[68:71], v128, s[8:11], s27 offen offset:2048 sc1
  buffer_load_dwordx4 v[24:27], v128, s[8:11], s28 offen offset:1024 sc1
  buffer_load_dwordx4 v[48:51], v128, s[8:11], s26 offen offset:1024 sc1
  buffer_load_dwordx4 v[72:75], v128, s[8:11], s27 offen offset:3072 sc1
  buffer_load_dword v133, v130, s[8:11], 0 offen sc1
  s_waitcnt vmcnt(16)
  v_mfma_f32_16x16x32_bf16 v[100:103], v[28:31], v[4:7], 0
  v_mfma_f32_16x16x32_bf16 v[104:107], v[52:55], v[4:7], 0
  s_waitcnt vmcnt(13)
  v_mfma_f32_16x16x32_bf16 v[100:103], v[32:35], v[8:11], v[100:103]
  v_mfma_f32_16x16x32_bf16 v[104:107], v[56:59], v[8:11], v[104:107]
  s_waitcnt vmcnt(10)
  v_mfma_f32_16x16x32_bf16 v[100:103], v[36:39], v[12:15], v[100:103]
  v_mfma_f32_16x16x32_bf16 v[104:107], v[60:63], v[12:15], v[104:107]
  s_waitcnt vmcnt(7)
  v_mfma_f32_16x16x32_bf16 v[100:103], v[40:43], v[16:19], v[100:103]
  v_mfma_f32_16x16x32_bf16 v[104:107], v[64:67], v[16:19], v[104:107]
  s_waitcnt vmcnt(4)
  v_mfma_f32_16x16x32_bf16 v[100:103], v[44:47], v[20:23], v[100:103]
  v_mfma_f32_16x16x32_bf16 v[104:107], v[68:71], v[20:23], v[104:107]
  s_waitcnt vmcnt(1)
  v_mfma_f32_16x16x32_bf16 v[100:103], v[48:51], v[24:27], v[100:103]
  v_mfma_f32_16x16x32_bf16 v[104:107], v[72:75], v[24:27], v[104:107]
  s_nop 6
  v_cvt_pk_bf16_f32 v135, v100, v101
  v_lshlrev_b32 v100, 16, v135
  v_and_b32 v101, 0xffff0000, v135
  v_cvt_pk_bf16_f32 v135, v102, v103
  v_lshlrev_b32 v102, 16, v135
  v_and_b32 v103, 0xffff0000, v135
  v_cvt_pk_bf16_f32 v135, v104, v105
  v_lshlrev_b32 v104, 16, v135
  v_and_b32 v105, 0xffff0000, v135
  v_cvt_pk_bf16_f32 v135, v106, v107
  v_lshlrev_b32 v106, 16, v135
  v_and_b32 v107, 0xffff0000, v135
  v_pk_fma_f32 v[100:101], v[100:101], v[124:125], v[112:113]
  v_cvt_pk_bf16_f32 v135, v100, v101
  v_lshlrev_b32 v100, 16, v135
  v_and_b32 v101, 0xffff0000, v135
  v_pk_fma_f32 v[102:103], v[102:103], v[124:125], v[114:115]
  v_cvt_pk_bf16_f32 v135, v102, v103
  v_lshlrev_b32 v102, 16, v135
  v_and_b32 v103, 0xffff0000, v135
  v_pk_fma_f32 v[104:105], v[104:105], v[124:125], v[116:117]
  v_cvt_pk_bf16_f32 v135, v104, v105
  v_lshlrev_b32 v104, 16, v135
  v_and_b32 v105, 0xffff0000, v135
  v_pk_fma_f32 v[106:107], v[106:107], v[124:125], v[118:119]
  v_cvt_pk_bf16_f32 v135, v106, v107
  v_lshlrev_b32 v106, 16, v135
  v_and_b32 v107, 0xffff0000, v135
  v_max3_f32 v137, v100, v101, v102
  v_max3_f32 v137, v137, v103, v104
  v_max3_f32 v137, v137, v105, v106
  v_max_f32 v137, v137, v107
  s_cmp_eq_u32 s34, 6
  s_cbranch_scc1 sm_boot2
sm_b2r:
  s_mov_b32 s25, 0
pw_39:
  buffer_load_dword v134, v131, s[8:11], 0 offen sc1
  s_add_u32 s25, s25, 1
  s_cmp_gt_u32 s25, 65536
  s_cbranch_scc1 role_abort
  s_waitcnt vmcnt(0)
pc_41:
  v_cmp_gt_u32 vcc, s34, v134
  s_nop 0
  s_and_b32 vcc_lo, vcc_lo, 0xffffffff
  s_and_b32 vcc_hi, vcc_hi, 0xffff
  s_cmp_eq_u64 vcc, 0
  s_cbranch_scc1 po_40
  s_sleep 2
  s_branch pw_39
po_40:
  buffer_load_dwordx4 v[76:79], v129, s[8:11], s31 offen offset:0 sc1
  buffer_load_dwordx4 v[80:83], v129, s[8:11], s31 offen offset:512 sc1
  buffer_load_dwordx4 v[84:87], v129, s[8:11], s31 offen offset:1024 sc1
  buffer_load_dwordx4 v[88:91], v129, s[8:11], s31 offen offset:1536 sc1
  buffer_load_dwordx4 v[92:95], v129, s[8:11], s31 offen offset:2048 sc1
  buffer_load_dwordx4 v[96:99], v129, s[8:11], s31 offen offset:2560 sc1
  s_waitcnt vmcnt(5)
  v_mfma_f32_16x16x32_bf16 v[108:111], v[76:79], v[4:7], 0
  s_waitcnt vmcnt(4)
  v_mfma_f32_16x16x32_bf16 v[108:111], v[80:83], v[8:11], v[108:111]
  s_waitcnt vmcnt(3)
  v_mfma_f32_16x16x32_bf16 v[108:111], v[84:87], v[12:15], v[108:111]
  s_waitcnt vmcnt(2)
  v_mfma_f32_16x16x32_bf16 v[108:111], v[88:91], v[16:19], v[108:111]
  s_waitcnt vmcnt(1)
  v_mfma_f32_16x16x32_bf16 v[108:111], v[92:95], v[20:23], v[108:111]
  s_waitcnt vmcnt(0)
  v_mfma_f32_16x16x32_bf16 v[108:111], v[96:99], v[24:27], v[108:111]
  s_nop 7
  v_cvt_pk_bf16_f32 v135, v108, v109
  v_lshlrev_b32 v108, 16, v135
  v_and_b32 v109, 0xffff0000, v135
  v_pk_mul_f32 v[108:109], v[108:109], v[124:125]
  v_cvt_pk_bf16_f32 v135, v108, v109
  v_lshlrev_b32 v108, 16, v135
  v_and_b32 v109, 0xffff0000, v135
  v_max3_f32 v137, v137, v108, v109
  v_mov_b32 v136, v137
  s_nop 1
  v_permlane16_swap_b32 v137, v136
  v_max_f32 v137, v137, v136
  v_mov_b32 v136, v137
  s_nop 1
  v_permlane32_swap_b32 v137, v136
  v_max_f32 v137, v137, v136
  v_sub_f32 v100, v100, v137
  v_sub_f32 v101, v101, v137
  v_sub_f32 v102, v102, v137
  v_sub_f32 v103, v103, v137
  v_sub_f32 v104, v104, v137
  v_sub_f32 v105, v105, v137
  v_sub_f32 v106, v106, v137
  v_sub_f32 v107, v107, v137
  v_sub_f32 v108, v108, v137
  v_sub_f32 v109, v109, v137
  v_mul_f32 v100, 0x3fb8aa3b, v100
  v_mul_f32 v101, 0x3fb8aa3b, v101
  v_mul_f32 v102, 0x3fb8aa3b, v102
  v_mul_f32 v103, 0x3fb8aa3b, v103
  v_mul_f32 v104, 0x3fb8aa3b, v104
  v_mul_f32 v105, 0x3fb8aa3b, v105
  v_mul_f32 v106, 0x3fb8aa3b, v106
  v_mul_f32 v107, 0x3fb8aa3b, v107
  v_mul_f32 v108, 0x3fb8aa3b, v108
  v_mul_f32 v109, 0x3fb8aa3b, v109
  v_exp_f32 v100, v100
  v_exp_f32 v101, v101
  v_exp_f32 v102, v102
  v_exp_f32 v103, v103
  v_exp_f32 v104, v104
  v_exp_f32 v105, v105
  v_exp_f32 v106, v106
  v_exp_f32 v107, v107
  v_exp_f32 v108, v108
  v_exp_f32 v109, v109
  v_pk_add_f32 v[126:127], v[100:101], v[102:103]
  v_pk_add_f32 v[110:111], v[104:105], v[106:107]
  v_pk_add_f32 v[126:127], v[126:127], v[108:109]
  v_pk_add_f32 v[126:127], v[126:127], v[110:111]
  v_add_f32 v137, v126, v127
  v_mov_b32 v136, v137
  s_nop 1
  v_permlane16_swap_b32 v137, v136
  v_add_f32 v137, v137, v136
  v_mov_b32 v136, v137
  s_nop 1
  v_permlane32_swap_b32 v137, v136
  v_add_f32 v137, v137, v136
  v_rcp_f32 v126, v137
  s_nop 0
  v_mov_b32 v127, v126
  v_pk_mul_f32 v[100:101], v[100:101], v[126:127]
  v_cvt_pk_bf16_f32 v120, v100, v101
  v_pk_mul_f32 v[102:103], v[102:103], v[126:127]
  v_cvt_pk_bf16_f32 v121, v102, v103
  v_pk_mul_f32 v[104:105], v[104:105], v[126:127]
  v_cvt_pk_bf16_f32 v122, v104, v105
  v_pk_mul_f32 v[106:107], v[106:107], v[126:127]
  v_cvt_pk_bf16_f32 v123, v106, v107
  v_pk_mul_f32 v[108:109], v[108:109], v[126:127]
  buffer_store_dwordx4 v[120:123], v128, s[8:11], s32 offen
  v_cvt_pk_bf16_f32 v138, v108, v109
  buffer_store_dword v138, v128, s[8:11], s33 offen
  v_mov_b32 v137, s34
  s_add_u32 s34, s34, 1
  s_waitcnt vmcnt(0)
  buffer_store_dword v137, v132, s[8:11], 0 offen
  s_cmp_le_u32 s34, 64
  s_cbranch_scc1 sm_loop
  s_endpgm
sm_boot2:
  v_mov_b32 v76, -1
  v_mov_b32 v77, -1
  v_mov_b32 v78, -1
  v_mov_b32 v79, -1
  s_lshl_b32 s27, s16, 3
  s_add_u32 s27, s27, s20
  s_lshl_b32 s26, s27, 10
  s_add_u32 s26, s26, 2097152
  buffer_store_dwordx4 v[76:79], v128, s[8:11], s26 offen sc1
  s_mul_i32 s26, s27, 15360
  s_add_u32 s26, s26, 2326528
  buffer_store_dwordx4 v[76:79], v128, s[8:11], s26 offen sc1
  s_add_u32 s26, s26, 1024
  buffer_store_dwordx4 v[76:79], v128, s[8:11], s26 offen sc1
  s_add_u32 s26, s26, 1024
  buffer_store_dwordx4 v[76:79], v128, s[8:11], s26 offen sc1
  s_add_u32 s26, s26, 1024
  buffer_store_dwordx4 v[76:79], v128, s[8:11], s26 offen sc1
  s_add_u32 s26, s26, 1024
  buffer_store_dwordx4 v[76:79], v128, s[8:11], s26 offen sc1
  s_add_u32 s26, s26, 1024
  buffer_store_dwordx4 v[76:79], v128, s[8:11], s26 offen sc1
  s_add_u32 s26, s26, 1024
  buffer_store_dwordx4 v[76:79], v128, s[8:11], s26 offen sc1
  s_add_u32 s26, s26, 1024
  buffer_store_dwordx4 v[76:79], v128, s[8:11], s26 offen sc1
  s_add_u32 s26, s26, 1024
  buffer_store_dwordx4 v[76:79], v128, s[8:11], s26 offen sc1
  s_add_u32 s26, s26, 1024
  buffer_store_dwordx4 v[76:79], v128, s[8:11], s26 offen sc1
  s_add_u32 s26, s26, 1024
  buffer_store_dwordx4 v[76:79], v128, s[8:11], s26 offen sc1
  s_add_u32 s26, s26, 1024
  buffer_store_dwordx4 v[76:79], v128, s[8:11], s26 offen sc1
  s_add_u32 s26, s26, 1024
  buffer_store_dwordx4 v[76:79], v128, s[8:11], s26 offen sc1
  s_add_u32 s26, s26, 1024
  buffer_store_dwordx4 v[76:79], v128, s[8:11], s26 offen sc1
  s_add_u32 s26, s26, 1024
  buffer_store_dwordx4 v[76:79], v128, s[8:11], s26 offen sc1
  s_add_u32 s26, s26, 1024
  v_mov_b32 v135, 196
  v_mov_b32 v136, 1
  s_waitcnt vmcnt(0)
  s_mov_b64 exec, 1
  buffer_atomic_add v136, v135, s[12:15], 0 offen sc1
  s_mov_b64 exec, -1
  s_branch sm_b2r
role_r:
  s_load_dwordx2 s[20:21], s[0:1], 0
  s_mov_b32 s22, 2621440
  s_mov_b32 s23, 0x00020000
  s_load_dwordx2 s[24:25], s[0:1], 112
  s_mov_b32 s26, 2621440
  s_mov_b32 s27, 0x00020000
  s_load_dwordx2 s[28:29], s[0:1], 64
  s_mov_b32 s30, 1280
  s_mov_b32 s31, 0x00020000
  s_load_dwordx2 s[44:45], s[0:1], 96
  s_mov_b32 s46, 1280
  s_mov_b32 s47, 0x00020000
  s_load_dwordx2 s[48:49], s[0:1], 104
  s_mov_b32 s50, 4915200
  s_mov_b32 s51, 0x00020000
  s_sub_u32 s32, s18, 28
  s_sub_u32 s52, 3, s32
  s_lshl_b32 s52, s52, 3
  s_add_u32 s52, s52, s16
  s_lshl_b32 s32, s32, 2
  s_add_u32 s32, s32, s17
  s_mul_i32 s38, s16, 2621440
  s_lshl_b32 s35, s32, 13
  s_add_u32 s35, s35, s38
  s_add_u32 s35, s35, 247463936
  v_lshlrev_b32 v2, 7, v1
  buffer_load_dword v3, v2, s[8:11], s35 offen sc1
  s_waitcnt lgkmcnt(0)
  v_lshlrev_b32 v226, 2, v1
  s_mul_i32 s37, s32, 5120
  v_and_b32 v90, 3, v1
  v_lshrrev_b32 v91, 2, v1
  v_mul_u32_u24 v160, 1280, v90
  v_lshl_add_u32 v160, v91, 4, v160
  buffer_load_dwordx4 v[100:103], v160, s[20:23], s37 offen offset:0
  buffer_load_dwordx4 v[104:107], v160, s[20:23], s37 offen offset:256
  buffer_load_dwordx4 v[108:111], v160, s[20:23], s37 offen offset:512
  buffer_load_dwordx4 v[112:115], v160, s[20:23], s37 offen offset:768
  buffer_load_dwordx4 v[116:119], v160, s[20:23], s37 offen offset:1024
  s_add_u32 s37, s37, 81920
  s_min_u32 s37, s37, 2616320
  buffer_load_dwordx4 v[120:123], v160, s[20:23], s37 offen offset:0
  buffer_load_dwordx4 v[124:127], v160, s[20:23], s37 offen offset:256
  buffer_load_dwordx4 v[128:131], v160, s[20:23], s37 offen offset:512
  buffer_load_dwordx4 v[132:135], v160, s[20:23], s37 offen offset:768
  buffer_load_dwordx4 v[136:139], v160, s[20:23], s37 offen offset:1024
  s_add_u32 s37, s37, 81920
  s_min_u32 s37, s37, 2616320
  s_add_u32 s35, s35, 131072
  buffer_load_dword a101, v2, s[8:11], s35 offen sc1
  v_lshlrev_b32 v161, 4, v90
  v_lshl_add_u32 v161, v91, 8, v161
  v_lshrrev_b32 v92, 1, v90
  v_mul_u32_u24 v162, 2528, v92
  v_lshl_add_u32 v162, v90, 4, v162
  v_lshl_add_u32 v162, v91, 5, v162
  v_cvt_f32_u32 v163, v92
  s_lshl_b32 s35, s16, 22
  s_lshl_b32 s36, s32, 13
  s_add_u32 s35, s35, s36
  s_add_u32 s35, s35, 68288512
  s_mov_b32 s36, 131072
  s_mov_b32 s53, 227328
  s_cmp_lt_u32 s32, 4
  s_cselect_b32 s36, s36, 4293804032
  s_cselect_b32 s53, s53, 147456
  s_add_u32 s36, s36, s35
  buffer_load_dword a100, v2, s[8:11], s36 offen sc1
  buffer_load_dword a100, v2, s[8:11], s35 offen sc1
  s_add_u32 s35, s35, 227328
  s_add_u32 s36, s36, s53
  buffer_load_dword a100, v2, s[8:11], s36 offen sc1
  buffer_load_dword a100, v2, s[8:11], s35 offen sc1
  s_add_u32 s35, s35, 227328
  s_add_u32 s36, s36, s53
  v_lshlrev_b32 v227, 3, v1
  s_lshl_b32 s35, s16, 8
  s_lshl_b32 s36, s32, 2
  s_add_u32 s35, s35, s36
  s_add_u32 s35, s35, 8192
  v_mov_b32 v228, s35
  v_mov_b32 v230, 0x00003f80
  v_mov_b32 v231, 0x3f800000
  s_mul_i32 s38, s16, 2621440
  s_add_u32 s38, s38, 247463936
  s_lshr_b32 s35, s32, 2
  s_mul_i32 s35, s35, 20480
  s_add_u32 s38, s38, s35
  s_lshl_b32 s35, s17, 6
  s_add_u32 s38, s38, s35
  s_waitcnt lgkmcnt(0)
  s_waitcnt vmcnt(10)
  v_lshlrev_b32 v2, 16, v100
  v_and_b32 v3, 0xffff0000, v100
  v_lshlrev_b32 v4, 16, v101
  v_and_b32 v5, 0xffff0000, v101
  v_lshlrev_b32 v6, 16, v102
  v_and_b32 v7, 0xffff0000, v102
  v_lshlrev_b32 v8, 16, v103
  v_and_b32 v9, 0xffff0000, v103
  v_lshlrev_b32 v10, 16, v104
  v_and_b32 v11, 0xffff0000, v104
  v_lshlrev_b32 v12, 16, v105
  v_and_b32 v13, 0xffff0000, v105
  v_lshlrev_b32 v14, 16, v106
  v_and_b32 v15, 0xffff0000, v106
  v_lshlrev_b32 v16, 16, v107
  v_and_b32 v17, 0xffff0000, v107
  v_lshlrev_b32 v18, 16, v108
  v_and_b32 v19, 0xffff0000, v108
  v_lshlrev_b32 v20, 16, v109
  v_and_b32 v21, 0xffff0000, v109
  v_lshlrev_b32 v22, 16, v110
  v_and_b32 v23, 0xffff0000, v110
  v_lshlrev_b32 v24, 16, v111
  v_and_b32 v25, 0xffff0000, v111
  v_lshlrev_b32 v26, 16, v112
  v_and_b32 v27, 0xffff0000, v112
  v_lshlrev_b32 v28, 16, v113
  v_and_b32 v29, 0xffff0000, v113
  v_lshlrev_b32 v30, 16, v114
  v_and_b32 v31, 0xffff0000, v114
  v_lshlrev_b32 v32, 16, v115
  v_and_b32 v33, 0xffff0000, v115
  v_lshlrev_b32 v34, 16, v116
  v_and_b32 v35, 0xffff0000, v116
  v_lshlrev_b32 v36, 16, v117
  v_and_b32 v37, 0xffff0000, v117
  v_lshlrev_b32 v38, 16, v118
  v_and_b32 v39, 0xffff0000, v118
  v_lshlrev_b32 v40, 16, v119
  v_and_b32 v41, 0xffff0000, v119
  v_pk_add_f32 v[86:87], v[2:3], v[4:5]
  v_pk_add_f32 v[88:89], v[6:7], v[8:9]
  v_pk_add_f32 v[86:87], v[86:87], v[10:11]
  v_pk_add_f32 v[88:89], v[88:89], v[12:13]
  v_pk_add_f32 v[86:87], v[86:87], v[14:15]
  v_pk_add_f32 v[88:89], v[88:89], v[16:17]
  v_pk_add_f32 v[86:87], v[86:87], v[18:19]
  v_pk_add_f32 v[88:89], v[88:89], v[20:21]
  v_pk_add_f32 v[86:87], v[86:87], v[22:23]
  v_pk_add_f32 v[88:89], v[88:89], v[24:25]
  v_pk_add_f32 v[86:87], v[86:87], v[26:27]
  v_pk_add_f32 v[88:89], v[88:89], v[28:29]
  v_pk_add_f32 v[86:87], v[86:87], v[30:31]
  v_pk_add_f32 v[88:89], v[88:89], v[32:33]
  v_pk_add_f32 v[86:87], v[86:87], v[34:35]
  v_pk_add_f32 v[88:89], v[88:89], v[36:37]
  v_pk_add_f32 v[86:87], v[86:87], v[38:39]
  v_pk_add_f32 v[88:89], v[88:89], v[40:41]
  v_pk_add_f32 v[86:87], v[86:87], v[88:89]
  v_add_f32 v86, v86, v87
  s_nop 1
  v_add_f32_dpp v86, v86, v86 row_ror:8 row_mask:0xf bank_mask:0xf
  s_nop 1
  v_add_f32_dpp v86, v86, v86 row_ror:4 row_mask:0xf bank_mask:0xf
  v_mov_b32 v90, v86
  s_nop 1
  v_permlane16_swap_b32 v86, v90
  v_add_f32 v86, v86, v90
  v_mov_b32 v90, v86
  s_nop 1
  v_permlane32_swap_b32 v86, v90
  v_add_f32 v86, v86, v90
  v_mul_f32 v88, 0xbacccccd, v86
  v_mul_f32 v89, 0xbacccccd, v86
  v_pk_add_f32 v[164:165], v[2:3], v[88:89]
  v_pk_add_f32 v[166:167], v[4:5], v[88:89]
  v_pk_mul_f32 v[170:171], v[164:165], v[164:165]
  v_pk_add_f32 v[168:169], v[6:7], v[88:89]
  v_pk_mul_f32 v[86:87], v[166:167], v[166:167]
  v_pk_add_f32 v[164:165], v[8:9], v[88:89]
  v_pk_fma_f32 v[170:171], v[168:169], v[168:169], v[170:171]
  v_pk_add_f32 v[166:167], v[10:11], v[88:89]
  v_pk_fma_f32 v[86:87], v[164:165], v[164:165], v[86:87]
  v_pk_add_f32 v[168:169], v[12:13], v[88:89]
  v_pk_fma_f32 v[170:171], v[166:167], v[166:167], v[170:171]
  v_pk_add_f32 v[164:165], v[14:15], v[88:89]
  v_pk_fma_f32 v[86:87], v[168:169], v[168:169], v[86:87]
  v_pk_add_f32 v[166:167], v[16:17], v[88:89]
  v_pk_fma_f32 v[170:171], v[164:165], v[164:165], v[170:171]
  v_pk_add_f32 v[168:169], v[18:19], v[88:89]
  v_pk_fma_f32 v[86:87], v[166:167], v[166:167], v[86:87]
  v_pk_add_f32 v[164:165], v[20:21], v[88:89]
  v_pk_fma_f32 v[170:171], v[168:169], v[168:169], v[170:171]
  v_pk_add_f32 v[166:167], v[22:23], v[88:89]
  v_pk_fma_f32 v[86:87], v[164:165], v[164:165], v[86:87]
  v_pk_add_f32 v[168:169], v[24:25], v[88:89]
  v_pk_fma_f32 v[170:171], v[166:167], v[166:167], v[170:171]
  v_pk_add_f32 v[164:165], v[26:27], v[88:89]
  v_pk_fma_f32 v[86:87], v[168:169], v[168:169], v[86:87]
  v_pk_add_f32 v[166:167], v[28:29], v[88:89]
  v_pk_fma_f32 v[170:171], v[164:165], v[164:165], v[170:171]
  v_pk_add_f32 v[168:169], v[30:31], v[88:89]
  v_pk_fma_f32 v[86:87], v[166:167], v[166:167], v[86:87]
  v_pk_add_f32 v[164:165], v[32:33], v[88:89]
  v_pk_fma_f32 v[170:171], v[168:169], v[168:169], v[170:171]
  v_pk_add_f32 v[166:167], v[34:35], v[88:89]
  v_pk_fma_f32 v[86:87], v[164:165], v[164:165], v[86:87]
  v_pk_add_f32 v[168:169], v[36:37], v[88:89]
  v_pk_fma_f32 v[170:171], v[166:167], v[166:167], v[170:171]
  v_pk_add_f32 v[164:165], v[38:39], v[88:89]
  v_pk_fma_f32 v[86:87], v[168:169], v[168:169], v[86:87]
  v_pk_add_f32 v[166:167], v[40:41], v[88:89]
  v_pk_fma_f32 v[170:171], v[164:165], v[164:165], v[170:171]
  v_pk_fma_f32 v[86:87], v[166:167], v[166:167], v[86:87]
  v_cvt_pk_bf16_f32 v91, v88, v89
  v_lshlrev_b32 v88, 16, v91
  v_and_b32 v89, 0xffff0000, v91
  v_pk_add_f32 v[86:87], v[86:87], v[170:171]
  v_add_f32 v86, v86, v87
  s_nop 1
  v_add_f32_dpp v86, v86, v86 row_ror:8 row_mask:0xf bank_mask:0xf
  s_nop 1
  v_add_f32_dpp v86, v86, v86 row_ror:4 row_mask:0xf bank_mask:0xf
  v_mov_b32 v90, v86
  s_nop 1
  v_permlane16_swap_b32 v86, v90
  v_add_f32 v86, v86, v90
  v_mov_b32 v90, v86
  s_nop 1
  v_permlane32_swap_b32 v86, v90
  v_add_f32 v86, v86, v90
  v_pk_add_f32 v[2:3], v[2:3], v[88:89]
  v_mul_f32 v86, 0x3acccccd, v86
  v_pk_add_f32 v[4:5], v[4:5], v[88:89]
  v_cvt_pk_bf16_f32 v86, v86, v86
  v_pk_add_f32 v[6:7], v[6:7], v[88:89]
  v_lshlrev_b32 v86, 16, v86
  v_pk_add_f32 v[8:9], v[8:9], v[88:89]
  v_add_f32 v86, 0x3727c5ac, v86
  v_pk_add_f32 v[10:11], v[10:11], v[88:89]
  v_cvt_pk_bf16_f32 v86, v86, v86
  v_pk_add_f32 v[12:13], v[12:13], v[88:89]
  v_lshlrev_b32 v86, 16, v86
  v_pk_add_f32 v[14:15], v[14:15], v[88:89]
  v_sqrt_f32 v86, v86
  v_pk_add_f32 v[16:17], v[16:17], v[88:89]
  v_cvt_pk_bf16_f32 v86, v86, v86
  v_pk_add_f32 v[18:19], v[18:19], v[88:89]
  v_lshlrev_b32 v86, 16, v86
  v_pk_add_f32 v[20:21], v[20:21], v[88:89]
  v_rcp_f32 v86, v86
  v_pk_add_f32 v[22:23], v[22:23], v[88:89]
  v_mov_b32 v87, v86
  v_pk_add_f32 v[24:25], v[24:25], v[88:89]
  v_pk_add_f32 v[26:27], v[26:27], v[88:89]
  v_pk_add_f32 v[28:29], v[28:29], v[88:89]
  v_pk_add_f32 v[30:31], v[30:31], v[88:89]
  v_pk_add_f32 v[32:33], v[32:33], v[88:89]
  v_pk_add_f32 v[34:35], v[34:35], v[88:89]
  v_pk_add_f32 v[36:37], v[36:37], v[88:89]
  v_pk_add_f32 v[38:39], v[38:39], v[88:89]
  v_pk_add_f32 v[40:41], v[40:41], v[88:89]
  v_cvt_pk_bf16_f32 v164, v2, v3
  v_lshlrev_b32 v2, 16, v164
  v_and_b32 v3, 0xffff0000, v164
  v_cvt_pk_bf16_f32 v165, v4, v5
  v_lshlrev_b32 v4, 16, v165
  v_and_b32 v5, 0xffff0000, v165
  v_cvt_pk_bf16_f32 v166, v6, v7
  v_lshlrev_b32 v6, 16, v166
  v_and_b32 v7, 0xffff0000, v166
  v_cvt_pk_bf16_f32 v167, v8, v9
  v_lshlrev_b32 v8, 16, v167
  v_and_b32 v9, 0xffff0000, v167
  v_cvt_pk_bf16_f32 v164, v10, v11
  v_lshlrev_b32 v10, 16, v164
  v_and_b32 v11, 0xffff0000, v164
  v_cvt_pk_bf16_f32 v165, v12, v13
  v_lshlrev_b32 v12, 16, v165
  v_and_b32 v13, 0xffff0000, v165
  v_cvt_pk_bf16_f32 v166, v14, v15
  v_lshlrev_b32 v14, 16, v166
  v_and_b32 v15, 0xffff0000, v166
  v_cvt_pk_bf16_f32 v167, v16, v17
  v_lshlrev_b32 v16, 16, v167
  v_and_b32 v17, 0xffff0000, v167
  v_cvt_pk_bf16_f32 v164, v18, v19
  v_lshlrev_b32 v18, 16, v164
  v_and_b32 v19, 0xffff0000, v164
  v_cvt_pk_bf16_f32 v165, v20, v21
  v_lshlrev_b32 v20, 16, v165
  v_and_b32 v21, 0xffff0000, v165
  v_cvt_pk_bf16_f32 v166, v22, v23
  v_lshlrev_b32 v22, 16, v166
  v_and_b32 v23, 0xffff0000, v166
  v_cvt_pk_bf16_f32 v167, v24, v25
  v_lshlrev_b32 v24, 16, v167
  v_and_b32 v25, 0xffff0000, v167
  v_cvt_pk_bf16_f32 v164, v26, v27
  v_lshlrev_b32 v26, 16, v164
  v_and_b32 v27, 0xffff0000, v164
  v_cvt_pk_bf16_f32 v165, v28, v29
  v_lshlrev_b32 v28, 16, v165
  v_and_b32 v29, 0xffff0000, v165
  v_cvt_pk_bf16_f32 v166, v30, v31
  v_lshlrev_b32 v30, 16, v166
  v_and_b32 v31, 0xffff0000, v166
  v_cvt_pk_bf16_f32 v167, v32, v33
  v_lshlrev_b32 v32, 16, v167
  v_and_b32 v33, 0xffff0000, v167
  v_cvt_pk_bf16_f32 v164, v34, v35
  v_lshlrev_b32 v34, 16, v164
  v_and_b32 v35, 0xffff0000, v164
  v_cvt_pk_bf16_f32 v165, v36, v37
  v_lshlrev_b32 v36, 16, v165
  v_and_b32 v37, 0xffff0000, v165
  v_cvt_pk_bf16_f32 v166, v38, v39
  v_lshlrev_b32 v38, 16, v166
  v_and_b32 v39, 0xffff0000, v166
  v_cvt_pk_bf16_f32 v167, v40, v41
  v_lshlrev_b32 v40, 16, v167
  v_and_b32 v41, 0xffff0000, v167
  v_pk_mul_f32 v[2:3], v[2:3], v[86:87]
  v_pk_mul_f32 v[4:5], v[4:5], v[86:87]
  v_pk_mul_f32 v[6:7], v[6:7], v[86:87]
  v_pk_mul_f32 v[8:9], v[8:9], v[86:87]
  v_pk_mul_f32 v[10:11], v[10:11], v[86:87]
  v_pk_mul_f32 v[12:13], v[12:13], v[86:87]
  v_pk_mul_f32 v[14:15], v[14:15], v[86:87]
  v_pk_mul_f32 v[16:17], v[16:17], v[86:87]
  v_pk_mul_f32 v[18:19], v[18:19], v[86:87]
  v_pk_mul_f32 v[20:21], v[20:21], v[86:87]
  v_pk_mul_f32 v[22:23], v[22:23], v[86:87]
  v_pk_mul_f32 v[24:25], v[24:25], v[86:87]
  v_pk_mul_f32 v[26:27], v[26:27], v[86:87]
  v_pk_mul_f32 v[28:29], v[28:29], v[86:87]
  v_pk_mul_f32 v[30:31], v[30:31], v[86:87]
  v_pk_mul_f32 v[32:33], v[32:33], v[86:87]
  v_pk_mul_f32 v[34:35], v[34:35], v[86:87]
  v_pk_mul_f32 v[36:37], v[36:37], v[86:87]
  v_pk_mul_f32 v[38:39], v[38:39], v[86:87]
  v_pk_mul_f32 v[40:41], v[40:41], v[86:87]
  v_cvt_pk_bf16_f32 v100, v2, v3
  v_cvt_pk_bf16_f32 v101, v4, v5
  v_cvt_pk_bf16_f32 v102, v6, v7
  v_cvt_pk_bf16_f32 v103, v8, v9
  v_cvt_pk_bf16_f32 v104, v10, v11
  v_cvt_pk_bf16_f32 v105, v12, v13
  v_cvt_pk_bf16_f32 v106, v14, v15
  v_cvt_pk_bf16_f32 v107, v16, v17
  v_cvt_pk_bf16_f32 v108, v18, v19
  v_cvt_pk_bf16_f32 v109, v20, v21
  v_cvt_pk_bf16_f32 v110, v22, v23
  v_cvt_pk_bf16_f32 v111, v24, v25
  v_cvt_pk_bf16_f32 v112, v26, v27
  v_cvt_pk_bf16_f32 v113, v28, v29
  v_cvt_pk_bf16_f32 v114, v30, v31
  v_cvt_pk_bf16_f32 v115, v32, v33
  v_cvt_pk_bf16_f32 v116, v34, v35
  v_cvt_pk_bf16_f32 v117, v36, v37
  v_cvt_pk_bf16_f32 v118, v38, v39
  v_cvt_pk_bf16_f32 v119, v40, v41
  s_waitcnt vmcnt(5)
  v_lshlrev_b32 v2, 16, v120
  v_and_b32 v3, 0xffff0000, v120
  v_lshlrev_b32 v4, 16, v121
  v_and_b32 v5, 0xffff0000, v121
  v_lshlrev_b32 v6, 16, v122
  v_and_b32 v7, 0xffff0000, v122
  v_lshlrev_b32 v8, 16, v123
  v_and_b32 v9, 0xffff0000, v123
  v_lshlrev_b32 v10, 16, v124
  v_and_b32 v11, 0xffff0000, v124
  v_lshlrev_b32 v12, 16, v125
  v_and_b32 v13, 0xffff0000, v125
  v_lshlrev_b32 v14, 16, v126
  v_and_b32 v15, 0xffff0000, v126
  v_lshlrev_b32 v16, 16, v127
  v_and_b32 v17, 0xffff0000, v127
  v_lshlrev_b32 v18, 16, v128
  v_and_b32 v19, 0xffff0000, v128
  v_lshlrev_b32 v20, 16, v129
  v_and_b32 v21, 0xffff0000, v129
  v_lshlrev_b32 v22, 16, v130
  v_and_b32 v23, 0xffff0000, v130
  v_lshlrev_b32 v24, 16, v131
  v_and_b32 v25, 0xffff0000, v131
  v_lshlrev_b32 v26, 16, v132
  v_and_b32 v27, 0xffff0000, v132
  v_lshlrev_b32 v28, 16, v133
  v_and_b32 v29, 0xffff0000, v133
  v_lshlrev_b32 v30, 16, v134
  v_and_b32 v31, 0xffff0000, v134
  v_lshlrev_b32 v32, 16, v135
  v_and_b32 v33, 0xffff0000, v135
  v_lshlrev_b32 v34, 16, v136
  v_and_b32 v35, 0xffff0000, v136
  v_lshlrev_b32 v36, 16, v137
  v_and_b32 v37, 0xffff0000, v137
  v_lshlrev_b32 v38, 16, v138
  v_and_b32 v39, 0xffff0000, v138
  v_lshlrev_b32 v40, 16, v139
  v_and_b32 v41, 0xffff0000, v139
  v_pk_add_f32 v[86:87], v[2:3], v[4:5]
  v_pk_add_f32 v[88:89], v[6:7], v[8:9]
  v_pk_add_f32 v[86:87], v[86:87], v[10:11]
  v_pk_add_f32 v[88:89], v[88:89], v[12:13]
  v_pk_add_f32 v[86:87], v[86:87], v[14:15]
  v_pk_add_f32 v[88:89], v[88:89], v[16:17]
  v_pk_add_f32 v[86:87], v[86:87], v[18:19]
  v_pk_add_f32 v[88:89], v[88:89], v[20:21]
  v_pk_add_f32 v[86:87], v[86:87], v[22:23]
  v_pk_add_f32 v[88:89], v[88:89], v[24:25]
  v_pk_add_f32 v[86:87], v[86:87], v[26:27]
  v_pk_add_f32 v[88:89], v[88:89], v[28:29]
  v_pk_add_f32 v[86:87], v[86:87], v[30:31]
  v_pk_add_f32 v[88:89], v[88:89], v[32:33]
  v_pk_add_f32 v[86:87], v[86:87], v[34:35]
  v_pk_add_f32 v[88:89], v[88:89], v[36:37]
  v_pk_add_f32 v[86:87], v[86:87], v[38:39]
  v_pk_add_f32 v[88:89], v[88:89], v[40:41]
  v_pk_add_f32 v[86:87], v[86:87], v[88:89]
  v_add_f32 v86, v86, v87
  s_nop 1
  v_add_f32_dpp v86, v86, v86 row_ror:8 row_mask:0xf bank_mask:0xf
  s_nop 1
  v_add_f32_dpp v86, v86, v86 row_ror:4 row_mask:0xf bank_mask:0xf
  v_mov_b32 v90, v86
  s_nop 1
  v_permlane16_swap_b32 v86, v90
  v_add_f32 v86, v86, v90
  v_mov_b32 v90, v86
  s_nop 1
  v_permlane32_swap_b32 v86, v90
  v_add_f32 v86, v86, v90
  v_mul_f32 v88, 0xbacccccd, v86
  v_mul_f32 v89, 0xbacccccd, v86
  v_pk_add_f32 v[164:165], v[2:3], v[88:89]
  v_pk_add_f32 v[166:167], v[4:5], v[88:89]
  v_pk_mul_f32 v[170:171], v[164:165], v[164:165]
  v_pk_add_f32 v[168:169], v[6:7], v[88:89]
  v_pk_mul_f32 v[86:87], v[166:167], v[166:167]
  v_pk_add_f32 v[164:165], v[8:9], v[88:89]
  v_pk_fma_f32 v[170:171], v[168:169], v[168:169], v[170:171]
  v_pk_add_f32 v[166:167], v[10:11], v[88:89]
  v_pk_fma_f32 v[86:87], v[164:165], v[164:165], v[86:87]
  v_pk_add_f32 v[168:169], v[12:13], v[88:89]
  v_pk_fma_f32 v[170:171], v[166:167], v[166:167], v[170:171]
  v_pk_add_f32 v[164:165], v[14:15], v[88:89]
  v_pk_fma_f32 v[86:87], v[168:169], v[168:169], v[86:87]
  v_pk_add_f32 v[166:167], v[16:17], v[88:89]
  v_pk_fma_f32 v[170:171], v[164:165], v[164:165], v[170:171]
  v_pk_add_f32 v[168:169], v[18:19], v[88:89]
  v_pk_fma_f32 v[86:87], v[166:167], v[166:167], v[86:87]
  v_pk_add_f32 v[164:165], v[20:21], v[88:89]
  v_pk_fma_f32 v[170:171], v[168:169], v[168:169], v[170:171]
  v_pk_add_f32 v[166:167], v[22:23], v[88:89]
  v_pk_fma_f32 v[86:87], v[164:165], v[164:165], v[86:87]
  v_pk_add_f32 v[168:169], v[24:25], v[88:89]
  v_pk_fma_f32 v[170:171], v[166:167], v[166:167], v[170:171]
  v_pk_add_f32 v[164:165], v[26:27], v[88:89]
  v_pk_fma_f32 v[86:87], v[168:169], v[168:169], v[86:87]
  v_pk_add_f32 v[166:167], v[28:29], v[88:89]
  v_pk_fma_f32 v[170:171], v[164:165], v[164:165], v[170:171]
  v_pk_add_f32 v[168:169], v[30:31], v[88:89]
  v_pk_fma_f32 v[86:87], v[166:167], v[166:167], v[86:87]
  v_pk_add_f32 v[164:165], v[32:33], v[88:89]
  v_pk_fma_f32 v[170:171], v[168:169], v[168:169], v[170:171]
  v_pk_add_f32 v[166:167], v[34:35], v[88:89]
  v_pk_fma_f32 v[86:87], v[164:165], v[164:165], v[86:87]
  v_pk_add_f32 v[168:169], v[36:37], v[88:89]
  v_pk_fma_f32 v[170:171], v[166:167], v[166:167], v[170:171]
  v_pk_add_f32 v[164:165], v[38:39], v[88:89]
  v_pk_fma_f32 v[86:87], v[168:169], v[168:169], v[86:87]
  v_pk_add_f32 v[166:167], v[40:41], v[88:89]
  v_pk_fma_f32 v[170:171], v[164:165], v[164:165], v[170:171]
  v_pk_fma_f32 v[86:87], v[166:167], v[166:167], v[86:87]
  v_cvt_pk_bf16_f32 v91, v88, v89
  v_lshlrev_b32 v88, 16, v91
  v_and_b32 v89, 0xffff0000, v91
  v_pk_add_f32 v[86:87], v[86:87], v[170:171]
  v_add_f32 v86, v86, v87
  s_nop 1
  v_add_f32_dpp v86, v86, v86 row_ror:8 row_mask:0xf bank_mask:0xf
  s_nop 1
  v_add_f32_dpp v86, v86, v86 row_ror:4 row_mask:0xf bank_mask:0xf
  v_mov_b32 v90, v86
  s_nop 1
  v_permlane16_swap_b32 v86, v90
  v_add_f32 v86, v86, v90
  v_mov_b32 v90, v86
  s_nop 1
  v_permlane32_swap_b32 v86, v90
  v_add_f32 v86, v86, v90
  v_pk_add_f32 v[2:3], v[2:3], v[88:89]
  v_mul_f32 v86, 0x3acccccd, v86
  v_pk_add_f32 v[4:5], v[4:5], v[88:89]
  v_cvt_pk_bf16_f32 v86, v86, v86
  v_pk_add_f32 v[6:7], v[6:7], v[88:89]
  v_lshlrev_b32 v86, 16, v86
  v_pk_add_f32 v[8:9], v[8:9], v[88:89]
  v_add_f32 v86, 0x3727c5ac, v86
  v_pk_add_f32 v[10:11], v[10:11], v[88:89]
  v_cvt_pk_bf16_f32 v86, v86, v86
  v_pk_add_f32 v[12:13], v[12:13], v[88:89]
  v_lshlrev_b32 v86, 16, v86
  v_pk_add_f32 v[14:15], v[14:15], v[88:89]
  v_sqrt_f32 v86, v86
  v_pk_add_f32 v[16:17], v[16:17], v[88:89]
  v_cvt_pk_bf16_f32 v86, v86, v86
  v_pk_add_f32 v[18:19], v[18:19], v[88:89]
  v_lshlrev_b32 v86, 16, v86
  v_pk_add_f32 v[20:21], v[20:21], v[88:89]
  v_rcp_f32 v86, v86
  v_pk_add_f32 v[22:23], v[22:23], v[88:89]
  v_mov_b32 v87, v86
  v_pk_add_f32 v[24:25], v[24:25], v[88:89]
  v_pk_add_f32 v[26:27], v[26:27], v[88:89]
  v_pk_add_f32 v[28:29], v[28:29], v[88:89]
  v_pk_add_f32 v[30:31], v[30:31], v[88:89]
  v_pk_add_f32 v[32:33], v[32:33], v[88:89]
  v_pk_add_f32 v[34:35], v[34:35], v[88:89]
  v_pk_add_f32 v[36:37], v[36:37], v[88:89]
  v_pk_add_f32 v[38:39], v[38:39], v[88:89]
  v_pk_add_f32 v[40:41], v[40:41], v[88:89]
  v_cvt_pk_bf16_f32 v164, v2, v3
  v_lshlrev_b32 v2, 16, v164
  v_and_b32 v3, 0xffff0000, v164
  v_cvt_pk_bf16_f32 v165, v4, v5
  v_lshlrev_b32 v4, 16, v165
  v_and_b32 v5, 0xffff0000, v165
  v_cvt_pk_bf16_f32 v166, v6, v7
  v_lshlrev_b32 v6, 16, v166
  v_and_b32 v7, 0xffff0000, v166
  v_cvt_pk_bf16_f32 v167, v8, v9
  v_lshlrev_b32 v8, 16, v167
  v_and_b32 v9, 0xffff0000, v167
  v_cvt_pk_bf16_f32 v164, v10, v11
  v_lshlrev_b32 v10, 16, v164
  v_and_b32 v11, 0xffff0000, v164
  v_cvt_pk_bf16_f32 v165, v12, v13
  v_lshlrev_b32 v12, 16, v165
  v_and_b32 v13, 0xffff0000, v165
  v_cvt_pk_bf16_f32 v166, v14, v15
  v_lshlrev_b32 v14, 16, v166
  v_and_b32 v15, 0xffff0000, v166
  v_cvt_pk_bf16_f32 v167, v16, v17
  v_lshlrev_b32 v16, 16, v167
  v_and_b32 v17, 0xffff0000, v167
  v_cvt_pk_bf16_f32 v164, v18, v19
  v_lshlrev_b32 v18, 16, v164
  v_and_b32 v19, 0xffff0000, v164
  v_cvt_pk_bf16_f32 v165, v20, v21
  v_lshlrev_b32 v20, 16, v165
  v_and_b32 v21, 0xffff0000, v165
  v_cvt_pk_bf16_f32 v166, v22, v23
  v_lshlrev_b32 v22, 16, v166
  v_and_b32 v23, 0xffff0000, v166
  v_cvt_pk_bf16_f32 v167, v24, v25
  v_lshlrev_b32 v24, 16, v167
  v_and_b32 v25, 0xffff0000, v167
  v_cvt_pk_bf16_f32 v164, v26, v27
  v_lshlrev_b32 v26, 16, v164
  v_and_b32 v27, 0xffff0000, v164
  v_cvt_pk_bf16_f32 v165, v28, v29
  v_lshlrev_b32 v28, 16, v165
  v_and_b32 v29, 0xffff0000, v165
  v_cvt_pk_bf16_f32 v166, v30, v31
  v_lshlrev_b32 v30, 16, v166
  v_and_b32 v31, 0xffff0000, v166
  v_cvt_pk_bf16_f32 v167, v32, v33
  v_lshlrev_b32 v32, 16, v167
  v_and_b32 v33, 0xffff0000, v167
  v_cvt_pk_bf16_f32 v164, v34, v35
  v_lshlrev_b32 v34, 16, v164
  v_and_b32 v35, 0xffff0000, v164
  v_cvt_pk_bf16_f32 v165, v36, v37
  v_lshlrev_b32 v36, 16, v165
  v_and_b32 v37, 0xffff0000, v165
  v_cvt_pk_bf16_f32 v166, v38, v39
  v_lshlrev_b32 v38, 16, v166
  v_and_b32 v39, 0xffff0000, v166
  v_cvt_pk_bf16_f32 v167, v40, v41
  v_lshlrev_b32 v40, 16, v167
  v_and_b32 v41, 0xffff0000, v167
  v_pk_mul_f32 v[2:3], v[2:3], v[86:87]
  v_pk_mul_f32 v[4:5], v[4:5], v[86:87]
  v_pk_mul_f32 v[6:7], v[6:7], v[86:87]
  v_pk_mul_f32 v[8:9], v[8:9], v[86:87]
  v_pk_mul_f32 v[10:11], v[10:11], v[86:87]
  v_pk_mul_f32 v[12:13], v[12:13], v[86:87]
  v_pk_mul_f32 v[14:15], v[14:15], v[86:87]
  v_pk_mul_f32 v[16:17], v[16:17], v[86:87]
  v_pk_mul_f32 v[18:19], v[18:19], v[86:87]
  v_pk_mul_f32 v[20:21], v[20:21], v[86:87]
  v_pk_mul_f32 v[22:23], v[22:23], v[86:87]
  v_pk_mul_f32 v[24:25], v[24:25], v[86:87]
  v_pk_mul_f32 v[26:27], v[26:27], v[86:87]
  v_pk_mul_f32 v[28:29], v[28:29], v[86:87]
  v_pk_mul_f32 v[30:31], v[30:31], v[86:87]
  v_pk_mul_f32 v[32:33], v[32:33], v[86:87]
  v_pk_mul_f32 v[34:35], v[34:35], v[86:87]
  v_pk_mul_f32 v[36:37], v[36:37], v[86:87]
  v_pk_mul_f32 v[38:39], v[38:39], v[86:87]
  v_pk_mul_f32 v[40:41], v[40:41], v[86:87]
  v_cvt_pk_bf16_f32 v120, v2, v3
  v_cvt_pk_bf16_f32 v121, v4, v5
  v_cvt_pk_bf16_f32 v122, v6, v7
  v_cvt_pk_bf16_f32 v123, v8, v9
  v_cvt_pk_bf16_f32 v124, v10, v11
  v_cvt_pk_bf16_f32 v125, v12, v13
  v_cvt_pk_bf16_f32 v126, v14, v15
  v_cvt_pk_bf16_f32 v127, v16, v17
  v_cvt_pk_bf16_f32 v128, v18, v19
  v_cvt_pk_bf16_f32 v129, v20, v21
  v_cvt_pk_bf16_f32 v130, v22, v23
  v_cvt_pk_bf16_f32 v131, v24, v25
  v_cvt_pk_bf16_f32 v132, v26, v27
  v_cvt_pk_bf16_f32 v133, v28, v29
  v_cvt_pk_bf16_f32 v134, v30, v31
  v_cvt_pk_bf16_f32 v135, v32, v33
  v_cvt_pk_bf16_f32 v136, v34, v35
  v_cvt_pk_bf16_f32 v137, v36, v37
  v_cvt_pk_bf16_f32 v138, v38, v39
  v_cvt_pk_bf16_f32 v139, v40, v41
  s_cmp_lg_u32 s17, 0
  s_cbranch_scc1 r_g1
  s_cmp_lg_u32 s18, 31
  s_cbranch_scc1 r_g0
  v_mov_b32 v90, 200
  s_mov_b32 s34, 0
gw_42:
  buffer_load_dword v91, v90, s[12:15], 0 offen sc1
  s_add_u32 s34, s34, 1
  s_cmp_gt_u32 s34, 65536
  s_cbranch_scc1 role_abort
  s_waitcnt vmcnt(0)
  v_cmp_gt_u32 vcc, 20, v91
  s_cbranch_vccz gk_43
  s_sleep 4
  s_branch gw_42
gk_43:
  s_lshl_b32 s35, s16, 2
  s_add_u32 s35, s35, 32
  v_mov_b32 v90, s35
  v_mov_b32 v91, 1
  s_waitcnt vmcnt(0)
  s_mov_b64 exec, 1
  buffer_atomic_add v91, v90, s[12:15], 0 offen
  s_mov_b64 exec, -1
r_g0:
  s_lshl_b32 s34, s16, 2
  s_add_u32 s34, s34, 32
  v_mov_b32 v90, s34
  s_mov_b32 s34, 0
  s_mov_b64 exec, 1
gw_44:
  buffer_load_dword v91, v90, s[12:15], 0 offen sc1
  s_add_u32 s34, s34, 1
  s_cmp_gt_u32 s34, 65536
  s_cbranch_scc1 role_abort
  s_waitcnt vmcnt(0)
  v_cmp_gt_u32 vcc, 2, v91
  s_cbranch_vccz gk_45
  s_sleep 2
  s_branch gw_44
gk_45:
  s_mov_b64 exec, -1
r_g1:
  s_barrier
  s_mov_b32 s35, 65536
  s_mov_b32 s33, 0
  buffer_load_dwordx4 v[176:179], v162, s[8:11], s35 offen offset:0 sc1
  buffer_load_dwordx4 v[180:183], v162, s[8:11], s35 offen offset:512 sc1
  buffer_load_dwordx4 v[184:187], v162, s[8:11], s35 offen offset:1024 sc1
  buffer_load_dwordx4 v[188:191], v162, s[8:11], s35 offen offset:1536 sc1
  buffer_load_dwordx4 v[192:195], v162, s[8:11], s35 offen offset:2048 sc1
  s_waitcnt vmcnt(4)
  v_add_f32 v176, v163, v176
  v_add_f32 v177, v163, v177
  v_add_f32 v178, v163, v178
  v_add_f32 v179, v163, v179
  v_cvt_pk_bf16_f32 v90, v176, v177
  v_lshlrev_b32 v176, 16, v90
  v_and_b32 v177, 0xffff0000, v90
  v_cvt_pk_bf16_f32 v91, v178, v179
  v_lshlrev_b32 v178, 16, v91
  v_and_b32 v179, 0xffff0000, v91
  s_waitcnt vmcnt(3)
  v_add_f32 v180, v163, v180
  v_add_f32 v181, v163, v181
  v_add_f32 v182, v163, v182
  v_add_f32 v183, v163, v183
  v_cvt_pk_bf16_f32 v90, v180, v181
  v_lshlrev_b32 v180, 16, v90
  v_and_b32 v181, 0xffff0000, v90
  v_cvt_pk_bf16_f32 v91, v182, v183
  v_lshlrev_b32 v182, 16, v91
  v_and_b32 v183, 0xffff0000, v91
  s_waitcnt vmcnt(2)
  v_add_f32 v184, v163, v184
  v_add_f32 v185, v163, v185
  v_add_f32 v186, v163, v186
  v_add_f32 v187, v163, v187
  v_cvt_pk_bf16_f32 v90, v184, v185
  v_lshlrev_b32 v184, 16, v90
  v_and_b32 v185, 0xffff0000, v90
  v_cvt_pk_bf16_f32 v91, v186, v187
  v_lshlrev_b32 v186, 16, v91
  v_and_b32 v187, 0xffff0000, v91
  s_waitcnt vmcnt(1)
  v_add_f32 v188, v163, v188
  v_add_f32 v189, v163, v189
  v_add_f32 v190, v163, v190
  v_add_f32 v191, v163, v191
  v_cvt_pk_bf16_f32 v90, v188, v189
  v_lshlrev_b32 v188, 16, v90
  v_and_b32 v189, 0xffff0000, v90
  v_cvt_pk_bf16_f32 v91, v190, v191
  v_lshlrev_b32 v190, 16, v91
  v_and_b32 v191, 0xffff0000, v91
  s_waitcnt vmcnt(0)
  v_add_f32 v192, v163, v192
  v_add_f32 v193, v163, v193
  v_add_f32 v194, v163, v194
  v_add_f32 v195, v163, v195
  v_cvt_pk_bf16_f32 v90, v192, v193
  v_lshlrev_b32 v192, 16, v90
  v_and_b32 v193, 0xffff0000, v90
  v_cvt_pk_bf16_f32 v91, v194, v195
  v_lshlrev_b32 v194, 16, v91
  v_and_b32 v195, 0xffff0000, v91
  v_lshlrev_b32 v2, 16, v100
  v_and_b32 v3, 0xffff0000, v100
  v_lshlrev_b32 v4, 16, v101
  v_and_b32 v5, 0xffff0000, v101
  v_lshlrev_b32 v6, 16, v102
  v_and_b32 v7, 0xffff0000, v102
  v_lshlrev_b32 v8, 16, v103
  v_and_b32 v9, 0xffff0000, v103
  v_mul_f32_dpp v2, v176, v2 quad_perm:[2,2,2,2] row_mask:0xf bank_mask:0xf
  v_mul_f32_dpp v3, v177, v3 quad_perm:[2,2,2,2] row_mask:0xf bank_mask:0xf
  v_mul_f32_dpp v4, v178, v4 quad_perm:[2,2,2,2] row_mask:0xf bank_mask:0xf
  v_mul_f32_dpp v5, v179, v5 quad_perm:[2,2,2,2] row_mask:0xf bank_mask:0xf
  v_mul_f32_dpp v6, v176, v6 quad_perm:[3,3,3,3] row_mask:0xf bank_mask:0xf
  v_mul_f32_dpp v7, v177, v7 quad_perm:[3,3,3,3] row_mask:0xf bank_mask:0xf
  v_mul_f32_dpp v8, v178, v8 quad_perm:[3,3,3,3] row_mask:0xf bank_mask:0xf
  v_mul_f32_dpp v9, v179, v9 quad_perm:[3,3,3,3] row_mask:0xf bank_mask:0xf
  v_cvt_pk_bf16_f32 v164, v2, v3
  v_lshlrev_b32 v2, 16, v164
  v_and_b32 v3, 0xffff0000, v164
  v_cvt_pk_bf16_f32 v165, v4, v5
  v_lshlrev_b32 v4, 16, v165
  v_and_b32 v5, 0xffff0000, v165
  v_cvt_pk_bf16_f32 v166, v6, v7
  v_lshlrev_b32 v6, 16, v166
  v_and_b32 v7, 0xffff0000, v166
  v_cvt_pk_bf16_f32 v167, v8, v9
  v_lshlrev_b32 v8, 16, v167
  v_and_b32 v9, 0xffff0000, v167
  v_add_f32_dpp v2, v176, v2 quad_perm:[0,0,0,0] row_mask:0xf bank_mask:0xf
  v_add_f32_dpp v3, v177, v3 quad_perm:[0,0,0,0] row_mask:0xf bank_mask:0xf
  v_add_f32_dpp v4, v178, v4 quad_perm:[0,0,0,0] row_mask:0xf bank_mask:0xf
  v_add_f32_dpp v5, v179, v5 quad_perm:[0,0,0,0] row_mask:0xf bank_mask:0xf
  v_add_f32_dpp v6, v176, v6 quad_perm:[1,1,1,1] row_mask:0xf bank_mask:0xf
  v_add_f32_dpp v7, v177, v7 quad_perm:[1,1,1,1] row_mask:0xf bank_mask:0xf
  v_add_f32_dpp v8, v178, v8 quad_perm:[1,1,1,1] row_mask:0xf bank_mask:0xf
  v_add_f32_dpp v9, v179, v9 quad_perm:[1,1,1,1] row_mask:0xf bank_mask:0xf
  v_cvt_pk_bf16_f32 v196, v2, v3
  v_cvt_pk_bf16_f32 v197, v4, v5
  v_cvt_pk_bf16_f32 v198, v6, v7
  v_cvt_pk_bf16_f32 v199, v8, v9
  s_add_u32 s35, s38, 0
  buffer_store_dwordx4 v[196:199], v161, s[8:11], s35 offen
  v_lshlrev_b32 v10, 16, v104
  v_and_b32 v11, 0xffff0000, v104
  v_lshlrev_b32 v12, 16, v105
  v_and_b32 v13, 0xffff0000, v105
  v_lshlrev_b32 v14, 16, v106
  v_and_b32 v15, 0xffff0000, v106
  v_lshlrev_b32 v16, 16, v107
  v_and_b32 v17, 0xffff0000, v107
  v_mul_f32_dpp v10, v180, v10 quad_perm:[2,2,2,2] row_mask:0xf bank_mask:0xf
  v_mul_f32_dpp v11, v181, v11 quad_perm:[2,2,2,2] row_mask:0xf bank_mask:0xf
  v_mul_f32_dpp v12, v182, v12 quad_perm:[2,2,2,2] row_mask:0xf bank_mask:0xf
  v_mul_f32_dpp v13, v183, v13 quad_perm:[2,2,2,2] row_mask:0xf bank_mask:0xf
  v_mul_f32_dpp v14, v180, v14 quad_perm:[3,3,3,3] row_mask:0xf bank_mask:0xf
  v_mul_f32_dpp v15, v181, v15 quad_perm:[3,3,3,3] row_mask:0xf bank_mask:0xf
  v_mul_f32_dpp v16, v182, v16 quad_perm:[3,3,3,3] row_mask:0xf bank_mask:0xf
  v_mul_f32_dpp v17, v183, v17 quad_perm:[3,3,3,3] row_mask:0xf bank_mask:0xf
  v_cvt_pk_bf16_f32 v164, v10, v11
  v_lshlrev_b32 v10, 16, v164
  v_and_b32 v11, 0xffff0000, v164
  v_cvt_pk_bf16_f32 v165, v12, v13
  v_lshlrev_b32 v12, 16, v165
  v_and_b32 v13, 0xffff0000, v165
  v_cvt_pk_bf16_f32 v166, v14, v15
  v_lshlrev_b32 v14, 16, v166
  v_and_b32 v15, 0xffff0000, v166
  v_cvt_pk_bf16_f32 v167, v16, v17
  v_lshlrev_b32 v16, 16, v167
  v_and_b32 v17, 0xffff0000, v167
  v_add_f32_dpp v10, v180, v10 quad_perm:[0,0,0,0] row_mask:0xf bank_mask:0xf
  v_add_f32_dpp v11, v181, v11 quad_perm:[0,0,0,0] row_mask:0xf bank_mask:0xf
  v_add_f32_dpp v12, v182, v12 quad_perm:[0,0,0,0] row_mask:0xf bank_mask:0xf
  v_add_f32_dpp v13, v183, v13 quad_perm:[0,0,0,0] row_mask:0xf bank_mask:0xf
  v_add_f32_dpp v14, v180, v14 quad_perm:[1,1,1,1] row_mask:0xf bank_mask:0xf
  v_add_f32_dpp v15, v181, v15 quad_perm:[1,1,1,1] row_mask:0xf bank_mask:0xf
  v_add_f32_dpp v16, v182, v16 quad_perm:[1,1,1,1] row_mask:0xf bank_mask:0xf
  v_add_f32_dpp v17, v183, v17 quad_perm:[1,1,1,1] row_mask:0xf bank_mask:0xf
  v_cvt_pk_bf16_f32 v200, v10, v11
  v_cvt_pk_bf16_f32 v201, v12, v13
  v_cvt_pk_bf16_f32 v202, v14, v15
  v_cvt_pk_bf16_f32 v203, v16, v17
  s_add_u32 s35, s38, 4096
  buffer_store_dwordx4 v[200:203], v161, s[8:11], s35 offen
  v_lshlrev_b32 v18, 16, v108
  v_and_b32 v19, 0xffff0000, v108
  v_lshlrev_b32 v20, 16, v109
  v_and_b32 v21, 0xffff0000, v109
  v_lshlrev_b32 v22, 16, v110
  v_and_b32 v23, 0xffff0000, v110
  v_lshlrev_b32 v24, 16, v111
  v_and_b32 v25, 0xffff0000, v111
  v_mul_f32_dpp v18, v184, v18 quad_perm:[2,2,2,2] row_mask:0xf bank_mask:0xf
  v_mul_f32_dpp v19, v185, v19 quad_perm:[2,2,2,2] row_mask:0xf bank_mask:0xf
  v_mul_f32_dpp v20, v186, v20 quad_perm:[2,2,2,2] row_mask:0xf bank_mask:0xf
  v_mul_f32_dpp v21, v187, v21 quad_perm:[2,2,2,2] row_mask:0xf bank_mask:0xf
  v_mul_f32_dpp v22, v184, v22 quad_perm:[3,3,3,3] row_mask:0xf bank_mask:0xf
  v_mul_f32_dpp v23, v185, v23 quad_perm:[3,3,3,3] row_mask:0xf bank_mask:0xf
  v_mul_f32_dpp v24, v186, v24 quad_perm:[3,3,3,3] row_mask:0xf bank_mask:0xf
  v_mul_f32_dpp v25, v187, v25 quad_perm:[3,3,3,3] row_mask:0xf bank_mask:0xf
  v_cvt_pk_bf16_f32 v164, v18, v19
  v_lshlrev_b32 v18, 16, v164
  v_and_b32 v19, 0xffff0000, v164
  v_cvt_pk_bf16_f32 v165, v20, v21
  v_lshlrev_b32 v20, 16, v165
  v_and_b32 v21, 0xffff0000, v165
  v_cvt_pk_bf16_f32 v166, v22, v23
  v_lshlrev_b32 v22, 16, v166
  v_and_b32 v23, 0xffff0000, v166
  v_cvt_pk_bf16_f32 v167, v24, v25
  v_lshlrev_b32 v24, 16, v167
  v_and_b32 v25, 0xffff0000, v167
  v_add_f32_dpp v18, v184, v18 quad_perm:[0,0,0,0] row_mask:0xf bank_mask:0xf
  v_add_f32_dpp v19, v185, v19 quad_perm:[0,0,0,0] row_mask:0xf bank_mask:0xf
  v_add_f32_dpp v20, v186, v20 quad_perm:[0,0,0,0] row_mask:0xf bank_mask:0xf
  v_add_f32_dpp v21, v187, v21 quad_perm:[0,0,0,0] row_mask:0xf bank_mask:0xf
  v_add_f32_dpp v22, v184, v22 quad_perm:[1,1,1,1] row_mask:0xf bank_mask:0xf
  v_add_f32_dpp v23, v185, v23 quad_perm:[1,1,1,1] row_mask:0xf bank_mask:0xf
  v_add_f32_dpp v24, v186, v24 quad_perm:[1,1,1,1] row_mask:0xf bank_mask:0xf
  v_add_f32_dpp v25, v187, v25 quad_perm:[1,1,1,1] row_mask:0xf bank_mask:0xf
  v_cvt_pk_bf16_f32 v204, v18, v19
  v_cvt_pk_bf16_f32 v205, v20, v21
  v_cvt_pk_bf16_f32 v206, v22, v23
  v_cvt_pk_bf16_f32 v207, v24, v25
  s_add_u32 s35, s38, 8192
  buffer_store_dwordx4 v[204:207], v161, s[8:11], s35 offen
  v_lshlrev_b32 v26, 16, v112
  v_and_b32 v27, 0xffff0000, v112
  v_lshlrev_b32 v28, 16, v113
  v_and_b32 v29, 0xffff0000, v113
  v_lshlrev_b32 v30, 16, v114
  v_and_b32 v31, 0xffff0000, v114
  v_lshlrev_b32 v32, 16, v115
  v_and_b32 v33, 0xffff0000, v115
  v_mul_f32_dpp v26, v188, v26 quad_perm:[2,2,2,2] row_mask:0xf bank_mask:0xf
  v_mul_f32_dpp v27, v189, v27 quad_perm:[2,2,2,2] row_mask:0xf bank_mask:0xf
  v_mul_f32_dpp v28, v190, v28 quad_perm:[2,2,2,2] row_mask:0xf bank_mask:0xf
  v_mul_f32_dpp v29, v191, v29 quad_perm:[2,2,2,2] row_mask:0xf bank_mask:0xf
  v_mul_f32_dpp v30, v188, v30 quad_perm:[3,3,3,3] row_mask:0xf bank_mask:0xf
  v_mul_f32_dpp v31, v189, v31 quad_perm:[3,3,3,3] row_mask:0xf bank_mask:0xf
  v_mul_f32_dpp v32, v190, v32 quad_perm:[3,3,3,3] row_mask:0xf bank_mask:0xf
  v_mul_f32_dpp v33, v191, v33 quad_perm:[3,3,3,3] row_mask:0xf bank_mask:0xf
  v_cvt_pk_bf16_f32 v164, v26, v27
  v_lshlrev_b32 v26, 16, v164
  v_and_b32 v27, 0xffff0000, v164
  v_cvt_pk_bf16_f32 v165, v28, v29
  v_lshlrev_b32 v28, 16, v165
  v_and_b32 v29, 0xffff0000, v165
  v_cvt_pk_bf16_f32 v166, v30, v31
  v_lshlrev_b32 v30, 16, v166
  v_and_b32 v31, 0xffff0000, v166
  v_cvt_pk_bf16_f32 v167, v32, v33
  v_lshlrev_b32 v32, 16, v167
  v_and_b32 v33, 0xffff0000, v167
  v_add_f32_dpp v26, v188, v26 quad_perm:[0,0,0,0] row_mask:0xf bank_mask:0xf
  v_add_f32_dpp v27, v189, v27 quad_perm:[0,0,0,0] row_mask:0xf bank_mask:0xf
  v_add_f32_dpp v28, v190, v28 quad_perm:[0,0,0,0] row_mask:0xf bank_mask:0xf
  v_add_f32_dpp v29, v191, v29 quad_perm:[0,0,0,0] row_mask:0xf bank_mask:0xf
  v_add_f32_dpp v30, v188, v30 quad_perm:[1,1,1,1] row_mask:0xf bank_mask:0xf
  v_add_f32_dpp v31, v189, v31 quad_perm:[1,1,1,1] row_mask:0xf bank_mask:0xf
  v_add_f32_dpp v32, v190, v32 quad_perm:[1,1,1,1] row_mask:0xf bank_mask:0xf
  v_add_f32_dpp v33, v191, v33 quad_perm:[1,1,1,1] row_mask:0xf bank_mask:0xf
  v_cvt_pk_bf16_f32 v208, v26, v27
  v_cvt_pk_bf16_f32 v209, v28, v29
  v_cvt_pk_bf16_f32 v210, v30, v31
  v_cvt_pk_bf16_f32 v211, v32, v33
  s_add_u32 s35, s38, 12288
  buffer_store_dwordx4 v[208:211], v161, s[8:11], s35 offen
  v_lshlrev_b32 v34, 16, v116
  v_and_b32 v35, 0xffff0000, v116
  v_lshlrev_b32 v36, 16, v117
  v_and_b32 v37, 0xffff0000, v117
  v_lshlrev_b32 v38, 16, v118
  v_and_b32 v39, 0xffff0000, v118
  v_lshlrev_b32 v40, 16, v119
  v_and_b32 v41, 0xffff0000, v119
  v_mul_f32_dpp v34, v192, v34 quad_perm:[2,2,2,2] row_mask:0xf bank_mask:0xf
  v_mul_f32_dpp v35, v193, v35 quad_perm:[2,2,2,2] row_mask:0xf bank_mask:0xf
  v_mul_f32_dpp v36, v194, v36 quad_perm:[2,2,2,2] row_mask:0xf bank_mask:0xf
  v_mul_f32_dpp v37, v195, v37 quad_perm:[2,2,2,2] row_mask:0xf bank_mask:0xf
  v_mul_f32_dpp v38, v192, v38 quad_perm:[3,3,3,3] row_mask:0xf bank_mask:0xf
  v_mul_f32_dpp v39, v193, v39 quad_perm:[3,3,3,3] row_mask:0xf bank_mask:0xf
  v_mul_f32_dpp v40, v194, v40 quad_perm:[3,3,3,3] row_mask:0xf bank_mask:0xf
  v_mul_f32_dpp v41, v195, v41 quad_perm:[3,3,3,3] row_mask:0xf bank_mask:0xf
  v_cvt_pk_bf16_f32 v164, v34, v35
  v_lshlrev_b32 v34, 16, v164
  v_and_b32 v35, 0xffff0000, v164
  v_cvt_pk_bf16_f32 v165, v36, v37
  v_lshlrev_b32 v36, 16, v165
  v_and_b32 v37, 0xffff0000, v165
  v_cvt_pk_bf16_f32 v166, v38, v39
  v_lshlrev_b32 v38, 16, v166
  v_and_b32 v39, 0xffff0000, v166
  v_cvt_pk_bf16_f32 v167, v40, v41
  v_lshlrev_b32 v40, 16, v167
  v_and_b32 v41, 0xffff0000, v167
  v_add_f32_dpp v34, v192, v34 quad_perm:[0,0,0,0] row_mask:0xf bank_mask:0xf
  v_add_f32_dpp v35, v193, v35 quad_perm:[0,0,0,0] row_mask:0xf bank_mask:0xf
  v_add_f32_dpp v36, v194, v36 quad_perm:[0,0,0,0] row_mask:0xf bank_mask:0xf
  v_add_f32_dpp v37, v195, v37 quad_perm:[0,0,0,0] row_mask:0xf bank_mask:0xf
  v_add_f32_dpp v38, v192, v38 quad_perm:[1,1,1,1] row_mask:0xf bank_mask:0xf
  v_add_f32_dpp v39, v193, v39 quad_perm:[1,1,1,1] row_mask:0xf bank_mask:0xf
  v_add_f32_dpp v40, v194, v40 quad_perm:[1,1,1,1] row_mask:0xf bank_mask:0xf
  v_add_f32_dpp v41, v195, v41 quad_perm:[1,1,1,1] row_mask:0xf bank_mask:0xf
  v_cvt_pk_bf16_f32 v212, v34, v35
  v_cvt_pk_bf16_f32 v213, v36, v37
  v_cvt_pk_bf16_f32 v214, v38, v39
  v_cvt_pk_bf16_f32 v215, v40, v41
  s_add_u32 s35, s38, 16384
  buffer_store_dwordx4 v[212:215], v161, s[8:11], s35 offen
  s_add_u32 s38, s38, 81920
  s_add_u32 s33, s33, 4
  v_lshlrev_b32 v2, 16, v120
  v_and_b32 v3, 0xffff0000, v120
  v_lshlrev_b32 v4, 16, v121
  v_and_b32 v5, 0xffff0000, v121
  v_lshlrev_b32 v6, 16, v122
  v_and_b32 v7, 0xffff0000, v122
  v_lshlrev_b32 v8, 16, v123
  v_and_b32 v9, 0xffff0000, v123
  v_mul_f32_dpp v2, v176, v2 quad_perm:[2,2,2,2] row_mask:0xf bank_mask:0xf
  v_mul_f32_dpp v3, v177, v3 quad_perm:[2,2,2,2] row_mask:0xf bank_mask:0xf
  v_mul_f32_dpp v4, v178, v4 quad_perm:[2,2,2,2] row_mask:0xf bank_mask:0xf
  v_mul_f32_dpp v5, v179, v5 quad_perm:[2,2,2,2] row_mask:0xf bank_mask:0xf
  v_mul_f32_dpp v6, v176, v6 quad_perm:[3,3,3,3] row_mask:0xf bank_mask:0xf
  v_mul_f32_dpp v7, v177, v7 quad_perm:[3,3,3,3] row_mask:0xf bank_mask:0xf
  v_mul_f32_dpp v8, v178, v8 quad_perm:[3,3,3,3] row_mask:0xf bank_mask:0xf
  v_mul_f32_dpp v9, v179, v9 quad_perm:[3,3,3,3] row_mask:0xf bank_mask:0xf
  v_cvt_pk_bf16_f32 v164, v2, v3
  v_lshlrev_b32 v2, 16, v164
  v_and_b32 v3, 0xffff0000, v164
  v_cvt_pk_bf16_f32 v165, v4, v5
  v_lshlrev_b32 v4, 16, v165
  v_and_b32 v5, 0xffff0000, v165
  v_cvt_pk_bf16_f32 v166, v6, v7
  v_lshlrev_b32 v6, 16, v166
  v_and_b32 v7, 0xffff0000, v166
  v_cvt_pk_bf16_f32 v167, v8, v9
  v_lshlrev_b32 v8, 16, v167
  v_and_b32 v9, 0xffff0000, v167
  v_add_f32_dpp v2, v176, v2 quad_perm:[0,0,0,0] row_mask:0xf bank_mask:0xf
  v_add_f32_dpp v3, v177, v3 quad_perm:[0,0,0,0] row_mask:0xf bank_mask:0xf
  v_add_f32_dpp v4, v178, v4 quad_perm:[0,0,0,0] row_mask:0xf bank_mask:0xf
  v_add_f32_dpp v5, v179, v5 quad_perm:[0,0,0,0] row_mask:0xf bank_mask:0xf
  v_add_f32_dpp v6, v176, v6 quad_perm:[1,1,1,1] row_mask:0xf bank_mask:0xf
  v_add_f32_dpp v7, v177, v7 quad_perm:[1,1,1,1] row_mask:0xf bank_mask:0xf
  v_add_f32_dpp v8, v178, v8 quad_perm:[1,1,1,1] row_mask:0xf bank_mask:0xf
  v_add_f32_dpp v9, v179, v9 quad_perm:[1,1,1,1] row_mask:0xf bank_mask:0xf
  v_cvt_pk_bf16_f32 v196, v2, v3
  v_cvt_pk_bf16_f32 v197, v4, v5
  v_cvt_pk_bf16_f32 v198, v6, v7
  v_cvt_pk_bf16_f32 v199, v8, v9
  v_mov_b32 v92, s33
  s_waitcnt vmcnt(0)
  buffer_store_dword v92, v228, s[8:11], 0 offen
  s_add_u32 s35, s38, 0
  buffer_store_dwordx4 v[196:199], v161, s[8:11], s35 offen
  v_lshlrev_b32 v10, 16, v124
  v_and_b32 v11, 0xffff0000, v124
  v_lshlrev_b32 v12, 16, v125
  v_and_b32 v13, 0xffff0000, v125
  v_lshlrev_b32 v14, 16, v126
  v_and_b32 v15, 0xffff0000, v126
  v_lshlrev_b32 v16, 16, v127
  v_and_b32 v17, 0xffff0000, v127
  v_mul_f32_dpp v10, v180, v10 quad_perm:[2,2,2,2] row_mask:0xf bank_mask:0xf
  v_mul_f32_dpp v11, v181, v11 quad_perm:[2,2,2,2] row_mask:0xf bank_mask:0xf
  v_mul_f32_dpp v12, v182, v12 quad_perm:[2,2,2,2] row_mask:0xf bank_mask:0xf
  v_mul_f32_dpp v13, v183, v13 quad_perm:[2,2,2,2] row_mask:0xf bank_mask:0xf
  v_mul_f32_dpp v14, v180, v14 quad_perm:[3,3,3,3] row_mask:0xf bank_mask:0xf
  v_mul_f32_dpp v15, v181, v15 quad_perm:[3,3,3,3] row_mask:0xf bank_mask:0xf
  v_mul_f32_dpp v16, v182, v16 quad_perm:[3,3,3,3] row_mask:0xf bank_mask:0xf
  v_mul_f32_dpp v17, v183, v17 quad_perm:[3,3,3,3] row_mask:0xf bank_mask:0xf
  v_cvt_pk_bf16_f32 v164, v10, v11
  v_lshlrev_b32 v10, 16, v164
  v_and_b32 v11, 0xffff0000, v164
  v_cvt_pk_bf16_f32 v165, v12, v13
  v_lshlrev_b32 v12, 16, v165
  v_and_b32 v13, 0xffff0000, v165
  v_cvt_pk_bf16_f32 v166, v14, v15
  v_lshlrev_b32 v14, 16, v166
  v_and_b32 v15, 0xffff0000, v166
  v_cvt_pk_bf16_f32 v167, v16, v17
  v_lshlrev_b32 v16, 16, v167
  v_and_b32 v17, 0xffff0000, v167
  v_add_f32_dpp v10, v180, v10 quad_perm:[0,0,0,0] row_mask:0xf bank_mask:0xf
  v_add_f32_dpp v11, v181, v11 quad_perm:[0,0,0,0] row_mask:0xf bank_mask:0xf
  v_add_f32_dpp v12, v182, v12 quad_perm:[0,0,0,0] row_mask:0xf bank_mask:0xf
  v_add_f32_dpp v13, v183, v13 quad_perm:[0,0,0,0] row_mask:0xf bank_mask:0xf
  v_add_f32_dpp v14, v180, v14 quad_perm:[1,1,1,1] row_mask:0xf bank_mask:0xf
  v_add_f32_dpp v15, v181, v15 quad_perm:[1,1,1,1] row_mask:0xf bank_mask:0xf
  v_add_f32_dpp v16, v182, v16 quad_perm:[1,1,1,1] row_mask:0xf bank_mask:0xf
  v_add_f32_dpp v17, v183, v17 quad_perm:[1,1,1,1] row_mask:0xf bank_mask:0xf
  v_cvt_pk_bf16_f32 v200, v10, v11
  v_cvt_pk_bf16_f32 v201, v12, v13
  v_cvt_pk_bf16_f32 v202, v14, v15
  v_cvt_pk_bf16_f32 v203, v16, v17
  s_add_u32 s35, s38, 4096
  buffer_store_dwordx4 v[200:203], v161, s[8:11], s35 offen
  v_lshlrev_b32 v18, 16, v128
  v_and_b32 v19, 0xffff0000, v128
  v_lshlrev_b32 v20, 16, v129
  v_and_b32 v21, 0xffff0000, v129
  v_lshlrev_b32 v22, 16, v130
  v_and_b32 v23, 0xffff0000, v130
  v_lshlrev_b32 v24, 16, v131
  v_and_b32 v25, 0xffff0000, v131
  v_mul_f32_dpp v18, v184, v18 quad_perm:[2,2,2,2] row_mask:0xf bank_mask:0xf
  v_mul_f32_dpp v19, v185, v19 quad_perm:[2,2,2,2] row_mask:0xf bank_mask:0xf
  v_mul_f32_dpp v20, v186, v20 quad_perm:[2,2,2,2] row_mask:0xf bank_mask:0xf
  v_mul_f32_dpp v21, v187, v21 quad_perm:[2,2,2,2] row_mask:0xf bank_mask:0xf
  v_mul_f32_dpp v22, v184, v22 quad_perm:[3,3,3,3] row_mask:0xf bank_mask:0xf
  v_mul_f32_dpp v23, v185, v23 quad_perm:[3,3,3,3] row_mask:0xf bank_mask:0xf
  v_mul_f32_dpp v24, v186, v24 quad_perm:[3,3,3,3] row_mask:0xf bank_mask:0xf
  v_mul_f32_dpp v25, v187, v25 quad_perm:[3,3,3,3] row_mask:0xf bank_mask:0xf
  v_cvt_pk_bf16_f32 v164, v18, v19
  v_lshlrev_b32 v18, 16, v164
  v_and_b32 v19, 0xffff0000, v164
  v_cvt_pk_bf16_f32 v165, v20, v21
  v_lshlrev_b32 v20, 16, v165
  v_and_b32 v21, 0xffff0000, v165
  v_cvt_pk_bf16_f32 v166, v22, v23
  v_lshlrev_b32 v22, 16, v166
  v_and_b32 v23, 0xffff0000, v166
  v_cvt_pk_bf16_f32 v167, v24, v25
  v_lshlrev_b32 v24, 16, v167
  v_and_b32 v25, 0xffff0000, v167
  v_add_f32_dpp v18, v184, v18 quad_perm:[0,0,0,0] row_mask:0xf bank_mask:0xf
  v_add_f32_dpp v19, v185, v19 quad_perm:[0,0,0,0] row_mask:0xf bank_mask:0xf
  v_add_f32_dpp v20, v186, v20 quad_perm:[0,0,0,0] row_mask:0xf bank_mask:0xf
  v_add_f32_dpp v21, v187, v21 quad_perm:[0,0,0,0] row_mask:0xf bank_mask:0xf
  v_add_f32_dpp v22, v184, v22 quad_perm:[1,1,1,1] row_mask:0xf bank_mask:0xf
  v_add_f32_dpp v23, v185, v23 quad_perm:[1,1,1,1] row_mask:0xf bank_mask:0xf
  v_add_f32_dpp v24, v186, v24 quad_perm:[1,1,1,1] row_mask:0xf bank_mask:0xf
  v_add_f32_dpp v25, v187, v25 quad_perm:[1,1,1,1] row_mask:0xf bank_mask:0xf
  v_cvt_pk_bf16_f32 v204, v18, v19
  v_cvt_pk_bf16_f32 v205, v20, v21
  v_cvt_pk_bf16_f32 v206, v22, v23
  v_cvt_pk_bf16_f32 v207, v24, v25
  s_add_u32 s35, s38, 8192
  buffer_store_dwordx4 v[204:207], v161, s[8:11], s35 offen
  v_lshlrev_b32 v26, 16, v132
  v_and_b32 v27, 0xffff0000, v132
  v_lshlrev_b32 v28, 16, v133
  v_and_b32 v29, 0xffff0000, v133
  v_lshlrev_b32 v30, 16, v134
  v_and_b32 v31, 0xffff0000, v134
  v_lshlrev_b32 v32, 16, v135
  v_and_b32 v33, 0xffff0000, v135
  v_mul_f32_dpp v26, v188, v26 quad_perm:[2,2,2,2] row_mask:0xf bank_mask:0xf
  v_mul_f32_dpp v27, v189, v27 quad_perm:[2,2,2,2] row_mask:0xf bank_mask:0xf
  v_mul_f32_dpp v28, v190, v28 quad_perm:[2,2,2,2] row_mask:0xf bank_mask:0xf
  v_mul_f32_dpp v29, v191, v29 quad_perm:[2,2,2,2] row_mask:0xf bank_mask:0xf
  v_mul_f32_dpp v30, v188, v30 quad_perm:[3,3,3,3] row_mask:0xf bank_mask:0xf
  v_mul_f32_dpp v31, v189, v31 quad_perm:[3,3,3,3] row_mask:0xf bank_mask:0xf
  v_mul_f32_dpp v32, v190, v32 quad_perm:[3,3,3,3] row_mask:0xf bank_mask:0xf
  v_mul_f32_dpp v33, v191, v33 quad_perm:[3,3,3,3] row_mask:0xf bank_mask:0xf
  v_cvt_pk_bf16_f32 v164, v26, v27
  v_lshlrev_b32 v26, 16, v164
  v_and_b32 v27, 0xffff0000, v164
  v_cvt_pk_bf16_f32 v165, v28, v29
  v_lshlrev_b32 v28, 16, v165
  v_and_b32 v29, 0xffff0000, v165
  v_cvt_pk_bf16_f32 v166, v30, v31
  v_lshlrev_b32 v30, 16, v166
  v_and_b32 v31, 0xffff0000, v166
  v_cvt_pk_bf16_f32 v167, v32, v33
  v_lshlrev_b32 v32, 16, v167
  v_and_b32 v33, 0xffff0000, v167
  v_add_f32_dpp v26, v188, v26 quad_perm:[0,0,0,0] row_mask:0xf bank_mask:0xf
  v_add_f32_dpp v27, v189, v27 quad_perm:[0,0,0,0] row_mask:0xf bank_mask:0xf
  v_add_f32_dpp v28, v190, v28 quad_perm:[0,0,0,0] row_mask:0xf bank_mask:0xf
  v_add_f32_dpp v29, v191, v29 quad_perm:[0,0,0,0] row_mask:0xf bank_mask:0xf
  v_add_f32_dpp v30, v188, v30 quad_perm:[1,1,1,1] row_mask:0xf bank_mask:0xf
  v_add_f32_dpp v31, v189, v31 quad_perm:[1,1,1,1] row_mask:0xf bank_mask:0xf
  v_add_f32_dpp v32, v190, v32 quad_perm:[1,1,1,1] row_mask:0xf bank_mask:0xf
  v_add_f32_dpp v33, v191, v33 quad_perm:[1,1,1,1] row_mask:0xf bank_mask:0xf
  v_cvt_pk_bf16_f32 v208, v26, v27
  v_cvt_pk_bf16_f32 v209, v28, v29
  v_cvt_pk_bf16_f32 v210, v30, v31
  v_cvt_pk_bf16_f32 v211, v32, v33
  s_add_u32 s35, s38, 12288
  buffer_store_dwordx4 v[208:211], v161, s[8:11], s35 offen
  v_lshlrev_b32 v34, 16, v136
  v_and_b32 v35, 0xffff0000, v136
  v_lshlrev_b32 v36, 16, v137
  v_and_b32 v37, 0xffff0000, v137
  v_lshlrev_b32 v38, 16, v138
  v_and_b32 v39, 0xffff0000, v138
  v_lshlrev_b32 v40, 16, v139
  v_and_b32 v41, 0xffff0000, v139
  v_mul_f32_dpp v34, v192, v34 quad_perm:[2,2,2,2] row_mask:0xf bank_mask:0xf
  v_mul_f32_dpp v35, v193, v35 quad_perm:[2,2,2,2] row_mask:0xf bank_mask:0xf
  v_mul_f32_dpp v36, v194, v36 quad_perm:[2,2,2,2] row_mask:0xf bank_mask:0xf
  v_mul_f32_dpp v37, v195, v37 quad_perm:[2,2,2,2] row_mask:0xf bank_mask:0xf
  v_mul_f32_dpp v38, v192, v38 quad_perm:[3,3,3,3] row_mask:0xf bank_mask:0xf
  v_mul_f32_dpp v39, v193, v39 quad_perm:[3,3,3,3] row_mask:0xf bank_mask:0xf
  v_mul_f32_dpp v40, v194, v40 quad_perm:[3,3,3,3] row_mask:0xf bank_mask:0xf
  v_mul_f32_dpp v41, v195, v41 quad_perm:[3,3,3,3] row_mask:0xf bank_mask:0xf
  v_cvt_pk_bf16_f32 v164, v34, v35
  v_lshlrev_b32 v34, 16, v164
  v_and_b32 v35, 0xffff0000, v164
  v_cvt_pk_bf16_f32 v165, v36, v37
  v_lshlrev_b32 v36, 16, v165
  v_and_b32 v37, 0xffff0000, v165
  v_cvt_pk_bf16_f32 v166, v38, v39
  v_lshlrev_b32 v38, 16, v166
  v_and_b32 v39, 0xffff0000, v166
  v_cvt_pk_bf16_f32 v167, v40, v41
  v_lshlrev_b32 v40, 16, v167
  v_and_b32 v41, 0xffff0000, v167
  v_add_f32_dpp v34, v192, v34 quad_perm:[0,0,0,0] row_mask:0xf bank_mask:0xf
  v_add_f32_dpp v35, v193, v35 quad_perm:[0,0,0,0] row_mask:0xf bank_mask:0xf
  v_add_f32_dpp v36, v194, v36 quad_perm:[0,0,0,0] row_mask:0xf bank_mask:0xf
  v_add_f32_dpp v37, v195, v37 quad_perm:[0,0,0,0] row_mask:0xf bank_mask:0xf
  v_add_f32_dpp v38, v192, v38 quad_perm:[1,1,1,1] row_mask:0xf bank_mask:0xf
  v_add_f32_dpp v39, v193, v39 quad_perm:[1,1,1,1] row_mask:0xf bank_mask:0xf
  v_add_f32_dpp v40, v194, v40 quad_perm:[1,1,1,1] row_mask:0xf bank_mask:0xf
  v_add_f32_dpp v41, v195, v41 quad_perm:[1,1,1,1] row_mask:0xf bank_mask:0xf
  v_cvt_pk_bf16_f32 v212, v34, v35
  v_cvt_pk_bf16_f32 v213, v36, v37
  v_cvt_pk_bf16_f32 v214, v38, v39
  v_cvt_pk_bf16_f32 v215, v40, v41
  s_add_u32 s35, s38, 16384
  buffer_store_dwordx4 v[212:215], v161, s[8:11], s35 offen
  s_add_u32 s38, s38, 81920
  s_add_u32 s33, s33, 4
  buffer_load_dwordx4 v[46:49], v160, s[20:23], s37 offen offset:0
  buffer_load_dwordx4 v[50:53], v160, s[20:23], s37 offen offset:256
  buffer_load_dwordx4 v[54:57], v160, s[20:23], s37 offen offset:512
  buffer_load_dwordx4 v[58:61], v160, s[20:23], s37 offen offset:768
  buffer_load_dwordx4 v[62:65], v160, s[20:23], s37 offen offset:1024
  s_add_u32 s37, s37, 81920
  s_min_u32 s37, s37, 2616320
  buffer_load_dwordx4 v[66:69], v160, s[20:23], s37 offen offset:0
  buffer_load_dwordx4 v[70:73], v160, s[20:23], s37 offen offset:256
  buffer_load_dwordx4 v[74:77], v160, s[20:23], s37 offen offset:512
  buffer_load_dwordx4 v[78:81], v160, s[20:23], s37 offen offset:768
  buffer_load_dwordx4 v[82:85], v160, s[20:23], s37 offen offset:1024
  s_add_u32 s37, s37, 81920
  s_min_u32 s37, s37, 2616320
  buffer_load_dwordx4 v[140:143], v160, s[20:23], s37 offen offset:0
  buffer_load_dwordx4 v[144:147], v160, s[20:23], s37 offen offset:256
  buffer_load_dwordx4 v[148:151], v160, s[20:23], s37 offen offset:512
  buffer_load_dwordx4 v[152:155], v160, s[20:23], s37 offen offset:768
  buffer_load_dwordx4 v[156:159], v160, s[20:23], s37 offen offset:1024
  s_add_u32 s37, s37, 81920
  s_min_u32 s37, s37, 2616320
  v_mov_b32 v92, s33
  s_waitcnt vmcnt(15)
  buffer_store_dword v92, v228, s[8:11], 0 offen
  s_waitcnt vmcnt(11)
  v_lshlrev_b32 v2, 16, v46
  v_and_b32 v3, 0xffff0000, v46
  v_lshlrev_b32 v4, 16, v47
  v_and_b32 v5, 0xffff0000, v47
  v_lshlrev_b32 v6, 16, v48
  v_and_b32 v7, 0xffff0000, v48
  v_lshlrev_b32 v8, 16, v49
  v_and_b32 v9, 0xffff0000, v49
  v_lshlrev_b32 v10, 16, v50
  v_and_b32 v11, 0xffff0000, v50
  v_lshlrev_b32 v12, 16, v51
  v_and_b32 v13, 0xffff0000, v51
  v_lshlrev_b32 v14, 16, v52
  v_and_b32 v15, 0xffff0000, v52
  v_lshlrev_b32 v16, 16, v53
  v_and_b32 v17, 0xffff0000, v53
  v_lshlrev_b32 v18, 16, v54
  v_and_b32 v19, 0xffff0000, v54
  v_lshlrev_b32 v20, 16, v55
  v_and_b32 v21, 0xffff0000, v55
  v_lshlrev_b32 v22, 16, v56
  v_and_b32 v23, 0xffff0000, v56
  v_lshlrev_b32 v24, 16, v57
  v_and_b32 v25, 0xffff0000, v57
  v_lshlrev_b32 v26, 16, v58
  v_and_b32 v27, 0xffff0000, v58
  v_lshlrev_b32 v28, 16, v59
  v_and_b32 v29, 0xffff0000, v59
  v_lshlrev_b32 v30, 16, v60
  v_and_b32 v31, 0xffff0000, v60
  v_lshlrev_b32 v32, 16, v61
  v_and_b32 v33, 0xffff0000, v61
  v_lshlrev_b32 v34, 16, v62
  v_and_b32 v35, 0xffff0000, v62
  v_lshlrev_b32 v36, 16, v63
  v_and_b32 v37, 0xffff0000, v63
  v_lshlrev_b32 v38, 16, v64
  v_and_b32 v39, 0xffff0000, v64
  v_lshlrev_b32 v40, 16, v65
  v_and_b32 v41, 0xffff0000, v65
  v_pk_add_f32 v[86:87], v[2:3], v[4:5]
  v_pk_add_f32 v[88:89], v[6:7], v[8:9]
  v_pk_add_f32 v[86:87], v[86:87], v[10:11]
  v_pk_add_f32 v[88:89], v[88:89], v[12:13]
  v_pk_add_f32 v[86:87], v[86:87], v[14:15]
  v_pk_add_f32 v[88:89], v[88:89], v[16:17]
  v_pk_add_f32 v[86:87], v[86:87], v[18:19]
  v_pk_add_f32 v[88:89], v[88:89], v[20:21]
  v_pk_add_f32 v[86:87], v[86:87], v[22:23]
  v_pk_add_f32 v[88:89], v[88:89], v[24:25]
  v_pk_add_f32 v[86:87], v[86:87], v[26:27]
  v_pk_add_f32 v[88:89], v[88:89], v[28:29]
  v_pk_add_f32 v[86:87], v[86:87], v[30:31]
  v_pk_add_f32 v[88:89], v[88:89], v[32:33]
  v_pk_add_f32 v[86:87], v[86:87], v[34:35]
  v_pk_add_f32 v[88:89], v[88:89], v[36:37]
  v_pk_add_f32 v[86:87], v[86:87], v[38:39]
  v_pk_add_f32 v[88:89], v[88:89], v[40:41]
  v_pk_add_f32 v[86:87], v[86:87], v[88:89]
  v_add_f32 v86, v86, v87
  s_nop 1
  v_add_f32_dpp v86, v86, v86 row_ror:8 row_mask:0xf bank_mask:0xf
  s_nop 1
  v_add_f32_dpp v86, v86, v86 row_ror:4 row_mask:0xf bank_mask:0xf
  v_mov_b32 v90, v86
  s_nop 1
  v_permlane16_swap_b32 v86, v90
  v_add_f32 v86, v86, v90
  v_mov_b32 v90, v86
  s_nop 1
  v_permlane32_swap_b32 v86, v90
  v_add_f32 v86, v86, v90
  v_mul_f32 v88, 0xbacccccd, v86
  v_mul_f32 v89, 0xbacccccd, v86
  v_pk_add_f32 v[164:165], v[2:3], v[88:89]
  v_pk_add_f32 v[166:167], v[4:5], v[88:89]
  v_pk_mul_f32 v[170:171], v[164:165], v[164:165]
  v_pk_add_f32 v[168:169], v[6:7], v[88:89]
  v_pk_mul_f32 v[86:87], v[166:167], v[166:167]
  v_pk_add_f32 v[164:165], v[8:9], v[88:89]
  v_pk_fma_f32 v[170:171], v[168:169], v[168:169], v[170:171]
  v_pk_add_f32 v[166:167], v[10:11], v[88:89]
  v_pk_fma_f32 v[86:87], v[164:165], v[164:165], v[86:87]
  v_pk_add_f32 v[168:169], v[12:13], v[88:89]
  v_pk_fma_f32 v[170:171], v[166:167], v[166:167], v[170:171]
  v_pk_add_f32 v[164:165], v[14:15], v[88:89]
  v_pk_fma_f32 v[86:87], v[168:169], v[168:169], v[86:87]
  v_pk_add_f32 v[166:167], v[16:17], v[88:89]
  v_pk_fma_f32 v[170:171], v[164:165], v[164:165], v[170:171]
  v_pk_add_f32 v[168:169], v[18:19], v[88:89]
  v_pk_fma_f32 v[86:87], v[166:167], v[166:167], v[86:87]
  v_pk_add_f32 v[164:165], v[20:21], v[88:89]
  v_pk_fma_f32 v[170:171], v[168:169], v[168:169], v[170:171]
  v_pk_add_f32 v[166:167], v[22:23], v[88:89]
  v_pk_fma_f32 v[86:87], v[164:165], v[164:165], v[86:87]
  v_pk_add_f32 v[168:169], v[24:25], v[88:89]
  v_pk_fma_f32 v[170:171], v[166:167], v[166:167], v[170:171]
  v_pk_add_f32 v[164:165], v[26:27], v[88:89]
  v_pk_fma_f32 v[86:87], v[168:169], v[168:169], v[86:87]
  v_pk_add_f32 v[166:167], v[28:29], v[88:89]
  v_pk_fma_f32 v[170:171], v[164:165], v[164:165], v[170:171]
  v_pk_add_f32 v[168:169], v[30:31], v[88:89]
  v_pk_fma_f32 v[86:87], v[166:167], v[166:167], v[86:87]
  v_pk_add_f32 v[164:165], v[32:33], v[88:89]
  v_pk_fma_f32 v[170:171], v[168:169], v[168:169], v[170:171]
  v_pk_add_f32 v[166:167], v[34:35], v[88:89]
  v_pk_fma_f32 v[86:87], v[164:165], v[164:165], v[86:87]
  v_pk_add_f32 v[168:169], v[36:37], v[88:89]
  v_pk_fma_f32 v[170:171], v[166:167], v[166:167], v[170:171]
  v_pk_add_f32 v[164:165], v[38:39], v[88:89]
  v_pk_fma_f32 v[86:87], v[168:169], v[168:169], v[86:87]
  v_pk_add_f32 v[166:167], v[40:41], v[88:89]
  v_pk_fma_f32 v[170:171], v[164:165], v[164:165], v[170:171]
  v_pk_fma_f32 v[86:87], v[166:167], v[166:167], v[86:87]
  v_cvt_pk_bf16_f32 v91, v88, v89
  v_lshlrev_b32 v88, 16, v91
  v_and_b32 v89, 0xffff0000, v91
  v_pk_add_f32 v[86:87], v[86:87], v[170:171]
  v_add_f32 v86, v86, v87
  s_nop 1
  v_add_f32_dpp v86, v86, v86 row_ror:8 row_mask:0xf bank_mask:0xf
  s_nop 1
  v_add_f32_dpp v86, v86, v86 row_ror:4 row_mask:0xf bank_mask:0xf
  v_mov_b32 v90, v86
  s_nop 1
  v_permlane16_swap_b32 v86, v90
  v_add_f32 v86, v86, v90
  v_mov_b32 v90, v86
  s_nop 1
  v_permlane32_swap_b32 v86, v90
  v_add_f32 v86, v86, v90
  v_pk_add_f32 v[2:3], v[2:3], v[88:89]
  v_mul_f32 v86, 0x3acccccd, v86
  v_pk_add_f32 v[4:5], v[4:5], v[88:89]
  v_cvt_pk_bf16_f32 v86, v86, v86
  v_pk_add_f32 v[6:7], v[6:7], v[88:89]
  v_lshlrev_b32 v86, 16, v86
  v_pk_add_f32 v[8:9], v[8:9], v[88:89]
  v_add_f32 v86, 0x3727c5ac, v86
  v_pk_add_f32 v[10:11], v[10:11], v[88:89]
  v_cvt_pk_bf16_f32 v86, v86, v86
  v_pk_add_f32 v[12:13], v[12:13], v[88:89]
  v_lshlrev_b32 v86, 16, v86
  v_pk_add_f32 v[14:15], v[14:15], v[88:89]
  v_sqrt_f32 v86, v86
  v_pk_add_f32 v[16:17], v[16:17], v[88:89]
  v_cvt_pk_bf16_f32 v86, v86, v86
  v_pk_add_f32 v[18:19], v[18:19], v[88:89]
  v_lshlrev_b32 v86, 16, v86
  v_pk_add_f32 v[20:21], v[20:21], v[88:89]
  v_rcp_f32 v86, v86
  v_pk_add_f32 v[22:23], v[22:23], v[88:89]
  v_mov_b32 v87, v86
  v_pk_add_f32 v[24:25], v[24:25], v[88:89]
  v_pk_add_f32 v[26:27], v[26:27], v[88:89]
  v_pk_add_f32 v[28:29], v[28:29], v[88:89]
  v_pk_add_f32 v[30:31], v[30:31], v[88:89]
  v_pk_add_f32 v[32:33], v[32:33], v[88:89]
  v_pk_add_f32 v[34:35], v[34:35], v[88:89]
  v_pk_add_f32 v[36:37], v[36:37], v[88:89]
  v_pk_add_f32 v[38:39], v[38:39], v[88:89]
  v_pk_add_f32 v[40:41], v[40:41], v[88:89]
  v_cvt_pk_bf16_f32 v164, v2, v3
  v_lshlrev_b32 v2, 16, v164
  v_and_b32 v3, 0xffff0000, v164
  v_cvt_pk_bf16_f32 v165, v4, v5
  v_lshlrev_b32 v4, 16, v165
  v_and_b32 v5, 0xffff0000, v165
  v_cvt_pk_bf16_f32 v166, v6, v7
  v_lshlrev_b32 v6, 16, v166
  v_and_b32 v7, 0xffff0000, v166
  v_cvt_pk_bf16_f32 v167, v8, v9
  v_lshlrev_b32 v8, 16, v167
  v_and_b32 v9, 0xffff0000, v167
  v_cvt_pk_bf16_f32 v164, v10, v11
  v_lshlrev_b32 v10, 16, v164
  v_and_b32 v11, 0xffff0000, v164
  v_cvt_pk_bf16_f32 v165, v12, v13
  v_lshlrev_b32 v12, 16, v165
  v_and_b32 v13, 0xffff0000, v165
  v_cvt_pk_bf16_f32 v166, v14, v15
  v_lshlrev_b32 v14, 16, v166
  v_and_b32 v15, 0xffff0000, v166
  v_cvt_pk_bf16_f32 v167, v16, v17
  v_lshlrev_b32 v16, 16, v167
  v_and_b32 v17, 0xffff0000, v167
  v_cvt_pk_bf16_f32 v164, v18, v19
  v_lshlrev_b32 v18, 16, v164
  v_and_b32 v19, 0xffff0000, v164
  v_cvt_pk_bf16_f32 v165, v20, v21
  v_lshlrev_b32 v20, 16, v165
  v_and_b32 v21, 0xffff0000, v165
  v_cvt_pk_bf16_f32 v166, v22, v23
  v_lshlrev_b32 v22, 16, v166
  v_and_b32 v23, 0xffff0000, v166
  v_cvt_pk_bf16_f32 v167, v24, v25
  v_lshlrev_b32 v24, 16, v167
  v_and_b32 v25, 0xffff0000, v167
  v_cvt_pk_bf16_f32 v164, v26, v27
  v_lshlrev_b32 v26, 16, v164
  v_and_b32 v27, 0xffff0000, v164
  v_cvt_pk_bf16_f32 v165, v28, v29
  v_lshlrev_b32 v28, 16, v165
  v_and_b32 v29, 0xffff0000, v165
  v_cvt_pk_bf16_f32 v166, v30, v31
  v_lshlrev_b32 v30, 16, v166
  v_and_b32 v31, 0xffff0000, v166
  v_cvt_pk_bf16_f32 v167, v32, v33
  v_lshlrev_b32 v32, 16, v167
  v_and_b32 v33, 0xffff0000, v167
  v_cvt_pk_bf16_f32 v164, v34, v35
  v_lshlrev_b32 v34, 16, v164
  v_and_b32 v35, 0xffff0000, v164
  v_cvt_pk_bf16_f32 v165, v36, v37
  v_lshlrev_b32 v36, 16, v165
  v_and_b32 v37, 0xffff0000, v165
  v_cvt_pk_bf16_f32 v166, v38, v39
  v_lshlrev_b32 v38, 16, v166
  v_and_b32 v39, 0xffff0000, v166
  v_cvt_pk_bf16_f32 v167, v40, v41
  v_lshlrev_b32 v40, 16, v167
  v_and_b32 v41, 0xffff0000, v167
  v_mov_b32 v92, s33
  s_waitcnt vmcnt(6)
  buffer_store_dword v92, v228, s[8:11], 0 offen
  v_pk_mul_f32 v[2:3], v[2:3], v[86:87]
  v_pk_mul_f32 v[4:5], v[4:5], v[86:87]
  v_pk_mul_f32 v[6:7], v[6:7], v[86:87]
  v_pk_mul_f32 v[8:9], v[8:9], v[86:87]
  v_pk_mul_f32 v[10:11], v[10:11], v[86:87]
  v_pk_mul_f32 v[12:13], v[12:13], v[86:87]
  v_pk_mul_f32 v[14:15], v[14:15], v[86:87]
  v_pk_mul_f32 v[16:17], v[16:17], v[86:87]
  v_pk_mul_f32 v[18:19], v[18:19], v[86:87]
  v_pk_mul_f32 v[20:21], v[20:21], v[86:87]
  v_pk_mul_f32 v[22:23], v[22:23], v[86:87]
  v_pk_mul_f32 v[24:25], v[24:25], v[86:87]
  v_pk_mul_f32 v[26:27], v[26:27], v[86:87]
  v_pk_mul_f32 v[28:29], v[28:29], v[86:87]
  v_pk_mul_f32 v[30:31], v[30:31], v[86:87]
  v_pk_mul_f32 v[32:33], v[32:33], v[86:87]
  v_pk_mul_f32 v[34:35], v[34:35], v[86:87]
  v_pk_mul_f32 v[36:37], v[36:37], v[86:87]
  v_pk_mul_f32 v[38:39], v[38:39], v[86:87]
  v_pk_mul_f32 v[40:41], v[40:41], v[86:87]
  v_cvt_pk_bf16_f32 v164, v2, v3
  v_lshlrev_b32 v2, 16, v164
  v_and_b32 v3, 0xffff0000, v164
  v_cvt_pk_bf16_f32 v165, v4, v5
  v_lshlrev_b32 v4, 16, v165
  v_and_b32 v5, 0xffff0000, v165
  v_cvt_pk_bf16_f32 v166, v6, v7
  v_lshlrev_b32 v6, 16, v166
  v_and_b32 v7, 0xffff0000, v166
  v_cvt_pk_bf16_f32 v167, v8, v9
  v_lshlrev_b32 v8, 16, v167
  v_and_b32 v9, 0xffff0000, v167
  v_cvt_pk_bf16_f32 v164, v10, v11
  v_lshlrev_b32 v10, 16, v164
  v_and_b32 v11, 0xffff0000, v164
  v_cvt_pk_bf16_f32 v165, v12, v13
  v_lshlrev_b32 v12, 16, v165
  v_and_b32 v13, 0xffff0000, v165
  v_cvt_pk_bf16_f32 v166, v14, v15
  v_lshlrev_b32 v14, 16, v166
  v_and_b32 v15, 0xffff0000, v166
  v_cvt_pk_bf16_f32 v167, v16, v17
  v_lshlrev_b32 v16, 16, v167
  v_and_b32 v17, 0xffff0000, v167
  v_cvt_pk_bf16_f32 v164, v18, v19
  v_lshlrev_b32 v18, 16, v164
  v_and_b32 v19, 0xffff0000, v164
  v_cvt_pk_bf16_f32 v165, v20, v21
  v_lshlrev_b32 v20, 16, v165
  v_and_b32 v21, 0xffff0000, v165
  v_cvt_pk_bf16_f32 v166, v22, v23
  v_lshlrev_b32 v22, 16, v166
  v_and_b32 v23, 0xffff0000, v166
  v_cvt_pk_bf16_f32 v167, v24, v25
  v_lshlrev_b32 v24, 16, v167
  v_and_b32 v25, 0xffff0000, v167
  v_cvt_pk_bf16_f32 v164, v26, v27
  v_lshlrev_b32 v26, 16, v164
  v_and_b32 v27, 0xffff0000, v164
  v_cvt_pk_bf16_f32 v165, v28, v29
  v_lshlrev_b32 v28, 16, v165
  v_and_b32 v29, 0xffff0000, v165
  v_cvt_pk_bf16_f32 v166, v30, v31
  v_lshlrev_b32 v30, 16, v166
  v_and_b32 v31, 0xffff0000, v166
  v_cvt_pk_bf16_f32 v167, v32, v33
  v_lshlrev_b32 v32, 16, v167
  v_and_b32 v33, 0xffff0000, v167
  v_cvt_pk_bf16_f32 v164, v34, v35
  v_lshlrev_b32 v34, 16, v164
  v_and_b32 v35, 0xffff0000, v164
  v_cvt_pk_bf16_f32 v165, v36, v37
  v_lshlrev_b32 v36, 16, v165
  v_and_b32 v37, 0xffff0000, v165
  v_cvt_pk_bf16_f32 v166, v38, v39
  v_lshlrev_b32 v38, 16, v166
  v_and_b32 v39, 0xffff0000, v166
  v_cvt_pk_bf16_f32 v167, v40, v41
  v_lshlrev_b32 v40, 16, v167
  v_and_b32 v41, 0xffff0000, v167
  v_mul_f32_dpp v2, v176, v2 quad_perm:[2,2,2,2] row_mask:0xf bank_mask:0xf
  v_mul_f32_dpp v3, v177, v3 quad_perm:[2,2,2,2] row_mask:0xf bank_mask:0xf
  v_mul_f32_dpp v4, v178, v4 quad_perm:[2,2,2,2] row_mask:0xf bank_mask:0xf
  v_mul_f32_dpp v5, v179, v5 quad_perm:[2,2,2,2] row_mask:0xf bank_mask:0xf
  v_mul_f32_dpp v6, v176, v6 quad_perm:[3,3,3,3] row_mask:0xf bank_mask:0xf
  v_mul_f32_dpp v7, v177, v7 quad_perm:[3,3,3,3] row_mask:0xf bank_mask:0xf
  v_mul_f32_dpp v8, v178, v8 quad_perm:[3,3,3,3] row_mask:0xf bank_mask:0xf
  v_mul_f32_dpp v9, v179, v9 quad_perm:[3,3,3,3] row_mask:0xf bank_mask:0xf
  v_cvt_pk_bf16_f32 v164, v2, v3
  v_lshlrev_b32 v2, 16, v164
  v_and_b32 v3, 0xffff0000, v164
  v_cvt_pk_bf16_f32 v165, v4, v5
  v_lshlrev_b32 v4, 16, v165
  v_and_b32 v5, 0xffff0000, v165
  v_cvt_pk_bf16_f32 v166, v6, v7
  v_lshlrev_b32 v6, 16, v166
  v_and_b32 v7, 0xffff0000, v166
  v_cvt_pk_bf16_f32 v167, v8, v9
  v_lshlrev_b32 v8, 16, v167
  v_and_b32 v9, 0xffff0000, v167
  v_add_f32_dpp v2, v176, v2 quad_perm:[0,0,0,0] row_mask:0xf bank_mask:0xf
  v_add_f32_dpp v3, v177, v3 quad_perm:[0,0,0,0] row_mask:0xf bank_mask:0xf
  v_add_f32_dpp v4, v178, v4 quad_perm:[0,0,0,0] row_mask:0xf bank_mask:0xf
  v_add_f32_dpp v5, v179, v5 quad_perm:[0,0,0,0] row_mask:0xf bank_mask:0xf
  v_add_f32_dpp v6, v176, v6 quad_perm:[1,1,1,1] row_mask:0xf bank_mask:0xf
  v_add_f32_dpp v7, v177, v7 quad_perm:[1,1,1,1] row_mask:0xf bank_mask:0xf
  v_add_f32_dpp v8, v178, v8 quad_perm:[1,1,1,1] row_mask:0xf bank_mask:0xf
  v_add_f32_dpp v9, v179, v9 quad_perm:[1,1,1,1] row_mask:0xf bank_mask:0xf
  v_cvt_pk_bf16_f32 v196, v2, v3
  v_cvt_pk_bf16_f32 v197, v4, v5
  v_cvt_pk_bf16_f32 v198, v6, v7
  v_cvt_pk_bf16_f32 v199, v8, v9
  s_add_u32 s35, s38, 0
  buffer_store_dwordx4 v[196:199], v161, s[8:11], s35 offen
  v_mul_f32_dpp v10, v180, v10 quad_perm:[2,2,2,2] row_mask:0xf bank_mask:0xf
  v_mul_f32_dpp v11, v181, v11 quad_perm:[2,2,2,2] row_mask:0xf bank_mask:0xf
  v_mul_f32_dpp v12, v182, v12 quad_perm:[2,2,2,2] row_mask:0xf bank_mask:0xf
  v_mul_f32_dpp v13, v183, v13 quad_perm:[2,2,2,2] row_mask:0xf bank_mask:0xf
  v_mul_f32_dpp v14, v180, v14 quad_perm:[3,3,3,3] row_mask:0xf bank_mask:0xf
  v_mul_f32_dpp v15, v181, v15 quad_perm:[3,3,3,3] row_mask:0xf bank_mask:0xf
  v_mul_f32_dpp v16, v182, v16 quad_perm:[3,3,3,3] row_mask:0xf bank_mask:0xf
  v_mul_f32_dpp v17, v183, v17 quad_perm:[3,3,3,3] row_mask:0xf bank_mask:0xf
  v_cvt_pk_bf16_f32 v164, v10, v11
  v_lshlrev_b32 v10, 16, v164
  v_and_b32 v11, 0xffff0000, v164
  v_cvt_pk_bf16_f32 v165, v12, v13
  v_lshlrev_b32 v12, 16, v165
  v_and_b32 v13, 0xffff0000, v165
  v_cvt_pk_bf16_f32 v166, v14, v15
  v_lshlrev_b32 v14, 16, v166
  v_and_b32 v15, 0xffff0000, v166
  v_cvt_pk_bf16_f32 v167, v16, v17
  v_lshlrev_b32 v16, 16, v167
  v_and_b32 v17, 0xffff0000, v167
  v_add_f32_dpp v10, v180, v10 quad_perm:[0,0,0,0] row_mask:0xf bank_mask:0xf
  v_add_f32_dpp v11, v181, v11 quad_perm:[0,0,0,0] row_mask:0xf bank_mask:0xf
  v_add_f32_dpp v12, v182, v12 quad_perm:[0,0,0,0] row_mask:0xf bank_mask:0xf
  v_add_f32_dpp v13, v183, v13 quad_perm:[0,0,0,0] row_mask:0xf bank_mask:0xf
  v_add_f32_dpp v14, v180, v14 quad_perm:[1,1,1,1] row_mask:0xf bank_mask:0xf
  v_add_f32_dpp v15, v181, v15 quad_perm:[1,1,1,1] row_mask:0xf bank_mask:0xf
  v_add_f32_dpp v16, v182, v16 quad_perm:[1,1,1,1] row_mask:0xf bank_mask:0xf
  v_add_f32_dpp v17, v183, v17 quad_perm:[1,1,1,1] row_mask:0xf bank_mask:0xf
  v_cvt_pk_bf16_f32 v200, v10, v11
  v_cvt_pk_bf16_f32 v201, v12, v13
  v_cvt_pk_bf16_f32 v202, v14, v15
  v_cvt_pk_bf16_f32 v203, v16, v17
  s_add_u32 s35, s38, 4096
  buffer_store_dwordx4 v[200:203], v161, s[8:11], s35 offen
  v_mul_f32_dpp v18, v184, v18 quad_perm:[2,2,2,2] row_mask:0xf bank_mask:0xf
  v_mul_f32_dpp v19, v185, v19 quad_perm:[2,2,2,2] row_mask:0xf bank_mask:0xf
  v_mul_f32_dpp v20, v186, v20 quad_perm:[2,2,2,2] row_mask:0xf bank_mask:0xf
  v_mul_f32_dpp v21, v187, v21 quad_perm:[2,2,2,2] row_mask:0xf bank_mask:0xf
  v_mul_f32_dpp v22, v184, v22 quad_perm:[3,3,3,3] row_mask:0xf bank_mask:0xf
  v_mul_f32_dpp v23, v185, v23 quad_perm:[3,3,3,3] row_mask:0xf bank_mask:0xf
  v_mul_f32_dpp v24, v186, v24 quad_perm:[3,3,3,3] row_mask:0xf bank_mask:0xf
  v_mul_f32_dpp v25, v187, v25 quad_perm:[3,3,3,3] row_mask:0xf bank_mask:0xf
  v_cvt_pk_bf16_f32 v164, v18, v19
  v_lshlrev_b32 v18, 16, v164
  v_and_b32 v19, 0xffff0000, v164
  v_cvt_pk_bf16_f32 v165, v20, v21
  v_lshlrev_b32 v20, 16, v165
  v_and_b32 v21, 0xffff0000, v165
  v_cvt_pk_bf16_f32 v166, v22, v23
  v_lshlrev_b32 v22, 16, v166
  v_and_b32 v23, 0xffff0000, v166
  v_cvt_pk_bf16_f32 v167, v24, v25
  v_lshlrev_b32 v24, 16, v167
  v_and_b32 v25, 0xffff0000, v167
  v_add_f32_dpp v18, v184, v18 quad_perm:[0,0,0,0] row_mask:0xf bank_mask:0xf
  v_add_f32_dpp v19, v185, v19 quad_perm:[0,0,0,0] row_mask:0xf bank_mask:0xf
  v_add_f32_dpp v20, v186, v20 quad_perm:[0,0,0,0] row_mask:0xf bank_mask:0xf
  v_add_f32_dpp v21, v187, v21 quad_perm:[0,0,0,0] row_mask:0xf bank_mask:0xf
  v_add_f32_dpp v22, v184, v22 quad_perm:[1,1,1,1] row_mask:0xf bank_mask:0xf
  v_add_f32_dpp v23, v185, v23 quad_perm:[1,1,1,1] row_mask:0xf bank_mask:0xf
  v_add_f32_dpp v24, v186, v24 quad_perm:[1,1,1,1] row_mask:0xf bank_mask:0xf
  v_add_f32_dpp v25, v187, v25 quad_perm:[1,1,1,1] row_mask:0xf bank_mask:0xf
  v_cvt_pk_bf16_f32 v204, v18, v19
  v_cvt_pk_bf16_f32 v205, v20, v21
  v_cvt_pk_bf16_f32 v206, v22, v23
  v_cvt_pk_bf16_f32 v207, v24, v25
  s_add_u32 s35, s38, 8192
  buffer_store_dwordx4 v[204:207], v161, s[8:11], s35 offen
  v_mul_f32_dpp v26, v188, v26 quad_perm:[2,2,2,2] row_mask:0xf bank_mask:0xf
  v_mul_f32_dpp v27, v189, v27 quad_perm:[2,2,2,2] row_mask:0xf bank_mask:0xf
  v_mul_f32_dpp v28, v190, v28 quad_perm:[2,2,2,2] row_mask:0xf bank_mask:0xf
  v_mul_f32_dpp v29, v191, v29 quad_perm:[2,2,2,2] row_mask:0xf bank_mask:0xf
  v_mul_f32_dpp v30, v188, v30 quad_perm:[3,3,3,3] row_mask:0xf bank_mask:0xf
  v_mul_f32_dpp v31, v189, v31 quad_perm:[3,3,3,3] row_mask:0xf bank_mask:0xf
  v_mul_f32_dpp v32, v190, v32 quad_perm:[3,3,3,3] row_mask:0xf bank_mask:0xf
  v_mul_f32_dpp v33, v191, v33 quad_perm:[3,3,3,3] row_mask:0xf bank_mask:0xf
  v_cvt_pk_bf16_f32 v164, v26, v27
  v_lshlrev_b32 v26, 16, v164
  v_and_b32 v27, 0xffff0000, v164
  v_cvt_pk_bf16_f32 v165, v28, v29
  v_lshlrev_b32 v28, 16, v165
  v_and_b32 v29, 0xffff0000, v165
  v_cvt_pk_bf16_f32 v166, v30, v31
  v_lshlrev_b32 v30, 16, v166
  v_and_b32 v31, 0xffff0000, v166
  v_cvt_pk_bf16_f32 v167, v32, v33
  v_lshlrev_b32 v32, 16, v167
  v_and_b32 v33, 0xffff0000, v167
  v_add_f32_dpp v26, v188, v26 quad_perm:[0,0,0,0] row_mask:0xf bank_mask:0xf
  v_add_f32_dpp v27, v189, v27 quad_perm:[0,0,0,0] row_mask:0xf bank_mask:0xf
  v_add_f32_dpp v28, v190, v28 quad_perm:[0,0,0,0] row_mask:0xf bank_mask:0xf
  v_add_f32_dpp v29, v191, v29 quad_perm:[0,0,0,0] row_mask:0xf bank_mask:0xf
  v_add_f32_dpp v30, v188, v30 quad_perm:[1,1,1,1] row_mask:0xf bank_mask:0xf
  v_add_f32_dpp v31, v189, v31 quad_perm:[1,1,1,1] row_mask:0xf bank_mask:0xf
  v_add_f32_dpp v32, v190, v32 quad_perm:[1,1,1,1] row_mask:0xf bank_mask:0xf
  v_add_f32_dpp v33, v191, v33 quad_perm:[1,1,1,1] row_mask:0xf bank_mask:0xf
  v_cvt_pk_bf16_f32 v208, v26, v27
  v_cvt_pk_bf16_f32 v209, v28, v29
  v_cvt_pk_bf16_f32 v210, v30, v31
  v_cvt_pk_bf16_f32 v211, v32, v33
  s_add_u32 s35, s38, 12288
  buffer_store_dwordx4 v[208:211], v161, s[8:11], s35 offen
  v_mul_f32_dpp v34, v192, v34 quad_perm:[2,2,2,2] row_mask:0xf bank_mask:0xf
  v_mul_f32_dpp v35, v193, v35 quad_perm:[2,2,2,2] row_mask:0xf bank_mask:0xf
  v_mul_f32_dpp v36, v194, v36 quad_perm:[2,2,2,2] row_mask:0xf bank_mask:0xf
  v_mul_f32_dpp v37, v195, v37 quad_perm:[2,2,2,2] row_mask:0xf bank_mask:0xf
  v_mul_f32_dpp v38, v192, v38 quad_perm:[3,3,3,3] row_mask:0xf bank_mask:0xf
  v_mul_f32_dpp v39, v193, v39 quad_perm:[3,3,3,3] row_mask:0xf bank_mask:0xf
  v_mul_f32_dpp v40, v194, v40 quad_perm:[3,3,3,3] row_mask:0xf bank_mask:0xf
  v_mul_f32_dpp v41, v195, v41 quad_perm:[3,3,3,3] row_mask:0xf bank_mask:0xf
  v_cvt_pk_bf16_f32 v164, v34, v35
  v_lshlrev_b32 v34, 16, v164
  v_and_b32 v35, 0xffff0000, v164
  v_cvt_pk_bf16_f32 v165, v36, v37
  v_lshlrev_b32 v36, 16, v165
  v_and_b32 v37, 0xffff0000, v165
  v_cvt_pk_bf16_f32 v166, v38, v39
  v_lshlrev_b32 v38, 16, v166
  v_and_b32 v39, 0xffff0000, v166
  v_cvt_pk_bf16_f32 v167, v40, v41
  v_lshlrev_b32 v40, 16, v167
  v_and_b32 v41, 0xffff0000, v167
  v_add_f32_dpp v34, v192, v34 quad_perm:[0,0,0,0] row_mask:0xf bank_mask:0xf
  v_add_f32_dpp v35, v193, v35 quad_perm:[0,0,0,0] row_mask:0xf bank_mask:0xf
  v_add_f32_dpp v36, v194, v36 quad_perm:[0,0,0,0] row_mask:0xf bank_mask:0xf
  v_add_f32_dpp v37, v195, v37 quad_perm:[0,0,0,0] row_mask:0xf bank_mask:0xf
  v_add_f32_dpp v38, v192, v38 quad_perm:[1,1,1,1] row_mask:0xf bank_mask:0xf
  v_add_f32_dpp v39, v193, v39 quad_perm:[1,1,1,1] row_mask:0xf bank_mask:0xf
  v_add_f32_dpp v40, v194, v40 quad_perm:[1,1,1,1] row_mask:0xf bank_mask:0xf
  v_add_f32_dpp v41, v195, v41 quad_perm:[1,1,1,1] row_mask:0xf bank_mask:0xf
  v_cvt_pk_bf16_f32 v212, v34, v35
  v_cvt_pk_bf16_f32 v213, v36, v37
  v_cvt_pk_bf16_f32 v214, v38, v39
  v_cvt_pk_bf16_f32 v215, v40, v41
  s_add_u32 s35, s38, 16384
  buffer_store_dwordx4 v[212:215], v161, s[8:11], s35 offen
  s_add_u32 s38, s38, 81920
  s_add_u32 s33, s33, 4
  buffer_load_dwordx4 v[46:49], v160, s[20:23], s37 offen offset:0
  buffer_load_dwordx4 v[50:53], v160, s[20:23], s37 offen offset:256
  buffer_load_dwordx4 v[54:57], v160, s[20:23], s37 offen offset:512
  buffer_load_dwordx4 v[58:61], v160, s[20:23], s37 offen offset:768
  buffer_load_dwordx4 v[62:65], v160, s[20:23], s37 offen offset:1024
  s_add_u32 s37, s37, 81920
  s_min_u32 s37, s37, 2616320
  s_cmp_lt_u32 s33, 128
r_ln1:
  v_lshlrev_b32 v2, 16, v66
  v_and_b32 v3, 0xffff0000, v66
  v_lshlrev_b32 v4, 16, v67
  v_and_b32 v5, 0xffff0000, v67
  v_lshlrev_b32 v6, 16, v68
  v_and_b32 v7, 0xffff0000, v68
  v_lshlrev_b32 v8, 16, v69
  v_and_b32 v9, 0xffff0000, v69
  v_lshlrev_b32 v10, 16, v70
  v_and_b32 v11, 0xffff0000, v70
  v_lshlrev_b32 v12, 16, v71
  v_and_b32 v13, 0xffff0000, v71
  v_lshlrev_b32 v14, 16, v72
  v_and_b32 v15, 0xffff0000, v72
  v_lshlrev_b32 v16, 16, v73
  v_and_b32 v17, 0xffff0000, v73
  v_lshlrev_b32 v18, 16, v74
  v_and_b32 v19, 0xffff0000, v74
  v_lshlrev_b32 v20, 16, v75
  v_and_b32 v21, 0xffff0000, v75
  v_lshlrev_b32 v22, 16, v76
  v_and_b32 v23, 0xffff0000, v76
  v_lshlrev_b32 v24, 16, v77
  v_and_b32 v25, 0xffff0000, v77
  v_lshlrev_b32 v26, 16, v78
  v_and_b32 v27, 0xffff0000, v78
  v_lshlrev_b32 v28, 16, v79
  v_and_b32 v29, 0xffff0000, v79
  v_lshlrev_b32 v30, 16, v80
  v_and_b32 v31, 0xffff0000, v80
  v_lshlrev_b32 v32, 16, v81
  v_and_b32 v33, 0xffff0000, v81
  v_lshlrev_b32 v34, 16, v82
  v_and_b32 v35, 0xffff0000, v82
  v_lshlrev_b32 v36, 16, v83
  v_and_b32 v37, 0xffff0000, v83
  v_lshlrev_b32 v38, 16, v84
  v_and_b32 v39, 0xffff0000, v84
  v_lshlrev_b32 v40, 16, v85
  v_and_b32 v41, 0xffff0000, v85
  v_pk_add_f32 v[86:87], v[2:3], v[4:5]
  v_pk_add_f32 v[88:89], v[6:7], v[8:9]
  v_pk_add_f32 v[86:87], v[86:87], v[10:11]
  v_pk_add_f32 v[88:89], v[88:89], v[12:13]
  v_pk_add_f32 v[86:87], v[86:87], v[14:15]
  v_pk_add_f32 v[88:89], v[88:89], v[16:17]
  v_pk_add_f32 v[86:87], v[86:87], v[18:19]
  v_pk_add_f32 v[88:89], v[88:89], v[20:21]
  v_pk_add_f32 v[86:87], v[86:87], v[22:23]
  v_pk_add_f32 v[88:89], v[88:89], v[24:25]
  v_pk_add_f32 v[86:87], v[86:87], v[26:27]
  v_pk_add_f32 v[88:89], v[88:89], v[28:29]
  v_pk_add_f32 v[86:87], v[86:87], v[30:31]
  v_pk_add_f32 v[88:89], v[88:89], v[32:33]
  v_pk_add_f32 v[86:87], v[86:87], v[34:35]
  v_pk_add_f32 v[88:89], v[88:89], v[36:37]
  v_pk_add_f32 v[86:87], v[86:87], v[38:39]
  v_pk_add_f32 v[88:89], v[88:89], v[40:41]
  v_pk_add_f32 v[86:87], v[86:87], v[88:89]
  v_add_f32 v86, v86, v87
  s_nop 1
  v_add_f32_dpp v86, v86, v86 row_ror:8 row_mask:0xf bank_mask:0xf
  s_nop 1
  v_add_f32_dpp v86, v86, v86 row_ror:4 row_mask:0xf bank_mask:0xf
  v_mov_b32 v90, v86
  s_nop 1
  v_permlane16_swap_b32 v86, v90
  v_add_f32 v86, v86, v90
  v_mov_b32 v90, v86
  s_nop 1
  v_permlane32_swap_b32 v86, v90
  v_add_f32 v86, v86, v90
  v_mul_f32 v88, 0xbacccccd, v86
  v_mul_f32 v89, 0xbacccccd, v86
  v_pk_add_f32 v[164:165], v[2:3], v[88:89]
  v_pk_add_f32 v[166:167], v[4:5], v[88:89]
  v_pk_mul_f32 v[170:171], v[164:165], v[164:165]
  v_pk_add_f32 v[168:169], v[6:7], v[88:89]
  v_pk_mul_f32 v[86:87], v[166:167], v[166:167]
  v_pk_add_f32 v[164:165], v[8:9], v[88:89]
  v_pk_fma_f32 v[170:171], v[168:169], v[168:169], v[170:171]
  v_pk_add_f32 v[166:167], v[10:11], v[88:89]
  v_pk_fma_f32 v[86:87], v[164:165], v[164:165], v[86:87]
  v_pk_add_f32 v[168:169], v[12:13], v[88:89]
  v_pk_fma_f32 v[170:171], v[166:167], v[166:167], v[170:171]
  v_pk_add_f32 v[164:165], v[14:15], v[88:89]
  v_pk_fma_f32 v[86:87], v[168:169], v[168:169], v[86:87]
  v_pk_add_f32 v[166:167], v[16:17], v[88:89]
  v_pk_fma_f32 v[170:171], v[164:165], v[164:165], v[170:171]
  v_pk_add_f32 v[168:169], v[18:19], v[88:89]
  v_pk_fma_f32 v[86:87], v[166:167], v[166:167], v[86:87]
  v_pk_add_f32 v[164:165], v[20:21], v[88:89]
  v_pk_fma_f32 v[170:171], v[168:169], v[168:169], v[170:171]
  v_pk_add_f32 v[166:167], v[22:23], v[88:89]
  v_pk_fma_f32 v[86:87], v[164:165], v[164:165], v[86:87]
  v_pk_add_f32 v[168:169], v[24:25], v[88:89]
  v_pk_fma_f32 v[170:171], v[166:167], v[166:167], v[170:171]
  v_pk_add_f32 v[164:165], v[26:27], v[88:89]
  v_pk_fma_f32 v[86:87], v[168:169], v[168:169], v[86:87]
  v_pk_add_f32 v[166:167], v[28:29], v[88:89]
  v_pk_fma_f32 v[170:171], v[164:165], v[164:165], v[170:171]
  v_pk_add_f32 v[168:169], v[30:31], v[88:89]
  v_pk_fma_f32 v[86:87], v[166:167], v[166:167], v[86:87]
  v_pk_add_f32 v[164:165], v[32:33], v[88:89]
  v_pk_fma_f32 v[170:171], v[168:169], v[168:169], v[170:171]
  v_pk_add_f32 v[166:167], v[34:35], v[88:89]
  v_pk_fma_f32 v[86:87], v[164:165], v[164:165], v[86:87]
  v_pk_add_f32 v[168:169], v[36:37], v[88:89]
  v_pk_fma_f32 v[170:171], v[166:167], v[166:167], v[170:171]
  v_pk_add_f32 v[164:165], v[38:39], v[88:89]
  v_pk_fma_f32 v[86:87], v[168:169], v[168:169], v[86:87]
  v_pk_add_f32 v[166:167], v[40:41], v[88:89]
  v_pk_fma_f32 v[170:171], v[164:165], v[164:165], v[170:171]
  v_pk_fma_f32 v[86:87], v[166:167], v[166:167], v[86:87]
  v_cvt_pk_bf16_f32 v91, v88, v89
  v_lshlrev_b32 v88, 16, v91
  v_and_b32 v89, 0xffff0000, v91
  v_pk_add_f32 v[86:87], v[86:87], v[170:171]
  v_add_f32 v86, v86, v87
  s_nop 1
  v_add_f32_dpp v86, v86, v86 row_ror:8 row_mask:0xf bank_mask:0xf
  s_nop 1
  v_add_f32_dpp v86, v86, v86 row_ror:4 row_mask:0xf bank_mask:0xf
  v_mov_b32 v90, v86
  s_nop 1
  v_permlane16_swap_b32 v86, v90
  v_add_f32 v86, v86, v90
  v_mov_b32 v90, v86
  s_nop 1
  v_permlane32_swap_b32 v86, v90
  v_add_f32 v86, v86, v90
  v_pk_add_f32 v[2:3], v[2:3], v[88:89]
  v_mul_f32 v86, 0x3acccccd, v86
  v_pk_add_f32 v[4:5], v[4:5], v[88:89]
  v_cvt_pk_bf16_f32 v86, v86, v86
  v_pk_add_f32 v[6:7], v[6:7], v[88:89]
  v_lshlrev_b32 v86, 16, v86
  v_pk_add_f32 v[8:9], v[8:9], v[88:89]
  v_add_f32 v86, 0x3727c5ac, v86
  v_pk_add_f32 v[10:11], v[10:11], v[88:89]
  v_cvt_pk_bf16_f32 v86, v86, v86
  v_pk_add_f32 v[12:13], v[12:13], v[88:89]
  v_lshlrev_b32 v86, 16, v86
  v_pk_add_f32 v[14:15], v[14:15], v[88:89]
  v_sqrt_f32 v86, v86
  v_pk_add_f32 v[16:17], v[16:17], v[88:89]
  v_cvt_pk_bf16_f32 v86, v86, v86
  v_pk_add_f32 v[18:19], v[18:19], v[88:89]
  v_lshlrev_b32 v86, 16, v86
  v_pk_add_f32 v[20:21], v[20:21], v[88:89]
  v_rcp_f32 v86, v86
  v_pk_add_f32 v[22:23], v[22:23], v[88:89]
  v_mov_b32 v87, v86
  v_pk_add_f32 v[24:25], v[24:25], v[88:89]
  v_pk_add_f32 v[26:27], v[26:27], v[88:89]
  v_pk_add_f32 v[28:29], v[28:29], v[88:89]
  v_pk_add_f32 v[30:31], v[30:31], v[88:89]
  v_pk_add_f32 v[32:33], v[32:33], v[88:89]
  v_pk_add_f32 v[34:35], v[34:35], v[88:89]
  v_pk_add_f32 v[36:37], v[36:37], v[88:89]
  v_pk_add_f32 v[38:39], v[38:39], v[88:89]
  v_pk_add_f32 v[40:41], v[40:41], v[88:89]
  v_cvt_pk_bf16_f32 v164, v2, v3
  v_lshlrev_b32 v2, 16, v164
  v_and_b32 v3, 0xffff0000, v164
  v_cvt_pk_bf16_f32 v165, v4, v5
  v_lshlrev_b32 v4, 16, v165
  v_and_b32 v5, 0xffff0000, v165
  v_cvt_pk_bf16_f32 v166, v6, v7
  v_lshlrev_b32 v6, 16, v166
  v_and_b32 v7, 0xffff0000, v166
  v_cvt_pk_bf16_f32 v167, v8, v9
  v_lshlrev_b32 v8, 16, v167
  v_and_b32 v9, 0xffff0000, v167
  v_cvt_pk_bf16_f32 v164, v10, v11
  v_lshlrev_b32 v10, 16, v164
  v_and_b32 v11, 0xffff0000, v164
  v_cvt_pk_bf16_f32 v165, v12, v13
  v_lshlrev_b32 v12, 16, v165
  v_and_b32 v13, 0xffff0000, v165
  v_cvt_pk_bf16_f32 v166, v14, v15
  v_lshlrev_b32 v14, 16, v166
  v_and_b32 v15, 0xffff0000, v166
  v_cvt_pk_bf16_f32 v167, v16, v17
  v_lshlrev_b32 v16, 16, v167
  v_and_b32 v17, 0xffff0000, v167
  v_cvt_pk_bf16_f32 v164, v18, v19
  v_lshlrev_b32 v18, 16, v164
  v_and_b32 v19, 0xffff0000, v164
  v_cvt_pk_bf16_f32 v165, v20, v21
  v_lshlrev_b32 v20, 16, v165
  v_and_b32 v21, 0xffff0000, v165
  v_cvt_pk_bf16_f32 v166, v22, v23
  v_lshlrev_b32 v22, 16, v166
  v_and_b32 v23, 0xffff0000, v166
  v_cvt_pk_bf16_f32 v167, v24, v25
  v_lshlrev_b32 v24, 16, v167
  v_and_b32 v25, 0xffff0000, v167
  v_cvt_pk_bf16_f32 v164, v26, v27
  v_lshlrev_b32 v26, 16, v164
  v_and_b32 v27, 0xffff0000, v164
  v_cvt_pk_bf16_f32 v165, v28, v29
  v_lshlrev_b32 v28, 16, v165
  v_and_b32 v29, 0xffff0000, v165
  v_cvt_pk_bf16_f32 v166, v30, v31
  v_lshlrev_b32 v30, 16, v166
  v_and_b32 v31, 0xffff0000, v166
  v_cvt_pk_bf16_f32 v167, v32, v33
  v_lshlrev_b32 v32, 16, v167
  v_and_b32 v33, 0xffff0000, v167
  v_cvt_pk_bf16_f32 v164, v34, v35
  v_lshlrev_b32 v34, 16, v164
  v_and_b32 v35, 0xffff0000, v164
  v_cvt_pk_bf16_f32 v165, v36, v37
  v_lshlrev_b32 v36, 16, v165
  v_and_b32 v37, 0xffff0000, v165
  v_cvt_pk_bf16_f32 v166, v38, v39
  v_lshlrev_b32 v38, 16, v166
  v_and_b32 v39, 0xffff0000, v166
  v_cvt_pk_bf16_f32 v167, v40, v41
  v_lshlrev_b32 v40, 16, v167
  v_and_b32 v41, 0xffff0000, v167
  v_mov_b32 v92, s33
  s_waitcnt vmcnt(5)
  buffer_store_dword v92, v228, s[8:11], 0 offen
  v_pk_mul_f32 v[2:3], v[2:3], v[86:87]
  v_pk_mul_f32 v[4:5], v[4:5], v[86:87]
  v_pk_mul_f32 v[6:7], v[6:7], v[86:87]
  v_pk_mul_f32 v[8:9], v[8:9], v[86:87]
  v_pk_mul_f32 v[10:11], v[10:11], v[86:87]
  v_pk_mul_f32 v[12:13], v[12:13], v[86:87]
  v_pk_mul_f32 v[14:15], v[14:15], v[86:87]
  v_pk_mul_f32 v[16:17], v[16:17], v[86:87]
  v_pk_mul_f32 v[18:19], v[18:19], v[86:87]
  v_pk_mul_f32 v[20:21], v[20:21], v[86:87]
  v_pk_mul_f32 v[22:23], v[22:23], v[86:87]
  v_pk_mul_f32 v[24:25], v[24:25], v[86:87]
  v_pk_mul_f32 v[26:27], v[26:27], v[86:87]
  v_pk_mul_f32 v[28:29], v[28:29], v[86:87]
  v_pk_mul_f32 v[30:31], v[30:31], v[86:87]
  v_pk_mul_f32 v[32:33], v[32:33], v[86:87]
  v_pk_mul_f32 v[34:35], v[34:35], v[86:87]
  v_pk_mul_f32 v[36:37], v[36:37], v[86:87]
  v_pk_mul_f32 v[38:39], v[38:39], v[86:87]
  v_pk_mul_f32 v[40:41], v[40:41], v[86:87]
  v_cvt_pk_bf16_f32 v164, v2, v3
  v_lshlrev_b32 v2, 16, v164
  v_and_b32 v3, 0xffff0000, v164
  v_cvt_pk_bf16_f32 v165, v4, v5
  v_lshlrev_b32 v4, 16, v165
  v_and_b32 v5, 0xffff0000, v165
  v_cvt_pk_bf16_f32 v166, v6, v7
  v_lshlrev_b32 v6, 16, v166
  v_and_b32 v7, 0xffff0000, v166
  v_cvt_pk_bf16_f32 v167, v8, v9
  v_lshlrev_b32 v8, 16, v167
  v_and_b32 v9, 0xffff0000, v167
  v_cvt_pk_bf16_f32 v164, v10, v11
  v_lshlrev_b32 v10, 16, v164
  v_and_b32 v11, 0xffff0000, v164
  v_cvt_pk_bf16_f32 v165, v12, v13
  v_lshlrev_b32 v12, 16, v165
  v_and_b32 v13, 0xffff0000, v165
  v_cvt_pk_bf16_f32 v166, v14, v15
  v_lshlrev_b32 v14, 16, v166
  v_and_b32 v15, 0xffff0000, v166
  v_cvt_pk_bf16_f32 v167, v16, v17
  v_lshlrev_b32 v16, 16, v167
  v_and_b32 v17, 0xffff0000, v167
  v_cvt_pk_bf16_f32 v164, v18, v19
  v_lshlrev_b32 v18, 16, v164
  v_and_b32 v19, 0xffff0000, v164
  v_cvt_pk_bf16_f32 v165, v20, v21
  v_lshlrev_b32 v20, 16, v165
  v_and_b32 v21, 0xffff0000, v165
  v_cvt_pk_bf16_f32 v166, v22, v23
  v_lshlrev_b32 v22, 16, v166
  v_and_b32 v23, 0xffff0000, v166
  v_cvt_pk_bf16_f32 v167, v24, v25
  v_lshlrev_b32 v24, 16, v167
  v_and_b32 v25, 0xffff0000, v167
  v_cvt_pk_bf16_f32 v164, v26, v27
  v_lshlrev_b32 v26, 16, v164
  v_and_b32 v27, 0xffff0000, v164
  v_cvt_pk_bf16_f32 v165, v28, v29
  v_lshlrev_b32 v28, 16, v165
  v_and_b32 v29, 0xffff0000, v165
  v_cvt_pk_bf16_f32 v166, v30, v31
  v_lshlrev_b32 v30, 16, v166
  v_and_b32 v31, 0xffff0000, v166
  v_cvt_pk_bf16_f32 v167, v32, v33
  v_lshlrev_b32 v32, 16, v167
  v_and_b32 v33, 0xffff0000, v167
  v_cvt_pk_bf16_f32 v164, v34, v35
  v_lshlrev_b32 v34, 16, v164
  v_and_b32 v35, 0xffff0000, v164
  v_cvt_pk_bf16_f32 v165, v36, v37
  v_lshlrev_b32 v36, 16, v165
  v_and_b32 v37, 0xffff0000, v165
  v_cvt_pk_bf16_f32 v166, v38, v39
  v_lshlrev_b32 v38, 16, v166
  v_and_b32 v39, 0xffff0000, v166
  v_cvt_pk_bf16_f32 v167, v40, v41
  v_lshlrev_b32 v40, 16, v167
  v_and_b32 v41, 0xffff0000, v167
  v_mul_f32_dpp v2, v176, v2 quad_perm:[2,2,2,2] row_mask:0xf bank_mask:0xf
  v_mul_f32_dpp v3, v177, v3 quad_perm:[2,2,2,2] row_mask:0xf bank_mask:0xf
  v_mul_f32_dpp v4, v178, v4 quad_perm:[2,2,2,2] row_mask:0xf bank_mask:0xf
  v_mul_f32_dpp v5, v179, v5 quad_perm:[2,2,2,2] row_mask:0xf bank_mask:0xf
  v_mul_f32_dpp v6, v176, v6 quad_perm:[3,3,3,3] row_mask:0xf bank_mask:0xf
  v_mul_f32_dpp v7, v177, v7 quad_perm:[3,3,3,3] row_mask:0xf bank_mask:0xf
  v_mul_f32_dpp v8, v178, v8 quad_perm:[3,3,3,3] row_mask:0xf bank_mask:0xf
  v_mul_f32_dpp v9, v179, v9 quad_perm:[3,3,3,3] row_mask:0xf bank_mask:0xf
  v_cvt_pk_bf16_f32 v164, v2, v3
  v_lshlrev_b32 v2, 16, v164
  v_and_b32 v3, 0xffff0000, v164
  v_cvt_pk_bf16_f32 v165, v4, v5
  v_lshlrev_b32 v4, 16, v165
  v_and_b32 v5, 0xffff0000, v165
  v_cvt_pk_bf16_f32 v166, v6, v7
  v_lshlrev_b32 v6, 16, v166
  v_and_b32 v7, 0xffff0000, v166
  v_cvt_pk_bf16_f32 v167, v8, v9
  v_lshlrev_b32 v8, 16, v167
  v_and_b32 v9, 0xffff0000, v167
  v_add_f32_dpp v2, v176, v2 quad_perm:[0,0,0,0] row_mask:0xf bank_mask:0xf
  v_add_f32_dpp v3, v177, v3 quad_perm:[0,0,0,0] row_mask:0xf bank_mask:0xf
  v_add_f32_dpp v4, v178, v4 quad_perm:[0,0,0,0] row_mask:0xf bank_mask:0xf
  v_add_f32_dpp v5, v179, v5 quad_perm:[0,0,0,0] row_mask:0xf bank_mask:0xf
  v_add_f32_dpp v6, v176, v6 quad_perm:[1,1,1,1] row_mask:0xf bank_mask:0xf
  v_add_f32_dpp v7, v177, v7 quad_perm:[1,1,1,1] row_mask:0xf bank_mask:0xf
  v_add_f32_dpp v8, v178, v8 quad_perm:[1,1,1,1] row_mask:0xf bank_mask:0xf
  v_add_f32_dpp v9, v179, v9 quad_perm:[1,1,1,1] row_mask:0xf bank_mask:0xf
  v_cvt_pk_bf16_f32 v196, v2, v3
  v_cvt_pk_bf16_f32 v197, v4, v5
  v_cvt_pk_bf16_f32 v198, v6, v7
  v_cvt_pk_bf16_f32 v199, v8, v9
  s_add_u32 s35, s38, 0
  buffer_store_dwordx4 v[196:199], v161, s[8:11], s35 offen
  v_mul_f32_dpp v10, v180, v10 quad_perm:[2,2,2,2] row_mask:0xf bank_mask:0xf
  v_mul_f32_dpp v11, v181, v11 quad_perm:[2,2,2,2] row_mask:0xf bank_mask:0xf
  v_mul_f32_dpp v12, v182, v12 quad_perm:[2,2,2,2] row_mask:0xf bank_mask:0xf
  v_mul_f32_dpp v13, v183, v13 quad_perm:[2,2,2,2] row_mask:0xf bank_mask:0xf
  v_mul_f32_dpp v14, v180, v14 quad_perm:[3,3,3,3] row_mask:0xf bank_mask:0xf
  v_mul_f32_dpp v15, v181, v15 quad_perm:[3,3,3,3] row_mask:0xf bank_mask:0xf
  v_mul_f32_dpp v16, v182, v16 quad_perm:[3,3,3,3] row_mask:0xf bank_mask:0xf
  v_mul_f32_dpp v17, v183, v17 quad_perm:[3,3,3,3] row_mask:0xf bank_mask:0xf
  v_cvt_pk_bf16_f32 v164, v10, v11
  v_lshlrev_b32 v10, 16, v164
  v_and_b32 v11, 0xffff0000, v164
  v_cvt_pk_bf16_f32 v165, v12, v13
  v_lshlrev_b32 v12, 16, v165
  v_and_b32 v13, 0xffff0000, v165
  v_cvt_pk_bf16_f32 v166, v14, v15
  v_lshlrev_b32 v14, 16, v166
  v_and_b32 v15, 0xffff0000, v166
  v_cvt_pk_bf16_f32 v167, v16, v17
  v_lshlrev_b32 v16, 16, v167
  v_and_b32 v17, 0xffff0000, v167
  v_add_f32_dpp v10, v180, v10 quad_perm:[0,0,0,0] row_mask:0xf bank_mask:0xf
  v_add_f32_dpp v11, v181, v11 quad_perm:[0,0,0,0] row_mask:0xf bank_mask:0xf
  v_add_f32_dpp v12, v182, v12 quad_perm:[0,0,0,0] row_mask:0xf bank_mask:0xf
  v_add_f32_dpp v13, v183, v13 quad_perm:[0,0,0,0] row_mask:0xf bank_mask:0xf
  v_add_f32_dpp v14, v180, v14 quad_perm:[1,1,1,1] row_mask:0xf bank_mask:0xf
  v_add_f32_dpp v15, v181, v15 quad_perm:[1,1,1,1] row_mask:0xf bank_mask:0xf
  v_add_f32_dpp v16, v182, v16 quad_perm:[1,1,1,1] row_mask:0xf bank_mask:0xf
  v_add_f32_dpp v17, v183, v17 quad_perm:[1,1,1,1] row_mask:0xf bank_mask:0xf
  v_cvt_pk_bf16_f32 v200, v10, v11
  v_cvt_pk_bf16_f32 v201, v12, v13
  v_cvt_pk_bf16_f32 v202, v14, v15
  v_cvt_pk_bf16_f32 v203, v16, v17
  s_add_u32 s35, s38, 4096
  buffer_store_dwordx4 v[200:203], v161, s[8:11], s35 offen
  v_mul_f32_dpp v18, v184, v18 quad_perm:[2,2,2,2] row_mask:0xf bank_mask:0xf
  v_mul_f32_dpp v19, v185, v19 quad_perm:[2,2,2,2] row_mask:0xf bank_mask:0xf
  v_mul_f32_dpp v20, v186, v20 quad_perm:[2,2,2,2] row_mask:0xf bank_mask:0xf
  v_mul_f32_dpp v21, v187, v21 quad_perm:[2,2,2,2] row_mask:0xf bank_mask:0xf
  v_mul_f32_dpp v22, v184, v22 quad_perm:[3,3,3,3] row_mask:0xf bank_mask:0xf
  v_mul_f32_dpp v23, v185, v23 quad_perm:[3,3,3,3] row_mask:0xf bank_mask:0xf
  v_mul_f32_dpp v24, v186, v24 quad_perm:[3,3,3,3] row_mask:0xf bank_mask:0xf
  v_mul_f32_dpp v25, v187, v25 quad_perm:[3,3,3,3] row_mask:0xf bank_mask:0xf
  v_cvt_pk_bf16_f32 v164, v18, v19
  v_lshlrev_b32 v18, 16, v164
  v_and_b32 v19, 0xffff0000, v164
  v_cvt_pk_bf16_f32 v165, v20, v21
  v_lshlrev_b32 v20, 16, v165
  v_and_b32 v21, 0xffff0000, v165
  v_cvt_pk_bf16_f32 v166, v22, v23
  v_lshlrev_b32 v22, 16, v166
  v_and_b32 v23, 0xffff0000, v166
  v_cvt_pk_bf16_f32 v167, v24, v25
  v_lshlrev_b32 v24, 16, v167
  v_and_b32 v25, 0xffff0000, v167
  v_add_f32_dpp v18, v184, v18 quad_perm:[0,0,0,0] row_mask:0xf bank_mask:0xf
  v_add_f32_dpp v19, v185, v19 quad_perm:[0,0,0,0] row_mask:0xf bank_mask:0xf
  v_add_f32_dpp v20, v186, v20 quad_perm:[0,0,0,0] row_mask:0xf bank_mask:0xf
  v_add_f32_dpp v21, v187, v21 quad_perm:[0,0,0,0] row_mask:0xf bank_mask:0xf
  v_add_f32_dpp v22, v184, v22 quad_perm:[1,1,1,1] row_mask:0xf bank_mask:0xf
  v_add_f32_dpp v23, v185, v23 quad_perm:[1,1,1,1] row_mask:0xf bank_mask:0xf
  v_add_f32_dpp v24, v186, v24 quad_perm:[1,1,1,1] row_mask:0xf bank_mask:0xf
  v_add_f32_dpp v25, v187, v25 quad_perm:[1,1,1,1] row_mask:0xf bank_mask:0xf
  v_cvt_pk_bf16_f32 v204, v18, v19
  v_cvt_pk_bf16_f32 v205, v20, v21
  v_cvt_pk_bf16_f32 v206, v22, v23
  v_cvt_pk_bf16_f32 v207, v24, v25
  s_add_u32 s35, s38, 8192
  buffer_store_dwordx4 v[204:207], v161, s[8:11], s35 offen
  v_mul_f32_dpp v26, v188, v26 quad_perm:[2,2,2,2] row_mask:0xf bank_mask:0xf
  v_mul_f32_dpp v27, v189, v27 quad_perm:[2,2,2,2] row_mask:0xf bank_mask:0xf
  v_mul_f32_dpp v28, v190, v28 quad_perm:[2,2,2,2] row_mask:0xf bank_mask:0xf
  v_mul_f32_dpp v29, v191, v29 quad_perm:[2,2,2,2] row_mask:0xf bank_mask:0xf
  v_mul_f32_dpp v30, v188, v30 quad_perm:[3,3,3,3] row_mask:0xf bank_mask:0xf
  v_mul_f32_dpp v31, v189, v31 quad_perm:[3,3,3,3] row_mask:0xf bank_mask:0xf
  v_mul_f32_dpp v32, v190, v32 quad_perm:[3,3,3,3] row_mask:0xf bank_mask:0xf
  v_mul_f32_dpp v33, v191, v33 quad_perm:[3,3,3,3] row_mask:0xf bank_mask:0xf
  v_cvt_pk_bf16_f32 v164, v26, v27
  v_lshlrev_b32 v26, 16, v164
  v_and_b32 v27, 0xffff0000, v164
  v_cvt_pk_bf16_f32 v165, v28, v29
  v_lshlrev_b32 v28, 16, v165
  v_and_b32 v29, 0xffff0000, v165
  v_cvt_pk_bf16_f32 v166, v30, v31
  v_lshlrev_b32 v30, 16, v166
  v_and_b32 v31, 0xffff0000, v166
  v_cvt_pk_bf16_f32 v167, v32, v33
  v_lshlrev_b32 v32, 16, v167
  v_and_b32 v33, 0xffff0000, v167
  v_add_f32_dpp v26, v188, v26 quad_perm:[0,0,0,0] row_mask:0xf bank_mask:0xf
  v_add_f32_dpp v27, v189, v27 quad_perm:[0,0,0,0] row_mask:0xf bank_mask:0xf
  v_add_f32_dpp v28, v190, v28 quad_perm:[0,0,0,0] row_mask:0xf bank_mask:0xf
  v_add_f32_dpp v29, v191, v29 quad_perm:[0,0,0,0] row_mask:0xf bank_mask:0xf
  v_add_f32_dpp v30, v188, v30 quad_perm:[1,1,1,1] row_mask:0xf bank_mask:0xf
  v_add_f32_dpp v31, v189, v31 quad_perm:[1,1,1,1] row_mask:0xf bank_mask:0xf
  v_add_f32_dpp v32, v190, v32 quad_perm:[1,1,1,1] row_mask:0xf bank_mask:0xf
  v_add_f32_dpp v33, v191, v33 quad_perm:[1,1,1,1] row_mask:0xf bank_mask:0xf
  v_cvt_pk_bf16_f32 v208, v26, v27
  v_cvt_pk_bf16_f32 v209, v28, v29
  v_cvt_pk_bf16_f32 v210, v30, v31
  v_cvt_pk_bf16_f32 v211, v32, v33
  s_add_u32 s35, s38, 12288
  buffer_store_dwordx4 v[208:211], v161, s[8:11], s35 offen
  v_mul_f32_dpp v34, v192, v34 quad_perm:[2,2,2,2] row_mask:0xf bank_mask:0xf
  v_mul_f32_dpp v35, v193, v35 quad_perm:[2,2,2,2] row_mask:0xf bank_mask:0xf
  v_mul_f32_dpp v36, v194, v36 quad_perm:[2,2,2,2] row_mask:0xf bank_mask:0xf
  v_mul_f32_dpp v37, v195, v37 quad_perm:[2,2,2,2] row_mask:0xf bank_mask:0xf
  v_mul_f32_dpp v38, v192, v38 quad_perm:[3,3,3,3] row_mask:0xf bank_mask:0xf
  v_mul_f32_dpp v39, v193, v39 quad_perm:[3,3,3,3] row_mask:0xf bank_mask:0xf
  v_mul_f32_dpp v40, v194, v40 quad_perm:[3,3,3,3] row_mask:0xf bank_mask:0xf
  v_mul_f32_dpp v41, v195, v41 quad_perm:[3,3,3,3] row_mask:0xf bank_mask:0xf
  v_cvt_pk_bf16_f32 v164, v34, v35
  v_lshlrev_b32 v34, 16, v164
  v_and_b32 v35, 0xffff0000, v164
  v_cvt_pk_bf16_f32 v165, v36, v37
  v_lshlrev_b32 v36, 16, v165
  v_and_b32 v37, 0xffff0000, v165
  v_cvt_pk_bf16_f32 v166, v38, v39
  v_lshlrev_b32 v38, 16, v166
  v_and_b32 v39, 0xffff0000, v166
  v_cvt_pk_bf16_f32 v167, v40, v41
  v_lshlrev_b32 v40, 16, v167
  v_and_b32 v41, 0xffff0000, v167
  v_add_f32_dpp v34, v192, v34 quad_perm:[0,0,0,0] row_mask:0xf bank_mask:0xf
  v_add_f32_dpp v35, v193, v35 quad_perm:[0,0,0,0] row_mask:0xf bank_mask:0xf
  v_add_f32_dpp v36, v194, v36 quad_perm:[0,0,0,0] row_mask:0xf bank_mask:0xf
  v_add_f32_dpp v37, v195, v37 quad_perm:[0,0,0,0] row_mask:0xf bank_mask:0xf
  v_add_f32_dpp v38, v192, v38 quad_perm:[1,1,1,1] row_mask:0xf bank_mask:0xf
  v_add_f32_dpp v39, v193, v39 quad_perm:[1,1,1,1] row_mask:0xf bank_mask:0xf
  v_add_f32_dpp v40, v194, v40 quad_perm:[1,1,1,1] row_mask:0xf bank_mask:0xf
  v_add_f32_dpp v41, v195, v41 quad_perm:[1,1,1,1] row_mask:0xf bank_mask:0xf
  v_cvt_pk_bf16_f32 v212, v34, v35
  v_cvt_pk_bf16_f32 v213, v36, v37
  v_cvt_pk_bf16_f32 v214, v38, v39
  v_cvt_pk_bf16_f32 v215, v40, v41
  s_add_u32 s35, s38, 16384
  buffer_store_dwordx4 v[212:215], v161, s[8:11], s35 offen
  s_add_u32 s38, s38, 81920
  s_add_u32 s33, s33, 4
  buffer_load_dwordx4 v[66:69], v160, s[20:23], s37 offen offset:0
  buffer_load_dwordx4 v[70:73], v160, s[20:23], s37 offen offset:256
  buffer_load_dwordx4 v[74:77], v160, s[20:23], s37 offen offset:512
  buffer_load_dwordx4 v[78:81], v160, s[20:23], s37 offen offset:768
  buffer_load_dwordx4 v[82:85], v160, s[20:23], s37 offen offset:1024
  s_add_u32 s37, s37, 81920
  s_min_u32 s37, s37, 2616320
  s_cmp_lt_u32 s33, 128
  s_cbranch_scc0 r_ln1e
  v_lshlrev_b32 v2, 16, v140
  v_and_b32 v3, 0xffff0000, v140
  v_lshlrev_b32 v4, 16, v141
  v_and_b32 v5, 0xffff0000, v141
  v_lshlrev_b32 v6, 16, v142
  v_and_b32 v7, 0xffff0000, v142
  v_lshlrev_b32 v8, 16, v143
  v_and_b32 v9, 0xffff0000, v143
  v_lshlrev_b32 v10, 16, v144
  v_and_b32 v11, 0xffff0000, v144
  v_lshlrev_b32 v12, 16, v145
  v_and_b32 v13, 0xffff0000, v145
  v_lshlrev_b32 v14, 16, v146
  v_and_b32 v15, 0xffff0000, v146
  v_lshlrev_b32 v16, 16, v147
  v_and_b32 v17, 0xffff0000, v147
  v_lshlrev_b32 v18, 16, v148
  v_and_b32 v19, 0xffff0000, v148
  v_lshlrev_b32 v20, 16, v149
  v_and_b32 v21, 0xffff0000, v149
  v_lshlrev_b32 v22, 16, v150
  v_and_b32 v23, 0xffff0000, v150
  v_lshlrev_b32 v24, 16, v151
  v_and_b32 v25, 0xffff0000, v151
  v_lshlrev_b32 v26, 16, v152
  v_and_b32 v27, 0xffff0000, v152
  v_lshlrev_b32 v28, 16, v153
  v_and_b32 v29, 0xffff0000, v153
  v_lshlrev_b32 v30, 16, v154
  v_and_b32 v31, 0xffff0000, v154
  v_lshlrev_b32 v32, 16, v155
  v_and_b32 v33, 0xffff0000, v155
  v_lshlrev_b32 v34, 16, v156
  v_and_b32 v35, 0xffff0000, v156
  v_lshlrev_b32 v36, 16, v157
  v_and_b32 v37, 0xffff0000, v157
  v_lshlrev_b32 v38, 16, v158
  v_and_b32 v39, 0xffff0000, v158
  v_lshlrev_b32 v40, 16, v159
  v_and_b32 v41, 0xffff0000, v159
  v_pk_add_f32 v[86:87], v[2:3], v[4:5]
  v_pk_add_f32 v[88:89], v[6:7], v[8:9]
  v_pk_add_f32 v[86:87], v[86:87], v[10:11]
  v_pk_add_f32 v[88:89], v[88:89], v[12:13]
  v_pk_add_f32 v[86:87], v[86:87], v[14:15]
  v_pk_add_f32 v[88:89], v[88:89], v[16:17]
  v_pk_add_f32 v[86:87], v[86:87], v[18:19]
  v_pk_add_f32 v[88:89], v[88:89], v[20:21]
  v_pk_add_f32 v[86:87], v[86:87], v[22:23]
  v_pk_add_f32 v[88:89], v[88:89], v[24:25]
  v_pk_add_f32 v[86:87], v[86:87], v[26:27]
  v_pk_add_f32 v[88:89], v[88:89], v[28:29]
  v_pk_add_f32 v[86:87], v[86:87], v[30:31]
  v_pk_add_f32 v[88:89], v[88:89], v[32:33]
  v_pk_add_f32 v[86:87], v[86:87], v[34:35]
  v_pk_add_f32 v[88:89], v[88:89], v[36:37]
  v_pk_add_f32 v[86:87], v[86:87], v[38:39]
  v_pk_add_f32 v[88:89], v[88:89], v[40:41]
  v_pk_add_f32 v[86:87], v[86:87], v[88:89]
  v_add_f32 v86, v86, v87
  s_nop 1
  v_add_f32_dpp v86, v86, v86 row_ror:8 row_mask:0xf bank_mask:0xf
  s_nop 1
  v_add_f32_dpp v86, v86, v86 row_ror:4 row_mask:0xf bank_mask:0xf
  v_mov_b32 v90, v86
  s_nop 1
  v_permlane16_swap_b32 v86, v90
  v_add_f32 v86, v86, v90
  v_mov_b32 v90, v86
  s_nop 1
  v_permlane32_swap_b32 v86, v90
  v_add_f32 v86, v86, v90
  v_mul_f32 v88, 0xbacccccd, v86
  v_mul_f32 v89, 0xbacccccd, v86
  v_pk_add_f32 v[164:165], v[2:3], v[88:89]
  v_pk_add_f32 v[166:167], v[4:5], v[88:89]
  v_pk_mul_f32 v[170:171], v[164:165], v[164:165]
  v_pk_add_f32 v[168:169], v[6:7], v[88:89]
  v_pk_mul_f32 v[86:87], v[166:167], v[166:167]
  v_pk_add_f32 v[164:165], v[8:9], v[88:89]
  v_pk_fma_f32 v[170:171], v[168:169], v[168:169], v[170:171]
  v_pk_add_f32 v[166:167], v[10:11], v[88:89]
  v_pk_fma_f32 v[86:87], v[164:165], v[164:165], v[86:87]
  v_pk_add_f32 v[168:169], v[12:13], v[88:89]
  v_pk_fma_f32 v[170:171], v[166:167], v[166:167], v[170:171]
  v_pk_add_f32 v[164:165], v[14:15], v[88:89]
  v_pk_fma_f32 v[86:87], v[168:169], v[168:169], v[86:87]
  v_pk_add_f32 v[166:167], v[16:17], v[88:89]
  v_pk_fma_f32 v[170:171], v[164:165], v[164:165], v[170:171]
  v_pk_add_f32 v[168:169], v[18:19], v[88:89]
  v_pk_fma_f32 v[86:87], v[166:167], v[166:167], v[86:87]
  v_pk_add_f32 v[164:165], v[20:21], v[88:89]
  v_pk_fma_f32 v[170:171], v[168:169], v[168:169], v[170:171]
  v_pk_add_f32 v[166:167], v[22:23], v[88:89]
  v_pk_fma_f32 v[86:87], v[164:165], v[164:165], v[86:87]
  v_pk_add_f32 v[168:169], v[24:25], v[88:89]
  v_pk_fma_f32 v[170:171], v[166:167], v[166:167], v[170:171]
  v_pk_add_f32 v[164:165], v[26:27], v[88:89]
  v_pk_fma_f32 v[86:87], v[168:169], v[168:169], v[86:87]
  v_pk_add_f32 v[166:167], v[28:29], v[88:89]
  v_pk_fma_f32 v[170:171], v[164:165], v[164:165], v[170:171]
  v_pk_add_f32 v[168:169], v[30:31], v[88:89]
  v_pk_fma_f32 v[86:87], v[166:167], v[166:167], v[86:87]
  v_pk_add_f32 v[164:165], v[32:33], v[88:89]
  v_pk_fma_f32 v[170:171], v[168:169], v[168:169], v[170:171]
  v_pk_add_f32 v[166:167], v[34:35], v[88:89]
  v_pk_fma_f32 v[86:87], v[164:165], v[164:165], v[86:87]
  v_pk_add_f32 v[168:169], v[36:37], v[88:89]
  v_pk_fma_f32 v[170:171], v[166:167], v[166:167], v[170:171]
  v_pk_add_f32 v[164:165], v[38:39], v[88:89]
  v_pk_fma_f32 v[86:87], v[168:169], v[168:169], v[86:87]
  v_pk_add_f32 v[166:167], v[40:41], v[88:89]
  v_pk_fma_f32 v[170:171], v[164:165], v[164:165], v[170:171]
  v_pk_fma_f32 v[86:87], v[166:167], v[166:167], v[86:87]
  v_cvt_pk_bf16_f32 v91, v88, v89
  v_lshlrev_b32 v88, 16, v91
  v_and_b32 v89, 0xffff0000, v91
  v_pk_add_f32 v[86:87], v[86:87], v[170:171]
  v_add_f32 v86, v86, v87
  s_nop 1
  v_add_f32_dpp v86, v86, v86 row_ror:8 row_mask:0xf bank_mask:0xf
  s_nop 1
  v_add_f32_dpp v86, v86, v86 row_ror:4 row_mask:0xf bank_mask:0xf
  v_mov_b32 v90, v86
  s_nop 1
  v_permlane16_swap_b32 v86, v90
  v_add_f32 v86, v86, v90
  v_mov_b32 v90, v86
  s_nop 1
  v_permlane32_swap_b32 v86, v90
  v_add_f32 v86, v86, v90
  v_pk_add_f32 v[2:3], v[2:3], v[88:89]
  v_mul_f32 v86, 0x3acccccd, v86
  v_pk_add_f32 v[4:5], v[4:5], v[88:89]
  v_cvt_pk_bf16_f32 v86, v86, v86
  v_pk_add_f32 v[6:7], v[6:7], v[88:89]
  v_lshlrev_b32 v86, 16, v86
  v_pk_add_f32 v[8:9], v[8:9], v[88:89]
  v_add_f32 v86, 0x3727c5ac, v86
  v_pk_add_f32 v[10:11], v[10:11], v[88:89]
  v_cvt_pk_bf16_f32 v86, v86, v86
  v_pk_add_f32 v[12:13], v[12:13], v[88:89]
  v_lshlrev_b32 v86, 16, v86
  v_pk_add_f32 v[14:15], v[14:15], v[88:89]
  v_sqrt_f32 v86, v86
  v_pk_add_f32 v[16:17], v[16:17], v[88:89]
  v_cvt_pk_bf16_f32 v86, v86, v86
  v_pk_add_f32 v[18:19], v[18:19], v[88:89]
  v_lshlrev_b32 v86, 16, v86
  v_pk_add_f32 v[20:21], v[20:21], v[88:89]
  v_rcp_f32 v86, v86
  v_pk_add_f32 v[22:23], v[22:23], v[88:89]
  v_mov_b32 v87, v86
  v_pk_add_f32 v[24:25], v[24:25], v[88:89]
  v_pk_add_f32 v[26:27], v[26:27], v[88:89]
  v_pk_add_f32 v[28:29], v[28:29], v[88:89]
  v_pk_add_f32 v[30:31], v[30:31], v[88:89]
  v_pk_add_f32 v[32:33], v[32:33], v[88:89]
  v_pk_add_f32 v[34:35], v[34:35], v[88:89]
  v_pk_add_f32 v[36:37], v[36:37], v[88:89]
  v_pk_add_f32 v[38:39], v[38:39], v[88:89]
  v_pk_add_f32 v[40:41], v[40:41], v[88:89]
  v_cvt_pk_bf16_f32 v164, v2, v3
  v_lshlrev_b32 v2, 16, v164
  v_and_b32 v3, 0xffff0000, v164
  v_cvt_pk_bf16_f32 v165, v4, v5
  v_lshlrev_b32 v4, 16, v165
  v_and_b32 v5, 0xffff0000, v165
  v_cvt_pk_bf16_f32 v166, v6, v7
  v_lshlrev_b32 v6, 16, v166
  v_and_b32 v7, 0xffff0000, v166
  v_cvt_pk_bf16_f32 v167, v8, v9
  v_lshlrev_b32 v8, 16, v167
  v_and_b32 v9, 0xffff0000, v167
  v_cvt_pk_bf16_f32 v164, v10, v11
  v_lshlrev_b32 v10, 16, v164
  v_and_b32 v11, 0xffff0000, v164
  v_cvt_pk_bf16_f32 v165, v12, v13
  v_lshlrev_b32 v12, 16, v165
  v_and_b32 v13, 0xffff0000, v165
  v_cvt_pk_bf16_f32 v166, v14, v15
  v_lshlrev_b32 v14, 16, v166
  v_and_b32 v15, 0xffff0000, v166
  v_cvt_pk_bf16_f32 v167, v16, v17
  v_lshlrev_b32 v16, 16, v167
  v_and_b32 v17, 0xffff0000, v167
  v_cvt_pk_bf16_f32 v164, v18, v19
  v_lshlrev_b32 v18, 16, v164
  v_and_b32 v19, 0xffff0000, v164
  v_cvt_pk_bf16_f32 v165, v20, v21
  v_lshlrev_b32 v20, 16, v165
  v_and_b32 v21, 0xffff0000, v165
  v_cvt_pk_bf16_f32 v166, v22, v23
  v_lshlrev_b32 v22, 16, v166
  v_and_b32 v23, 0xffff0000, v166
  v_cvt_pk_bf16_f32 v167, v24, v25
  v_lshlrev_b32 v24, 16, v167
  v_and_b32 v25, 0xffff0000, v167
  v_cvt_pk_bf16_f32 v164, v26, v27
  v_lshlrev_b32 v26, 16, v164
  v_and_b32 v27, 0xffff0000, v164
  v_cvt_pk_bf16_f32 v165, v28, v29
  v_lshlrev_b32 v28, 16, v165
  v_and_b32 v29, 0xffff0000, v165
  v_cvt_pk_bf16_f32 v166, v30, v31
  v_lshlrev_b32 v30, 16, v166
  v_and_b32 v31, 0xffff0000, v166
  v_cvt_pk_bf16_f32 v167, v32, v33
  v_lshlrev_b32 v32, 16, v167
  v_and_b32 v33, 0xffff0000, v167
  v_cvt_pk_bf16_f32 v164, v34, v35
  v_lshlrev_b32 v34, 16, v164
  v_and_b32 v35, 0xffff0000, v164
  v_cvt_pk_bf16_f32 v165, v36, v37
  v_lshlrev_b32 v36, 16, v165
  v_and_b32 v37, 0xffff0000, v165
  v_cvt_pk_bf16_f32 v166, v38, v39
  v_lshlrev_b32 v38, 16, v166
  v_and_b32 v39, 0xffff0000, v166
  v_cvt_pk_bf16_f32 v167, v40, v41
  v_lshlrev_b32 v40, 16, v167
  v_and_b32 v41, 0xffff0000, v167
  v_mov_b32 v92, s33
  s_waitcnt vmcnt(5)
  buffer_store_dword v92, v228, s[8:11], 0 offen
  v_pk_mul_f32 v[2:3], v[2:3], v[86:87]
  v_pk_mul_f32 v[4:5], v[4:5], v[86:87]
  v_pk_mul_f32 v[6:7], v[6:7], v[86:87]
  v_pk_mul_f32 v[8:9], v[8:9], v[86:87]
  v_pk_mul_f32 v[10:11], v[10:11], v[86:87]
  v_pk_mul_f32 v[12:13], v[12:13], v[86:87]
  v_pk_mul_f32 v[14:15], v[14:15], v[86:87]
  v_pk_mul_f32 v[16:17], v[16:17], v[86:87]
  v_pk_mul_f32 v[18:19], v[18:19], v[86:87]
  v_pk_mul_f32 v[20:21], v[20:21], v[86:87]
  v_pk_mul_f32 v[22:23], v[22:23], v[86:87]
  v_pk_mul_f32 v[24:25], v[24:25], v[86:87]
  v_pk_mul_f32 v[26:27], v[26:27], v[86:87]
  v_pk_mul_f32 v[28:29], v[28:29], v[86:87]
  v_pk_mul_f32 v[30:31], v[30:31], v[86:87]
  v_pk_mul_f32 v[32:33], v[32:33], v[86:87]
  v_pk_mul_f32 v[34:35], v[34:35], v[86:87]
  v_pk_mul_f32 v[36:37], v[36:37], v[86:87]
  v_pk_mul_f32 v[38:39], v[38:39], v[86:87]
  v_pk_mul_f32 v[40:41], v[40:41], v[86:87]
  v_cvt_pk_bf16_f32 v164, v2, v3
  v_lshlrev_b32 v2, 16, v164
  v_and_b32 v3, 0xffff0000, v164
  v_cvt_pk_bf16_f32 v165, v4, v5
  v_lshlrev_b32 v4, 16, v165
  v_and_b32 v5, 0xffff0000, v165
  v_cvt_pk_bf16_f32 v166, v6, v7
  v_lshlrev_b32 v6, 16, v166
  v_and_b32 v7, 0xffff0000, v166
  v_cvt_pk_bf16_f32 v167, v8, v9
  v_lshlrev_b32 v8, 16, v167
  v_and_b32 v9, 0xffff0000, v167
  v_cvt_pk_bf16_f32 v164, v10, v11
  v_lshlrev_b32 v10, 16, v164
  v_and_b32 v11, 0xffff0000, v164
  v_cvt_pk_bf16_f32 v165, v12, v13
  v_lshlrev_b32 v12, 16, v165
  v_and_b32 v13, 0xffff0000, v165
  v_cvt_pk_bf16_f32 v166, v14, v15
  v_lshlrev_b32 v14, 16, v166
  v_and_b32 v15, 0xffff0000, v166
  v_cvt_pk_bf16_f32 v167, v16, v17
  v_lshlrev_b32 v16, 16, v167
  v_and_b32 v17, 0xffff0000, v167
  v_cvt_pk_bf16_f32 v164, v18, v19
  v_lshlrev_b32 v18, 16, v164
  v_and_b32 v19, 0xffff0000, v164
  v_cvt_pk_bf16_f32 v165, v20, v21
  v_lshlrev_b32 v20, 16, v165
  v_and_b32 v21, 0xffff0000, v165
  v_cvt_pk_bf16_f32 v166, v22, v23
  v_lshlrev_b32 v22, 16, v166
  v_and_b32 v23, 0xffff0000, v166
  v_cvt_pk_bf16_f32 v167, v24, v25
  v_lshlrev_b32 v24, 16, v167
  v_and_b32 v25, 0xffff0000, v167
  v_cvt_pk_bf16_f32 v164, v26, v27
  v_lshlrev_b32 v26, 16, v164
  v_and_b32 v27, 0xffff0000, v164
  v_cvt_pk_bf16_f32 v165, v28, v29
  v_lshlrev_b32 v28, 16, v165
  v_and_b32 v29, 0xffff0000, v165
  v_cvt_pk_bf16_f32 v166, v30, v31
  v_lshlrev_b32 v30, 16, v166
  v_and_b32 v31, 0xffff0000, v166
  v_cvt_pk_bf16_f32 v167, v32, v33
  v_lshlrev_b32 v32, 16, v167
  v_and_b32 v33, 0xffff0000, v167
  v_cvt_pk_bf16_f32 v164, v34, v35
  v_lshlrev_b32 v34, 16, v164
  v_and_b32 v35, 0xffff0000, v164
  v_cvt_pk_bf16_f32 v165, v36, v37
  v_lshlrev_b32 v36, 16, v165
  v_and_b32 v37, 0xffff0000, v165
  v_cvt_pk_bf16_f32 v166, v38, v39
  v_lshlrev_b32 v38, 16, v166
  v_and_b32 v39, 0xffff0000, v166
  v_cvt_pk_bf16_f32 v167, v40, v41
  v_lshlrev_b32 v40, 16, v167
  v_and_b32 v41, 0xffff0000, v167
  v_mul_f32_dpp v2, v176, v2 quad_perm:[2,2,2,2] row_mask:0xf bank_mask:0xf
  v_mul_f32_dpp v3, v177, v3 quad_perm:[2,2,2,2] row_mask:0xf bank_mask:0xf
  v_mul_f32_dpp v4, v178, v4 quad_perm:[2,2,2,2] row_mask:0xf bank_mask:0xf
  v_mul_f32_dpp v5, v179, v5 quad_perm:[2,2,2,2] row_mask:0xf bank_mask:0xf
  v_mul_f32_dpp v6, v176, v6 quad_perm:[3,3,3,3] row_mask:0xf bank_mask:0xf
  v_mul_f32_dpp v7, v177, v7 quad_perm:[3,3,3,3] row_mask:0xf bank_mask:0xf
  v_mul_f32_dpp v8, v178, v8 quad_perm:[3,3,3,3] row_mask:0xf bank_mask:0xf
  v_mul_f32_dpp v9, v179, v9 quad_perm:[3,3,3,3] row_mask:0xf bank_mask:0xf
  v_cvt_pk_bf16_f32 v164, v2, v3
  v_lshlrev_b32 v2, 16, v164
  v_and_b32 v3, 0xffff0000, v164
  v_cvt_pk_bf16_f32 v165, v4, v5
  v_lshlrev_b32 v4, 16, v165
  v_and_b32 v5, 0xffff0000, v165
  v_cvt_pk_bf16_f32 v166, v6, v7
  v_lshlrev_b32 v6, 16, v166
  v_and_b32 v7, 0xffff0000, v166
  v_cvt_pk_bf16_f32 v167, v8, v9
  v_lshlrev_b32 v8, 16, v167
  v_and_b32 v9, 0xffff0000, v167
  v_add_f32_dpp v2, v176, v2 quad_perm:[0,0,0,0] row_mask:0xf bank_mask:0xf
  v_add_f32_dpp v3, v177, v3 quad_perm:[0,0,0,0] row_mask:0xf bank_mask:0xf
  v_add_f32_dpp v4, v178, v4 quad_perm:[0,0,0,0] row_mask:0xf bank_mask:0xf
  v_add_f32_dpp v5, v179, v5 quad_perm:[0,0,0,0] row_mask:0xf bank_mask:0xf
  v_add_f32_dpp v6, v176, v6 quad_perm:[1,1,1,1] row_mask:0xf bank_mask:0xf
  v_add_f32_dpp v7, v177, v7 quad_perm:[1,1,1,1] row_mask:0xf bank_mask:0xf
  v_add_f32_dpp v8, v178, v8 quad_perm:[1,1,1,1] row_mask:0xf bank_mask:0xf
  v_add_f32_dpp v9, v179, v9 quad_perm:[1,1,1,1] row_mask:0xf bank_mask:0xf
  v_cvt_pk_bf16_f32 v196, v2, v3
  v_cvt_pk_bf16_f32 v197, v4, v5
  v_cvt_pk_bf16_f32 v198, v6, v7
  v_cvt_pk_bf16_f32 v199, v8, v9
  s_add_u32 s35, s38, 0
  buffer_store_dwordx4 v[196:199], v161, s[8:11], s35 offen
  v_mul_f32_dpp v10, v180, v10 quad_perm:[2,2,2,2] row_mask:0xf bank_mask:0xf
  v_mul_f32_dpp v11, v181, v11 quad_perm:[2,2,2,2] row_mask:0xf bank_mask:0xf
  v_mul_f32_dpp v12, v182, v12 quad_perm:[2,2,2,2] row_mask:0xf bank_mask:0xf
  v_mul_f32_dpp v13, v183, v13 quad_perm:[2,2,2,2] row_mask:0xf bank_mask:0xf
  v_mul_f32_dpp v14, v180, v14 quad_perm:[3,3,3,3] row_mask:0xf bank_mask:0xf
  v_mul_f32_dpp v15, v181, v15 quad_perm:[3,3,3,3] row_mask:0xf bank_mask:0xf
  v_mul_f32_dpp v16, v182, v16 quad_perm:[3,3,3,3] row_mask:0xf bank_mask:0xf
  v_mul_f32_dpp v17, v183, v17 quad_perm:[3,3,3,3] row_mask:0xf bank_mask:0xf
  v_cvt_pk_bf16_f32 v164, v10, v11
  v_lshlrev_b32 v10, 16, v164
  v_and_b32 v11, 0xffff0000, v164
  v_cvt_pk_bf16_f32 v165, v12, v13
  v_lshlrev_b32 v12, 16, v165
  v_and_b32 v13, 0xffff0000, v165
  v_cvt_pk_bf16_f32 v166, v14, v15
  v_lshlrev_b32 v14, 16, v166
  v_and_b32 v15, 0xffff0000, v166
  v_cvt_pk_bf16_f32 v167, v16, v17
  v_lshlrev_b32 v16, 16, v167
  v_and_b32 v17, 0xffff0000, v167
  v_add_f32_dpp v10, v180, v10 quad_perm:[0,0,0,0] row_mask:0xf bank_mask:0xf
  v_add_f32_dpp v11, v181, v11 quad_perm:[0,0,0,0] row_mask:0xf bank_mask:0xf
  v_add_f32_dpp v12, v182, v12 quad_perm:[0,0,0,0] row_mask:0xf bank_mask:0xf
  v_add_f32_dpp v13, v183, v13 quad_perm:[0,0,0,0] row_mask:0xf bank_mask:0xf
  v_add_f32_dpp v14, v180, v14 quad_perm:[1,1,1,1] row_mask:0xf bank_mask:0xf
  v_add_f32_dpp v15, v181, v15 quad_perm:[1,1,1,1] row_mask:0xf bank_mask:0xf
  v_add_f32_dpp v16, v182, v16 quad_perm:[1,1,1,1] row_mask:0xf bank_mask:0xf
  v_add_f32_dpp v17, v183, v17 quad_perm:[1,1,1,1] row_mask:0xf bank_mask:0xf
  v_cvt_pk_bf16_f32 v200, v10, v11
  v_cvt_pk_bf16_f32 v201, v12, v13
  v_cvt_pk_bf16_f32 v202, v14, v15
  v_cvt_pk_bf16_f32 v203, v16, v17
  s_add_u32 s35, s38, 4096
  buffer_store_dwordx4 v[200:203], v161, s[8:11], s35 offen
  v_mul_f32_dpp v18, v184, v18 quad_perm:[2,2,2,2] row_mask:0xf bank_mask:0xf
  v_mul_f32_dpp v19, v185, v19 quad_perm:[2,2,2,2] row_mask:0xf bank_mask:0xf
  v_mul_f32_dpp v20, v186, v20 quad_perm:[2,2,2,2] row_mask:0xf bank_mask:0xf
  v_mul_f32_dpp v21, v187, v21 quad_perm:[2,2,2,2] row_mask:0xf bank_mask:0xf
  v_mul_f32_dpp v22, v184, v22 quad_perm:[3,3,3,3] row_mask:0xf bank_mask:0xf
  v_mul_f32_dpp v23, v185, v23 quad_perm:[3,3,3,3] row_mask:0xf bank_mask:0xf
  v_mul_f32_dpp v24, v186, v24 quad_perm:[3,3,3,3] row_mask:0xf bank_mask:0xf
  v_mul_f32_dpp v25, v187, v25 quad_perm:[3,3,3,3] row_mask:0xf bank_mask:0xf
  v_cvt_pk_bf16_f32 v164, v18, v19
  v_lshlrev_b32 v18, 16, v164
  v_and_b32 v19, 0xffff0000, v164
  v_cvt_pk_bf16_f32 v165, v20, v21
  v_lshlrev_b32 v20, 16, v165
  v_and_b32 v21, 0xffff0000, v165
  v_cvt_pk_bf16_f32 v166, v22, v23
  v_lshlrev_b32 v22, 16, v166
  v_and_b32 v23, 0xffff0000, v166
  v_cvt_pk_bf16_f32 v167, v24, v25
  v_lshlrev_b32 v24, 16, v167
  v_and_b32 v25, 0xffff0000, v167
  v_add_f32_dpp v18, v184, v18 quad_perm:[0,0,0,0] row_mask:0xf bank_mask:0xf
  v_add_f32_dpp v19, v185, v19 quad_perm:[0,0,0,0] row_mask:0xf bank_mask:0xf
  v_add_f32_dpp v20, v186, v20 quad_perm:[0,0,0,0] row_mask:0xf bank_mask:0xf
  v_add_f32_dpp v21, v187, v21 quad_perm:[0,0,0,0] row_mask:0xf bank_mask:0xf
  v_add_f32_dpp v22, v184, v22 quad_perm:[1,1,1,1] row_mask:0xf bank_mask:0xf
  v_add_f32_dpp v23, v185, v23 quad_perm:[1,1,1,1] row_mask:0xf bank_mask:0xf
  v_add_f32_dpp v24, v186, v24 quad_perm:[1,1,1,1] row_mask:0xf bank_mask:0xf
  v_add_f32_dpp v25, v187, v25 quad_perm:[1,1,1,1] row_mask:0xf bank_mask:0xf
  v_cvt_pk_bf16_f32 v204, v18, v19
  v_cvt_pk_bf16_f32 v205, v20, v21
  v_cvt_pk_bf16_f32 v206, v22, v23
  v_cvt_pk_bf16_f32 v207, v24, v25
  s_add_u32 s35, s38, 8192
  buffer_store_dwordx4 v[204:207], v161, s[8:11], s35 offen
  v_mul_f32_dpp v26, v188, v26 quad_perm:[2,2,2,2] row_mask:0xf bank_mask:0xf
  v_mul_f32_dpp v27, v189, v27 quad_perm:[2,2,2,2] row_mask:0xf bank_mask:0xf
  v_mul_f32_dpp v28, v190, v28 quad_perm:[2,2,2,2] row_mask:0xf bank_mask:0xf
  v_mul_f32_dpp v29, v191, v29 quad_perm:[2,2,2,2] row_mask:0xf bank_mask:0xf
  v_mul_f32_dpp v30, v188, v30 quad_perm:[3,3,3,3] row_mask:0xf bank_mask:0xf
  v_mul_f32_dpp v31, v189, v31 quad_perm:[3,3,3,3] row_mask:0xf bank_mask:0xf
  v_mul_f32_dpp v32, v190, v32 quad_perm:[3,3,3,3] row_mask:0xf bank_mask:0xf
  v_mul_f32_dpp v33, v191, v33 quad_perm:[3,3,3,3] row_mask:0xf bank_mask:0xf
  v_cvt_pk_bf16_f32 v164, v26, v27
  v_lshlrev_b32 v26, 16, v164
  v_and_b32 v27, 0xffff0000, v164
  v_cvt_pk_bf16_f32 v165, v28, v29
  v_lshlrev_b32 v28, 16, v165
  v_and_b32 v29, 0xffff0000, v165
  v_cvt_pk_bf16_f32 v166, v30, v31
  v_lshlrev_b32 v30, 16, v166
  v_and_b32 v31, 0xffff0000, v166
  v_cvt_pk_bf16_f32 v167, v32, v33
  v_lshlrev_b32 v32, 16, v167
  v_and_b32 v33, 0xffff0000, v167
  v_add_f32_dpp v26, v188, v26 quad_perm:[0,0,0,0] row_mask:0xf bank_mask:0xf
  v_add_f32_dpp v27, v189, v27 quad_perm:[0,0,0,0] row_mask:0xf bank_mask:0xf
  v_add_f32_dpp v28, v190, v28 quad_perm:[0,0,0,0] row_mask:0xf bank_mask:0xf
  v_add_f32_dpp v29, v191, v29 quad_perm:[0,0,0,0] row_mask:0xf bank_mask:0xf
  v_add_f32_dpp v30, v188, v30 quad_perm:[1,1,1,1] row_mask:0xf bank_mask:0xf
  v_add_f32_dpp v31, v189, v31 quad_perm:[1,1,1,1] row_mask:0xf bank_mask:0xf
  v_add_f32_dpp v32, v190, v32 quad_perm:[1,1,1,1] row_mask:0xf bank_mask:0xf
  v_add_f32_dpp v33, v191, v33 quad_perm:[1,1,1,1] row_mask:0xf bank_mask:0xf
  v_cvt_pk_bf16_f32 v208, v26, v27
  v_cvt_pk_bf16_f32 v209, v28, v29
  v_cvt_pk_bf16_f32 v210, v30, v31
  v_cvt_pk_bf16_f32 v211, v32, v33
  s_add_u32 s35, s38, 12288
  buffer_store_dwordx4 v[208:211], v161, s[8:11], s35 offen
  v_mul_f32_dpp v34, v192, v34 quad_perm:[2,2,2,2] row_mask:0xf bank_mask:0xf
  v_mul_f32_dpp v35, v193, v35 quad_perm:[2,2,2,2] row_mask:0xf bank_mask:0xf
  v_mul_f32_dpp v36, v194, v36 quad_perm:[2,2,2,2] row_mask:0xf bank_mask:0xf
  v_mul_f32_dpp v37, v195, v37 quad_perm:[2,2,2,2] row_mask:0xf bank_mask:0xf
  v_mul_f32_dpp v38, v192, v38 quad_perm:[3,3,3,3] row_mask:0xf bank_mask:0xf
  v_mul_f32_dpp v39, v193, v39 quad_perm:[3,3,3,3] row_mask:0xf bank_mask:0xf
  v_mul_f32_dpp v40, v194, v40 quad_perm:[3,3,3,3] row_mask:0xf bank_mask:0xf
  v_mul_f32_dpp v41, v195, v41 quad_perm:[3,3,3,3] row_mask:0xf bank_mask:0xf
  v_cvt_pk_bf16_f32 v164, v34, v35
  v_lshlrev_b32 v34, 16, v164
  v_and_b32 v35, 0xffff0000, v164
  v_cvt_pk_bf16_f32 v165, v36, v37
  v_lshlrev_b32 v36, 16, v165
  v_and_b32 v37, 0xffff0000, v165
  v_cvt_pk_bf16_f32 v166, v38, v39
  v_lshlrev_b32 v38, 16, v166
  v_and_b32 v39, 0xffff0000, v166
  v_cvt_pk_bf16_f32 v167, v40, v41
  v_lshlrev_b32 v40, 16, v167
  v_and_b32 v41, 0xffff0000, v167
  v_add_f32_dpp v34, v192, v34 quad_perm:[0,0,0,0] row_mask:0xf bank_mask:0xf
  v_add_f32_dpp v35, v193, v35 quad_perm:[0,0,0,0] row_mask:0xf bank_mask:0xf
  v_add_f32_dpp v36, v194, v36 quad_perm:[0,0,0,0] row_mask:0xf bank_mask:0xf
  v_add_f32_dpp v37, v195, v37 quad_perm:[0,0,0,0] row_mask:0xf bank_mask:0xf
  v_add_f32_dpp v38, v192, v38 quad_perm:[1,1,1,1] row_mask:0xf bank_mask:0xf
  v_add_f32_dpp v39, v193, v39 quad_perm:[1,1,1,1] row_mask:0xf bank_mask:0xf
  v_add_f32_dpp v40, v194, v40 quad_perm:[1,1,1,1] row_mask:0xf bank_mask:0xf
  v_add_f32_dpp v41, v195, v41 quad_perm:[1,1,1,1] row_mask:0xf bank_mask:0xf
  v_cvt_pk_bf16_f32 v212, v34, v35
  v_cvt_pk_bf16_f32 v213, v36, v37
  v_cvt_pk_bf16_f32 v214, v38, v39
  v_cvt_pk_bf16_f32 v215, v40, v41
  s_add_u32 s35, s38, 16384
  buffer_store_dwordx4 v[212:215], v161, s[8:11], s35 offen
  s_add_u32 s38, s38, 81920
  s_add_u32 s33, s33, 4
  buffer_load_dwordx4 v[140:143], v160, s[20:23], s37 offen offset:0
  buffer_load_dwordx4 v[144:147], v160, s[20:23], s37 offen offset:256
  buffer_load_dwordx4 v[148:151], v160, s[20:23], s37 offen offset:512
  buffer_load_dwordx4 v[152:155], v160, s[20:23], s37 offen offset:768
  buffer_load_dwordx4 v[156:159], v160, s[20:23], s37 offen offset:1024
  s_add_u32 s37, s37, 81920
  s_min_u32 s37, s37, 2616320
  s_cmp_lt_u32 s33, 128
  s_cbranch_scc0 r_ln1e
  v_lshlrev_b32 v2, 16, v46
  v_and_b32 v3, 0xffff0000, v46
  v_lshlrev_b32 v4, 16, v47
  v_and_b32 v5, 0xffff0000, v47
  v_lshlrev_b32 v6, 16, v48
  v_and_b32 v7, 0xffff0000, v48
  v_lshlrev_b32 v8, 16, v49
  v_and_b32 v9, 0xffff0000, v49
  v_lshlrev_b32 v10, 16, v50
  v_and_b32 v11, 0xffff0000, v50
  v_lshlrev_b32 v12, 16, v51
  v_and_b32 v13, 0xffff0000, v51
  v_lshlrev_b32 v14, 16, v52
  v_and_b32 v15, 0xffff0000, v52
  v_lshlrev_b32 v16, 16, v53
  v_and_b32 v17, 0xffff0000, v53
  v_lshlrev_b32 v18, 16, v54
  v_and_b32 v19, 0xffff0000, v54
  v_lshlrev_b32 v20, 16, v55
  v_and_b32 v21, 0xffff0000, v55
  v_lshlrev_b32 v22, 16, v56
  v_and_b32 v23, 0xffff0000, v56
  v_lshlrev_b32 v24, 16, v57
  v_and_b32 v25, 0xffff0000, v57
  v_lshlrev_b32 v26, 16, v58
  v_and_b32 v27, 0xffff0000, v58
  v_lshlrev_b32 v28, 16, v59
  v_and_b32 v29, 0xffff0000, v59
  v_lshlrev_b32 v30, 16, v60
  v_and_b32 v31, 0xffff0000, v60
  v_lshlrev_b32 v32, 16, v61
  v_and_b32 v33, 0xffff0000, v61
  v_lshlrev_b32 v34, 16, v62
  v_and_b32 v35, 0xffff0000, v62
  v_lshlrev_b32 v36, 16, v63
  v_and_b32 v37, 0xffff0000, v63
  v_lshlrev_b32 v38, 16, v64
  v_and_b32 v39, 0xffff0000, v64
  v_lshlrev_b32 v40, 16, v65
  v_and_b32 v41, 0xffff0000, v65
  v_pk_add_f32 v[86:87], v[2:3], v[4:5]
  v_pk_add_f32 v[88:89], v[6:7], v[8:9]
  v_pk_add_f32 v[86:87], v[86:87], v[10:11]
  v_pk_add_f32 v[88:89], v[88:89], v[12:13]
  v_pk_add_f32 v[86:87], v[86:87], v[14:15]
  v_pk_add_f32 v[88:89], v[88:89], v[16:17]
  v_pk_add_f32 v[86:87], v[86:87], v[18:19]
  v_pk_add_f32 v[88:89], v[88:89], v[20:21]
  v_pk_add_f32 v[86:87], v[86:87], v[22:23]
  v_pk_add_f32 v[88:89], v[88:89], v[24:25]
  v_pk_add_f32 v[86:87], v[86:87], v[26:27]
  v_pk_add_f32 v[88:89], v[88:89], v[28:29]
  v_pk_add_f32 v[86:87], v[86:87], v[30:31]
  v_pk_add_f32 v[88:89], v[88:89], v[32:33]
  v_pk_add_f32 v[86:87], v[86:87], v[34:35]
  v_pk_add_f32 v[88:89], v[88:89], v[36:37]
  v_pk_add_f32 v[86:87], v[86:87], v[38:39]
  v_pk_add_f32 v[88:89], v[88:89], v[40:41]
  v_pk_add_f32 v[86:87], v[86:87], v[88:89]
  v_add_f32 v86, v86, v87
  s_nop 1
  v_add_f32_dpp v86, v86, v86 row_ror:8 row_mask:0xf bank_mask:0xf
  s_nop 1
  v_add_f32_dpp v86, v86, v86 row_ror:4 row_mask:0xf bank_mask:0xf
  v_mov_b32 v90, v86
  s_nop 1
  v_permlane16_swap_b32 v86, v90
  v_add_f32 v86, v86, v90
  v_mov_b32 v90, v86
  s_nop 1
  v_permlane32_swap_b32 v86, v90
  v_add_f32 v86, v86, v90
  v_mul_f32 v88, 0xbacccccd, v86
  v_mul_f32 v89, 0xbacccccd, v86
  v_pk_add_f32 v[164:165], v[2:3], v[88:89]
  v_pk_add_f32 v[166:167], v[4:5], v[88:89]
  v_pk_mul_f32 v[170:171], v[164:165], v[164:165]
  v_pk_add_f32 v[168:169], v[6:7], v[88:89]
  v_pk_mul_f32 v[86:87], v[166:167], v[166:167]
  v_pk_add_f32 v[164:165], v[8:9], v[88:89]
  v_pk_fma_f32 v[170:171], v[168:169], v[168:169], v[170:171]
  v_pk_add_f32 v[166:167], v[10:11], v[88:89]
  v_pk_fma_f32 v[86:87], v[164:165], v[164:165], v[86:87]
  v_pk_add_f32 v[168:169], v[12:13], v[88:89]
  v_pk_fma_f32 v[170:171], v[166:167], v[166:167], v[170:171]
  v_pk_add_f32 v[164:165], v[14:15], v[88:89]
  v_pk_fma_f32 v[86:87], v[168:169], v[168:169], v[86:87]
  v_pk_add_f32 v[166:167], v[16:17], v[88:89]
  v_pk_fma_f32 v[170:171], v[164:165], v[164:165], v[170:171]
  v_pk_add_f32 v[168:169], v[18:19], v[88:89]
  v_pk_fma_f32 v[86:87], v[166:167], v[166:167], v[86:87]
  v_pk_add_f32 v[164:165], v[20:21], v[88:89]
  v_pk_fma_f32 v[170:171], v[168:169], v[168:169], v[170:171]
  v_pk_add_f32 v[166:167], v[22:23], v[88:89]
  v_pk_fma_f32 v[86:87], v[164:165], v[164:165], v[86:87]
  v_pk_add_f32 v[168:169], v[24:25], v[88:89]
  v_pk_fma_f32 v[170:171], v[166:167], v[166:167], v[170:171]
  v_pk_add_f32 v[164:165], v[26:27], v[88:89]
  v_pk_fma_f32 v[86:87], v[168:169], v[168:169], v[86:87]
  v_pk_add_f32 v[166:167], v[28:29], v[88:89]
  v_pk_fma_f32 v[170:171], v[164:165], v[164:165], v[170:171]
  v_pk_add_f32 v[168:169], v[30:31], v[88:89]
  v_pk_fma_f32 v[86:87], v[166:167], v[166:167], v[86:87]
  v_pk_add_f32 v[164:165], v[32:33], v[88:89]
  v_pk_fma_f32 v[170:171], v[168:169], v[168:169], v[170:171]
  v_pk_add_f32 v[166:167], v[34:35], v[88:89]
  v_pk_fma_f32 v[86:87], v[164:165], v[164:165], v[86:87]
  v_pk_add_f32 v[168:169], v[36:37], v[88:89]
  v_pk_fma_f32 v[170:171], v[166:167], v[166:167], v[170:171]
  v_pk_add_f32 v[164:165], v[38:39], v[88:89]
  v_pk_fma_f32 v[86:87], v[168:169], v[168:169], v[86:87]
  v_pk_add_f32 v[166:167], v[40:41], v[88:89]
  v_pk_fma_f32 v[170:171], v[164:165], v[164:165], v[170:171]
  v_pk_fma_f32 v[86:87], v[166:167], v[166:167], v[86:87]
  v_cvt_pk_bf16_f32 v91, v88, v89
  v_lshlrev_b32 v88, 16, v91
  v_and_b32 v89, 0xffff0000, v91
  v_pk_add_f32 v[86:87], v[86:87], v[170:171]
  v_add_f32 v86, v86, v87
  s_nop 1
  v_add_f32_dpp v86, v86, v86 row_ror:8 row_mask:0xf bank_mask:0xf
  s_nop 1
  v_add_f32_dpp v86, v86, v86 row_ror:4 row_mask:0xf bank_mask:0xf
  v_mov_b32 v90, v86
  s_nop 1
  v_permlane16_swap_b32 v86, v90
  v_add_f32 v86, v86, v90
  v_mov_b32 v90, v86
  s_nop 1
  v_permlane32_swap_b32 v86, v90
  v_add_f32 v86, v86, v90
  v_pk_add_f32 v[2:3], v[2:3], v[88:89]
  v_mul_f32 v86, 0x3acccccd, v86
  v_pk_add_f32 v[4:5], v[4:5], v[88:89]
  v_cvt_pk_bf16_f32 v86, v86, v86
  v_pk_add_f32 v[6:7], v[6:7], v[88:89]
  v_lshlrev_b32 v86, 16, v86
  v_pk_add_f32 v[8:9], v[8:9], v[88:89]
  v_add_f32 v86, 0x3727c5ac, v86
  v_pk_add_f32 v[10:11], v[10:11], v[88:89]
  v_cvt_pk_bf16_f32 v86, v86, v86
  v_pk_add_f32 v[12:13], v[12:13], v[88:89]
  v_lshlrev_b32 v86, 16, v86
  v_pk_add_f32 v[14:15], v[14:15], v[88:89]
  v_sqrt_f32 v86, v86
  v_pk_add_f32 v[16:17], v[16:17], v[88:89]
  v_cvt_pk_bf16_f32 v86, v86, v86
  v_pk_add_f32 v[18:19], v[18:19], v[88:89]
  v_lshlrev_b32 v86, 16, v86
  v_pk_add_f32 v[20:21], v[20:21], v[88:89]
  v_rcp_f32 v86, v86
  v_pk_add_f32 v[22:23], v[22:23], v[88:89]
  v_mov_b32 v87, v86
  v_pk_add_f32 v[24:25], v[24:25], v[88:89]
  v_pk_add_f32 v[26:27], v[26:27], v[88:89]
  v_pk_add_f32 v[28:29], v[28:29], v[88:89]
  v_pk_add_f32 v[30:31], v[30:31], v[88:89]
  v_pk_add_f32 v[32:33], v[32:33], v[88:89]
  v_pk_add_f32 v[34:35], v[34:35], v[88:89]
  v_pk_add_f32 v[36:37], v[36:37], v[88:89]
  v_pk_add_f32 v[38:39], v[38:39], v[88:89]
  v_pk_add_f32 v[40:41], v[40:41], v[88:89]
  v_cvt_pk_bf16_f32 v164, v2, v3
  v_lshlrev_b32 v2, 16, v164
  v_and_b32 v3, 0xffff0000, v164
  v_cvt_pk_bf16_f32 v165, v4, v5
  v_lshlrev_b32 v4, 16, v165
  v_and_b32 v5, 0xffff0000, v165
  v_cvt_pk_bf16_f32 v166, v6, v7
  v_lshlrev_b32 v6, 16, v166
  v_and_b32 v7, 0xffff0000, v166
  v_cvt_pk_bf16_f32 v167, v8, v9
  v_lshlrev_b32 v8, 16, v167
  v_and_b32 v9, 0xffff0000, v167
  v_cvt_pk_bf16_f32 v164, v10, v11
  v_lshlrev_b32 v10, 16, v164
  v_and_b32 v11, 0xffff0000, v164
  v_cvt_pk_bf16_f32 v165, v12, v13
  v_lshlrev_b32 v12, 16, v165
  v_and_b32 v13, 0xffff0000, v165
  v_cvt_pk_bf16_f32 v166, v14, v15
  v_lshlrev_b32 v14, 16, v166
  v_and_b32 v15, 0xffff0000, v166
  v_cvt_pk_bf16_f32 v167, v16, v17
  v_lshlrev_b32 v16, 16, v167
  v_and_b32 v17, 0xffff0000, v167
  v_cvt_pk_bf16_f32 v164, v18, v19
  v_lshlrev_b32 v18, 16, v164
  v_and_b32 v19, 0xffff0000, v164
  v_cvt_pk_bf16_f32 v165, v20, v21
  v_lshlrev_b32 v20, 16, v165
  v_and_b32 v21, 0xffff0000, v165
  v_cvt_pk_bf16_f32 v166, v22, v23
  v_lshlrev_b32 v22, 16, v166
  v_and_b32 v23, 0xffff0000, v166
  v_cvt_pk_bf16_f32 v167, v24, v25
  v_lshlrev_b32 v24, 16, v167
  v_and_b32 v25, 0xffff0000, v167
  v_cvt_pk_bf16_f32 v164, v26, v27
  v_lshlrev_b32 v26, 16, v164
  v_and_b32 v27, 0xffff0000, v164
  v_cvt_pk_bf16_f32 v165, v28, v29
  v_lshlrev_b32 v28, 16, v165
  v_and_b32 v29, 0xffff0000, v165
  v_cvt_pk_bf16_f32 v166, v30, v31
  v_lshlrev_b32 v30, 16, v166
  v_and_b32 v31, 0xffff0000, v166
  v_cvt_pk_bf16_f32 v167, v32, v33
  v_lshlrev_b32 v32, 16, v167
  v_and_b32 v33, 0xffff0000, v167
  v_cvt_pk_bf16_f32 v164, v34, v35
  v_lshlrev_b32 v34, 16, v164
  v_and_b32 v35, 0xffff0000, v164
  v_cvt_pk_bf16_f32 v165, v36, v37
  v_lshlrev_b32 v36, 16, v165
  v_and_b32 v37, 0xffff0000, v165
  v_cvt_pk_bf16_f32 v166, v38, v39
  v_lshlrev_b32 v38, 16, v166
  v_and_b32 v39, 0xffff0000, v166
  v_cvt_pk_bf16_f32 v167, v40, v41
  v_lshlrev_b32 v40, 16, v167
  v_and_b32 v41, 0xffff0000, v167
  v_mov_b32 v92, s33
  s_waitcnt vmcnt(5)
  buffer_store_dword v92, v228, s[8:11], 0 offen
  v_pk_mul_f32 v[2:3], v[2:3], v[86:87]
  v_pk_mul_f32 v[4:5], v[4:5], v[86:87]
  v_pk_mul_f32 v[6:7], v[6:7], v[86:87]
  v_pk_mul_f32 v[8:9], v[8:9], v[86:87]
  v_pk_mul_f32 v[10:11], v[10:11], v[86:87]
  v_pk_mul_f32 v[12:13], v[12:13], v[86:87]
  v_pk_mul_f32 v[14:15], v[14:15], v[86:87]
  v_pk_mul_f32 v[16:17], v[16:17], v[86:87]
  v_pk_mul_f32 v[18:19], v[18:19], v[86:87]
  v_pk_mul_f32 v[20:21], v[20:21], v[86:87]
  v_pk_mul_f32 v[22:23], v[22:23], v[86:87]
  v_pk_mul_f32 v[24:25], v[24:25], v[86:87]
  v_pk_mul_f32 v[26:27], v[26:27], v[86:87]
  v_pk_mul_f32 v[28:29], v[28:29], v[86:87]
  v_pk_mul_f32 v[30:31], v[30:31], v[86:87]
  v_pk_mul_f32 v[32:33], v[32:33], v[86:87]
  v_pk_mul_f32 v[34:35], v[34:35], v[86:87]
  v_pk_mul_f32 v[36:37], v[36:37], v[86:87]
  v_pk_mul_f32 v[38:39], v[38:39], v[86:87]
  v_pk_mul_f32 v[40:41], v[40:41], v[86:87]
  v_cvt_pk_bf16_f32 v164, v2, v3
  v_lshlrev_b32 v2, 16, v164
  v_and_b32 v3, 0xffff0000, v164
  v_cvt_pk_bf16_f32 v165, v4, v5
  v_lshlrev_b32 v4, 16, v165
  v_and_b32 v5, 0xffff0000, v165
  v_cvt_pk_bf16_f32 v166, v6, v7
  v_lshlrev_b32 v6, 16, v166
  v_and_b32 v7, 0xffff0000, v166
  v_cvt_pk_bf16_f32 v167, v8, v9
  v_lshlrev_b32 v8, 16, v167
  v_and_b32 v9, 0xffff0000, v167
  v_cvt_pk_bf16_f32 v164, v10, v11
  v_lshlrev_b32 v10, 16, v164
  v_and_b32 v11, 0xffff0000, v164
  v_cvt_pk_bf16_f32 v165, v12, v13
  v_lshlrev_b32 v12, 16, v165
  v_and_b32 v13, 0xffff0000, v165
  v_cvt_pk_bf16_f32 v166, v14, v15
  v_lshlrev_b32 v14, 16, v166
  v_and_b32 v15, 0xffff0000, v166
  v_cvt_pk_bf16_f32 v167, v16, v17
  v_lshlrev_b32 v16, 16, v167
  v_and_b32 v17, 0xffff0000, v167
  v_cvt_pk_bf16_f32 v164, v18, v19
  v_lshlrev_b32 v18, 16, v164
  v_and_b32 v19, 0xffff0000, v164
  v_cvt_pk_bf16_f32 v165, v20, v21
  v_lshlrev_b32 v20, 16, v165
  v_and_b32 v21, 0xffff0000, v165
  v_cvt_pk_bf16_f32 v166, v22, v23
  v_lshlrev_b32 v22, 16, v166
  v_and_b32 v23, 0xffff0000, v166
  v_cvt_pk_bf16_f32 v167, v24, v25
  v_lshlrev_b32 v24, 16, v167
  v_and_b32 v25, 0xffff0000, v167
  v_cvt_pk_bf16_f32 v164, v26, v27
  v_lshlrev_b32 v26, 16, v164
  v_and_b32 v27, 0xffff0000, v164
  v_cvt_pk_bf16_f32 v165, v28, v29
  v_lshlrev_b32 v28, 16, v165
  v_and_b32 v29, 0xffff0000, v165
  v_cvt_pk_bf16_f32 v166, v30, v31
  v_lshlrev_b32 v30, 16, v166
  v_and_b32 v31, 0xffff0000, v166
  v_cvt_pk_bf16_f32 v167, v32, v33
  v_lshlrev_b32 v32, 16, v167
  v_and_b32 v33, 0xffff0000, v167
  v_cvt_pk_bf16_f32 v164, v34, v35
  v_lshlrev_b32 v34, 16, v164
  v_and_b32 v35, 0xffff0000, v164
  v_cvt_pk_bf16_f32 v165, v36, v37
  v_lshlrev_b32 v36, 16, v165
  v_and_b32 v37, 0xffff0000, v165
  v_cvt_pk_bf16_f32 v166, v38, v39
  v_lshlrev_b32 v38, 16, v166
  v_and_b32 v39, 0xffff0000, v166
  v_cvt_pk_bf16_f32 v167, v40, v41
  v_lshlrev_b32 v40, 16, v167
  v_and_b32 v41, 0xffff0000, v167
  v_mul_f32_dpp v2, v176, v2 quad_perm:[2,2,2,2] row_mask:0xf bank_mask:0xf
  v_mul_f32_dpp v3, v177, v3 quad_perm:[2,2,2,2] row_mask:0xf bank_mask:0xf
  v_mul_f32_dpp v4, v178, v4 quad_perm:[2,2,2,2] row_mask:0xf bank_mask:0xf
  v_mul_f32_dpp v5, v179, v5 quad_perm:[2,2,2,2] row_mask:0xf bank_mask:0xf
  v_mul_f32_dpp v6, v176, v6 quad_perm:[3,3,3,3] row_mask:0xf bank_mask:0xf
  v_mul_f32_dpp v7, v177, v7 quad_perm:[3,3,3,3] row_mask:0xf bank_mask:0xf
  v_mul_f32_dpp v8, v178, v8 quad_perm:[3,3,3,3] row_mask:0xf bank_mask:0xf
  v_mul_f32_dpp v9, v179, v9 quad_perm:[3,3,3,3] row_mask:0xf bank_mask:0xf
  v_cvt_pk_bf16_f32 v164, v2, v3
  v_lshlrev_b32 v2, 16, v164
  v_and_b32 v3, 0xffff0000, v164
  v_cvt_pk_bf16_f32 v165, v4, v5
  v_lshlrev_b32 v4, 16, v165
  v_and_b32 v5, 0xffff0000, v165
  v_cvt_pk_bf16_f32 v166, v6, v7
  v_lshlrev_b32 v6, 16, v166
  v_and_b32 v7, 0xffff0000, v166
  v_cvt_pk_bf16_f32 v167, v8, v9
  v_lshlrev_b32 v8, 16, v167
  v_and_b32 v9, 0xffff0000, v167
  v_add_f32_dpp v2, v176, v2 quad_perm:[0,0,0,0] row_mask:0xf bank_mask:0xf
  v_add_f32_dpp v3, v177, v3 quad_perm:[0,0,0,0] row_mask:0xf bank_mask:0xf
  v_add_f32_dpp v4, v178, v4 quad_perm:[0,0,0,0] row_mask:0xf bank_mask:0xf
  v_add_f32_dpp v5, v179, v5 quad_perm:[0,0,0,0] row_mask:0xf bank_mask:0xf
  v_add_f32_dpp v6, v176, v6 quad_perm:[1,1,1,1] row_mask:0xf bank_mask:0xf
  v_add_f32_dpp v7, v177, v7 quad_perm:[1,1,1,1] row_mask:0xf bank_mask:0xf
  v_add_f32_dpp v8, v178, v8 quad_perm:[1,1,1,1] row_mask:0xf bank_mask:0xf
  v_add_f32_dpp v9, v179, v9 quad_perm:[1,1,1,1] row_mask:0xf bank_mask:0xf
  v_cvt_pk_bf16_f32 v196, v2, v3
  v_cvt_pk_bf16_f32 v197, v4, v5
  v_cvt_pk_bf16_f32 v198, v6, v7
  v_cvt_pk_bf16_f32 v199, v8, v9
  s_add_u32 s35, s38, 0
  buffer_store_dwordx4 v[196:199], v161, s[8:11], s35 offen
  v_mul_f32_dpp v10, v180, v10 quad_perm:[2,2,2,2] row_mask:0xf bank_mask:0xf
  v_mul_f32_dpp v11, v181, v11 quad_perm:[2,2,2,2] row_mask:0xf bank_mask:0xf
  v_mul_f32_dpp v12, v182, v12 quad_perm:[2,2,2,2] row_mask:0xf bank_mask:0xf
  v_mul_f32_dpp v13, v183, v13 quad_perm:[2,2,2,2] row_mask:0xf bank_mask:0xf
  v_mul_f32_dpp v14, v180, v14 quad_perm:[3,3,3,3] row_mask:0xf bank_mask:0xf
  v_mul_f32_dpp v15, v181, v15 quad_perm:[3,3,3,3] row_mask:0xf bank_mask:0xf
  v_mul_f32_dpp v16, v182, v16 quad_perm:[3,3,3,3] row_mask:0xf bank_mask:0xf
  v_mul_f32_dpp v17, v183, v17 quad_perm:[3,3,3,3] row_mask:0xf bank_mask:0xf
  v_cvt_pk_bf16_f32 v164, v10, v11
  v_lshlrev_b32 v10, 16, v164
  v_and_b32 v11, 0xffff0000, v164
  v_cvt_pk_bf16_f32 v165, v12, v13
  v_lshlrev_b32 v12, 16, v165
  v_and_b32 v13, 0xffff0000, v165
  v_cvt_pk_bf16_f32 v166, v14, v15
  v_lshlrev_b32 v14, 16, v166
  v_and_b32 v15, 0xffff0000, v166
  v_cvt_pk_bf16_f32 v167, v16, v17
  v_lshlrev_b32 v16, 16, v167
  v_and_b32 v17, 0xffff0000, v167
  v_add_f32_dpp v10, v180, v10 quad_perm:[0,0,0,0] row_mask:0xf bank_mask:0xf
  v_add_f32_dpp v11, v181, v11 quad_perm:[0,0,0,0] row_mask:0xf bank_mask:0xf
  v_add_f32_dpp v12, v182, v12 quad_perm:[0,0,0,0] row_mask:0xf bank_mask:0xf
  v_add_f32_dpp v13, v183, v13 quad_perm:[0,0,0,0] row_mask:0xf bank_mask:0xf
  v_add_f32_dpp v14, v180, v14 quad_perm:[1,1,1,1] row_mask:0xf bank_mask:0xf
  v_add_f32_dpp v15, v181, v15 quad_perm:[1,1,1,1] row_mask:0xf bank_mask:0xf
  v_add_f32_dpp v16, v182, v16 quad_perm:[1,1,1,1] row_mask:0xf bank_mask:0xf
  v_add_f32_dpp v17, v183, v17 quad_perm:[1,1,1,1] row_mask:0xf bank_mask:0xf
  v_cvt_pk_bf16_f32 v200, v10, v11
  v_cvt_pk_bf16_f32 v201, v12, v13
  v_cvt_pk_bf16_f32 v202, v14, v15
  v_cvt_pk_bf16_f32 v203, v16, v17
  s_add_u32 s35, s38, 4096
  buffer_store_dwordx4 v[200:203], v161, s[8:11], s35 offen
  v_mul_f32_dpp v18, v184, v18 quad_perm:[2,2,2,2] row_mask:0xf bank_mask:0xf
  v_mul_f32_dpp v19, v185, v19 quad_perm:[2,2,2,2] row_mask:0xf bank_mask:0xf
  v_mul_f32_dpp v20, v186, v20 quad_perm:[2,2,2,2] row_mask:0xf bank_mask:0xf
  v_mul_f32_dpp v21, v187, v21 quad_perm:[2,2,2,2] row_mask:0xf bank_mask:0xf
  v_mul_f32_dpp v22, v184, v22 quad_perm:[3,3,3,3] row_mask:0xf bank_mask:0xf
  v_mul_f32_dpp v23, v185, v23 quad_perm:[3,3,3,3] row_mask:0xf bank_mask:0xf
  v_mul_f32_dpp v24, v186, v24 quad_perm:[3,3,3,3] row_mask:0xf bank_mask:0xf
  v_mul_f32_dpp v25, v187, v25 quad_perm:[3,3,3,3] row_mask:0xf bank_mask:0xf
  v_cvt_pk_bf16_f32 v164, v18, v19
  v_lshlrev_b32 v18, 16, v164
  v_and_b32 v19, 0xffff0000, v164
  v_cvt_pk_bf16_f32 v165, v20, v21
  v_lshlrev_b32 v20, 16, v165
  v_and_b32 v21, 0xffff0000, v165
  v_cvt_pk_bf16_f32 v166, v22, v23
  v_lshlrev_b32 v22, 16, v166
  v_and_b32 v23, 0xffff0000, v166
  v_cvt_pk_bf16_f32 v167, v24, v25
  v_lshlrev_b32 v24, 16, v167
  v_and_b32 v25, 0xffff0000, v167
  v_add_f32_dpp v18, v184, v18 quad_perm:[0,0,0,0] row_mask:0xf bank_mask:0xf
  v_add_f32_dpp v19, v185, v19 quad_perm:[0,0,0,0] row_mask:0xf bank_mask:0xf
  v_add_f32_dpp v20, v186, v20 quad_perm:[0,0,0,0] row_mask:0xf bank_mask:0xf
  v_add_f32_dpp v21, v187, v21 quad_perm:[0,0,0,0] row_mask:0xf bank_mask:0xf
  v_add_f32_dpp v22, v184, v22 quad_perm:[1,1,1,1] row_mask:0xf bank_mask:0xf
  v_add_f32_dpp v23, v185, v23 quad_perm:[1,1,1,1] row_mask:0xf bank_mask:0xf
  v_add_f32_dpp v24, v186, v24 quad_perm:[1,1,1,1] row_mask:0xf bank_mask:0xf
  v_add_f32_dpp v25, v187, v25 quad_perm:[1,1,1,1] row_mask:0xf bank_mask:0xf
  v_cvt_pk_bf16_f32 v204, v18, v19
  v_cvt_pk_bf16_f32 v205, v20, v21
  v_cvt_pk_bf16_f32 v206, v22, v23
  v_cvt_pk_bf16_f32 v207, v24, v25
  s_add_u32 s35, s38, 8192
  buffer_store_dwordx4 v[204:207], v161, s[8:11], s35 offen
  v_mul_f32_dpp v26, v188, v26 quad_perm:[2,2,2,2] row_mask:0xf bank_mask:0xf
  v_mul_f32_dpp v27, v189, v27 quad_perm:[2,2,2,2] row_mask:0xf bank_mask:0xf
  v_mul_f32_dpp v28, v190, v28 quad_perm:[2,2,2,2] row_mask:0xf bank_mask:0xf
  v_mul_f32_dpp v29, v191, v29 quad_perm:[2,2,2,2] row_mask:0xf bank_mask:0xf
  v_mul_f32_dpp v30, v188, v30 quad_perm:[3,3,3,3] row_mask:0xf bank_mask:0xf
  v_mul_f32_dpp v31, v189, v31 quad_perm:[3,3,3,3] row_mask:0xf bank_mask:0xf
  v_mul_f32_dpp v32, v190, v32 quad_perm:[3,3,3,3] row_mask:0xf bank_mask:0xf
  v_mul_f32_dpp v33, v191, v33 quad_perm:[3,3,3,3] row_mask:0xf bank_mask:0xf
  v_cvt_pk_bf16_f32 v164, v26, v27
  v_lshlrev_b32 v26, 16, v164
  v_and_b32 v27, 0xffff0000, v164
  v_cvt_pk_bf16_f32 v165, v28, v29
  v_lshlrev_b32 v28, 16, v165
  v_and_b32 v29, 0xffff0000, v165
  v_cvt_pk_bf16_f32 v166, v30, v31
  v_lshlrev_b32 v30, 16, v166
  v_and_b32 v31, 0xffff0000, v166
  v_cvt_pk_bf16_f32 v167, v32, v33
  v_lshlrev_b32 v32, 16, v167
  v_and_b32 v33, 0xffff0000, v167
  v_add_f32_dpp v26, v188, v26 quad_perm:[0,0,0,0] row_mask:0xf bank_mask:0xf
  v_add_f32_dpp v27, v189, v27 quad_perm:[0,0,0,0] row_mask:0xf bank_mask:0xf
  v_add_f32_dpp v28, v190, v28 quad_perm:[0,0,0,0] row_mask:0xf bank_mask:0xf
  v_add_f32_dpp v29, v191, v29 quad_perm:[0,0,0,0] row_mask:0xf bank_mask:0xf
  v_add_f32_dpp v30, v188, v30 quad_perm:[1,1,1,1] row_mask:0xf bank_mask:0xf
  v_add_f32_dpp v31, v189, v31 quad_perm:[1,1,1,1] row_mask:0xf bank_mask:0xf
  v_add_f32_dpp v32, v190, v32 quad_perm:[1,1,1,1] row_mask:0xf bank_mask:0xf
  v_add_f32_dpp v33, v191, v33 quad_perm:[1,1,1,1] row_mask:0xf bank_mask:0xf
  v_cvt_pk_bf16_f32 v208, v26, v27
  v_cvt_pk_bf16_f32 v209, v28, v29
  v_cvt_pk_bf16_f32 v210, v30, v31
  v_cvt_pk_bf16_f32 v211, v32, v33
  s_add_u32 s35, s38, 12288
  buffer_store_dwordx4 v[208:211], v161, s[8:11], s35 offen
  v_mul_f32_dpp v34, v192, v34 quad_perm:[2,2,2,2] row_mask:0xf bank_mask:0xf
  v_mul_f32_dpp v35, v193, v35 quad_perm:[2,2,2,2] row_mask:0xf bank_mask:0xf
  v_mul_f32_dpp v36, v194, v36 quad_perm:[2,2,2,2] row_mask:0xf bank_mask:0xf
  v_mul_f32_dpp v37, v195, v37 quad_perm:[2,2,2,2] row_mask:0xf bank_mask:0xf
  v_mul_f32_dpp v38, v192, v38 quad_perm:[3,3,3,3] row_mask:0xf bank_mask:0xf
  v_mul_f32_dpp v39, v193, v39 quad_perm:[3,3,3,3] row_mask:0xf bank_mask:0xf
  v_mul_f32_dpp v40, v194, v40 quad_perm:[3,3,3,3] row_mask:0xf bank_mask:0xf
  v_mul_f32_dpp v41, v195, v41 quad_perm:[3,3,3,3] row_mask:0xf bank_mask:0xf
  v_cvt_pk_bf16_f32 v164, v34, v35
  v_lshlrev_b32 v34, 16, v164
  v_and_b32 v35, 0xffff0000, v164
  v_cvt_pk_bf16_f32 v165, v36, v37
  v_lshlrev_b32 v36, 16, v165
  v_and_b32 v37, 0xffff0000, v165
  v_cvt_pk_bf16_f32 v166, v38, v39
  v_lshlrev_b32 v38, 16, v166
  v_and_b32 v39, 0xffff0000, v166
  v_cvt_pk_bf16_f32 v167, v40, v41
  v_lshlrev_b32 v40, 16, v167
  v_and_b32 v41, 0xffff0000, v167
  v_add_f32_dpp v34, v192, v34 quad_perm:[0,0,0,0] row_mask:0xf bank_mask:0xf
  v_add_f32_dpp v35, v193, v35 quad_perm:[0,0,0,0] row_mask:0xf bank_mask:0xf
  v_add_f32_dpp v36, v194, v36 quad_perm:[0,0,0,0] row_mask:0xf bank_mask:0xf
  v_add_f32_dpp v37, v195, v37 quad_perm:[0,0,0,0] row_mask:0xf bank_mask:0xf
  v_add_f32_dpp v38, v192, v38 quad_perm:[1,1,1,1] row_mask:0xf bank_mask:0xf
  v_add_f32_dpp v39, v193, v39 quad_perm:[1,1,1,1] row_mask:0xf bank_mask:0xf
  v_add_f32_dpp v40, v194, v40 quad_perm:[1,1,1,1] row_mask:0xf bank_mask:0xf
  v_add_f32_dpp v41, v195, v41 quad_perm:[1,1,1,1] row_mask:0xf bank_mask:0xf
  v_cvt_pk_bf16_f32 v212, v34, v35
  v_cvt_pk_bf16_f32 v213, v36, v37
  v_cvt_pk_bf16_f32 v214, v38, v39
  v_cvt_pk_bf16_f32 v215, v40, v41
  s_add_u32 s35, s38, 16384
  buffer_store_dwordx4 v[212:215], v161, s[8:11], s35 offen
  s_add_u32 s38, s38, 81920
  s_add_u32 s33, s33, 4
  buffer_load_dwordx4 v[46:49], v160, s[20:23], s37 offen offset:0
  buffer_load_dwordx4 v[50:53], v160, s[20:23], s37 offen offset:256
  buffer_load_dwordx4 v[54:57], v160, s[20:23], s37 offen offset:512
  buffer_load_dwordx4 v[58:61], v160, s[20:23], s37 offen offset:768
  buffer_load_dwordx4 v[62:65], v160, s[20:23], s37 offen offset:1024
  s_add_u32 s37, s37, 81920
  s_min_u32 s37, s37, 2616320
  s_cmp_lt_u32 s33, 128
  s_cbranch_scc1 r_ln1
r_ln1e:
  v_mov_b32 v92, s33
  s_waitcnt vmcnt(0)
  buffer_store_dword v92, v228, s[8:11], 0 offen
  s_add_u32 s52, s52, 20
r_mod2:
  v_lshlrev_b32 v12, 2, v0
  buffer_load_dword v13, v12, s[44:47], 0 offen
  buffer_load_dword v14, v12, s[44:47], 0 offen offset:1024
  v_lshrrev_b32 v20, 3, v0
  v_and_b32 v21, 7, v0
  v_mul_u32_u24 v22, 153600, v20
  v_lshl_add_u32 v22, v21, 4, v22
  s_lshl_b32 s6, s52, 7
  buffer_load_dwordx4 v[28:31], v22, s[48:51], s6 offen nt
  s_add_u32 s6, s6, 7680
  buffer_load_dwordx4 v[32:35], v22, s[48:51], s6 offen nt
  s_add_u32 s6, s6, 7680
  buffer_load_dwordx4 v[36:39], v22, s[48:51], s6 offen nt
  s_add_u32 s6, s6, 7680
  buffer_load_dwordx4 v[40:43], v22, s[48:51], s6 offen nt
  s_add_u32 s6, s6, 7680
  buffer_load_dwordx4 v[44:47], v22, s[48:51], s6 offen nt
  s_add_u32 s6, s6, 7680
  buffer_load_dwordx4 v[48:51], v22, s[48:51], s6 offen nt
  s_add_u32 s6, s6, 7680
  buffer_load_dwordx4 v[52:55], v22, s[48:51], s6 offen nt
  s_add_u32 s6, s6, 7680
  buffer_load_dwordx4 v[56:59], v22, s[48:51], s6 offen nt
  s_add_u32 s6, s6, 7680
  buffer_load_dwordx4 v[60:63], v22, s[48:51], s6 offen nt
  s_add_u32 s6, s6, 7680
  buffer_load_dwordx4 v[64:67], v22, s[48:51], s6 offen nt
  s_add_u32 s6, s6, 7680
  buffer_load_dwordx4 v[68:71], v22, s[48:51], s6 offen nt
  s_add_u32 s6, s6, 7680
  buffer_load_dwordx4 v[72:75], v22, s[48:51], s6 offen nt
  s_add_u32 s6, s6, 7680
  buffer_load_dwordx4 v[76:79], v22, s[48:51], s6 offen nt
  s_add_u32 s6, s6, 7680
  buffer_load_dwordx4 v[80:83], v22, s[48:51], s6 offen nt
  s_add_u32 s6, s6, 7680
  buffer_load_dwordx4 v[84:87], v22, s[48:51], s6 offen nt
  s_add_u32 s6, s6, 7680
  buffer_load_dwordx4 v[88:91], v22, s[48:51], s6 offen nt
  s_add_u32 s6, s6, 7680
  buffer_load_dwordx4 v[92:95], v22, s[48:51], s6 offen nt
  s_add_u32 s6, s6, 7680
  buffer_load_dwordx4 v[96:99], v22, s[48:51], s6 offen nt
  s_add_u32 s6, s6, 7680
  buffer_load_dwordx4 v[100:103], v22, s[48:51], s6 offen nt
  s_add_u32 s6, s6, 7680
  buffer_load_dwordx4 v[104:107], v22, s[48:51], s6 offen nt
  s_add_u32 s6, s6, 7680
  s_waitcnt vmcnt(20)
  v_lshlrev_b32 v24, 16, v13
  v_and_b32 v25, 0xffff0000, v13
  v_mul_f32 v16, 0xbfb8aa3b, v24
  v_mul_f32 v17, 0xbfb8aa3b, v25
  v_exp_f32 v16, v16
  v_exp_f32 v17, v17
  v_add_f32 v16, 1.0, v16
  v_add_f32 v17, 1.0, v17
  v_rcp_f32 v16, v16
  v_rcp_f32 v17, v17
  v_mul_f32 v24, v24, v16
  v_mul_f32 v25, v25, v17
  v_cvt_pk_bf16_f32 v16, v24, v25
  v_lshlrev_b32 v24, 16, v16
  v_and_b32 v25, 0xffff0000, v16
  v_lshlrev_b32 v26, 16, v14
  v_and_b32 v27, 0xffff0000, v14
  v_mul_f32 v16, 0xbfb8aa3b, v26
  v_mul_f32 v17, 0xbfb8aa3b, v27
  v_exp_f32 v16, v16
  v_exp_f32 v17, v17
  v_add_f32 v16, 1.0, v16
  v_add_f32 v17, 1.0, v17
  v_rcp_f32 v16, v16
  v_rcp_f32 v17, v17
  v_mul_f32 v26, v26, v16
  v_mul_f32 v27, v27, v17
  v_cvt_pk_bf16_f32 v16, v26, v27
  v_lshlrev_b32 v26, 16, v16
  v_and_b32 v27, 0xffff0000, v16
  v_lshlrev_b32 v12, 3, v0
  ds_write_b64 v12, v[24:25]
  ds_write_b64 v12, v[26:27] offset:2048
  v_mul_u32_u24 v12, 80, v20
  s_waitcnt lgkmcnt(0)
  s_barrier
  ds_read_b128 v[108:111], v12 offset:0
  ds_read_b128 v[112:115], v12 offset:16
  ds_read_b128 v[116:119], v12 offset:32
  ds_read_b128 v[120:123], v12 offset:48
  ds_read_b128 v[124:127], v12 offset:64
  v_mov_b32 v148, 0
  v_mov_b32 v149, 0
  v_mov_b32 v150, 0
  v_mov_b32 v151, 0
  v_mov_b32 v152, 0
  v_mov_b32 v153, 0
  v_mov_b32 v154, 0
  v_mov_b32 v155, 0
  s_waitcnt lgkmcnt(0)
  v_lshrrev_b32 v128, 16, v108
  v_lshrrev_b32 v129, 16, v109
  v_lshrrev_b32 v130, 16, v110
  v_lshrrev_b32 v131, 16, v111
  v_lshrrev_b32 v132, 16, v112
  v_lshrrev_b32 v133, 16, v113
  v_lshrrev_b32 v134, 16, v114
  v_lshrrev_b32 v135, 16, v115
  v_lshrrev_b32 v136, 16, v116
  v_lshrrev_b32 v137, 16, v117
  v_lshrrev_b32 v138, 16, v118
  v_lshrrev_b32 v139, 16, v119
  v_lshrrev_b32 v140, 16, v120
  v_lshrrev_b32 v141, 16, v121
  v_lshrrev_b32 v142, 16, v122
  v_lshrrev_b32 v143, 16, v123
  v_lshrrev_b32 v144, 16, v124
  v_lshrrev_b32 v145, 16, v125
  v_lshrrev_b32 v146, 16, v126
  v_lshrrev_b32 v147, 16, v127
  s_waitcnt vmcnt(18)
  v_dot2c_f32_bf16 v148, v28, v128
  v_dot2c_f32_bf16 v149, v28, v108
  v_dot2c_f32_bf16 v150, v29, v128
  v_dot2c_f32_bf16 v151, v29, v108
  v_dot2c_f32_bf16 v152, v30, v128
  v_dot2c_f32_bf16 v153, v30, v108
  v_dot2c_f32_bf16 v154, v31, v128
  v_dot2c_f32_bf16 v155, v31, v108
  v_dot2c_f32_bf16 v148, v32, v129
  v_dot2c_f32_bf16 v149, v32, v109
  v_dot2c_f32_bf16 v150, v33, v129
  v_dot2c_f32_bf16 v151, v33, v109
  v_dot2c_f32_bf16 v152, v34, v129
  v_dot2c_f32_bf16 v153, v34, v109
  v_dot2c_f32_bf16 v154, v35, v129
  v_dot2c_f32_bf16 v155, v35, v109
  s_waitcnt vmcnt(16)
  v_dot2c_f32_bf16 v148, v36, v130
  v_dot2c_f32_bf16 v149, v36, v110
  v_dot2c_f32_bf16 v150, v37, v130
  v_dot2c_f32_bf16 v151, v37, v110
  v_dot2c_f32_bf16 v152, v38, v130
  v_dot2c_f32_bf16 v153, v38, v110
  v_dot2c_f32_bf16 v154, v39, v130
  v_dot2c_f32_bf16 v155, v39, v110
  v_dot2c_f32_bf16 v148, v40, v131
  v_dot2c_f32_bf16 v149, v40, v111
  v_dot2c_f32_bf16 v150, v41, v131
  v_dot2c_f32_bf16 v151, v41, v111
  v_dot2c_f32_bf16 v152, v42, v131
  v_dot2c_f32_bf16 v153, v42, v111
  v_dot2c_f32_bf16 v154, v43, v131
  v_dot2c_f32_bf16 v155, v43, v111
  s_waitcnt vmcnt(14)
  v_dot2c_f32_bf16 v148, v44, v132
  v_dot2c_f32_bf16 v149, v44, v112
  v_dot2c_f32_bf16 v150, v45, v132
  v_dot2c_f32_bf16 v151, v45, v112
  v_dot2c_f32_bf16 v152, v46, v132
  v_dot2c_f32_bf16 v153, v46, v112
  v_dot2c_f32_bf16 v154, v47, v132
  v_dot2c_f32_bf16 v155, v47, v112
  v_dot2c_f32_bf16 v148, v48, v133
  v_dot2c_f32_bf16 v149, v48, v113
  v_dot2c_f32_bf16 v150, v49, v133
  v_dot2c_f32_bf16 v151, v49, v113
  v_dot2c_f32_bf16 v152, v50, v133
  v_dot2c_f32_bf16 v153, v50, v113
  v_dot2c_f32_bf16 v154, v51, v133
  v_dot2c_f32_bf16 v155, v51, v113
  s_waitcnt vmcnt(12)
  v_dot2c_f32_bf16 v148, v52, v134
  v_dot2c_f32_bf16 v149, v52, v114
  v_dot2c_f32_bf16 v150, v53, v134
  v_dot2c_f32_bf16 v151, v53, v114
  v_dot2c_f32_bf16 v152, v54, v134
  v_dot2c_f32_bf16 v153, v54, v114
  v_dot2c_f32_bf16 v154, v55, v134
  v_dot2c_f32_bf16 v155, v55, v114
  v_dot2c_f32_bf16 v148, v56, v135
  v_dot2c_f32_bf16 v149, v56, v115
  v_dot2c_f32_bf16 v150, v57, v135
  v_dot2c_f32_bf16 v151, v57, v115
  v_dot2c_f32_bf16 v152, v58, v135
  v_dot2c_f32_bf16 v153, v58, v115
  v_dot2c_f32_bf16 v154, v59, v135
  v_dot2c_f32_bf16 v155, v59, v115
  s_waitcnt vmcnt(10)
  v_dot2c_f32_bf16 v148, v60, v136
  v_dot2c_f32_bf16 v149, v60, v116
  v_dot2c_f32_bf16 v150, v61, v136
  v_dot2c_f32_bf16 v151, v61, v116
  v_dot2c_f32_bf16 v152, v62, v136
  v_dot2c_f32_bf16 v153, v62, v116
  v_dot2c_f32_bf16 v154, v63, v136
  v_dot2c_f32_bf16 v155, v63, v116
  v_dot2c_f32_bf16 v148, v64, v137
  v_dot2c_f32_bf16 v149, v64, v117
  v_dot2c_f32_bf16 v150, v65, v137
  v_dot2c_f32_bf16 v151, v65, v117
  v_dot2c_f32_bf16 v152, v66, v137
  v_dot2c_f32_bf16 v153, v66, v117
  v_dot2c_f32_bf16 v154, v67, v137
  v_dot2c_f32_bf16 v155, v67, v117
  s_waitcnt vmcnt(8)
  v_dot2c_f32_bf16 v148, v68, v138
  v_dot2c_f32_bf16 v149, v68, v118
  v_dot2c_f32_bf16 v150, v69, v138
  v_dot2c_f32_bf16 v151, v69, v118
  v_dot2c_f32_bf16 v152, v70, v138
  v_dot2c_f32_bf16 v153, v70, v118
  v_dot2c_f32_bf16 v154, v71, v138
  v_dot2c_f32_bf16 v155, v71, v118
  v_dot2c_f32_bf16 v148, v72, v139
  v_dot2c_f32_bf16 v149, v72, v119
  v_dot2c_f32_bf16 v150, v73, v139
  v_dot2c_f32_bf16 v151, v73, v119
  v_dot2c_f32_bf16 v152, v74, v139
  v_dot2c_f32_bf16 v153, v74, v119
  v_dot2c_f32_bf16 v154, v75, v139
  v_dot2c_f32_bf16 v155, v75, v119
  s_waitcnt vmcnt(6)
  v_dot2c_f32_bf16 v148, v76, v140
  v_dot2c_f32_bf16 v149, v76, v120
  v_dot2c_f32_bf16 v150, v77, v140
  v_dot2c_f32_bf16 v151, v77, v120
  v_dot2c_f32_bf16 v152, v78, v140
  v_dot2c_f32_bf16 v153, v78, v120
  v_dot2c_f32_bf16 v154, v79, v140
  v_dot2c_f32_bf16 v155, v79, v120
  v_dot2c_f32_bf16 v148, v80, v141
  v_dot2c_f32_bf16 v149, v80, v121
  v_dot2c_f32_bf16 v150, v81, v141
  v_dot2c_f32_bf16 v151, v81, v121
  v_dot2c_f32_bf16 v152, v82, v141
  v_dot2c_f32_bf16 v153, v82, v121
  v_dot2c_f32_bf16 v154, v83, v141
  v_dot2c_f32_bf16 v155, v83, v121
  s_waitcnt vmcnt(4)
  v_dot2c_f32_bf16 v148, v84, v142
  v_dot2c_f32_bf16 v149, v84, v122
  v_dot2c_f32_bf16 v150, v85, v142
  v_dot2c_f32_bf16 v151, v85, v122
  v_dot2c_f32_bf16 v152, v86, v142
  v_dot2c_f32_bf16 v153, v86, v122
  v_dot2c_f32_bf16 v154, v87, v142
  v_dot2c_f32_bf16 v155, v87, v122
  v_dot2c_f32_bf16 v148, v88, v143
  v_dot2c_f32_bf16 v149, v88, v123
  v_dot2c_f32_bf16 v150, v89, v143
  v_dot2c_f32_bf16 v151, v89, v123
  v_dot2c_f32_bf16 v152, v90, v143
  v_dot2c_f32_bf16 v153, v90, v123
  v_dot2c_f32_bf16 v154, v91, v143
  v_dot2c_f32_bf16 v155, v91, v123
  s_waitcnt vmcnt(2)
  v_dot2c_f32_bf16 v148, v92, v144
  v_dot2c_f32_bf16 v149, v92, v124
  v_dot2c_f32_bf16 v150, v93, v144
  v_dot2c_f32_bf16 v151, v93, v124
  v_dot2c_f32_bf16 v152, v94, v144
  v_dot2c_f32_bf16 v153, v94, v124
  v_dot2c_f32_bf16 v154, v95, v144
  v_dot2c_f32_bf16 v155, v95, v124
  v_dot2c_f32_bf16 v148, v96, v145
  v_dot2c_f32_bf16 v149, v96, v125
  v_dot2c_f32_bf16 v150, v97, v145
  v_dot2c_f32_bf16 v151, v97, v125
  v_dot2c_f32_bf16 v152, v98, v145
  v_dot2c_f32_bf16 v153, v98, v125
  v_dot2c_f32_bf16 v154, v99, v145
  v_dot2c_f32_bf16 v155, v99, v125
  s_waitcnt vmcnt(0)
  v_dot2c_f32_bf16 v148, v100, v146
  v_dot2c_f32_bf16 v149, v100, v126
  v_dot2c_f32_bf16 v150, v101, v146
  v_dot2c_f32_bf16 v151, v101, v126
  v_dot2c_f32_bf16 v152, v102, v146
  v_dot2c_f32_bf16 v153, v102, v126
  v_dot2c_f32_bf16 v154, v103, v146
  v_dot2c_f32_bf16 v155, v103, v126
  v_dot2c_f32_bf16 v148, v104, v147
  v_dot2c_f32_bf16 v149, v104, v127
  v_dot2c_f32_bf16 v150, v105, v147
  v_dot2c_f32_bf16 v151, v105, v127
  v_dot2c_f32_bf16 v152, v106, v147
  v_dot2c_f32_bf16 v153, v106, v127
  v_dot2c_f32_bf16 v154, v107, v147
  v_dot2c_f32_bf16 v155, v107, v127
  v_lshlrev_b32 v12, 5, v0
  ds_write_b128 v12, v[148:151] offset:4096
  s_nop 0
  ds_write_b128 v12, v[152:155] offset:4112
  v_lshlrev_b32 v12, 2, v0
  s_waitcnt lgkmcnt(0)
  s_barrier
  s_cmp_lg_u32 s17, 0
  s_cbranch_scc1 mod_endb
  ds_read2st64_b32 v[28:29], v12 offset0:16 offset1:17
  ds_read2st64_b32 v[30:31], v12 offset0:18 offset1:19
  ds_read2st64_b32 v[32:33], v12 offset0:20 offset1:21
  ds_read2st64_b32 v[34:35], v12 offset0:22 offset1:23
  ds_read2st64_b32 v[36:37], v12 offset0:24 offset1:25
  ds_read2st64_b32 v[38:39], v12 offset0:26 offset1:27
  ds_read2st64_b32 v[40:41], v12 offset0:28 offset1:29
  ds_read2st64_b32 v[42:43], v12 offset0:30 offset1:31
  ds_read2st64_b32 v[44:45], v12 offset0:32 offset1:33
  ds_read2st64_b32 v[46:47], v12 offset0:34 offset1:35
  ds_read2st64_b32 v[48:49], v12 offset0:36 offset1:37
  ds_read2st64_b32 v[50:51], v12 offset0:38 offset1:39
  ds_read2st64_b32 v[52:53], v12 offset0:40 offset1:41
  ds_read2st64_b32 v[54:55], v12 offset0:42 offset1:43
  ds_read2st64_b32 v[56:57], v12 offset0:44 offset1:45
  ds_read2st64_b32 v[58:59], v12 offset0:46 offset1:47
  s_waitcnt lgkmcnt(11)
  v_pk_add_f32 v[28:29], v[28:29], v[30:31]
  v_pk_add_f32 v[28:29], v[28:29], v[32:33]
  v_pk_add_f32 v[28:29], v[28:29], v[34:35]
  v_pk_add_f32 v[28:29], v[28:29], v[36:37]
  s_waitcnt lgkmcnt(7)
  v_pk_add_f32 v[28:29], v[28:29], v[38:39]
  v_pk_add_f32 v[28:29], v[28:29], v[40:41]
  v_pk_add_f32 v[28:29], v[28:29], v[42:43]
  v_pk_add_f32 v[28:29], v[28:29], v[44:45]
  s_waitcnt lgkmcnt(3)
  v_pk_add_f32 v[28:29], v[28:29], v[46:47]
  v_pk_add_f32 v[28:29], v[28:29], v[48:49]
  v_pk_add_f32 v[28:29], v[28:29], v[50:51]
  v_pk_add_f32 v[28:29], v[28:29], v[52:53]
  s_waitcnt lgkmcnt(0)
  v_pk_add_f32 v[28:29], v[28:29], v[54:55]
  v_pk_add_f32 v[28:29], v[28:29], v[56:57]
  v_pk_add_f32 v[28:29], v[28:29], v[58:59]
  v_add_f32 v28, v28, v29
  v_cvt_pk_bf16_f32 v28, v28, v28
  v_lshlrev_b32 v28, 16, v28
  s_lshl_b32 s6, s52, 8
  s_add_u32 s6, s6, 65536
  buffer_store_dword v28, v12, s[8:11], s6 offen sc1
  v_mov_b32 v16, 196
  v_mov_b32 v17, 1
  s_waitcnt vmcnt(0)
  s_mov_b64 exec, 1
  buffer_atomic_add v17, v16, s[12:15], 0 offen sc1
  s_mov_b64 exec, -1
mod_endb:
  s_barrier
  s_add_u32 s52, s52, 32
  s_cmp_lt_u32 s52, 60
  s_cbranch_scc1 r_mod2
  v_mov_b32 v233, 0
  v_mov_b32 v234, 0
  v_mov_b32 v235, 0
  v_mov_b32 v236, 0
  v_mov_b32 v237, 0
  s_cmp_eq_u32 s18, 31
  s_cbranch_scc1 r_now
  s_load_dwordx2 s[56:57], s[0:1], 72
  s_mov_b32 s58, 1966080
  s_mov_b32 s59, 0x00020000
  s_load_dwordx2 s[60:61], s[0:1], 80
  s_mov_b32 s62, 1966080
  s_mov_b32 s63, 0x00020000
  s_load_dwordx2 s[64:65], s[0:1], 88
  s_mov_b32 s66, 1966080
  s_mov_b32 s67, 0x00020000
  s_mul_i32 s68, s16, 3
  s_add_u32 s68, s68, s18
  s_sub_u32 s68, s68, 28
  s_mul_i32 s73, s17, 40960
  v_lshrrev_b32 v124, 4, v1
  v_and_b32 v124, 3, v124
  v_lshlrev_b32 v124, 1, v124
  v_and_b32 v4, 7, v1
  v_xor_b32 v4, v4, v124
  v_lshlrev_b32 v4, 4, v4
  v_lshrrev_b32 v124, 3, v1
  v_mul_u32_u24 v124, 0, v124
  v_add_u32 v4, v4, v124
  v_lshrrev_b32 v124, 4, v1
  v_and_b32 v124, 3, v124
  v_lshlrev_b32 v124, 1, v124
  v_and_b32 v5, 7, v1
  v_xor_b32 v5, v5, v124
  v_lshlrev_b32 v5, 4, v5
  v_lshrrev_b32 v124, 3, v1
  v_mul_u32_u24 v124, 1280, v124
  v_add_u32 v5, v5, v124
  v_bfe_u32 v124, v1, 3, 2
  v_bfe_u32 v125, v1, 5, 1
  v_lshl_add_u32 v124, v125, 3, v124
  v_mul_u32_u24 v124, 3072, v124
  v_add_u32 v4, v4, v124
  v_lshrrev_b32 v124, 2, v1
  v_lshrrev_b32 v125, 1, v124
  v_and_b32 v125, 3, v125
  v_lshlrev_b32 v125, 1, v125
  v_bfe_u32 v144, v1, 1, 1
  v_add_u32 v144, 0, v144
  v_xor_b32 v144, v144, v125
  v_lshlrev_b32 v144, 4, v144
  v_lshlrev_b32 v124, 7, v124
  v_add_u32 v144, v144, v124
  v_and_b32 v124, 1, v1
  v_lshlrev_b32 v124, 3, v124
  v_add_u32 v144, v144, v124
  v_add_u32 v144, s73, v144
  v_lshrrev_b32 v124, 2, v1
  v_lshrrev_b32 v125, 1, v124
  v_and_b32 v125, 3, v125
  v_lshlrev_b32 v125, 1, v125
  v_bfe_u32 v145, v1, 1, 1
  v_add_u32 v145, 2, v145
  v_xor_b32 v145, v145, v125
  v_lshlrev_b32 v145, 4, v145
  v_lshlrev_b32 v124, 7, v124
  v_add_u32 v145, v145, v124
  v_and_b32 v124, 1, v1
  v_lshlrev_b32 v124, 3, v124
  v_add_u32 v145, v145, v124
  v_add_u32 v145, s73, v145
  v_lshrrev_b32 v124, 2, v1
  v_lshrrev_b32 v125, 1, v124
  v_and_b32 v125, 3, v125
  v_lshlrev_b32 v125, 1, v125
  v_bfe_u32 v146, v1, 1, 1
  v_add_u32 v146, 4, v146
  v_xor_b32 v146, v146, v125
  v_lshlrev_b32 v146, 4, v146
  v_lshlrev_b32 v124, 7, v124
  v_add_u32 v146, v146, v124
  v_and_b32 v124, 1, v1
  v_lshlrev_b32 v124, 3, v124
  v_add_u32 v146, v146, v124
  v_add_u32 v146, s73, v146
  v_lshrrev_b32 v124, 2, v1
  v_lshrrev_b32 v125, 1, v124
  v_and_b32 v125, 3, v125
  v_lshlrev_b32 v125, 1, v125
  v_bfe_u32 v147, v1, 1, 1
  v_add_u32 v147, 6, v147
  v_xor_b32 v147, v147, v125
  v_lshlrev_b32 v147, 4, v147
  v_lshlrev_b32 v124, 7, v124
  v_add_u32 v147, v147, v124
  v_and_b32 v124, 1, v1
  v_lshlrev_b32 v124, 3, v124
  v_add_u32 v147, v147, v124
  v_add_u32 v147, s73, v147
  s_mul_i32 s72, s17, 491520
  s_lshl_b32 s70, s68, 7
  s_add_u32 s72, s72, s70
  s_waitcnt lgkmcnt(0)
  s_barrier
  s_add_u32 m0, s73, 0
  s_add_u32 s70, s72, 0
  buffer_load_dwordx4 v4, s[56:59], s70 offen nt lds
  s_add_u32 m0, s73, 1024
  s_add_u32 s70, s72, 49152
  buffer_load_dwordx4 v4, s[56:59], s70 offen nt lds
  s_add_u32 m0, s73, 2048
  s_add_u32 s70, s72, 12288
  buffer_load_dwordx4 v4, s[56:59], s70 offen nt lds
  s_add_u32 m0, s73, 3072
  s_add_u32 s70, s72, 61440
  buffer_load_dwordx4 v4, s[56:59], s70 offen nt lds
  s_add_u32 m0, s73, 4096
  s_add_u32 s70, s72, 98304
  buffer_load_dwordx4 v4, s[56:59], s70 offen nt lds
  s_add_u32 m0, s73, 5120
  s_add_u32 s70, s72, 147456
  buffer_load_dwordx4 v4, s[56:59], s70 offen nt lds
  s_add_u32 m0, s73, 6144
  s_add_u32 s70, s72, 110592
  buffer_load_dwordx4 v4, s[56:59], s70 offen nt lds
  s_add_u32 m0, s73, 7168
  s_add_u32 s70, s72, 159744
  buffer_load_dwordx4 v4, s[56:59], s70 offen nt lds
  s_add_u32 m0, s73, 8192
  s_add_u32 s70, s72, 196608
  buffer_load_dwordx4 v4, s[56:59], s70 offen nt lds
  s_add_u32 m0, s73, 9216
  s_add_u32 s70, s72, 245760
  buffer_load_dwordx4 v4, s[56:59], s70 offen nt lds
  s_add_u32 m0, s73, 10240
  s_add_u32 s70, s72, 208896
  buffer_load_dwordx4 v4, s[56:59], s70 offen nt lds
  s_add_u32 m0, s73, 11264
  s_add_u32 s70, s72, 258048
  buffer_load_dwordx4 v4, s[56:59], s70 offen nt lds
  s_add_u32 m0, s73, 12288
  s_add_u32 s70, s72, 294912
  buffer_load_dwordx4 v4, s[56:59], s70 offen nt lds
  s_add_u32 m0, s73, 13312
  s_add_u32 s70, s72, 344064
  buffer_load_dwordx4 v4, s[56:59], s70 offen nt lds
  s_add_u32 m0, s73, 14336
  s_add_u32 s70, s72, 307200
  buffer_load_dwordx4 v4, s[56:59], s70 offen nt lds
  s_add_u32 m0, s73, 15360
  s_add_u32 s70, s72, 356352
  buffer_load_dwordx4 v4, s[56:59], s70 offen nt lds
  s_add_u32 m0, s73, 16384
  s_add_u32 s70, s72, 393216
  buffer_load_dwordx4 v4, s[56:59], s70 offen nt lds
  s_add_u32 m0, s73, 17408
  s_add_u32 s70, s72, 442368
  buffer_load_dwordx4 v4, s[56:59], s70 offen nt lds
  s_add_u32 m0, s73, 18432
  s_add_u32 s70, s72, 405504
  buffer_load_dwordx4 v4, s[56:59], s70 offen nt lds
  s_add_u32 m0, s73, 19456
  s_add_u32 s70, s72, 454656
  buffer_load_dwordx4 v4, s[56:59], s70 offen nt lds
  s_add_u32 m0, s73, 20480
  s_add_u32 s70, s72, 0
  buffer_load_dwordx4 v4, s[60:63], s70 offen nt lds
  s_add_u32 m0, s73, 21504
  s_add_u32 s70, s72, 49152
  buffer_load_dwordx4 v4, s[60:63], s70 offen nt lds
  s_add_u32 m0, s73, 22528
  s_add_u32 s70, s72, 12288
  buffer_load_dwordx4 v4, s[60:63], s70 offen nt lds
  s_add_u32 m0, s73, 23552
  s_add_u32 s70, s72, 61440
  buffer_load_dwordx4 v4, s[60:63], s70 offen nt lds
  s_add_u32 m0, s73, 24576
  s_add_u32 s70, s72, 98304
  buffer_load_dwordx4 v4, s[60:63], s70 offen nt lds
  s_add_u32 m0, s73, 25600
  s_add_u32 s70, s72, 147456
  buffer_load_dwordx4 v4, s[60:63], s70 offen nt lds
  s_add_u32 m0, s73, 26624
  s_add_u32 s70, s72, 110592
  buffer_load_dwordx4 v4, s[60:63], s70 offen nt lds
  s_add_u32 m0, s73, 27648
  s_add_u32 s70, s72, 159744
  buffer_load_dwordx4 v4, s[60:63], s70 offen nt lds
  s_add_u32 m0, s73, 28672
  s_add_u32 s70, s72, 196608
  buffer_load_dwordx4 v4, s[60:63], s70 offen nt lds
  s_add_u32 m0, s73, 29696
  s_add_u32 s70, s72, 245760
  buffer_load_dwordx4 v4, s[60:63], s70 offen nt lds
  s_add_u32 m0, s73, 30720
  s_add_u32 s70, s72, 208896
  buffer_load_dwordx4 v4, s[60:63], s70 offen nt lds
  s_add_u32 m0, s73, 31744
  s_add_u32 s70, s72, 258048
  buffer_load_dwordx4 v4, s[60:63], s70 offen nt lds
  s_add_u32 m0, s73, 32768
  s_add_u32 s70, s72, 294912
  buffer_load_dwordx4 v4, s[60:63], s70 offen nt lds
  s_add_u32 m0, s73, 33792
  s_add_u32 s70, s72, 344064
  buffer_load_dwordx4 v4, s[60:63], s70 offen nt lds
  s_add_u32 m0, s73, 34816
  s_add_u32 s70, s72, 307200
  buffer_load_dwordx4 v4, s[60:63], s70 offen nt lds
  s_add_u32 m0, s73, 35840
  s_add_u32 s70, s72, 356352
  buffer_load_dwordx4 v4, s[60:63], s70 offen nt lds
  s_add_u32 m0, s73, 36864
  s_add_u32 s70, s72, 393216
  buffer_load_dwordx4 v4, s[60:63], s70 offen nt lds
  s_add_u32 m0, s73, 37888
  s_add_u32 s70, s72, 442368
  buffer_load_dwordx4 v4, s[60:63], s70 offen nt lds
  s_add_u32 m0, s73, 38912
  s_add_u32 s70, s72, 405504
  buffer_load_dwordx4 v4, s[60:63], s70 offen nt lds
  s_add_u32 m0, s73, 39936
  s_add_u32 s70, s72, 454656
  buffer_load_dwordx4 v4, s[60:63], s70 offen nt lds
  s_waitcnt vmcnt(36)
  ds_read_b64_tr_b16 a[0:1], v144 offset:0
  ds_read_b64_tr_b16 a[2:3], v144 offset:2048
  ds_read_b64_tr_b16 a[20:21], v145 offset:0
  ds_read_b64_tr_b16 a[22:23], v145 offset:2048
  ds_read_b64_tr_b16 a[40:41], v146 offset:0
  ds_read_b64_tr_b16 a[42:43], v146 offset:2048
  ds_read_b64_tr_b16 a[60:61], v147 offset:0
  ds_read_b64_tr_b16 a[62:63], v147 offset:2048
  s_waitcnt vmcnt(32)
  ds_read_b64_tr_b16 a[4:5], v144 offset:4096
  ds_read_b64_tr_b16 a[6:7], v144 offset:6144
  ds_read_b64_tr_b16 a[24:25], v145 offset:4096
  ds_read_b64_tr_b16 a[26:27], v145 offset:6144
  ds_read_b64_tr_b16 a[44:45], v146 offset:4096
  ds_read_b64_tr_b16 a[46:47], v146 offset:6144
  ds_read_b64_tr_b16 a[64:65], v147 offset:4096
  ds_read_b64_tr_b16 a[66:67], v147 offset:6144
  s_waitcnt lgkmcnt(0)
  s_waitcnt vmcnt(28)
  ds_read_b64_tr_b16 a[8:9], v144 offset:8192
  ds_read_b64_tr_b16 a[10:11], v144 offset:10240
  ds_read_b64_tr_b16 a[28:29], v145 offset:8192
  ds_read_b64_tr_b16 a[30:31], v145 offset:10240
  ds_read_b64_tr_b16 a[48:49], v146 offset:8192
  ds_read_b64_tr_b16 a[50:51], v146 offset:10240
  ds_read_b64_tr_b16 a[68:69], v147 offset:8192
  ds_read_b64_tr_b16 a[70:71], v147 offset:10240
  s_waitcnt vmcnt(24)
  ds_read_b64_tr_b16 a[12:13], v144 offset:12288
  ds_read_b64_tr_b16 a[14:15], v144 offset:14336
  ds_read_b64_tr_b16 a[32:33], v145 offset:12288
  ds_read_b64_tr_b16 a[34:35], v145 offset:14336
  ds_read_b64_tr_b16 a[52:53], v146 offset:12288
  ds_read_b64_tr_b16 a[54:55], v146 offset:14336
  ds_read_b64_tr_b16 a[72:73], v147 offset:12288
  ds_read_b64_tr_b16 a[74:75], v147 offset:14336
  s_waitcnt lgkmcnt(0)
  s_waitcnt vmcnt(20)
  ds_read_b64_tr_b16 a[16:17], v144 offset:16384
  ds_read_b64_tr_b16 a[18:19], v144 offset:18432
  ds_read_b64_tr_b16 a[36:37], v145 offset:16384
  ds_read_b64_tr_b16 a[38:39], v145 offset:18432
  ds_read_b64_tr_b16 a[56:57], v146 offset:16384
  ds_read_b64_tr_b16 a[58:59], v146 offset:18432
  ds_read_b64_tr_b16 a[76:77], v147 offset:16384
  ds_read_b64_tr_b16 a[78:79], v147 offset:18432
  s_waitcnt vmcnt(16)
  ds_read_b64_tr_b16 a[80:81], v144 offset:20480
  ds_read_b64_tr_b16 a[82:83], v144 offset:22528
  ds_read_b64_tr_b16 a[100:101], v145 offset:20480
  ds_read_b64_tr_b16 a[102:103], v145 offset:22528
  ds_read_b64_tr_b16 a[120:121], v146 offset:20480
  ds_read_b64_tr_b16 a[122:123], v146 offset:22528
  ds_read_b64_tr_b16 a[140:141], v147 offset:20480
  ds_read_b64_tr_b16 a[142:143], v147 offset:22528
  s_waitcnt lgkmcnt(0)
  s_waitcnt vmcnt(12)
  ds_read_b64_tr_b16 a[84:85], v144 offset:24576
  ds_read_b64_tr_b16 a[86:87], v144 offset:26624
  ds_read_b64_tr_b16 a[104:105], v145 offset:24576
  ds_read_b64_tr_b16 a[106:107], v145 offset:26624
  ds_read_b64_tr_b16 a[124:125], v146 offset:24576
  ds_read_b64_tr_b16 a[126:127], v146 offset:26624
  ds_read_b64_tr_b16 a[144:145], v147 offset:24576
  ds_read_b64_tr_b16 a[146:147], v147 offset:26624
  s_waitcnt vmcnt(8)
  ds_read_b64_tr_b16 a[88:89], v144 offset:28672
  ds_read_b64_tr_b16 a[90:91], v144 offset:30720
  ds_read_b64_tr_b16 a[108:109], v145 offset:28672
  ds_read_b64_tr_b16 a[110:111], v145 offset:30720
  ds_read_b64_tr_b16 a[128:129], v146 offset:28672
  ds_read_b64_tr_b16 a[130:131], v146 offset:30720
  ds_read_b64_tr_b16 a[148:149], v147 offset:28672
  ds_read_b64_tr_b16 a[150:151], v147 offset:30720
  s_waitcnt lgkmcnt(0)
  s_waitcnt vmcnt(4)
  ds_read_b64_tr_b16 a[92:93], v144 offset:32768
  ds_read_b64_tr_b16 a[94:95], v144 offset:34816
  ds_read_b64_tr_b16 a[112:113], v145 offset:32768
  ds_read_b64_tr_b16 a[114:115], v145 offset:34816
  ds_read_b64_tr_b16 a[132:133], v146 offset:32768
  ds_read_b64_tr_b16 a[134:135], v146 offset:34816
  ds_read_b64_tr_b16 a[152:153], v147 offset:32768
  ds_read_b64_tr_b16 a[154:155], v147 offset:34816
  s_waitcnt vmcnt(0)
  ds_read_b64_tr_b16 a[96:97], v144 offset:36864
  ds_read_b64_tr_b16 a[98:99], v144 offset:38912
  ds_read_b64_tr_b16 a[116:117], v145 offset:36864
  ds_read_b64_tr_b16 a[118:119], v145 offset:38912
  ds_read_b64_tr_b16 a[136:137], v146 offset:36864
  ds_read_b64_tr_b16 a[138:139], v146 offset:38912
  ds_read_b64_tr_b16 a[156:157], v147 offset:36864
  ds_read_b64_tr_b16 a[158:159], v147 offset:38912
  s_waitcnt lgkmcnt(0)
  s_mul_i32 s72, s68, 81920
  s_mul_i32 s70, s17, 320
  s_add_u32 s72, s72, s70
  s_add_u32 m0, s73, 0
  s_add_u32 s70, s72, 0
  buffer_load_dwordx4 v5, s[64:67], s70 offen nt lds
  s_add_u32 m0, s73, 1024
  s_add_u32 s70, s72, 10240
  buffer_load_dwordx4 v5, s[64:67], s70 offen nt lds
  s_add_u32 m0, s73, 2048
  s_add_u32 s70, s72, 20480
  buffer_load_dwordx4 v5, s[64:67], s70 offen nt lds
  s_add_u32 m0, s73, 3072
  s_add_u32 s70, s72, 30720
  buffer_load_dwordx4 v5, s[64:67], s70 offen nt lds
  s_add_u32 m0, s73, 4096
  s_add_u32 s70, s72, 40960
  buffer_load_dwordx4 v5, s[64:67], s70 offen nt lds
  s_add_u32 m0, s73, 5120
  s_add_u32 s70, s72, 51200
  buffer_load_dwordx4 v5, s[64:67], s70 offen nt lds
  s_add_u32 m0, s73, 6144
  s_add_u32 s70, s72, 61440
  buffer_load_dwordx4 v5, s[64:67], s70 offen nt lds
  s_add_u32 m0, s73, 7168
  s_add_u32 s70, s72, 71680
  buffer_load_dwordx4 v5, s[64:67], s70 offen nt lds
  s_add_u32 m0, s73, 8192
  s_add_u32 s70, s72, 128
  buffer_load_dwordx4 v5, s[64:67], s70 offen nt lds
  s_add_u32 m0, s73, 9216
  s_add_u32 s70, s72, 10368
  buffer_load_dwordx4 v5, s[64:67], s70 offen nt lds
  s_add_u32 m0, s73, 10240
  s_add_u32 s70, s72, 20608
  buffer_load_dwordx4 v5, s[64:67], s70 offen nt lds
  s_add_u32 m0, s73, 11264
  s_add_u32 s70, s72, 30848
  buffer_load_dwordx4 v5, s[64:67], s70 offen nt lds
  s_add_u32 m0, s73, 12288
  s_add_u32 s70, s72, 41088
  buffer_load_dwordx4 v5, s[64:67], s70 offen nt lds
  s_add_u32 m0, s73, 13312
  s_add_u32 s70, s72, 51328
  buffer_load_dwordx4 v5, s[64:67], s70 offen nt lds
  s_add_u32 m0, s73, 14336
  s_add_u32 s70, s72, 61568
  buffer_load_dwordx4 v5, s[64:67], s70 offen nt lds
  s_add_u32 m0, s73, 15360
  s_add_u32 s70, s72, 71808
  buffer_load_dwordx4 v5, s[64:67], s70 offen nt lds
  s_add_u32 m0, s73, 16384
  s_add_u32 s70, s72, 256
  buffer_load_dwordx4 v5, s[64:67], s70 offen nt lds
  s_add_u32 m0, s73, 17408
  s_add_u32 s70, s72, 10496
  buffer_load_dwordx4 v5, s[64:67], s70 offen nt lds
  s_add_u32 m0, s73, 18432
  s_add_u32 s70, s72, 20736
  buffer_load_dwordx4 v5, s[64:67], s70 offen nt lds
  s_add_u32 m0, s73, 19456
  s_add_u32 s70, s72, 30976
  buffer_load_dwordx4 v5, s[64:67], s70 offen nt lds
  s_add_u32 m0, s73, 20480
  s_add_u32 s70, s72, 41216
  buffer_load_dwordx4 v5, s[64:67], s70 offen nt lds
  s_add_u32 m0, s73, 21504
  s_add_u32 s70, s72, 51456
  buffer_load_dwordx4 v5, s[64:67], s70 offen nt lds
  s_add_u32 m0, s73, 22528
  s_add_u32 s70, s72, 61696
  buffer_load_dwordx4 v5, s[64:67], s70 offen nt lds
  s_add_u32 m0, s73, 23552
  s_add_u32 s70, s72, 71936
  buffer_load_dwordx4 v5, s[64:67], s70 offen nt lds
  s_waitcnt vmcnt(0)
  ds_read_b64_tr_b16 a[160:161], v144 offset:0
  ds_read_b64_tr_b16 a[162:163], v144 offset:2048
  ds_read_b64_tr_b16 a[164:165], v144 offset:4096
  ds_read_b64_tr_b16 a[166:167], v144 offset:6144
  ds_read_b64_tr_b16 a[168:169], v145 offset:0
  ds_read_b64_tr_b16 a[170:171], v145 offset:2048
  ds_read_b64_tr_b16 a[172:173], v145 offset:4096
  ds_read_b64_tr_b16 a[174:175], v145 offset:6144
  ds_read_b64_tr_b16 a[176:177], v146 offset:0
  ds_read_b64_tr_b16 a[178:179], v146 offset:2048
  ds_read_b64_tr_b16 a[180:181], v146 offset:4096
  ds_read_b64_tr_b16 a[182:183], v146 offset:6144
  s_waitcnt lgkmcnt(0)
  ds_read_b64_tr_b16 a[184:185], v147 offset:0
  ds_read_b64_tr_b16 a[186:187], v147 offset:2048
  ds_read_b64_tr_b16 a[188:189], v147 offset:4096
  ds_read_b64_tr_b16 a[190:191], v147 offset:6144
  ds_read_b64_tr_b16 a[192:193], v144 offset:8192
  ds_read_b64_tr_b16 a[194:195], v144 offset:10240
  ds_read_b64_tr_b16 a[196:197], v144 offset:12288
  ds_read_b64_tr_b16 a[198:199], v144 offset:14336
  ds_read_b64_tr_b16 a[200:201], v145 offset:8192
  ds_read_b64_tr_b16 a[202:203], v145 offset:10240
  ds_read_b64_tr_b16 a[204:205], v145 offset:12288
  ds_read_b64_tr_b16 a[206:207], v145 offset:14336
  s_waitcnt lgkmcnt(0)
  ds_read_b64_tr_b16 a[208:209], v146 offset:8192
  ds_read_b64_tr_b16 a[210:211], v146 offset:10240
  ds_read_b64_tr_b16 a[212:213], v146 offset:12288
  ds_read_b64_tr_b16 a[214:215], v146 offset:14336
  ds_read_b64_tr_b16 a[216:217], v147 offset:8192
  ds_read_b64_tr_b16 a[218:219], v147 offset:10240
  ds_read_b64_tr_b16 a[220:221], v147 offset:12288
  ds_read_b64_tr_b16 a[222:223], v147 offset:14336
  ds_read_b64_tr_b16 a[224:225], v144 offset:16384
  ds_read_b64_tr_b16 a[226:227], v144 offset:18432
  ds_read_b64_tr_b16 a[228:229], v144 offset:20480
  ds_read_b64_tr_b16 a[230:231], v144 offset:22528
  s_waitcnt lgkmcnt(0)
  ds_read_b64_tr_b16 a[232:233], v145 offset:16384
  ds_read_b64_tr_b16 a[234:235], v145 offset:18432
  ds_read_b64_tr_b16 a[236:237], v145 offset:20480
  ds_read_b64_tr_b16 a[238:239], v145 offset:22528
  v_lshlrev_b32 v233, 4, v1
  v_lshrrev_b32 v124, 2, v1
  v_and_b32 v125, 3, v1
  v_lshlrev_b32 v125, 2, v125
  v_lshl_add_u32 v234, v124, 7, v125
  v_lshrrev_b32 v124, 4, v1
  v_and_b32 v125, 7, v1
  v_lshlrev_b32 v125, 4, v125
  v_lshl_add_u32 v236, v124, 7, v125
  v_lshrrev_b32 v124, 5, v1
  v_mul_u32_u24 v124, 20480, v124
  v_and_b32 v125, 31, v1
  v_lshl_add_u32 v237, v125, 4, v124
  s_mul_i32 s78, s17, 24
  s_add_u32 s78, s78, s68
  s_mov_b32 s74, 0
  s_mov_b32 s75, 2097152
  s_waitcnt lgkmcnt(0)
  s_barrier
  s_mov_b32 s79, 0
  s_mov_b32 s80, 0
  s_mov_b32 s81, 0
  s_mov_b32 s82, 0
  s_mov_b32 s83, 0
  s_mov_b32 s84, 0
  s_mov_b32 s85, 0
  s_mov_b32 s86, 0
r_now:
  v_mov_b32 v90, 196
  s_mov_b32 s34, 0
gw_46:
  buffer_load_dword v91, v90, s[12:15], 0 offen sc1
  s_add_u32 s34, s34, 1
  s_cmp_gt_u32 s34, 65536
  s_cbranch_scc1 role_abort
  s_waitcnt vmcnt(0)
  v_cmp_gt_u32 vcc, 104, v91
  s_cbranch_vccz gk_47
  s_sleep 8
  s_branch gw_46
gk_47:
  s_mov_b32 s35, 70656
  buffer_load_dwordx2 v[196:197], v227, s[8:11], s35 offen offset:0 sc1
  buffer_load_dwordx2 v[198:199], v227, s[8:11], s35 offen offset:512 sc1
  buffer_load_dwordx2 v[200:201], v227, s[8:11], s35 offen offset:1024 sc1
  buffer_load_dwordx2 v[202:203], v227, s[8:11], s35 offen offset:1536 sc1
  buffer_load_dwordx2 v[204:205], v227, s[8:11], s35 offen offset:2048 sc1
  s_mov_b32 s35, 73216
  buffer_load_dwordx2 v[186:187], v227, s[8:11], s35 offen offset:0 sc1
  buffer_load_dwordx2 v[188:189], v227, s[8:11], s35 offen offset:512 sc1
  buffer_load_dwordx2 v[190:191], v227, s[8:11], s35 offen offset:1024 sc1
  buffer_load_dwordx2 v[192:193], v227, s[8:11], s35 offen offset:1536 sc1
  buffer_load_dwordx2 v[194:195], v227, s[8:11], s35 offen offset:2048 sc1
  s_mov_b32 s35, 75776
  buffer_load_dwordx2 v[176:177], v227, s[8:11], s35 offen offset:0 sc1
  buffer_load_dwordx2 v[178:179], v227, s[8:11], s35 offen offset:512 sc1
  buffer_load_dwordx2 v[180:181], v227, s[8:11], s35 offen offset:1024 sc1
  buffer_load_dwordx2 v[182:183], v227, s[8:11], s35 offen offset:1536 sc1
  buffer_load_dwordx2 v[184:185], v227, s[8:11], s35 offen offset:2048 sc1
  s_mov_b32 s35, 78336
  buffer_load_dwordx2 v[206:207], v227, s[8:11], s35 offen offset:0 sc1
  buffer_load_dwordx2 v[208:209], v227, s[8:11], s35 offen offset:512 sc1
  buffer_load_dwordx2 v[210:211], v227, s[8:11], s35 offen offset:1024 sc1
  buffer_load_dwordx2 v[212:213], v227, s[8:11], s35 offen offset:1536 sc1
  buffer_load_dwordx2 v[214:215], v227, s[8:11], s35 offen offset:2048 sc1
  buffer_load_dword v22, v226, s[28:31], 0 offen offset:0
  buffer_load_dword v23, v226, s[28:31], 0 offen offset:256
  buffer_load_dword v24, v226, s[28:31], 0 offen offset:512
  buffer_load_dword v25, v226, s[28:31], 0 offen offset:768
  buffer_load_dword v26, v226, s[28:31], 0 offen offset:1024
  v_lshlrev_b32 v229, 4, v1
  s_lshl_b32 s35, s16, 8
  s_add_u32 s35, s35, 12288
  v_and_b32 v90, 7, v1
  v_lshl_add_u32 v232, v90, 2, s35
  s_waitcnt vmcnt(0)
  v_add_f32 v176, 1.0, v176
  v_add_f32 v177, 1.0, v177
  v_cvt_pk_bf16_f32 v90, v176, v177
  v_lshlrev_b32 v176, 16, v90
  v_and_b32 v177, 0xffff0000, v90
  v_add_f32 v178, 1.0, v178
  v_add_f32 v179, 1.0, v179
  v_cvt_pk_bf16_f32 v90, v178, v179
  v_lshlrev_b32 v178, 16, v90
  v_and_b32 v179, 0xffff0000, v90
  v_add_f32 v180, 1.0, v180
  v_add_f32 v181, 1.0, v181
  v_cvt_pk_bf16_f32 v90, v180, v181
  v_lshlrev_b32 v180, 16, v90
  v_and_b32 v181, 0xffff0000, v90
  v_add_f32 v182, 1.0, v182
  v_add_f32 v183, 1.0, v183
  v_cvt_pk_bf16_f32 v90, v182, v183
  v_lshlrev_b32 v182, 16, v90
  v_and_b32 v183, 0xffff0000, v90
  v_add_f32 v184, 1.0, v184
  v_add_f32 v185, 1.0, v185
  v_cvt_pk_bf16_f32 v90, v184, v185
  v_lshlrev_b32 v184, 16, v90
  v_and_b32 v185, 0xffff0000, v90
  v_lshlrev_b32 v216, 16, v22
  v_and_b32 v217, 0xffff0000, v22
  v_lshlrev_b32 v218, 16, v23
  v_and_b32 v219, 0xffff0000, v23
  v_lshlrev_b32 v220, 16, v24
  v_and_b32 v221, 0xffff0000, v24
  v_lshlrev_b32 v222, 16, v25
  v_and_b32 v223, 0xffff0000, v25
  v_lshlrev_b32 v224, 16, v26
  v_and_b32 v225, 0xffff0000, v26
  s_mov_b32 s33, s16
r_loop:
  s_lshl_b32 s40, s33, 4
  s_add_u32 s40, s40, s32
  s_mul_i32 s37, s40, 1280
  s_lshr_b32 s39, s33, 1
  s_mul_i32 s38, s39, 327680
  s_and_b32 s35, s40, 31
  s_mul_i32 s35, s35, 1280
  s_add_u32 s38, s38, s35
  s_add_u32 s38, s38, 226492416
  s_add_u32 s41, s39, 2
  s_min_u32 s41, s41, 64
  s_lshl_b32 s36, s39, 10
  s_add_u32 s36, s36, 2162688
  buffer_load_dword v22, v226, s[20:23], s37 offen offset:0
  buffer_load_dword v23, v226, s[20:23], s37 offen offset:256
  buffer_load_dword v24, v226, s[20:23], s37 offen offset:512
  buffer_load_dword v25, v226, s[20:23], s37 offen offset:768
  buffer_load_dword v26, v226, s[20:23], s37 offen offset:1024
  s_mov_b32 s34, 0
pw_48:
  buffer_load_dword v93, v232, s[8:11], 0 offen sc1
  s_add_u32 s34, s34, 1
  s_cmp_gt_u32 s34, 65536
  s_cbranch_scc1 role_abort
  s_waitcnt vmcnt(0)
pc_50:
  v_cmp_gt_u32 vcc, s41, v93
  s_nop 0
  s_and_b32 vcc_lo, vcc_lo, 0xff
  s_and_b32 vcc_hi, vcc_hi, 0x0
  s_cmp_eq_u64 vcc, 0
  s_cbranch_scc1 po_49
  s_sleep 8
  s_branch pw_48
po_49:
  s_cmp_lt_u32 s39, 63
  s_cbranch_scc1 r_p0
  s_sleep 16
r_p0:
  s_mov_b32 s34, 0
r_poll:
  buffer_load_dwordx4 v[96:99], v229, s[8:11], s36 offen sc1
  s_add_u32 s34, s34, 1
  s_cmp_gt_u32 s34, 65536
  s_cbranch_scc1 role_abort
  s_waitcnt vmcnt(0)
  v_max3_u32 v90, v96, v97, v98
  v_max_u32 v90, v90, v99
  v_cmp_eq_u32 vcc, -1, v90
  s_nop 0
  s_and_b32 vcc_lo, vcc_lo, 0x1f1f1f1f
  s_and_b32 vcc_hi, vcc_hi, 0x1f1f1f1f
  s_cmp_eq_u64 vcc, 0
  s_cbranch_scc1 r_go
  s_sleep 4
  s_branch r_poll
r_go:
  buffer_load_dword v46, v226, s[8:11], s38 offen offset:0 sc1
  buffer_load_dword v47, v226, s[8:11], s38 offen offset:256 sc1
  buffer_load_dword v48, v226, s[8:11], s38 offen offset:512 sc1
  buffer_load_dword v49, v226, s[8:11], s38 offen offset:768 sc1
  buffer_load_dword v50, v226, s[8:11], s38 offen offset:1024 sc1
  s_add_u32 s38, s38, 40960
  buffer_load_dword v51, v226, s[8:11], s38 offen offset:0 sc1
  buffer_load_dword v52, v226, s[8:11], s38 offen offset:256 sc1
  buffer_load_dword v53, v226, s[8:11], s38 offen offset:512 sc1
  buffer_load_dword v54, v226, s[8:11], s38 offen offset:768 sc1
  buffer_load_dword v55, v226, s[8:11], s38 offen offset:1024 sc1
  s_add_u32 s38, s38, 40960
  buffer_load_dword v56, v226, s[8:11], s38 offen offset:0 sc1
  buffer_load_dword v57, v226, s[8:11], s38 offen offset:256 sc1
  buffer_load_dword v58, v226, s[8:11], s38 offen offset:512 sc1
  buffer_load_dword v59, v226, s[8:11], s38 offen offset:768 sc1
  buffer_load_dword v60, v226, s[8:11], s38 offen offset:1024 sc1
  s_add_u32 s38, s38, 40960
  buffer_load_dword v61, v226, s[8:11], s38 offen offset:0 sc1
  buffer_load_dword v62, v226, s[8:11], s38 offen offset:256 sc1
  buffer_load_dword v63, v226, s[8:11], s38 offen offset:512 sc1
  buffer_load_dword v64, v226, s[8:11], s38 offen offset:768 sc1
  buffer_load_dword v65, v226, s[8:11], s38 offen offset:1024 sc1
  s_add_u32 s38, s38, 40960
  buffer_load_dword v66, v226, s[8:11], s38 offen offset:0 sc1
  buffer_load_dword v67, v226, s[8:11], s38 offen offset:256 sc1
  buffer_load_dword v68, v226, s[8:11], s38 offen offset:512 sc1
  buffer_load_dword v69, v226, s[8:11], s38 offen offset:768 sc1
  buffer_load_dword v70, v226, s[8:11], s38 offen offset:1024 sc1
  s_add_u32 s38, s38, 40960
  buffer_load_dword v71, v226, s[8:11], s38 offen offset:0 sc1
  buffer_load_dword v72, v226, s[8:11], s38 offen offset:256 sc1
  buffer_load_dword v73, v226, s[8:11], s38 offen offset:512 sc1
  buffer_load_dword v74, v226, s[8:11], s38 offen offset:768 sc1
  buffer_load_dword v75, v226, s[8:11], s38 offen offset:1024 sc1
  s_add_u32 s38, s38, 40960
  buffer_load_dword v76, v226, s[8:11], s38 offen offset:0 sc1
  buffer_load_dword v77, v226, s[8:11], s38 offen offset:256 sc1
  buffer_load_dword v78, v226, s[8:11], s38 offen offset:512 sc1
  buffer_load_dword v79, v226, s[8:11], s38 offen offset:768 sc1
  buffer_load_dword v80, v226, s[8:11], s38 offen offset:1024 sc1
  s_add_u32 s38, s38, 40960
  buffer_load_dword v81, v226, s[8:11], s38 offen offset:0 sc1
  buffer_load_dword v82, v226, s[8:11], s38 offen offset:256 sc1
  buffer_load_dword v83, v226, s[8:11], s38 offen offset:512 sc1
  buffer_load_dword v84, v226, s[8:11], s38 offen offset:768 sc1
  buffer_load_dword v85, v226, s[8:11], s38 offen offset:1024 sc1
  s_add_u32 s38, s38, 40960
  v_lshlrev_b32 v2, 16, v22
  v_and_b32 v3, 0xffff0000, v22
  v_lshlrev_b32 v4, 16, v23
  v_and_b32 v5, 0xffff0000, v23
  v_lshlrev_b32 v6, 16, v24
  v_and_b32 v7, 0xffff0000, v24
  v_lshlrev_b32 v8, 16, v25
  v_and_b32 v9, 0xffff0000, v25
  v_lshlrev_b32 v10, 16, v26
  v_and_b32 v11, 0xffff0000, v26
  s_waitcnt vmcnt(35)
  v_lshlrev_b32 v12, 16, v46
  v_and_b32 v13, 0xffff0000, v46
  v_lshlrev_b32 v14, 16, v47
  v_and_b32 v15, 0xffff0000, v47
  v_lshlrev_b32 v16, 16, v48
  v_and_b32 v17, 0xffff0000, v48
  v_lshlrev_b32 v18, 16, v49
  v_and_b32 v19, 0xffff0000, v49
  v_lshlrev_b32 v20, 16, v50
  v_and_b32 v21, 0xffff0000, v50
  s_waitcnt vmcnt(30)
  v_dot2c_f32_bf16 v12, v51, v230
  v_dot2c_f32_bf16 v13, v51, v231
  v_dot2c_f32_bf16 v14, v52, v230
  v_dot2c_f32_bf16 v15, v52, v231
  v_dot2c_f32_bf16 v16, v53, v230
  v_dot2c_f32_bf16 v17, v53, v231
  v_dot2c_f32_bf16 v18, v54, v230
  v_dot2c_f32_bf16 v19, v54, v231
  v_dot2c_f32_bf16 v20, v55, v230
  v_dot2c_f32_bf16 v21, v55, v231
  s_waitcnt vmcnt(25)
  v_dot2c_f32_bf16 v12, v56, v230
  v_dot2c_f32_bf16 v13, v56, v231
  v_dot2c_f32_bf16 v14, v57, v230
  v_dot2c_f32_bf16 v15, v57, v231
  v_dot2c_f32_bf16 v16, v58, v230
  v_dot2c_f32_bf16 v17, v58, v231
  v_dot2c_f32_bf16 v18, v59, v230
  v_dot2c_f32_bf16 v19, v59, v231
  v_dot2c_f32_bf16 v20, v60, v230
  v_dot2c_f32_bf16 v21, v60, v231
  s_waitcnt vmcnt(20)
  v_dot2c_f32_bf16 v12, v61, v230
  v_dot2c_f32_bf16 v13, v61, v231
  v_dot2c_f32_bf16 v14, v62, v230
  v_dot2c_f32_bf16 v15, v62, v231
  v_dot2c_f32_bf16 v16, v63, v230
  v_dot2c_f32_bf16 v17, v63, v231
  v_dot2c_f32_bf16 v18, v64, v230
  v_dot2c_f32_bf16 v19, v64, v231
  v_dot2c_f32_bf16 v20, v65, v230
  v_dot2c_f32_bf16 v21, v65, v231
  s_waitcnt vmcnt(15)
  v_dot2c_f32_bf16 v12, v66, v230
  v_dot2c_f32_bf16 v13, v66, v231
  v_dot2c_f32_bf16 v14, v67, v230
  v_dot2c_f32_bf16 v15, v67, v231
  v_dot2c_f32_bf16 v16, v68, v230
  v_dot2c_f32_bf16 v17, v68, v231
  v_dot2c_f32_bf16 v18, v69, v230
  v_dot2c_f32_bf16 v19, v69, v231
  v_dot2c_f32_bf16 v20, v70, v230
  v_dot2c_f32_bf16 v21, v70, v231
  s_waitcnt vmcnt(10)
  v_dot2c_f32_bf16 v12, v71, v230
  v_dot2c_f32_bf16 v13, v71, v231
  v_dot2c_f32_bf16 v14, v72, v230
  v_dot2c_f32_bf16 v15, v72, v231
  v_dot2c_f32_bf16 v16, v73, v230
  v_dot2c_f32_bf16 v17, v73, v231
  v_dot2c_f32_bf16 v18, v74, v230
  v_dot2c_f32_bf16 v19, v74, v231
  v_dot2c_f32_bf16 v20, v75, v230
  v_dot2c_f32_bf16 v21, v75, v231
  s_waitcnt vmcnt(5)
  v_dot2c_f32_bf16 v12, v76, v230
  v_dot2c_f32_bf16 v13, v76, v231
  v_dot2c_f32_bf16 v14, v77, v230
  v_dot2c_f32_bf16 v15, v77, v231
  v_dot2c_f32_bf16 v16, v78, v230
  v_dot2c_f32_bf16 v17, v78, v231
  v_dot2c_f32_bf16 v18, v79, v230
  v_dot2c_f32_bf16 v19, v79, v231
  v_dot2c_f32_bf16 v20, v80, v230
  v_dot2c_f32_bf16 v21, v80, v231
  s_waitcnt vmcnt(0)
  v_dot2c_f32_bf16 v12, v81, v230
  v_dot2c_f32_bf16 v13, v81, v231
  v_dot2c_f32_bf16 v14, v82, v230
  v_dot2c_f32_bf16 v15, v82, v231
  v_dot2c_f32_bf16 v16, v83, v230
  v_dot2c_f32_bf16 v17, v83, v231
  v_dot2c_f32_bf16 v18, v84, v230
  v_dot2c_f32_bf16 v19, v84, v231
  v_dot2c_f32_bf16 v20, v85, v230
  v_dot2c_f32_bf16 v21, v85, v231
  v_cvt_pk_bf16_f32 v90, v12, v13
  v_lshlrev_b32 v12, 16, v90
  v_and_b32 v13, 0xffff0000, v90
  v_cvt_pk_bf16_f32 v90, v14, v15
  v_lshlrev_b32 v14, 16, v90
  v_and_b32 v15, 0xffff0000, v90
  v_cvt_pk_bf16_f32 v90, v16, v17
  v_lshlrev_b32 v16, 16, v90
  v_and_b32 v17, 0xffff0000, v90
  v_cvt_pk_bf16_f32 v90, v18, v19
  v_lshlrev_b32 v18, 16, v90
  v_and_b32 v19, 0xffff0000, v90
  v_cvt_pk_bf16_f32 v90, v20, v21
  v_lshlrev_b32 v20, 16, v90
  v_and_b32 v21, 0xffff0000, v90
  v_pk_mul_f32 v[12:13], v[12:13], v[196:197]
  v_cvt_pk_bf16_f32 v90, v12, v13
  v_lshlrev_b32 v12, 16, v90
  v_and_b32 v13, 0xffff0000, v90
  v_pk_mul_f32 v[14:15], v[14:15], v[198:199]
  v_cvt_pk_bf16_f32 v90, v14, v15
  v_lshlrev_b32 v14, 16, v90
  v_and_b32 v15, 0xffff0000, v90
  v_pk_mul_f32 v[16:17], v[16:17], v[200:201]
  v_cvt_pk_bf16_f32 v90, v16, v17
  v_lshlrev_b32 v16, 16, v90
  v_and_b32 v17, 0xffff0000, v90
  v_pk_mul_f32 v[18:19], v[18:19], v[202:203]
  v_cvt_pk_bf16_f32 v90, v18, v19
  v_lshlrev_b32 v18, 16, v90
  v_and_b32 v19, 0xffff0000, v90
  v_pk_mul_f32 v[20:21], v[20:21], v[204:205]
  v_cvt_pk_bf16_f32 v90, v20, v21
  v_lshlrev_b32 v20, 16, v90
  v_and_b32 v21, 0xffff0000, v90
  v_pk_add_f32 v[2:3], v[2:3], v[12:13]
  v_cvt_pk_bf16_f32 v34, v2, v3
  v_lshlrev_b32 v2, 16, v34
  v_and_b32 v3, 0xffff0000, v34
  v_pk_add_f32 v[4:5], v[4:5], v[14:15]
  v_cvt_pk_bf16_f32 v35, v4, v5
  v_lshlrev_b32 v4, 16, v35
  v_and_b32 v5, 0xffff0000, v35
  v_pk_add_f32 v[6:7], v[6:7], v[16:17]
  v_cvt_pk_bf16_f32 v36, v6, v7
  v_lshlrev_b32 v6, 16, v36
  v_and_b32 v7, 0xffff0000, v36
  v_pk_add_f32 v[8:9], v[8:9], v[18:19]
  v_cvt_pk_bf16_f32 v37, v8, v9
  v_lshlrev_b32 v8, 16, v37
  v_and_b32 v9, 0xffff0000, v37
  v_pk_add_f32 v[10:11], v[10:11], v[20:21]
  v_cvt_pk_bf16_f32 v38, v10, v11
  v_lshlrev_b32 v10, 16, v38
  v_and_b32 v11, 0xffff0000, v38
  s_add_u32 s35, s37, 5242880
  buffer_store_dword v34, v226, s[8:11], s35 offen offset:0 sc1
  buffer_store_dword v35, v226, s[8:11], s35 offen offset:256 sc1
  buffer_store_dword v36, v226, s[8:11], s35 offen offset:512 sc1
  buffer_store_dword v37, v226, s[8:11], s35 offen offset:768 sc1
  buffer_store_dword v38, v226, s[8:11], s35 offen offset:1024 sc1
  v_pk_add_f32 v[86:87], v[2:3], v[4:5]
  v_pk_add_f32 v[88:89], v[6:7], v[8:9]
  v_pk_add_f32 v[86:87], v[86:87], v[10:11]
  v_pk_add_f32 v[86:87], v[86:87], v[88:89]
  v_add_f32 v86, v86, v87
  s_nop 1
  v_add_f32_dpp v86, v86, v86 row_ror:8 row_mask:0xf bank_mask:0xf
  s_nop 1
  v_add_f32_dpp v86, v86, v86 row_ror:4 row_mask:0xf bank_mask:0xf
  s_nop 1
  v_add_f32_dpp v86, v86, v86 row_ror:2 row_mask:0xf bank_mask:0xf
  s_nop 1
  v_add_f32_dpp v86, v86, v86 row_ror:1 row_mask:0xf bank_mask:0xf
  v_mov_b32 v90, v86
  s_nop 1
  v_permlane16_swap_b32 v86, v90
  v_add_f32 v86, v86, v90
  v_mov_b32 v90, v86
  s_nop 1
  v_permlane32_swap_b32 v86, v90
  v_add_f32 v86, v86, v90
  v_mul_f32 v88, 0xbacccccd, v86
  v_mul_f32 v89, 0xbacccccd, v86
  v_pk_add_f32 v[12:13], v[2:3], v[88:89]
  v_pk_add_f32 v[14:15], v[4:5], v[88:89]
  v_pk_add_f32 v[16:17], v[6:7], v[88:89]
  v_pk_add_f32 v[18:19], v[8:9], v[88:89]
  v_pk_add_f32 v[20:21], v[10:11], v[88:89]
  v_pk_mul_f32 v[86:87], v[12:13], v[12:13]
  v_pk_fma_f32 v[86:87], v[14:15], v[14:15], v[86:87]
  v_pk_fma_f32 v[86:87], v[16:17], v[16:17], v[86:87]
  v_pk_fma_f32 v[86:87], v[18:19], v[18:19], v[86:87]
  v_pk_fma_f32 v[86:87], v[20:21], v[20:21], v[86:87]
  v_add_f32 v86, v86, v87
  v_cvt_pk_bf16_f32 v91, v88, v89
  v_lshlrev_b32 v88, 16, v91
  v_and_b32 v89, 0xffff0000, v91
  v_add_f32_dpp v86, v86, v86 row_ror:8 row_mask:0xf bank_mask:0xf
  s_nop 1
  v_add_f32_dpp v86, v86, v86 row_ror:4 row_mask:0xf bank_mask:0xf
  s_nop 1
  v_add_f32_dpp v86, v86, v86 row_ror:2 row_mask:0xf bank_mask:0xf
  s_nop 1
  v_add_f32_dpp v86, v86, v86 row_ror:1 row_mask:0xf bank_mask:0xf
  v_mov_b32 v90, v86
  s_nop 1
  v_permlane16_swap_b32 v86, v90
  v_add_f32 v86, v86, v90
  v_mov_b32 v90, v86
  s_nop 1
  v_permlane32_swap_b32 v86, v90
  v_add_f32 v86, v86, v90
  v_pk_add_f32 v[12:13], v[2:3], v[88:89]
  v_pk_add_f32 v[14:15], v[4:5], v[88:89]
  v_pk_add_f32 v[16:17], v[6:7], v[88:89]
  v_pk_add_f32 v[18:19], v[8:9], v[88:89]
  v_pk_add_f32 v[20:21], v[10:11], v[88:89]
  v_mul_f32 v86, 0x3acccccd, v86
  v_cvt_pk_bf16_f32 v86, v86, v86
  v_lshlrev_b32 v86, 16, v86
  v_add_f32 v86, 0x3727c5ac, v86
  v_cvt_pk_bf16_f32 v86, v86, v86
  v_lshlrev_b32 v86, 16, v86
  v_sqrt_f32 v86, v86
  v_cvt_pk_bf16_f32 v90, v12, v13
  v_lshlrev_b32 v12, 16, v90
  v_and_b32 v13, 0xffff0000, v90
  v_cvt_pk_bf16_f32 v86, v86, v86
  v_lshlrev_b32 v86, 16, v86
  v_rcp_f32 v86, v86
  v_cvt_pk_bf16_f32 v90, v14, v15
  v_lshlrev_b32 v14, 16, v90
  v_and_b32 v15, 0xffff0000, v90
  v_cvt_pk_bf16_f32 v90, v16, v17
  v_lshlrev_b32 v16, 16, v90
  v_and_b32 v17, 0xffff0000, v90
  v_cvt_pk_bf16_f32 v90, v18, v19
  v_lshlrev_b32 v18, 16, v90
  v_and_b32 v19, 0xffff0000, v90
  v_cvt_pk_bf16_f32 v90, v20, v21
  v_lshlrev_b32 v20, 16, v90
  v_and_b32 v21, 0xffff0000, v90
  v_mov_b32 v87, v86
  v_pk_mul_f32 v[12:13], v[12:13], v[86:87]
  v_cvt_pk_bf16_f32 v90, v12, v13
  v_lshlrev_b32 v12, 16, v90
  v_and_b32 v13, 0xffff0000, v90
  v_pk_mul_f32 v[14:15], v[14:15], v[86:87]
  v_cvt_pk_bf16_f32 v90, v14, v15
  v_lshlrev_b32 v14, 16, v90
  v_and_b32 v15, 0xffff0000, v90
  v_pk_mul_f32 v[16:17], v[16:17], v[86:87]
  v_cvt_pk_bf16_f32 v90, v16, v17
  v_lshlrev_b32 v16, 16, v90
  v_and_b32 v17, 0xffff0000, v90
  v_pk_mul_f32 v[18:19], v[18:19], v[86:87]
  v_cvt_pk_bf16_f32 v90, v18, v19
  v_lshlrev_b32 v18, 16, v90
  v_and_b32 v19, 0xffff0000, v90
  v_pk_mul_f32 v[20:21], v[20:21], v[86:87]
  v_cvt_pk_bf16_f32 v90, v20, v21
  v_lshlrev_b32 v20, 16, v90
  v_and_b32 v21, 0xffff0000, v90
  v_pk_mul_f32 v[12:13], v[12:13], v[176:177]
  v_cvt_pk_bf16_f32 v90, v12, v13
  v_lshlrev_b32 v12, 16, v90
  v_and_b32 v13, 0xffff0000, v90
  v_pk_mul_f32 v[14:15], v[14:15], v[178:179]
  v_cvt_pk_bf16_f32 v90, v14, v15
  v_lshlrev_b32 v14, 16, v90
  v_and_b32 v15, 0xffff0000, v90
  v_pk_mul_f32 v[16:17], v[16:17], v[180:181]
  v_cvt_pk_bf16_f32 v90, v16, v17
  v_lshlrev_b32 v16, 16, v90
  v_and_b32 v17, 0xffff0000, v90
  v_pk_mul_f32 v[18:19], v[18:19], v[182:183]
  v_cvt_pk_bf16_f32 v90, v18, v19
  v_lshlrev_b32 v18, 16, v90
  v_and_b32 v19, 0xffff0000, v90
  v_pk_mul_f32 v[20:21], v[20:21], v[184:185]
  v_cvt_pk_bf16_f32 v90, v20, v21
  v_lshlrev_b32 v20, 16, v90
  v_and_b32 v21, 0xffff0000, v90
  v_pk_add_f32 v[12:13], v[12:13], v[186:187]
  v_cvt_pk_bf16_f32 v28, v12, v13
  v_pk_add_f32 v[14:15], v[14:15], v[188:189]
  v_cvt_pk_bf16_f32 v29, v14, v15
  v_pk_add_f32 v[16:17], v[16:17], v[190:191]
  v_cvt_pk_bf16_f32 v30, v16, v17
  v_pk_add_f32 v[18:19], v[18:19], v[192:193]
  v_cvt_pk_bf16_f32 v31, v18, v19
  v_pk_add_f32 v[20:21], v[20:21], v[194:195]
  v_cvt_pk_bf16_f32 v32, v20, v21
  s_add_u32 s35, s37, 8388608
  buffer_store_dword v28, v226, s[8:11], s35 offen offset:0 sc1
  buffer_store_dword v29, v226, s[8:11], s35 offen offset:256 sc1
  buffer_store_dword v30, v226, s[8:11], s35 offen offset:512 sc1
  buffer_store_dword v31, v226, s[8:11], s35 offen offset:768 sc1
  buffer_store_dword v32, v226, s[8:11], s35 offen offset:1024 sc1
  v_lshlrev_b32 v12, 16, v28
  v_and_b32 v13, 0xffff0000, v28
  v_lshlrev_b32 v14, 16, v29
  v_and_b32 v15, 0xffff0000, v29
  v_lshlrev_b32 v16, 16, v30
  v_and_b32 v17, 0xffff0000, v30
  v_lshlrev_b32 v18, 16, v31
  v_and_b32 v19, 0xffff0000, v31
  v_lshlrev_b32 v20, 16, v32
  v_and_b32 v21, 0xffff0000, v32
  v_pk_mul_f32 v[86:87], v[12:13], v[216:217]
  v_pk_fma_f32 v[86:87], v[14:15], v[218:219], v[86:87]
  v_pk_fma_f32 v[86:87], v[16:17], v[220:221], v[86:87]
  v_pk_fma_f32 v[86:87], v[18:19], v[222:223], v[86:87]
  v_pk_fma_f32 v[86:87], v[20:21], v[224:225], v[86:87]
  v_add_f32 v86, v86, v87
  v_pk_mul_f32 v[12:13], v[12:13], v[206:207]
  v_cvt_pk_bf16_f32 v90, v12, v13
  v_lshlrev_b32 v12, 16, v90
  v_and_b32 v13, 0xffff0000, v90
  v_pk_mul_f32 v[14:15], v[14:15], v[208:209]
  v_cvt_pk_bf16_f32 v90, v14, v15
  v_lshlrev_b32 v14, 16, v90
  v_and_b32 v15, 0xffff0000, v90
  v_pk_mul_f32 v[16:17], v[16:17], v[210:211]
  v_cvt_pk_bf16_f32 v90, v16, v17
  v_lshlrev_b32 v16, 16, v90
  v_and_b32 v17, 0xffff0000, v90
  v_pk_mul_f32 v[18:19], v[18:19], v[212:213]
  v_cvt_pk_bf16_f32 v90, v18, v19
  v_lshlrev_b32 v18, 16, v90
  v_and_b32 v19, 0xffff0000, v90
  v_pk_mul_f32 v[20:21], v[20:21], v[214:215]
  v_cvt_pk_bf16_f32 v90, v20, v21
  v_lshlrev_b32 v20, 16, v90
  v_and_b32 v21, 0xffff0000, v90
  v_pk_add_f32 v[12:13], v[12:13], v[2:3]
  v_cvt_pk_bf16_f32 v40, v12, v13
  v_pk_add_f32 v[14:15], v[14:15], v[4:5]
  v_cvt_pk_bf16_f32 v41, v14, v15
  v_pk_add_f32 v[16:17], v[16:17], v[6:7]
  v_cvt_pk_bf16_f32 v42, v16, v17
  v_pk_add_f32 v[18:19], v[18:19], v[8:9]
  v_cvt_pk_bf16_f32 v43, v18, v19
  v_pk_add_f32 v[20:21], v[20:21], v[10:11]
  v_cvt_pk_bf16_f32 v44, v20, v21
  buffer_store_dword v40, v226, s[24:27], s37 offen offset:0 sc1
  buffer_store_dword v41, v226, s[24:27], s37 offen offset:256 sc1
  buffer_store_dword v42, v226, s[24:27], s37 offen offset:512 sc1
  buffer_store_dword v43, v226, s[24:27], s37 offen offset:768 sc1
  buffer_store_dword v44, v226, s[24:27], s37 offen offset:1024 sc1
  v_add_f32_dpp v86, v86, v86 row_ror:8 row_mask:0xf bank_mask:0xf
  s_nop 1
  v_add_f32_dpp v86, v86, v86 row_ror:4 row_mask:0xf bank_mask:0xf
  s_nop 1
  v_add_f32_dpp v86, v86, v86 row_ror:2 row_mask:0xf bank_mask:0xf
  s_nop 1
  v_add_f32_dpp v86, v86, v86 row_ror:1 row_mask:0xf bank_mask:0xf
  v_mov_b32 v90, v86
  s_nop 1
  v_permlane16_swap_b32 v86, v90
  v_add_f32 v86, v86, v90
  v_mov_b32 v90, v86
  s_nop 1
  v_permlane32_swap_b32 v86, v90
  v_add_f32 v86, v86, v90
  v_cvt_pk_bf16_f32 v86, v86, v86
  v_lshlrev_b32 v86, 16, v86
  v_ashrrev_i32 v90, 31, v86
  v_or_b32 v90, 0x80000000, v90
  v_xor_b32 v86, v86, v90
  v_and_b32 v86, 0xffff0000, v86
  s_sub_u32 s35, 2047, s40
  v_or_b32 v86, s35, v86
  s_lshr_b32 s35, s40, 2
  s_lshl_b32 s35, s35, 7
  s_lshl_b32 s36, s17, 2
  s_add_u32 s35, s35, s36
  s_add_u32 s35, s35, 2097152
  v_mov_b32 v91, s35
  s_waitcnt vmcnt(0)
  s_mov_b64 exec, 1
  buffer_store_dword v86, v91, s[8:11], 0 offen sc1
  s_mov_b64 exec, -1
  s_cmp_eq_u32 s18, 31
  s_cbranch_scc1 r_nc
  s_lshr_b32 s53, s33, 3
  s_lshl_b32 s53, s53, 1
  s_sub_u32 s53, s53, 1
mc_51_chunk:
  s_cmp_ge_i32 s74, s53
  s_cbranch_scc1 mc_51_done
  s_mov_b32 s69, 0
mc_51_kp:
  buffer_load_dword v235, v234, s[8:11], s75 offen sc1
  s_add_u32 s69, s69, 1
  s_cmp_gt_u32 s69, 65536
  s_cbranch_scc1 role_abort
  s_waitcnt vmcnt(0)
  v_cmp_eq_u32 vcc, -1, v235
  s_cbranch_vccz mc_51_ins
  s_sleep 4
  s_branch mc_51_kp
mc_51_ins:
  v_cmp_lt_u32 vcc, s86, v235
  s_cbranch_vccz mc_51_nx
  s_ff1_i32_b64 s70, vcc
  v_readlane_b32 s76, v235, s70
  v_writelane_b32 v235, 0, s70
  s_min_u32 s77, s79, s76
  s_max_u32 s79, s79, s76
  s_min_u32 s76, s80, s77
  s_max_u32 s80, s80, s77
  s_min_u32 s77, s81, s76
  s_max_u32 s81, s81, s76
  s_min_u32 s76, s82, s77
  s_max_u32 s82, s82, s77
  s_min_u32 s77, s83, s76
  s_max_u32 s83, s83, s76
  s_min_u32 s76, s84, s77
  s_max_u32 s84, s84, s77
  s_min_u32 s77, s85, s76
  s_max_u32 s85, s85, s76
  s_min_u32 s76, s86, s77
  s_max_u32 s86, s86, s77
  s_branch mc_51_ins
mc_51_nx:
  s_add_u32 s75, s75, 2048
  s_add_u32 s74, s74, 1
  s_branch mc_51_chunk
mc_51_done:
r_nc:
  s_add_u32 s33, s33, 8
  s_cmp_lt_u32 s33, 128
  s_cbranch_scc1 r_loop
  s_cmp_eq_u32 s18, 31
  s_cbranch_scc1 moe_end
mc_52_chunk:
  s_cmp_ge_i32 s74, 30
  s_cbranch_scc1 mc_52_done
  s_mov_b32 s69, 0
mc_52_kp:
  buffer_load_dword v235, v234, s[8:11], s75 offen sc1
  s_add_u32 s69, s69, 1
  s_cmp_gt_u32 s69, 65536
  s_cbranch_scc1 role_abort
  s_waitcnt vmcnt(0)
  v_cmp_eq_u32 vcc, -1, v235
  s_cbranch_vccz mc_52_ins
  s_sleep 4
  s_branch mc_52_kp
mc_52_ins:
  v_cmp_lt_u32 vcc, s86, v235
  s_cbranch_vccz mc_52_nx
  s_ff1_i32_b64 s70, vcc
  v_readlane_b32 s76, v235, s70
  v_writelane_b32 v235, 0, s70
  s_min_u32 s77, s79, s76
  s_max_u32 s79, s79, s76
  s_min_u32 s76, s80, s77
  s_max_u32 s80, s80, s77
  s_min_u32 s77, s81, s76
  s_max_u32 s81, s81, s76
  s_min_u32 s76, s82, s77
  s_max_u32 s82, s82, s77
  s_min_u32 s77, s83, s76
  s_max_u32 s83, s83, s76
  s_min_u32 s76, s84, s77
  s_max_u32 s84, s84, s77
  s_min_u32 s77, s85, s76
  s_max_u32 s85, s85, s76
  s_min_u32 s76, s86, s77
  s_max_u32 s86, s86, s77
  s_branch mc_52_ins
mc_52_nx:
  s_add_u32 s75, s75, 2048
  s_add_u32 s74, s74, 1
  s_branch mc_52_chunk
mc_52_done:
  s_mov_b32 s41, 64
  s_mov_b32 s34, 0
pw_53:
  buffer_load_dword v93, v232, s[8:11], 0 offen sc1
  s_add_u32 s34, s34, 1
  s_cmp_gt_u32 s34, 65536
  s_cbranch_scc1 role_abort
  s_waitcnt vmcnt(0)
pc_55:
  v_cmp_gt_u32 vcc, s41, v93
  s_nop 0
  s_and_b32 vcc_lo, vcc_lo, 0xff
  s_and_b32 vcc_hi, vcc_hi, 0x0
  s_cmp_eq_u64 vcc, 0
  s_cbranch_scc1 po_54
  s_sleep 4
  s_branch pw_53
po_54:
mc_56_chunk:
  s_cmp_ge_i32 s74, 31
  s_cbranch_scc1 mc_56_done
  s_mov_b32 s69, 0
mc_56_kp:
  buffer_load_dword v235, v234, s[8:11], s75 offen sc1
  s_add_u32 s69, s69, 1
  s_cmp_gt_u32 s69, 65536
  s_cbranch_scc1 role_abort
  s_waitcnt vmcnt(0)
  v_cmp_eq_u32 vcc, -1, v235
  s_cbranch_vccz mc_56_ins
  s_sleep 4
  s_branch mc_56_kp
mc_56_ins:
  v_cmp_lt_u32 vcc, s86, v235
  s_cbranch_vccz mc_56_nx
  s_ff1_i32_b64 s70, vcc
  v_readlane_b32 s76, v235, s70
  v_writelane_b32 v235, 0, s70
  s_min_u32 s77, s79, s76
  s_max_u32 s79, s79, s76
  s_min_u32 s76, s80, s77
  s_max_u32 s80, s80, s77
  s_min_u32 s77, s81, s76
  s_max_u32 s81, s81, s76
  s_min_u32 s76, s82, s77
  s_max_u32 s82, s82, s77
  s_min_u32 s77, s83, s76
  s_max_u32 s83, s83, s76
  s_min_u32 s76, s84, s77
  s_max_u32 s84, s84, s77
  s_min_u32 s77, s85, s76
  s_max_u32 s85, s85, s76
  s_min_u32 s76, s86, s77
  s_max_u32 s86, s86, s77
  s_branch mc_56_ins
mc_56_nx:
  s_add_u32 s75, s75, 2048
  s_add_u32 s74, s74, 1
  s_branch mc_56_chunk
mc_56_done:
  s_cmp_ge_u32 s16, 4
  s_cbranch_scc1 r_c31
  s_sleep 32
r_c31:
mc_57_chunk:
  s_cmp_ge_i32 s74, 32
  s_cbranch_scc1 mc_57_done
  s_mov_b32 s69, 0
mc_57_kp:
  buffer_load_dword v235, v234, s[8:11], s75 offen sc1
  s_add_u32 s69, s69, 1
  s_cmp_gt_u32 s69, 65536
  s_cbranch_scc1 role_abort
  s_waitcnt vmcnt(0)
  v_cmp_eq_u32 vcc, -1, v235
  s_cbranch_vccz mc_57_ins
  s_sleep 4
  s_branch mc_57_kp
mc_57_ins:
  v_cmp_lt_u32 vcc, s86, v235
  s_cbranch_vccz mc_57_nx
  s_ff1_i32_b64 s70, vcc
  v_readlane_b32 s76, v235, s70
  v_writelane_b32 v235, 0, s70
  s_min_u32 s77, s79, s76
  s_max_u32 s79, s79, s76
  s_min_u32 s76, s80, s77
  s_max_u32 s80, s80, s77
  s_min_u32 s77, s81, s76
  s_max_u32 s81, s81, s76
  s_min_u32 s76, s82, s77
  s_max_u32 s82, s82, s77
  s_min_u32 s77, s83, s76
  s_max_u32 s83, s83, s76
  s_min_u32 s76, s84, s77
  s_max_u32 s84, s84, s77
  s_min_u32 s77, s85, s76
  s_max_u32 s85, s85, s76
  s_min_u32 s76, s86, s77
  s_max_u32 s86, s86, s77
  s_branch mc_57_ins
mc_57_nx:
  s_add_u32 s75, s75, 2048
  s_add_u32 s74, s74, 1
  s_branch mc_57_chunk
mc_57_done:
  s_mov_b32 exec_lo, 0x1010101
  s_mov_b32 exec_hi, 0x1010101
  v_mov_b32 v120, s79
  s_mov_b32 exec_lo, 0x2020202
  s_mov_b32 exec_hi, 0x2020202
  v_mov_b32 v120, s80
  s_mov_b32 exec_lo, 0x4040404
  s_mov_b32 exec_hi, 0x4040404
  v_mov_b32 v120, s81
  s_mov_b32 exec_lo, 0x8080808
  s_mov_b32 exec_hi, 0x8080808
  v_mov_b32 v120, s82
  s_mov_b32 exec_lo, 0x10101010
  s_mov_b32 exec_hi, 0x10101010
  v_mov_b32 v120, s83
  s_mov_b32 exec_lo, 0x20202020
  s_mov_b32 exec_hi, 0x20202020
  v_mov_b32 v120, s84
  s_mov_b32 exec_lo, 0x40404040
  s_mov_b32 exec_hi, 0x40404040
  v_mov_b32 v120, s85
  s_mov_b32 exec_lo, 0x80808080
  s_mov_b32 exec_hi, 0x80808080
  v_mov_b32 v120, s86
  s_mov_b64 exec, -1
  v_and_b32 v124, 0x7ff, v120
  v_sub_u32 v124, 2047, v124
  v_mul_u32_u24 v122, 1280, v124
  v_lshrrev_b32 v125, 4, v1
  v_lshl_add_u32 v121, v125, 4, v122
  s_mul_i32 s70, s17, 320
  s_add_u32 s70, s70, 8388608
  buffer_load_dwordx4 v[4:7], v121, s[8:11], s70 offen offset:0 sc1
  buffer_load_dwordx4 v[8:11], v121, s[8:11], s70 offen offset:64 sc1
  buffer_load_dwordx4 v[12:15], v121, s[8:11], s70 offen offset:128 sc1
  buffer_load_dwordx4 v[16:19], v121, s[8:11], s70 offen offset:192 sc1
  buffer_load_dwordx4 v[20:23], v121, s[8:11], s70 offen offset:256 sc1
  v_bfe_u32 v125, v1, 3, 2
  s_min_u32 s72, s78, 39
  s_lshl_b32 s71, s72, 5
  v_lshl_add_u32 v126, v125, 3, s71
  v_add_u32 v122, v122, v126
  v_lshlrev_b32 v126, 1, v126
  s_mov_b32 s70, 5242880
  s_mov_b32 s71, 8388608
  s_mov_b32 s76, 78336
  buffer_load_dwordx2 v[128:129], v122, s[8:11], s70 offen sc1
  buffer_load_dwordx2 v[130:131], v122, s[8:11], s71 offen sc1
  buffer_load_dwordx4 v[132:135], v126, s[8:11], s76 offen sc1
  v_and_b32 v124, 0xffff0000, v120
  v_ashrrev_i32 v125, 31, v124
  v_not_b32 v125, v125
  v_or_b32 v125, 0x80000000, v125
  v_and_b32 v125, 0xffff0000, v125
  v_xor_b32 v124, v124, v125
  v_mul_f32 v124, 0xbfb8aa3b, v124
  v_exp_f32 v124, v124
  s_nop 0
  v_add_f32 v124, 1.0, v124
  v_rcp_f32 v124, v124
  s_nop 0
  v_cvt_pk_bf16_f32 v124, v124, v124
  v_lshlrev_b32 v123, 16, v124
  s_lshl_b32 s70, s17, 13
  v_add_u32 v126, s70, v233
  s_lshl_b32 s70, s17, 10
  v_add_u32 v127, s70, v233
  s_waitcnt vmcnt(7)
  v_mfma_f32_16x16x32_bf16 v[24:27], a[0:3], v[4:7], 0
  v_mfma_f32_16x16x32_bf16 v[28:31], a[20:23], v[4:7], 0
  v_mfma_f32_16x16x32_bf16 v[32:35], a[40:43], v[4:7], 0
  v_mfma_f32_16x16x32_bf16 v[36:39], a[60:63], v[4:7], 0
  v_mfma_f32_16x16x32_bf16 v[40:43], a[80:83], v[4:7], 0
  v_mfma_f32_16x16x32_bf16 v[44:47], a[100:103], v[4:7], 0
  v_mfma_f32_16x16x32_bf16 v[48:51], a[120:123], v[4:7], 0
  v_mfma_f32_16x16x32_bf16 v[52:55], a[140:143], v[4:7], 0
  s_waitcnt vmcnt(6)
  v_mfma_f32_16x16x32_bf16 v[24:27], a[4:7], v[8:11], v[24:27]
  v_mfma_f32_16x16x32_bf16 v[28:31], a[24:27], v[8:11], v[28:31]
  v_mfma_f32_16x16x32_bf16 v[32:35], a[44:47], v[8:11], v[32:35]
  v_mfma_f32_16x16x32_bf16 v[36:39], a[64:67], v[8:11], v[36:39]
  v_mfma_f32_16x16x32_bf16 v[40:43], a[84:87], v[8:11], v[40:43]
  v_mfma_f32_16x16x32_bf16 v[44:47], a[104:107], v[8:11], v[44:47]
  v_mfma_f32_16x16x32_bf16 v[48:51], a[124:127], v[8:11], v[48:51]
  v_mfma_f32_16x16x32_bf16 v[52:55], a[144:147], v[8:11], v[52:55]
  s_waitcnt vmcnt(5)
  v_mfma_f32_16x16x32_bf16 v[24:27], a[8:11], v[12:15], v[24:27]
  v_mfma_f32_16x16x32_bf16 v[28:31], a[28:31], v[12:15], v[28:31]
  v_mfma_f32_16x16x32_bf16 v[32:35], a[48:51], v[12:15], v[32:35]
  v_mfma_f32_16x16x32_bf16 v[36:39], a[68:71], v[12:15], v[36:39]
  v_mfma_f32_16x16x32_bf16 v[40:43], a[88:91], v[12:15], v[40:43]
  v_mfma_f32_16x16x32_bf16 v[44:47], a[108:111], v[12:15], v[44:47]
  v_mfma_f32_16x16x32_bf16 v[48:51], a[128:131], v[12:15], v[48:51]
  v_mfma_f32_16x16x32_bf16 v[52:55], a[148:151], v[12:15], v[52:55]
  s_waitcnt vmcnt(4)
  v_mfma_f32_16x16x32_bf16 v[24:27], a[12:15], v[16:19], v[24:27]
  v_mfma_f32_16x16x32_bf16 v[28:31], a[32:35], v[16:19], v[28:31]
  v_mfma_f32_16x16x32_bf16 v[32:35], a[52:55], v[16:19], v[32:35]
  v_mfma_f32_16x16x32_bf16 v[36:39], a[72:75], v[16:19], v[36:39]
  v_mfma_f32_16x16x32_bf16 v[40:43], a[92:95], v[16:19], v[40:43]
  v_mfma_f32_16x16x32_bf16 v[44:47], a[112:115], v[16:19], v[44:47]
  v_mfma_f32_16x16x32_bf16 v[48:51], a[132:135], v[16:19], v[48:51]
  v_mfma_f32_16x16x32_bf16 v[52:55], a[152:155], v[16:19], v[52:55]
  s_waitcnt vmcnt(3)
  v_mfma_f32_16x16x32_bf16 v[24:27], a[16:19], v[20:23], v[24:27]
  v_mfma_f32_16x16x32_bf16 v[28:31], a[36:39], v[20:23], v[28:31]
  v_mfma_f32_16x16x32_bf16 v[32:35], a[56:59], v[20:23], v[32:35]
  v_mfma_f32_16x16x32_bf16 v[36:39], a[76:79], v[20:23], v[36:39]
  v_mfma_f32_16x16x32_bf16 v[40:43], a[96:99], v[20:23], v[40:43]
  v_mfma_f32_16x16x32_bf16 v[44:47], a[116:119], v[20:23], v[44:47]
  v_mfma_f32_16x16x32_bf16 v[48:51], a[136:139], v[20:23], v[48:51]
  v_mfma_f32_16x16x32_bf16 v[52:55], a[156:159], v[20:23], v[52:55]
  s_nop 0
  ds_write_b128 v126, v[24:27] offset:0
  ds_write_b128 v126, v[28:31] offset:1024
  ds_write_b128 v126, v[32:35] offset:2048
  ds_write_b128 v126, v[36:39] offset:3072
  ds_write_b128 v126, v[40:43] offset:4096
  ds_write_b128 v126, v[44:47] offset:5120
  ds_write_b128 v126, v[48:51] offset:6144
  ds_write_b128 v126, v[52:55] offset:7168
  s_waitcnt lgkmcnt(0)
  s_barrier
  ds_read_b128 v[64:67], v127 offset:0
  ds_read_b128 v[80:83], v127 offset:4096
  ds_read_b128 v[68:71], v127 offset:8192
  ds_read_b128 v[84:87], v127 offset:12288
  ds_read_b128 v[72:75], v127 offset:16384
  ds_read_b128 v[88:91], v127 offset:20480
  ds_read_b128 v[76:79], v127 offset:24576
  ds_read_b128 v[92:95], v127 offset:28672
  s_waitcnt lgkmcnt(0)
  v_pk_add_f32 v[64:65], v[64:65], v[68:69]
  v_pk_add_f32 v[72:73], v[72:73], v[76:77]
  v_pk_add_f32 v[66:67], v[66:67], v[70:71]
  v_pk_add_f32 v[74:75], v[74:75], v[78:79]
  v_pk_add_f32 v[64:65], v[64:65], v[72:73]
  v_cvt_pk_bf16_f32 v124, v64, v65
  v_lshlrev_b32 v64, 16, v124
  v_and_b32 v65, 0xffff0000, v124
  v_pk_add_f32 v[66:67], v[66:67], v[74:75]
  v_cvt_pk_bf16_f32 v124, v66, v67
  v_lshlrev_b32 v66, 16, v124
  v_and_b32 v67, 0xffff0000, v124
  v_pk_add_f32 v[80:81], v[80:81], v[84:85]
  v_pk_add_f32 v[88:89], v[88:89], v[92:93]
  v_pk_add_f32 v[82:83], v[82:83], v[86:87]
  v_pk_add_f32 v[90:91], v[90:91], v[94:95]
  v_pk_add_f32 v[80:81], v[80:81], v[88:89]
  v_cvt_pk_bf16_f32 v124, v80, v81
  v_lshlrev_b32 v80, 16, v124
  v_and_b32 v81, 0xffff0000, v124
  v_pk_add_f32 v[82:83], v[82:83], v[90:91]
  v_cvt_pk_bf16_f32 v124, v82, v83
  v_lshlrev_b32 v82, 16, v124
  v_and_b32 v83, 0xffff0000, v124
  v_mul_f32 v140, 0xbfb8aa3b, v64
  v_mul_f32 v141, 0xbfb8aa3b, v65
  v_mul_f32 v142, 0xbfb8aa3b, v66
  v_mul_f32 v143, 0xbfb8aa3b, v67
  v_exp_f32 v140, v140
  v_exp_f32 v141, v141
  v_exp_f32 v142, v142
  v_exp_f32 v143, v143
  v_add_f32 v140, 1.0, v140
  v_add_f32 v141, 1.0, v141
  v_add_f32 v142, 1.0, v142
  v_add_f32 v143, 1.0, v143
  v_rcp_f32 v140, v140
  v_rcp_f32 v141, v141
  v_rcp_f32 v142, v142
  v_rcp_f32 v143, v143
  v_pk_mul_f32 v[64:65], v[64:65], v[140:141]
  v_cvt_pk_bf16_f32 v124, v64, v65
  v_lshlrev_b32 v64, 16, v124
  v_and_b32 v65, 0xffff0000, v124
  v_pk_mul_f32 v[64:65], v[64:65], v[80:81]
  v_cvt_pk_bf16_f32 v140, v64, v65
  v_pk_mul_f32 v[66:67], v[66:67], v[142:143]
  v_cvt_pk_bf16_f32 v124, v66, v67
  v_lshlrev_b32 v66, 16, v124
  v_and_b32 v67, 0xffff0000, v124
  v_pk_mul_f32 v[66:67], v[66:67], v[82:83]
  v_cvt_pk_bf16_f32 v141, v66, v67
  s_lshr_b32 s70, s17, 1
  s_lshl_b32 s70, s70, 10
  s_and_b32 s71, s17, 1
  s_lshl_b32 s71, s71, 3
  s_add_u32 s70, s70, s71
  v_add_u32 v126, s70, v233
  ds_write_b64 v126, v[140:141] offset:32768
  s_waitcnt lgkmcnt(0)
  s_barrier
  ds_read_b128 v[112:115], v233 offset:32768
  ds_read_b128 v[116:119], v233 offset:33792
  s_mul_i32 s70, s68, 20480
  s_mul_i32 s71, s17, 5120
  s_add_u32 s70, s70, s71
  s_add_u32 s70, s70, 2326528
  s_add_u32 s71, s70, 4096
  s_waitcnt lgkmcnt(0)
  v_mfma_f32_16x16x32_bf16 v[24:27], a[160:163], v[112:115], 0
  v_mfma_f32_16x16x32_bf16 v[28:31], a[168:171], v[112:115], 0
  v_mfma_f32_16x16x32_bf16 v[32:35], a[176:179], v[112:115], 0
  v_mfma_f32_16x16x32_bf16 v[36:39], a[184:187], v[112:115], 0
  v_mfma_f32_16x16x32_bf16 v[40:43], a[192:195], v[112:115], 0
  v_mfma_f32_16x16x32_bf16 v[44:47], a[200:203], v[112:115], 0
  v_mfma_f32_16x16x32_bf16 v[48:51], a[208:211], v[112:115], 0
  v_mfma_f32_16x16x32_bf16 v[52:55], a[216:219], v[112:115], 0
  v_mfma_f32_16x16x32_bf16 v[56:59], a[224:227], v[112:115], 0
  v_mfma_f32_16x16x32_bf16 v[60:63], a[232:235], v[112:115], 0
  v_mfma_f32_16x16x32_bf16 v[24:27], a[164:167], v[116:119], v[24:27]
  v_mfma_f32_16x16x32_bf16 v[28:31], a[172:175], v[116:119], v[28:31]
  v_mfma_f32_16x16x32_bf16 v[32:35], a[180:183], v[116:119], v[32:35]
  v_mfma_f32_16x16x32_bf16 v[36:39], a[188:191], v[116:119], v[36:39]
  v_mfma_f32_16x16x32_bf16 v[40:43], a[196:199], v[116:119], v[40:43]
  v_mfma_f32_16x16x32_bf16 v[44:47], a[204:207], v[116:119], v[44:47]
  v_mfma_f32_16x16x32_bf16 v[48:51], a[212:215], v[116:119], v[48:51]
  v_mfma_f32_16x16x32_bf16 v[52:55], a[220:223], v[116:119], v[52:55]
  v_mfma_f32_16x16x32_bf16 v[56:59], a[228:231], v[116:119], v[56:59]
  v_mfma_f32_16x16x32_bf16 v[60:63], a[236:239], v[116:119], v[60:63]
  s_mov_b32 exec_lo, 0x00ff00ff
  s_mov_b32 exec_hi, 0x00ff00ff
  buffer_store_dwordx4 v[24:27], v236, s[8:11], s70 offen offset:0 sc1
  buffer_store_dwordx4 v[28:31], v236, s[8:11], s70 offen offset:512 sc1
  buffer_store_dwordx4 v[32:35], v236, s[8:11], s70 offen offset:1024 sc1
  buffer_store_dwordx4 v[36:39], v236, s[8:11], s70 offen offset:1536 sc1
  buffer_store_dwordx4 v[40:43], v236, s[8:11], s70 offen offset:2048 sc1
  buffer_store_dwordx4 v[44:47], v236, s[8:11], s70 offen offset:2560 sc1
  buffer_store_dwordx4 v[48:51], v236, s[8:11], s70 offen offset:3072 sc1
  buffer_store_dwordx4 v[52:55], v236, s[8:11], s70 offen offset:3584 sc1
  buffer_store_dwordx4 v[56:59], v236, s[8:11], s71 offen offset:0 sc1
  buffer_store_dwordx4 v[60:63], v236, s[8:11], s71 offen offset:512 sc1
  s_mov_b64 exec, -1
  s_cmp_ge_u32 s78, 40
  s_cbranch_scc1 moe_end
  s_lshl_b32 s72, s78, 9
  s_add_u32 s72, s72, 2326528
  s_sleep 8
  s_mov_b32 s69, 0
moe_yp:
  s_mov_b32 s70, s72
  buffer_load_dwordx4 v[64:67], v237, s[8:11], s70 offen sc1
  s_add_u32 s70, s70, 40960
  buffer_load_dwordx4 v[68:71], v237, s[8:11], s70 offen sc1
  s_add_u32 s70, s70, 40960
  buffer_load_dwordx4 v[72:75], v237, s[8:11], s70 offen sc1
  s_add_u32 s70, s70, 40960
  buffer_load_dwordx4 v[76:79], v237, s[8:11], s70 offen sc1
  s_add_u32 s70, s70, 40960
  buffer_load_dwordx4 v[80:83], v237, s[8:11], s70 offen sc1
  s_add_u32 s70, s70, 40960
  buffer_load_dwordx4 v[84:87], v237, s[8:11], s70 offen sc1
  s_add_u32 s70, s70, 40960
  buffer_load_dwordx4 v[88:91], v237, s[8:11], s70 offen sc1
  s_add_u32 s70, s70, 40960
  buffer_load_dwordx4 v[92:95], v237, s[8:11], s70 offen sc1
  s_add_u32 s70, s70, 40960
  buffer_load_dwordx4 v[96:99], v237, s[8:11], s70 offen sc1
  s_add_u32 s70, s70, 40960
  buffer_load_dwordx4 v[100:103], v237, s[8:11], s70 offen sc1
  s_add_u32 s70, s70, 40960
  buffer_load_dwordx4 v[104:107], v237, s[8:11], s70 offen sc1
  s_add_u32 s70, s70, 40960
  buffer_load_dwordx4 v[108:111], v237, s[8:11], s70 offen sc1
  s_add_u32 s70, s70, 40960
  s_add_u32 s69, s69, 1
  s_cmp_gt_u32 s69, 65536
  s_cbranch_scc1 role_abort
  s_waitcnt vmcnt(10)
  v_pk_add_f32 v[136:137], v[64:65], v[68:69]
  v_pk_add_f32 v[138:139], v[66:67], v[70:71]
  s_waitcnt vmcnt(9)
  v_pk_add_f32 v[136:137], v[136:137], v[72:73]
  v_pk_add_f32 v[138:139], v[138:139], v[74:75]
  s_waitcnt vmcnt(8)
  v_pk_add_f32 v[136:137], v[136:137], v[76:77]
  v_pk_add_f32 v[138:139], v[138:139], v[78:79]
  s_waitcnt vmcnt(7)
  v_pk_add_f32 v[136:137], v[136:137], v[80:81]
  v_pk_add_f32 v[138:139], v[138:139], v[82:83]
  s_waitcnt vmcnt(6)
  v_pk_add_f32 v[136:137], v[136:137], v[84:85]
  v_pk_add_f32 v[138:139], v[138:139], v[86:87]
  s_waitcnt vmcnt(5)
  v_pk_add_f32 v[136:137], v[136:137], v[88:89]
  v_pk_add_f32 v[138:139], v[138:139], v[90:91]
  s_waitcnt vmcnt(4)
  v_pk_add_f32 v[136:137], v[136:137], v[92:93]
  v_pk_add_f32 v[138:139], v[138:139], v[94:95]
  s_waitcnt vmcnt(3)
  v_pk_add_f32 v[136:137], v[136:137], v[96:97]
  v_pk_add_f32 v[138:139], v[138:139], v[98:99]
  s_waitcnt vmcnt(2)
  v_pk_add_f32 v[136:137], v[136:137], v[100:101]
  v_pk_add_f32 v[138:139], v[138:139], v[102:103]
  s_waitcnt vmcnt(1)
  v_pk_add_f32 v[136:137], v[136:137], v[104:105]
  v_pk_add_f32 v[138:139], v[138:139], v[106:107]
  s_waitcnt vmcnt(0)
  v_pk_add_f32 v[136:137], v[136:137], v[108:109]
  v_pk_add_f32 v[138:139], v[138:139], v[110:111]
  v_add_f32 v124, v136, v137
  v_add_f32 v125, v138, v139
  v_cmp_u_f32 vcc, v124, v125
  s_cbranch_vccz moe_yok
  s_sleep 2
  s_branch moe_yp
moe_yok:
  v_mov_b32 v140, v136
  v_mov_b32 v141, v137
  v_mov_b32 v142, v138
  v_mov_b32 v143, v139
  v_permlane32_swap_b32 v136, v140
  v_permlane32_swap_b32 v137, v141
  v_permlane32_swap_b32 v138, v142
  v_permlane32_swap_b32 v139, v143
  v_lshlrev_b32 v64, 16, v128
  v_and_b32 v65, 0xffff0000, v128
  v_lshlrev_b32 v68, 16, v130
  v_and_b32 v69, 0xffff0000, v130
  v_lshlrev_b32 v66, 16, v129
  v_and_b32 v67, 0xffff0000, v129
  v_lshlrev_b32 v70, 16, v131
  v_and_b32 v71, 0xffff0000, v131
  v_pk_add_f32 v[136:137], v[136:137], v[140:141]
  v_cvt_pk_bf16_f32 v124, v136, v137
  v_lshlrev_b32 v136, 16, v124
  v_and_b32 v137, 0xffff0000, v124
  v_mul_f32 v136, v136, v123
  v_mul_f32 v137, v137, v123
  v_cvt_pk_bf16_f32 v124, v136, v137
  v_lshlrev_b32 v136, 16, v124
  v_and_b32 v137, 0xffff0000, v124
  v_pk_add_f32 v[136:137], v[136:137], v[68:69]
  v_cvt_pk_bf16_f32 v124, v136, v137
  v_lshlrev_b32 v136, 16, v124
  v_and_b32 v137, 0xffff0000, v124
  v_pk_mul_f32 v[136:137], v[136:137], v[132:133]
  v_cvt_pk_bf16_f32 v124, v136, v137
  v_lshlrev_b32 v136, 16, v124
  v_and_b32 v137, 0xffff0000, v124
  v_pk_add_f32 v[136:137], v[136:137], v[64:65]
  v_cvt_pk_bf16_f32 v140, v136, v137
  v_pk_add_f32 v[138:139], v[138:139], v[142:143]
  v_cvt_pk_bf16_f32 v124, v138, v139
  v_lshlrev_b32 v138, 16, v124
  v_and_b32 v139, 0xffff0000, v124
  v_mul_f32 v138, v138, v123
  v_mul_f32 v139, v139, v123
  v_cvt_pk_bf16_f32 v124, v138, v139
  v_lshlrev_b32 v138, 16, v124
  v_and_b32 v139, 0xffff0000, v124
  v_pk_add_f32 v[138:139], v[138:139], v[70:71]
  v_cvt_pk_bf16_f32 v124, v138, v139
  v_lshlrev_b32 v138, 16, v124
  v_and_b32 v139, 0xffff0000, v124
  v_pk_mul_f32 v[138:139], v[138:139], v[134:135]
  v_cvt_pk_bf16_f32 v124, v138, v139
  v_lshlrev_b32 v138, 16, v124
  v_and_b32 v139, 0xffff0000, v124
  v_pk_add_f32 v[138:139], v[138:139], v[66:67]
  v_cvt_pk_bf16_f32 v141, v138, v139
  s_mov_b32 exec_hi, 0
  buffer_store_dwordx2 v[140:141], v122, s[24:27], 0 offen sc1
moe_end:
  s_endpgm
role_chain:
  s_load_dwordx2 s[20:21], s[0:1], 16
  s_mov_b32 s22, 7864320
  s_mov_b32 s23, 0x00020000
  s_load_dwordx2 s[24:25], s[0:1], 24
  s_mov_b32 s26, 7864320
  s_mov_b32 s27, 0x00020000
  s_load_dwordx2 s[28:29], s[0:1], 32
  s_mov_b32 s30, 7864320
  s_mov_b32 s31, 0x00020000
  s_load_dwordx2 s[32:33], s[0:1], 40
  s_mov_b32 s34, 7864320
  s_mov_b32 s35, 0x00020000
  s_mov_b32 s36, s18
  s_mul_i32 s37, s36, 43
  s_lshr_b32 s37, s37, 7
  s_mul_i32 s41, s37, 3
  s_sub_u32 s38, s36, s41
  v_lshrrev_b32 v171, 4, v1
  v_and_b32 v171, 3, v171
  v_lshlrev_b32 v171, 1, v171
  v_and_b32 v4, 7, v1
  v_xor_b32 v4, v4, v171
  v_lshlrev_b32 v4, 4, v4
  v_lshrrev_b32 v171, 3, v1
  v_mul_u32_u24 v171, 12288, v171
  v_add_u32 v4, v4, v171
  s_lshl_b32 s41, s16, 2
  s_add_u32 s41, s41, s37
  s_mul_i32 s61, s41, 384
  s_lshl_b32 s41, s38, 7
  s_add_u32 s61, s61, s41
  s_mul_i32 s41, s17, 983040
  s_add_u32 s61, s61, s41
  s_lshl_b32 s41, s16, 2
  s_add_u32 s41, s41, s17
  s_mul_i32 s62, s41, 245760
  s_min_u32 s41, s36, 9
  s_lshl_b32 s41, s41, 7
  s_add_u32 s62, s62, s41
  s_mul_i32 s44, s17, 10240
  s_waitcnt lgkmcnt(0)
  s_add_u32 m0, s44, 0
  s_add_u32 s41, s61, 3932160
  buffer_load_dwordx4 v4, s[28:31], s41 offen nt lds
  s_add_u32 m0, s44, 1024
  s_add_u32 s41, s61, 4030464
  buffer_load_dwordx4 v4, s[28:31], s41 offen nt lds
  s_add_u32 m0, s44, 2048
  s_add_u32 s41, s61, 4128768
  buffer_load_dwordx4 v4, s[28:31], s41 offen nt lds
  s_add_u32 m0, s44, 3072
  s_add_u32 s41, s61, 4227072
  buffer_load_dwordx4 v4, s[28:31], s41 offen nt lds
  s_add_u32 m0, s44, 4096
  s_add_u32 s41, s61, 4325376
  buffer_load_dwordx4 v4, s[28:31], s41 offen nt lds
  s_add_u32 m0, s44, 5120
  s_add_u32 s41, s61, 4423680
  buffer_load_dwordx4 v4, s[28:31], s41 offen nt lds
  s_add_u32 m0, s44, 6144
  s_add_u32 s41, s61, 4521984
  buffer_load_dwordx4 v4, s[28:31], s41 offen nt lds
  s_add_u32 m0, s44, 7168
  s_add_u32 s41, s61, 4620288
  buffer_load_dwordx4 v4, s[28:31], s41 offen nt lds
  s_add_u32 m0, s44, 8192
  s_add_u32 s41, s61, 4718592
  buffer_load_dwordx4 v4, s[28:31], s41 offen nt lds
  s_add_u32 m0, s44, 9216
  s_add_u32 s41, s61, 4816896
  buffer_load_dwordx4 v4, s[28:31], s41 offen nt lds
  s_add_u32 m0, s44, 40960
  s_add_u32 s41, s61, 3932160
  buffer_load_dwordx4 v4, s[24:27], s41 offen nt lds
  s_add_u32 m0, s44, 41984
  s_add_u32 s41, s61, 4030464
  buffer_load_dwordx4 v4, s[24:27], s41 offen nt lds
  s_add_u32 m0, s44, 43008
  s_add_u32 s41, s61, 4128768
  buffer_load_dwordx4 v4, s[24:27], s41 offen nt lds
  s_add_u32 m0, s44, 44032
  s_add_u32 s41, s61, 4227072
  buffer_load_dwordx4 v4, s[24:27], s41 offen nt lds
  s_add_u32 m0, s44, 45056
  s_add_u32 s41, s61, 4325376
  buffer_load_dwordx4 v4, s[24:27], s41 offen nt lds
  s_add_u32 m0, s44, 46080
  s_add_u32 s41, s61, 4423680
  buffer_load_dwordx4 v4, s[24:27], s41 offen nt lds
  s_add_u32 m0, s44, 47104
  s_add_u32 s41, s61, 4521984
  buffer_load_dwordx4 v4, s[24:27], s41 offen nt lds
  s_add_u32 m0, s44, 48128
  s_add_u32 s41, s61, 4620288
  buffer_load_dwordx4 v4, s[24:27], s41 offen nt lds
  s_add_u32 m0, s44, 49152
  s_add_u32 s41, s61, 4718592
  buffer_load_dwordx4 v4, s[24:27], s41 offen nt lds
  s_add_u32 m0, s44, 50176
  s_add_u32 s41, s61, 4816896
  buffer_load_dwordx4 v4, s[24:27], s41 offen nt lds
  s_lshl_b32 s41, s17, 1
  v_lshrrev_b32 v171, 2, v1
  v_lshrrev_b32 v172, 1, v171
  v_and_b32 v172, 3, v172
  v_lshlrev_b32 v172, 1, v172
  v_bfe_u32 v6, v1, 1, 1
  v_add_u32 v6, s41, v6
  v_xor_b32 v6, v6, v172
  v_lshlrev_b32 v6, 4, v6
  v_lshlrev_b32 v171, 7, v171
  v_add_u32 v6, v6, v171
  v_and_b32 v171, 1, v1
  v_lshlrev_b32 v171, 3, v171
  v_add_u32 v6, v6, v171
  v_add_u32 v7, 40960, v6
  v_add_u32 v8, 81920, v6
  v_add_u32 v9, 122880, v6
  v_lshrrev_b32 v171, 4, v1
  v_and_b32 v171, 3, v171
  v_lshlrev_b32 v171, 1, v171
  v_and_b32 v5, 7, v1
  v_xor_b32 v5, v5, v171
  v_lshlrev_b32 v5, 4, v5
  v_lshrrev_b32 v171, 3, v1
  v_mul_u32_u24 v171, 0, v171
  v_add_u32 v5, v5, v171
  v_bfe_u32 v171, v1, 3, 2
  v_lshlrev_b32 v171, 2, v171
  v_bfe_u32 v172, v1, 5, 1
  v_lshl_add_u32 v171, v172, 1, v171
  v_mul_u32_u24 v171, 1280, v171
  v_add_u32 v5, v5, v171
  v_lshrrev_b32 v171, 2, v1
  v_lshrrev_b32 v172, 1, v171
  v_and_b32 v172, 3, v172
  v_lshlrev_b32 v172, 1, v172
  v_bfe_u32 v10, v1, 1, 1
  v_add_u32 v10, 0, v10
  v_xor_b32 v10, v10, v172
  v_lshlrev_b32 v10, 4, v10
  v_lshlrev_b32 v171, 7, v171
  v_add_u32 v10, v10, v171
  v_and_b32 v171, 1, v1
  v_lshlrev_b32 v171, 3, v171
  v_add_u32 v10, v10, v171
  v_add_u32 v10, s44, v10
  v_lshrrev_b32 v171, 2, v1
  v_lshrrev_b32 v172, 1, v171
  v_and_b32 v172, 3, v172
  v_lshlrev_b32 v172, 1, v172
  v_bfe_u32 v11, v1, 1, 1
  v_add_u32 v11, 2, v11
  v_xor_b32 v11, v11, v172
  v_lshlrev_b32 v11, 4, v11
  v_lshlrev_b32 v171, 7, v171
  v_add_u32 v11, v11, v171
  v_and_b32 v171, 1, v1
  v_lshlrev_b32 v171, 3, v171
  v_add_u32 v11, v11, v171
  v_add_u32 v11, s44, v11
  v_lshrrev_b32 v171, 2, v1
  v_lshrrev_b32 v172, 1, v171
  v_and_b32 v172, 3, v172
  v_lshlrev_b32 v172, 1, v172
  v_bfe_u32 v12, v1, 1, 1
  v_add_u32 v12, 4, v12
  v_xor_b32 v12, v12, v172
  v_lshlrev_b32 v12, 4, v12
  v_lshlrev_b32 v171, 7, v171
  v_add_u32 v12, v12, v171
  v_and_b32 v171, 1, v1
  v_lshlrev_b32 v171, 3, v171
  v_add_u32 v12, v12, v171
  v_add_u32 v12, s44, v12
  v_lshrrev_b32 v171, 2, v1
  v_lshrrev_b32 v172, 1, v171
  v_and_b32 v172, 3, v172
  v_lshlrev_b32 v172, 1, v172
  v_bfe_u32 v13, v1, 1, 1
  v_add_u32 v13, 6, v13
  v_xor_b32 v13, v13, v172
  v_lshlrev_b32 v13, 4, v13
  v_lshlrev_b32 v171, 7, v171
  v_add_u32 v13, v13, v171
  v_and_b32 v171, 1, v1
  v_lshlrev_b32 v171, 3, v171
  v_add_u32 v13, v13, v171
  v_add_u32 v13, s44, v13
  v_mov_b32 v88, 0x3f803f80
  v_mov_b32 v89, 0x3f803f80
  v_mov_b32 v90, 0x3f803f80
  v_mov_b32 v91, 0x3f803f80
  v_mov_b32 v116, 0
  v_mov_b32 v117, 0
  v_mov_b32 v118, 0
  v_mov_b32 v119, 0
  v_mov_b32 v120, 0
  v_mov_b32 v121, 0
  v_mov_b32 v122, 0
  v_mov_b32 v123, 0
  v_mov_b32 v124, 0
  v_mov_b32 v125, 0
  v_mov_b32 v126, 0
  v_mov_b32 v127, 0
  v_lshlrev_b32 v152, 4, v1
  v_lshlrev_b32 v153, 3, v1
  v_lshlrev_b32 v168, 2, v1
  s_mul_i32 s41, s17, 2560
  v_add_u32 v154, s41, v152
  s_add_u32 s41, s41, 2048
  v_add_u32 v155, s41, v168
  v_lshrrev_b32 v44, 4, v1
  v_and_b32 v45, 7, v1
  v_and_b32 v46, 15, v1
  v_bfe_u32 v171, v1, 1, 1
  v_mul_u32_u24 v171, 0xaaaa, v171
  v_add_u32 v164, 0x4444, v171
  v_bfe_u32 v171, v1, 2, 1
  v_mov_b32 v165, 0x05040100
  v_mov_b32 v172, 0x03020706
  v_cmp_eq_u32 vcc, 1, v171
  s_nop 1
  v_cndmask_b32 v165, v165, v172, vcc
  s_lshl_b32 s41, s17, 9
  s_add_u32 s41, s41, 10240
  v_lshlrev_b32 v171, 5, v46
  v_lshl_add_u32 v171, v44, 2, v171
  v_add_u32 v156, s41, v171
  v_lshl_add_u32 v157, v44, 2, v156
  v_add_u32 v157, 2048, v157
  s_lshl_b32 s41, s17, 8
  v_add_u32 v158, s41, v168
  s_lshl_b32 s41, s36, 10
  v_add_u32 v161, s41, v158
  s_lshl_b32 s41, s38, 10
  s_lshl_b32 s42, s38, 2
  s_add_u32 s42, s42, 3072
  s_cmp_lt_u32 s17, 2
  s_cselect_b32 s53, s41, s42
  s_add_u32 s54, s41, 4096
  v_bfe_u32 v171, v1, 2, 2
  v_lshlrev_b32 v171, 1, v171
  v_and_b32 v172, 1, v1
  v_add_u32 v171, v171, v172
  v_lshl_add_u32 v171, v44, 3, v171
  v_lshlrev_b32 v171, 4, v171
  v_add_u32 v166, s41, v171
  s_lshl_b32 s41, s17, 11
  s_add_u32 s41, s41, 14336
  v_add_u32 v159, s41, v152
  s_lshl_b32 s41, s17, 2
  s_add_u32 s41, s41, 22528
  v_lshl_add_u32 v169, v46, 4, s41
  s_lshl_b32 s41, s17, 9
  s_add_u32 s41, s41, 14336
  v_and_b32 v171, 3, v1
  v_lshlrev_b32 v171, 5, v171
  v_bfe_u32 v172, v1, 4, 1
  v_lshl_add_u32 v171, v172, 4, v171
  v_add_u32 v170, 22528, v171
  v_bfe_u32 v172, v1, 5, 1
  v_lshl_add_u32 v171, v172, 3, v171
  v_bfe_u32 v172, v1, 2, 2
  v_lshl_add_u32 v171, v172, 7, v171
  v_add_u32 v160, s41, v171
  s_mov_b32 s74, 0x00ff00ff
  s_mov_b32 s75, 0x00ff00ff
  s_mov_b32 s76, 0xff00ff00
  s_mov_b32 s77, 0xff00ff00
  s_cmp_eq_u32 s17, 0
  s_cselect_b64 s[78:79], s[74:75], s[76:77]
  s_mov_b32 s82, 0x3dd53b95
  s_mov_b32 s83, s82
  s_mov_b64 s[80:81], 0
  s_mul_i32 s45, s16, 10240
  s_add_u32 s45, s45, 131072
  s_lshl_b32 s41, s16, 17
  s_add_u32 s41, s41, 3407872
  s_lshl_b32 s42, s37, 13
  s_add_u32 s47, s41, s42
  s_lshl_b32 s42, s17, 13
  s_add_u32 s48, s41, s42
  s_lshl_b32 s43, s16, 22
  s_add_u32 s43, s43, 67108864
  s_mul_i32 s58, s37, 3072
  s_add_u32 s58, s58, s43
  s_add_u32 s58, s58, 1384448
  s_mul_i32 s57, s37, 12288
  s_add_u32 s57, s57, s43
  s_add_u32 s57, s57, 49152
  s_and_b32 s41, s17, 1
  s_mul_i32 s41, s41, 6144
  s_add_u32 s57, s57, s41
  s_lshl_b32 s41, s38, 11
  s_add_u32 s57, s57, s41
  s_mul_i32 s60, s17, 40960
  s_add_u32 s60, s60, s43
  s_add_u32 s60, s60, 1179648
  s_lshl_b32 s42, s36, 12
  s_add_u32 s60, s60, s42
  s_mul_i32 s59, s17, 10240
  s_add_u32 s59, s59, s43
  s_add_u32 s59, s59, 1343488
  s_lshl_b32 s42, s36, 10
  s_add_u32 s59, s59, s42
  s_mul_i32 s64, s36, 16384
  s_lshl_b32 s41, s17, 11
  s_add_u32 s64, s64, s41
  s_add_u32 s64, s64, 16777216
  v_lshlrev_b32 v175, 2, v44
  v_lshl_add_u32 v175, v46, 4, v175
  s_lshr_b32 s72, s16, 2
  s_lshl_b32 s72, s72, 10
  s_and_b32 s41, s16, 3
  s_lshl_b32 s41, s41, 4
  s_mov_b64 s[70:71], 0xffff
  s_lshl_b64 s[70:71], s[70:71], s41
  s_not_b64 s[70:71], s[70:71]
  s_lshl_b32 s41, s16, 8
  v_add_u32 v162, s41, v168
  s_lshl_b32 s42, s36, 4
  s_add_u32 s41, s41, s42
  s_lshl_b32 s42, s17, 2
  s_add_u32 s41, s41, s42
  s_add_u32 s41, s41, 4096
  v_mov_b32 v163, s41
  v_mov_b32 v167, 0
  s_mov_b32 s39, 0
  v_and_b32 v172, 3, v1
  v_mov_b32 v173, 0
  v_mov_b32 v174, 0x3f80
  v_cmp_eq_u32 vcc, 0, v172
  s_nop 1
  v_cndmask_b32 v173, v173, v174, vcc
  v_mov_b32 v174, 0x3f800000
  v_cmp_eq_u32 vcc, 1, v172
  s_nop 1
  v_cndmask_b32 v173, v173, v174, vcc
  v_lshrrev_b32 v171, 2, v46
  v_mov_b32 v174, 0
  v_mov_b32 v130, 0x3f803f80
  v_mov_b32 v131, 0
  v_cmp_eq_u32 vcc, 0, v171
  s_nop 1
  v_cndmask_b32 v84, v174, v173, vcc
  v_cmp_eq_u32 vcc, 1, v171
  s_nop 1
  v_cndmask_b32 v85, v174, v173, vcc
  v_cmp_eq_u32 vcc, 2, v171
  s_nop 1
  v_cndmask_b32 v86, v174, v173, vcc
  v_cmp_eq_u32 vcc, 3, v171
  s_nop 1
  v_cndmask_b32 v87, v174, v173, vcc
  s_waitcnt vmcnt(10)
  s_add_u32 m0, s44, 81920
  s_add_u32 s41, s61, 3932160
  buffer_load_dwordx4 v4, s[20:23], s41 offen nt lds
  s_add_u32 m0, s44, 82944
  s_add_u32 s41, s61, 4030464
  buffer_load_dwordx4 v4, s[20:23], s41 offen nt lds
  s_add_u32 m0, s44, 83968
  s_add_u32 s41, s61, 4128768
  buffer_load_dwordx4 v4, s[20:23], s41 offen nt lds
  s_add_u32 m0, s44, 84992
  s_add_u32 s41, s61, 4227072
  buffer_load_dwordx4 v4, s[20:23], s41 offen nt lds
  s_add_u32 m0, s44, 86016
  s_add_u32 s41, s61, 4325376
  buffer_load_dwordx4 v4, s[20:23], s41 offen nt lds
  s_add_u32 m0, s44, 87040
  s_add_u32 s41, s61, 4423680
  buffer_load_dwordx4 v4, s[20:23], s41 offen nt lds
  s_add_u32 m0, s44, 88064
  s_add_u32 s41, s61, 4521984
  buffer_load_dwordx4 v4, s[20:23], s41 offen nt lds
  s_add_u32 m0, s44, 89088
  s_add_u32 s41, s61, 4620288
  buffer_load_dwordx4 v4, s[20:23], s41 offen nt lds
  s_add_u32 m0, s44, 90112
  s_add_u32 s41, s61, 4718592
  buffer_load_dwordx4 v4, s[20:23], s41 offen nt lds
  s_add_u32 m0, s44, 91136
  s_add_u32 s41, s61, 4816896
  buffer_load_dwordx4 v4, s[20:23], s41 offen nt lds
  s_barrier
  ds_read_b64_tr_b16 a[200:201], v6 offset:0
  ds_read_b64_tr_b16 a[202:203], v6 offset:2048
  ds_read_b64_tr_b16 a[204:205], v6 offset:4096
  ds_read_b64_tr_b16 a[206:207], v6 offset:6144
  ds_read_b64_tr_b16 a[208:209], v6 offset:8192
  ds_read_b64_tr_b16 a[210:211], v6 offset:10240
  ds_read_b64_tr_b16 a[212:213], v6 offset:12288
  ds_read_b64_tr_b16 a[214:215], v6 offset:14336
  ds_read_b64_tr_b16 a[216:217], v6 offset:16384
  ds_read_b64_tr_b16 a[218:219], v6 offset:18432
  ds_read_b64_tr_b16 a[220:221], v6 offset:20480
  ds_read_b64_tr_b16 a[222:223], v6 offset:22528
  ds_read_b64_tr_b16 a[224:225], v6 offset:24576
  ds_read_b64_tr_b16 a[226:227], v6 offset:26624
  ds_read_b64_tr_b16 a[228:229], v6 offset:28672
  ds_read_b64_tr_b16 a[230:231], v6 offset:30720
  ds_read_b64_tr_b16 a[232:233], v6 offset:32768
  ds_read_b64_tr_b16 a[234:235], v6 offset:34816
  ds_read_b64_tr_b16 a[236:237], v6 offset:36864
  ds_read_b64_tr_b16 a[238:239], v6 offset:38912
  s_waitcnt lgkmcnt(0)
  s_barrier
  s_waitcnt vmcnt(10)
  s_add_u32 m0, s44, 122880
  s_add_u32 s41, s61, 0
  buffer_load_dwordx4 v4, s[28:31], s41 offen nt lds
  s_add_u32 m0, s44, 123904
  s_add_u32 s41, s61, 98304
  buffer_load_dwordx4 v4, s[28:31], s41 offen nt lds
  s_add_u32 m0, s44, 124928
  s_add_u32 s41, s61, 196608
  buffer_load_dwordx4 v4, s[28:31], s41 offen nt lds
  s_add_u32 m0, s44, 125952
  s_add_u32 s41, s61, 294912
  buffer_load_dwordx4 v4, s[28:31], s41 offen nt lds
  s_add_u32 m0, s44, 126976
  s_add_u32 s41, s61, 393216
  buffer_load_dwordx4 v4, s[28:31], s41 offen nt lds
  s_add_u32 m0, s44, 128000
  s_add_u32 s41, s61, 491520
  buffer_load_dwordx4 v4, s[28:31], s41 offen nt lds
  s_add_u32 m0, s44, 129024
  s_add_u32 s41, s61, 589824
  buffer_load_dwordx4 v4, s[28:31], s41 offen nt lds
  s_add_u32 m0, s44, 130048
  s_add_u32 s41, s61, 688128
  buffer_load_dwordx4 v4, s[28:31], s41 offen nt lds
  s_add_u32 m0, s44, 131072
  s_add_u32 s41, s61, 786432
  buffer_load_dwordx4 v4, s[28:31], s41 offen nt lds
  s_add_u32 m0, s44, 132096
  s_add_u32 s41, s61, 884736
  buffer_load_dwordx4 v4, s[28:31], s41 offen nt lds
  s_barrier
  ds_read_b64_tr_b16 a[120:121], v7 offset:0
  ds_read_b64_tr_b16 a[122:123], v7 offset:2048
  ds_read_b64_tr_b16 a[124:125], v7 offset:4096
  ds_read_b64_tr_b16 a[126:127], v7 offset:6144
  ds_read_b64_tr_b16 a[128:129], v7 offset:8192
  ds_read_b64_tr_b16 a[130:131], v7 offset:10240
  ds_read_b64_tr_b16 a[132:133], v7 offset:12288
  ds_read_b64_tr_b16 a[134:135], v7 offset:14336
  ds_read_b64_tr_b16 a[136:137], v7 offset:16384
  ds_read_b64_tr_b16 a[138:139], v7 offset:18432
  ds_read_b64_tr_b16 a[140:141], v7 offset:20480
  ds_read_b64_tr_b16 a[142:143], v7 offset:22528
  ds_read_b64_tr_b16 a[144:145], v7 offset:24576
  ds_read_b64_tr_b16 a[146:147], v7 offset:26624
  ds_read_b64_tr_b16 a[148:149], v7 offset:28672
  ds_read_b64_tr_b16 a[150:151], v7 offset:30720
  ds_read_b64_tr_b16 a[152:153], v7 offset:32768
  ds_read_b64_tr_b16 a[154:155], v7 offset:34816
  ds_read_b64_tr_b16 a[156:157], v7 offset:36864
  ds_read_b64_tr_b16 a[158:159], v7 offset:38912
  s_waitcnt lgkmcnt(0)
  s_barrier
  s_waitcnt vmcnt(10)
  s_add_u32 m0, s44, 0
  s_add_u32 s41, s61, 0
  buffer_load_dwordx4 v4, s[24:27], s41 offen nt lds
  s_add_u32 m0, s44, 1024
  s_add_u32 s41, s61, 98304
  buffer_load_dwordx4 v4, s[24:27], s41 offen nt lds
  s_add_u32 m0, s44, 2048
  s_add_u32 s41, s61, 196608
  buffer_load_dwordx4 v4, s[24:27], s41 offen nt lds
  s_add_u32 m0, s44, 3072
  s_add_u32 s41, s61, 294912
  buffer_load_dwordx4 v4, s[24:27], s41 offen nt lds
  s_add_u32 m0, s44, 4096
  s_add_u32 s41, s61, 393216
  buffer_load_dwordx4 v4, s[24:27], s41 offen nt lds
  s_add_u32 m0, s44, 5120
  s_add_u32 s41, s61, 491520
  buffer_load_dwordx4 v4, s[24:27], s41 offen nt lds
  s_add_u32 m0, s44, 6144
  s_add_u32 s41, s61, 589824
  buffer_load_dwordx4 v4, s[24:27], s41 offen nt lds
  s_add_u32 m0, s44, 7168
  s_add_u32 s41, s61, 688128
  buffer_load_dwordx4 v4, s[24:27], s41 offen nt lds
  s_add_u32 m0, s44, 8192
  s_add_u32 s41, s61, 786432
  buffer_load_dwordx4 v4, s[24:27], s41 offen nt lds
  s_add_u32 m0, s44, 9216
  s_add_u32 s41, s61, 884736
  buffer_load_dwordx4 v4, s[24:27], s41 offen nt lds
  s_barrier
  ds_read_b64_tr_b16 a[40:41], v8 offset:0
  ds_read_b64_tr_b16 a[42:43], v8 offset:2048
  ds_read_b64_tr_b16 a[44:45], v8 offset:4096
  ds_read_b64_tr_b16 a[46:47], v8 offset:6144
  ds_read_b64_tr_b16 a[48:49], v8 offset:8192
  ds_read_b64_tr_b16 a[50:51], v8 offset:10240
  ds_read_b64_tr_b16 a[52:53], v8 offset:12288
  ds_read_b64_tr_b16 a[54:55], v8 offset:14336
  ds_read_b64_tr_b16 a[56:57], v8 offset:16384
  ds_read_b64_tr_b16 a[58:59], v8 offset:18432
  ds_read_b64_tr_b16 a[60:61], v8 offset:20480
  ds_read_b64_tr_b16 a[62:63], v8 offset:22528
  ds_read_b64_tr_b16 a[64:65], v8 offset:24576
  ds_read_b64_tr_b16 a[66:67], v8 offset:26624
  ds_read_b64_tr_b16 a[68:69], v8 offset:28672
  ds_read_b64_tr_b16 a[70:71], v8 offset:30720
  ds_read_b64_tr_b16 a[72:73], v8 offset:32768
  ds_read_b64_tr_b16 a[74:75], v8 offset:34816
  ds_read_b64_tr_b16 a[76:77], v8 offset:36864
  ds_read_b64_tr_b16 a[78:79], v8 offset:38912
  s_waitcnt lgkmcnt(0)
  s_barrier
  s_waitcnt vmcnt(10)
  s_add_u32 m0, s44, 40960
  s_add_u32 s41, s61, 0
  buffer_load_dwordx4 v4, s[20:23], s41 offen nt lds
  s_add_u32 m0, s44, 41984
  s_add_u32 s41, s61, 98304
  buffer_load_dwordx4 v4, s[20:23], s41 offen nt lds
  s_add_u32 m0, s44, 43008
  s_add_u32 s41, s61, 196608
  buffer_load_dwordx4 v4, s[20:23], s41 offen nt lds
  s_add_u32 m0, s44, 44032
  s_add_u32 s41, s61, 294912
  buffer_load_dwordx4 v4, s[20:23], s41 offen nt lds
  s_add_u32 m0, s44, 45056
  s_add_u32 s41, s61, 393216
  buffer_load_dwordx4 v4, s[20:23], s41 offen nt lds
  s_add_u32 m0, s44, 46080
  s_add_u32 s41, s61, 491520
  buffer_load_dwordx4 v4, s[20:23], s41 offen nt lds
  s_add_u32 m0, s44, 47104
  s_add_u32 s41, s61, 589824
  buffer_load_dwordx4 v4, s[20:23], s41 offen nt lds
  s_add_u32 m0, s44, 48128
  s_add_u32 s41, s61, 688128
  buffer_load_dwordx4 v4, s[20:23], s41 offen nt lds
  s_add_u32 m0, s44, 49152
  s_add_u32 s41, s61, 786432
  buffer_load_dwordx4 v4, s[20:23], s41 offen nt lds
  s_add_u32 m0, s44, 50176
  s_add_u32 s41, s61, 884736
  buffer_load_dwordx4 v4, s[20:23], s41 offen nt lds
  s_barrier
  ds_read_b64_tr_b16 a[160:161], v9 offset:0
  ds_read_b64_tr_b16 a[162:163], v9 offset:2048
  ds_read_b64_tr_b16 a[164:165], v9 offset:4096
  ds_read_b64_tr_b16 a[166:167], v9 offset:6144
  ds_read_b64_tr_b16 a[168:169], v9 offset:8192
  ds_read_b64_tr_b16 a[170:171], v9 offset:10240
  ds_read_b64_tr_b16 a[172:173], v9 offset:12288
  ds_read_b64_tr_b16 a[174:175], v9 offset:14336
  ds_read_b64_tr_b16 a[176:177], v9 offset:16384
  ds_read_b64_tr_b16 a[178:179], v9 offset:18432
  ds_read_b64_tr_b16 a[180:181], v9 offset:20480
  ds_read_b64_tr_b16 a[182:183], v9 offset:22528
  ds_read_b64_tr_b16 a[184:185], v9 offset:24576
  ds_read_b64_tr_b16 a[186:187], v9 offset:26624
  ds_read_b64_tr_b16 a[188:189], v9 offset:28672
  ds_read_b64_tr_b16 a[190:191], v9 offset:30720
  ds_read_b64_tr_b16 a[192:193], v9 offset:32768
  ds_read_b64_tr_b16 a[194:195], v9 offset:34816
  ds_read_b64_tr_b16 a[196:197], v9 offset:36864
  ds_read_b64_tr_b16 a[198:199], v9 offset:38912
  s_waitcnt lgkmcnt(0)
  s_barrier
  s_waitcnt vmcnt(10)
  s_add_u32 m0, s44, 81920
  s_add_u32 s41, s62, 163840
  buffer_load_dwordx4 v5, s[32:35], s41 offen nt lds
  s_add_u32 m0, s44, 82944
  s_add_u32 s41, s62, 184320
  buffer_load_dwordx4 v5, s[32:35], s41 offen nt lds
  s_add_u32 m0, s44, 83968
  s_add_u32 s41, s62, 165120
  buffer_load_dwordx4 v5, s[32:35], s41 offen nt lds
  s_add_u32 m0, s44, 84992
  s_add_u32 s41, s62, 185600
  buffer_load_dwordx4 v5, s[32:35], s41 offen nt lds
  s_add_u32 m0, s44, 86016
  s_add_u32 s41, s62, 204800
  buffer_load_dwordx4 v5, s[32:35], s41 offen nt lds
  s_add_u32 m0, s44, 87040
  s_add_u32 s41, s62, 225280
  buffer_load_dwordx4 v5, s[32:35], s41 offen nt lds
  s_add_u32 m0, s44, 88064
  s_add_u32 s41, s62, 206080
  buffer_load_dwordx4 v5, s[32:35], s41 offen nt lds
  s_add_u32 m0, s44, 89088
  s_add_u32 s41, s62, 226560
  buffer_load_dwordx4 v5, s[32:35], s41 offen nt lds
  s_barrier
  ds_read_b64_tr_b16 a[80:81], v6 offset:0
  ds_read_b64_tr_b16 a[82:83], v6 offset:2048
  ds_read_b64_tr_b16 a[84:85], v6 offset:4096
  ds_read_b64_tr_b16 a[86:87], v6 offset:6144
  ds_read_b64_tr_b16 a[88:89], v6 offset:8192
  ds_read_b64_tr_b16 a[90:91], v6 offset:10240
  ds_read_b64_tr_b16 a[92:93], v6 offset:12288
  ds_read_b64_tr_b16 a[94:95], v6 offset:14336
  ds_read_b64_tr_b16 a[96:97], v6 offset:16384
  ds_read_b64_tr_b16 a[98:99], v6 offset:18432
  ds_read_b64_tr_b16 a[100:101], v6 offset:20480
  ds_read_b64_tr_b16 a[102:103], v6 offset:22528
  ds_read_b64_tr_b16 a[104:105], v6 offset:24576
  ds_read_b64_tr_b16 a[106:107], v6 offset:26624
  ds_read_b64_tr_b16 a[108:109], v6 offset:28672
  ds_read_b64_tr_b16 a[110:111], v6 offset:30720
  ds_read_b64_tr_b16 a[112:113], v6 offset:32768
  ds_read_b64_tr_b16 a[114:115], v6 offset:34816
  ds_read_b64_tr_b16 a[116:117], v6 offset:36864
  ds_read_b64_tr_b16 a[118:119], v6 offset:38912
  s_waitcnt lgkmcnt(0)
  s_barrier
  s_waitcnt vmcnt(8)
  s_add_u32 m0, s44, 122880
  s_add_u32 s41, s62, 81920
  buffer_load_dwordx4 v5, s[32:35], s41 offen nt lds
  s_add_u32 m0, s44, 123904
  s_add_u32 s41, s62, 102400
  buffer_load_dwordx4 v5, s[32:35], s41 offen nt lds
  s_add_u32 m0, s44, 124928
  s_add_u32 s41, s62, 83200
  buffer_load_dwordx4 v5, s[32:35], s41 offen nt lds
  s_add_u32 m0, s44, 125952
  s_add_u32 s41, s62, 103680
  buffer_load_dwordx4 v5, s[32:35], s41 offen nt lds
  s_add_u32 m0, s44, 126976
  s_add_u32 s41, s62, 122880
  buffer_load_dwordx4 v5, s[32:35], s41 offen nt lds
  s_add_u32 m0, s44, 128000
  s_add_u32 s41, s62, 143360
  buffer_load_dwordx4 v5, s[32:35], s41 offen nt lds
  s_add_u32 m0, s44, 129024
  s_add_u32 s41, s62, 124160
  buffer_load_dwordx4 v5, s[32:35], s41 offen nt lds
  s_add_u32 m0, s44, 130048
  s_add_u32 s41, s62, 144640
  buffer_load_dwordx4 v5, s[32:35], s41 offen nt lds
  s_barrier
  ds_read_b64_tr_b16 a[0:1], v7 offset:0
  ds_read_b64_tr_b16 a[2:3], v7 offset:2048
  ds_read_b64_tr_b16 a[4:5], v7 offset:4096
  ds_read_b64_tr_b16 a[6:7], v7 offset:6144
  ds_read_b64_tr_b16 a[8:9], v7 offset:8192
  ds_read_b64_tr_b16 a[10:11], v7 offset:10240
  ds_read_b64_tr_b16 a[12:13], v7 offset:12288
  ds_read_b64_tr_b16 a[14:15], v7 offset:14336
  ds_read_b64_tr_b16 a[16:17], v7 offset:16384
  ds_read_b64_tr_b16 a[18:19], v7 offset:18432
  ds_read_b64_tr_b16 a[20:21], v7 offset:20480
  ds_read_b64_tr_b16 a[22:23], v7 offset:22528
  ds_read_b64_tr_b16 a[24:25], v7 offset:24576
  ds_read_b64_tr_b16 a[26:27], v7 offset:26624
  ds_read_b64_tr_b16 a[28:29], v7 offset:28672
  ds_read_b64_tr_b16 a[30:31], v7 offset:30720
  ds_read_b64_tr_b16 a[32:33], v7 offset:32768
  ds_read_b64_tr_b16 a[34:35], v7 offset:34816
  ds_read_b64_tr_b16 a[36:37], v7 offset:36864
  ds_read_b64_tr_b16 a[38:39], v7 offset:38912
  s_waitcnt lgkmcnt(0)
  s_barrier
  s_waitcnt vmcnt(8)
  s_add_u32 m0, s44, 0
  s_add_u32 s41, s62, 0
  buffer_load_dwordx4 v5, s[32:35], s41 offen nt lds
  s_add_u32 m0, s44, 1024
  s_add_u32 s41, s62, 20480
  buffer_load_dwordx4 v5, s[32:35], s41 offen nt lds
  s_add_u32 m0, s44, 2048
  s_add_u32 s41, s62, 1280
  buffer_load_dwordx4 v5, s[32:35], s41 offen nt lds
  s_add_u32 m0, s44, 3072
  s_add_u32 s41, s62, 21760
  buffer_load_dwordx4 v5, s[32:35], s41 offen nt lds
  s_add_u32 m0, s44, 4096
  s_add_u32 s41, s62, 40960
  buffer_load_dwordx4 v5, s[32:35], s41 offen nt lds
  s_add_u32 m0, s44, 5120
  s_add_u32 s41, s62, 61440
  buffer_load_dwordx4 v5, s[32:35], s41 offen nt lds
  s_add_u32 m0, s44, 6144
  s_add_u32 s41, s62, 42240
  buffer_load_dwordx4 v5, s[32:35], s41 offen nt lds
  s_add_u32 m0, s44, 7168
  s_add_u32 s41, s62, 62720
  buffer_load_dwordx4 v5, s[32:35], s41 offen nt lds
  v_add_u32 v171, 81920, v10
  ds_read_b64_tr_b16 v[192:193], v171 offset:0
  ds_read_b64_tr_b16 v[194:195], v171 offset:2048
  ds_read_b64_tr_b16 v[196:197], v171 offset:4096
  ds_read_b64_tr_b16 v[198:199], v171 offset:6144
  v_add_u32 v171, 81920, v11
  ds_read_b64_tr_b16 v[216:217], v171 offset:0
  ds_read_b64_tr_b16 v[218:219], v171 offset:2048
  ds_read_b64_tr_b16 v[220:221], v171 offset:4096
  ds_read_b64_tr_b16 v[222:223], v171 offset:6144
  v_add_u32 v171, 81920, v12
  ds_read_b64_tr_b16 v[240:241], v171 offset:0
  ds_read_b64_tr_b16 v[242:243], v171 offset:2048
  ds_read_b64_tr_b16 v[244:245], v171 offset:4096
  ds_read_b64_tr_b16 v[246:247], v171 offset:6144
  v_add_u32 v171, 81920, v13
  ds_read_b64_tr_b16 a[248:249], v171 offset:0
  ds_read_b64_tr_b16 a[250:251], v171 offset:2048
  ds_read_b64_tr_b16 a[252:253], v171 offset:4096
  ds_read_b64_tr_b16 a[254:255], v171 offset:6144
  s_waitcnt lgkmcnt(0)
  s_waitcnt vmcnt(8)
  v_add_u32 v171, 122880, v10
  ds_read_b64_tr_b16 v[184:185], v171 offset:0
  ds_read_b64_tr_b16 v[186:187], v171 offset:2048
  ds_read_b64_tr_b16 v[188:189], v171 offset:4096
  ds_read_b64_tr_b16 v[190:191], v171 offset:6144
  v_add_u32 v171, 122880, v11
  ds_read_b64_tr_b16 v[208:209], v171 offset:0
  ds_read_b64_tr_b16 v[210:211], v171 offset:2048
  ds_read_b64_tr_b16 v[212:213], v171 offset:4096
  ds_read_b64_tr_b16 v[214:215], v171 offset:6144
  v_add_u32 v171, 122880, v12
  ds_read_b64_tr_b16 v[232:233], v171 offset:0
  ds_read_b64_tr_b16 v[234:235], v171 offset:2048
  ds_read_b64_tr_b16 v[236:237], v171 offset:4096
  ds_read_b64_tr_b16 v[238:239], v171 offset:6144
  v_add_u32 v171, 122880, v13
  ds_read_b64_tr_b16 a[240:241], v171 offset:0
  ds_read_b64_tr_b16 a[242:243], v171 offset:2048
  ds_read_b64_tr_b16 a[244:245], v171 offset:4096
  ds_read_b64_tr_b16 a[246:247], v171 offset:6144
  s_waitcnt lgkmcnt(0)
  s_waitcnt vmcnt(0)
  v_add_u32 v171, 0, v10
  ds_read_b64_tr_b16 v[176:177], v171 offset:0
  ds_read_b64_tr_b16 v[178:179], v171 offset:2048
  ds_read_b64_tr_b16 v[180:181], v171 offset:4096
  ds_read_b64_tr_b16 v[182:183], v171 offset:6144
  v_add_u32 v171, 0, v11
  ds_read_b64_tr_b16 v[200:201], v171 offset:0
  ds_read_b64_tr_b16 v[202:203], v171 offset:2048
  ds_read_b64_tr_b16 v[204:205], v171 offset:4096
  ds_read_b64_tr_b16 v[206:207], v171 offset:6144
  v_add_u32 v171, 0, v12
  ds_read_b64_tr_b16 v[224:225], v171 offset:0
  ds_read_b64_tr_b16 v[226:227], v171 offset:2048
  ds_read_b64_tr_b16 v[228:229], v171 offset:4096
  ds_read_b64_tr_b16 v[230:231], v171 offset:6144
  v_add_u32 v171, 0, v13
  ds_read_b64_tr_b16 v[248:249], v171 offset:0
  ds_read_b64_tr_b16 v[250:251], v171 offset:2048
  ds_read_b64_tr_b16 v[252:253], v171 offset:4096
  ds_read_b64_tr_b16 v[254:255], v171 offset:6144
  s_waitcnt lgkmcnt(0)
  s_barrier
  s_lshl_b32 s40, s16, 2
  s_add_u32 s40, s40, 32
  v_mov_b32 v171, s40
  s_mov_b32 s40, 0
  s_mov_b64 exec, 1
gw_58:
  buffer_load_dword v172, v171, s[12:15], 0 offen sc1
  s_add_u32 s40, s40, 1
  s_cmp_gt_u32 s40, 65536
  s_cbranch_scc1 chain_abort
  s_waitcnt vmcnt(0)
  v_cmp_gt_u32 vcc, 2, v172
  s_cbranch_vccz gk_59
  s_sleep 4
  s_branch gw_58
gk_59:
  s_mov_b64 exec, -1
  s_cmp_lt_u32 s36, 10
  s_cbranch_scc0 chain_nw
  s_cmp_lt_u32 s17, 2
  s_cbranch_scc1 chain_pro_c0w
  s_cmp_eq_u32 s17, 2
  s_cbranch_scc1 chain_pro_c1w
  s_branch chain_pro_c2w
chain_nw:
  s_cmp_lt_u32 s17, 2
  s_cbranch_scc1 chain_pro_c0n
  s_cmp_eq_u32 s17, 2
  s_cbranch_scc1 chain_pro_c1n
  s_branch chain_pro_c2n
chain_pro_c0w:
  s_mov_b32 s40, 0
cpw_60:
  v_cmp_gt_u32 vcc, 1, v167
  s_nop 0
  s_and_b32 vcc_lo, vcc_lo, 0xfff000
  s_and_b32 vcc_hi, vcc_hi, 0x10fffff0
  s_cmp_eq_u64 vcc, 0
  s_cbranch_scc1 cpo_61
  s_sleep 1
  buffer_load_dword v167, v162, s[8:11], 0 offen sc1
  s_add_u32 s40, s40, 1
  s_cmp_gt_u32 s40, 65536
  s_cbranch_scc1 chain_abort
  s_waitcnt vmcnt(0)
  s_branch cpw_60
cpo_61:
  v_readlane_b32 s41, v167, 60
  s_nop 0
  s_sub_u32 s41, s41, 1
  s_lshl_b32 s41, s41, 13
  s_add_u32 s64, s64, s41
  s_and_b32 s66, s39, 7
  s_mul_i32 s66, s66, 147456
  s_add_u32 s66, s66, s57
  s_and_b32 s67, s39, 3
  s_mul_i32 s67, s67, 227328
  s_add_u32 s67, s67, s60
  s_and_b32 s41, s39, 3
  s_mul_i32 s46, s41, 81920
  s_add_u32 s46, s46, s45
  s_lshl_b32 s42, s41, 15
  s_add_u32 s43, s47, s42
  s_add_u32 s49, s43, s53
  s_add_u32 s50, s43, s54
  s_mul_i32 s43, s41, 227328
  s_add_u32 s55, s58, s43
  s_add_u32 s56, s59, s43
  s_add_u32 s51, s48, s42
  s_add_u32 s52, s51, 4096
  s_mul_i32 s62, s41, 163840
  s_add_u32 s62, s62, s64
  s_lshl_b32 s42, s16, 8
  s_add_u32 s61, s62, s42
  s_xor_b32 s63, s61, 8192
  v_mov_b32 v92, 0
  v_mov_b32 v93, 0
  v_mov_b32 v94, 0
  v_mov_b32 v95, 0
  v_mov_b32 v96, 0
  v_mov_b32 v97, 0
  v_mov_b32 v98, 0
  v_mov_b32 v99, 0
  v_mov_b32 v100, 0
  v_mov_b32 v101, 0
  v_mov_b32 v102, 0
  v_mov_b32 v103, 0
  v_mov_b32 v104, 0
  v_mov_b32 v105, 0
  v_mov_b32 v106, 0
  v_mov_b32 v107, 0
  v_mov_b32 v68, 0
  v_mov_b32 v69, 0
  v_mov_b32 v70, 0
  v_mov_b32 v71, 0
  v_mov_b32 v72, 0
  v_mov_b32 v73, 0
  v_mov_b32 v74, 0
  v_mov_b32 v75, 0
  v_mov_b32 v76, 0
  v_mov_b32 v77, 0
  v_mov_b32 v78, 0
  v_mov_b32 v79, 0
chain_loop_c0w:
  s_mov_b32 s40, 0
  buffer_load_dwordx4 v[140:143], v154, s[8:11], s46 offen sc1
  buffer_load_dwordx4 v[144:147], v154, s[8:11], s46 offen offset:1024 sc1
  buffer_load_dword v148, v155, s[8:11], s46 offen sc1
  buffer_load_dword v149, v155, s[8:11], s46 offen offset:256 sc1
  s_nop 15
  s_nop 15
mq_62:
  buffer_load_dwordx4 v[108:111], v154, s[8:11], s46 offen sc1
  buffer_load_dwordx4 v[112:115], v154, s[8:11], s46 offen offset:1024 sc1
  buffer_load_dword v150, v155, s[8:11], s46 offen sc1
  buffer_load_dword v151, v155, s[8:11], s46 offen offset:256 sc1
  s_add_u32 s40, s40, 1
  s_cmp_gt_u32 s40, 65536
  s_cbranch_scc1 chain_abort
  s_waitcnt vmcnt(4)
  v_max3_u32 v171, v140, v144, v148
  v_max_u32 v171, v171, v149
  v_cmp_eq_u32 vcc, -1, v171
  ds_write_b128 v154, v[140:143]
  ds_write_b128 v154, v[144:147] offset:1024
  ds_write2st64_b32 v155, v148, v149 offset0:0 offset1:1
  s_cbranch_vccz mq_62_ok
  buffer_load_dwordx4 v[140:143], v154, s[8:11], s46 offen sc1
  buffer_load_dwordx4 v[144:147], v154, s[8:11], s46 offen offset:1024 sc1
  buffer_load_dword v148, v155, s[8:11], s46 offen sc1
  buffer_load_dword v149, v155, s[8:11], s46 offen offset:256 sc1
  s_waitcnt vmcnt(4)
  v_max3_u32 v171, v108, v112, v150
  v_max_u32 v171, v171, v151
  v_cmp_eq_u32 vcc, -1, v171
  ds_write_b128 v154, v[108:111]
  ds_write_b128 v154, v[112:115] offset:1024
  ds_write2st64_b32 v155, v150, v151 offset0:0 offset1:1
  s_cbranch_vccz mq_62_ok
  s_branch mq_62
mq_62_ok:
  s_waitcnt lgkmcnt(0)
  s_barrier
  ds_read_b128 v[4:7], v152 offset:0
  ds_read_b128 v[8:11], v152 offset:1024
  ds_read_b128 v[12:15], v152 offset:2048
  ds_read_b128 v[16:19], v152 offset:3072
  ds_read_b128 v[20:23], v152 offset:4096
  ds_read_b128 v[24:27], v152 offset:5120
  ds_read_b128 v[28:31], v152 offset:6144
  ds_read_b128 v[32:35], v152 offset:7168
  ds_read_b128 v[36:39], v152 offset:8192
  ds_read_b128 v[40:43], v152 offset:9216
  s_waitcnt lgkmcnt(9)
  v_smfmac_f32_16x16x64_bf16 v[76:79], v[4:7], a[160:167], v164
  buffer_load_dwordx4 v[60:63], v152, s[8:11], s66 offen offset:0 sc1
  s_waitcnt lgkmcnt(8)
  v_smfmac_f32_16x16x64_bf16 v[76:79], v[8:11], a[168:175], v164
  s_waitcnt lgkmcnt(7)
  v_smfmac_f32_16x16x64_bf16 v[76:79], v[12:15], a[176:183], v164
  buffer_load_dwordx4 v[64:67], v152, s[8:11], s66 offen offset:1024 sc1
  s_waitcnt lgkmcnt(6)
  v_smfmac_f32_16x16x64_bf16 v[76:79], v[16:19], a[184:191], v164
  s_waitcnt lgkmcnt(5)
  v_smfmac_f32_16x16x64_bf16 v[76:79], v[20:23], a[192:199], v164
  buffer_load_dwordx4 v[44:47], v152, s[8:11], s67 offen offset:0 sc1
  s_waitcnt lgkmcnt(4)
  v_smfmac_f32_16x16x64_bf16 v[76:79], v[24:27], a[200:207], v164
  s_waitcnt lgkmcnt(3)
  v_smfmac_f32_16x16x64_bf16 v[76:79], v[28:31], a[208:215], v164
  s_waitcnt lgkmcnt(2)
  v_smfmac_f32_16x16x64_bf16 v[76:79], v[32:35], a[216:223], v164
  buffer_load_dwordx4 v[48:51], v152, s[8:11], s67 offen offset:1024 sc1
  s_waitcnt lgkmcnt(1)
  v_smfmac_f32_16x16x64_bf16 v[76:79], v[36:39], a[224:231], v164
  s_waitcnt lgkmcnt(0)
  v_smfmac_f32_16x16x64_bf16 v[76:79], v[40:43], a[232:239], v164
  s_nop 2
  v_smfmac_f32_16x16x64_bf16 v[68:71], v[4:7], a[0:7], v164
  s_nop 2
  v_smfmac_f32_16x16x64_bf16 v[68:71], v[8:11], a[8:15], v164
  v_add_f32 v76, v76, v78
  v_add_f32 v77, v77, v79
  v_smfmac_f32_16x16x64_bf16 v[68:71], v[12:15], a[16:23], v164
  v_cvt_pk_bf16_f32 v171, v76, v77
  s_nop 0
  v_smfmac_f32_16x16x64_bf16 v[68:71], v[16:19], a[24:31], v164
  v_mov_b32_dpp v172, v171 row_ror:4 row_mask:0xf bank_mask:0xa
  s_nop 0
  v_smfmac_f32_16x16x64_bf16 v[68:71], v[20:23], a[32:39], v164
  v_mov_b32_dpp v172, v171 row_ror:12 row_mask:0xf bank_mask:0x5
  s_nop 0
  v_smfmac_f32_16x16x64_bf16 v[68:71], v[24:27], a[40:47], v164
  v_perm_b32 v171, v172, v171, v165
  buffer_store_dword v171, v158, s[8:11], s50 offen
  v_smfmac_f32_16x16x64_bf16 v[68:71], v[28:31], a[48:55], v164
  buffer_load_dwordx4 v[52:55], v152, s[8:11], s67 offen offset:2048 sc1
  v_smfmac_f32_16x16x64_bf16 v[68:71], v[32:35], a[56:63], v164
  v_smfmac_f32_16x16x64_bf16 v[68:71], v[36:39], a[64:71], v164
  buffer_load_dwordx4 v[56:59], v152, s[8:11], s67 offen offset:3072 sc1
  v_smfmac_f32_16x16x64_bf16 v[68:71], v[40:43], a[72:79], v164
  s_nop 2
  v_smfmac_f32_16x16x64_bf16 v[72:75], v[4:7], a[80:87], v164
  s_nop 2
  v_smfmac_f32_16x16x64_bf16 v[72:75], v[8:11], a[88:95], v164
  v_add_f32 v68, v68, v70
  v_add_f32 v69, v69, v71
  v_smfmac_f32_16x16x64_bf16 v[72:75], v[12:15], a[96:103], v164
  v_cvt_pk_bf16_f32 v128, v68, v69
  ds_write2_b32 v156, v128, v128 offset0:0 offset1:4
  v_smfmac_f32_16x16x64_bf16 v[72:75], v[16:19], a[104:111], v164
  buffer_load_dword v167, v162, s[8:11], 0 offen sc1
  v_smfmac_f32_16x16x64_bf16 v[72:75], v[20:23], a[112:119], v164
  v_smfmac_f32_16x16x64_bf16 v[72:75], v[24:27], a[120:127], v164
  v_smfmac_f32_16x16x64_bf16 v[72:75], v[28:31], a[128:135], v164
  ds_read_b64_tr_b16 v[132:133], v153 offset:10240
  ds_read_b64_tr_b16 v[134:135], v153 offset:10752
  v_smfmac_f32_16x16x64_bf16 v[72:75], v[32:35], a[136:143], v164
  ds_read_b64_tr_b16 v[136:137], v153 offset:11264
  ds_read_b64_tr_b16 v[138:139], v153 offset:11776
  v_smfmac_f32_16x16x64_bf16 v[72:75], v[36:39], a[144:151], v164
  v_smfmac_f32_16x16x64_bf16 v[72:75], v[40:43], a[152:159], v164
  s_waitcnt vmcnt(6)
  s_nop 6
  v_add_f32 v72, v72, v74
  v_add_f32 v73, v73, v75
  v_cvt_pk_bf16_f32 v129, v72, v73
  ds_write2_b32 v157, v129, v129 offset0:0 offset1:1
  s_waitcnt lgkmcnt(1)
  v_mfma_f32_16x16x32_bf16 v[80:83], v[60:63], v[132:135], 0
  v_mfma_f32_16x16x32_bf16 v[80:83], v[64:67], v[136:139], v[80:83]
  buffer_load_dwordx4 v[4:7], v152, s[8:11], s52 offen offset:0 sc1
  buffer_load_dwordx4 v[8:11], v152, s[8:11], s52 offen offset:1024 sc1
  buffer_load_dwordx4 v[12:15], v152, s[8:11], s52 offen offset:2048 sc1
  s_nop 4
  v_cmp_u_f32 vcc, v80, v81
  s_mov_b64 exec, s[78:79]
  s_cbranch_vccnz sx_63_r
sx_63:
  buffer_store_dwordx4 v[80:83], v152, s[8:11], s49 offen
  s_mov_b64 exec, -1
  s_mov_b32 s40, 0
  s_nop 15
  s_nop 15
  s_nop 3
  s_waitcnt vmcnt(1)
gv_67:
  v_max3_u32 v171, v4, v8, v12
  v_cmp_eq_u32 vcc, -1, v171
  s_cbranch_vccnz gv_67_r
  v_smfmac_f32_16x16x64_bf16 v[92:95], v[4:7], v[176:183], v164
  v_smfmac_f32_16x16x64_bf16 v[96:99], v[4:7], v[200:207], v164
  v_smfmac_f32_16x16x64_bf16 v[100:103], v[4:7], v[224:231], v164
  v_smfmac_f32_16x16x64_bf16 v[104:107], v[4:7], v[248:255], v164
  buffer_load_dwordx4 v[20:23], v152, s[8:11], s51 offen offset:0 sc1
  v_smfmac_f32_16x16x64_bf16 v[92:95], v[8:11], v[184:191], v164
  buffer_load_dwordx4 v[24:27], v152, s[8:11], s51 offen offset:1024 sc1
  v_smfmac_f32_16x16x64_bf16 v[96:99], v[8:11], v[208:215], v164
  buffer_load_dwordx4 v[28:31], v152, s[8:11], s51 offen offset:2048 sc1
  v_smfmac_f32_16x16x64_bf16 v[100:103], v[8:11], v[232:239], v164
  v_smfmac_f32_16x16x64_bf16 v[104:107], v[8:11], a[240:247], v164
  v_smfmac_f32_16x16x64_bf16 v[92:95], v[12:15], v[192:199], v164
  buffer_load_dwordx3 v[16:18], v152, s[8:11], s51 offen offset:3072 sc1
  v_smfmac_f32_16x16x64_bf16 v[96:99], v[12:15], v[216:223], v164
  v_smfmac_f32_16x16x64_bf16 v[100:103], v[12:15], v[240:247], v164
  v_smfmac_f32_16x16x64_bf16 v[104:107], v[12:15], a[248:255], v164
  s_nop 3
  v_cvt_pk_bf16_f32 v108, v92, v93
  v_cvt_pk_bf16_f32 v109, v94, v95
  s_nop 0
  v_cvt_pk_bf16_f32 v112, v100, v101
  v_cvt_pk_bf16_f32 v113, v102, v103
  v_cvt_pk_bf16_f32 v110, v96, v97
  v_cvt_pk_bf16_f32 v111, v98, v99
  v_cvt_pk_bf16_f32 v114, v104, v105
  v_cvt_pk_bf16_f32 v115, v106, v107
  s_add_u32 s39, s39, 1
  s_add_u32 s65, s62, s72
  s_waitcnt vmcnt(1)
gx_64:
  v_pk_add_f32 v[68:69], v[20:21], v[24:25]
  v_pk_add_f32 v[70:71], v[22:23], v[26:27]
  v_pk_add_f32 v[68:69], v[68:69], v[28:29]
  v_pk_add_f32 v[70:71], v[70:71], v[30:31]
  v_cmp_u_f32 vcc, v68, v68
  v_pk_mul_f32 v[68:69], v[68:69], s[82:83]
  v_pk_mul_f32 v[70:71], v[70:71], s[82:83]
  v_exp_f32 v68, v68
  s_cbranch_vccnz gx_64_r
  v_exp_f32 v69, v69
  v_exp_f32 v70, v70
  v_exp_f32 v71, v71
  s_waitcnt vmcnt(0)
gm_65:
  v_add_f32 v72, v16, v17
  v_cvt_pk_bf16_f32 v148, v68, v69
  v_cvt_pk_bf16_f32 v149, v70, v71
  v_add_f32 v72, v72, v18
  v_cmp_u_f32 vcc, v72, v72
  v_mov_b32_dpp v116, v148 quad_perm:[0,1,2,3] row_mask:0xf bank_mask:0x3
  v_mov_b32_dpp v117, v149 quad_perm:[0,1,2,3] row_mask:0xf bank_mask:0x3
  v_mul_f32 v72, s82, v72
  v_mov_b32_dpp v118, v148 row_ror:8 row_mask:0xf bank_mask:0x3
  v_mov_b32_dpp v119, v149 row_ror:8 row_mask:0xf bank_mask:0x3
  v_exp_f32 v72, v72
  s_cbranch_vccnz gm_65_r
  v_mfma_f32_16x16x32_bf16 v[80:83], v[88:91], v[116:119], 0
  v_mov_b32_dpp v120, v148 row_ror:8 row_mask:0xf bank_mask:0xc
  v_mov_b32_dpp v121, v149 row_ror:8 row_mask:0xf bank_mask:0xc
  v_mov_b32_dpp v122, v148 quad_perm:[0,1,2,3] row_mask:0xf bank_mask:0xc
  v_mov_b32_dpp v123, v149 quad_perm:[0,1,2,3] row_mask:0xf bank_mask:0xc
  v_mfma_f32_16x16x32_bf16 v[140:143], v[44:47], v[116:119], 0
  v_mov_b32_dpp v73, v72 row_ror:8 row_mask:0xf bank_mask:0xf
  v_cvt_pk_bf16_f32 v150, v72, v73
  v_mfma_f32_16x16x32_bf16 v[144:147], v[52:55], v[116:119], 0
  s_nop 0
  v_mov_b32_dpp v124, v150 quad_perm:[0,1,2,3] row_mask:0xf bank_mask:0x3
  v_mov_b32_dpp v125, v150 quad_perm:[0,1,2,3] row_mask:0xf bank_mask:0x3
  v_mfma_f32_16x16x32_bf16 v[140:143], v[48:51], v[120:123], v[140:143]
  v_mov_b32_dpp v126, v150 row_ror:8 row_mask:0xf bank_mask:0xc
  v_mov_b32_dpp v127, v150 row_ror:8 row_mask:0xf bank_mask:0xc
  v_mfma_f32_16x16x32_bf16 v[144:147], v[56:59], v[120:123], v[144:147]
  v_mfma_f32_16x16x16_bf16 v[80:83], v[130:131], v[124:125], v[80:83]
  s_nop 1
  v_mfma_f32_16x16x16_bf16 v[140:143], v[108:109], v[124:125], v[140:143]
  s_nop 1
  v_mfma_f32_16x16x16_bf16 v[144:147], v[112:113], v[124:125], v[144:147]
  v_mfma_f32_16x16x16_bf16 v[140:143], v[110:111], v[126:127], v[140:143]
  s_nop 0
  v_subrev_u32 v171, 0x21800000, v80
  v_rcp_f32 v128, v80
  v_mfma_f32_16x16x16_bf16 v[144:147], v[114:115], v[126:127], v[144:147]
  v_cmp_lt_u32 vcc, 0x50000000, v171
  ds_write_b32 v169, v128
  s_and_b64 vcc, vcc, s[74:75]
  s_cbranch_vccnz gz_66_r
gz_66:
  s_cmp_eq_u32 s39, 64
  s_cbranch_scc1 chain_last_c0w
  ds_write_b128 v159, v[140:143] offset:0
  s_nop 0
  ds_write_b128 v159, v[144:147] offset:1024
  s_waitcnt lgkmcnt(0)
  s_barrier
  ds_read_b128 v[108:111], v170
  ds_read_b64 v[132:133], v160 offset:0
  ds_read_b64 v[134:135], v160 offset:2048
  ds_read_b64 v[136:137], v160 offset:4096
  ds_read_b64 v[138:139], v160 offset:6144
  s_waitcnt lgkmcnt(3)
  v_pk_mul_f32 v[128:129], v[132:133], v[108:109] op_sel_hi:[1,0]
  s_waitcnt lgkmcnt(2)
  v_pk_fma_f32 v[128:129], v[134:135], v[108:109], v[128:129] op_sel:[0,1,0]
  s_waitcnt lgkmcnt(1)
  v_pk_fma_f32 v[128:129], v[136:137], v[110:111], v[128:129] op_sel_hi:[1,0,1]
  s_waitcnt lgkmcnt(0)
  v_pk_fma_f32 v[128:129], v[138:139], v[110:111], v[128:129] op_sel:[0,1,0]
  v_cvt_pk_bf16_f32 v128, v128, v129
  buffer_store_dword v128, v168, s[8:11], s63 offen sc1
  buffer_store_dword v128, v168, s[8:11], s61 offen sc1
  s_xor_b32 s68, s65, 1024
  ds_bpermute_b32 v42, v175, v128
  v_mov_b32 v4, 0
  v_mov_b32 v5, 0
  v_mov_b32 v6, 0
  v_mov_b32 v7, 0
  v_pk_add_f32 v[92:93], v[92:93], v[94:95]
  v_cvt_pk_bf16_f32 v80, v92, v93
  v_pk_add_f32 v[96:97], v[96:97], v[98:99]
  v_cvt_pk_bf16_f32 v81, v96, v97
  v_pk_add_f32 v[100:101], v[100:101], v[102:103]
  v_cvt_pk_bf16_f32 v82, v100, v101
  v_pk_add_f32 v[104:105], v[104:105], v[106:107]
  v_cvt_pk_bf16_f32 v83, v104, v105
  buffer_store_dwordx4 v[80:83], v152, s[8:11], s56 offen
  s_add_u32 s43, s39, 1
  v_mov_b32 v174, s39
  s_mov_b32 s40, 0
cpw_68:
  v_cmp_gt_u32 vcc, s43, v167
  s_nop 0
  s_and_b32 vcc_lo, vcc_lo, 0xfff000
  s_and_b32 vcc_hi, vcc_hi, 0xfffff0
  s_cmp_eq_u64 vcc, 0
  s_cbranch_scc1 cpo_69
  s_sleep 1
  buffer_load_dword v167, v162, s[8:11], 0 offen sc1
  s_add_u32 s40, s40, 1
  s_cmp_gt_u32 s40, 65536
  s_cbranch_scc1 chain_abort
  s_waitcnt vmcnt(0)
  s_branch cpw_68
cpo_69:
  s_and_b32 s41, s39, 3
  s_mul_i32 s46, s41, 81920
  s_add_u32 s46, s46, s45
  s_lshl_b32 s42, s41, 15
  s_add_u32 s43, s47, s42
  s_add_u32 s49, s43, s53
  s_add_u32 s50, s43, s54
  s_mul_i32 s43, s41, 227328
  s_add_u32 s55, s58, s43
  s_add_u32 s56, s59, s43
  s_add_u32 s51, s48, s42
  s_add_u32 s52, s51, 4096
  s_mul_i32 s62, s41, 163840
  s_add_u32 s62, s62, s64
  s_lshl_b32 s42, s16, 8
  s_add_u32 s61, s62, s42
  s_xor_b32 s63, s61, 8192
  v_mov_b32 v92, 0
  v_mov_b32 v93, 0
  v_mov_b32 v94, 0
  v_mov_b32 v95, 0
  v_mov_b32 v96, 0
  v_mov_b32 v97, 0
  v_mov_b32 v98, 0
  v_mov_b32 v99, 0
  v_mov_b32 v100, 0
  v_mov_b32 v101, 0
  v_mov_b32 v102, 0
  v_mov_b32 v103, 0
  v_mov_b32 v104, 0
  v_mov_b32 v105, 0
  v_mov_b32 v106, 0
  v_mov_b32 v107, 0
  v_mov_b32 v68, 0
  v_mov_b32 v69, 0
  v_mov_b32 v70, 0
  v_mov_b32 v71, 0
  v_mov_b32 v72, 0
  v_mov_b32 v73, 0
  v_mov_b32 v74, 0
  v_mov_b32 v75, 0
  v_mov_b32 v76, 0
  v_mov_b32 v77, 0
  v_mov_b32 v78, 0
  v_mov_b32 v79, 0
  s_nop 15
  s_nop 15
  s_nop 7
  s_mov_b64 exec, s[70:71]
  buffer_load_dwordx4 v[4:7], v152, s[8:11], s65 offen sc1
  s_mov_b64 exec, -1
  buffer_load_dwordx4 v[8:11], v152, s[8:11], s68 offen sc1
  s_waitcnt lgkmcnt(0)
  v_lshlrev_b32 v40, 16, v42
  v_and_b32 v41, 0xffff0000, v42
  s_and_b32 s66, s39, 7
  s_mul_i32 s66, s66, 147456
  s_add_u32 s66, s66, s57
  s_and_b32 s67, s39, 3
  s_mul_i32 s67, s67, 227328
  s_add_u32 s67, s67, s60
  s_mov_b32 s40, 0
  s_waitcnt vmcnt(0)
xp_70:
  v_mfma_f32_16x16x32_bf16 v[36:39], v[84:87], v[4:7], v[40:43]
  v_mfma_f32_16x16x32_bf16 v[36:39], v[84:87], v[8:11], v[36:39]
  s_nop 7
  v_cmp_u_f32 vcc, v36, v37
  v_cvt_pk_bf16_f32 v172, v36, v37
  s_cbranch_vccnz xp_70_r
xp_70_ok:
  buffer_store_dword v172, v161, s[8:11], s46 offen
  buffer_store_dword v174, v163, s[8:11], 0 offen
  s_branch chain_loop_c0w
sx_63_r:
  s_mov_b64 exec, -1
  ds_read_b64_tr_b16 v[132:133], v153 offset:10240
  ds_read_b64_tr_b16 v[134:135], v153 offset:10752
  ds_read_b64_tr_b16 v[136:137], v153 offset:11264
  ds_read_b64_tr_b16 v[138:139], v153 offset:11776
  s_add_u32 s40, s40, 1
  s_cmp_gt_u32 s40, 65536
  s_cbranch_scc1 chain_abort
  s_waitcnt lgkmcnt(0)
  v_mfma_f32_16x16x32_bf16 v[80:83], v[60:63], v[132:135], 0
  v_mfma_f32_16x16x32_bf16 v[80:83], v[64:67], v[136:139], v[80:83]
  s_nop 7
  v_cmp_u_f32 vcc, v80, v81
  s_mov_b64 exec, s[78:79]
  s_cbranch_vccnz sx_63_r
  s_branch sx_63
gx_64_r:
  v_max3_u32 v173, v20, v21, v22
  v_max_u32 v173, v173, v23
  v_cmp_eq_u32 vcc, -1, v173
  s_cbranch_vccz gx_64_s0
  s_mov_b64 exec, vcc
  buffer_load_dwordx4 v[20:23], v152, s[8:11], s51 offen offset:0 sc1
  s_mov_b64 exec, -1
gx_64_s0:
  v_max3_u32 v173, v24, v25, v26
  v_max_u32 v173, v173, v27
  v_cmp_eq_u32 vcc, -1, v173
  s_cbranch_vccz gx_64_s1
  s_mov_b64 exec, vcc
  buffer_load_dwordx4 v[24:27], v152, s[8:11], s51 offen offset:1024 sc1
  s_mov_b64 exec, -1
gx_64_s1:
  v_max3_u32 v173, v28, v29, v30
  v_max_u32 v173, v173, v31
  v_cmp_eq_u32 vcc, -1, v173
  s_cbranch_vccz gx_64_s2
  s_mov_b64 exec, vcc
  buffer_load_dwordx4 v[28:31], v152, s[8:11], s51 offen offset:2048 sc1
  s_mov_b64 exec, -1
gx_64_s2:
  buffer_load_dwordx3 v[16:18], v152, s[8:11], s51 offen offset:3072 sc1
  s_add_u32 s40, s40, 1
  s_cmp_gt_u32 s40, 65536
  s_cbranch_scc1 chain_abort
  s_waitcnt vmcnt(0)
  s_branch gx_64
gm_65_r:
  v_max3_u32 v173, v16, v17, v18
  v_cmp_eq_u32 vcc, -1, v173
  s_cbranch_vccz gm_65_s0
  s_mov_b64 exec, vcc
  buffer_load_dwordx3 v[16:18], v152, s[8:11], s51 offen offset:3072 sc1
  s_mov_b64 exec, -1
gm_65_s0:
  s_add_u32 s40, s40, 1
  s_cmp_gt_u32 s40, 65536
  s_cbranch_scc1 chain_abort
  s_waitcnt vmcnt(0)
  s_branch gm_65
gv_67_r:
  v_max3_u32 v173, v4, v5, v6
  v_max_u32 v173, v173, v7
  v_cmp_eq_u32 vcc, -1, v173
  s_cbranch_vccz gv_67_s0
  s_mov_b64 exec, vcc
  buffer_load_dwordx4 v[4:7], v152, s[8:11], s52 offen offset:0 sc1
  s_mov_b64 exec, -1
gv_67_s0:
  v_max3_u32 v173, v8, v9, v10
  v_max_u32 v173, v173, v11
  v_cmp_eq_u32 vcc, -1, v173
  s_cbranch_vccz gv_67_s1
  s_mov_b64 exec, vcc
  buffer_load_dwordx4 v[8:11], v152, s[8:11], s52 offen offset:1024 sc1
  s_mov_b64 exec, -1
gv_67_s1:
  v_max3_u32 v173, v12, v13, v14
  v_max_u32 v173, v173, v15
  v_cmp_eq_u32 vcc, -1, v173
  s_cbranch_vccz gv_67_s2
  s_mov_b64 exec, vcc
  buffer_load_dwordx4 v[12:15], v152, s[8:11], s52 offen offset:2048 sc1
  s_mov_b64 exec, -1
gv_67_s2:
  s_add_u32 s40, s40, 1
  s_cmp_gt_u32 s40, 65536
  s_cbranch_scc1 chain_abort
  s_waitcnt vmcnt(0)
  s_branch gv_67
gz_66_r:
  v_pk_add_f32 v[68:69], v[20:21], v[24:25]
  v_pk_add_f32 v[70:71], v[22:23], v[26:27]
  v_pk_add_f32 v[68:69], v[68:69], v[28:29]
  v_pk_add_f32 v[70:71], v[70:71], v[30:31]
  v_add_f32 v72, v16, v17
  v_add_f32 v72, v72, v18
  v_max3_f32 v171, v68, v69, v70
  v_max3_f32 v171, v171, v71, v72
  s_nop 1
  v_max_f32_dpp v171, v171, v171 row_ror:8 row_mask:0xf bank_mask:0xf
  v_mov_b32 v172, v171
  s_nop 1
  v_permlane16_swap_b32 v171, v172
  v_max_f32 v171, v171, v172
  v_mov_b32 v172, v171
  s_nop 1
  v_permlane32_swap_b32 v171, v172
  v_max_f32 v171, v171, v172
  v_sub_f32 v68, v68, v171
  v_mul_f32 v68, s82, v68
  v_exp_f32 v68, v68
  v_sub_f32 v69, v69, v171
  v_mul_f32 v69, s82, v69
  v_exp_f32 v69, v69
  v_sub_f32 v70, v70, v171
  v_mul_f32 v70, s82, v70
  v_exp_f32 v70, v70
  v_sub_f32 v71, v71, v171
  v_mul_f32 v71, s82, v71
  v_exp_f32 v71, v71
  v_sub_f32 v72, v72, v171
  v_mul_f32 v72, s82, v72
  v_exp_f32 v72, v72
  v_cvt_pk_bf16_f32 v148, v68, v69
  v_cvt_pk_bf16_f32 v149, v70, v71
  s_nop 0
  v_mov_b32_dpp v116, v148 quad_perm:[0,1,2,3] row_mask:0xf bank_mask:0x3
  v_mov_b32_dpp v117, v149 quad_perm:[0,1,2,3] row_mask:0xf bank_mask:0x3
  v_mov_b32_dpp v118, v148 row_ror:8 row_mask:0xf bank_mask:0x3
  v_mov_b32_dpp v119, v149 row_ror:8 row_mask:0xf bank_mask:0x3
  v_mov_b32_dpp v120, v148 row_ror:8 row_mask:0xf bank_mask:0xc
  v_mov_b32_dpp v121, v149 row_ror:8 row_mask:0xf bank_mask:0xc
  v_mov_b32_dpp v122, v148 quad_perm:[0,1,2,3] row_mask:0xf bank_mask:0xc
  v_mov_b32_dpp v123, v149 quad_perm:[0,1,2,3] row_mask:0xf bank_mask:0xc
  v_mov_b32_dpp v73, v72 row_ror:8 row_mask:0xf bank_mask:0xf
  v_cvt_pk_bf16_f32 v150, v72, v73
  s_nop 1
  v_mov_b32_dpp v124, v150 quad_perm:[0,1,2,3] row_mask:0xf bank_mask:0x3
  v_mov_b32_dpp v125, v150 quad_perm:[0,1,2,3] row_mask:0xf bank_mask:0x3
  v_mov_b32_dpp v126, v150 row_ror:8 row_mask:0xf bank_mask:0xc
  v_mov_b32_dpp v127, v150 row_ror:8 row_mask:0xf bank_mask:0xc
  v_mfma_f32_16x16x32_bf16 v[80:83], v[88:91], v[116:119], 0
  v_mfma_f32_16x16x32_bf16 v[140:143], v[44:47], v[116:119], 0
  v_mfma_f32_16x16x32_bf16 v[144:147], v[52:55], v[116:119], 0
  v_mfma_f32_16x16x32_bf16 v[140:143], v[48:51], v[120:123], v[140:143]
  v_mfma_f32_16x16x32_bf16 v[144:147], v[56:59], v[120:123], v[144:147]
  s_nop 1
  v_mfma_f32_16x16x16_bf16 v[80:83], v[130:131], v[124:125], v[80:83]
  s_nop 1
  v_mfma_f32_16x16x16_bf16 v[140:143], v[108:109], v[124:125], v[140:143]
  v_mfma_f32_16x16x16_bf16 v[144:147], v[112:113], v[124:125], v[144:147]
  v_mfma_f32_16x16x16_bf16 v[140:143], v[110:111], v[126:127], v[140:143]
  v_mfma_f32_16x16x16_bf16 v[144:147], v[114:115], v[126:127], v[144:147]
  s_nop 1
  v_rcp_f32 v128, v80
  s_nop 0
  ds_write_b32 v169, v128
  s_branch gz_66
xp_70_r:
  v_max3_u32 v173, v4, v5, v6
  v_max_u32 v173, v173, v7
  v_cmp_eq_u32 vcc, -1, v173
  s_cbranch_vccz xp_70_s0
  s_mov_b64 exec, vcc
  buffer_load_dwordx4 v[4:7], v152, s[8:11], s65 offen sc1
  s_mov_b64 exec, -1
  s_mov_b64 exec, -1
xp_70_s0:
  v_max3_u32 v173, v8, v9, v10
  v_max_u32 v173, v173, v11
  v_cmp_eq_u32 vcc, -1, v173
  s_cbranch_vccz xp_70_s1
  s_mov_b64 exec, vcc
  buffer_load_dwordx4 v[8:11], v152, s[8:11], s68 offen sc1
  s_mov_b64 exec, -1
xp_70_s1:
  s_add_u32 s40, s40, 1
  s_cmp_gt_u32 s40, 65536
  s_cbranch_scc1 chain_abort
  s_waitcnt vmcnt(0)
  s_branch xp_70
chain_last_c0w:
  v_pk_add_f32 v[92:93], v[92:93], v[94:95]
  v_cvt_pk_bf16_f32 v80, v92, v93
  v_pk_add_f32 v[96:97], v[96:97], v[98:99]
  v_cvt_pk_bf16_f32 v81, v96, v97
  v_pk_add_f32 v[100:101], v[100:101], v[102:103]
  v_cvt_pk_bf16_f32 v82, v100, v101
  v_pk_add_f32 v[104:105], v[104:105], v[106:107]
  v_cvt_pk_bf16_f32 v83, v104, v105
  buffer_store_dwordx4 v[80:83], v152, s[8:11], s56 offen
  s_waitcnt lgkmcnt(0)
  s_barrier
  v_mov_b32 v174, s39
  s_waitcnt vmcnt(0)
  buffer_store_dword v174, v163, s[8:11], 0 offen
  s_branch chain_end
chain_pro_c1w:
  s_mov_b32 s40, 0
cpw_71:
  v_cmp_gt_u32 vcc, 1, v167
  s_nop 0
  s_and_b32 vcc_lo, vcc_lo, 0xfff000
  s_and_b32 vcc_hi, vcc_hi, 0x10fffff0
  s_cmp_eq_u64 vcc, 0
  s_cbranch_scc1 cpo_72
  s_sleep 1
  buffer_load_dword v167, v162, s[8:11], 0 offen sc1
  s_add_u32 s40, s40, 1
  s_cmp_gt_u32 s40, 65536
  s_cbranch_scc1 chain_abort
  s_waitcnt vmcnt(0)
  s_branch cpw_71
cpo_72:
  v_readlane_b32 s41, v167, 60
  s_nop 0
  s_sub_u32 s41, s41, 1
  s_lshl_b32 s41, s41, 13
  s_add_u32 s64, s64, s41
  s_and_b32 s67, s39, 3
  s_mul_i32 s67, s67, 227328
  s_add_u32 s67, s67, s60
  s_and_b32 s41, s39, 3
  s_mul_i32 s46, s41, 81920
  s_add_u32 s46, s46, s45
  s_lshl_b32 s42, s41, 15
  s_add_u32 s43, s47, s42
  s_add_u32 s49, s43, s53
  s_add_u32 s50, s43, s54
  s_mul_i32 s43, s41, 227328
  s_add_u32 s55, s58, s43
  s_add_u32 s56, s59, s43
  s_add_u32 s51, s48, s42
  s_add_u32 s52, s51, 4096
  s_mul_i32 s62, s41, 163840
  s_add_u32 s62, s62, s64
  s_lshl_b32 s42, s16, 8
  s_add_u32 s61, s62, s42
  s_xor_b32 s63, s61, 8192
  v_mov_b32 v92, 0
  v_mov_b32 v93, 0
  v_mov_b32 v94, 0
  v_mov_b32 v95, 0
  v_mov_b32 v96, 0
  v_mov_b32 v97, 0
  v_mov_b32 v98, 0
  v_mov_b32 v99, 0
  v_mov_b32 v100, 0
  v_mov_b32 v101, 0
  v_mov_b32 v102, 0
  v_mov_b32 v103, 0
  v_mov_b32 v104, 0
  v_mov_b32 v105, 0
  v_mov_b32 v106, 0
  v_mov_b32 v107, 0
  v_mov_b32 v68, 0
  v_mov_b32 v69, 0
  v_mov_b32 v70, 0
  v_mov_b32 v71, 0
  v_mov_b32 v72, 0
  v_mov_b32 v73, 0
  v_mov_b32 v74, 0
  v_mov_b32 v75, 0
  v_mov_b32 v76, 0
  v_mov_b32 v77, 0
  v_mov_b32 v78, 0
  v_mov_b32 v79, 0
  v_mov_b32 v16, -1
  v_mov_b32 v17, -1
  v_mov_b32 v18, -1
  v_mov_b32 v19, -1
  ds_write_b128 v152, v[16:19] offset:10240
  ds_write_b128 v152, v[16:19] offset:11264
chain_loop_c1w:
  s_mov_b32 s40, 0
  buffer_load_dwordx4 v[140:143], v154, s[8:11], s46 offen sc1
  buffer_load_dwordx4 v[144:147], v154, s[8:11], s46 offen offset:1024 sc1
  buffer_load_dword v148, v155, s[8:11], s46 offen sc1
  buffer_load_dword v149, v155, s[8:11], s46 offen offset:256 sc1
  s_nop 15
  s_nop 15
mq_73:
  buffer_load_dwordx4 v[108:111], v154, s[8:11], s46 offen sc1
  buffer_load_dwordx4 v[112:115], v154, s[8:11], s46 offen offset:1024 sc1
  buffer_load_dword v150, v155, s[8:11], s46 offen sc1
  buffer_load_dword v151, v155, s[8:11], s46 offen offset:256 sc1
  s_add_u32 s40, s40, 1
  s_cmp_gt_u32 s40, 65536
  s_cbranch_scc1 chain_abort
  s_waitcnt vmcnt(4)
  v_max3_u32 v171, v140, v144, v148
  v_max_u32 v171, v171, v149
  v_cmp_eq_u32 vcc, -1, v171
  ds_write_b128 v154, v[140:143]
  ds_write_b128 v154, v[144:147] offset:1024
  ds_write2st64_b32 v155, v148, v149 offset0:0 offset1:1
  s_cbranch_vccz mq_73_ok
  buffer_load_dwordx4 v[140:143], v154, s[8:11], s46 offen sc1
  buffer_load_dwordx4 v[144:147], v154, s[8:11], s46 offen offset:1024 sc1
  buffer_load_dword v148, v155, s[8:11], s46 offen sc1
  buffer_load_dword v149, v155, s[8:11], s46 offen offset:256 sc1
  s_waitcnt vmcnt(4)
  v_max3_u32 v171, v108, v112, v150
  v_max_u32 v171, v171, v151
  v_cmp_eq_u32 vcc, -1, v171
  ds_write_b128 v154, v[108:111]
  ds_write_b128 v154, v[112:115] offset:1024
  ds_write2st64_b32 v155, v150, v151 offset0:0 offset1:1
  s_cbranch_vccz mq_73_ok
  s_branch mq_73
mq_73_ok:
  s_waitcnt lgkmcnt(0)
  s_barrier
  ds_read_b128 v[4:7], v152 offset:0
  ds_read_b128 v[8:11], v152 offset:1024
  ds_read_b128 v[12:15], v152 offset:2048
  ds_read_b128 v[16:19], v152 offset:3072
  ds_read_b128 v[20:23], v152 offset:4096
  ds_read_b128 v[24:27], v152 offset:5120
  ds_read_b128 v[28:31], v152 offset:6144
  ds_read_b128 v[32:35], v152 offset:7168
  ds_read_b128 v[36:39], v152 offset:8192
  ds_read_b128 v[40:43], v152 offset:9216
  s_waitcnt lgkmcnt(9)
  v_smfmac_f32_16x16x64_bf16 v[76:79], v[4:7], a[160:167], v164
  s_waitcnt lgkmcnt(8)
  v_smfmac_f32_16x16x64_bf16 v[76:79], v[8:11], a[168:175], v164
  buffer_load_dwordx4 v[44:47], v152, s[8:11], s67 offen offset:0 sc1
  s_waitcnt lgkmcnt(7)
  v_smfmac_f32_16x16x64_bf16 v[76:79], v[12:15], a[176:183], v164
  s_waitcnt lgkmcnt(6)
  v_smfmac_f32_16x16x64_bf16 v[76:79], v[16:19], a[184:191], v164
  buffer_load_dwordx4 v[48:51], v152, s[8:11], s67 offen offset:1024 sc1
  s_waitcnt lgkmcnt(5)
  v_smfmac_f32_16x16x64_bf16 v[76:79], v[20:23], a[192:199], v164
  s_waitcnt lgkmcnt(4)
  v_smfmac_f32_16x16x64_bf16 v[76:79], v[24:27], a[200:207], v164
  s_waitcnt lgkmcnt(3)
  v_smfmac_f32_16x16x64_bf16 v[76:79], v[28:31], a[208:215], v164
  buffer_load_dwordx4 v[52:55], v152, s[8:11], s67 offen offset:2048 sc1
  s_waitcnt lgkmcnt(2)
  v_smfmac_f32_16x16x64_bf16 v[76:79], v[32:35], a[216:223], v164
  s_waitcnt lgkmcnt(1)
  v_smfmac_f32_16x16x64_bf16 v[76:79], v[36:39], a[224:231], v164
  s_waitcnt lgkmcnt(0)
  v_smfmac_f32_16x16x64_bf16 v[76:79], v[40:43], a[232:239], v164
  s_nop 2
  v_smfmac_f32_16x16x64_bf16 v[68:71], v[4:7], a[0:7], v164
  s_nop 2
  v_smfmac_f32_16x16x64_bf16 v[68:71], v[8:11], a[8:15], v164
  v_add_f32 v76, v76, v78
  v_add_f32 v77, v77, v79
  v_smfmac_f32_16x16x64_bf16 v[68:71], v[12:15], a[16:23], v164
  v_cvt_pk_bf16_f32 v171, v76, v77
  s_nop 0
  v_smfmac_f32_16x16x64_bf16 v[68:71], v[16:19], a[24:31], v164
  v_mov_b32_dpp v172, v171 row_ror:4 row_mask:0xf bank_mask:0xa
  s_nop 0
  v_smfmac_f32_16x16x64_bf16 v[68:71], v[20:23], a[32:39], v164
  v_mov_b32_dpp v172, v171 row_ror:12 row_mask:0xf bank_mask:0x5
  s_nop 0
  v_smfmac_f32_16x16x64_bf16 v[68:71], v[24:27], a[40:47], v164
  v_perm_b32 v171, v172, v171, v165
  buffer_store_dword v171, v158, s[8:11], s50 offen
  v_smfmac_f32_16x16x64_bf16 v[68:71], v[28:31], a[48:55], v164
  v_smfmac_f32_16x16x64_bf16 v[68:71], v[32:35], a[56:63], v164
  buffer_load_dwordx4 v[56:59], v152, s[8:11], s67 offen offset:3072 sc1
  v_smfmac_f32_16x16x64_bf16 v[68:71], v[36:39], a[64:71], v164
  v_smfmac_f32_16x16x64_bf16 v[68:71], v[40:43], a[72:79], v164
  s_nop 2
  v_smfmac_f32_16x16x64_bf16 v[72:75], v[4:7], a[80:87], v164
  s_nop 2
  v_smfmac_f32_16x16x64_bf16 v[72:75], v[8:11], a[88:95], v164
  v_add_f32 v68, v68, v70
  v_add_f32 v69, v69, v71
  v_smfmac_f32_16x16x64_bf16 v[72:75], v[12:15], a[96:103], v164
  v_cvt_pk_bf16_f32 v128, v68, v69
  ds_write2_b32 v156, v128, v128 offset0:0 offset1:4
  v_smfmac_f32_16x16x64_bf16 v[72:75], v[16:19], a[104:111], v164
  v_smfmac_f32_16x16x64_bf16 v[72:75], v[20:23], a[112:119], v164
  buffer_load_dword v167, v162, s[8:11], 0 offen sc1
  v_smfmac_f32_16x16x64_bf16 v[72:75], v[24:27], a[120:127], v164
  v_smfmac_f32_16x16x64_bf16 v[72:75], v[28:31], a[128:135], v164
  ds_read_b64_tr_b16 v[132:133], v153 offset:10240
  ds_read_b64_tr_b16 v[134:135], v153 offset:10752
  v_smfmac_f32_16x16x64_bf16 v[72:75], v[32:35], a[136:143], v164
  ds_read_b64_tr_b16 v[136:137], v153 offset:11264
  ds_read_b64_tr_b16 v[138:139], v153 offset:11776
  v_smfmac_f32_16x16x64_bf16 v[72:75], v[36:39], a[144:151], v164
  v_smfmac_f32_16x16x64_bf16 v[72:75], v[40:43], a[152:159], v164
  s_nop 7
  v_add_f32 v72, v72, v74
  v_add_f32 v73, v73, v75
  v_cvt_pk_bf16_f32 v129, v72, v73
  ds_write2_b32 v157, v129, v129 offset0:0 offset1:1
  s_nop 11
  ds_read_b64_tr_b16 v[60:61], v153 offset:12288
  ds_read_b64_tr_b16 v[62:63], v153 offset:12800
  ds_read_b64_tr_b16 v[64:65], v153 offset:13312
  ds_read_b64_tr_b16 v[66:67], v153 offset:13824
  buffer_load_dwordx4 v[4:7], v152, s[8:11], s52 offen offset:0 sc1
  buffer_load_dwordx4 v[8:11], v152, s[8:11], s52 offen offset:1024 sc1
  buffer_load_dwordx4 v[12:15], v152, s[8:11], s52 offen offset:2048 sc1
  s_waitcnt lgkmcnt(2)
  v_mfma_f32_16x16x32_bf16 v[80:83], v[60:63], v[132:135], 0
  s_waitcnt lgkmcnt(0)
  v_mfma_f32_16x16x32_bf16 v[80:83], v[64:67], v[136:139], v[80:83]
  s_nop 7
  v_cmp_u_f32 vcc, v80, v81
  v_cndmask_b32 v171, v80, v81, s[76:77]
  s_cbranch_vccnz sx_74_r
sx_742:
  buffer_store_dword v171, v152, s[8:11], s49 offen
  s_mov_b32 s40, 0
  s_nop 15
  s_waitcnt vmcnt(1)
gv_78:
  v_max3_u32 v171, v4, v8, v12
  v_cmp_eq_u32 vcc, -1, v171
  s_cbranch_vccnz gv_78_r
  v_smfmac_f32_16x16x64_bf16 v[92:95], v[4:7], v[176:183], v164
  v_smfmac_f32_16x16x64_bf16 v[96:99], v[4:7], v[200:207], v164
  v_smfmac_f32_16x16x64_bf16 v[100:103], v[4:7], v[224:231], v164
  v_smfmac_f32_16x16x64_bf16 v[104:107], v[4:7], v[248:255], v164
  buffer_load_dwordx4 v[20:23], v152, s[8:11], s51 offen offset:0 sc1
  v_smfmac_f32_16x16x64_bf16 v[92:95], v[8:11], v[184:191], v164
  buffer_load_dwordx4 v[24:27], v152, s[8:11], s51 offen offset:1024 sc1
  v_smfmac_f32_16x16x64_bf16 v[96:99], v[8:11], v[208:215], v164
  buffer_load_dwordx4 v[28:31], v152, s[8:11], s51 offen offset:2048 sc1
  v_smfmac_f32_16x16x64_bf16 v[100:103], v[8:11], v[232:239], v164
  v_smfmac_f32_16x16x64_bf16 v[104:107], v[8:11], a[240:247], v164
  v_smfmac_f32_16x16x64_bf16 v[92:95], v[12:15], v[192:199], v164
  buffer_load_dwordx3 v[16:18], v152, s[8:11], s51 offen offset:3072 sc1
  v_smfmac_f32_16x16x64_bf16 v[96:99], v[12:15], v[216:223], v164
  v_smfmac_f32_16x16x64_bf16 v[100:103], v[12:15], v[240:247], v164
  v_smfmac_f32_16x16x64_bf16 v[104:107], v[12:15], a[248:255], v164
  s_nop 3
  v_cvt_pk_bf16_f32 v108, v92, v93
  v_cvt_pk_bf16_f32 v109, v94, v95
  s_nop 0
  v_cvt_pk_bf16_f32 v112, v100, v101
  v_cvt_pk_bf16_f32 v113, v102, v103
  v_cvt_pk_bf16_f32 v110, v96, v97
  v_cvt_pk_bf16_f32 v111, v98, v99
  v_cvt_pk_bf16_f32 v114, v104, v105
  v_cvt_pk_bf16_f32 v115, v106, v107
  s_add_u32 s39, s39, 1
  s_add_u32 s65, s62, s72
  s_waitcnt vmcnt(1)
gx_75:
  v_pk_add_f32 v[68:69], v[20:21], v[24:25]
  v_pk_add_f32 v[70:71], v[22:23], v[26:27]
  v_pk_add_f32 v[68:69], v[68:69], v[28:29]
  v_pk_add_f32 v[70:71], v[70:71], v[30:31]
  v_cmp_u_f32 vcc, v68, v68
  v_pk_mul_f32 v[68:69], v[68:69], s[82:83]
  v_pk_mul_f32 v[70:71], v[70:71], s[82:83]
  v_exp_f32 v68, v68
  s_cbranch_vccnz gx_75_r
  v_exp_f32 v69, v69
  v_exp_f32 v70, v70
  v_exp_f32 v71, v71
  s_waitcnt vmcnt(0)
gm_76:
  v_add_f32 v72, v16, v17
  v_cvt_pk_bf16_f32 v148, v68, v69
  v_cvt_pk_bf16_f32 v149, v70, v71
  v_add_f32 v72, v72, v18
  v_cmp_u_f32 vcc, v72, v72
  v_mov_b32_dpp v116, v148 quad_perm:[0,1,2,3] row_mask:0xf bank_mask:0x3
  v_mov_b32_dpp v117, v149 quad_perm:[0,1,2,3] row_mask:0xf bank_mask:0x3
  v_mul_f32 v72, s82, v72
  v_mov_b32_dpp v118, v148 row_ror:8 row_mask:0xf bank_mask:0x3
  v_mov_b32_dpp v119, v149 row_ror:8 row_mask:0xf bank_mask:0x3
  v_exp_f32 v72, v72
  s_cbranch_vccnz gm_76_r
  v_mfma_f32_16x16x32_bf16 v[80:83], v[88:91], v[116:119], 0
  v_mov_b32_dpp v120, v148 row_ror:8 row_mask:0xf bank_mask:0xc
  v_mov_b32_dpp v121, v149 row_ror:8 row_mask:0xf bank_mask:0xc
  v_mov_b32_dpp v122, v148 quad_perm:[0,1,2,3] row_mask:0xf bank_mask:0xc
  v_mov_b32_dpp v123, v149 quad_perm:[0,1,2,3] row_mask:0xf bank_mask:0xc
  v_mfma_f32_16x16x32_bf16 v[140:143], v[44:47], v[116:119], 0
  v_mov_b32_dpp v73, v72 row_ror:8 row_mask:0xf bank_mask:0xf
  v_cvt_pk_bf16_f32 v150, v72, v73
  v_mfma_f32_16x16x32_bf16 v[144:147], v[52:55], v[116:119], 0
  s_nop 0
  v_mov_b32_dpp v124, v150 quad_perm:[0,1,2,3] row_mask:0xf bank_mask:0x3
  v_mov_b32_dpp v125, v150 quad_perm:[0,1,2,3] row_mask:0xf bank_mask:0x3
  v_mfma_f32_16x16x32_bf16 v[140:143], v[48:51], v[120:123], v[140:143]
  v_mov_b32_dpp v126, v150 row_ror:8 row_mask:0xf bank_mask:0xc
  v_mov_b32_dpp v127, v150 row_ror:8 row_mask:0xf bank_mask:0xc
  v_mfma_f32_16x16x32_bf16 v[144:147], v[56:59], v[120:123], v[144:147]
  v_mfma_f32_16x16x16_bf16 v[80:83], v[130:131], v[124:125], v[80:83]
  s_nop 1
  v_mfma_f32_16x16x16_bf16 v[140:143], v[108:109], v[124:125], v[140:143]
  s_nop 1
  v_mfma_f32_16x16x16_bf16 v[144:147], v[112:113], v[124:125], v[144:147]
  v_mfma_f32_16x16x16_bf16 v[140:143], v[110:111], v[126:127], v[140:143]
  s_nop 0
  v_subrev_u32 v171, 0x21800000, v80
  v_rcp_f32 v128, v80
  v_mfma_f32_16x16x16_bf16 v[144:147], v[114:115], v[126:127], v[144:147]
  v_cmp_lt_u32 vcc, 0x50000000, v171
  ds_write_b32 v169, v128
  s_and_b64 vcc, vcc, s[74:75]
  s_cbranch_vccnz gz_77_r
gz_77:
  s_cmp_eq_u32 s39, 64
  s_cbranch_scc1 chain_last_c1w
  ds_write_b128 v159, v[140:143] offset:0
  s_nop 0
  ds_write_b128 v159, v[144:147] offset:1024
  s_waitcnt lgkmcnt(0)
  s_barrier
  ds_read_b128 v[108:111], v170
  ds_read_b64 v[132:133], v160 offset:0
  ds_read_b64 v[134:135], v160 offset:2048
  ds_read_b64 v[136:137], v160 offset:4096
  ds_read_b64 v[138:139], v160 offset:6144
  s_waitcnt lgkmcnt(3)
  v_pk_mul_f32 v[128:129], v[132:133], v[108:109] op_sel_hi:[1,0]
  s_waitcnt lgkmcnt(2)
  v_pk_fma_f32 v[128:129], v[134:135], v[108:109], v[128:129] op_sel:[0,1,0]
  s_waitcnt lgkmcnt(1)
  v_pk_fma_f32 v[128:129], v[136:137], v[110:111], v[128:129] op_sel_hi:[1,0,1]
  s_waitcnt lgkmcnt(0)
  v_pk_fma_f32 v[128:129], v[138:139], v[110:111], v[128:129] op_sel:[0,1,0]
  v_cvt_pk_bf16_f32 v128, v128, v129
  buffer_store_dword v128, v168, s[8:11], s63 offen sc1
  buffer_store_dword v128, v168, s[8:11], s61 offen sc1
  s_xor_b32 s68, s65, 1024
  ds_bpermute_b32 v42, v175, v128
  v_mov_b32 v4, 0
  v_mov_b32 v5, 0
  v_mov_b32 v6, 0
  v_mov_b32 v7, 0
  v_pk_add_f32 v[92:93], v[92:93], v[94:95]
  v_cvt_pk_bf16_f32 v80, v92, v93
  v_pk_add_f32 v[96:97], v[96:97], v[98:99]
  v_cvt_pk_bf16_f32 v81, v96, v97
  v_pk_add_f32 v[100:101], v[100:101], v[102:103]
  v_cvt_pk_bf16_f32 v82, v100, v101
  v_pk_add_f32 v[104:105], v[104:105], v[106:107]
  v_cvt_pk_bf16_f32 v83, v104, v105
  buffer_store_dwordx4 v[80:83], v152, s[8:11], s56 offen
  v_mov_b32 v16, -1
  v_mov_b32 v17, -1
  v_mov_b32 v18, -1
  v_mov_b32 v19, -1
  ds_write_b128 v152, v[16:19] offset:10240
  ds_write_b128 v152, v[16:19] offset:11264
  s_add_u32 s43, s39, 1
  v_mov_b32 v174, s39
  s_mov_b32 s40, 0
cpw_79:
  v_cmp_gt_u32 vcc, s43, v167
  s_nop 0
  s_and_b32 vcc_lo, vcc_lo, 0xfff000
  s_and_b32 vcc_hi, vcc_hi, 0xfffff0
  s_cmp_eq_u64 vcc, 0
  s_cbranch_scc1 cpo_80
  s_sleep 1
  buffer_load_dword v167, v162, s[8:11], 0 offen sc1
  s_add_u32 s40, s40, 1
  s_cmp_gt_u32 s40, 65536
  s_cbranch_scc1 chain_abort
  s_waitcnt vmcnt(0)
  s_branch cpw_79
cpo_80:
  s_and_b32 s41, s39, 3
  s_mul_i32 s46, s41, 81920
  s_add_u32 s46, s46, s45
  s_lshl_b32 s42, s41, 15
  s_add_u32 s43, s47, s42
  s_add_u32 s49, s43, s53
  s_add_u32 s50, s43, s54
  s_mul_i32 s43, s41, 227328
  s_add_u32 s55, s58, s43
  s_add_u32 s56, s59, s43
  s_add_u32 s51, s48, s42
  s_add_u32 s52, s51, 4096
  s_mul_i32 s62, s41, 163840
  s_add_u32 s62, s62, s64
  s_lshl_b32 s42, s16, 8
  s_add_u32 s61, s62, s42
  s_xor_b32 s63, s61, 8192
  v_mov_b32 v92, 0
  v_mov_b32 v93, 0
  v_mov_b32 v94, 0
  v_mov_b32 v95, 0
  v_mov_b32 v96, 0
  v_mov_b32 v97, 0
  v_mov_b32 v98, 0
  v_mov_b32 v99, 0
  v_mov_b32 v100, 0
  v_mov_b32 v101, 0
  v_mov_b32 v102, 0
  v_mov_b32 v103, 0
  v_mov_b32 v104, 0
  v_mov_b32 v105, 0
  v_mov_b32 v106, 0
  v_mov_b32 v107, 0
  v_mov_b32 v68, 0
  v_mov_b32 v69, 0
  v_mov_b32 v70, 0
  v_mov_b32 v71, 0
  v_mov_b32 v72, 0
  v_mov_b32 v73, 0
  v_mov_b32 v74, 0
  v_mov_b32 v75, 0
  v_mov_b32 v76, 0
  v_mov_b32 v77, 0
  v_mov_b32 v78, 0
  v_mov_b32 v79, 0
  s_nop 15
  s_nop 3
  s_mov_b64 exec, s[70:71]
  buffer_load_dwordx4 v[4:7], v152, s[8:11], s65 offen sc1
  s_mov_b64 exec, -1
  buffer_load_dwordx4 v[8:11], v152, s[8:11], s68 offen sc1
  s_waitcnt lgkmcnt(0)
  v_lshlrev_b32 v40, 16, v42
  v_and_b32 v41, 0xffff0000, v42
  s_and_b32 s67, s39, 3
  s_mul_i32 s67, s67, 227328
  s_add_u32 s67, s67, s60
  s_mov_b32 s40, 0
  s_waitcnt vmcnt(0)
xp_81:
  v_mfma_f32_16x16x32_bf16 v[36:39], v[84:87], v[4:7], v[40:43]
  v_mfma_f32_16x16x32_bf16 v[36:39], v[84:87], v[8:11], v[36:39]
  s_nop 7
  v_cmp_u_f32 vcc, v36, v37
  v_cvt_pk_bf16_f32 v172, v36, v37
  s_cbranch_vccnz xp_81_r
xp_81_ok:
  buffer_store_dword v172, v161, s[8:11], s46 offen
  buffer_store_dword v174, v163, s[8:11], 0 offen
  s_branch chain_loop_c1w
sx_74_r:
  s_mov_b64 exec, -1
  ds_read_b64_tr_b16 v[132:133], v153 offset:10240
  ds_read_b64_tr_b16 v[134:135], v153 offset:10752
  ds_read_b64_tr_b16 v[136:137], v153 offset:11264
  ds_read_b64_tr_b16 v[138:139], v153 offset:11776
  ds_read_b64_tr_b16 v[60:61], v153 offset:12288
  ds_read_b64_tr_b16 v[62:63], v153 offset:12800
  ds_read_b64_tr_b16 v[64:65], v153 offset:13312
  ds_read_b64_tr_b16 v[66:67], v153 offset:13824
  s_add_u32 s40, s40, 1
  s_cmp_gt_u32 s40, 65536
  s_cbranch_scc1 chain_abort
  s_waitcnt lgkmcnt(0)
  v_mfma_f32_16x16x32_bf16 v[80:83], v[60:63], v[132:135], 0
  v_mfma_f32_16x16x32_bf16 v[80:83], v[64:67], v[136:139], v[80:83]
  s_nop 7
  v_cmp_u_f32 vcc, v80, v81
  s_cbranch_vccnz sx_74_r
  s_branch sx_74
sx_74:
  v_cndmask_b32 v171, v80, v81, s[76:77]
  s_branch sx_742
gx_75_r:
  v_max3_u32 v173, v20, v21, v22
  v_max_u32 v173, v173, v23
  v_cmp_eq_u32 vcc, -1, v173
  s_cbranch_vccz gx_75_s0
  s_mov_b64 exec, vcc
  buffer_load_dwordx4 v[20:23], v152, s[8:11], s51 offen offset:0 sc1
  s_mov_b64 exec, -1
gx_75_s0:
  v_max3_u32 v173, v24, v25, v26
  v_max_u32 v173, v173, v27
  v_cmp_eq_u32 vcc, -1, v173
  s_cbranch_vccz gx_75_s1
  s_mov_b64 exec, vcc
  buffer_load_dwordx4 v[24:27], v152, s[8:11], s51 offen offset:1024 sc1
  s_mov_b64 exec, -1
gx_75_s1:
  v_max3_u32 v173, v28, v29, v30
  v_max_u32 v173, v173, v31
  v_cmp_eq_u32 vcc, -1, v173
  s_cbranch_vccz gx_75_s2
  s_mov_b64 exec, vcc
  buffer_load_dwordx4 v[28:31], v152, s[8:11], s51 offen offset:2048 sc1
  s_mov_b64 exec, -1
gx_75_s2:
  buffer_load_dwordx3 v[16:18], v152, s[8:11], s51 offen offset:3072 sc1
  s_add_u32 s40, s40, 1
  s_cmp_gt_u32 s40, 65536
  s_cbranch_scc1 chain_abort
  s_waitcnt vmcnt(0)
  s_branch gx_75
gm_76_r:
  v_max3_u32 v173, v16, v17, v18
  v_cmp_eq_u32 vcc, -1, v173
  s_cbranch_vccz gm_76_s0
  s_mov_b64 exec, vcc
  buffer_load_dwordx3 v[16:18], v152, s[8:11], s51 offen offset:3072 sc1
  s_mov_b64 exec, -1
gm_76_s0:
  s_add_u32 s40, s40, 1
  s_cmp_gt_u32 s40, 65536
  s_cbranch_scc1 chain_abort
  s_waitcnt vmcnt(0)
  s_branch gm_76
gv_78_r:
  v_max3_u32 v173, v4, v5, v6
  v_max_u32 v173, v173, v7
  v_cmp_eq_u32 vcc, -1, v173
  s_cbranch_vccz gv_78_s0
  s_mov_b64 exec, vcc
  buffer_load_dwordx4 v[4:7], v152, s[8:11], s52 offen offset:0 sc1
  s_mov_b64 exec, -1
gv_78_s0:
  v_max3_u32 v173, v8, v9, v10
  v_max_u32 v173, v173, v11
  v_cmp_eq_u32 vcc, -1, v173
  s_cbranch_vccz gv_78_s1
  s_mov_b64 exec, vcc
  buffer_load_dwordx4 v[8:11], v152, s[8:11], s52 offen offset:1024 sc1
  s_mov_b64 exec, -1
gv_78_s1:
  v_max3_u32 v173, v12, v13, v14
  v_max_u32 v173, v173, v15
  v_cmp_eq_u32 vcc, -1, v173
  s_cbranch_vccz gv_78_s2
  s_mov_b64 exec, vcc
  buffer_load_dwordx4 v[12:15], v152, s[8:11], s52 offen offset:2048 sc1
  s_mov_b64 exec, -1
gv_78_s2:
  s_add_u32 s40, s40, 1
  s_cmp_gt_u32 s40, 65536
  s_cbranch_scc1 chain_abort
  s_waitcnt vmcnt(0)
  s_branch gv_78
gz_77_r:
  v_pk_add_f32 v[68:69], v[20:21], v[24:25]
  v_pk_add_f32 v[70:71], v[22:23], v[26:27]
  v_pk_add_f32 v[68:69], v[68:69], v[28:29]
  v_pk_add_f32 v[70:71], v[70:71], v[30:31]
  v_add_f32 v72, v16, v17
  v_add_f32 v72, v72, v18
  v_max3_f32 v171, v68, v69, v70
  v_max3_f32 v171, v171, v71, v72
  s_nop 1
  v_max_f32_dpp v171, v171, v171 row_ror:8 row_mask:0xf bank_mask:0xf
  v_mov_b32 v172, v171
  s_nop 1
  v_permlane16_swap_b32 v171, v172
  v_max_f32 v171, v171, v172
  v_mov_b32 v172, v171
  s_nop 1
  v_permlane32_swap_b32 v171, v172
  v_max_f32 v171, v171, v172
  v_sub_f32 v68, v68, v171
  v_mul_f32 v68, s82, v68
  v_exp_f32 v68, v68
  v_sub_f32 v69, v69, v171
  v_mul_f32 v69, s82, v69
  v_exp_f32 v69, v69
  v_sub_f32 v70, v70, v171
  v_mul_f32 v70, s82, v70
  v_exp_f32 v70, v70
  v_sub_f32 v71, v71, v171
  v_mul_f32 v71, s82, v71
  v_exp_f32 v71, v71
  v_sub_f32 v72, v72, v171
  v_mul_f32 v72, s82, v72
  v_exp_f32 v72, v72
  v_cvt_pk_bf16_f32 v148, v68, v69
  v_cvt_pk_bf16_f32 v149, v70, v71
  s_nop 0
  v_mov_b32_dpp v116, v148 quad_perm:[0,1,2,3] row_mask:0xf bank_mask:0x3
  v_mov_b32_dpp v117, v149 quad_perm:[0,1,2,3] row_mask:0xf bank_mask:0x3
  v_mov_b32_dpp v118, v148 row_ror:8 row_mask:0xf bank_mask:0x3
  v_mov_b32_dpp v119, v149 row_ror:8 row_mask:0xf bank_mask:0x3
  v_mov_b32_dpp v120, v148 row_ror:8 row_mask:0xf bank_mask:0xc
  v_mov_b32_dpp v121, v149 row_ror:8 row_mask:0xf bank_mask:0xc
  v_mov_b32_dpp v122, v148 quad_perm:[0,1,2,3] row_mask:0xf bank_mask:0xc
  v_mov_b32_dpp v123, v149 quad_perm:[0,1,2,3] row_mask:0xf bank_mask:0xc
  v_mov_b32_dpp v73, v72 row_ror:8 row_mask:0xf bank_mask:0xf
  v_cvt_pk_bf16_f32 v150, v72, v73
  s_nop 1
  v_mov_b32_dpp v124, v150 quad_perm:[0,1,2,3] row_mask:0xf bank_mask:0x3
  v_mov_b32_dpp v125, v150 quad_perm:[0,1,2,3] row_mask:0xf bank_mask:0x3
  v_mov_b32_dpp v126, v150 row_ror:8 row_mask:0xf bank_mask:0xc
  v_mov_b32_dpp v127, v150 row_ror:8 row_mask:0xf bank_mask:0xc
  v_mfma_f32_16x16x32_bf16 v[80:83], v[88:91], v[116:119], 0
  v_mfma_f32_16x16x32_bf16 v[140:143], v[44:47], v[116:119], 0
  v_mfma_f32_16x16x32_bf16 v[144:147], v[52:55], v[116:119], 0
  v_mfma_f32_16x16x32_bf16 v[140:143], v[48:51], v[120:123], v[140:143]
  v_mfma_f32_16x16x32_bf16 v[144:147], v[56:59], v[120:123], v[144:147]
  s_nop 1
  v_mfma_f32_16x16x16_bf16 v[80:83], v[130:131], v[124:125], v[80:83]
  s_nop 1
  v_mfma_f32_16x16x16_bf16 v[140:143], v[108:109], v[124:125], v[140:143]
  v_mfma_f32_16x16x16_bf16 v[144:147], v[112:113], v[124:125], v[144:147]
  v_mfma_f32_16x16x16_bf16 v[140:143], v[110:111], v[126:127], v[140:143]
  v_mfma_f32_16x16x16_bf16 v[144:147], v[114:115], v[126:127], v[144:147]
  s_nop 1
  v_rcp_f32 v128, v80
  s_nop 0
  ds_write_b32 v169, v128
  s_branch gz_77
xp_81_r:
  v_max3_u32 v173, v4, v5, v6
  v_max_u32 v173, v173, v7
  v_cmp_eq_u32 vcc, -1, v173
  s_cbranch_vccz xp_81_s0
  s_mov_b64 exec, vcc
  buffer_load_dwordx4 v[4:7], v152, s[8:11], s65 offen sc1
  s_mov_b64 exec, -1
  s_mov_b64 exec, -1
xp_81_s0:
  v_max3_u32 v173, v8, v9, v10
  v_max_u32 v173, v173, v11
  v_cmp_eq_u32 vcc, -1, v173
  s_cbranch_vccz xp_81_s1
  s_mov_b64 exec, vcc
  buffer_load_dwordx4 v[8:11], v152, s[8:11], s68 offen sc1
  s_mov_b64 exec, -1
xp_81_s1:
  s_add_u32 s40, s40, 1
  s_cmp_gt_u32 s40, 65536
  s_cbranch_scc1 chain_abort
  s_waitcnt vmcnt(0)
  s_branch xp_81
chain_last_c1w:
  v_pk_add_f32 v[92:93], v[92:93], v[94:95]
  v_cvt_pk_bf16_f32 v80, v92, v93
  v_pk_add_f32 v[96:97], v[96:97], v[98:99]
  v_cvt_pk_bf16_f32 v81, v96, v97
  v_pk_add_f32 v[100:101], v[100:101], v[102:103]
  v_cvt_pk_bf16_f32 v82, v100, v101
  v_pk_add_f32 v[104:105], v[104:105], v[106:107]
  v_cvt_pk_bf16_f32 v83, v104, v105
  buffer_store_dwordx4 v[80:83], v152, s[8:11], s56 offen
  s_waitcnt lgkmcnt(0)
  s_barrier
  v_mov_b32 v16, -1
  v_mov_b32 v17, -1
  v_mov_b32 v18, -1
  v_mov_b32 v19, -1
  ds_write_b128 v152, v[16:19] offset:10240
  ds_write_b128 v152, v[16:19] offset:11264
  v_mov_b32 v174, s39
  s_waitcnt vmcnt(0)
  buffer_store_dword v174, v163, s[8:11], 0 offen
  s_branch chain_end
chain_pro_c2w:
  s_mov_b32 s40, 0
cpw_82:
  v_cmp_gt_u32 vcc, 1, v167
  s_nop 0
  s_and_b32 vcc_lo, vcc_lo, 0xfff000
  s_and_b32 vcc_hi, vcc_hi, 0x10fffff0
  s_cmp_eq_u64 vcc, 0
  s_cbranch_scc1 cpo_83
  s_sleep 1
  buffer_load_dword v167, v162, s[8:11], 0 offen sc1
  s_add_u32 s40, s40, 1
  s_cmp_gt_u32 s40, 65536
  s_cbranch_scc1 chain_abort
  s_waitcnt vmcnt(0)
  s_branch cpw_82
cpo_83:
  v_readlane_b32 s41, v167, 60
  s_nop 0
  s_sub_u32 s41, s41, 1
  s_lshl_b32 s41, s41, 13
  s_add_u32 s64, s64, s41
  s_and_b32 s67, s39, 3
  s_mul_i32 s67, s67, 227328
  s_add_u32 s67, s67, s60
  s_and_b32 s41, s39, 3
  s_mul_i32 s46, s41, 81920
  s_add_u32 s46, s46, s45
  s_lshl_b32 s42, s41, 15
  s_add_u32 s43, s47, s42
  s_add_u32 s49, s43, s53
  s_add_u32 s50, s43, s54
  s_mul_i32 s43, s41, 227328
  s_add_u32 s55, s58, s43
  s_add_u32 s56, s59, s43
  s_add_u32 s51, s48, s42
  s_add_u32 s52, s51, 4096
  s_mul_i32 s62, s41, 163840
  s_add_u32 s62, s62, s64
  s_lshl_b32 s42, s16, 8
  s_add_u32 s61, s62, s42
  s_xor_b32 s63, s61, 8192
  v_mov_b32 v92, 0
  v_mov_b32 v93, 0
  v_mov_b32 v94, 0
  v_mov_b32 v95, 0
  v_mov_b32 v96, 0
  v_mov_b32 v97, 0
  v_mov_b32 v98, 0
  v_mov_b32 v99, 0
  v_mov_b32 v100, 0
  v_mov_b32 v101, 0
  v_mov_b32 v102, 0
  v_mov_b32 v103, 0
  v_mov_b32 v104, 0
  v_mov_b32 v105, 0
  v_mov_b32 v106, 0
  v_mov_b32 v107, 0
  v_mov_b32 v68, 0
  v_mov_b32 v69, 0
  v_mov_b32 v70, 0
  v_mov_b32 v71, 0
  v_mov_b32 v72, 0
  v_mov_b32 v73, 0
  v_mov_b32 v74, 0
  v_mov_b32 v75, 0
  v_mov_b32 v76, 0
  v_mov_b32 v77, 0
  v_mov_b32 v78, 0
  v_mov_b32 v79, 0
  v_mov_b32 v16, -1
  v_mov_b32 v17, -1
  v_mov_b32 v18, -1
  v_mov_b32 v19, -1
  ds_write_b128 v152, v[16:19] offset:12288
  ds_write_b128 v152, v[16:19] offset:13312
chain_loop_c2w:
  s_mov_b32 s40, 0
  buffer_load_dwordx4 v[140:143], v154, s[8:11], s46 offen sc1
  buffer_load_dwordx4 v[144:147], v154, s[8:11], s46 offen offset:1024 sc1
  buffer_load_dword v148, v155, s[8:11], s46 offen sc1
  buffer_load_dword v149, v155, s[8:11], s46 offen offset:256 sc1
  s_nop 15
  s_nop 15
mq_84:
  buffer_load_dwordx4 v[108:111], v154, s[8:11], s46 offen sc1
  buffer_load_dwordx4 v[112:115], v154, s[8:11], s46 offen offset:1024 sc1
  buffer_load_dword v150, v155, s[8:11], s46 offen sc1
  buffer_load_dword v151, v155, s[8:11], s46 offen offset:256 sc1
  s_add_u32 s40, s40, 1
  s_cmp_gt_u32 s40, 65536
  s_cbranch_scc1 chain_abort
  s_waitcnt vmcnt(4)
  v_max3_u32 v171, v140, v144, v148
  v_max_u32 v171, v171, v149
  v_cmp_eq_u32 vcc, -1, v171
  ds_write_b128 v154, v[140:143]
  ds_write_b128 v154, v[144:147] offset:1024
  ds_write2st64_b32 v155, v148, v149 offset0:0 offset1:1
  s_cbranch_vccz mq_84_ok
  buffer_load_dwordx4 v[140:143], v154, s[8:11], s46 offen sc1
  buffer_load_dwordx4 v[144:147], v154, s[8:11], s46 offen offset:1024 sc1
  buffer_load_dword v148, v155, s[8:11], s46 offen sc1
  buffer_load_dword v149, v155, s[8:11], s46 offen offset:256 sc1
  s_waitcnt vmcnt(4)
  v_max3_u32 v171, v108, v112, v150
  v_max_u32 v171, v171, v151
  v_cmp_eq_u32 vcc, -1, v171
  ds_write_b128 v154, v[108:111]
  ds_write_b128 v154, v[112:115] offset:1024
  ds_write2st64_b32 v155, v150, v151 offset0:0 offset1:1
  s_cbranch_vccz mq_84_ok
  s_branch mq_84
mq_84_ok:
  s_waitcnt lgkmcnt(0)
  s_barrier
  ds_read_b128 v[4:7], v152 offset:0
  ds_read_b128 v[8:11], v152 offset:1024
  ds_read_b128 v[12:15], v152 offset:2048
  ds_read_b128 v[16:19], v152 offset:3072
  ds_read_b128 v[20:23], v152 offset:4096
  ds_read_b128 v[24:27], v152 offset:5120
  ds_read_b128 v[28:31], v152 offset:6144
  ds_read_b128 v[32:35], v152 offset:7168
  ds_read_b128 v[36:39], v152 offset:8192
  ds_read_b128 v[40:43], v152 offset:9216
  s_waitcnt lgkmcnt(9)
  v_smfmac_f32_16x16x64_bf16 v[76:79], v[4:7], a[160:167], v164
  s_waitcnt lgkmcnt(8)
  v_smfmac_f32_16x16x64_bf16 v[76:79], v[8:11], a[168:175], v164
  buffer_load_dwordx4 v[44:47], v152, s[8:11], s67 offen offset:0 sc1
  s_waitcnt lgkmcnt(7)
  v_smfmac_f32_16x16x64_bf16 v[76:79], v[12:15], a[176:183], v164
  s_waitcnt lgkmcnt(6)
  v_smfmac_f32_16x16x64_bf16 v[76:79], v[16:19], a[184:191], v164
  buffer_load_dwordx4 v[48:51], v152, s[8:11], s67 offen offset:1024 sc1
  s_waitcnt lgkmcnt(5)
  v_smfmac_f32_16x16x64_bf16 v[76:79], v[20:23], a[192:199], v164
  s_waitcnt lgkmcnt(4)
  v_smfmac_f32_16x16x64_bf16 v[76:79], v[24:27], a[200:207], v164
  s_waitcnt lgkmcnt(3)
  v_smfmac_f32_16x16x64_bf16 v[76:79], v[28:31], a[208:215], v164
  buffer_load_dwordx4 v[52:55], v152, s[8:11], s67 offen offset:2048 sc1
  s_waitcnt lgkmcnt(2)
  v_smfmac_f32_16x16x64_bf16 v[76:79], v[32:35], a[216:223], v164
  s_waitcnt lgkmcnt(1)
  v_smfmac_f32_16x16x64_bf16 v[76:79], v[36:39], a[224:231], v164
  s_waitcnt lgkmcnt(0)
  v_smfmac_f32_16x16x64_bf16 v[76:79], v[40:43], a[232:239], v164
  s_nop 2
  v_smfmac_f32_16x16x64_bf16 v[68:71], v[4:7], a[0:7], v164
  s_nop 2
  v_smfmac_f32_16x16x64_bf16 v[68:71], v[8:11], a[8:15], v164
  v_add_f32 v76, v76, v78
  v_add_f32 v77, v77, v79
  v_smfmac_f32_16x16x64_bf16 v[68:71], v[12:15], a[16:23], v164
  v_cvt_pk_bf16_f32 v171, v76, v77
  s_nop 0
  v_smfmac_f32_16x16x64_bf16 v[68:71], v[16:19], a[24:31], v164
  v_mov_b32_dpp v172, v171 row_ror:4 row_mask:0xf bank_mask:0xa
  s_nop 0
  v_smfmac_f32_16x16x64_bf16 v[68:71], v[20:23], a[32:39], v164
  v_mov_b32_dpp v172, v171 row_ror:12 row_mask:0xf bank_mask:0x5
  s_nop 0
  v_smfmac_f32_16x16x64_bf16 v[68:71], v[24:27], a[40:47], v164
  v_perm_b32 v171, v172, v171, v165
  buffer_store_dword v171, v158, s[8:11], s50 offen
  v_smfmac_f32_16x16x64_bf16 v[68:71], v[28:31], a[48:55], v164
  v_smfmac_f32_16x16x64_bf16 v[68:71], v[32:35], a[56:63], v164
  buffer_load_dwordx4 v[56:59], v152, s[8:11], s67 offen offset:3072 sc1
  v_smfmac_f32_16x16x64_bf16 v[68:71], v[36:39], a[64:71], v164
  v_smfmac_f32_16x16x64_bf16 v[68:71], v[40:43], a[72:79], v164
  s_nop 2
  v_smfmac_f32_16x16x64_bf16 v[72:75], v[4:7], a[80:87], v164
  s_nop 2
  v_smfmac_f32_16x16x64_bf16 v[72:75], v[8:11], a[88:95], v164
  v_add_f32 v68, v68, v70
  v_add_f32 v69, v69, v71
  v_smfmac_f32_16x16x64_bf16 v[72:75], v[12:15], a[96:103], v164
  v_cvt_pk_bf16_f32 v128, v68, v69
  ds_write2_b32 v156, v128, v128 offset0:0 offset1:4
  v_smfmac_f32_16x16x64_bf16 v[72:75], v[16:19], a[104:111], v164
  v_smfmac_f32_16x16x64_bf16 v[72:75], v[20:23], a[112:119], v164
  buffer_load_dword v167, v162, s[8:11], 0 offen sc1
  v_smfmac_f32_16x16x64_bf16 v[72:75], v[24:27], a[120:127], v164
  v_smfmac_f32_16x16x64_bf16 v[72:75], v[28:31], a[128:135], v164
  v_smfmac_f32_16x16x64_bf16 v[72:75], v[32:35], a[136:143], v164
  v_smfmac_f32_16x16x64_bf16 v[72:75], v[36:39], a[144:151], v164
  v_smfmac_f32_16x16x64_bf16 v[72:75], v[40:43], a[152:159], v164
  s_nop 7
  v_add_f32 v72, v72, v74
  v_add_f32 v73, v73, v75
  v_cvt_pk_bf16_f32 v129, v72, v73
  ds_write2_b32 v157, v129, v129 offset0:0 offset1:1
  buffer_load_dwordx4 v[4:7], v152, s[8:11], s52 offen offset:0 sc1
  buffer_load_dwordx4 v[8:11], v152, s[8:11], s52 offen offset:1024 sc1
  buffer_load_dwordx4 v[12:15], v152, s[8:11], s52 offen offset:2048 sc1
  s_mov_b32 s40, 0
  s_nop 15
  s_nop 15
  s_nop 15
  s_nop 15
  s_nop 5
  s_waitcnt vmcnt(0)
gv_89:
  v_max3_u32 v171, v4, v8, v12
  v_cmp_eq_u32 vcc, -1, v171
  s_cbranch_vccnz gv_89_r
  v_smfmac_f32_16x16x64_bf16 v[92:95], v[4:7], v[176:183], v164
  v_smfmac_f32_16x16x64_bf16 v[96:99], v[4:7], v[200:207], v164
  v_smfmac_f32_16x16x64_bf16 v[100:103], v[4:7], v[224:231], v164
  v_smfmac_f32_16x16x64_bf16 v[104:107], v[4:7], v[248:255], v164
  buffer_load_dwordx4 v[20:23], v152, s[8:11], s51 offen offset:0 sc1
  v_smfmac_f32_16x16x64_bf16 v[92:95], v[8:11], v[184:191], v164
  buffer_load_dwordx4 v[24:27], v152, s[8:11], s51 offen offset:1024 sc1
  v_smfmac_f32_16x16x64_bf16 v[96:99], v[8:11], v[208:215], v164
  buffer_load_dwordx4 v[28:31], v152, s[8:11], s51 offen offset:2048 sc1
  v_smfmac_f32_16x16x64_bf16 v[100:103], v[8:11], v[232:239], v164
  v_smfmac_f32_16x16x64_bf16 v[104:107], v[8:11], a[240:247], v164
  v_smfmac_f32_16x16x64_bf16 v[92:95], v[12:15], v[192:199], v164
  buffer_load_dwordx3 v[16:18], v152, s[8:11], s51 offen offset:3072 sc1
  v_smfmac_f32_16x16x64_bf16 v[96:99], v[12:15], v[216:223], v164
  v_smfmac_f32_16x16x64_bf16 v[100:103], v[12:15], v[240:247], v164
  v_smfmac_f32_16x16x64_bf16 v[104:107], v[12:15], a[248:255], v164
  s_nop 3
  v_cvt_pk_bf16_f32 v108, v92, v93
  v_cvt_pk_bf16_f32 v109, v94, v95
  s_nop 0
  v_cvt_pk_bf16_f32 v112, v100, v101
  v_cvt_pk_bf16_f32 v113, v102, v103
  v_cvt_pk_bf16_f32 v110, v96, v97
  v_cvt_pk_bf16_f32 v111, v98, v99
  v_cvt_pk_bf16_f32 v114, v104, v105
  v_cvt_pk_bf16_f32 v115, v106, v107
  s_add_u32 s39, s39, 1
  s_add_u32 s65, s62, s72
  s_waitcnt vmcnt(1)
gx_86:
  v_pk_add_f32 v[68:69], v[20:21], v[24:25]
  v_pk_add_f32 v[70:71], v[22:23], v[26:27]
  v_pk_add_f32 v[68:69], v[68:69], v[28:29]
  v_pk_add_f32 v[70:71], v[70:71], v[30:31]
  v_cmp_u_f32 vcc, v68, v68
  v_pk_mul_f32 v[68:69], v[68:69], s[82:83]
  v_pk_mul_f32 v[70:71], v[70:71], s[82:83]
  v_exp_f32 v68, v68
  s_cbranch_vccnz gx_86_r
  v_exp_f32 v69, v69
  v_exp_f32 v70, v70
  v_exp_f32 v71, v71
  s_waitcnt vmcnt(0)
gm_87:
  v_add_f32 v72, v16, v17
  v_cvt_pk_bf16_f32 v148, v68, v69
  v_cvt_pk_bf16_f32 v149, v70, v71
  v_add_f32 v72, v72, v18
  v_cmp_u_f32 vcc, v72, v72
  v_mov_b32_dpp v116, v148 quad_perm:[0,1,2,3] row_mask:0xf bank_mask:0x3
  v_mov_b32_dpp v117, v149 quad_perm:[0,1,2,3] row_mask:0xf bank_mask:0x3
  v_mul_f32 v72, s82, v72
  v_mov_b32_dpp v118, v148 row_ror:8 row_mask:0xf bank_mask:0x3
  v_mov_b32_dpp v119, v149 row_ror:8 row_mask:0xf bank_mask:0x3
  v_exp_f32 v72, v72
  s_cbranch_vccnz gm_87_r
  v_mfma_f32_16x16x32_bf16 v[80:83], v[88:91], v[116:119], 0
  v_mov_b32_dpp v120, v148 row_ror:8 row_mask:0xf bank_mask:0xc
  v_mov_b32_dpp v121, v149 row_ror:8 row_mask:0xf bank_mask:0xc
  v_mov_b32_dpp v122, v148 quad_perm:[0,1,2,3] row_mask:0xf bank_mask:0xc
  v_mov_b32_dpp v123, v149 quad_perm:[0,1,2,3] row_mask:0xf bank_mask:0xc
  v_mfma_f32_16x16x32_bf16 v[140:143], v[44:47], v[116:119], 0
  v_mov_b32_dpp v73, v72 row_ror:8 row_mask:0xf bank_mask:0xf
  v_cvt_pk_bf16_f32 v150, v72, v73
  v_mfma_f32_16x16x32_bf16 v[144:147], v[52:55], v[116:119], 0
  s_nop 0
  v_mov_b32_dpp v124, v150 quad_perm:[0,1,2,3] row_mask:0xf bank_mask:0x3
  v_mov_b32_dpp v125, v150 quad_perm:[0,1,2,3] row_mask:0xf bank_mask:0x3
  v_mfma_f32_16x16x32_bf16 v[140:143], v[48:51], v[120:123], v[140:143]
  v_mov_b32_dpp v126, v150 row_ror:8 row_mask:0xf bank_mask:0xc
  v_mov_b32_dpp v127, v150 row_ror:8 row_mask:0xf bank_mask:0xc
  v_mfma_f32_16x16x32_bf16 v[144:147], v[56:59], v[120:123], v[144:147]
  v_mfma_f32_16x16x16_bf16 v[80:83], v[130:131], v[124:125], v[80:83]
  s_nop 1
  v_mfma_f32_16x16x16_bf16 v[140:143], v[108:109], v[124:125], v[140:143]
  s_nop 1
  v_mfma_f32_16x16x16_bf16 v[144:147], v[112:113], v[124:125], v[144:147]
  v_mfma_f32_16x16x16_bf16 v[140:143], v[110:111], v[126:127], v[140:143]
  s_nop 0
  v_subrev_u32 v171, 0x21800000, v80
  v_rcp_f32 v128, v80
  v_mfma_f32_16x16x16_bf16 v[144:147], v[114:115], v[126:127], v[144:147]
  v_cmp_lt_u32 vcc, 0x50000000, v171
  ds_write_b32 v169, v128
  s_and_b64 vcc, vcc, s[74:75]
  s_cbranch_vccnz gz_88_r
gz_88:
  s_cmp_eq_u32 s39, 64
  s_cbranch_scc1 chain_last_c2w
  ds_write_b128 v159, v[140:143] offset:0
  s_nop 0
  ds_write_b128 v159, v[144:147] offset:1024
  s_waitcnt lgkmcnt(0)
  s_barrier
  ds_read_b128 v[108:111], v170
  ds_read_b64 v[132:133], v160 offset:0
  ds_read_b64 v[134:135], v160 offset:2048
  ds_read_b64 v[136:137], v160 offset:4096
  ds_read_b64 v[138:139], v160 offset:6144
  s_waitcnt lgkmcnt(3)
  v_pk_mul_f32 v[128:129], v[132:133], v[108:109] op_sel_hi:[1,0]
  s_waitcnt lgkmcnt(2)
  v_pk_fma_f32 v[128:129], v[134:135], v[108:109], v[128:129] op_sel:[0,1,0]
  s_waitcnt lgkmcnt(1)
  v_pk_fma_f32 v[128:129], v[136:137], v[110:111], v[128:129] op_sel_hi:[1,0,1]
  s_waitcnt lgkmcnt(0)
  v_pk_fma_f32 v[128:129], v[138:139], v[110:111], v[128:129] op_sel:[0,1,0]
  v_cvt_pk_bf16_f32 v128, v128, v129
  buffer_store_dword v128, v168, s[8:11], s63 offen sc1
  buffer_store_dword v128, v168, s[8:11], s61 offen sc1
  s_xor_b32 s68, s65, 1024
  ds_bpermute_b32 v42, v175, v128
  v_mov_b32 v4, 0
  v_mov_b32 v5, 0
  v_mov_b32 v6, 0
  v_mov_b32 v7, 0
  v_pk_add_f32 v[92:93], v[92:93], v[94:95]
  v_cvt_pk_bf16_f32 v80, v92, v93
  v_pk_add_f32 v[96:97], v[96:97], v[98:99]
  v_cvt_pk_bf16_f32 v81, v96, v97
  v_pk_add_f32 v[100:101], v[100:101], v[102:103]
  v_cvt_pk_bf16_f32 v82, v100, v101
  v_pk_add_f32 v[104:105], v[104:105], v[106:107]
  v_cvt_pk_bf16_f32 v83, v104, v105
  buffer_store_dwordx4 v[80:83], v152, s[8:11], s56 offen
  ds_read_b64_tr_b16 v[60:61], v153 offset:12288
  ds_read_b64_tr_b16 v[62:63], v153 offset:12800
  ds_read_b64_tr_b16 v[64:65], v153 offset:13312
  ds_read_b64_tr_b16 v[66:67], v153 offset:13824
  v_mov_b32 v16, -1
  v_mov_b32 v17, -1
  v_mov_b32 v18, -1
  v_mov_b32 v19, -1
  ds_write_b128 v152, v[16:19] offset:12288
  ds_write_b128 v152, v[16:19] offset:13312
  s_waitcnt lgkmcnt(2)
  buffer_store_dwordx4 v[60:63], v166, s[8:11], s55 offen
  buffer_store_dwordx4 v[64:67], v166, s[8:11], s55 offen offset:512
  s_add_u32 s43, s39, 1
  v_mov_b32 v174, s39
  s_mov_b32 s40, 0
cpw_90:
  v_cmp_gt_u32 vcc, s43, v167
  s_nop 0
  s_and_b32 vcc_lo, vcc_lo, 0xfff000
  s_and_b32 vcc_hi, vcc_hi, 0xfffff0
  s_cmp_eq_u64 vcc, 0
  s_cbranch_scc1 cpo_91
  s_sleep 1
  buffer_load_dword v167, v162, s[8:11], 0 offen sc1
  s_add_u32 s40, s40, 1
  s_cmp_gt_u32 s40, 65536
  s_cbranch_scc1 chain_abort
  s_waitcnt vmcnt(0)
  s_branch cpw_90
cpo_91:
  s_and_b32 s41, s39, 3
  s_mul_i32 s46, s41, 81920
  s_add_u32 s46, s46, s45
  s_lshl_b32 s42, s41, 15
  s_add_u32 s43, s47, s42
  s_add_u32 s49, s43, s53
  s_add_u32 s50, s43, s54
  s_mul_i32 s43, s41, 227328
  s_add_u32 s55, s58, s43
  s_add_u32 s56, s59, s43
  s_add_u32 s51, s48, s42
  s_add_u32 s52, s51, 4096
  s_mul_i32 s62, s41, 163840
  s_add_u32 s62, s62, s64
  s_lshl_b32 s42, s16, 8
  s_add_u32 s61, s62, s42
  s_xor_b32 s63, s61, 8192
  v_mov_b32 v92, 0
  v_mov_b32 v93, 0
  v_mov_b32 v94, 0
  v_mov_b32 v95, 0
  v_mov_b32 v96, 0
  v_mov_b32 v97, 0
  v_mov_b32 v98, 0
  v_mov_b32 v99, 0
  v_mov_b32 v100, 0
  v_mov_b32 v101, 0
  v_mov_b32 v102, 0
  v_mov_b32 v103, 0
  v_mov_b32 v104, 0
  v_mov_b32 v105, 0
  v_mov_b32 v106, 0
  v_mov_b32 v107, 0
  v_mov_b32 v68, 0
  v_mov_b32 v69, 0
  v_mov_b32 v70, 0
  v_mov_b32 v71, 0
  v_mov_b32 v72, 0
  v_mov_b32 v73, 0
  v_mov_b32 v74, 0
  v_mov_b32 v75, 0
  v_mov_b32 v76, 0
  v_mov_b32 v77, 0
  v_mov_b32 v78, 0
  v_mov_b32 v79, 0
  s_mov_b64 exec, s[70:71]
  buffer_load_dwordx4 v[4:7], v152, s[8:11], s65 offen sc1
  s_mov_b64 exec, -1
  buffer_load_dwordx4 v[8:11], v152, s[8:11], s68 offen sc1
  s_waitcnt lgkmcnt(0)
  v_lshlrev_b32 v40, 16, v42
  v_and_b32 v41, 0xffff0000, v42
  s_and_b32 s67, s39, 3
  s_mul_i32 s67, s67, 227328
  s_add_u32 s67, s67, s60
  s_mov_b32 s40, 0
  s_waitcnt vmcnt(0)
xp_92:
  v_mfma_f32_16x16x32_bf16 v[36:39], v[84:87], v[4:7], v[40:43]
  v_mfma_f32_16x16x32_bf16 v[36:39], v[84:87], v[8:11], v[36:39]
  s_nop 7
  v_cmp_u_f32 vcc, v36, v37
  v_cvt_pk_bf16_f32 v172, v36, v37
  s_cbranch_vccnz xp_92_r
xp_92_ok:
  buffer_store_dword v172, v161, s[8:11], s46 offen
  buffer_store_dword v174, v163, s[8:11], 0 offen
  s_branch chain_loop_c2w
gx_86_r:
  v_max3_u32 v173, v20, v21, v22
  v_max_u32 v173, v173, v23
  v_cmp_eq_u32 vcc, -1, v173
  s_cbranch_vccz gx_86_s0
  s_mov_b64 exec, vcc
  buffer_load_dwordx4 v[20:23], v152, s[8:11], s51 offen offset:0 sc1
  s_mov_b64 exec, -1
gx_86_s0:
  v_max3_u32 v173, v24, v25, v26
  v_max_u32 v173, v173, v27
  v_cmp_eq_u32 vcc, -1, v173
  s_cbranch_vccz gx_86_s1
  s_mov_b64 exec, vcc
  buffer_load_dwordx4 v[24:27], v152, s[8:11], s51 offen offset:1024 sc1
  s_mov_b64 exec, -1
gx_86_s1:
  v_max3_u32 v173, v28, v29, v30
  v_max_u32 v173, v173, v31
  v_cmp_eq_u32 vcc, -1, v173
  s_cbranch_vccz gx_86_s2
  s_mov_b64 exec, vcc
  buffer_load_dwordx4 v[28:31], v152, s[8:11], s51 offen offset:2048 sc1
  s_mov_b64 exec, -1
gx_86_s2:
  buffer_load_dwordx3 v[16:18], v152, s[8:11], s51 offen offset:3072 sc1
  s_add_u32 s40, s40, 1
  s_cmp_gt_u32 s40, 65536
  s_cbranch_scc1 chain_abort
  s_waitcnt vmcnt(0)
  s_branch gx_86
gm_87_r:
  v_max3_u32 v173, v16, v17, v18
  v_cmp_eq_u32 vcc, -1, v173
  s_cbranch_vccz gm_87_s0
  s_mov_b64 exec, vcc
  buffer_load_dwordx3 v[16:18], v152, s[8:11], s51 offen offset:3072 sc1
  s_mov_b64 exec, -1
gm_87_s0:
  s_add_u32 s40, s40, 1
  s_cmp_gt_u32 s40, 65536
  s_cbranch_scc1 chain_abort
  s_waitcnt vmcnt(0)
  s_branch gm_87
gv_89_r:
  v_max3_u32 v173, v4, v5, v6
  v_max_u32 v173, v173, v7
  v_cmp_eq_u32 vcc, -1, v173
  s_cbranch_vccz gv_89_s0
  s_mov_b64 exec, vcc
  buffer_load_dwordx4 v[4:7], v152, s[8:11], s52 offen offset:0 sc1
  s_mov_b64 exec, -1
gv_89_s0:
  v_max3_u32 v173, v8, v9, v10
  v_max_u32 v173, v173, v11
  v_cmp_eq_u32 vcc, -1, v173
  s_cbranch_vccz gv_89_s1
  s_mov_b64 exec, vcc
  buffer_load_dwordx4 v[8:11], v152, s[8:11], s52 offen offset:1024 sc1
  s_mov_b64 exec, -1
gv_89_s1:
  v_max3_u32 v173, v12, v13, v14
  v_max_u32 v173, v173, v15
  v_cmp_eq_u32 vcc, -1, v173
  s_cbranch_vccz gv_89_s2
  s_mov_b64 exec, vcc
  buffer_load_dwordx4 v[12:15], v152, s[8:11], s52 offen offset:2048 sc1
  s_mov_b64 exec, -1
gv_89_s2:
  s_add_u32 s40, s40, 1
  s_cmp_gt_u32 s40, 65536
  s_cbranch_scc1 chain_abort
  s_waitcnt vmcnt(0)
  s_branch gv_89
gz_88_r:
  v_pk_add_f32 v[68:69], v[20:21], v[24:25]
  v_pk_add_f32 v[70:71], v[22:23], v[26:27]
  v_pk_add_f32 v[68:69], v[68:69], v[28:29]
  v_pk_add_f32 v[70:71], v[70:71], v[30:31]
  v_add_f32 v72, v16, v17
  v_add_f32 v72, v72, v18
  v_max3_f32 v171, v68, v69, v70
  v_max3_f32 v171, v171, v71, v72
  s_nop 1
  v_max_f32_dpp v171, v171, v171 row_ror:8 row_mask:0xf bank_mask:0xf
  v_mov_b32 v172, v171
  s_nop 1
  v_permlane16_swap_b32 v171, v172
  v_max_f32 v171, v171, v172
  v_mov_b32 v172, v171
  s_nop 1
  v_permlane32_swap_b32 v171, v172
  v_max_f32 v171, v171, v172
  v_sub_f32 v68, v68, v171
  v_mul_f32 v68, s82, v68
  v_exp_f32 v68, v68
  v_sub_f32 v69, v69, v171
  v_mul_f32 v69, s82, v69
  v_exp_f32 v69, v69
  v_sub_f32 v70, v70, v171
  v_mul_f32 v70, s82, v70
  v_exp_f32 v70, v70
  v_sub_f32 v71, v71, v171
  v_mul_f32 v71, s82, v71
  v_exp_f32 v71, v71
  v_sub_f32 v72, v72, v171
  v_mul_f32 v72, s82, v72
  v_exp_f32 v72, v72
  v_cvt_pk_bf16_f32 v148, v68, v69
  v_cvt_pk_bf16_f32 v149, v70, v71
  s_nop 0
  v_mov_b32_dpp v116, v148 quad_perm:[0,1,2,3] row_mask:0xf bank_mask:0x3
  v_mov_b32_dpp v117, v149 quad_perm:[0,1,2,3] row_mask:0xf bank_mask:0x3
  v_mov_b32_dpp v118, v148 row_ror:8 row_mask:0xf bank_mask:0x3
  v_mov_b32_dpp v119, v149 row_ror:8 row_mask:0xf bank_mask:0x3
  v_mov_b32_dpp v120, v148 row_ror:8 row_mask:0xf bank_mask:0xc
  v_mov_b32_dpp v121, v149 row_ror:8 row_mask:0xf bank_mask:0xc
  v_mov_b32_dpp v122, v148 quad_perm:[0,1,2,3] row_mask:0xf bank_mask:0xc
  v_mov_b32_dpp v123, v149 quad_perm:[0,1,2,3] row_mask:0xf bank_mask:0xc
  v_mov_b32_dpp v73, v72 row_ror:8 row_mask:0xf bank_mask:0xf
  v_cvt_pk_bf16_f32 v150, v72, v73
  s_nop 1
  v_mov_b32_dpp v124, v150 quad_perm:[0,1,2,3] row_mask:0xf bank_mask:0x3
  v_mov_b32_dpp v125, v150 quad_perm:[0,1,2,3] row_mask:0xf bank_mask:0x3
  v_mov_b32_dpp v126, v150 row_ror:8 row_mask:0xf bank_mask:0xc
  v_mov_b32_dpp v127, v150 row_ror:8 row_mask:0xf bank_mask:0xc
  v_mfma_f32_16x16x32_bf16 v[80:83], v[88:91], v[116:119], 0
  v_mfma_f32_16x16x32_bf16 v[140:143], v[44:47], v[116:119], 0
  v_mfma_f32_16x16x32_bf16 v[144:147], v[52:55], v[116:119], 0
  v_mfma_f32_16x16x32_bf16 v[140:143], v[48:51], v[120:123], v[140:143]
  v_mfma_f32_16x16x32_bf16 v[144:147], v[56:59], v[120:123], v[144:147]
  s_nop 1
  v_mfma_f32_16x16x16_bf16 v[80:83], v[130:131], v[124:125], v[80:83]
  s_nop 1
  v_mfma_f32_16x16x16_bf16 v[140:143], v[108:109], v[124:125], v[140:143]
  v_mfma_f32_16x16x16_bf16 v[144:147], v[112:113], v[124:125], v[144:147]
  v_mfma_f32_16x16x16_bf16 v[140:143], v[110:111], v[126:127], v[140:143]
  v_mfma_f32_16x16x16_bf16 v[144:147], v[114:115], v[126:127], v[144:147]
  s_nop 1
  v_rcp_f32 v128, v80
  s_nop 0
  ds_write_b32 v169, v128
  s_branch gz_88
xp_92_r:
  v_max3_u32 v173, v4, v5, v6
  v_max_u32 v173, v173, v7
  v_cmp_eq_u32 vcc, -1, v173
  s_cbranch_vccz xp_92_s0
  s_mov_b64 exec, vcc
  buffer_load_dwordx4 v[4:7], v152, s[8:11], s65 offen sc1
  s_mov_b64 exec, -1
  s_mov_b64 exec, -1
xp_92_s0:
  v_max3_u32 v173, v8, v9, v10
  v_max_u32 v173, v173, v11
  v_cmp_eq_u32 vcc, -1, v173
  s_cbranch_vccz xp_92_s1
  s_mov_b64 exec, vcc
  buffer_load_dwordx4 v[8:11], v152, s[8:11], s68 offen sc1
  s_mov_b64 exec, -1
xp_92_s1:
  s_add_u32 s40, s40, 1
  s_cmp_gt_u32 s40, 65536
  s_cbranch_scc1 chain_abort
  s_waitcnt vmcnt(0)
  s_branch xp_92
chain_last_c2w:
  v_pk_add_f32 v[92:93], v[92:93], v[94:95]
  v_cvt_pk_bf16_f32 v80, v92, v93
  v_pk_add_f32 v[96:97], v[96:97], v[98:99]
  v_cvt_pk_bf16_f32 v81, v96, v97
  v_pk_add_f32 v[100:101], v[100:101], v[102:103]
  v_cvt_pk_bf16_f32 v82, v100, v101
  v_pk_add_f32 v[104:105], v[104:105], v[106:107]
  v_cvt_pk_bf16_f32 v83, v104, v105
  buffer_store_dwordx4 v[80:83], v152, s[8:11], s56 offen
  s_waitcnt lgkmcnt(0)
  s_barrier
  ds_read_b64_tr_b16 v[60:61], v153 offset:12288
  ds_read_b64_tr_b16 v[62:63], v153 offset:12800
  ds_read_b64_tr_b16 v[64:65], v153 offset:13312
  ds_read_b64_tr_b16 v[66:67], v153 offset:13824
  v_mov_b32 v16, -1
  v_mov_b32 v17, -1
  v_mov_b32 v18, -1
  v_mov_b32 v19, -1
  ds_write_b128 v152, v[16:19] offset:12288
  ds_write_b128 v152, v[16:19] offset:13312
  s_waitcnt lgkmcnt(2)
  buffer_store_dwordx4 v[60:63], v166, s[8:11], s55 offen
  buffer_store_dwordx4 v[64:67], v166, s[8:11], s55 offen offset:512
  v_mov_b32 v174, s39
  s_waitcnt vmcnt(0)
  buffer_store_dword v174, v163, s[8:11], 0 offen
  s_branch chain_end
chain_pro_c0n:
  s_mov_b32 s40, 0
cpw_93:
  v_cmp_gt_u32 vcc, 1, v167
  s_nop 0
  s_and_b32 vcc_lo, vcc_lo, 0xfff000
  s_and_b32 vcc_hi, vcc_hi, 0x10000000
  s_cmp_eq_u64 vcc, 0
  s_cbranch_scc1 cpo_94
  s_sleep 1
  buffer_load_dword v167, v162, s[8:11], 0 offen sc1
  s_add_u32 s40, s40, 1
  s_cmp_gt_u32 s40, 65536
  s_cbranch_scc1 chain_abort
  s_waitcnt vmcnt(0)
  s_branch cpw_93
cpo_94:
  s_sub_u32 s41, s36, 10
  s_lshl_b32 s41, s41, 2
  s_add_u32 s41, s41, s17
  s_cmp_lt_u32 s41, 4
  s_cselect_b32 s63, 16, 0
  s_lshl_b32 s63, s63, 13
  s_lshl_b32 s64, s41, 13
  s_mul_i32 s42, s41, 1280
  v_add_u32 v160, s42, v152
  v_add_u32 v161, s42, v168
  s_lshl_b32 s48, s41, 12
  s_lshl_b32 s41, s16, 17
  s_add_u32 s48, s48, s41
  s_add_u32 s48, s48, 3407872
  s_lshl_b32 s41, s16, 8
  s_add_u32 s64, s64, s41
  s_add_u32 s64, s64, 16777216
  v_lshrrev_b32 v171, 4, v1
  v_lshlrev_b32 v171, 11, v171
  v_and_b32 v172, 15, v1
  v_lshl_add_u32 v159, v172, 4, v171
  v_mov_b32 v84, -1
  v_mov_b32 v85, -1
  v_mov_b32 v86, -1
  v_mov_b32 v87, -1
  s_and_b32 s66, s39, 7
  s_mul_i32 s66, s66, 147456
  s_add_u32 s66, s66, s57
  buffer_load_dwordx4 v[60:63], v152, s[8:11], s66 offen offset:0 sc1
  buffer_load_dwordx4 v[64:67], v152, s[8:11], s66 offen offset:1024 sc1
  buffer_load_dword v167, v162, s[8:11], 0 offen sc1
  s_and_b32 s41, s39, 3
  s_mul_i32 s46, s41, 81920
  s_add_u32 s46, s46, s45
  s_lshl_b32 s42, s41, 15
  s_add_u32 s43, s47, s42
  s_add_u32 s49, s43, s53
  s_add_u32 s50, s43, s54
  s_mul_i32 s43, s41, 227328
  s_add_u32 s55, s58, s43
  v_mov_b32 v68, 0
  v_mov_b32 v69, 0
  v_mov_b32 v70, 0
  v_mov_b32 v71, 0
  v_mov_b32 v72, 0
  v_mov_b32 v73, 0
  v_mov_b32 v74, 0
  v_mov_b32 v75, 0
  v_mov_b32 v76, 0
  v_mov_b32 v77, 0
  v_mov_b32 v78, 0
  v_mov_b32 v79, 0
chain_loop_c0n:
  s_mov_b32 s40, 0
  buffer_load_dwordx4 v[140:143], v154, s[8:11], s46 offen sc1
  buffer_load_dwordx4 v[144:147], v154, s[8:11], s46 offen offset:1024 sc1
  buffer_load_dword v148, v155, s[8:11], s46 offen sc1
  buffer_load_dword v149, v155, s[8:11], s46 offen offset:256 sc1
  s_nop 15
  s_nop 15
mq_95:
  buffer_load_dwordx4 v[108:111], v154, s[8:11], s46 offen sc1
  buffer_load_dwordx4 v[112:115], v154, s[8:11], s46 offen offset:1024 sc1
  buffer_load_dword v150, v155, s[8:11], s46 offen sc1
  buffer_load_dword v151, v155, s[8:11], s46 offen offset:256 sc1
  s_add_u32 s40, s40, 1
  s_cmp_gt_u32 s40, 65536
  s_cbranch_scc1 chain_abort
  s_waitcnt vmcnt(4)
  v_max3_u32 v171, v140, v144, v148
  v_max_u32 v171, v171, v149
  v_cmp_eq_u32 vcc, -1, v171
  ds_write_b128 v154, v[140:143]
  ds_write_b128 v154, v[144:147] offset:1024
  ds_write2st64_b32 v155, v148, v149 offset0:0 offset1:1
  s_cbranch_vccz mq_95_ok
  buffer_load_dwordx4 v[140:143], v154, s[8:11], s46 offen sc1
  buffer_load_dwordx4 v[144:147], v154, s[8:11], s46 offen offset:1024 sc1
  buffer_load_dword v148, v155, s[8:11], s46 offen sc1
  buffer_load_dword v149, v155, s[8:11], s46 offen offset:256 sc1
  s_waitcnt vmcnt(4)
  v_max3_u32 v171, v108, v112, v150
  v_max_u32 v171, v171, v151
  v_cmp_eq_u32 vcc, -1, v171
  ds_write_b128 v154, v[108:111]
  ds_write_b128 v154, v[112:115] offset:1024
  ds_write2st64_b32 v155, v150, v151 offset0:0 offset1:1
  s_cbranch_vccz mq_95_ok
  s_branch mq_95
mq_95_ok:
  s_waitcnt lgkmcnt(0)
  s_barrier
  ds_read_b128 v[4:7], v152 offset:0
  ds_read_b128 v[8:11], v152 offset:1024
  ds_read_b128 v[12:15], v152 offset:2048
  ds_read_b128 v[16:19], v152 offset:3072
  ds_read_b128 v[20:23], v152 offset:4096
  ds_read_b128 v[24:27], v152 offset:5120
  ds_read_b128 v[28:31], v152 offset:6144
  ds_read_b128 v[32:35], v152 offset:7168
  ds_read_b128 v[36:39], v152 offset:8192
  ds_read_b128 v[40:43], v152 offset:9216
  s_waitcnt lgkmcnt(9)
  v_smfmac_f32_16x16x64_bf16 v[76:79], v[4:7], a[160:167], v164
  s_waitcnt lgkmcnt(8)
  v_smfmac_f32_16x16x64_bf16 v[76:79], v[8:11], a[168:175], v164
  s_waitcnt lgkmcnt(7)
  v_smfmac_f32_16x16x64_bf16 v[76:79], v[12:15], a[176:183], v164
  s_waitcnt lgkmcnt(6)
  v_smfmac_f32_16x16x64_bf16 v[76:79], v[16:19], a[184:191], v164
  s_waitcnt lgkmcnt(5)
  v_smfmac_f32_16x16x64_bf16 v[76:79], v[20:23], a[192:199], v164
  s_waitcnt lgkmcnt(4)
  v_smfmac_f32_16x16x64_bf16 v[76:79], v[24:27], a[200:207], v164
  s_waitcnt lgkmcnt(3)
  v_smfmac_f32_16x16x64_bf16 v[76:79], v[28:31], a[208:215], v164
  s_waitcnt lgkmcnt(2)
  v_smfmac_f32_16x16x64_bf16 v[76:79], v[32:35], a[216:223], v164
  s_waitcnt lgkmcnt(1)
  v_smfmac_f32_16x16x64_bf16 v[76:79], v[36:39], a[224:231], v164
  s_waitcnt lgkmcnt(0)
  v_smfmac_f32_16x16x64_bf16 v[76:79], v[40:43], a[232:239], v164
  s_nop 2
  v_smfmac_f32_16x16x64_bf16 v[68:71], v[4:7], a[0:7], v164
  s_nop 2
  v_smfmac_f32_16x16x64_bf16 v[68:71], v[8:11], a[8:15], v164
  v_add_f32 v76, v76, v78
  v_add_f32 v77, v77, v79
  v_smfmac_f32_16x16x64_bf16 v[68:71], v[12:15], a[16:23], v164
  v_cvt_pk_bf16_f32 v171, v76, v77
  s_nop 0
  v_smfmac_f32_16x16x64_bf16 v[68:71], v[16:19], a[24:31], v164
  v_mov_b32_dpp v172, v171 row_ror:4 row_mask:0xf bank_mask:0xa
  s_nop 0
  v_smfmac_f32_16x16x64_bf16 v[68:71], v[20:23], a[32:39], v164
  v_mov_b32_dpp v172, v171 row_ror:12 row_mask:0xf bank_mask:0x5
  s_nop 0
  v_smfmac_f32_16x16x64_bf16 v[68:71], v[24:27], a[40:47], v164
  v_perm_b32 v171, v172, v171, v165
  buffer_store_dword v171, v158, s[8:11], s50 offen
  v_smfmac_f32_16x16x64_bf16 v[68:71], v[28:31], a[48:55], v164
  v_smfmac_f32_16x16x64_bf16 v[68:71], v[32:35], a[56:63], v164
  v_smfmac_f32_16x16x64_bf16 v[68:71], v[36:39], a[64:71], v164
  v_smfmac_f32_16x16x64_bf16 v[68:71], v[40:43], a[72:79], v164
  s_nop 2
  v_smfmac_f32_16x16x64_bf16 v[72:75], v[4:7], a[80:87], v164
  s_nop 2
  v_smfmac_f32_16x16x64_bf16 v[72:75], v[8:11], a[88:95], v164
  v_add_f32 v68, v68, v70
  v_add_f32 v69, v69, v71
  v_smfmac_f32_16x16x64_bf16 v[72:75], v[12:15], a[96:103], v164
  v_cvt_pk_bf16_f32 v128, v68, v69
  ds_write2_b32 v156, v128, v128 offset0:0 offset1:4
  v_smfmac_f32_16x16x64_bf16 v[72:75], v[16:19], a[104:111], v164
  v_smfmac_f32_16x16x64_bf16 v[72:75], v[20:23], a[112:119], v164
  v_smfmac_f32_16x16x64_bf16 v[72:75], v[24:27], a[120:127], v164
  v_smfmac_f32_16x16x64_bf16 v[72:75], v[28:31], a[128:135], v164
  ds_read_b64_tr_b16 v[132:133], v153 offset:10240
  ds_read_b64_tr_b16 v[134:135], v153 offset:10752
  v_smfmac_f32_16x16x64_bf16 v[72:75], v[32:35], a[136:143], v164
  ds_read_b64_tr_b16 v[136:137], v153 offset:11264
  ds_read_b64_tr_b16 v[138:139], v153 offset:11776
  v_smfmac_f32_16x16x64_bf16 v[72:75], v[36:39], a[144:151], v164
  v_smfmac_f32_16x16x64_bf16 v[72:75], v[40:43], a[152:159], v164
  s_nop 7
  v_add_f32 v72, v72, v74
  v_add_f32 v73, v73, v75
  v_cvt_pk_bf16_f32 v129, v72, v73
  ds_write2_b32 v157, v129, v129 offset0:0 offset1:1
  s_waitcnt lgkmcnt(1)
  v_mfma_f32_16x16x32_bf16 v[80:83], v[60:63], v[132:135], 0
  v_mfma_f32_16x16x32_bf16 v[80:83], v[64:67], v[136:139], v[80:83]
  s_nop 7
  v_cmp_u_f32 vcc, v80, v81
  s_mov_b64 exec, s[78:79]
  s_cbranch_vccnz sx_96_r
sx_96:
  buffer_store_dwordx4 v[80:83], v152, s[8:11], s49 offen
  s_mov_b64 exec, -1
  s_sub_u32 s41, s39, 1
  s_and_b32 s41, s41, 3
  s_lshl_b32 s42, s41, 15
  s_add_u32 s42, s42, s48
  s_mul_i32 s41, s41, 81920
  s_add_u32 s41, s41, s45
  s_add_u32 s39, s39, 1
  v_mov_b32 v174, s39
  s_waitcnt vmcnt(0) lgkmcnt(0)
  s_barrier
  s_waitcnt vmcnt(0)
  buffer_store_dword v174, v163, s[8:11], 0 offen
  s_cmp_eq_u32 s39, 64
  s_cbranch_scc1 chain_end
  s_barrier
  buffer_store_dwordx4 v[84:87], v152, s[8:11], s42 offen offset:0
  buffer_store_dwordx4 v[84:87], v152, s[8:11], s42 offen offset:1024
  buffer_store_dwordx4 v[84:87], v152, s[8:11], s42 offen offset:2048
  buffer_store_dwordx4 v[84:87], v152, s[8:11], s42 offen offset:3072
  buffer_store_dwordx4 v[84:87], v160, s[8:11], s41 offen
  buffer_store_dword v84, v161, s[8:11], s41 offen offset:1024
  s_add_u32 s41, s39, 1
  s_and_b32 s41, s41, 3
  s_mul_i32 s41, s41, 163840
  s_add_u32 s41, s41, s64
  s_add_u32 s43, s41, s63
  buffer_store_dwordx4 v[84:87], v159, s[8:11], s41 offen sc1
  s_add_u32 s41, s41, 65536
  buffer_store_dwordx4 v[84:87], v159, s[8:11], s41 offen sc1
  s_add_u32 s41, s41, 65536
  buffer_store_dwordx4 v[84:87], v159, s[8:11], s43 offen sc1
  s_add_u32 s43, s39, 1
  s_mov_b32 s40, 0
cpw_97:
  v_cmp_gt_u32 vcc, s43, v167
  s_nop 0
  s_and_b32 vcc_lo, vcc_lo, 0xfff000
  s_and_b32 vcc_hi, vcc_hi, 0x0
  s_cmp_eq_u64 vcc, 0
  s_cbranch_scc1 cpo_98
  s_sleep 1
  buffer_load_dword v167, v162, s[8:11], 0 offen sc1
  s_add_u32 s40, s40, 1
  s_cmp_gt_u32 s40, 65536
  s_cbranch_scc1 chain_abort
  s_waitcnt vmcnt(0)
  s_branch cpw_97
cpo_98:
  s_and_b32 s66, s39, 7
  s_mul_i32 s66, s66, 147456
  s_add_u32 s66, s66, s57
  buffer_load_dwordx4 v[60:63], v152, s[8:11], s66 offen offset:0 sc1
  buffer_load_dwordx4 v[64:67], v152, s[8:11], s66 offen offset:1024 sc1
  buffer_load_dword v167, v162, s[8:11], 0 offen sc1
  s_and_b32 s41, s39, 3
  s_mul_i32 s46, s41, 81920
  s_add_u32 s46, s46, s45
  s_lshl_b32 s42, s41, 15
  s_add_u32 s43, s47, s42
  s_add_u32 s49, s43, s53
  s_add_u32 s50, s43, s54
  s_mul_i32 s43, s41, 227328
  s_add_u32 s55, s58, s43
  v_mov_b32 v68, 0
  v_mov_b32 v69, 0
  v_mov_b32 v70, 0
  v_mov_b32 v71, 0
  v_mov_b32 v72, 0
  v_mov_b32 v73, 0
  v_mov_b32 v74, 0
  v_mov_b32 v75, 0
  v_mov_b32 v76, 0
  v_mov_b32 v77, 0
  v_mov_b32 v78, 0
  v_mov_b32 v79, 0
  s_waitcnt vmcnt(0)
  s_sleep 8
  s_branch chain_loop_c0n
sx_96_r:
  s_mov_b64 exec, -1
  ds_read_b64_tr_b16 v[132:133], v153 offset:10240
  ds_read_b64_tr_b16 v[134:135], v153 offset:10752
  ds_read_b64_tr_b16 v[136:137], v153 offset:11264
  ds_read_b64_tr_b16 v[138:139], v153 offset:11776
  s_add_u32 s40, s40, 1
  s_cmp_gt_u32 s40, 65536
  s_cbranch_scc1 chain_abort
  s_waitcnt lgkmcnt(0)
  v_mfma_f32_16x16x32_bf16 v[80:83], v[60:63], v[132:135], 0
  v_mfma_f32_16x16x32_bf16 v[80:83], v[64:67], v[136:139], v[80:83]
  s_nop 7
  v_cmp_u_f32 vcc, v80, v81
  s_mov_b64 exec, s[78:79]
  s_cbranch_vccnz sx_96_r
  s_branch sx_96
chain_pro_c1n:
  s_mov_b32 s40, 0
cpw_99:
  v_cmp_gt_u32 vcc, 1, v167
  s_nop 0
  s_and_b32 vcc_lo, vcc_lo, 0xfff000
  s_and_b32 vcc_hi, vcc_hi, 0x10000000
  s_cmp_eq_u64 vcc, 0
  s_cbranch_scc1 cpo_100
  s_sleep 1
  buffer_load_dword v167, v162, s[8:11], 0 offen sc1
  s_add_u32 s40, s40, 1
  s_cmp_gt_u32 s40, 65536
  s_cbranch_scc1 chain_abort
  s_waitcnt vmcnt(0)
  s_branch cpw_99
cpo_100:
  s_sub_u32 s41, s36, 10
  s_lshl_b32 s41, s41, 2
  s_add_u32 s41, s41, s17
  s_cmp_lt_u32 s41, 4
  s_cselect_b32 s63, 16, 0
  s_lshl_b32 s63, s63, 13
  s_lshl_b32 s64, s41, 13
  s_mul_i32 s42, s41, 1280
  v_add_u32 v160, s42, v152
  v_add_u32 v161, s42, v168
  s_lshl_b32 s48, s41, 12
  s_lshl_b32 s41, s16, 17
  s_add_u32 s48, s48, s41
  s_add_u32 s48, s48, 3407872
  s_lshl_b32 s41, s16, 8
  s_add_u32 s64, s64, s41
  s_add_u32 s64, s64, 16777216
  v_lshrrev_b32 v171, 4, v1
  v_lshlrev_b32 v171, 11, v171
  v_and_b32 v172, 15, v1
  v_lshl_add_u32 v159, v172, 4, v171
  v_mov_b32 v84, -1
  v_mov_b32 v85, -1
  v_mov_b32 v86, -1
  v_mov_b32 v87, -1
  buffer_load_dword v167, v162, s[8:11], 0 offen sc1
  s_and_b32 s41, s39, 3
  s_mul_i32 s46, s41, 81920
  s_add_u32 s46, s46, s45
  s_lshl_b32 s42, s41, 15
  s_add_u32 s43, s47, s42
  s_add_u32 s49, s43, s53
  s_add_u32 s50, s43, s54
  s_mul_i32 s43, s41, 227328
  s_add_u32 s55, s58, s43
  v_mov_b32 v68, 0
  v_mov_b32 v69, 0
  v_mov_b32 v70, 0
  v_mov_b32 v71, 0
  v_mov_b32 v72, 0
  v_mov_b32 v73, 0
  v_mov_b32 v74, 0
  v_mov_b32 v75, 0
  v_mov_b32 v76, 0
  v_mov_b32 v77, 0
  v_mov_b32 v78, 0
  v_mov_b32 v79, 0
  v_mov_b32 v16, -1
  v_mov_b32 v17, -1
  v_mov_b32 v18, -1
  v_mov_b32 v19, -1
  ds_write_b128 v152, v[16:19] offset:10240
  ds_write_b128 v152, v[16:19] offset:11264
chain_loop_c1n:
  s_mov_b32 s40, 0
  buffer_load_dwordx4 v[140:143], v154, s[8:11], s46 offen sc1
  buffer_load_dwordx4 v[144:147], v154, s[8:11], s46 offen offset:1024 sc1
  buffer_load_dword v148, v155, s[8:11], s46 offen sc1
  buffer_load_dword v149, v155, s[8:11], s46 offen offset:256 sc1
  s_nop 15
  s_nop 15
mq_101:
  buffer_load_dwordx4 v[108:111], v154, s[8:11], s46 offen sc1
  buffer_load_dwordx4 v[112:115], v154, s[8:11], s46 offen offset:1024 sc1
  buffer_load_dword v150, v155, s[8:11], s46 offen sc1
  buffer_load_dword v151, v155, s[8:11], s46 offen offset:256 sc1
  s_add_u32 s40, s40, 1
  s_cmp_gt_u32 s40, 65536
  s_cbranch_scc1 chain_abort
  s_waitcnt vmcnt(4)
  v_max3_u32 v171, v140, v144, v148
  v_max_u32 v171, v171, v149
  v_cmp_eq_u32 vcc, -1, v171
  ds_write_b128 v154, v[140:143]
  ds_write_b128 v154, v[144:147] offset:1024
  ds_write2st64_b32 v155, v148, v149 offset0:0 offset1:1
  s_cbranch_vccz mq_101_ok
  buffer_load_dwordx4 v[140:143], v154, s[8:11], s46 offen sc1
  buffer_load_dwordx4 v[144:147], v154, s[8:11], s46 offen offset:1024 sc1
  buffer_load_dword v148, v155, s[8:11], s46 offen sc1
  buffer_load_dword v149, v155, s[8:11], s46 offen offset:256 sc1
  s_waitcnt vmcnt(4)
  v_max3_u32 v171, v108, v112, v150
  v_max_u32 v171, v171, v151
  v_cmp_eq_u32 vcc, -1, v171
  ds_write_b128 v154, v[108:111]
  ds_write_b128 v154, v[112:115] offset:1024
  ds_write2st64_b32 v155, v150, v151 offset0:0 offset1:1
  s_cbranch_vccz mq_101_ok
  s_branch mq_101
mq_101_ok:
  s_waitcnt lgkmcnt(0)
  s_barrier
  ds_read_b128 v[4:7], v152 offset:0
  ds_read_b128 v[8:11], v152 offset:1024
  ds_read_b128 v[12:15], v152 offset:2048
  ds_read_b128 v[16:19], v152 offset:3072
  ds_read_b128 v[20:23], v152 offset:4096
  ds_read_b128 v[24:27], v152 offset:5120
  ds_read_b128 v[28:31], v152 offset:6144
  ds_read_b128 v[32:35], v152 offset:7168
  ds_read_b128 v[36:39], v152 offset:8192
  ds_read_b128 v[40:43], v152 offset:9216
  s_waitcnt lgkmcnt(9)
  v_smfmac_f32_16x16x64_bf16 v[76:79], v[4:7], a[160:167], v164
  s_waitcnt lgkmcnt(8)
  v_smfmac_f32_16x16x64_bf16 v[76:79], v[8:11], a[168:175], v164
  s_waitcnt lgkmcnt(7)
  v_smfmac_f32_16x16x64_bf16 v[76:79], v[12:15], a[176:183], v164
  s_waitcnt lgkmcnt(6)
  v_smfmac_f32_16x16x64_bf16 v[76:79], v[16:19], a[184:191], v164
  s_waitcnt lgkmcnt(5)
  v_smfmac_f32_16x16x64_bf16 v[76:79], v[20:23], a[192:199], v164
  s_waitcnt lgkmcnt(4)
  v_smfmac_f32_16x16x64_bf16 v[76:79], v[24:27], a[200:207], v164
  s_waitcnt lgkmcnt(3)
  v_smfmac_f32_16x16x64_bf16 v[76:79], v[28:31], a[208:215], v164
  s_waitcnt lgkmcnt(2)
  v_smfmac_f32_16x16x64_bf16 v[76:79], v[32:35], a[216:223], v164
  s_waitcnt lgkmcnt(1)
  v_smfmac_f32_16x16x64_bf16 v[76:79], v[36:39], a[224:231], v164
  s_waitcnt lgkmcnt(0)
  v_smfmac_f32_16x16x64_bf16 v[76:79], v[40:43], a[232:239], v164
  s_nop 2
  v_smfmac_f32_16x16x64_bf16 v[68:71], v[4:7], a[0:7], v164
  s_nop 2
  v_smfmac_f32_16x16x64_bf16 v[68:71], v[8:11], a[8:15], v164
  v_add_f32 v76, v76, v78
  v_add_f32 v77, v77, v79
  v_smfmac_f32_16x16x64_bf16 v[68:71], v[12:15], a[16:23], v164
  v_cvt_pk_bf16_f32 v171, v76, v77
  s_nop 0
  v_smfmac_f32_16x16x64_bf16 v[68:71], v[16:19], a[24:31], v164
  v_mov_b32_dpp v172, v171 row_ror:4 row_mask:0xf bank_mask:0xa
  s_nop 0
  v_smfmac_f32_16x16x64_bf16 v[68:71], v[20:23], a[32:39], v164
  v_mov_b32_dpp v172, v171 row_ror:12 row_mask:0xf bank_mask:0x5
  s_nop 0
  v_smfmac_f32_16x16x64_bf16 v[68:71], v[24:27], a[40:47], v164
  v_perm_b32 v171, v172, v171, v165
  buffer_store_dword v171, v158, s[8:11], s50 offen
  v_smfmac_f32_16x16x64_bf16 v[68:71], v[28:31], a[48:55], v164
  v_smfmac_f32_16x16x64_bf16 v[68:71], v[32:35], a[56:63], v164
  v_smfmac_f32_16x16x64_bf16 v[68:71], v[36:39], a[64:71], v164
  v_smfmac_f32_16x16x64_bf16 v[68:71], v[40:43], a[72:79], v164
  s_nop 2
  v_smfmac_f32_16x16x64_bf16 v[72:75], v[4:7], a[80:87], v164
  s_nop 2
  v_smfmac_f32_16x16x64_bf16 v[72:75], v[8:11], a[88:95], v164
  v_add_f32 v68, v68, v70
  v_add_f32 v69, v69, v71
  v_smfmac_f32_16x16x64_bf16 v[72:75], v[12:15], a[96:103], v164
  v_cvt_pk_bf16_f32 v128, v68, v69
  ds_write2_b32 v156, v128, v128 offset0:0 offset1:4
  v_smfmac_f32_16x16x64_bf16 v[72:75], v[16:19], a[104:111], v164
  v_smfmac_f32_16x16x64_bf16 v[72:75], v[20:23], a[112:119], v164
  v_smfmac_f32_16x16x64_bf16 v[72:75], v[24:27], a[120:127], v164
  v_smfmac_f32_16x16x64_bf16 v[72:75], v[28:31], a[128:135], v164
  ds_read_b64_tr_b16 v[132:133], v153 offset:10240
  ds_read_b64_tr_b16 v[134:135], v153 offset:10752
  v_smfmac_f32_16x16x64_bf16 v[72:75], v[32:35], a[136:143], v164
  ds_read_b64_tr_b16 v[136:137], v153 offset:11264
  ds_read_b64_tr_b16 v[138:139], v153 offset:11776
  v_smfmac_f32_16x16x64_bf16 v[72:75], v[36:39], a[144:151], v164
  v_smfmac_f32_16x16x64_bf16 v[72:75], v[40:43], a[152:159], v164
  s_nop 7
  v_add_f32 v72, v72, v74
  v_add_f32 v73, v73, v75
  v_cvt_pk_bf16_f32 v129, v72, v73
  ds_write2_b32 v157, v129, v129 offset0:0 offset1:1
  s_nop 11
  ds_read_b64_tr_b16 v[60:61], v153 offset:12288
  ds_read_b64_tr_b16 v[62:63], v153 offset:12800
  ds_read_b64_tr_b16 v[64:65], v153 offset:13312
  ds_read_b64_tr_b16 v[66:67], v153 offset:13824
  s_waitcnt lgkmcnt(2)
  v_mfma_f32_16x16x32_bf16 v[80:83], v[60:63], v[132:135], 0
  s_waitcnt lgkmcnt(0)
  v_mfma_f32_16x16x32_bf16 v[80:83], v[64:67], v[136:139], v[80:83]
  s_nop 7
  v_cmp_u_f32 vcc, v80, v81
  v_cndmask_b32 v171, v80, v81, s[76:77]
  s_cbranch_vccnz sx_102_r
sx_1022:
  buffer_store_dword v171, v152, s[8:11], s49 offen
  s_sub_u32 s41, s39, 1
  s_and_b32 s41, s41, 3
  s_lshl_b32 s42, s41, 15
  s_add_u32 s42, s42, s48
  s_mul_i32 s41, s41, 81920
  s_add_u32 s41, s41, s45
  s_add_u32 s39, s39, 1
  v_mov_b32 v174, s39
  s_waitcnt vmcnt(0) lgkmcnt(0)
  s_barrier
  v_mov_b32 v16, -1
  v_mov_b32 v17, -1
  v_mov_b32 v18, -1
  v_mov_b32 v19, -1
  ds_write_b128 v152, v[16:19] offset:10240
  ds_write_b128 v152, v[16:19] offset:11264
  s_waitcnt vmcnt(0)
  buffer_store_dword v174, v163, s[8:11], 0 offen
  s_cmp_eq_u32 s39, 64
  s_cbranch_scc1 chain_end
  s_barrier
  buffer_store_dwordx4 v[84:87], v152, s[8:11], s42 offen offset:0
  buffer_store_dwordx4 v[84:87], v152, s[8:11], s42 offen offset:1024
  buffer_store_dwordx4 v[84:87], v152, s[8:11], s42 offen offset:2048
  buffer_store_dwordx4 v[84:87], v152, s[8:11], s42 offen offset:3072
  buffer_store_dwordx4 v[84:87], v160, s[8:11], s41 offen
  buffer_store_dword v84, v161, s[8:11], s41 offen offset:1024
  s_add_u32 s41, s39, 1
  s_and_b32 s41, s41, 3
  s_mul_i32 s41, s41, 163840
  s_add_u32 s41, s41, s64
  s_add_u32 s43, s41, s63
  buffer_store_dwordx4 v[84:87], v159, s[8:11], s41 offen sc1
  s_add_u32 s41, s41, 65536
  buffer_store_dwordx4 v[84:87], v159, s[8:11], s41 offen sc1
  s_add_u32 s41, s41, 65536
  buffer_store_dwordx4 v[84:87], v159, s[8:11], s43 offen sc1
  s_add_u32 s43, s39, 1
  s_and_b32 s41, s39, 3
  s_mul_i32 s46, s41, 81920
  s_add_u32 s46, s46, s45
  s_lshl_b32 s42, s41, 15
  s_add_u32 s43, s47, s42
  s_add_u32 s49, s43, s53
  s_add_u32 s50, s43, s54
  s_mul_i32 s43, s41, 227328
  s_add_u32 s55, s58, s43
  v_mov_b32 v68, 0
  v_mov_b32 v69, 0
  v_mov_b32 v70, 0
  v_mov_b32 v71, 0
  v_mov_b32 v72, 0
  v_mov_b32 v73, 0
  v_mov_b32 v74, 0
  v_mov_b32 v75, 0
  v_mov_b32 v76, 0
  v_mov_b32 v77, 0
  v_mov_b32 v78, 0
  v_mov_b32 v79, 0
  s_waitcnt vmcnt(0)
  s_sleep 8
  s_branch chain_loop_c1n
sx_102_r:
  s_mov_b64 exec, -1
  ds_read_b64_tr_b16 v[132:133], v153 offset:10240
  ds_read_b64_tr_b16 v[134:135], v153 offset:10752
  ds_read_b64_tr_b16 v[136:137], v153 offset:11264
  ds_read_b64_tr_b16 v[138:139], v153 offset:11776
  ds_read_b64_tr_b16 v[60:61], v153 offset:12288
  ds_read_b64_tr_b16 v[62:63], v153 offset:12800
  ds_read_b64_tr_b16 v[64:65], v153 offset:13312
  ds_read_b64_tr_b16 v[66:67], v153 offset:13824
  s_add_u32 s40, s40, 1
  s_cmp_gt_u32 s40, 65536
  s_cbranch_scc1 chain_abort
  s_waitcnt lgkmcnt(0)
  v_mfma_f32_16x16x32_bf16 v[80:83], v[60:63], v[132:135], 0
  v_mfma_f32_16x16x32_bf16 v[80:83], v[64:67], v[136:139], v[80:83]
  s_nop 7
  v_cmp_u_f32 vcc, v80, v81
  s_cbranch_vccnz sx_102_r
  s_branch sx_102
sx_102:
  v_cndmask_b32 v171, v80, v81, s[76:77]
  s_branch sx_1022
chain_pro_c2n:
  s_mov_b32 s40, 0
cpw_103:
  v_cmp_gt_u32 vcc, 1, v167
  s_nop 0
  s_and_b32 vcc_lo, vcc_lo, 0xfff000
  s_and_b32 vcc_hi, vcc_hi, 0x10000000
  s_cmp_eq_u64 vcc, 0
  s_cbranch_scc1 cpo_104
  s_sleep 1
  buffer_load_dword v167, v162, s[8:11], 0 offen sc1
  s_add_u32 s40, s40, 1
  s_cmp_gt_u32 s40, 65536
  s_cbranch_scc1 chain_abort
  s_waitcnt vmcnt(0)
  s_branch cpw_103
cpo_104:
  s_sub_u32 s41, s36, 10
  s_lshl_b32 s41, s41, 2
  s_add_u32 s41, s41, s17
  s_cmp_lt_u32 s41, 4
  s_cselect_b32 s63, 16, 0
  s_lshl_b32 s63, s63, 13
  s_lshl_b32 s64, s41, 13
  s_mul_i32 s42, s41, 1280
  v_add_u32 v160, s42, v152
  v_add_u32 v161, s42, v168
  s_lshl_b32 s48, s41, 12
  s_lshl_b32 s41, s16, 17
  s_add_u32 s48, s48, s41
  s_add_u32 s48, s48, 3407872
  s_lshl_b32 s41, s16, 8
  s_add_u32 s64, s64, s41
  s_add_u32 s64, s64, 16777216
  v_lshrrev_b32 v171, 4, v1
  v_lshlrev_b32 v171, 11, v171
  v_and_b32 v172, 15, v1
  v_lshl_add_u32 v159, v172, 4, v171
  v_mov_b32 v84, -1
  v_mov_b32 v85, -1
  v_mov_b32 v86, -1
  v_mov_b32 v87, -1
  buffer_load_dword v167, v162, s[8:11], 0 offen sc1
  s_and_b32 s41, s39, 3
  s_mul_i32 s46, s41, 81920
  s_add_u32 s46, s46, s45
  s_lshl_b32 s42, s41, 15
  s_add_u32 s43, s47, s42
  s_add_u32 s49, s43, s53
  s_add_u32 s50, s43, s54
  s_mul_i32 s43, s41, 227328
  s_add_u32 s55, s58, s43
  v_mov_b32 v68, 0
  v_mov_b32 v69, 0
  v_mov_b32 v70, 0
  v_mov_b32 v71, 0
  v_mov_b32 v72, 0
  v_mov_b32 v73, 0
  v_mov_b32 v74, 0
  v_mov_b32 v75, 0
  v_mov_b32 v76, 0
  v_mov_b32 v77, 0
  v_mov_b32 v78, 0
  v_mov_b32 v79, 0
  v_mov_b32 v16, -1
  v_mov_b32 v17, -1
  v_mov_b32 v18, -1
  v_mov_b32 v19, -1
  ds_write_b128 v152, v[16:19] offset:12288
  ds_write_b128 v152, v[16:19] offset:13312
chain_loop_c2n:
  s_mov_b32 s40, 0
  buffer_load_dwordx4 v[140:143], v154, s[8:11], s46 offen sc1
  buffer_load_dwordx4 v[144:147], v154, s[8:11], s46 offen offset:1024 sc1
  buffer_load_dword v148, v155, s[8:11], s46 offen sc1
  buffer_load_dword v149, v155, s[8:11], s46 offen offset:256 sc1
  s_nop 15
  s_nop 15
mq_105:
  buffer_load_dwordx4 v[108:111], v154, s[8:11], s46 offen sc1
  buffer_load_dwordx4 v[112:115], v154, s[8:11], s46 offen offset:1024 sc1
  buffer_load_dword v150, v155, s[8:11], s46 offen sc1
  buffer_load_dword v151, v155, s[8:11], s46 offen offset:256 sc1
  s_add_u32 s40, s40, 1
  s_cmp_gt_u32 s40, 65536
  s_cbranch_scc1 chain_abort
  s_waitcnt vmcnt(4)
  v_max3_u32 v171, v140, v144, v148
  v_max_u32 v171, v171, v149
  v_cmp_eq_u32 vcc, -1, v171
  ds_write_b128 v154, v[140:143]
  ds_write_b128 v154, v[144:147] offset:1024
  ds_write2st64_b32 v155, v148, v149 offset0:0 offset1:1
  s_cbranch_vccz mq_105_ok
  buffer_load_dwordx4 v[140:143], v154, s[8:11], s46 offen sc1
  buffer_load_dwordx4 v[144:147], v154, s[8:11], s46 offen offset:1024 sc1
  buffer_load_dword v148, v155, s[8:11], s46 offen sc1
  buffer_load_dword v149, v155, s[8:11], s46 offen offset:256 sc1
  s_waitcnt vmcnt(4)
  v_max3_u32 v171, v108, v112, v150
  v_max_u32 v171, v171, v151
  v_cmp_eq_u32 vcc, -1, v171
  ds_write_b128 v154, v[108:111]
  ds_write_b128 v154, v[112:115] offset:1024
  ds_write2st64_b32 v155, v150, v151 offset0:0 offset1:1
  s_cbranch_vccz mq_105_ok
  s_branch mq_105
mq_105_ok:
  s_waitcnt lgkmcnt(0)
  s_barrier
  ds_read_b128 v[4:7], v152 offset:0
  ds_read_b128 v[8:11], v152 offset:1024
  ds_read_b128 v[12:15], v152 offset:2048
  ds_read_b128 v[16:19], v152 offset:3072
  ds_read_b128 v[20:23], v152 offset:4096
  ds_read_b128 v[24:27], v152 offset:5120
  ds_read_b128 v[28:31], v152 offset:6144
  ds_read_b128 v[32:35], v152 offset:7168
  ds_read_b128 v[36:39], v152 offset:8192
  ds_read_b128 v[40:43], v152 offset:9216
  s_waitcnt lgkmcnt(9)
  v_smfmac_f32_16x16x64_bf16 v[76:79], v[4:7], a[160:167], v164
  s_waitcnt lgkmcnt(8)
  v_smfmac_f32_16x16x64_bf16 v[76:79], v[8:11], a[168:175], v164
  s_waitcnt lgkmcnt(7)
  v_smfmac_f32_16x16x64_bf16 v[76:79], v[12:15], a[176:183], v164
  s_waitcnt lgkmcnt(6)
  v_smfmac_f32_16x16x64_bf16 v[76:79], v[16:19], a[184:191], v164
  s_waitcnt lgkmcnt(5)
  v_smfmac_f32_16x16x64_bf16 v[76:79], v[20:23], a[192:199], v164
  s_waitcnt lgkmcnt(4)
  v_smfmac_f32_16x16x64_bf16 v[76:79], v[24:27], a[200:207], v164
  s_waitcnt lgkmcnt(3)
  v_smfmac_f32_16x16x64_bf16 v[76:79], v[28:31], a[208:215], v164
  s_waitcnt lgkmcnt(2)
  v_smfmac_f32_16x16x64_bf16 v[76:79], v[32:35], a[216:223], v164
  s_waitcnt lgkmcnt(1)
  v_smfmac_f32_16x16x64_bf16 v[76:79], v[36:39], a[224:231], v164
  s_waitcnt lgkmcnt(0)
  v_smfmac_f32_16x16x64_bf16 v[76:79], v[40:43], a[232:239], v164
  s_nop 2
  v_smfmac_f32_16x16x64_bf16 v[68:71], v[4:7], a[0:7], v164
  s_nop 2
  v_smfmac_f32_16x16x64_bf16 v[68:71], v[8:11], a[8:15], v164
  v_add_f32 v76, v76, v78
  v_add_f32 v77, v77, v79
  v_smfmac_f32_16x16x64_bf16 v[68:71], v[12:15], a[16:23], v164
  v_cvt_pk_bf16_f32 v171, v76, v77
  s_nop 0
  v_smfmac_f32_16x16x64_bf16 v[68:71], v[16:19], a[24:31], v164
  v_mov_b32_dpp v172, v171 row_ror:4 row_mask:0xf bank_mask:0xa
  s_nop 0
  v_smfmac_f32_16x16x64_bf16 v[68:71], v[20:23], a[32:39], v164
  v_mov_b32_dpp v172, v171 row_ror:12 row_mask:0xf bank_mask:0x5
  s_nop 0
  v_smfmac_f32_16x16x64_bf16 v[68:71], v[24:27], a[40:47], v164
  v_perm_b32 v171, v172, v171, v165
  buffer_store_dword v171, v158, s[8:11], s50 offen
  v_smfmac_f32_16x16x64_bf16 v[68:71], v[28:31], a[48:55], v164
  v_smfmac_f32_16x16x64_bf16 v[68:71], v[32:35], a[56:63], v164
  v_smfmac_f32_16x16x64_bf16 v[68:71], v[36:39], a[64:71], v164
  v_smfmac_f32_16x16x64_bf16 v[68:71], v[40:43], a[72:79], v164
  s_nop 2
  v_smfmac_f32_16x16x64_bf16 v[72:75], v[4:7], a[80:87], v164
  s_nop 2
  v_smfmac_f32_16x16x64_bf16 v[72:75], v[8:11], a[88:95], v164
  v_add_f32 v68, v68, v70
  v_add_f32 v69, v69, v71
  v_smfmac_f32_16x16x64_bf16 v[72:75], v[12:15], a[96:103], v164
  v_cvt_pk_bf16_f32 v128, v68, v69
  ds_write2_b32 v156, v128, v128 offset0:0 offset1:4
  v_smfmac_f32_16x16x64_bf16 v[72:75], v[16:19], a[104:111], v164
  v_smfmac_f32_16x16x64_bf16 v[72:75], v[20:23], a[112:119], v164
  v_smfmac_f32_16x16x64_bf16 v[72:75], v[24:27], a[120:127], v164
  v_smfmac_f32_16x16x64_bf16 v[72:75], v[28:31], a[128:135], v164
  v_smfmac_f32_16x16x64_bf16 v[72:75], v[32:35], a[136:143], v164
  v_smfmac_f32_16x16x64_bf16 v[72:75], v[36:39], a[144:151], v164
  v_smfmac_f32_16x16x64_bf16 v[72:75], v[40:43], a[152:159], v164
  s_nop 7
  v_add_f32 v72, v72, v74
  v_add_f32 v73, v73, v75
  v_cvt_pk_bf16_f32 v129, v72, v73
  ds_write2_b32 v157, v129, v129 offset0:0 offset1:1
  s_sub_u32 s41, s39, 1
  s_and_b32 s41, s41, 3
  s_lshl_b32 s42, s41, 15
  s_add_u32 s42, s42, s48
  s_mul_i32 s41, s41, 81920
  s_add_u32 s41, s41, s45
  s_add_u32 s39, s39, 1
  v_mov_b32 v174, s39
  s_waitcnt vmcnt(0) lgkmcnt(0)
  s_barrier
  ds_read_b64_tr_b16 v[60:61], v153 offset:12288
  ds_read_b64_tr_b16 v[62:63], v153 offset:12800
  ds_read_b64_tr_b16 v[64:65], v153 offset:13312
  ds_read_b64_tr_b16 v[66:67], v153 offset:13824
  v_mov_b32 v16, -1
  v_mov_b32 v17, -1
  v_mov_b32 v18, -1
  v_mov_b32 v19, -1
  ds_write_b128 v152, v[16:19] offset:12288
  ds_write_b128 v152, v[16:19] offset:13312
  s_waitcnt lgkmcnt(2)
  buffer_store_dwordx4 v[60:63], v166, s[8:11], s55 offen
  buffer_store_dwordx4 v[64:67], v166, s[8:11], s55 offen offset:512
  s_waitcnt vmcnt(0)
  buffer_store_dword v174, v163, s[8:11], 0 offen
  s_cmp_eq_u32 s39, 64
  s_cbranch_scc1 chain_end
  s_barrier
  buffer_store_dwordx4 v[84:87], v152, s[8:11], s42 offen offset:0
  buffer_store_dwordx4 v[84:87], v152, s[8:11], s42 offen offset:1024
  buffer_store_dwordx4 v[84:87], v152, s[8:11], s42 offen offset:2048
  buffer_store_dwordx4 v[84:87], v152, s[8:11], s42 offen offset:3072
  buffer_store_dwordx4 v[84:87], v160, s[8:11], s41 offen
  buffer_store_dword v84, v161, s[8:11], s41 offen offset:1024
  s_add_u32 s41, s39, 1
  s_and_b32 s41, s41, 3
  s_mul_i32 s41, s41, 163840
  s_add_u32 s41, s41, s64
  s_add_u32 s43, s41, s63
  buffer_store_dwordx4 v[84:87], v159, s[8:11], s41 offen sc1
  s_add_u32 s41, s41, 65536
  buffer_store_dwordx4 v[84:87], v159, s[8:11], s41 offen sc1
  s_add_u32 s41, s41, 65536
  buffer_store_dwordx4 v[84:87], v159, s[8:11], s43 offen sc1
  s_add_u32 s43, s39, 1
  s_and_b32 s41, s39, 3
  s_mul_i32 s46, s41, 81920
  s_add_u32 s46, s46, s45
  s_lshl_b32 s42, s41, 15
  s_add_u32 s43, s47, s42
  s_add_u32 s49, s43, s53
  s_add_u32 s50, s43, s54
  s_mul_i32 s43, s41, 227328
  s_add_u32 s55, s58, s43
  v_mov_b32 v68, 0
  v_mov_b32 v69, 0
  v_mov_b32 v70, 0
  v_mov_b32 v71, 0
  v_mov_b32 v72, 0
  v_mov_b32 v73, 0
  v_mov_b32 v74, 0
  v_mov_b32 v75, 0
  v_mov_b32 v76, 0
  v_mov_b32 v77, 0
  v_mov_b32 v78, 0
  v_mov_b32 v79, 0
  s_waitcnt vmcnt(0)
  s_sleep 8
  s_branch chain_loop_c2n
chain_end:
  s_endpgm
chain_abort:
  v_mov_b32 v171, 128
  v_mov_b32 v172, 1
  s_mov_b64 exec, 1
  buffer_atomic_add v172, v171, s[12:15], 0 offen
  s_endpgm
.section .rodata,"a"
.p2align 6
.amdhsa_kernel main_kernel
  .amdhsa_next_free_vgpr 512
  .amdhsa_next_free_sgpr 102
  .amdhsa_accum_offset 256
  .amdhsa_group_segment_fixed_size 0
  .amdhsa_kernarg_size 136
  .amdhsa_user_sgpr_count 2
  .amdhsa_user_sgpr_kernarg_segment_ptr 1
  .amdhsa_system_sgpr_workgroup_id_x 1
.end_amdhsa_kernel
```

```asm
; @launch kernel=main_kernel grid=(256,1,1) block=(256,1,1) lds=163840
.amdgcn_target "amdgcn-amd-amdhsa--gfx950"
.text
.globl main_kernel
.p2align 8
.type main_kernel,@function
main_kernel:
  s_load_dwordx2 s[8:9], s[0:1], 128
  s_mov_b32 s10, 268435456
  s_mov_b32 s11, 0x00020000
  s_load_dwordx2 s[12:13], s[0:1], 120
  s_mov_b32 s14, 256
  s_mov_b32 s15, 0x00020000
  s_load_dword s4, s[0:1], 0
  s_load_dword s5, s[0:1], 64
  s_getreg_b32 s16, hwreg(HW_REG_XCC_ID)
  s_and_b32 s16, s16, 7
  v_and_b32 v1, 63, v0
  v_lshrrev_b32 v2, 6, v0
  s_nop 0
  v_readfirstlane_b32 s17, v2
  v_mov_b32 v3, 1
  s_lshl_b32 s3, s16, 2
  v_mov_b32 v4, s3
  v_mov_b32 v5, 0
  s_waitcnt lgkmcnt(0)
  v_cmp_eq_u32 vcc, 0, v0
  s_nop 0
  s_and_b64 exec, exec, vcc
  s_cbranch_execz main_tk
  buffer_atomic_add v3, v4, s[12:15], 0 offen sc0
  s_waitcnt vmcnt(0)
  ds_write_b32 v5, v3
  s_waitcnt lgkmcnt(0)
main_tk:
  s_mov_b64 exec, -1
  s_barrier
  ds_read_b32 v3, v5
  s_waitcnt lgkmcnt(0)
  v_readfirstlane_b32 s18, v3
  s_barrier
  s_cmp_ge_u32 s18, 32
  s_cbranch_scc1 role_none
  s_sub_u32 s18, 31, s18
  s_cmp_lt_u32 s18, 18
  s_cbranch_scc1 role_b
  s_cmp_lt_u32 s18, 27
  s_cbranch_scc1 role_w
  s_cmp_gt_u32 s18, 28
  s_cbranch_scc1 role_r
  s_sub_u32 s20, 28, s18
  s_lshl_b32 s20, s20, 2
  s_add_u32 s20, s20, s17
  s_load_dwordx2 s[24:25], s[0:1], 8
  s_mov_b32 s26, 10240
  s_mov_b32 s27, 0x00020000
  v_lshlrev_b32 v2, 4, v1
  v_lshlrev_b32 v3, 7, v1
  v_mov_b32 v4, -1
  v_mov_b32 v5, -1
  v_mov_b32 v6, -1
  v_mov_b32 v7, -1
  v_mov_b32 v8, 0
  v_mov_b32 v9, 0
  v_mov_b32 v10, 0
  v_mov_b32 v11, 0
  v_lshrrev_b32 v12, 4, v1
  v_and_b32 v13, 15, v1
  v_lshlrev_b32 v13, 4, v13
  v_lshl_add_u32 v14, v12, 12, v13
  v_lshl_add_u32 v15, v12, 11, v13
  s_lshl_b32 s28, s16, 8
  s_cmp_lg_u32 s20, 4
  s_cbranch_scc1 boot_nf
  buffer_load_dwordx4 v[40:43], v14, s[8:11], s28 offen sc1
  s_waitcnt vmcnt(0)
  buffer_store_dwordx4 v[8:11], v14, s[8:11], s28 offen
  s_lshl_b32 s30, s16, 2
  s_add_u32 s30, s30, 32
  v_mov_b32 v16, s30
  v_mov_b32 v17, 1
  s_waitcnt vmcnt(0)
  s_mov_b64 exec, 1
  buffer_atomic_add v17, v16, s[12:15], 0 offen
  s_mov_b64 exec, -1
boot_nf:
  s_lshl_b32 s29, s16, 17
  s_lshl_b32 s30, s20, 14
  s_add_u32 s29, s29, s30
  s_add_u32 s29, s29, 3407872
  buffer_load_dword v44, v3, s[8:11], s29 offen sc1
  s_add_u32 s30, s29, 8192
  buffer_load_dword v45, v3, s[8:11], s30 offen sc1
  v_bfe_u32 v13, v1, 5, 1
  v_lshlrev_b32 v12, 6, v13
  v_bfe_u32 v13, v1, 4, 1
  v_lshl_add_u32 v12, v13, 4, v12
  v_bfe_u32 v13, v1, 1, 1
  v_lshl_add_u32 v12, v13, 2, v12
  v_bfe_u32 v13, v1, 2, 2
  v_lshlrev_b32 v13, 1, v13
  v_and_b32 v18, 1, v1
  v_add_u32 v13, v13, v18
  v_mul_u32_u24 v13, 1280, v13
  v_add_u32 v12, v12, v13
  s_waitcnt lgkmcnt(0)
  s_mov_b32 s31, s20
  s_lshl_b32 s30, s31, 7
  buffer_load_dword v20, v12, s[24:27], s30 offen
  buffer_load_dword v21, v12, s[24:27], s30 offen offset:32
  buffer_load_dword v22, v12, s[24:27], s30 offen offset:8
  buffer_load_dword v23, v12, s[24:27], s30 offen offset:40
  s_lshl_b32 s31, s31, 10
  s_mul_i32 s30, s16, 10240
  s_add_u32 s32, s31, s30
  s_add_u32 s32, s32, 131072
  s_add_u32 s33, s32, 81920
  buffer_load_dwordx4 v[46:49], v2, s[8:11], s32 offen sc1
  buffer_load_dwordx4 v[50:53], v2, s[8:11], s33 offen sc1
  s_add_u32 s36, s32, 163840
  s_add_u32 s37, s32, 245760
  buffer_load_dwordx4 v[46:49], v2, s[8:11], s36 offen sc1
  buffer_load_dwordx4 v[50:53], v2, s[8:11], s37 offen sc1
  s_add_u32 s31, s20, 8
  s_min_u32 s31, s31, 9
  s_lshl_b32 s30, s31, 7
  buffer_load_dword v24, v12, s[24:27], s30 offen
  buffer_load_dword v25, v12, s[24:27], s30 offen offset:32
  buffer_load_dword v26, v12, s[24:27], s30 offen offset:8
  buffer_load_dword v27, v12, s[24:27], s30 offen offset:40
  s_lshl_b32 s31, s31, 10
  s_mul_i32 s30, s16, 10240
  s_add_u32 s34, s31, s30
  s_add_u32 s34, s34, 131072
  s_add_u32 s35, s34, 81920
  buffer_load_dwordx4 v[46:49], v2, s[8:11], s34 offen sc1
  buffer_load_dwordx4 v[50:53], v2, s[8:11], s35 offen sc1
  s_add_u32 s38, s34, 163840
  s_add_u32 s39, s34, 245760
  buffer_load_dwordx4 v[46:49], v2, s[8:11], s38 offen sc1
  buffer_load_dwordx4 v[50:53], v2, s[8:11], s39 offen sc1
  s_waitcnt vmcnt(0)
  buffer_store_dwordx4 v[20:23], v2, s[8:11], s32 offen
  buffer_store_dwordx4 v[4:7], v2, s[8:11], s33 offen
  buffer_store_dwordx4 v[4:7], v2, s[8:11], s36 offen
  buffer_store_dwordx4 v[4:7], v2, s[8:11], s37 offen
  buffer_store_dwordx4 v[24:27], v2, s[8:11], s34 offen
  buffer_store_dwordx4 v[4:7], v2, s[8:11], s35 offen
  buffer_store_dwordx4 v[4:7], v2, s[8:11], s38 offen
  buffer_store_dwordx4 v[4:7], v2, s[8:11], s39 offen
  buffer_store_dwordx4 v[4:7], v2, s[8:11], s29 offen offset:0
  buffer_store_dwordx4 v[4:7], v2, s[8:11], s29 offen offset:1024
  buffer_store_dwordx4 v[4:7], v2, s[8:11], s29 offen offset:2048
  buffer_store_dwordx4 v[4:7], v2, s[8:11], s29 offen offset:3072
  s_add_u32 s29, s29, 4096
  buffer_store_dwordx4 v[4:7], v2, s[8:11], s29 offen offset:0
  buffer_store_dwordx4 v[4:7], v2, s[8:11], s29 offen offset:1024
  buffer_store_dwordx4 v[4:7], v2, s[8:11], s29 offen offset:2048
  buffer_store_dwordx4 v[4:7], v2, s[8:11], s29 offen offset:3072
  s_add_u32 s29, s29, 4096
  buffer_store_dwordx4 v[4:7], v2, s[8:11], s29 offen offset:0
  buffer_store_dwordx4 v[4:7], v2, s[8:11], s29 offen offset:1024
  buffer_store_dwordx4 v[4:7], v2, s[8:11], s29 offen offset:2048
  buffer_store_dwordx4 v[4:7], v2, s[8:11], s29 offen offset:3072
  s_add_u32 s29, s29, 4096
  buffer_store_dwordx4 v[4:7], v2, s[8:11], s29 offen offset:0
  buffer_store_dwordx4 v[4:7], v2, s[8:11], s29 offen offset:1024
  buffer_store_dwordx4 v[4:7], v2, s[8:11], s29 offen offset:2048
  buffer_store_dwordx4 v[4:7], v2, s[8:11], s29 offen offset:3072
  s_add_u32 s29, s29, 4096
  s_mul_i32 s30, s20, 81920
  s_add_u32 s30, s30, s28
  s_add_u32 s30, s30, 16777216
  buffer_store_dwordx4 v[4:7], v15, s[8:11], s30 offen sc1
  s_add_u32 s30, s30, 8192
  buffer_store_dwordx4 v[4:7], v15, s[8:11], s30 offen sc1
  s_add_u32 s30, s30, 8192
  buffer_store_dwordx4 v[4:7], v15, s[8:11], s30 offen sc1
  s_add_u32 s30, s30, 8192
  buffer_store_dwordx4 v[4:7], v15, s[8:11], s30 offen sc1
  s_add_u32 s30, s30, 8192
  buffer_store_dwordx4 v[4:7], v15, s[8:11], s30 offen sc1
  s_add_u32 s30, s30, 8192
  buffer_store_dwordx4 v[4:7], v15, s[8:11], s30 offen sc1
  s_add_u32 s30, s30, 8192
  buffer_store_dwordx4 v[4:7], v15, s[8:11], s30 offen sc1
  s_add_u32 s30, s30, 8192
  buffer_store_dwordx4 v[4:7], v15, s[8:11], s30 offen sc1
  s_add_u32 s30, s30, 8192
  buffer_store_dwordx4 v[4:7], v15, s[8:11], s30 offen sc1
  s_add_u32 s30, s30, 8192
  buffer_store_dwordx4 v[4:7], v15, s[8:11], s30 offen sc1
  s_add_u32 s30, s30, 8192
  v_lshrrev_b32 v12, 3, v1
  v_and_b32 v13, 7, v1
  v_lshlrev_b32 v13, 4, v13
  v_lshl_add_u32 v12, v12, 10, v13
  s_lshl_b32 s30, s20, 13
  s_lshl_b32 s31, s16, 7
  s_add_u32 s30, s30, s31
  s_add_u32 s30, s30, 2162688
  buffer_store_dwordx4 v[4:7], v12, s[8:11], s30 offen sc1
  s_waitcnt vmcnt(0)
  s_barrier
  s_cmp_lg_u32 s17, 0
  s_cbranch_scc1 boot_ng
  v_mov_b32 v16, 192
  v_mov_b32 v17, 1
  s_waitcnt vmcnt(0)
  s_mov_b64 exec, 1
  buffer_atomic_add v17, v16, s[12:15], 0 offen sc1
  s_mov_b64 exec, -1
boot_ng:
  s_lshl_b32 s28, s16, 22
  s_lshl_b32 s29, s20, 13
  s_add_u32 s28, s28, s29
  s_add_u32 s28, s28, 67108864
  s_add_u32 s29, s28, 622592
  buffer_load_dword v20, v3, s[8:11], s29 offen sc1
  s_add_u32 s29, s28, 557056
  buffer_load_dword v21, v3, s[8:11], s29 offen sc1
  s_waitcnt vmcnt(2)
  s_add_u32 s29, s28, 294912
  buffer_load_dword v22, v3, s[8:11], s29 offen sc1
  s_add_u32 s29, s28, 360448
  buffer_load_dword v23, v3, s[8:11], s29 offen sc1
  s_waitcnt vmcnt(2)
  s_add_u32 s29, s28, 425984
  buffer_load_dword v24, v3, s[8:11], s29 offen sc1
  s_add_u32 s29, s28, 491520
  buffer_load_dword v25, v3, s[8:11], s29 offen sc1
  s_waitcnt vmcnt(2)
  s_cmp_eq_u32 s18, 27
  s_cbranch_scc1 role_w
  s_branch role_sm
role_none:
  s_endpgm
role_abort:
  v_mov_b32 v2, 132
  v_mov_b32 v3, 1
  s_mov_b64 exec, 1
  buffer_atomic_add v3, v2, s[12:15], 0 offen
  s_endpgm
role_sm:
  v_lshlrev_b32 v166, 4, v1
  v_bfe_u32 v171, v1, 2, 2
  v_and_b32 v172, 1, v1
  v_lshl_add_u32 v171, v171, 1, v172
  v_lshrrev_b32 v172, 4, v1
  v_lshl_add_u32 v171, v172, 3, v171
  v_lshlrev_b32 v167, 4, v171
  v_and_b32 v171, 15, v1
  v_lshlrev_b32 v172, 2, v172
  v_sub_u32 v171, v171, v172
  v_mov_b32 v172, 0
  v_mov_b32 v170, 0xf149f2ca
  v_cmp_le_i32 vcc, 0, v171
  s_nop 1
  v_cndmask_b32 v148, v170, v172, vcc
  v_cmp_le_i32 vcc, 1, v171
  s_nop 1
  v_cndmask_b32 v149, v170, v172, vcc
  v_cmp_le_i32 vcc, 2, v171
  s_nop 1
  v_cndmask_b32 v150, v170, v172, vcc
  v_cmp_le_i32 vcc, 3, v171
  s_nop 1
  v_cndmask_b32 v151, v170, v172, vcc
  v_mov_b32 v160, 0x3d93cd3a
  v_mov_b32 v161, 0x3d93cd3a
  v_mov_b32 v154, 0
  v_mov_b32 v155, 0
  s_lshl_b32 s23, s16, 8
  s_lshl_b32 s24, s17, 6
  s_add_u32 s24, s24, s23
  v_and_b32 v171, 15, v1
  v_lshl_add_u32 v168, v171, 2, s24
  s_lshl_b32 s24, s17, 2
  s_add_u32 s23, s23, s24
  s_add_u32 s23, s23, 4192
  v_mov_b32 v169, s23
  s_lshl_b32 s25, s16, 22
  s_add_u32 s25, s25, 67108864
  s_mul_i32 s33, s17, 12288
  s_add_u32 s33, s33, s25
  s_mul_i32 s34, s17, 3072
  s_add_u32 s34, s34, s25
  s_add_u32 s34, s34, 589824
  s_lshl_b32 s35, s17, 11
  s_add_u32 s35, s35, s25
  s_add_u32 s35, s35, 602112
  s_add_u32 s36, s24, s25
  s_add_u32 s36, s36, 610304
  s_mov_b32 s32, 1
  v_lshlrev_b32 v179, 7, v1
  s_lshl_b32 s37, s16, 2
  s_add_u32 s37, s37, s17
  s_mul_i32 s37, s37, 10240
  s_add_u32 s37, s37, 226492416
  v_mov_b32 v170, 0
  s_waitcnt vmcnt(0)
  s_lshl_b32 s22, s16, 2
  s_add_u32 s22, s22, 32
  v_mov_b32 v171, s22
  s_mov_b32 s22, 0
  s_mov_b64 exec, 1
gw_1:
  buffer_load_dword v172, v171, s[12:15], 0 offen sc1
  s_add_u32 s22, s22, 1
  s_cmp_gt_u32 s22, 65536
  s_cbranch_scc1 role_abort
  s_waitcnt vmcnt(0)
  v_cmp_gt_u32 vcc, 2, v172
  s_cbranch_vccz gk_2
  s_sleep 8
  s_branch gw_1
gk_2:
  s_mov_b64 exec, -1
sm_loop:
  s_sub_u32 s21, s32, 1
  s_and_b32 s23, s21, 3
  s_mul_i32 s23, s23, 147456
  s_add_u32 s27, s33, s23
  s_add_u32 s28, s27, 49152
  s_and_b32 s23, s21, 3
  s_mul_i32 s23, s23, 24576
  s_add_u32 s29, s34, s23
  s_add_u32 s30, s35, s23
  s_add_u32 s31, s36, s23
  s_mov_b32 s22, 0
  s_branch pc_5
pw_3:
  buffer_load_dword v170, v168, s[8:11], 0 offen sc1
  s_add_u32 s22, s22, 1
  s_cmp_gt_u32 s22, 65536
  s_cbranch_scc1 role_abort
  s_waitcnt vmcnt(0)
pc_5:
  v_cmp_gt_u32 vcc, s32, v170
  s_nop 0
  s_and_b32 vcc_lo, vcc_lo, 0xfff
  s_and_b32 vcc_hi, vcc_hi, 0x0
  s_cmp_eq_u64 vcc, 0
  s_cbranch_scc1 po_4
  s_sleep 4
  s_branch pw_3
po_4:
  s_add_u32 s23, s28, 4096
  s_add_u32 s24, s28, 8192
  s_add_u32 s25, s27, 4096
  s_add_u32 s26, s27, 8192
  buffer_load_dwordx4 v[4:7], v166, s[8:11], s27 offen offset:0 sc1
  buffer_load_dwordx4 v[28:31], v166, s[8:11], s25 offen offset:2048 sc1
  buffer_load_dwordx4 v[52:55], v166, s[8:11], s28 offen offset:0 sc1
  buffer_load_dwordx4 v[76:79], v166, s[8:11], s23 offen offset:2048 sc1
  buffer_load_dwordx4 v[8:11], v166, s[8:11], s27 offen offset:1024 sc1
  buffer_load_dwordx4 v[32:35], v166, s[8:11], s25 offen offset:3072 sc1
  buffer_load_dwordx4 v[56:59], v166, s[8:11], s28 offen offset:1024 sc1
  buffer_load_dwordx4 v[80:83], v166, s[8:11], s23 offen offset:3072 sc1
  buffer_load_dwordx4 v[12:15], v166, s[8:11], s27 offen offset:2048 sc1
  buffer_load_dwordx4 v[36:39], v166, s[8:11], s26 offen offset:0 sc1
  buffer_load_dwordx4 v[60:63], v166, s[8:11], s28 offen offset:2048 sc1
  buffer_load_dwordx4 v[84:87], v166, s[8:11], s24 offen offset:0 sc1
  buffer_load_dwordx4 v[16:19], v166, s[8:11], s27 offen offset:3072 sc1
  buffer_load_dwordx4 v[40:43], v166, s[8:11], s26 offen offset:1024 sc1
  buffer_load_dwordx4 v[64:67], v166, s[8:11], s28 offen offset:3072 sc1
  buffer_load_dwordx4 v[88:91], v166, s[8:11], s24 offen offset:1024 sc1
  buffer_load_dwordx4 v[20:23], v166, s[8:11], s25 offen offset:0 sc1
  buffer_load_dwordx4 v[44:47], v166, s[8:11], s26 offen offset:2048 sc1
  buffer_load_dwordx4 v[68:71], v166, s[8:11], s23 offen offset:0 sc1
  buffer_load_dwordx4 v[92:95], v166, s[8:11], s24 offen offset:2048 sc1
  buffer_load_dwordx4 v[24:27], v166, s[8:11], s25 offen offset:1024 sc1
  buffer_load_dwordx4 v[48:51], v166, s[8:11], s26 offen offset:3072 sc1
  buffer_load_dwordx4 v[72:75], v166, s[8:11], s23 offen offset:1024 sc1
  buffer_load_dwordx4 v[96:99], v166, s[8:11], s24 offen offset:3072 sc1
  s_waitcnt vmcnt(20)
  v_mfma_f32_16x16x32_bf16 v[124:127], v[52:55], v[4:7], 0
  v_mfma_f32_16x16x32_bf16 v[132:135], v[52:55], v[28:31], 0
  v_mfma_f32_16x16x32_bf16 v[136:139], v[76:79], v[28:31], 0
  s_waitcnt vmcnt(16)
  v_mfma_f32_16x16x32_bf16 v[124:127], v[56:59], v[8:11], v[124:127]
  v_mfma_f32_16x16x32_bf16 v[132:135], v[56:59], v[32:35], v[132:135]
  v_mfma_f32_16x16x32_bf16 v[136:139], v[80:83], v[32:35], v[136:139]
  s_waitcnt vmcnt(12)
  v_mfma_f32_16x16x32_bf16 v[124:127], v[60:63], v[12:15], v[124:127]
  v_mfma_f32_16x16x32_bf16 v[132:135], v[60:63], v[36:39], v[132:135]
  v_mfma_f32_16x16x32_bf16 v[136:139], v[84:87], v[36:39], v[136:139]
  s_waitcnt vmcnt(8)
  v_mfma_f32_16x16x32_bf16 v[124:127], v[64:67], v[16:19], v[124:127]
  v_mfma_f32_16x16x32_bf16 v[132:135], v[64:67], v[40:43], v[132:135]
  v_mfma_f32_16x16x32_bf16 v[136:139], v[88:91], v[40:43], v[136:139]
  s_waitcnt vmcnt(4)
  v_mfma_f32_16x16x32_bf16 v[124:127], v[68:71], v[20:23], v[124:127]
  v_mfma_f32_16x16x32_bf16 v[132:135], v[68:71], v[44:47], v[132:135]
  v_mfma_f32_16x16x32_bf16 v[136:139], v[92:95], v[44:47], v[136:139]
  s_waitcnt vmcnt(0)
  v_mfma_f32_16x16x32_bf16 v[124:127], v[72:75], v[24:27], v[124:127]
  v_mfma_f32_16x16x32_bf16 v[132:135], v[72:75], v[48:51], v[132:135]
  v_mfma_f32_16x16x32_bf16 v[136:139], v[96:99], v[48:51], v[136:139]
  s_nop 5
  v_cvt_pk_bf16_f32 v173, v124, v125
  v_lshlrev_b32 v124, 16, v173
  v_and_b32 v125, 0xffff0000, v173
  v_cvt_pk_bf16_f32 v173, v126, v127
  v_lshlrev_b32 v126, 16, v173
  v_and_b32 v127, 0xffff0000, v173
  v_cvt_pk_bf16_f32 v174, v132, v133
  v_lshlrev_b32 v132, 16, v174
  v_and_b32 v133, 0xffff0000, v174
  v_cvt_pk_bf16_f32 v174, v134, v135
  v_lshlrev_b32 v134, 16, v174
  v_and_b32 v135, 0xffff0000, v174
  v_cvt_pk_bf16_f32 v174, v136, v137
  v_lshlrev_b32 v136, 16, v174
  v_and_b32 v137, 0xffff0000, v174
  v_cvt_pk_bf16_f32 v174, v138, v139
  v_lshlrev_b32 v138, 16, v174
  v_and_b32 v139, 0xffff0000, v174
  v_pk_fma_f32 v[124:125], v[124:125], v[160:161], v[148:149]
  v_cvt_pk_bf16_f32 v173, v124, v125
  v_lshlrev_b32 v124, 16, v173
  v_and_b32 v125, 0xffff0000, v173
  v_pk_fma_f32 v[126:127], v[126:127], v[160:161], v[150:151]
  v_cvt_pk_bf16_f32 v173, v126, v127
  v_lshlrev_b32 v126, 16, v173
  v_and_b32 v127, 0xffff0000, v173
  v_pk_mul_f32 v[132:133], v[132:133], v[160:161]
  v_cvt_pk_bf16_f32 v174, v132, v133
  v_lshlrev_b32 v132, 16, v174
  v_and_b32 v133, 0xffff0000, v174
  v_pk_mul_f32 v[134:135], v[134:135], v[160:161]
  v_cvt_pk_bf16_f32 v174, v134, v135
  v_lshlrev_b32 v134, 16, v174
  v_and_b32 v135, 0xffff0000, v174
  v_pk_fma_f32 v[136:137], v[136:137], v[160:161], v[148:149]
  v_cvt_pk_bf16_f32 v174, v136, v137
  v_lshlrev_b32 v136, 16, v174
  v_and_b32 v137, 0xffff0000, v174
  v_pk_fma_f32 v[138:139], v[138:139], v[160:161], v[150:151]
  v_cvt_pk_bf16_f32 v174, v138, v139
  v_lshlrev_b32 v138, 16, v174
  v_and_b32 v139, 0xffff0000, v174
  v_max3_f32 v175, v124, v125, v126
  v_max3_f32 v176, v132, v133, v134
  v_max_f32 v175, v175, v127
  v_max3_f32 v176, v176, v135, v136
  v_max3_f32 v176, v176, v137, v138
  v_max_f32 v176, v176, v139
  s_cmp_eq_u32 s32, 6
  s_cbranch_scc1 sm_boot2
sm_b2r:
  s_mov_b32 s22, 0
pw_6:
  buffer_load_dword v170, v168, s[8:11], 0 offen sc1
  s_add_u32 s22, s22, 1
  s_cmp_gt_u32 s22, 65536
  s_cbranch_scc1 role_abort
  s_waitcnt vmcnt(0)
pc_8:
  v_cmp_gt_u32 vcc, s32, v170
  s_nop 0
  s_and_b32 vcc_lo, vcc_lo, 0x7000
  s_and_b32 vcc_hi, vcc_hi, 0x0
  s_cmp_eq_u64 vcc, 0
  s_cbranch_scc1 po_7
  s_sleep 2
  s_branch pw_6
po_7:
  buffer_load_dwordx4 v[100:103], v167, s[8:11], s29 offen offset:0 sc1
  buffer_load_dwordx4 v[104:107], v167, s[8:11], s29 offen offset:512 sc1
  buffer_load_dwordx4 v[108:111], v167, s[8:11], s29 offen offset:1024 sc1
  buffer_load_dwordx4 v[112:115], v167, s[8:11], s29 offen offset:1536 sc1
  buffer_load_dwordx4 v[116:119], v167, s[8:11], s29 offen offset:2048 sc1
  buffer_load_dwordx4 v[120:123], v167, s[8:11], s29 offen offset:2560 sc1
  s_waitcnt vmcnt(5)
  v_mfma_f32_16x16x32_bf16 v[140:143], v[100:103], v[4:7], 0
  v_mfma_f32_16x16x32_bf16 v[144:147], v[100:103], v[28:31], 0
  s_waitcnt vmcnt(4)
  v_mfma_f32_16x16x32_bf16 v[140:143], v[104:107], v[8:11], v[140:143]
  v_mfma_f32_16x16x32_bf16 v[144:147], v[104:107], v[32:35], v[144:147]
  s_waitcnt vmcnt(3)
  v_mfma_f32_16x16x32_bf16 v[140:143], v[108:111], v[12:15], v[140:143]
  v_mfma_f32_16x16x32_bf16 v[144:147], v[108:111], v[36:39], v[144:147]
  s_waitcnt vmcnt(2)
  v_mfma_f32_16x16x32_bf16 v[140:143], v[112:115], v[16:19], v[140:143]
  v_mfma_f32_16x16x32_bf16 v[144:147], v[112:115], v[40:43], v[144:147]
  s_waitcnt vmcnt(1)
  v_mfma_f32_16x16x32_bf16 v[140:143], v[116:119], v[20:23], v[140:143]
  v_mfma_f32_16x16x32_bf16 v[144:147], v[116:119], v[44:47], v[144:147]
  s_waitcnt vmcnt(0)
  v_mfma_f32_16x16x32_bf16 v[140:143], v[120:123], v[24:27], v[140:143]
  v_mfma_f32_16x16x32_bf16 v[144:147], v[120:123], v[48:51], v[144:147]
  s_nop 6
  v_cvt_pk_bf16_f32 v173, v140, v141
  v_cvt_pk_bf16_f32 v174, v144, v145
  v_lshlrev_b32 v140, 16, v173
  v_lshlrev_b32 v144, 16, v174
  v_and_b32 v141, 0xffff0000, v173
  v_and_b32 v145, 0xffff0000, v174
  v_pk_mul_f32 v[140:141], v[140:141], v[160:161]
  v_pk_mul_f32 v[144:145], v[144:145], v[160:161]
  v_cvt_pk_bf16_f32 v173, v140, v141
  v_cvt_pk_bf16_f32 v174, v144, v145
  v_lshlrev_b32 v140, 16, v173
  v_lshlrev_b32 v144, 16, v174
  v_and_b32 v141, 0xffff0000, v173
  v_and_b32 v145, 0xffff0000, v174
  v_max3_f32 v175, v175, v140, v141
  v_max3_f32 v176, v176, v144, v145
  v_mov_b32 v173, v175
  v_mov_b32 v174, v176
  s_nop 0
  v_permlane16_swap_b32 v175, v173
  v_permlane16_swap_b32 v176, v174
  v_max_f32 v175, v175, v173
  v_max_f32 v176, v176, v174
  v_mov_b32 v173, v175
  v_mov_b32 v174, v176
  s_nop 0
  v_permlane32_swap_b32 v175, v173
  v_permlane32_swap_b32 v176, v174
  v_max_f32 v175, v175, v173
  v_max_f32 v176, v176, v174
  v_sub_f32 v124, v124, v175
  v_sub_f32 v125, v125, v175
  v_sub_f32 v126, v126, v175
  v_sub_f32 v127, v127, v175
  v_sub_f32 v132, v132, v176
  v_sub_f32 v133, v133, v176
  v_sub_f32 v134, v134, v176
  v_sub_f32 v135, v135, v176
  v_sub_f32 v136, v136, v176
  v_sub_f32 v137, v137, v176
  v_sub_f32 v138, v138, v176
  v_sub_f32 v139, v139, v176
  v_sub_f32 v140, v140, v175
  v_sub_f32 v141, v141, v175
  v_sub_f32 v144, v144, v176
  v_sub_f32 v145, v145, v176
  v_mul_f32 v124, 0x3fb8aa3b, v124
  v_mul_f32 v125, 0x3fb8aa3b, v125
  v_mul_f32 v126, 0x3fb8aa3b, v126
  v_mul_f32 v127, 0x3fb8aa3b, v127
  v_mul_f32 v132, 0x3fb8aa3b, v132
  v_mul_f32 v133, 0x3fb8aa3b, v133
  v_mul_f32 v134, 0x3fb8aa3b, v134
  v_mul_f32 v135, 0x3fb8aa3b, v135
  v_mul_f32 v136, 0x3fb8aa3b, v136
  v_mul_f32 v137, 0x3fb8aa3b, v137
  v_mul_f32 v138, 0x3fb8aa3b, v138
  v_mul_f32 v139, 0x3fb8aa3b, v139
  v_mul_f32 v140, 0x3fb8aa3b, v140
  v_mul_f32 v141, 0x3fb8aa3b, v141
  v_mul_f32 v144, 0x3fb8aa3b, v144
  v_mul_f32 v145, 0x3fb8aa3b, v145
  v_exp_f32 v124, v124
  v_exp_f32 v125, v125
  v_exp_f32 v126, v126
  v_exp_f32 v127, v127
  v_exp_f32 v132, v132
  v_exp_f32 v133, v133
  v_exp_f32 v134, v134
  v_exp_f32 v135, v135
  v_exp_f32 v136, v136
  v_exp_f32 v137, v137
  v_exp_f32 v138, v138
  v_exp_f32 v139, v139
  v_exp_f32 v140, v140
  v_exp_f32 v141, v141
  v_exp_f32 v144, v144
  v_exp_f32 v145, v145
  v_pk_add_f32 v[162:163], v[124:125], v[126:127]
  v_pk_add_f32 v[164:165], v[132:133], v[134:135]
  v_pk_add_f32 v[146:147], v[136:137], v[138:139]
  v_pk_add_f32 v[162:163], v[162:163], v[140:141]
  v_pk_add_f32 v[164:165], v[164:165], v[144:145]
  v_pk_add_f32 v[164:165], v[164:165], v[146:147]
  v_add_f32 v175, v162, v163
  v_add_f32 v176, v164, v165
  v_mov_b32 v173, v175
  v_mov_b32 v174, v176
  s_nop 0
  v_permlane16_swap_b32 v175, v173
  v_permlane16_swap_b32 v176, v174
  v_add_f32 v175, v175, v173
  v_add_f32 v176, v176, v174
  v_mov_b32 v173, v175
  v_mov_b32 v174, v176
  s_nop 0
  v_permlane32_swap_b32 v175, v173
  v_permlane32_swap_b32 v176, v174
  v_add_f32 v175, v175, v173
  v_add_f32 v176, v176, v174
  v_rcp_f32 v162, v175
  v_rcp_f32 v164, v176
  v_mov_b32 v163, v162
  v_mov_b32 v165, v164
  v_pk_mul_f32 v[124:125], v[124:125], v[162:163]
  v_cvt_pk_bf16_f32 v152, v124, v125
  v_pk_mul_f32 v[126:127], v[126:127], v[162:163]
  v_cvt_pk_bf16_f32 v153, v126, v127
  v_pk_mul_f32 v[140:141], v[140:141], v[162:163]
  buffer_store_dwordx4 v[152:155], v166, s[8:11], s30 offen offset:0
  v_cvt_pk_bf16_f32 v177, v140, v141
  buffer_store_dword v177, v166, s[8:11], s31 offen offset:0
  v_pk_mul_f32 v[132:133], v[132:133], v[164:165]
  v_cvt_pk_bf16_f32 v156, v132, v133
  v_pk_mul_f32 v[134:135], v[134:135], v[164:165]
  v_cvt_pk_bf16_f32 v157, v134, v135
  v_pk_mul_f32 v[136:137], v[136:137], v[164:165]
  v_cvt_pk_bf16_f32 v158, v136, v137
  v_pk_mul_f32 v[138:139], v[138:139], v[164:165]
  v_cvt_pk_bf16_f32 v159, v138, v139
  v_pk_mul_f32 v[144:145], v[144:145], v[164:165]
  buffer_store_dwordx4 v[156:159], v166, s[8:11], s30 offen offset:1024
  v_cvt_pk_bf16_f32 v178, v144, v145
  buffer_store_dword v178, v166, s[8:11], s31 offen offset:1024
  v_mov_b32 v171, s32
  s_add_u32 s32, s32, 1
  s_waitcnt vmcnt(0)
  buffer_store_dword v171, v169, s[8:11], 0 offen
  s_cmp_le_u32 s32, 64
  s_cbranch_scc1 sm_loop
  s_endpgm
sm_boot2:
  s_add_u32 s25, s17, 0
  v_mov_b32 v100, -1
  v_mov_b32 v101, -1
  v_mov_b32 v102, -1
  v_mov_b32 v103, -1
  s_lshl_b32 s24, s16, 3
  s_add_u32 s24, s24, s25
  s_lshl_b32 s23, s24, 10
  s_add_u32 s23, s23, 2097152
  buffer_store_dwordx4 v[100:103], v166, s[8:11], s23 offen sc1
  s_mul_i32 s23, s24, 15360
  s_add_u32 s23, s23, 2326528
  buffer_store_dwordx4 v[100:103], v166, s[8:11], s23 offen sc1
  s_add_u32 s23, s23, 1024
  buffer_store_dwordx4 v[100:103], v166, s[8:11], s23 offen sc1
  s_add_u32 s23, s23, 1024
  buffer_store_dwordx4 v[100:103], v166, s[8:11], s23 offen sc1
  s_add_u32 s23, s23, 1024
  buffer_store_dwordx4 v[100:103], v166, s[8:11], s23 offen sc1
  s_add_u32 s23, s23, 1024
  buffer_store_dwordx4 v[100:103], v166, s[8:11], s23 offen sc1
  s_add_u32 s23, s23, 1024
  buffer_store_dwordx4 v[100:103], v166, s[8:11], s23 offen sc1
  s_add_u32 s23, s23, 1024
  buffer_store_dwordx4 v[100:103], v166, s[8:11], s23 offen sc1
  s_add_u32 s23, s23, 1024
  buffer_store_dwordx4 v[100:103], v166, s[8:11], s23 offen sc1
  s_add_u32 s23, s23, 1024
  buffer_store_dwordx4 v[100:103], v166, s[8:11], s23 offen sc1
  s_add_u32 s23, s23, 1024
  buffer_store_dwordx4 v[100:103], v166, s[8:11], s23 offen sc1
  s_add_u32 s23, s23, 1024
  buffer_store_dwordx4 v[100:103], v166, s[8:11], s23 offen sc1
  s_add_u32 s23, s23, 1024
  buffer_store_dwordx4 v[100:103], v166, s[8:11], s23 offen sc1
  s_add_u32 s23, s23, 1024
  buffer_store_dwordx4 v[100:103], v166, s[8:11], s23 offen sc1
  s_add_u32 s23, s23, 1024
  buffer_store_dwordx4 v[100:103], v166, s[8:11], s23 offen sc1
  s_add_u32 s23, s23, 1024
  buffer_store_dwordx4 v[100:103], v166, s[8:11], s23 offen sc1
  s_add_u32 s23, s23, 1024
  v_mov_b32 v171, 196
  v_mov_b32 v172, 1
  s_waitcnt vmcnt(0)
  s_mov_b64 exec, 1
  buffer_atomic_add v172, v171, s[12:15], 0 offen sc1
  s_mov_b64 exec, -1
  s_add_u32 s25, s17, 4
  v_mov_b32 v100, -1
  v_mov_b32 v101, -1
  v_mov_b32 v102, -1
  v_mov_b32 v103, -1
  s_lshl_b32 s24, s16, 3
  s_add_u32 s24, s24, s25
  s_lshl_b32 s23, s24, 10
  s_add_u32 s23, s23, 2097152
  buffer_store_dwordx4 v[100:103], v166, s[8:11], s23 offen sc1
  s_mul_i32 s23, s24, 15360
  s_add_u32 s23, s23, 2326528
  buffer_store_dwordx4 v[100:103], v166, s[8:11], s23 offen sc1
  s_add_u32 s23, s23, 1024
  buffer_store_dwordx4 v[100:103], v166, s[8:11], s23 offen sc1
  s_add_u32 s23, s23, 1024
  buffer_store_dwordx4 v[100:103], v166, s[8:11], s23 offen sc1
  s_add_u32 s23, s23, 1024
  buffer_store_dwordx4 v[100:103], v166, s[8:11], s23 offen sc1
  s_add_u32 s23, s23, 1024
  buffer_store_dwordx4 v[100:103], v166, s[8:11], s23 offen sc1
  s_add_u32 s23, s23, 1024
  buffer_store_dwordx4 v[100:103], v166, s[8:11], s23 offen sc1
  s_add_u32 s23, s23, 1024
  buffer_store_dwordx4 v[100:103], v166, s[8:11], s23 offen sc1
  s_add_u32 s23, s23, 1024
  buffer_store_dwordx4 v[100:103], v166, s[8:11], s23 offen sc1
  s_add_u32 s23, s23, 1024
  buffer_store_dwordx4 v[100:103], v166, s[8:11], s23 offen sc1
  s_add_u32 s23, s23, 1024
  buffer_store_dwordx4 v[100:103], v166, s[8:11], s23 offen sc1
  s_add_u32 s23, s23, 1024
  buffer_store_dwordx4 v[100:103], v166, s[8:11], s23 offen sc1
  s_add_u32 s23, s23, 1024
  buffer_store_dwordx4 v[100:103], v166, s[8:11], s23 offen sc1
  s_add_u32 s23, s23, 1024
  buffer_store_dwordx4 v[100:103], v166, s[8:11], s23 offen sc1
  s_add_u32 s23, s23, 1024
  buffer_store_dwordx4 v[100:103], v166, s[8:11], s23 offen sc1
  s_add_u32 s23, s23, 1024
  buffer_store_dwordx4 v[100:103], v166, s[8:11], s23 offen sc1
  s_add_u32 s23, s23, 1024
  v_mov_b32 v171, 196
  v_mov_b32 v172, 1
  s_waitcnt vmcnt(0)
  s_mov_b64 exec, 1
  buffer_atomic_add v172, v171, s[12:15], 0 offen sc1
  s_mov_b64 exec, -1
  s_branch sm_b2r
role_r:
  s_load_dwordx2 s[20:21], s[0:1], 0
  s_mov_b32 s22, 2621440
  s_mov_b32 s23, 0x00020000
  s_load_dwordx2 s[24:25], s[0:1], 112
  s_mov_b32 s26, 2621440
  s_mov_b32 s27, 0x00020000
  s_load_dwordx2 s[28:29], s[0:1], 64
  s_mov_b32 s30, 1280
  s_mov_b32 s31, 0x00020000
  s_load_dwordx2 s[44:45], s[0:1], 96
  s_mov_b32 s46, 1280
  s_mov_b32 s47, 0x00020000
  s_load_dwordx2 s[48:49], s[0:1], 104
  s_mov_b32 s50, 4915200
  s_mov_b32 s51, 0x00020000
  s_sub_u32 s54, s18, 29
  s_sub_u32 s52, 2, s54
  s_lshl_b32 s52, s52, 3
  s_add_u32 s52, s52, s16
  s_lshl_b32 s32, s54, 2
  s_add_u32 s32, s32, s17
  s_mul_i32 s38, s16, 2621440
  s_lshl_b32 s35, s32, 13
  s_add_u32 s35, s35, s38
  s_add_u32 s35, s35, 247463936
  v_lshlrev_b32 v2, 7, v1
  buffer_load_dword v3, v2, s[8:11], s35 offen sc1
  s_waitcnt lgkmcnt(0)
  s_mov_b32 s40, s54
  s_mov_b32 s41, s54
  s_mul_i32 s39, s16, 3
  s_add_u32 s39, s39, s54
  s_add_u32 s39, s39, 24
  v_lshlrev_b32 v226, 2, v1
  s_mul_i32 s37, s32, 5120
  v_and_b32 v90, 3, v1
  v_lshrrev_b32 v91, 2, v1
  v_mul_u32_u24 v160, 1280, v90
  v_lshrrev_b32 v92, 4, v1
  v_bfe_u32 v93, v1, 2, 2
  v_lshl_add_u32 v93, v92, 3, v93
  v_lshl_add_u32 v160, v93, 3, v160
  buffer_load_dwordx2 v[100:101], v160, s[20:23], s37 offen offset:0
  buffer_load_dwordx2 v[102:103], v160, s[20:23], s37 offen offset:32
  buffer_load_dwordx2 v[104:105], v160, s[20:23], s37 offen offset:256
  buffer_load_dwordx2 v[106:107], v160, s[20:23], s37 offen offset:288
  buffer_load_dwordx2 v[108:109], v160, s[20:23], s37 offen offset:512
  buffer_load_dwordx2 v[110:111], v160, s[20:23], s37 offen offset:544
  buffer_load_dwordx2 v[112:113], v160, s[20:23], s37 offen offset:768
  buffer_load_dwordx2 v[114:115], v160, s[20:23], s37 offen offset:800
  buffer_load_dwordx2 v[116:117], v160, s[20:23], s37 offen offset:1024
  buffer_load_dwordx2 v[118:119], v160, s[20:23], s37 offen offset:1056
  s_add_u32 s36, s40, 24
  s_cmp_lt_u32 s40, 24
  s_cselect_b32 s36, s39, s36
  s_add_u32 s40, s40, 3
  s_cmp_lt_u32 s40, 24
  s_cselect_b32 s40, s40, s36
  s_min_u32 s40, s40, 127
  s_mul_i32 s37, s40, 20480
  s_mul_i32 s36, s17, 5120
  s_add_u32 s37, s37, s36
  buffer_load_dwordx2 v[120:121], v160, s[20:23], s37 offen offset:0
  buffer_load_dwordx2 v[122:123], v160, s[20:23], s37 offen offset:32
  buffer_load_dwordx2 v[124:125], v160, s[20:23], s37 offen offset:256
  buffer_load_dwordx2 v[126:127], v160, s[20:23], s37 offen offset:288
  buffer_load_dwordx2 v[128:129], v160, s[20:23], s37 offen offset:512
  buffer_load_dwordx2 v[130:131], v160, s[20:23], s37 offen offset:544
  buffer_load_dwordx2 v[132:133], v160, s[20:23], s37 offen offset:768
  buffer_load_dwordx2 v[134:135], v160, s[20:23], s37 offen offset:800
  buffer_load_dwordx2 v[136:137], v160, s[20:23], s37 offen offset:1024
  buffer_load_dwordx2 v[138:139], v160, s[20:23], s37 offen offset:1056
  s_add_u32 s36, s40, 24
  s_cmp_lt_u32 s40, 24
  s_cselect_b32 s36, s39, s36
  s_add_u32 s40, s40, 3
  s_cmp_lt_u32 s40, 24
  s_cselect_b32 s40, s40, s36
  s_min_u32 s40, s40, 127
  s_mul_i32 s37, s40, 20480
  s_mul_i32 s36, s17, 5120
  s_add_u32 s37, s37, s36
  s_add_u32 s35, s35, 98304
  buffer_load_dword a101, v2, s[8:11], s35 offen sc1
  v_lshlrev_b32 v161, 4, v90
  v_lshl_add_u32 v161, v91, 8, v161
  v_lshrrev_b32 v92, 1, v90
  v_mul_u32_u24 v162, 2432, v92
  v_lshl_add_u32 v162, v90, 6, v162
  v_lshl_add_u32 v162, v93, 4, v162
  v_cvt_f32_u32 v163, v92
  s_lshl_b32 s35, s16, 22
  s_lshl_b32 s36, s32, 13
  s_add_u32 s35, s35, s36
  s_add_u32 s35, s35, 67108864
  buffer_load_dword a100, v2, s[8:11], s35 offen sc1
  s_add_u32 s35, s35, 98304
  buffer_load_dword a100, v2, s[8:11], s35 offen sc1
  s_add_u32 s35, s35, 98304
  buffer_load_dword a100, v2, s[8:11], s35 offen sc1
  s_add_u32 s35, s35, 98304
  v_lshlrev_b32 v227, 3, v1
  s_lshl_b32 s35, s16, 8
  s_lshl_b32 s36, s32, 2
  s_add_u32 s35, s35, s36
  s_add_u32 s35, s35, 8192
  v_mov_b32 v228, s35
  v_mov_b32 v230, 0x00003f80
  v_mov_b32 v231, 0x3f800000
  s_mul_i32 s38, s16, 2621440
  s_add_u32 s38, s38, 247463936
  s_mul_i32 s35, s54, 20480
  s_add_u32 s38, s38, s35
  s_lshl_b32 s35, s17, 6
  s_add_u32 s38, s38, s35
  s_waitcnt lgkmcnt(0)
  s_waitcnt vmcnt(14)
  v_lshlrev_b32 v2, 16, v100
  v_and_b32 v3, 0xffff0000, v100
  v_lshlrev_b32 v4, 16, v101
  v_and_b32 v5, 0xffff0000, v101
  v_lshlrev_b32 v6, 16, v102
  v_and_b32 v7, 0xffff0000, v102
  v_lshlrev_b32 v8, 16, v103
  v_and_b32 v9, 0xffff0000, v103
  v_lshlrev_b32 v10, 16, v104
  v_and_b32 v11, 0xffff0000, v104
  v_lshlrev_b32 v12, 16, v105
  v_and_b32 v13, 0xffff0000, v105
  v_lshlrev_b32 v14, 16, v106
  v_and_b32 v15, 0xffff0000, v106
  v_lshlrev_b32 v16, 16, v107
  v_and_b32 v17, 0xffff0000, v107
  v_lshlrev_b32 v18, 16, v108
  v_and_b32 v19, 0xffff0000, v108
  v_lshlrev_b32 v20, 16, v109
  v_and_b32 v21, 0xffff0000, v109
  v_lshlrev_b32 v22, 16, v110
  v_and_b32 v23, 0xffff0000, v110
  v_lshlrev_b32 v24, 16, v111
  v_and_b32 v25, 0xffff0000, v111
  v_lshlrev_b32 v26, 16, v112
  v_and_b32 v27, 0xffff0000, v112
  v_lshlrev_b32 v28, 16, v113
  v_and_b32 v29, 0xffff0000, v113
  v_lshlrev_b32 v30, 16, v114
  v_and_b32 v31, 0xffff0000, v114
  v_lshlrev_b32 v32, 16, v115
  v_and_b32 v33, 0xffff0000, v115
  v_lshlrev_b32 v34, 16, v116
  v_and_b32 v35, 0xffff0000, v116
  v_lshlrev_b32 v36, 16, v117
  v_and_b32 v37, 0xffff0000, v117
  v_lshlrev_b32 v38, 16, v118
  v_and_b32 v39, 0xffff0000, v118
  v_lshlrev_b32 v40, 16, v119
  v_and_b32 v41, 0xffff0000, v119
  v_pk_add_f32 v[86:87], v[2:3], v[4:5]
  v_pk_add_f32 v[88:89], v[6:7], v[8:9]
  v_pk_add_f32 v[86:87], v[86:87], v[10:11]
  v_pk_add_f32 v[88:89], v[88:89], v[12:13]
  v_pk_add_f32 v[86:87], v[86:87], v[14:15]
  v_pk_add_f32 v[88:89], v[88:89], v[16:17]
  v_pk_add_f32 v[86:87], v[86:87], v[18:19]
  v_pk_add_f32 v[88:89], v[88:89], v[20:21]
  v_pk_add_f32 v[86:87], v[86:87], v[22:23]
  v_pk_add_f32 v[88:89], v[88:89], v[24:25]
  v_pk_add_f32 v[86:87], v[86:87], v[26:27]
  v_pk_add_f32 v[88:89], v[88:89], v[28:29]
  v_pk_add_f32 v[86:87], v[86:87], v[30:31]
  v_pk_add_f32 v[88:89], v[88:89], v[32:33]
  v_pk_add_f32 v[86:87], v[86:87], v[34:35]
  v_pk_add_f32 v[88:89], v[88:89], v[36:37]
  v_pk_add_f32 v[86:87], v[86:87], v[38:39]
  v_pk_add_f32 v[88:89], v[88:89], v[40:41]
  v_pk_add_f32 v[86:87], v[86:87], v[88:89]
  v_add_f32 v86, v86, v87
  s_nop 1
  v_add_f32_dpp v86, v86, v86 row_ror:8 row_mask:0xf bank_mask:0xf
  s_nop 1
  v_add_f32_dpp v86, v86, v86 row_ror:4 row_mask:0xf bank_mask:0xf
  v_mov_b32 v90, v86
  s_nop 1
  v_permlane16_swap_b32 v86, v90
  v_add_f32 v86, v86, v90
  v_mov_b32 v90, v86
  s_nop 1
  v_permlane32_swap_b32 v86, v90
  v_add_f32 v86, v86, v90
  v_mul_f32 v88, 0xbacccccd, v86
  v_mul_f32 v89, 0xbacccccd, v86
  v_pk_add_f32 v[164:165], v[2:3], v[88:89]
  v_pk_add_f32 v[166:167], v[4:5], v[88:89]
  v_pk_mul_f32 v[170:171], v[164:165], v[164:165]
  v_pk_add_f32 v[168:169], v[6:7], v[88:89]
  v_pk_mul_f32 v[86:87], v[166:167], v[166:167]
  v_pk_add_f32 v[164:165], v[8:9], v[88:89]
  v_pk_fma_f32 v[170:171], v[168:169], v[168:169], v[170:171]
  v_pk_add_f32 v[166:167], v[10:11], v[88:89]
  v_pk_fma_f32 v[86:87], v[164:165], v[164:165], v[86:87]
  v_pk_add_f32 v[168:169], v[12:13], v[88:89]
  v_pk_fma_f32 v[170:171], v[166:167], v[166:167], v[170:171]
  v_pk_add_f32 v[164:165], v[14:15], v[88:89]
  v_pk_fma_f32 v[86:87], v[168:169], v[168:169], v[86:87]
  v_pk_add_f32 v[166:167], v[16:17], v[88:89]
  v_pk_fma_f32 v[170:171], v[164:165], v[164:165], v[170:171]
  v_pk_add_f32 v[168:169], v[18:19], v[88:89]
  v_pk_fma_f32 v[86:87], v[166:167], v[166:167], v[86:87]
  v_pk_add_f32 v[164:165], v[20:21], v[88:89]
  v_pk_fma_f32 v[170:171], v[168:169], v[168:169], v[170:171]
  v_pk_add_f32 v[166:167], v[22:23], v[88:89]
  v_pk_fma_f32 v[86:87], v[164:165], v[164:165], v[86:87]
  v_pk_add_f32 v[168:169], v[24:25], v[88:89]
  v_pk_fma_f32 v[170:171], v[166:167], v[166:167], v[170:171]
  v_pk_add_f32 v[164:165], v[26:27], v[88:89]
  v_pk_fma_f32 v[86:87], v[168:169], v[168:169], v[86:87]
  v_pk_add_f32 v[166:167], v[28:29], v[88:89]
  v_pk_fma_f32 v[170:171], v[164:165], v[164:165], v[170:171]
  v_pk_add_f32 v[168:169], v[30:31], v[88:89]
  v_pk_fma_f32 v[86:87], v[166:167], v[166:167], v[86:87]
  v_pk_add_f32 v[164:165], v[32:33], v[88:89]
  v_pk_fma_f32 v[170:171], v[168:169], v[168:169], v[170:171]
  v_pk_add_f32 v[166:167], v[34:35], v[88:89]
  v_pk_fma_f32 v[86:87], v[164:165], v[164:165], v[86:87]
  v_pk_add_f32 v[168:169], v[36:37], v[88:89]
  v_pk_fma_f32 v[170:171], v[166:167], v[166:167], v[170:171]
  v_pk_add_f32 v[164:165], v[38:39], v[88:89]
  v_pk_fma_f32 v[86:87], v[168:169], v[168:169], v[86:87]
  v_pk_add_f32 v[166:167], v[40:41], v[88:89]
  v_pk_fma_f32 v[170:171], v[164:165], v[164:165], v[170:171]
  v_pk_fma_f32 v[86:87], v[166:167], v[166:167], v[86:87]
  v_cvt_pk_bf16_f32 v91, v88, v89
  v_lshlrev_b32 v88, 16, v91
  v_and_b32 v89, 0xffff0000, v91
  v_pk_add_f32 v[86:87], v[86:87], v[170:171]
  v_add_f32 v86, v86, v87
  s_nop 1
  v_add_f32_dpp v86, v86, v86 row_ror:8 row_mask:0xf bank_mask:0xf
  s_nop 1
  v_add_f32_dpp v86, v86, v86 row_ror:4 row_mask:0xf bank_mask:0xf
  v_mov_b32 v90, v86
  s_nop 1
  v_permlane16_swap_b32 v86, v90
  v_add_f32 v86, v86, v90
  v_mov_b32 v90, v86
  s_nop 1
  v_permlane32_swap_b32 v86, v90
  v_add_f32 v86, v86, v90
  v_pk_add_f32 v[2:3], v[2:3], v[88:89]
  v_mul_f32 v86, 0x3acccccd, v86
  v_pk_add_f32 v[4:5], v[4:5], v[88:89]
  v_cvt_pk_bf16_f32 v86, v86, v86
  v_pk_add_f32 v[6:7], v[6:7], v[88:89]
  v_lshlrev_b32 v86, 16, v86
  v_pk_add_f32 v[8:9], v[8:9], v[88:89]
  v_add_f32 v86, 0x3727c5ac, v86
  v_pk_add_f32 v[10:11], v[10:11], v[88:89]
  v_cvt_pk_bf16_f32 v86, v86, v86
  v_pk_add_f32 v[12:13], v[12:13], v[88:89]
  v_lshlrev_b32 v86, 16, v86
  v_pk_add_f32 v[14:15], v[14:15], v[88:89]
  v_sqrt_f32 v86, v86
  v_pk_add_f32 v[16:17], v[16:17], v[88:89]
  v_cvt_pk_bf16_f32 v86, v86, v86
  v_pk_add_f32 v[18:19], v[18:19], v[88:89]
  v_lshlrev_b32 v86, 16, v86
  v_pk_add_f32 v[20:21], v[20:21], v[88:89]
  v_rcp_f32 v86, v86
  v_pk_add_f32 v[22:23], v[22:23], v[88:89]
  v_mov_b32 v87, v86
  v_pk_add_f32 v[24:25], v[24:25], v[88:89]
  v_pk_add_f32 v[26:27], v[26:27], v[88:89]
  v_pk_add_f32 v[28:29], v[28:29], v[88:89]
  v_pk_add_f32 v[30:31], v[30:31], v[88:89]
  v_pk_add_f32 v[32:33], v[32:33], v[88:89]
  v_pk_add_f32 v[34:35], v[34:35], v[88:89]
  v_pk_add_f32 v[36:37], v[36:37], v[88:89]
  v_pk_add_f32 v[38:39], v[38:39], v[88:89]
  v_pk_add_f32 v[40:41], v[40:41], v[88:89]
  v_cvt_pk_bf16_f32 v164, v2, v3
  v_lshlrev_b32 v2, 16, v164
  v_and_b32 v3, 0xffff0000, v164
  v_cvt_pk_bf16_f32 v165, v4, v5
  v_lshlrev_b32 v4, 16, v165
  v_and_b32 v5, 0xffff0000, v165
  v_cvt_pk_bf16_f32 v166, v6, v7
  v_lshlrev_b32 v6, 16, v166
  v_and_b32 v7, 0xffff0000, v166
  v_cvt_pk_bf16_f32 v167, v8, v9
  v_lshlrev_b32 v8, 16, v167
  v_and_b32 v9, 0xffff0000, v167
  v_cvt_pk_bf16_f32 v164, v10, v11
  v_lshlrev_b32 v10, 16, v164
  v_and_b32 v11, 0xffff0000, v164
  v_cvt_pk_bf16_f32 v165, v12, v13
  v_lshlrev_b32 v12, 16, v165
  v_and_b32 v13, 0xffff0000, v165
  v_cvt_pk_bf16_f32 v166, v14, v15
  v_lshlrev_b32 v14, 16, v166
  v_and_b32 v15, 0xffff0000, v166
  v_cvt_pk_bf16_f32 v167, v16, v17
  v_lshlrev_b32 v16, 16, v167
  v_and_b32 v17, 0xffff0000, v167
  v_cvt_pk_bf16_f32 v164, v18, v19
  v_lshlrev_b32 v18, 16, v164
  v_and_b32 v19, 0xffff0000, v164
  v_cvt_pk_bf16_f32 v165, v20, v21
  v_lshlrev_b32 v20, 16, v165
  v_and_b32 v21, 0xffff0000, v165
  v_cvt_pk_bf16_f32 v166, v22, v23
  v_lshlrev_b32 v22, 16, v166
  v_and_b32 v23, 0xffff0000, v166
  v_cvt_pk_bf16_f32 v167, v24, v25
  v_lshlrev_b32 v24, 16, v167
  v_and_b32 v25, 0xffff0000, v167
  v_cvt_pk_bf16_f32 v164, v26, v27
  v_lshlrev_b32 v26, 16, v164
  v_and_b32 v27, 0xffff0000, v164
  v_cvt_pk_bf16_f32 v165, v28, v29
  v_lshlrev_b32 v28, 16, v165
  v_and_b32 v29, 0xffff0000, v165
  v_cvt_pk_bf16_f32 v166, v30, v31
  v_lshlrev_b32 v30, 16, v166
  v_and_b32 v31, 0xffff0000, v166
  v_cvt_pk_bf16_f32 v167, v32, v33
  v_lshlrev_b32 v32, 16, v167
  v_and_b32 v33, 0xffff0000, v167
  v_cvt_pk_bf16_f32 v164, v34, v35
  v_lshlrev_b32 v34, 16, v164
  v_and_b32 v35, 0xffff0000, v164
  v_cvt_pk_bf16_f32 v165, v36, v37
  v_lshlrev_b32 v36, 16, v165
  v_and_b32 v37, 0xffff0000, v165
  v_cvt_pk_bf16_f32 v166, v38, v39
  v_lshlrev_b32 v38, 16, v166
  v_and_b32 v39, 0xffff0000, v166
  v_cvt_pk_bf16_f32 v167, v40, v41
  v_lshlrev_b32 v40, 16, v167
  v_and_b32 v41, 0xffff0000, v167
  v_pk_mul_f32 v[2:3], v[2:3], v[86:87]
  v_pk_mul_f32 v[4:5], v[4:5], v[86:87]
  v_pk_mul_f32 v[6:7], v[6:7], v[86:87]
  v_pk_mul_f32 v[8:9], v[8:9], v[86:87]
  v_pk_mul_f32 v[10:11], v[10:11], v[86:87]
  v_pk_mul_f32 v[12:13], v[12:13], v[86:87]
  v_pk_mul_f32 v[14:15], v[14:15], v[86:87]
  v_pk_mul_f32 v[16:17], v[16:17], v[86:87]
  v_pk_mul_f32 v[18:19], v[18:19], v[86:87]
  v_pk_mul_f32 v[20:21], v[20:21], v[86:87]
  v_pk_mul_f32 v[22:23], v[22:23], v[86:87]
  v_pk_mul_f32 v[24:25], v[24:25], v[86:87]
  v_pk_mul_f32 v[26:27], v[26:27], v[86:87]
  v_pk_mul_f32 v[28:29], v[28:29], v[86:87]
  v_pk_mul_f32 v[30:31], v[30:31], v[86:87]
  v_pk_mul_f32 v[32:33], v[32:33], v[86:87]
  v_pk_mul_f32 v[34:35], v[34:35], v[86:87]
  v_pk_mul_f32 v[36:37], v[36:37], v[86:87]
  v_pk_mul_f32 v[38:39], v[38:39], v[86:87]
  v_pk_mul_f32 v[40:41], v[40:41], v[86:87]
  v_cvt_pk_bf16_f32 v100, v2, v3
  v_cvt_pk_bf16_f32 v101, v4, v5
  v_cvt_pk_bf16_f32 v102, v6, v7
  v_cvt_pk_bf16_f32 v103, v8, v9
  v_cvt_pk_bf16_f32 v104, v10, v11
  v_cvt_pk_bf16_f32 v105, v12, v13
  v_cvt_pk_bf16_f32 v106, v14, v15
  v_cvt_pk_bf16_f32 v107, v16, v17
  v_cvt_pk_bf16_f32 v108, v18, v19
  v_cvt_pk_bf16_f32 v109, v20, v21
  v_cvt_pk_bf16_f32 v110, v22, v23
  v_cvt_pk_bf16_f32 v111, v24, v25
  v_cvt_pk_bf16_f32 v112, v26, v27
  v_cvt_pk_bf16_f32 v113, v28, v29
  v_cvt_pk_bf16_f32 v114, v30, v31
  v_cvt_pk_bf16_f32 v115, v32, v33
  v_cvt_pk_bf16_f32 v116, v34, v35
  v_cvt_pk_bf16_f32 v117, v36, v37
  v_cvt_pk_bf16_f32 v118, v38, v39
  v_cvt_pk_bf16_f32 v119, v40, v41
  s_waitcnt vmcnt(4)
  v_lshlrev_b32 v2, 16, v120
  v_and_b32 v3, 0xffff0000, v120
  v_lshlrev_b32 v4, 16, v121
  v_and_b32 v5, 0xffff0000, v121
  v_lshlrev_b32 v6, 16, v122
  v_and_b32 v7, 0xffff0000, v122
  v_lshlrev_b32 v8, 16, v123
  v_and_b32 v9, 0xffff0000, v123
  v_lshlrev_b32 v10, 16, v124
  v_and_b32 v11, 0xffff0000, v124
  v_lshlrev_b32 v12, 16, v125
  v_and_b32 v13, 0xffff0000, v125
  v_lshlrev_b32 v14, 16, v126
  v_and_b32 v15, 0xffff0000, v126
  v_lshlrev_b32 v16, 16, v127
  v_and_b32 v17, 0xffff0000, v127
  v_lshlrev_b32 v18, 16, v128
  v_and_b32 v19, 0xffff0000, v128
  v_lshlrev_b32 v20, 16, v129
  v_and_b32 v21, 0xffff0000, v129
  v_lshlrev_b32 v22, 16, v130
  v_and_b32 v23, 0xffff0000, v130
  v_lshlrev_b32 v24, 16, v131
  v_and_b32 v25, 0xffff0000, v131
  v_lshlrev_b32 v26, 16, v132
  v_and_b32 v27, 0xffff0000, v132
  v_lshlrev_b32 v28, 16, v133
  v_and_b32 v29, 0xffff0000, v133
  v_lshlrev_b32 v30, 16, v134
  v_and_b32 v31, 0xffff0000, v134
  v_lshlrev_b32 v32, 16, v135
  v_and_b32 v33, 0xffff0000, v135
  v_lshlrev_b32 v34, 16, v136
  v_and_b32 v35, 0xffff0000, v136
  v_lshlrev_b32 v36, 16, v137
  v_and_b32 v37, 0xffff0000, v137
  v_lshlrev_b32 v38, 16, v138
  v_and_b32 v39, 0xffff0000, v138
  v_lshlrev_b32 v40, 16, v139
  v_and_b32 v41, 0xffff0000, v139
  v_pk_add_f32 v[86:87], v[2:3], v[4:5]
  v_pk_add_f32 v[88:89], v[6:7], v[8:9]
  v_pk_add_f32 v[86:87], v[86:87], v[10:11]
  v_pk_add_f32 v[88:89], v[88:89], v[12:13]
  v_pk_add_f32 v[86:87], v[86:87], v[14:15]
  v_pk_add_f32 v[88:89], v[88:89], v[16:17]
  v_pk_add_f32 v[86:87], v[86:87], v[18:19]
  v_pk_add_f32 v[88:89], v[88:89], v[20:21]
  v_pk_add_f32 v[86:87], v[86:87], v[22:23]
  v_pk_add_f32 v[88:89], v[88:89], v[24:25]
  v_pk_add_f32 v[86:87], v[86:87], v[26:27]
  v_pk_add_f32 v[88:89], v[88:89], v[28:29]
  v_pk_add_f32 v[86:87], v[86:87], v[30:31]
  v_pk_add_f32 v[88:89], v[88:89], v[32:33]
  v_pk_add_f32 v[86:87], v[86:87], v[34:35]
  v_pk_add_f32 v[88:89], v[88:89], v[36:37]
  v_pk_add_f32 v[86:87], v[86:87], v[38:39]
  v_pk_add_f32 v[88:89], v[88:89], v[40:41]
  v_pk_add_f32 v[86:87], v[86:87], v[88:89]
  v_add_f32 v86, v86, v87
  s_nop 1
  v_add_f32_dpp v86, v86, v86 row_ror:8 row_mask:0xf bank_mask:0xf
  s_nop 1
  v_add_f32_dpp v86, v86, v86 row_ror:4 row_mask:0xf bank_mask:0xf
  v_mov_b32 v90, v86
  s_nop 1
  v_permlane16_swap_b32 v86, v90
  v_add_f32 v86, v86, v90
  v_mov_b32 v90, v86
  s_nop 1
  v_permlane32_swap_b32 v86, v90
  v_add_f32 v86, v86, v90
  v_mul_f32 v88, 0xbacccccd, v86
  v_mul_f32 v89, 0xbacccccd, v86
  v_pk_add_f32 v[164:165], v[2:3], v[88:89]
  v_pk_add_f32 v[166:167], v[4:5], v[88:89]
  v_pk_mul_f32 v[170:171], v[164:165], v[164:165]
  v_pk_add_f32 v[168:169], v[6:7], v[88:89]
  v_pk_mul_f32 v[86:87], v[166:167], v[166:167]
  v_pk_add_f32 v[164:165], v[8:9], v[88:89]
  v_pk_fma_f32 v[170:171], v[168:169], v[168:169], v[170:171]
  v_pk_add_f32 v[166:167], v[10:11], v[88:89]
  v_pk_fma_f32 v[86:87], v[164:165], v[164:165], v[86:87]
  v_pk_add_f32 v[168:169], v[12:13], v[88:89]
  v_pk_fma_f32 v[170:171], v[166:167], v[166:167], v[170:171]
  v_pk_add_f32 v[164:165], v[14:15], v[88:89]
  v_pk_fma_f32 v[86:87], v[168:169], v[168:169], v[86:87]
  v_pk_add_f32 v[166:167], v[16:17], v[88:89]
  v_pk_fma_f32 v[170:171], v[164:165], v[164:165], v[170:171]
  v_pk_add_f32 v[168:169], v[18:19], v[88:89]
  v_pk_fma_f32 v[86:87], v[166:167], v[166:167], v[86:87]
  v_pk_add_f32 v[164:165], v[20:21], v[88:89]
  v_pk_fma_f32 v[170:171], v[168:169], v[168:169], v[170:171]
  v_pk_add_f32 v[166:167], v[22:23], v[88:89]
  v_pk_fma_f32 v[86:87], v[164:165], v[164:165], v[86:87]
  v_pk_add_f32 v[168:169], v[24:25], v[88:89]
  v_pk_fma_f32 v[170:171], v[166:167], v[166:167], v[170:171]
  v_pk_add_f32 v[164:165], v[26:27], v[88:89]
  v_pk_fma_f32 v[86:87], v[168:169], v[168:169], v[86:87]
  v_pk_add_f32 v[166:167], v[28:29], v[88:89]
  v_pk_fma_f32 v[170:171], v[164:165], v[164:165], v[170:171]
  v_pk_add_f32 v[168:169], v[30:31], v[88:89]
  v_pk_fma_f32 v[86:87], v[166:167], v[166:167], v[86:87]
  v_pk_add_f32 v[164:165], v[32:33], v[88:89]
  v_pk_fma_f32 v[170:171], v[168:169], v[168:169], v[170:171]
  v_pk_add_f32 v[166:167], v[34:35], v[88:89]
  v_pk_fma_f32 v[86:87], v[164:165], v[164:165], v[86:87]
  v_pk_add_f32 v[168:169], v[36:37], v[88:89]
  v_pk_fma_f32 v[170:171], v[166:167], v[166:167], v[170:171]
  v_pk_add_f32 v[164:165], v[38:39], v[88:89]
  v_pk_fma_f32 v[86:87], v[168:169], v[168:169], v[86:87]
  v_pk_add_f32 v[166:167], v[40:41], v[88:89]
  v_pk_fma_f32 v[170:171], v[164:165], v[164:165], v[170:171]
  v_pk_fma_f32 v[86:87], v[166:167], v[166:167], v[86:87]
  v_cvt_pk_bf16_f32 v91, v88, v89
  v_lshlrev_b32 v88, 16, v91
  v_and_b32 v89, 0xffff0000, v91
  v_pk_add_f32 v[86:87], v[86:87], v[170:171]
  v_add_f32 v86, v86, v87
  s_nop 1
  v_add_f32_dpp v86, v86, v86 row_ror:8 row_mask:0xf bank_mask:0xf
  s_nop 1
  v_add_f32_dpp v86, v86, v86 row_ror:4 row_mask:0xf bank_mask:0xf
  v_mov_b32 v90, v86
  s_nop 1
  v_permlane16_swap_b32 v86, v90
  v_add_f32 v86, v86, v90
  v_mov_b32 v90, v86
  s_nop 1
  v_permlane32_swap_b32 v86, v90
  v_add_f32 v86, v86, v90
  v_pk_add_f32 v[2:3], v[2:3], v[88:89]
  v_mul_f32 v86, 0x3acccccd, v86
  v_pk_add_f32 v[4:5], v[4:5], v[88:89]
  v_cvt_pk_bf16_f32 v86, v86, v86
  v_pk_add_f32 v[6:7], v[6:7], v[88:89]
  v_lshlrev_b32 v86, 16, v86
  v_pk_add_f32 v[8:9], v[8:9], v[88:89]
  v_add_f32 v86, 0x3727c5ac, v86
  v_pk_add_f32 v[10:11], v[10:11], v[88:89]
  v_cvt_pk_bf16_f32 v86, v86, v86
  v_pk_add_f32 v[12:13], v[12:13], v[88:89]
  v_lshlrev_b32 v86, 16, v86
  v_pk_add_f32 v[14:15], v[14:15], v[88:89]
  v_sqrt_f32 v86, v86
  v_pk_add_f32 v[16:17], v[16:17], v[88:89]
  v_cvt_pk_bf16_f32 v86, v86, v86
  v_pk_add_f32 v[18:19], v[18:19], v[88:89]
  v_lshlrev_b32 v86, 16, v86
  v_pk_add_f32 v[20:21], v[20:21], v[88:89]
  v_rcp_f32 v86, v86
  v_pk_add_f32 v[22:23], v[22:23], v[88:89]
  v_mov_b32 v87, v86
  v_pk_add_f32 v[24:25], v[24:25], v[88:89]
  v_pk_add_f32 v[26:27], v[26:27], v[88:89]
  v_pk_add_f32 v[28:29], v[28:29], v[88:89]
  v_pk_add_f32 v[30:31], v[30:31], v[88:89]
  v_pk_add_f32 v[32:33], v[32:33], v[88:89]
  v_pk_add_f32 v[34:35], v[34:35], v[88:89]
  v_pk_add_f32 v[36:37], v[36:37], v[88:89]
  v_pk_add_f32 v[38:39], v[38:39], v[88:89]
  v_pk_add_f32 v[40:41], v[40:41], v[88:89]
  v_cvt_pk_bf16_f32 v164, v2, v3
  v_lshlrev_b32 v2, 16, v164
  v_and_b32 v3, 0xffff0000, v164
  v_cvt_pk_bf16_f32 v165, v4, v5
  v_lshlrev_b32 v4, 16, v165
  v_and_b32 v5, 0xffff0000, v165
  v_cvt_pk_bf16_f32 v166, v6, v7
  v_lshlrev_b32 v6, 16, v166
  v_and_b32 v7, 0xffff0000, v166
  v_cvt_pk_bf16_f32 v167, v8, v9
  v_lshlrev_b32 v8, 16, v167
  v_and_b32 v9, 0xffff0000, v167
  v_cvt_pk_bf16_f32 v164, v10, v11
  v_lshlrev_b32 v10, 16, v164
  v_and_b32 v11, 0xffff0000, v164
  v_cvt_pk_bf16_f32 v165, v12, v13
  v_lshlrev_b32 v12, 16, v165
  v_and_b32 v13, 0xffff0000, v165
  v_cvt_pk_bf16_f32 v166, v14, v15
  v_lshlrev_b32 v14, 16, v166
  v_and_b32 v15, 0xffff0000, v166
  v_cvt_pk_bf16_f32 v167, v16, v17
  v_lshlrev_b32 v16, 16, v167
  v_and_b32 v17, 0xffff0000, v167
  v_cvt_pk_bf16_f32 v164, v18, v19
  v_lshlrev_b32 v18, 16, v164
  v_and_b32 v19, 0xffff0000, v164
  v_cvt_pk_bf16_f32 v165, v20, v21
  v_lshlrev_b32 v20, 16, v165
  v_and_b32 v21, 0xffff0000, v165
  v_cvt_pk_bf16_f32 v166, v22, v23
  v_lshlrev_b32 v22, 16, v166
  v_and_b32 v23, 0xffff0000, v166
  v_cvt_pk_bf16_f32 v167, v24, v25
  v_lshlrev_b32 v24, 16, v167
  v_and_b32 v25, 0xffff0000, v167
  v_cvt_pk_bf16_f32 v164, v26, v27
  v_lshlrev_b32 v26, 16, v164
  v_and_b32 v27, 0xffff0000, v164
  v_cvt_pk_bf16_f32 v165, v28, v29
  v_lshlrev_b32 v28, 16, v165
  v_and_b32 v29, 0xffff0000, v165
  v_cvt_pk_bf16_f32 v166, v30, v31
  v_lshlrev_b32 v30, 16, v166
  v_and_b32 v31, 0xffff0000, v166
  v_cvt_pk_bf16_f32 v167, v32, v33
  v_lshlrev_b32 v32, 16, v167
  v_and_b32 v33, 0xffff0000, v167
  v_cvt_pk_bf16_f32 v164, v34, v35
  v_lshlrev_b32 v34, 16, v164
  v_and_b32 v35, 0xffff0000, v164
  v_cvt_pk_bf16_f32 v165, v36, v37
  v_lshlrev_b32 v36, 16, v165
  v_and_b32 v37, 0xffff0000, v165
  v_cvt_pk_bf16_f32 v166, v38, v39
  v_lshlrev_b32 v38, 16, v166
  v_and_b32 v39, 0xffff0000, v166
  v_cvt_pk_bf16_f32 v167, v40, v41
  v_lshlrev_b32 v40, 16, v167
  v_and_b32 v41, 0xffff0000, v167
  v_pk_mul_f32 v[2:3], v[2:3], v[86:87]
  v_pk_mul_f32 v[4:5], v[4:5], v[86:87]
  v_pk_mul_f32 v[6:7], v[6:7], v[86:87]
  v_pk_mul_f32 v[8:9], v[8:9], v[86:87]
  v_pk_mul_f32 v[10:11], v[10:11], v[86:87]
  v_pk_mul_f32 v[12:13], v[12:13], v[86:87]
  v_pk_mul_f32 v[14:15], v[14:15], v[86:87]
  v_pk_mul_f32 v[16:17], v[16:17], v[86:87]
  v_pk_mul_f32 v[18:19], v[18:19], v[86:87]
  v_pk_mul_f32 v[20:21], v[20:21], v[86:87]
  v_pk_mul_f32 v[22:23], v[22:23], v[86:87]
  v_pk_mul_f32 v[24:25], v[24:25], v[86:87]
  v_pk_mul_f32 v[26:27], v[26:27], v[86:87]
  v_pk_mul_f32 v[28:29], v[28:29], v[86:87]
  v_pk_mul_f32 v[30:31], v[30:31], v[86:87]
  v_pk_mul_f32 v[32:33], v[32:33], v[86:87]
  v_pk_mul_f32 v[34:35], v[34:35], v[86:87]
  v_pk_mul_f32 v[36:37], v[36:37], v[86:87]
  v_pk_mul_f32 v[38:39], v[38:39], v[86:87]
  v_pk_mul_f32 v[40:41], v[40:41], v[86:87]
  v_cvt_pk_bf16_f32 v120, v2, v3
  v_cvt_pk_bf16_f32 v121, v4, v5
  v_cvt_pk_bf16_f32 v122, v6, v7
  v_cvt_pk_bf16_f32 v123, v8, v9
  v_cvt_pk_bf16_f32 v124, v10, v11
  v_cvt_pk_bf16_f32 v125, v12, v13
  v_cvt_pk_bf16_f32 v126, v14, v15
  v_cvt_pk_bf16_f32 v127, v16, v17
  v_cvt_pk_bf16_f32 v128, v18, v19
  v_cvt_pk_bf16_f32 v129, v20, v21
  v_cvt_pk_bf16_f32 v130, v22, v23
  v_cvt_pk_bf16_f32 v131, v24, v25
  v_cvt_pk_bf16_f32 v132, v26, v27
  v_cvt_pk_bf16_f32 v133, v28, v29
  v_cvt_pk_bf16_f32 v134, v30, v31
  v_cvt_pk_bf16_f32 v135, v32, v33
  v_cvt_pk_bf16_f32 v136, v34, v35
  v_cvt_pk_bf16_f32 v137, v36, v37
  v_cvt_pk_bf16_f32 v138, v38, v39
  v_cvt_pk_bf16_f32 v139, v40, v41
  s_cmp_lg_u32 s17, 0
  s_cbranch_scc1 r_g1
  s_cmp_lg_u32 s18, 31
  s_cbranch_scc1 r_g0
  v_mov_b32 v90, 200
  s_mov_b32 s34, 0
gw_9:
  buffer_load_dword v91, v90, s[12:15], 0 offen sc1
  s_add_u32 s34, s34, 1
  s_cmp_gt_u32 s34, 65536
  s_cbranch_scc1 role_abort
  s_waitcnt vmcnt(0)
  v_cmp_gt_u32 vcc, 20, v91
  s_cbranch_vccz gk_10
  s_sleep 4
  s_branch gw_9
gk_10:
  s_lshl_b32 s35, s16, 2
  s_add_u32 s35, s35, 32
  v_mov_b32 v90, s35
  v_mov_b32 v91, 1
  s_waitcnt vmcnt(0)
  s_mov_b64 exec, 1
  buffer_atomic_add v91, v90, s[12:15], 0 offen
  s_mov_b64 exec, -1
r_g0:
  s_lshl_b32 s34, s16, 2
  s_add_u32 s34, s34, 32
  v_mov_b32 v90, s34
  s_mov_b32 s34, 0
  s_mov_b64 exec, 1
gw_11:
  buffer_load_dword v91, v90, s[12:15], 0 offen sc1
  s_add_u32 s34, s34, 1
  s_cmp_gt_u32 s34, 65536
  s_cbranch_scc1 role_abort
  s_waitcnt vmcnt(0)
  v_cmp_gt_u32 vcc, 2, v91
  s_cbranch_vccz gk_12
  s_sleep 2
  s_branch gw_11
gk_12:
  s_mov_b64 exec, -1
r_g1:
  s_barrier
  s_mov_b32 s35, 65536
  s_mov_b32 s33, s54
  buffer_load_dwordx4 v[176:179], v162, s[8:11], s35 offen offset:0 sc1
  buffer_load_dwordx4 v[180:183], v162, s[8:11], s35 offen offset:512 sc1
  buffer_load_dwordx4 v[184:187], v162, s[8:11], s35 offen offset:1024 sc1
  buffer_load_dwordx4 v[188:191], v162, s[8:11], s35 offen offset:1536 sc1
  buffer_load_dwordx4 v[192:195], v162, s[8:11], s35 offen offset:2048 sc1
  s_waitcnt vmcnt(4)
  v_add_f32 v176, v163, v176
  v_add_f32 v177, v163, v177
  v_add_f32 v178, v163, v178
  v_add_f32 v179, v163, v179
  v_cvt_pk_bf16_f32 v90, v176, v177
  v_lshlrev_b32 v176, 16, v90
  v_and_b32 v177, 0xffff0000, v90
  v_cvt_pk_bf16_f32 v91, v178, v179
  v_lshlrev_b32 v178, 16, v91
  v_and_b32 v179, 0xffff0000, v91
  s_waitcnt vmcnt(3)
  v_add_f32 v180, v163, v180
  v_add_f32 v181, v163, v181
  v_add_f32 v182, v163, v182
  v_add_f32 v183, v163, v183
  v_cvt_pk_bf16_f32 v90, v180, v181
  v_lshlrev_b32 v180, 16, v90
  v_and_b32 v181, 0xffff0000, v90
  v_cvt_pk_bf16_f32 v91, v182, v183
  v_lshlrev_b32 v182, 16, v91
  v_and_b32 v183, 0xffff0000, v91
  s_waitcnt vmcnt(2)
  v_add_f32 v184, v163, v184
  v_add_f32 v185, v163, v185
  v_add_f32 v186, v163, v186
  v_add_f32 v187, v163, v187
  v_cvt_pk_bf16_f32 v90, v184, v185
  v_lshlrev_b32 v184, 16, v90
  v_and_b32 v185, 0xffff0000, v90
  v_cvt_pk_bf16_f32 v91, v186, v187
  v_lshlrev_b32 v186, 16, v91
  v_and_b32 v187, 0xffff0000, v91
  s_waitcnt vmcnt(1)
  v_add_f32 v188, v163, v188
  v_add_f32 v189, v163, v189
  v_add_f32 v190, v163, v190
  v_add_f32 v191, v163, v191
  v_cvt_pk_bf16_f32 v90, v188, v189
  v_lshlrev_b32 v188, 16, v90
  v_and_b32 v189, 0xffff0000, v90
  v_cvt_pk_bf16_f32 v91, v190, v191
  v_lshlrev_b32 v190, 16, v91
  v_and_b32 v191, 0xffff0000, v91
  s_waitcnt vmcnt(0)
  v_add_f32 v192, v163, v192
  v_add_f32 v193, v163, v193
  v_add_f32 v194, v163, v194
  v_add_f32 v195, v163, v195
  v_cvt_pk_bf16_f32 v90, v192, v193
  v_lshlrev_b32 v192, 16, v90
  v_and_b32 v193, 0xffff0000, v90
  v_cvt_pk_bf16_f32 v91, v194, v195
  v_lshlrev_b32 v194, 16, v91
  v_and_b32 v195, 0xffff0000, v91
  v_lshlrev_b32 v2, 16, v100
  v_and_b32 v3, 0xffff0000, v100
  v_lshlrev_b32 v4, 16, v101
  v_and_b32 v5, 0xffff0000, v101
  v_lshlrev_b32 v6, 16, v102
  v_and_b32 v7, 0xffff0000, v102
  v_lshlrev_b32 v8, 16, v103
  v_and_b32 v9, 0xffff0000, v103
  v_mul_f32_dpp v2, v176, v2 quad_perm:[2,2,2,2] row_mask:0xf bank_mask:0xf
  v_mul_f32_dpp v3, v177, v3 quad_perm:[2,2,2,2] row_mask:0xf bank_mask:0xf
  v_mul_f32_dpp v4, v178, v4 quad_perm:[2,2,2,2] row_mask:0xf bank_mask:0xf
  v_mul_f32_dpp v5, v179, v5 quad_perm:[2,2,2,2] row_mask:0xf bank_mask:0xf
  v_mul_f32_dpp v6, v176, v6 quad_perm:[3,3,3,3] row_mask:0xf bank_mask:0xf
  v_mul_f32_dpp v7, v177, v7 quad_perm:[3,3,3,3] row_mask:0xf bank_mask:0xf
  v_mul_f32_dpp v8, v178, v8 quad_perm:[3,3,3,3] row_mask:0xf bank_mask:0xf
  v_mul_f32_dpp v9, v179, v9 quad_perm:[3,3,3,3] row_mask:0xf bank_mask:0xf
  v_cvt_pk_bf16_f32 v164, v2, v3
  v_lshlrev_b32 v2, 16, v164
  v_and_b32 v3, 0xffff0000, v164
  v_cvt_pk_bf16_f32 v165, v4, v5
  v_lshlrev_b32 v4, 16, v165
  v_and_b32 v5, 0xffff0000, v165
  v_cvt_pk_bf16_f32 v166, v6, v7
  v_lshlrev_b32 v6, 16, v166
  v_and_b32 v7, 0xffff0000, v166
  v_cvt_pk_bf16_f32 v167, v8, v9
  v_lshlrev_b32 v8, 16, v167
  v_and_b32 v9, 0xffff0000, v167
  v_add_f32_dpp v2, v176, v2 quad_perm:[0,0,0,0] row_mask:0xf bank_mask:0xf
  v_add_f32_dpp v3, v177, v3 quad_perm:[0,0,0,0] row_mask:0xf bank_mask:0xf
  v_add_f32_dpp v4, v178, v4 quad_perm:[0,0,0,0] row_mask:0xf bank_mask:0xf
  v_add_f32_dpp v5, v179, v5 quad_perm:[0,0,0,0] row_mask:0xf bank_mask:0xf
  v_add_f32_dpp v6, v176, v6 quad_perm:[1,1,1,1] row_mask:0xf bank_mask:0xf
  v_add_f32_dpp v7, v177, v7 quad_perm:[1,1,1,1] row_mask:0xf bank_mask:0xf
  v_add_f32_dpp v8, v178, v8 quad_perm:[1,1,1,1] row_mask:0xf bank_mask:0xf
  v_add_f32_dpp v9, v179, v9 quad_perm:[1,1,1,1] row_mask:0xf bank_mask:0xf
  v_cvt_pk_bf16_f32 v196, v2, v3
  v_cvt_pk_bf16_f32 v197, v4, v5
  v_cvt_pk_bf16_f32 v198, v6, v7
  v_cvt_pk_bf16_f32 v199, v8, v9
  s_add_u32 s35, s38, 0
  buffer_store_dwordx4 v[196:199], v161, s[8:11], s35 offen
  v_lshlrev_b32 v10, 16, v104
  v_and_b32 v11, 0xffff0000, v104
  v_lshlrev_b32 v12, 16, v105
  v_and_b32 v13, 0xffff0000, v105
  v_lshlrev_b32 v14, 16, v106
  v_and_b32 v15, 0xffff0000, v106
  v_lshlrev_b32 v16, 16, v107
  v_and_b32 v17, 0xffff0000, v107
  v_mul_f32_dpp v10, v180, v10 quad_perm:[2,2,2,2] row_mask:0xf bank_mask:0xf
  v_mul_f32_dpp v11, v181, v11 quad_perm:[2,2,2,2] row_mask:0xf bank_mask:0xf
  v_mul_f32_dpp v12, v182, v12 quad_perm:[2,2,2,2] row_mask:0xf bank_mask:0xf
  v_mul_f32_dpp v13, v183, v13 quad_perm:[2,2,2,2] row_mask:0xf bank_mask:0xf
  v_mul_f32_dpp v14, v180, v14 quad_perm:[3,3,3,3] row_mask:0xf bank_mask:0xf
  v_mul_f32_dpp v15, v181, v15 quad_perm:[3,3,3,3] row_mask:0xf bank_mask:0xf
  v_mul_f32_dpp v16, v182, v16 quad_perm:[3,3,3,3] row_mask:0xf bank_mask:0xf
  v_mul_f32_dpp v17, v183, v17 quad_perm:[3,3,3,3] row_mask:0xf bank_mask:0xf
  v_cvt_pk_bf16_f32 v164, v10, v11
  v_lshlrev_b32 v10, 16, v164
  v_and_b32 v11, 0xffff0000, v164
  v_cvt_pk_bf16_f32 v165, v12, v13
  v_lshlrev_b32 v12, 16, v165
  v_and_b32 v13, 0xffff0000, v165
  v_cvt_pk_bf16_f32 v166, v14, v15
  v_lshlrev_b32 v14, 16, v166
  v_and_b32 v15, 0xffff0000, v166
  v_cvt_pk_bf16_f32 v167, v16, v17
  v_lshlrev_b32 v16, 16, v167
  v_and_b32 v17, 0xffff0000, v167
  v_add_f32_dpp v10, v180, v10 quad_perm:[0,0,0,0] row_mask:0xf bank_mask:0xf
  v_add_f32_dpp v11, v181, v11 quad_perm:[0,0,0,0] row_mask:0xf bank_mask:0xf
  v_add_f32_dpp v12, v182, v12 quad_perm:[0,0,0,0] row_mask:0xf bank_mask:0xf
  v_add_f32_dpp v13, v183, v13 quad_perm:[0,0,0,0] row_mask:0xf bank_mask:0xf
  v_add_f32_dpp v14, v180, v14 quad_perm:[1,1,1,1] row_mask:0xf bank_mask:0xf
  v_add_f32_dpp v15, v181, v15 quad_perm:[1,1,1,1] row_mask:0xf bank_mask:0xf
  v_add_f32_dpp v16, v182, v16 quad_perm:[1,1,1,1] row_mask:0xf bank_mask:0xf
  v_add_f32_dpp v17, v183, v17 quad_perm:[1,1,1,1] row_mask:0xf bank_mask:0xf
  v_cvt_pk_bf16_f32 v200, v10, v11
  v_cvt_pk_bf16_f32 v201, v12, v13
  v_cvt_pk_bf16_f32 v202, v14, v15
  v_cvt_pk_bf16_f32 v203, v16, v17
  s_add_u32 s35, s38, 4096
  buffer_store_dwordx4 v[200:203], v161, s[8:11], s35 offen
  v_lshlrev_b32 v18, 16, v108
  v_and_b32 v19, 0xffff0000, v108
  v_lshlrev_b32 v20, 16, v109
  v_and_b32 v21, 0xffff0000, v109
  v_lshlrev_b32 v22, 16, v110
  v_and_b32 v23, 0xffff0000, v110
  v_lshlrev_b32 v24, 16, v111
  v_and_b32 v25, 0xffff0000, v111
  v_mul_f32_dpp v18, v184, v18 quad_perm:[2,2,2,2] row_mask:0xf bank_mask:0xf
  v_mul_f32_dpp v19, v185, v19 quad_perm:[2,2,2,2] row_mask:0xf bank_mask:0xf
  v_mul_f32_dpp v20, v186, v20 quad_perm:[2,2,2,2] row_mask:0xf bank_mask:0xf
  v_mul_f32_dpp v21, v187, v21 quad_perm:[2,2,2,2] row_mask:0xf bank_mask:0xf
  v_mul_f32_dpp v22, v184, v22 quad_perm:[3,3,3,3] row_mask:0xf bank_mask:0xf
  v_mul_f32_dpp v23, v185, v23 quad_perm:[3,3,3,3] row_mask:0xf bank_mask:0xf
  v_mul_f32_dpp v24, v186, v24 quad_perm:[3,3,3,3] row_mask:0xf bank_mask:0xf
  v_mul_f32_dpp v25, v187, v25 quad_perm:[3,3,3,3] row_mask:0xf bank_mask:0xf
  v_cvt_pk_bf16_f32 v164, v18, v19
  v_lshlrev_b32 v18, 16, v164
  v_and_b32 v19, 0xffff0000, v164
  v_cvt_pk_bf16_f32 v165, v20, v21
  v_lshlrev_b32 v20, 16, v165
  v_and_b32 v21, 0xffff0000, v165
  v_cvt_pk_bf16_f32 v166, v22, v23
  v_lshlrev_b32 v22, 16, v166
  v_and_b32 v23, 0xffff0000, v166
  v_cvt_pk_bf16_f32 v167, v24, v25
  v_lshlrev_b32 v24, 16, v167
  v_and_b32 v25, 0xffff0000, v167
  v_add_f32_dpp v18, v184, v18 quad_perm:[0,0,0,0] row_mask:0xf bank_mask:0xf
  v_add_f32_dpp v19, v185, v19 quad_perm:[0,0,0,0] row_mask:0xf bank_mask:0xf
  v_add_f32_dpp v20, v186, v20 quad_perm:[0,0,0,0] row_mask:0xf bank_mask:0xf
  v_add_f32_dpp v21, v187, v21 quad_perm:[0,0,0,0] row_mask:0xf bank_mask:0xf
  v_add_f32_dpp v22, v184, v22 quad_perm:[1,1,1,1] row_mask:0xf bank_mask:0xf
  v_add_f32_dpp v23, v185, v23 quad_perm:[1,1,1,1] row_mask:0xf bank_mask:0xf
  v_add_f32_dpp v24, v186, v24 quad_perm:[1,1,1,1] row_mask:0xf bank_mask:0xf
  v_add_f32_dpp v25, v187, v25 quad_perm:[1,1,1,1] row_mask:0xf bank_mask:0xf
  v_cvt_pk_bf16_f32 v204, v18, v19
  v_cvt_pk_bf16_f32 v205, v20, v21
  v_cvt_pk_bf16_f32 v206, v22, v23
  v_cvt_pk_bf16_f32 v207, v24, v25
  s_add_u32 s35, s38, 8192
  buffer_store_dwordx4 v[204:207], v161, s[8:11], s35 offen
  v_lshlrev_b32 v26, 16, v112
  v_and_b32 v27, 0xffff0000, v112
  v_lshlrev_b32 v28, 16, v113
  v_and_b32 v29, 0xffff0000, v113
  v_lshlrev_b32 v30, 16, v114
  v_and_b32 v31, 0xffff0000, v114
  v_lshlrev_b32 v32, 16, v115
  v_and_b32 v33, 0xffff0000, v115
  v_mul_f32_dpp v26, v188, v26 quad_perm:[2,2,2,2] row_mask:0xf bank_mask:0xf
  v_mul_f32_dpp v27, v189, v27 quad_perm:[2,2,2,2] row_mask:0xf bank_mask:0xf
  v_mul_f32_dpp v28, v190, v28 quad_perm:[2,2,2,2] row_mask:0xf bank_mask:0xf
  v_mul_f32_dpp v29, v191, v29 quad_perm:[2,2,2,2] row_mask:0xf bank_mask:0xf
  v_mul_f32_dpp v30, v188, v30 quad_perm:[3,3,3,3] row_mask:0xf bank_mask:0xf
  v_mul_f32_dpp v31, v189, v31 quad_perm:[3,3,3,3] row_mask:0xf bank_mask:0xf
  v_mul_f32_dpp v32, v190, v32 quad_perm:[3,3,3,3] row_mask:0xf bank_mask:0xf
  v_mul_f32_dpp v33, v191, v33 quad_perm:[3,3,3,3] row_mask:0xf bank_mask:0xf
  v_cvt_pk_bf16_f32 v164, v26, v27
  v_lshlrev_b32 v26, 16, v164
  v_and_b32 v27, 0xffff0000, v164
  v_cvt_pk_bf16_f32 v165, v28, v29
  v_lshlrev_b32 v28, 16, v165
  v_and_b32 v29, 0xffff0000, v165
  v_cvt_pk_bf16_f32 v166, v30, v31
  v_lshlrev_b32 v30, 16, v166
  v_and_b32 v31, 0xffff0000, v166
  v_cvt_pk_bf16_f32 v167, v32, v33
  v_lshlrev_b32 v32, 16, v167
  v_and_b32 v33, 0xffff0000, v167
  v_add_f32_dpp v26, v188, v26 quad_perm:[0,0,0,0] row_mask:0xf bank_mask:0xf
  v_add_f32_dpp v27, v189, v27 quad_perm:[0,0,0,0] row_mask:0xf bank_mask:0xf
  v_add_f32_dpp v28, v190, v28 quad_perm:[0,0,0,0] row_mask:0xf bank_mask:0xf
  v_add_f32_dpp v29, v191, v29 quad_perm:[0,0,0,0] row_mask:0xf bank_mask:0xf
  v_add_f32_dpp v30, v188, v30 quad_perm:[1,1,1,1] row_mask:0xf bank_mask:0xf
  v_add_f32_dpp v31, v189, v31 quad_perm:[1,1,1,1] row_mask:0xf bank_mask:0xf
  v_add_f32_dpp v32, v190, v32 quad_perm:[1,1,1,1] row_mask:0xf bank_mask:0xf
  v_add_f32_dpp v33, v191, v33 quad_perm:[1,1,1,1] row_mask:0xf bank_mask:0xf
  v_cvt_pk_bf16_f32 v208, v26, v27
  v_cvt_pk_bf16_f32 v209, v28, v29
  v_cvt_pk_bf16_f32 v210, v30, v31
  v_cvt_pk_bf16_f32 v211, v32, v33
  s_add_u32 s35, s38, 12288
  buffer_store_dwordx4 v[208:211], v161, s[8:11], s35 offen
  v_lshlrev_b32 v34, 16, v116
  v_and_b32 v35, 0xffff0000, v116
  v_lshlrev_b32 v36, 16, v117
  v_and_b32 v37, 0xffff0000, v117
  v_lshlrev_b32 v38, 16, v118
  v_and_b32 v39, 0xffff0000, v118
  v_lshlrev_b32 v40, 16, v119
  v_and_b32 v41, 0xffff0000, v119
  v_mul_f32_dpp v34, v192, v34 quad_perm:[2,2,2,2] row_mask:0xf bank_mask:0xf
  v_mul_f32_dpp v35, v193, v35 quad_perm:[2,2,2,2] row_mask:0xf bank_mask:0xf
  v_mul_f32_dpp v36, v194, v36 quad_perm:[2,2,2,2] row_mask:0xf bank_mask:0xf
  v_mul_f32_dpp v37, v195, v37 quad_perm:[2,2,2,2] row_mask:0xf bank_mask:0xf
  v_mul_f32_dpp v38, v192, v38 quad_perm:[3,3,3,3] row_mask:0xf bank_mask:0xf
  v_mul_f32_dpp v39, v193, v39 quad_perm:[3,3,3,3] row_mask:0xf bank_mask:0xf
  v_mul_f32_dpp v40, v194, v40 quad_perm:[3,3,3,3] row_mask:0xf bank_mask:0xf
  v_mul_f32_dpp v41, v195, v41 quad_perm:[3,3,3,3] row_mask:0xf bank_mask:0xf
  v_cvt_pk_bf16_f32 v164, v34, v35
  v_lshlrev_b32 v34, 16, v164
  v_and_b32 v35, 0xffff0000, v164
  v_cvt_pk_bf16_f32 v165, v36, v37
  v_lshlrev_b32 v36, 16, v165
  v_and_b32 v37, 0xffff0000, v165
  v_cvt_pk_bf16_f32 v166, v38, v39
  v_lshlrev_b32 v38, 16, v166
  v_and_b32 v39, 0xffff0000, v166
  v_cvt_pk_bf16_f32 v167, v40, v41
  v_lshlrev_b32 v40, 16, v167
  v_and_b32 v41, 0xffff0000, v167
  v_add_f32_dpp v34, v192, v34 quad_perm:[0,0,0,0] row_mask:0xf bank_mask:0xf
  v_add_f32_dpp v35, v193, v35 quad_perm:[0,0,0,0] row_mask:0xf bank_mask:0xf
  v_add_f32_dpp v36, v194, v36 quad_perm:[0,0,0,0] row_mask:0xf bank_mask:0xf
  v_add_f32_dpp v37, v195, v37 quad_perm:[0,0,0,0] row_mask:0xf bank_mask:0xf
  v_add_f32_dpp v38, v192, v38 quad_perm:[1,1,1,1] row_mask:0xf bank_mask:0xf
  v_add_f32_dpp v39, v193, v39 quad_perm:[1,1,1,1] row_mask:0xf bank_mask:0xf
  v_add_f32_dpp v40, v194, v40 quad_perm:[1,1,1,1] row_mask:0xf bank_mask:0xf
  v_add_f32_dpp v41, v195, v41 quad_perm:[1,1,1,1] row_mask:0xf bank_mask:0xf
  v_cvt_pk_bf16_f32 v212, v34, v35
  v_cvt_pk_bf16_f32 v213, v36, v37
  v_cvt_pk_bf16_f32 v214, v38, v39
  v_cvt_pk_bf16_f32 v215, v40, v41
  s_add_u32 s35, s38, 16384
  buffer_store_dwordx4 v[212:215], v161, s[8:11], s35 offen
  s_add_u32 s36, s41, 24
  s_cmp_lt_u32 s41, 24
  s_cselect_b32 s36, s39, s36
  s_add_u32 s41, s41, 3
  s_cmp_lt_u32 s41, 24
  s_cselect_b32 s41, s41, s36
  s_min_u32 s41, s41, 127
  s_mul_i32 s38, s16, 2621440
  s_cmp_lt_u32 s41, 24
  s_cselect_b32 s38, s38, 0
  s_mul_i32 s36, s41, 20480
  s_add_u32 s38, s38, s36
  s_lshl_b32 s36, s17, 6
  s_add_u32 s38, s38, s36
  s_add_u32 s38, s38, 247463936
  s_add_u32 s33, s33, 3
  v_lshlrev_b32 v2, 16, v120
  v_and_b32 v3, 0xffff0000, v120
  v_lshlrev_b32 v4, 16, v121
  v_and_b32 v5, 0xffff0000, v121
  v_lshlrev_b32 v6, 16, v122
  v_and_b32 v7, 0xffff0000, v122
  v_lshlrev_b32 v8, 16, v123
  v_and_b32 v9, 0xffff0000, v123
  v_mul_f32_dpp v2, v176, v2 quad_perm:[2,2,2,2] row_mask:0xf bank_mask:0xf
  v_mul_f32_dpp v3, v177, v3 quad_perm:[2,2,2,2] row_mask:0xf bank_mask:0xf
  v_mul_f32_dpp v4, v178, v4 quad_perm:[2,2,2,2] row_mask:0xf bank_mask:0xf
  v_mul_f32_dpp v5, v179, v5 quad_perm:[2,2,2,2] row_mask:0xf bank_mask:0xf
  v_mul_f32_dpp v6, v176, v6 quad_perm:[3,3,3,3] row_mask:0xf bank_mask:0xf
  v_mul_f32_dpp v7, v177, v7 quad_perm:[3,3,3,3] row_mask:0xf bank_mask:0xf
  v_mul_f32_dpp v8, v178, v8 quad_perm:[3,3,3,3] row_mask:0xf bank_mask:0xf
  v_mul_f32_dpp v9, v179, v9 quad_perm:[3,3,3,3] row_mask:0xf bank_mask:0xf
  v_cvt_pk_bf16_f32 v164, v2, v3
  v_lshlrev_b32 v2, 16, v164
  v_and_b32 v3, 0xffff0000, v164
  v_cvt_pk_bf16_f32 v165, v4, v5
  v_lshlrev_b32 v4, 16, v165
  v_and_b32 v5, 0xffff0000, v165
  v_cvt_pk_bf16_f32 v166, v6, v7
  v_lshlrev_b32 v6, 16, v166
  v_and_b32 v7, 0xffff0000, v166
  v_cvt_pk_bf16_f32 v167, v8, v9
  v_lshlrev_b32 v8, 16, v167
  v_and_b32 v9, 0xffff0000, v167
  v_add_f32_dpp v2, v176, v2 quad_perm:[0,0,0,0] row_mask:0xf bank_mask:0xf
  v_add_f32_dpp v3, v177, v3 quad_perm:[0,0,0,0] row_mask:0xf bank_mask:0xf
  v_add_f32_dpp v4, v178, v4 quad_perm:[0,0,0,0] row_mask:0xf bank_mask:0xf
  v_add_f32_dpp v5, v179, v5 quad_perm:[0,0,0,0] row_mask:0xf bank_mask:0xf
  v_add_f32_dpp v6, v176, v6 quad_perm:[1,1,1,1] row_mask:0xf bank_mask:0xf
  v_add_f32_dpp v7, v177, v7 quad_perm:[1,1,1,1] row_mask:0xf bank_mask:0xf
  v_add_f32_dpp v8, v178, v8 quad_perm:[1,1,1,1] row_mask:0xf bank_mask:0xf
  v_add_f32_dpp v9, v179, v9 quad_perm:[1,1,1,1] row_mask:0xf bank_mask:0xf
  v_cvt_pk_bf16_f32 v196, v2, v3
  v_cvt_pk_bf16_f32 v197, v4, v5
  v_cvt_pk_bf16_f32 v198, v6, v7
  v_cvt_pk_bf16_f32 v199, v8, v9
  s_sub_u32 s36, s33, 0
  s_min_u32 s36, s36, 24
  v_mov_b32 v92, s36
  s_waitcnt vmcnt(0)
  buffer_store_dword v92, v228, s[8:11], 0 offen
  s_add_u32 s35, s38, 0
  buffer_store_dwordx4 v[196:199], v161, s[8:11], s35 offen
  v_lshlrev_b32 v10, 16, v124
  v_and_b32 v11, 0xffff0000, v124
  v_lshlrev_b32 v12, 16, v125
  v_and_b32 v13, 0xffff0000, v125
  v_lshlrev_b32 v14, 16, v126
  v_and_b32 v15, 0xffff0000, v126
  v_lshlrev_b32 v16, 16, v127
  v_and_b32 v17, 0xffff0000, v127
  v_mul_f32_dpp v10, v180, v10 quad_perm:[2,2,2,2] row_mask:0xf bank_mask:0xf
  v_mul_f32_dpp v11, v181, v11 quad_perm:[2,2,2,2] row_mask:0xf bank_mask:0xf
  v_mul_f32_dpp v12, v182, v12 quad_perm:[2,2,2,2] row_mask:0xf bank_mask:0xf
  v_mul_f32_dpp v13, v183, v13 quad_perm:[2,2,2,2] row_mask:0xf bank_mask:0xf
  v_mul_f32_dpp v14, v180, v14 quad_perm:[3,3,3,3] row_mask:0xf bank_mask:0xf
  v_mul_f32_dpp v15, v181, v15 quad_perm:[3,3,3,3] row_mask:0xf bank_mask:0xf
  v_mul_f32_dpp v16, v182, v16 quad_perm:[3,3,3,3] row_mask:0xf bank_mask:0xf
  v_mul_f32_dpp v17, v183, v17 quad_perm:[3,3,3,3] row_mask:0xf bank_mask:0xf
  v_cvt_pk_bf16_f32 v164, v10, v11
  v_lshlrev_b32 v10, 16, v164
  v_and_b32 v11, 0xffff0000, v164
  v_cvt_pk_bf16_f32 v165, v12, v13
  v_lshlrev_b32 v12, 16, v165
  v_and_b32 v13, 0xffff0000, v165
  v_cvt_pk_bf16_f32 v166, v14, v15
  v_lshlrev_b32 v14, 16, v166
  v_and_b32 v15, 0xffff0000, v166
  v_cvt_pk_bf16_f32 v167, v16, v17
  v_lshlrev_b32 v16, 16, v167
  v_and_b32 v17, 0xffff0000, v167
  v_add_f32_dpp v10, v180, v10 quad_perm:[0,0,0,0] row_mask:0xf bank_mask:0xf
  v_add_f32_dpp v11, v181, v11 quad_perm:[0,0,0,0] row_mask:0xf bank_mask:0xf
  v_add_f32_dpp v12, v182, v12 quad_perm:[0,0,0,0] row_mask:0xf bank_mask:0xf
  v_add_f32_dpp v13, v183, v13 quad_perm:[0,0,0,0] row_mask:0xf bank_mask:0xf
  v_add_f32_dpp v14, v180, v14 quad_perm:[1,1,1,1] row_mask:0xf bank_mask:0xf
  v_add_f32_dpp v15, v181, v15 quad_perm:[1,1,1,1] row_mask:0xf bank_mask:0xf
  v_add_f32_dpp v16, v182, v16 quad_perm:[1,1,1,1] row_mask:0xf bank_mask:0xf
  v_add_f32_dpp v17, v183, v17 quad_perm:[1,1,1,1] row_mask:0xf bank_mask:0xf
  v_cvt_pk_bf16_f32 v200, v10, v11
  v_cvt_pk_bf16_f32 v201, v12, v13
  v_cvt_pk_bf16_f32 v202, v14, v15
  v_cvt_pk_bf16_f32 v203, v16, v17
  s_add_u32 s35, s38, 4096
  buffer_store_dwordx4 v[200:203], v161, s[8:11], s35 offen
  v_lshlrev_b32 v18, 16, v128
  v_and_b32 v19, 0xffff0000, v128
  v_lshlrev_b32 v20, 16, v129
  v_and_b32 v21, 0xffff0000, v129
  v_lshlrev_b32 v22, 16, v130
  v_and_b32 v23, 0xffff0000, v130
  v_lshlrev_b32 v24, 16, v131
  v_and_b32 v25, 0xffff0000, v131
  v_mul_f32_dpp v18, v184, v18 quad_perm:[2,2,2,2] row_mask:0xf bank_mask:0xf
  v_mul_f32_dpp v19, v185, v19 quad_perm:[2,2,2,2] row_mask:0xf bank_mask:0xf
  v_mul_f32_dpp v20, v186, v20 quad_perm:[2,2,2,2] row_mask:0xf bank_mask:0xf
  v_mul_f32_dpp v21, v187, v21 quad_perm:[2,2,2,2] row_mask:0xf bank_mask:0xf
  v_mul_f32_dpp v22, v184, v22 quad_perm:[3,3,3,3] row_mask:0xf bank_mask:0xf
  v_mul_f32_dpp v23, v185, v23 quad_perm:[3,3,3,3] row_mask:0xf bank_mask:0xf
  v_mul_f32_dpp v24, v186, v24 quad_perm:[3,3,3,3] row_mask:0xf bank_mask:0xf
  v_mul_f32_dpp v25, v187, v25 quad_perm:[3,3,3,3] row_mask:0xf bank_mask:0xf
  v_cvt_pk_bf16_f32 v164, v18, v19
  v_lshlrev_b32 v18, 16, v164
  v_and_b32 v19, 0xffff0000, v164
  v_cvt_pk_bf16_f32 v165, v20, v21
  v_lshlrev_b32 v20, 16, v165
  v_and_b32 v21, 0xffff0000, v165
  v_cvt_pk_bf16_f32 v166, v22, v23
  v_lshlrev_b32 v22, 16, v166
  v_and_b32 v23, 0xffff0000, v166
  v_cvt_pk_bf16_f32 v167, v24, v25
  v_lshlrev_b32 v24, 16, v167
  v_and_b32 v25, 0xffff0000, v167
  v_add_f32_dpp v18, v184, v18 quad_perm:[0,0,0,0] row_mask:0xf bank_mask:0xf
  v_add_f32_dpp v19, v185, v19 quad_perm:[0,0,0,0] row_mask:0xf bank_mask:0xf
  v_add_f32_dpp v20, v186, v20 quad_perm:[0,0,0,0] row_mask:0xf bank_mask:0xf
  v_add_f32_dpp v21, v187, v21 quad_perm:[0,0,0,0] row_mask:0xf bank_mask:0xf
  v_add_f32_dpp v22, v184, v22 quad_perm:[1,1,1,1] row_mask:0xf bank_mask:0xf
  v_add_f32_dpp v23, v185, v23 quad_perm:[1,1,1,1] row_mask:0xf bank_mask:0xf
  v_add_f32_dpp v24, v186, v24 quad_perm:[1,1,1,1] row_mask:0xf bank_mask:0xf
  v_add_f32_dpp v25, v187, v25 quad_perm:[1,1,1,1] row_mask:0xf bank_mask:0xf
  v_cvt_pk_bf16_f32 v204, v18, v19
  v_cvt_pk_bf16_f32 v205, v20, v21
  v_cvt_pk_bf16_f32 v206, v22, v23
  v_cvt_pk_bf16_f32 v207, v24, v25
  s_add_u32 s35, s38, 8192
  buffer_store_dwordx4 v[204:207], v161, s[8:11], s35 offen
  v_lshlrev_b32 v26, 16, v132
  v_and_b32 v27, 0xffff0000, v132
  v_lshlrev_b32 v28, 16, v133
  v_and_b32 v29, 0xffff0000, v133
  v_lshlrev_b32 v30, 16, v134
  v_and_b32 v31, 0xffff0000, v134
  v_lshlrev_b32 v32, 16, v135
  v_and_b32 v33, 0xffff0000, v135
  v_mul_f32_dpp v26, v188, v26 quad_perm:[2,2,2,2] row_mask:0xf bank_mask:0xf
  v_mul_f32_dpp v27, v189, v27 quad_perm:[2,2,2,2] row_mask:0xf bank_mask:0xf
  v_mul_f32_dpp v28, v190, v28 quad_perm:[2,2,2,2] row_mask:0xf bank_mask:0xf
  v_mul_f32_dpp v29, v191, v29 quad_perm:[2,2,2,2] row_mask:0xf bank_mask:0xf
  v_mul_f32_dpp v30, v188, v30 quad_perm:[3,3,3,3] row_mask:0xf bank_mask:0xf
  v_mul_f32_dpp v31, v189, v31 quad_perm:[3,3,3,3] row_mask:0xf bank_mask:0xf
  v_mul_f32_dpp v32, v190, v32 quad_perm:[3,3,3,3] row_mask:0xf bank_mask:0xf
  v_mul_f32_dpp v33, v191, v33 quad_perm:[3,3,3,3] row_mask:0xf bank_mask:0xf
  v_cvt_pk_bf16_f32 v164, v26, v27
  v_lshlrev_b32 v26, 16, v164
  v_and_b32 v27, 0xffff0000, v164
  v_cvt_pk_bf16_f32 v165, v28, v29
  v_lshlrev_b32 v28, 16, v165
  v_and_b32 v29, 0xffff0000, v165
  v_cvt_pk_bf16_f32 v166, v30, v31
  v_lshlrev_b32 v30, 16, v166
  v_and_b32 v31, 0xffff0000, v166
  v_cvt_pk_bf16_f32 v167, v32, v33
  v_lshlrev_b32 v32, 16, v167
  v_and_b32 v33, 0xffff0000, v167
  v_add_f32_dpp v26, v188, v26 quad_perm:[0,0,0,0] row_mask:0xf bank_mask:0xf
  v_add_f32_dpp v27, v189, v27 quad_perm:[0,0,0,0] row_mask:0xf bank_mask:0xf
  v_add_f32_dpp v28, v190, v28 quad_perm:[0,0,0,0] row_mask:0xf bank_mask:0xf
  v_add_f32_dpp v29, v191, v29 quad_perm:[0,0,0,0] row_mask:0xf bank_mask:0xf
  v_add_f32_dpp v30, v188, v30 quad_perm:[1,1,1,1] row_mask:0xf bank_mask:0xf
  v_add_f32_dpp v31, v189, v31 quad_perm:[1,1,1,1] row_mask:0xf bank_mask:0xf
  v_add_f32_dpp v32, v190, v32 quad_perm:[1,1,1,1] row_mask:0xf bank_mask:0xf
  v_add_f32_dpp v33, v191, v33 quad_perm:[1,1,1,1] row_mask:0xf bank_mask:0xf
  v_cvt_pk_bf16_f32 v208, v26, v27
  v_cvt_pk_bf16_f32 v209, v28, v29
  v_cvt_pk_bf16_f32 v210, v30, v31
  v_cvt_pk_bf16_f32 v211, v32, v33
  s_add_u32 s35, s38, 12288
  buffer_store_dwordx4 v[208:211], v161, s[8:11], s35 offen
  v_lshlrev_b32 v34, 16, v136
  v_and_b32 v35, 0xffff0000, v136
  v_lshlrev_b32 v36, 16, v137
  v_and_b32 v37, 0xffff0000, v137
  v_lshlrev_b32 v38, 16, v138
  v_and_b32 v39, 0xffff0000, v138
  v_lshlrev_b32 v40, 16, v139
  v_and_b32 v41, 0xffff0000, v139
  v_mul_f32_dpp v34, v192, v34 quad_perm:[2,2,2,2] row_mask:0xf bank_mask:0xf
  v_mul_f32_dpp v35, v193, v35 quad_perm:[2,2,2,2] row_mask:0xf bank_mask:0xf
  v_mul_f32_dpp v36, v194, v36 quad_perm:[2,2,2,2] row_mask:0xf bank_mask:0xf
  v_mul_f32_dpp v37, v195, v37 quad_perm:[2,2,2,2] row_mask:0xf bank_mask:0xf
  v_mul_f32_dpp v38, v192, v38 quad_perm:[3,3,3,3] row_mask:0xf bank_mask:0xf
  v_mul_f32_dpp v39, v193, v39 quad_perm:[3,3,3,3] row_mask:0xf bank_mask:0xf
  v_mul_f32_dpp v40, v194, v40 quad_perm:[3,3,3,3] row_mask:0xf bank_mask:0xf
  v_mul_f32_dpp v41, v195, v41 quad_perm:[3,3,3,3] row_mask:0xf bank_mask:0xf
  v_cvt_pk_bf16_f32 v164, v34, v35
  v_lshlrev_b32 v34, 16, v164
  v_and_b32 v35, 0xffff0000, v164
  v_cvt_pk_bf16_f32 v165, v36, v37
  v_lshlrev_b32 v36, 16, v165
  v_and_b32 v37, 0xffff0000, v165
  v_cvt_pk_bf16_f32 v166, v38, v39
  v_lshlrev_b32 v38, 16, v166
  v_and_b32 v39, 0xffff0000, v166
  v_cvt_pk_bf16_f32 v167, v40, v41
  v_lshlrev_b32 v40, 16, v167
  v_and_b32 v41, 0xffff0000, v167
  v_add_f32_dpp v34, v192, v34 quad_perm:[0,0,0,0] row_mask:0xf bank_mask:0xf
  v_add_f32_dpp v35, v193, v35 quad_perm:[0,0,0,0] row_mask:0xf bank_mask:0xf
  v_add_f32_dpp v36, v194, v36 quad_perm:[0,0,0,0] row_mask:0xf bank_mask:0xf
  v_add_f32_dpp v37, v195, v37 quad_perm:[0,0,0,0] row_mask:0xf bank_mask:0xf
  v_add_f32_dpp v38, v192, v38 quad_perm:[1,1,1,1] row_mask:0xf bank_mask:0xf
  v_add_f32_dpp v39, v193, v39 quad_perm:[1,1,1,1] row_mask:0xf bank_mask:0xf
  v_add_f32_dpp v40, v194, v40 quad_perm:[1,1,1,1] row_mask:0xf bank_mask:0xf
  v_add_f32_dpp v41, v195, v41 quad_perm:[1,1,1,1] row_mask:0xf bank_mask:0xf
  v_cvt_pk_bf16_f32 v212, v34, v35
  v_cvt_pk_bf16_f32 v213, v36, v37
  v_cvt_pk_bf16_f32 v214, v38, v39
  v_cvt_pk_bf16_f32 v215, v40, v41
  s_add_u32 s35, s38, 16384
  buffer_store_dwordx4 v[212:215], v161, s[8:11], s35 offen
  s_add_u32 s36, s41, 24
  s_cmp_lt_u32 s41, 24
  s_cselect_b32 s36, s39, s36
  s_add_u32 s41, s41, 3
  s_cmp_lt_u32 s41, 24
  s_cselect_b32 s41, s41, s36
  s_min_u32 s41, s41, 127
  s_mul_i32 s38, s16, 2621440
  s_cmp_lt_u32 s41, 24
  s_cselect_b32 s38, s38, 0
  s_mul_i32 s36, s41, 20480
  s_add_u32 s38, s38, s36
  s_lshl_b32 s36, s17, 6
  s_add_u32 s38, s38, s36
  s_add_u32 s38, s38, 247463936
  s_add_u32 s33, s33, 3
  buffer_load_dwordx2 v[46:47], v160, s[20:23], s37 offen offset:0
  buffer_load_dwordx2 v[48:49], v160, s[20:23], s37 offen offset:32
  buffer_load_dwordx2 v[50:51], v160, s[20:23], s37 offen offset:256
  buffer_load_dwordx2 v[52:53], v160, s[20:23], s37 offen offset:288
  buffer_load_dwordx2 v[54:55], v160, s[20:23], s37 offen offset:512
  buffer_load_dwordx2 v[56:57], v160, s[20:23], s37 offen offset:544
  buffer_load_dwordx2 v[58:59], v160, s[20:23], s37 offen offset:768
  buffer_load_dwordx2 v[60:61], v160, s[20:23], s37 offen offset:800
  buffer_load_dwordx2 v[62:63], v160, s[20:23], s37 offen offset:1024
  buffer_load_dwordx2 v[64:65], v160, s[20:23], s37 offen offset:1056
  s_add_u32 s36, s40, 24
  s_cmp_lt_u32 s40, 24
  s_cselect_b32 s36, s39, s36
  s_add_u32 s40, s40, 3
  s_cmp_lt_u32 s40, 24
  s_cselect_b32 s40, s40, s36
  s_min_u32 s40, s40, 127
  s_mul_i32 s37, s40, 20480
  s_mul_i32 s36, s17, 5120
  s_add_u32 s37, s37, s36
  buffer_load_dwordx2 v[66:67], v160, s[20:23], s37 offen offset:0
  buffer_load_dwordx2 v[68:69], v160, s[20:23], s37 offen offset:32
  buffer_load_dwordx2 v[70:71], v160, s[20:23], s37 offen offset:256
  buffer_load_dwordx2 v[72:73], v160, s[20:23], s37 offen offset:288
  buffer_load_dwordx2 v[74:75], v160, s[20:23], s37 offen offset:512
  buffer_load_dwordx2 v[76:77], v160, s[20:23], s37 offen offset:544
  buffer_load_dwordx2 v[78:79], v160, s[20:23], s37 offen offset:768
  buffer_load_dwordx2 v[80:81], v160, s[20:23], s37 offen offset:800
  buffer_load_dwordx2 v[82:83], v160, s[20:23], s37 offen offset:1024
  buffer_load_dwordx2 v[84:85], v160, s[20:23], s37 offen offset:1056
  s_add_u32 s36, s40, 24
  s_cmp_lt_u32 s40, 24
  s_cselect_b32 s36, s39, s36
  s_add_u32 s40, s40, 3
  s_cmp_lt_u32 s40, 24
  s_cselect_b32 s40, s40, s36
  s_min_u32 s40, s40, 127
  s_mul_i32 s37, s40, 20480
  s_mul_i32 s36, s17, 5120
  s_add_u32 s37, s37, s36
  buffer_load_dwordx2 v[140:141], v160, s[20:23], s37 offen offset:0
  buffer_load_dwordx2 v[142:143], v160, s[20:23], s37 offen offset:32
  buffer_load_dwordx2 v[144:145], v160, s[20:23], s37 offen offset:256
  buffer_load_dwordx2 v[146:147], v160, s[20:23], s37 offen offset:288
  buffer_load_dwordx2 v[148:149], v160, s[20:23], s37 offen offset:512
  buffer_load_dwordx2 v[150:151], v160, s[20:23], s37 offen offset:544
  buffer_load_dwordx2 v[152:153], v160, s[20:23], s37 offen offset:768
  buffer_load_dwordx2 v[154:155], v160, s[20:23], s37 offen offset:800
  buffer_load_dwordx2 v[156:157], v160, s[20:23], s37 offen offset:1024
  buffer_load_dwordx2 v[158:159], v160, s[20:23], s37 offen offset:1056
  s_add_u32 s36, s40, 24
  s_cmp_lt_u32 s40, 24
  s_cselect_b32 s36, s39, s36
  s_add_u32 s40, s40, 3
  s_cmp_lt_u32 s40, 24
  s_cselect_b32 s40, s40, s36
  s_min_u32 s40, s40, 127
  s_mul_i32 s37, s40, 20480
  s_mul_i32 s36, s17, 5120
  s_add_u32 s37, s37, s36
  s_sub_u32 s36, s33, 0
  s_min_u32 s36, s36, 24
  v_mov_b32 v92, s36
  s_waitcnt vmcnt(30)
  buffer_store_dword v92, v228, s[8:11], 0 offen
  s_waitcnt vmcnt(21)
  v_lshlrev_b32 v2, 16, v46
  v_and_b32 v3, 0xffff0000, v46
  v_lshlrev_b32 v4, 16, v47
  v_and_b32 v5, 0xffff0000, v47
  v_lshlrev_b32 v6, 16, v48
  v_and_b32 v7, 0xffff0000, v48
  v_lshlrev_b32 v8, 16, v49
  v_and_b32 v9, 0xffff0000, v49
  v_lshlrev_b32 v10, 16, v50
  v_and_b32 v11, 0xffff0000, v50
  v_lshlrev_b32 v12, 16, v51
  v_and_b32 v13, 0xffff0000, v51
  v_lshlrev_b32 v14, 16, v52
  v_and_b32 v15, 0xffff0000, v52
  v_lshlrev_b32 v16, 16, v53
  v_and_b32 v17, 0xffff0000, v53
  v_lshlrev_b32 v18, 16, v54
  v_and_b32 v19, 0xffff0000, v54
  v_lshlrev_b32 v20, 16, v55
  v_and_b32 v21, 0xffff0000, v55
  v_lshlrev_b32 v22, 16, v56
  v_and_b32 v23, 0xffff0000, v56
  v_lshlrev_b32 v24, 16, v57
  v_and_b32 v25, 0xffff0000, v57
  v_lshlrev_b32 v26, 16, v58
  v_and_b32 v27, 0xffff0000, v58
  v_lshlrev_b32 v28, 16, v59
  v_and_b32 v29, 0xffff0000, v59
  v_lshlrev_b32 v30, 16, v60
  v_and_b32 v31, 0xffff0000, v60
  v_lshlrev_b32 v32, 16, v61
  v_and_b32 v33, 0xffff0000, v61
  v_lshlrev_b32 v34, 16, v62
  v_and_b32 v35, 0xffff0000, v62
  v_lshlrev_b32 v36, 16, v63
  v_and_b32 v37, 0xffff0000, v63
  v_lshlrev_b32 v38, 16, v64
  v_and_b32 v39, 0xffff0000, v64
  v_lshlrev_b32 v40, 16, v65
  v_and_b32 v41, 0xffff0000, v65
  v_pk_add_f32 v[86:87], v[2:3], v[4:5]
  v_pk_add_f32 v[88:89], v[6:7], v[8:9]
  v_pk_add_f32 v[86:87], v[86:87], v[10:11]
  v_pk_add_f32 v[88:89], v[88:89], v[12:13]
  v_pk_add_f32 v[86:87], v[86:87], v[14:15]
  v_pk_add_f32 v[88:89], v[88:89], v[16:17]
  v_pk_add_f32 v[86:87], v[86:87], v[18:19]
  v_pk_add_f32 v[88:89], v[88:89], v[20:21]
  v_pk_add_f32 v[86:87], v[86:87], v[22:23]
  v_pk_add_f32 v[88:89], v[88:89], v[24:25]
  v_pk_add_f32 v[86:87], v[86:87], v[26:27]
  v_pk_add_f32 v[88:89], v[88:89], v[28:29]
  v_pk_add_f32 v[86:87], v[86:87], v[30:31]
  v_pk_add_f32 v[88:89], v[88:89], v[32:33]
  v_pk_add_f32 v[86:87], v[86:87], v[34:35]
  v_pk_add_f32 v[88:89], v[88:89], v[36:37]
  v_pk_add_f32 v[86:87], v[86:87], v[38:39]
  v_pk_add_f32 v[88:89], v[88:89], v[40:41]
  v_pk_add_f32 v[86:87], v[86:87], v[88:89]
  v_add_f32 v86, v86, v87
  s_nop 1
  v_add_f32_dpp v86, v86, v86 row_ror:8 row_mask:0xf bank_mask:0xf
  s_nop 1
  v_add_f32_dpp v86, v86, v86 row_ror:4 row_mask:0xf bank_mask:0xf
  v_mov_b32 v90, v86
  s_nop 1
  v_permlane16_swap_b32 v86, v90
  v_add_f32 v86, v86, v90
  v_mov_b32 v90, v86
  s_nop 1
  v_permlane32_swap_b32 v86, v90
  v_add_f32 v86, v86, v90
  v_mul_f32 v88, 0xbacccccd, v86
  v_mul_f32 v89, 0xbacccccd, v86
  v_pk_add_f32 v[164:165], v[2:3], v[88:89]
  v_pk_add_f32 v[166:167], v[4:5], v[88:89]
  v_pk_mul_f32 v[170:171], v[164:165], v[164:165]
  v_pk_add_f32 v[168:169], v[6:7], v[88:89]
  v_pk_mul_f32 v[86:87], v[166:167], v[166:167]
  v_pk_add_f32 v[164:165], v[8:9], v[88:89]
  v_pk_fma_f32 v[170:171], v[168:169], v[168:169], v[170:171]
  v_pk_add_f32 v[166:167], v[10:11], v[88:89]
  v_pk_fma_f32 v[86:87], v[164:165], v[164:165], v[86:87]
  v_pk_add_f32 v[168:169], v[12:13], v[88:89]
  v_pk_fma_f32 v[170:171], v[166:167], v[166:167], v[170:171]
  v_pk_add_f32 v[164:165], v[14:15], v[88:89]
  v_pk_fma_f32 v[86:87], v[168:169], v[168:169], v[86:87]
  v_pk_add_f32 v[166:167], v[16:17], v[88:89]
  v_pk_fma_f32 v[170:171], v[164:165], v[164:165], v[170:171]
  v_pk_add_f32 v[168:169], v[18:19], v[88:89]
  v_pk_fma_f32 v[86:87], v[166:167], v[166:167], v[86:87]
  v_pk_add_f32 v[164:165], v[20:21], v[88:89]
  v_pk_fma_f32 v[170:171], v[168:169], v[168:169], v[170:171]
  v_pk_add_f32 v[166:167], v[22:23], v[88:89]
  v_pk_fma_f32 v[86:87], v[164:165], v[164:165], v[86:87]
  v_pk_add_f32 v[168:169], v[24:25], v[88:89]
  v_pk_fma_f32 v[170:171], v[166:167], v[166:167], v[170:171]
  v_pk_add_f32 v[164:165], v[26:27], v[88:89]
  v_pk_fma_f32 v[86:87], v[168:169], v[168:169], v[86:87]
  v_pk_add_f32 v[166:167], v[28:29], v[88:89]
  v_pk_fma_f32 v[170:171], v[164:165], v[164:165], v[170:171]
  v_pk_add_f32 v[168:169], v[30:31], v[88:89]
  v_pk_fma_f32 v[86:87], v[166:167], v[166:167], v[86:87]
  v_pk_add_f32 v[164:165], v[32:33], v[88:89]
  v_pk_fma_f32 v[170:171], v[168:169], v[168:169], v[170:171]
  v_pk_add_f32 v[166:167], v[34:35], v[88:89]
  v_pk_fma_f32 v[86:87], v[164:165], v[164:165], v[86:87]
  v_pk_add_f32 v[168:169], v[36:37], v[88:89]
  v_pk_fma_f32 v[170:171], v[166:167], v[166:167], v[170:171]
  v_pk_add_f32 v[164:165], v[38:39], v[88:89]
  v_pk_fma_f32 v[86:87], v[168:169], v[168:169], v[86:87]
  v_pk_add_f32 v[166:167], v[40:41], v[88:89]
  v_pk_fma_f32 v[170:171], v[164:165], v[164:165], v[170:171]
  v_pk_fma_f32 v[86:87], v[166:167], v[166:167], v[86:87]
  v_cvt_pk_bf16_f32 v91, v88, v89
  v_lshlrev_b32 v88, 16, v91
  v_and_b32 v89, 0xffff0000, v91
  v_pk_add_f32 v[86:87], v[86:87], v[170:171]
  v_add_f32 v86, v86, v87
  s_nop 1
  v_add_f32_dpp v86, v86, v86 row_ror:8 row_mask:0xf bank_mask:0xf
  s_nop 1
  v_add_f32_dpp v86, v86, v86 row_ror:4 row_mask:0xf bank_mask:0xf
  v_mov_b32 v90, v86
  s_nop 1
  v_permlane16_swap_b32 v86, v90
  v_add_f32 v86, v86, v90
  v_mov_b32 v90, v86
  s_nop 1
  v_permlane32_swap_b32 v86, v90
  v_add_f32 v86, v86, v90
  v_pk_add_f32 v[2:3], v[2:3], v[88:89]
  v_mul_f32 v86, 0x3acccccd, v86
  v_pk_add_f32 v[4:5], v[4:5], v[88:89]
  v_cvt_pk_bf16_f32 v86, v86, v86
  v_pk_add_f32 v[6:7], v[6:7], v[88:89]
  v_lshlrev_b32 v86, 16, v86
  v_pk_add_f32 v[8:9], v[8:9], v[88:89]
  v_add_f32 v86, 0x3727c5ac, v86
  v_pk_add_f32 v[10:11], v[10:11], v[88:89]
  v_cvt_pk_bf16_f32 v86, v86, v86
  v_pk_add_f32 v[12:13], v[12:13], v[88:89]
  v_lshlrev_b32 v86, 16, v86
  v_pk_add_f32 v[14:15], v[14:15], v[88:89]
  v_sqrt_f32 v86, v86
  v_pk_add_f32 v[16:17], v[16:17], v[88:89]
  v_cvt_pk_bf16_f32 v86, v86, v86
  v_pk_add_f32 v[18:19], v[18:19], v[88:89]
  v_lshlrev_b32 v86, 16, v86
  v_pk_add_f32 v[20:21], v[20:21], v[88:89]
  v_rcp_f32 v86, v86
  v_pk_add_f32 v[22:23], v[22:23], v[88:89]
  v_mov_b32 v87, v86
  v_pk_add_f32 v[24:25], v[24:25], v[88:89]
  v_pk_add_f32 v[26:27], v[26:27], v[88:89]
  v_pk_add_f32 v[28:29], v[28:29], v[88:89]
  v_pk_add_f32 v[30:31], v[30:31], v[88:89]
  v_pk_add_f32 v[32:33], v[32:33], v[88:89]
  v_pk_add_f32 v[34:35], v[34:35], v[88:89]
  v_pk_add_f32 v[36:37], v[36:37], v[88:89]
  v_pk_add_f32 v[38:39], v[38:39], v[88:89]
  v_pk_add_f32 v[40:41], v[40:41], v[88:89]
  v_cvt_pk_bf16_f32 v164, v2, v3
  v_lshlrev_b32 v2, 16, v164
  v_and_b32 v3, 0xffff0000, v164
  v_cvt_pk_bf16_f32 v165, v4, v5
  v_lshlrev_b32 v4, 16, v165
  v_and_b32 v5, 0xffff0000, v165
  v_cvt_pk_bf16_f32 v166, v6, v7
  v_lshlrev_b32 v6, 16, v166
  v_and_b32 v7, 0xffff0000, v166
  v_cvt_pk_bf16_f32 v167, v8, v9
  v_lshlrev_b32 v8, 16, v167
  v_and_b32 v9, 0xffff0000, v167
  v_cvt_pk_bf16_f32 v164, v10, v11
  v_lshlrev_b32 v10, 16, v164
  v_and_b32 v11, 0xffff0000, v164
  v_cvt_pk_bf16_f32 v165, v12, v13
  v_lshlrev_b32 v12, 16, v165
  v_and_b32 v13, 0xffff0000, v165
  v_cvt_pk_bf16_f32 v166, v14, v15
  v_lshlrev_b32 v14, 16, v166
  v_and_b32 v15, 0xffff0000, v166
  v_cvt_pk_bf16_f32 v167, v16, v17
  v_lshlrev_b32 v16, 16, v167
  v_and_b32 v17, 0xffff0000, v167
  v_cvt_pk_bf16_f32 v164, v18, v19
  v_lshlrev_b32 v18, 16, v164
  v_and_b32 v19, 0xffff0000, v164
  v_cvt_pk_bf16_f32 v165, v20, v21
  v_lshlrev_b32 v20, 16, v165
  v_and_b32 v21, 0xffff0000, v165
  v_cvt_pk_bf16_f32 v166, v22, v23
  v_lshlrev_b32 v22, 16, v166
  v_and_b32 v23, 0xffff0000, v166
  v_cvt_pk_bf16_f32 v167, v24, v25
  v_lshlrev_b32 v24, 16, v167
  v_and_b32 v25, 0xffff0000, v167
  v_cvt_pk_bf16_f32 v164, v26, v27
  v_lshlrev_b32 v26, 16, v164
  v_and_b32 v27, 0xffff0000, v164
  v_cvt_pk_bf16_f32 v165, v28, v29
  v_lshlrev_b32 v28, 16, v165
  v_and_b32 v29, 0xffff0000, v165
  v_cvt_pk_bf16_f32 v166, v30, v31
  v_lshlrev_b32 v30, 16, v166
  v_and_b32 v31, 0xffff0000, v166
  v_cvt_pk_bf16_f32 v167, v32, v33
  v_lshlrev_b32 v32, 16, v167
  v_and_b32 v33, 0xffff0000, v167
  v_cvt_pk_bf16_f32 v164, v34, v35
  v_lshlrev_b32 v34, 16, v164
  v_and_b32 v35, 0xffff0000, v164
  v_cvt_pk_bf16_f32 v165, v36, v37
  v_lshlrev_b32 v36, 16, v165
  v_and_b32 v37, 0xffff0000, v165
  v_cvt_pk_bf16_f32 v166, v38, v39
  v_lshlrev_b32 v38, 16, v166
  v_and_b32 v39, 0xffff0000, v166
  v_cvt_pk_bf16_f32 v167, v40, v41
  v_lshlrev_b32 v40, 16, v167
  v_and_b32 v41, 0xffff0000, v167
  s_sub_u32 s36, s33, 0
  s_min_u32 s36, s36, 24
  v_mov_b32 v92, s36
  s_waitcnt vmcnt(11)
  buffer_store_dword v92, v228, s[8:11], 0 offen
  v_pk_mul_f32 v[2:3], v[2:3], v[86:87]
  v_pk_mul_f32 v[4:5], v[4:5], v[86:87]
  v_pk_mul_f32 v[6:7], v[6:7], v[86:87]
  v_pk_mul_f32 v[8:9], v[8:9], v[86:87]
  v_pk_mul_f32 v[10:11], v[10:11], v[86:87]
  v_pk_mul_f32 v[12:13], v[12:13], v[86:87]
  v_pk_mul_f32 v[14:15], v[14:15], v[86:87]
  v_pk_mul_f32 v[16:17], v[16:17], v[86:87]
  v_pk_mul_f32 v[18:19], v[18:19], v[86:87]
  v_pk_mul_f32 v[20:21], v[20:21], v[86:87]
  v_pk_mul_f32 v[22:23], v[22:23], v[86:87]
  v_pk_mul_f32 v[24:25], v[24:25], v[86:87]
  v_pk_mul_f32 v[26:27], v[26:27], v[86:87]
  v_pk_mul_f32 v[28:29], v[28:29], v[86:87]
  v_pk_mul_f32 v[30:31], v[30:31], v[86:87]
  v_pk_mul_f32 v[32:33], v[32:33], v[86:87]
  v_pk_mul_f32 v[34:35], v[34:35], v[86:87]
  v_pk_mul_f32 v[36:37], v[36:37], v[86:87]
  v_pk_mul_f32 v[38:39], v[38:39], v[86:87]
  v_pk_mul_f32 v[40:41], v[40:41], v[86:87]
  v_cvt_pk_bf16_f32 v164, v2, v3
  v_lshlrev_b32 v2, 16, v164
  v_and_b32 v3, 0xffff0000, v164
  v_cvt_pk_bf16_f32 v165, v4, v5
  v_lshlrev_b32 v4, 16, v165
  v_and_b32 v5, 0xffff0000, v165
  v_cvt_pk_bf16_f32 v166, v6, v7
  v_lshlrev_b32 v6, 16, v166
  v_and_b32 v7, 0xffff0000, v166
  v_cvt_pk_bf16_f32 v167, v8, v9
  v_lshlrev_b32 v8, 16, v167
  v_and_b32 v9, 0xffff0000, v167
  v_cvt_pk_bf16_f32 v164, v10, v11
  v_lshlrev_b32 v10, 16, v164
  v_and_b32 v11, 0xffff0000, v164
  v_cvt_pk_bf16_f32 v165, v12, v13
  v_lshlrev_b32 v12, 16, v165
  v_and_b32 v13, 0xffff0000, v165
  v_cvt_pk_bf16_f32 v166, v14, v15
  v_lshlrev_b32 v14, 16, v166
  v_and_b32 v15, 0xffff0000, v166
  v_cvt_pk_bf16_f32 v167, v16, v17
  v_lshlrev_b32 v16, 16, v167
  v_and_b32 v17, 0xffff0000, v167
  v_cvt_pk_bf16_f32 v164, v18, v19
  v_lshlrev_b32 v18, 16, v164
  v_and_b32 v19, 0xffff0000, v164
  v_cvt_pk_bf16_f32 v165, v20, v21
  v_lshlrev_b32 v20, 16, v165
  v_and_b32 v21, 0xffff0000, v165
  v_cvt_pk_bf16_f32 v166, v22, v23
  v_lshlrev_b32 v22, 16, v166
  v_and_b32 v23, 0xffff0000, v166
  v_cvt_pk_bf16_f32 v167, v24, v25
  v_lshlrev_b32 v24, 16, v167
  v_and_b32 v25, 0xffff0000, v167
  v_cvt_pk_bf16_f32 v164, v26, v27
  v_lshlrev_b32 v26, 16, v164
  v_and_b32 v27, 0xffff0000, v164
  v_cvt_pk_bf16_f32 v165, v28, v29
  v_lshlrev_b32 v28, 16, v165
  v_and_b32 v29, 0xffff0000, v165
  v_cvt_pk_bf16_f32 v166, v30, v31
  v_lshlrev_b32 v30, 16, v166
  v_and_b32 v31, 0xffff0000, v166
  v_cvt_pk_bf16_f32 v167, v32, v33
  v_lshlrev_b32 v32, 16, v167
  v_and_b32 v33, 0xffff0000, v167
  v_cvt_pk_bf16_f32 v164, v34, v35
  v_lshlrev_b32 v34, 16, v164
  v_and_b32 v35, 0xffff0000, v164
  v_cvt_pk_bf16_f32 v165, v36, v37
  v_lshlrev_b32 v36, 16, v165
  v_and_b32 v37, 0xffff0000, v165
  v_cvt_pk_bf16_f32 v166, v38, v39
  v_lshlrev_b32 v38, 16, v166
  v_and_b32 v39, 0xffff0000, v166
  v_cvt_pk_bf16_f32 v167, v40, v41
  v_lshlrev_b32 v40, 16, v167
  v_and_b32 v41, 0xffff0000, v167
  v_mul_f32_dpp v2, v176, v2 quad_perm:[2,2,2,2] row_mask:0xf bank_mask:0xf
  v_mul_f32_dpp v3, v177, v3 quad_perm:[2,2,2,2] row_mask:0xf bank_mask:0xf
  v_mul_f32_dpp v4, v178, v4 quad_perm:[2,2,2,2] row_mask:0xf bank_mask:0xf
  v_mul_f32_dpp v5, v179, v5 quad_perm:[2,2,2,2] row_mask:0xf bank_mask:0xf
  v_mul_f32_dpp v6, v176, v6 quad_perm:[3,3,3,3] row_mask:0xf bank_mask:0xf
  v_mul_f32_dpp v7, v177, v7 quad_perm:[3,3,3,3] row_mask:0xf bank_mask:0xf
  v_mul_f32_dpp v8, v178, v8 quad_perm:[3,3,3,3] row_mask:0xf bank_mask:0xf
  v_mul_f32_dpp v9, v179, v9 quad_perm:[3,3,3,3] row_mask:0xf bank_mask:0xf
  v_cvt_pk_bf16_f32 v164, v2, v3
  v_lshlrev_b32 v2, 16, v164
  v_and_b32 v3, 0xffff0000, v164
  v_cvt_pk_bf16_f32 v165, v4, v5
  v_lshlrev_b32 v4, 16, v165
  v_and_b32 v5, 0xffff0000, v165
  v_cvt_pk_bf16_f32 v166, v6, v7
  v_lshlrev_b32 v6, 16, v166
  v_and_b32 v7, 0xffff0000, v166
  v_cvt_pk_bf16_f32 v167, v8, v9
  v_lshlrev_b32 v8, 16, v167
  v_and_b32 v9, 0xffff0000, v167
  v_add_f32_dpp v2, v176, v2 quad_perm:[0,0,0,0] row_mask:0xf bank_mask:0xf
  v_add_f32_dpp v3, v177, v3 quad_perm:[0,0,0,0] row_mask:0xf bank_mask:0xf
  v_add_f32_dpp v4, v178, v4 quad_perm:[0,0,0,0] row_mask:0xf bank_mask:0xf
  v_add_f32_dpp v5, v179, v5 quad_perm:[0,0,0,0] row_mask:0xf bank_mask:0xf
  v_add_f32_dpp v6, v176, v6 quad_perm:[1,1,1,1] row_mask:0xf bank_mask:0xf
  v_add_f32_dpp v7, v177, v7 quad_perm:[1,1,1,1] row_mask:0xf bank_mask:0xf
  v_add_f32_dpp v8, v178, v8 quad_perm:[1,1,1,1] row_mask:0xf bank_mask:0xf
  v_add_f32_dpp v9, v179, v9 quad_perm:[1,1,1,1] row_mask:0xf bank_mask:0xf
  v_cvt_pk_bf16_f32 v196, v2, v3
  v_cvt_pk_bf16_f32 v197, v4, v5
  v_cvt_pk_bf16_f32 v198, v6, v7
  v_cvt_pk_bf16_f32 v199, v8, v9
  s_add_u32 s35, s38, 0
  buffer_store_dwordx4 v[196:199], v161, s[8:11], s35 offen sc1
  v_mul_f32_dpp v10, v180, v10 quad_perm:[2,2,2,2] row_mask:0xf bank_mask:0xf
  v_mul_f32_dpp v11, v181, v11 quad_perm:[2,2,2,2] row_mask:0xf bank_mask:0xf
  v_mul_f32_dpp v12, v182, v12 quad_perm:[2,2,2,2] row_mask:0xf bank_mask:0xf
  v_mul_f32_dpp v13, v183, v13 quad_perm:[2,2,2,2] row_mask:0xf bank_mask:0xf
  v_mul_f32_dpp v14, v180, v14 quad_perm:[3,3,3,3] row_mask:0xf bank_mask:0xf
  v_mul_f32_dpp v15, v181, v15 quad_perm:[3,3,3,3] row_mask:0xf bank_mask:0xf
  v_mul_f32_dpp v16, v182, v16 quad_perm:[3,3,3,3] row_mask:0xf bank_mask:0xf
  v_mul_f32_dpp v17, v183, v17 quad_perm:[3,3,3,3] row_mask:0xf bank_mask:0xf
  v_cvt_pk_bf16_f32 v164, v10, v11
  v_lshlrev_b32 v10, 16, v164
  v_and_b32 v11, 0xffff0000, v164
  v_cvt_pk_bf16_f32 v165, v12, v13
  v_lshlrev_b32 v12, 16, v165
  v_and_b32 v13, 0xffff0000, v165
  v_cvt_pk_bf16_f32 v166, v14, v15
  v_lshlrev_b32 v14, 16, v166
  v_and_b32 v15, 0xffff0000, v166
  v_cvt_pk_bf16_f32 v167, v16, v17
  v_lshlrev_b32 v16, 16, v167
  v_and_b32 v17, 0xffff0000, v167
  v_add_f32_dpp v10, v180, v10 quad_perm:[0,0,0,0] row_mask:0xf bank_mask:0xf
  v_add_f32_dpp v11, v181, v11 quad_perm:[0,0,0,0] row_mask:0xf bank_mask:0xf
  v_add_f32_dpp v12, v182, v12 quad_perm:[0,0,0,0] row_mask:0xf bank_mask:0xf
  v_add_f32_dpp v13, v183, v13 quad_perm:[0,0,0,0] row_mask:0xf bank_mask:0xf
  v_add_f32_dpp v14, v180, v14 quad_perm:[1,1,1,1] row_mask:0xf bank_mask:0xf
  v_add_f32_dpp v15, v181, v15 quad_perm:[1,1,1,1] row_mask:0xf bank_mask:0xf
  v_add_f32_dpp v16, v182, v16 quad_perm:[1,1,1,1] row_mask:0xf bank_mask:0xf
  v_add_f32_dpp v17, v183, v17 quad_perm:[1,1,1,1] row_mask:0xf bank_mask:0xf
  v_cvt_pk_bf16_f32 v200, v10, v11
  v_cvt_pk_bf16_f32 v201, v12, v13
  v_cvt_pk_bf16_f32 v202, v14, v15
  v_cvt_pk_bf16_f32 v203, v16, v17
  s_add_u32 s35, s38, 4096
  buffer_store_dwordx4 v[200:203], v161, s[8:11], s35 offen sc1
  v_mul_f32_dpp v18, v184, v18 quad_perm:[2,2,2,2] row_mask:0xf bank_mask:0xf
  v_mul_f32_dpp v19, v185, v19 quad_perm:[2,2,2,2] row_mask:0xf bank_mask:0xf
  v_mul_f32_dpp v20, v186, v20 quad_perm:[2,2,2,2] row_mask:0xf bank_mask:0xf
  v_mul_f32_dpp v21, v187, v21 quad_perm:[2,2,2,2] row_mask:0xf bank_mask:0xf
  v_mul_f32_dpp v22, v184, v22 quad_perm:[3,3,3,3] row_mask:0xf bank_mask:0xf
  v_mul_f32_dpp v23, v185, v23 quad_perm:[3,3,3,3] row_mask:0xf bank_mask:0xf
  v_mul_f32_dpp v24, v186, v24 quad_perm:[3,3,3,3] row_mask:0xf bank_mask:0xf
  v_mul_f32_dpp v25, v187, v25 quad_perm:[3,3,3,3] row_mask:0xf bank_mask:0xf
  v_cvt_pk_bf16_f32 v164, v18, v19
  v_lshlrev_b32 v18, 16, v164
  v_and_b32 v19, 0xffff0000, v164
  v_cvt_pk_bf16_f32 v165, v20, v21
  v_lshlrev_b32 v20, 16, v165
  v_and_b32 v21, 0xffff0000, v165
  v_cvt_pk_bf16_f32 v166, v22, v23
  v_lshlrev_b32 v22, 16, v166
  v_and_b32 v23, 0xffff0000, v166
  v_cvt_pk_bf16_f32 v167, v24, v25
  v_lshlrev_b32 v24, 16, v167
  v_and_b32 v25, 0xffff0000, v167
  v_add_f32_dpp v18, v184, v18 quad_perm:[0,0,0,0] row_mask:0xf bank_mask:0xf
  v_add_f32_dpp v19, v185, v19 quad_perm:[0,0,0,0] row_mask:0xf bank_mask:0xf
  v_add_f32_dpp v20, v186, v20 quad_perm:[0,0,0,0] row_mask:0xf bank_mask:0xf
  v_add_f32_dpp v21, v187, v21 quad_perm:[0,0,0,0] row_mask:0xf bank_mask:0xf
  v_add_f32_dpp v22, v184, v22 quad_perm:[1,1,1,1] row_mask:0xf bank_mask:0xf
  v_add_f32_dpp v23, v185, v23 quad_perm:[1,1,1,1] row_mask:0xf bank_mask:0xf
  v_add_f32_dpp v24, v186, v24 quad_perm:[1,1,1,1] row_mask:0xf bank_mask:0xf
  v_add_f32_dpp v25, v187, v25 quad_perm:[1,1,1,1] row_mask:0xf bank_mask:0xf
  v_cvt_pk_bf16_f32 v204, v18, v19
  v_cvt_pk_bf16_f32 v205, v20, v21
  v_cvt_pk_bf16_f32 v206, v22, v23
  v_cvt_pk_bf16_f32 v207, v24, v25
  s_add_u32 s35, s38, 8192
  buffer_store_dwordx4 v[204:207], v161, s[8:11], s35 offen sc1
  v_mul_f32_dpp v26, v188, v26 quad_perm:[2,2,2,2] row_mask:0xf bank_mask:0xf
  v_mul_f32_dpp v27, v189, v27 quad_perm:[2,2,2,2] row_mask:0xf bank_mask:0xf
  v_mul_f32_dpp v28, v190, v28 quad_perm:[2,2,2,2] row_mask:0xf bank_mask:0xf
  v_mul_f32_dpp v29, v191, v29 quad_perm:[2,2,2,2] row_mask:0xf bank_mask:0xf
  v_mul_f32_dpp v30, v188, v30 quad_perm:[3,3,3,3] row_mask:0xf bank_mask:0xf
  v_mul_f32_dpp v31, v189, v31 quad_perm:[3,3,3,3] row_mask:0xf bank_mask:0xf
  v_mul_f32_dpp v32, v190, v32 quad_perm:[3,3,3,3] row_mask:0xf bank_mask:0xf
  v_mul_f32_dpp v33, v191, v33 quad_perm:[3,3,3,3] row_mask:0xf bank_mask:0xf
  v_cvt_pk_bf16_f32 v164, v26, v27
  v_lshlrev_b32 v26, 16, v164
  v_and_b32 v27, 0xffff0000, v164
  v_cvt_pk_bf16_f32 v165, v28, v29
  v_lshlrev_b32 v28, 16, v165
  v_and_b32 v29, 0xffff0000, v165
  v_cvt_pk_bf16_f32 v166, v30, v31
  v_lshlrev_b32 v30, 16, v166
  v_and_b32 v31, 0xffff0000, v166
  v_cvt_pk_bf16_f32 v167, v32, v33
  v_lshlrev_b32 v32, 16, v167
  v_and_b32 v33, 0xffff0000, v167
  v_add_f32_dpp v26, v188, v26 quad_perm:[0,0,0,0] row_mask:0xf bank_mask:0xf
  v_add_f32_dpp v27, v189, v27 quad_perm:[0,0,0,0] row_mask:0xf bank_mask:0xf
  v_add_f32_dpp v28, v190, v28 quad_perm:[0,0,0,0] row_mask:0xf bank_mask:0xf
  v_add_f32_dpp v29, v191, v29 quad_perm:[0,0,0,0] row_mask:0xf bank_mask:0xf
  v_add_f32_dpp v30, v188, v30 quad_perm:[1,1,1,1] row_mask:0xf bank_mask:0xf
  v_add_f32_dpp v31, v189, v31 quad_perm:[1,1,1,1] row_mask:0xf bank_mask:0xf
  v_add_f32_dpp v32, v190, v32 quad_perm:[1,1,1,1] row_mask:0xf bank_mask:0xf
  v_add_f32_dpp v33, v191, v33 quad_perm:[1,1,1,1] row_mask:0xf bank_mask:0xf
  v_cvt_pk_bf16_f32 v208, v26, v27
  v_cvt_pk_bf16_f32 v209, v28, v29
  v_cvt_pk_bf16_f32 v210, v30, v31
  v_cvt_pk_bf16_f32 v211, v32, v33
  s_add_u32 s35, s38, 12288
  buffer_store_dwordx4 v[208:211], v161, s[8:11], s35 offen sc1
  v_mul_f32_dpp v34, v192, v34 quad_perm:[2,2,2,2] row_mask:0xf bank_mask:0xf
  v_mul_f32_dpp v35, v193, v35 quad_perm:[2,2,2,2] row_mask:0xf bank_mask:0xf
  v_mul_f32_dpp v36, v194, v36 quad_perm:[2,2,2,2] row_mask:0xf bank_mask:0xf
  v_mul_f32_dpp v37, v195, v37 quad_perm:[2,2,2,2] row_mask:0xf bank_mask:0xf
  v_mul_f32_dpp v38, v192, v38 quad_perm:[3,3,3,3] row_mask:0xf bank_mask:0xf
  v_mul_f32_dpp v39, v193, v39 quad_perm:[3,3,3,3] row_mask:0xf bank_mask:0xf
  v_mul_f32_dpp v40, v194, v40 quad_perm:[3,3,3,3] row_mask:0xf bank_mask:0xf
  v_mul_f32_dpp v41, v195, v41 quad_perm:[3,3,3,3] row_mask:0xf bank_mask:0xf
  v_cvt_pk_bf16_f32 v164, v34, v35
  v_lshlrev_b32 v34, 16, v164
  v_and_b32 v35, 0xffff0000, v164
  v_cvt_pk_bf16_f32 v165, v36, v37
  v_lshlrev_b32 v36, 16, v165
  v_and_b32 v37, 0xffff0000, v165
  v_cvt_pk_bf16_f32 v166, v38, v39
  v_lshlrev_b32 v38, 16, v166
  v_and_b32 v39, 0xffff0000, v166
  v_cvt_pk_bf16_f32 v167, v40, v41
  v_lshlrev_b32 v40, 16, v167
  v_and_b32 v41, 0xffff0000, v167
  v_add_f32_dpp v34, v192, v34 quad_perm:[0,0,0,0] row_mask:0xf bank_mask:0xf
  v_add_f32_dpp v35, v193, v35 quad_perm:[0,0,0,0] row_mask:0xf bank_mask:0xf
  v_add_f32_dpp v36, v194, v36 quad_perm:[0,0,0,0] row_mask:0xf bank_mask:0xf
  v_add_f32_dpp v37, v195, v37 quad_perm:[0,0,0,0] row_mask:0xf bank_mask:0xf
  v_add_f32_dpp v38, v192, v38 quad_perm:[1,1,1,1] row_mask:0xf bank_mask:0xf
  v_add_f32_dpp v39, v193, v39 quad_perm:[1,1,1,1] row_mask:0xf bank_mask:0xf
  v_add_f32_dpp v40, v194, v40 quad_perm:[1,1,1,1] row_mask:0xf bank_mask:0xf
  v_add_f32_dpp v41, v195, v41 quad_perm:[1,1,1,1] row_mask:0xf bank_mask:0xf
  v_cvt_pk_bf16_f32 v212, v34, v35
  v_cvt_pk_bf16_f32 v213, v36, v37
  v_cvt_pk_bf16_f32 v214, v38, v39
  v_cvt_pk_bf16_f32 v215, v40, v41
  s_add_u32 s35, s38, 16384
  buffer_store_dwordx4 v[212:215], v161, s[8:11], s35 offen sc1
  s_add_u32 s36, s41, 24
  s_cmp_lt_u32 s41, 24
  s_cselect_b32 s36, s39, s36
  s_add_u32 s41, s41, 3
  s_cmp_lt_u32 s41, 24
  s_cselect_b32 s41, s41, s36
  s_min_u32 s41, s41, 127
  s_mul_i32 s38, s16, 2621440
  s_cmp_lt_u32 s41, 24
  s_cselect_b32 s38, s38, 0
  s_mul_i32 s36, s41, 20480
  s_add_u32 s38, s38, s36
  s_lshl_b32 s36, s17, 6
  s_add_u32 s38, s38, s36
  s_add_u32 s38, s38, 247463936
  s_add_u32 s33, s33, 3
  buffer_load_dwordx2 v[46:47], v160, s[20:23], s37 offen offset:0
  buffer_load_dwordx2 v[48:49], v160, s[20:23], s37 offen offset:32
  buffer_load_dwordx2 v[50:51], v160, s[20:23], s37 offen offset:256
  buffer_load_dwordx2 v[52:53], v160, s[20:23], s37 offen offset:288
  buffer_load_dwordx2 v[54:55], v160, s[20:23], s37 offen offset:512
  buffer_load_dwordx2 v[56:57], v160, s[20:23], s37 offen offset:544
  buffer_load_dwordx2 v[58:59], v160, s[20:23], s37 offen offset:768
  buffer_load_dwordx2 v[60:61], v160, s[20:23], s37 offen offset:800
  buffer_load_dwordx2 v[62:63], v160, s[20:23], s37 offen offset:1024
  buffer_load_dwordx2 v[64:65], v160, s[20:23], s37 offen offset:1056
  s_add_u32 s36, s40, 24
  s_cmp_lt_u32 s40, 24
  s_cselect_b32 s36, s39, s36
  s_add_u32 s40, s40, 3
  s_cmp_lt_u32 s40, 24
  s_cselect_b32 s40, s40, s36
  s_min_u32 s40, s40, 127
  s_mul_i32 s37, s40, 20480
  s_mul_i32 s36, s17, 5120
  s_add_u32 s37, s37, s36
  s_cmp_lt_u32 s33, 39
r_ln1:
  v_lshlrev_b32 v2, 16, v66
  v_and_b32 v3, 0xffff0000, v66
  v_lshlrev_b32 v4, 16, v67
  v_and_b32 v5, 0xffff0000, v67
  v_lshlrev_b32 v6, 16, v68
  v_and_b32 v7, 0xffff0000, v68
  v_lshlrev_b32 v8, 16, v69
  v_and_b32 v9, 0xffff0000, v69
  v_lshlrev_b32 v10, 16, v70
  v_and_b32 v11, 0xffff0000, v70
  v_lshlrev_b32 v12, 16, v71
  v_and_b32 v13, 0xffff0000, v71
  v_lshlrev_b32 v14, 16, v72
  v_and_b32 v15, 0xffff0000, v72
  v_lshlrev_b32 v16, 16, v73
  v_and_b32 v17, 0xffff0000, v73
  v_lshlrev_b32 v18, 16, v74
  v_and_b32 v19, 0xffff0000, v74
  v_lshlrev_b32 v20, 16, v75
  v_and_b32 v21, 0xffff0000, v75
  v_lshlrev_b32 v22, 16, v76
  v_and_b32 v23, 0xffff0000, v76
  v_lshlrev_b32 v24, 16, v77
  v_and_b32 v25, 0xffff0000, v77
  v_lshlrev_b32 v26, 16, v78
  v_and_b32 v27, 0xffff0000, v78
  v_lshlrev_b32 v28, 16, v79
  v_and_b32 v29, 0xffff0000, v79
  v_lshlrev_b32 v30, 16, v80
  v_and_b32 v31, 0xffff0000, v80
  v_lshlrev_b32 v32, 16, v81
  v_and_b32 v33, 0xffff0000, v81
  v_lshlrev_b32 v34, 16, v82
  v_and_b32 v35, 0xffff0000, v82
  v_lshlrev_b32 v36, 16, v83
  v_and_b32 v37, 0xffff0000, v83
  v_lshlrev_b32 v38, 16, v84
  v_and_b32 v39, 0xffff0000, v84
  v_lshlrev_b32 v40, 16, v85
  v_and_b32 v41, 0xffff0000, v85
  v_pk_add_f32 v[86:87], v[2:3], v[4:5]
  v_pk_add_f32 v[88:89], v[6:7], v[8:9]
  v_pk_add_f32 v[86:87], v[86:87], v[10:11]
  v_pk_add_f32 v[88:89], v[88:89], v[12:13]
  v_pk_add_f32 v[86:87], v[86:87], v[14:15]
  v_pk_add_f32 v[88:89], v[88:89], v[16:17]
  v_pk_add_f32 v[86:87], v[86:87], v[18:19]
  v_pk_add_f32 v[88:89], v[88:89], v[20:21]
  v_pk_add_f32 v[86:87], v[86:87], v[22:23]
  v_pk_add_f32 v[88:89], v[88:89], v[24:25]
  v_pk_add_f32 v[86:87], v[86:87], v[26:27]
  v_pk_add_f32 v[88:89], v[88:89], v[28:29]
  v_pk_add_f32 v[86:87], v[86:87], v[30:31]
  v_pk_add_f32 v[88:89], v[88:89], v[32:33]
  v_pk_add_f32 v[86:87], v[86:87], v[34:35]
  v_pk_add_f32 v[88:89], v[88:89], v[36:37]
  v_pk_add_f32 v[86:87], v[86:87], v[38:39]
  v_pk_add_f32 v[88:89], v[88:89], v[40:41]
  v_pk_add_f32 v[86:87], v[86:87], v[88:89]
  v_add_f32 v86, v86, v87
  s_nop 1
  v_add_f32_dpp v86, v86, v86 row_ror:8 row_mask:0xf bank_mask:0xf
  s_nop 1
  v_add_f32_dpp v86, v86, v86 row_ror:4 row_mask:0xf bank_mask:0xf
  v_mov_b32 v90, v86
  s_nop 1
  v_permlane16_swap_b32 v86, v90
  v_add_f32 v86, v86, v90
  v_mov_b32 v90, v86
  s_nop 1
  v_permlane32_swap_b32 v86, v90
  v_add_f32 v86, v86, v90
  v_mul_f32 v88, 0xbacccccd, v86
  v_mul_f32 v89, 0xbacccccd, v86
  v_pk_add_f32 v[164:165], v[2:3], v[88:89]
  v_pk_add_f32 v[166:167], v[4:5], v[88:89]
  v_pk_mul_f32 v[170:171], v[164:165], v[164:165]
  v_pk_add_f32 v[168:169], v[6:7], v[88:89]
  v_pk_mul_f32 v[86:87], v[166:167], v[166:167]
  v_pk_add_f32 v[164:165], v[8:9], v[88:89]
  v_pk_fma_f32 v[170:171], v[168:169], v[168:169], v[170:171]
  v_pk_add_f32 v[166:167], v[10:11], v[88:89]
  v_pk_fma_f32 v[86:87], v[164:165], v[164:165], v[86:87]
  v_pk_add_f32 v[168:169], v[12:13], v[88:89]
  v_pk_fma_f32 v[170:171], v[166:167], v[166:167], v[170:171]
  v_pk_add_f32 v[164:165], v[14:15], v[88:89]
  v_pk_fma_f32 v[86:87], v[168:169], v[168:169], v[86:87]
  v_pk_add_f32 v[166:167], v[16:17], v[88:89]
  v_pk_fma_f32 v[170:171], v[164:165], v[164:165], v[170:171]
  v_pk_add_f32 v[168:169], v[18:19], v[88:89]
  v_pk_fma_f32 v[86:87], v[166:167], v[166:167], v[86:87]
  v_pk_add_f32 v[164:165], v[20:21], v[88:89]
  v_pk_fma_f32 v[170:171], v[168:169], v[168:169], v[170:171]
  v_pk_add_f32 v[166:167], v[22:23], v[88:89]
  v_pk_fma_f32 v[86:87], v[164:165], v[164:165], v[86:87]
  v_pk_add_f32 v[168:169], v[24:25], v[88:89]
  v_pk_fma_f32 v[170:171], v[166:167], v[166:167], v[170:171]
  v_pk_add_f32 v[164:165], v[26:27], v[88:89]
  v_pk_fma_f32 v[86:87], v[168:169], v[168:169], v[86:87]
  v_pk_add_f32 v[166:167], v[28:29], v[88:89]
  v_pk_fma_f32 v[170:171], v[164:165], v[164:165], v[170:171]
  v_pk_add_f32 v[168:169], v[30:31], v[88:89]
  v_pk_fma_f32 v[86:87], v[166:167], v[166:167], v[86:87]
  v_pk_add_f32 v[164:165], v[32:33], v[88:89]
  v_pk_fma_f32 v[170:171], v[168:169], v[168:169], v[170:171]
  v_pk_add_f32 v[166:167], v[34:35], v[88:89]
  v_pk_fma_f32 v[86:87], v[164:165], v[164:165], v[86:87]
  v_pk_add_f32 v[168:169], v[36:37], v[88:89]
  v_pk_fma_f32 v[170:171], v[166:167], v[166:167], v[170:171]
  v_pk_add_f32 v[164:165], v[38:39], v[88:89]
  v_pk_fma_f32 v[86:87], v[168:169], v[168:169], v[86:87]
  v_pk_add_f32 v[166:167], v[40:41], v[88:89]
  v_pk_fma_f32 v[170:171], v[164:165], v[164:165], v[170:171]
  v_pk_fma_f32 v[86:87], v[166:167], v[166:167], v[86:87]
  v_cvt_pk_bf16_f32 v91, v88, v89
  v_lshlrev_b32 v88, 16, v91
  v_and_b32 v89, 0xffff0000, v91
  v_pk_add_f32 v[86:87], v[86:87], v[170:171]
  v_add_f32 v86, v86, v87
  s_nop 1
  v_add_f32_dpp v86, v86, v86 row_ror:8 row_mask:0xf bank_mask:0xf
  s_nop 1
  v_add_f32_dpp v86, v86, v86 row_ror:4 row_mask:0xf bank_mask:0xf
  v_mov_b32 v90, v86
  s_nop 1
  v_permlane16_swap_b32 v86, v90
  v_add_f32 v86, v86, v90
  v_mov_b32 v90, v86
  s_nop 1
  v_permlane32_swap_b32 v86, v90
  v_add_f32 v86, v86, v90
  v_pk_add_f32 v[2:3], v[2:3], v[88:89]
  v_mul_f32 v86, 0x3acccccd, v86
  v_pk_add_f32 v[4:5], v[4:5], v[88:89]
  v_cvt_pk_bf16_f32 v86, v86, v86
  v_pk_add_f32 v[6:7], v[6:7], v[88:89]
  v_lshlrev_b32 v86, 16, v86
  v_pk_add_f32 v[8:9], v[8:9], v[88:89]
  v_add_f32 v86, 0x3727c5ac, v86
  v_pk_add_f32 v[10:11], v[10:11], v[88:89]
  v_cvt_pk_bf16_f32 v86, v86, v86
  v_pk_add_f32 v[12:13], v[12:13], v[88:89]
  v_lshlrev_b32 v86, 16, v86
  v_pk_add_f32 v[14:15], v[14:15], v[88:89]
  v_sqrt_f32 v86, v86
  v_pk_add_f32 v[16:17], v[16:17], v[88:89]
  v_cvt_pk_bf16_f32 v86, v86, v86
  v_pk_add_f32 v[18:19], v[18:19], v[88:89]
  v_lshlrev_b32 v86, 16, v86
  v_pk_add_f32 v[20:21], v[20:21], v[88:89]
  v_rcp_f32 v86, v86
  v_pk_add_f32 v[22:23], v[22:23], v[88:89]
  v_mov_b32 v87, v86
  v_pk_add_f32 v[24:25], v[24:25], v[88:89]
  v_pk_add_f32 v[26:27], v[26:27], v[88:89]
  v_pk_add_f32 v[28:29], v[28:29], v[88:89]
  v_pk_add_f32 v[30:31], v[30:31], v[88:89]
  v_pk_add_f32 v[32:33], v[32:33], v[88:89]
  v_pk_add_f32 v[34:35], v[34:35], v[88:89]
  v_pk_add_f32 v[36:37], v[36:37], v[88:89]
  v_pk_add_f32 v[38:39], v[38:39], v[88:89]
  v_pk_add_f32 v[40:41], v[40:41], v[88:89]
  v_cvt_pk_bf16_f32 v164, v2, v3
  v_lshlrev_b32 v2, 16, v164
  v_and_b32 v3, 0xffff0000, v164
  v_cvt_pk_bf16_f32 v165, v4, v5
  v_lshlrev_b32 v4, 16, v165
  v_and_b32 v5, 0xffff0000, v165
  v_cvt_pk_bf16_f32 v166, v6, v7
  v_lshlrev_b32 v6, 16, v166
  v_and_b32 v7, 0xffff0000, v166
  v_cvt_pk_bf16_f32 v167, v8, v9
  v_lshlrev_b32 v8, 16, v167
  v_and_b32 v9, 0xffff0000, v167
  v_cvt_pk_bf16_f32 v164, v10, v11
  v_lshlrev_b32 v10, 16, v164
  v_and_b32 v11, 0xffff0000, v164
  v_cvt_pk_bf16_f32 v165, v12, v13
  v_lshlrev_b32 v12, 16, v165
  v_and_b32 v13, 0xffff0000, v165
  v_cvt_pk_bf16_f32 v166, v14, v15
  v_lshlrev_b32 v14, 16, v166
  v_and_b32 v15, 0xffff0000, v166
  v_cvt_pk_bf16_f32 v167, v16, v17
  v_lshlrev_b32 v16, 16, v167
  v_and_b32 v17, 0xffff0000, v167
  v_cvt_pk_bf16_f32 v164, v18, v19
  v_lshlrev_b32 v18, 16, v164
  v_and_b32 v19, 0xffff0000, v164
  v_cvt_pk_bf16_f32 v165, v20, v21
  v_lshlrev_b32 v20, 16, v165
  v_and_b32 v21, 0xffff0000, v165
  v_cvt_pk_bf16_f32 v166, v22, v23
  v_lshlrev_b32 v22, 16, v166
  v_and_b32 v23, 0xffff0000, v166
  v_cvt_pk_bf16_f32 v167, v24, v25
  v_lshlrev_b32 v24, 16, v167
  v_and_b32 v25, 0xffff0000, v167
  v_cvt_pk_bf16_f32 v164, v26, v27
  v_lshlrev_b32 v26, 16, v164
  v_and_b32 v27, 0xffff0000, v164
  v_cvt_pk_bf16_f32 v165, v28, v29
  v_lshlrev_b32 v28, 16, v165
  v_and_b32 v29, 0xffff0000, v165
  v_cvt_pk_bf16_f32 v166, v30, v31
  v_lshlrev_b32 v30, 16, v166
  v_and_b32 v31, 0xffff0000, v166
  v_cvt_pk_bf16_f32 v167, v32, v33
  v_lshlrev_b32 v32, 16, v167
  v_and_b32 v33, 0xffff0000, v167
  v_cvt_pk_bf16_f32 v164, v34, v35
  v_lshlrev_b32 v34, 16, v164
  v_and_b32 v35, 0xffff0000, v164
  v_cvt_pk_bf16_f32 v165, v36, v37
  v_lshlrev_b32 v36, 16, v165
  v_and_b32 v37, 0xffff0000, v165
  v_cvt_pk_bf16_f32 v166, v38, v39
  v_lshlrev_b32 v38, 16, v166
  v_and_b32 v39, 0xffff0000, v166
  v_cvt_pk_bf16_f32 v167, v40, v41
  v_lshlrev_b32 v40, 16, v167
  v_and_b32 v41, 0xffff0000, v167
  s_sub_u32 s36, s33, 0
  s_min_u32 s36, s36, 24
  v_mov_b32 v92, s36
  s_waitcnt vmcnt(10)
  buffer_store_dword v92, v228, s[8:11], 0 offen
  v_pk_mul_f32 v[2:3], v[2:3], v[86:87]
  v_pk_mul_f32 v[4:5], v[4:5], v[86:87]
  v_pk_mul_f32 v[6:7], v[6:7], v[86:87]
  v_pk_mul_f32 v[8:9], v[8:9], v[86:87]
  v_pk_mul_f32 v[10:11], v[10:11], v[86:87]
  v_pk_mul_f32 v[12:13], v[12:13], v[86:87]
  v_pk_mul_f32 v[14:15], v[14:15], v[86:87]
  v_pk_mul_f32 v[16:17], v[16:17], v[86:87]
  v_pk_mul_f32 v[18:19], v[18:19], v[86:87]
  v_pk_mul_f32 v[20:21], v[20:21], v[86:87]
  v_pk_mul_f32 v[22:23], v[22:23], v[86:87]
  v_pk_mul_f32 v[24:25], v[24:25], v[86:87]
  v_pk_mul_f32 v[26:27], v[26:27], v[86:87]
  v_pk_mul_f32 v[28:29], v[28:29], v[86:87]
  v_pk_mul_f32 v[30:31], v[30:31], v[86:87]
  v_pk_mul_f32 v[32:33], v[32:33], v[86:87]
  v_pk_mul_f32 v[34:35], v[34:35], v[86:87]
  v_pk_mul_f32 v[36:37], v[36:37], v[86:87]
  v_pk_mul_f32 v[38:39], v[38:39], v[86:87]
  v_pk_mul_f32 v[40:41], v[40:41], v[86:87]
  v_cvt_pk_bf16_f32 v164, v2, v3
  v_lshlrev_b32 v2, 16, v164
  v_and_b32 v3, 0xffff0000, v164
  v_cvt_pk_bf16_f32 v165, v4, v5
  v_lshlrev_b32 v4, 16, v165
  v_and_b32 v5, 0xffff0000, v165
  v_cvt_pk_bf16_f32 v166, v6, v7
  v_lshlrev_b32 v6, 16, v166
  v_and_b32 v7, 0xffff0000, v166
  v_cvt_pk_bf16_f32 v167, v8, v9
  v_lshlrev_b32 v8, 16, v167
  v_and_b32 v9, 0xffff0000, v167
  v_cvt_pk_bf16_f32 v164, v10, v11
  v_lshlrev_b32 v10, 16, v164
  v_and_b32 v11, 0xffff0000, v164
  v_cvt_pk_bf16_f32 v165, v12, v13
  v_lshlrev_b32 v12, 16, v165
  v_and_b32 v13, 0xffff0000, v165
  v_cvt_pk_bf16_f32 v166, v14, v15
  v_lshlrev_b32 v14, 16, v166
  v_and_b32 v15, 0xffff0000, v166
  v_cvt_pk_bf16_f32 v167, v16, v17
  v_lshlrev_b32 v16, 16, v167
  v_and_b32 v17, 0xffff0000, v167
  v_cvt_pk_bf16_f32 v164, v18, v19
  v_lshlrev_b32 v18, 16, v164
  v_and_b32 v19, 0xffff0000, v164
  v_cvt_pk_bf16_f32 v165, v20, v21
  v_lshlrev_b32 v20, 16, v165
  v_and_b32 v21, 0xffff0000, v165
  v_cvt_pk_bf16_f32 v166, v22, v23
  v_lshlrev_b32 v22, 16, v166
  v_and_b32 v23, 0xffff0000, v166
  v_cvt_pk_bf16_f32 v167, v24, v25
  v_lshlrev_b32 v24, 16, v167
  v_and_b32 v25, 0xffff0000, v167
  v_cvt_pk_bf16_f32 v164, v26, v27
  v_lshlrev_b32 v26, 16, v164
  v_and_b32 v27, 0xffff0000, v164
  v_cvt_pk_bf16_f32 v165, v28, v29
  v_lshlrev_b32 v28, 16, v165
  v_and_b32 v29, 0xffff0000, v165
  v_cvt_pk_bf16_f32 v166, v30, v31
  v_lshlrev_b32 v30, 16, v166
  v_and_b32 v31, 0xffff0000, v166
  v_cvt_pk_bf16_f32 v167, v32, v33
  v_lshlrev_b32 v32, 16, v167
  v_and_b32 v33, 0xffff0000, v167
  v_cvt_pk_bf16_f32 v164, v34, v35
  v_lshlrev_b32 v34, 16, v164
  v_and_b32 v35, 0xffff0000, v164
  v_cvt_pk_bf16_f32 v165, v36, v37
  v_lshlrev_b32 v36, 16, v165
  v_and_b32 v37, 0xffff0000, v165
  v_cvt_pk_bf16_f32 v166, v38, v39
  v_lshlrev_b32 v38, 16, v166
  v_and_b32 v39, 0xffff0000, v166
  v_cvt_pk_bf16_f32 v167, v40, v41
  v_lshlrev_b32 v40, 16, v167
  v_and_b32 v41, 0xffff0000, v167
  v_mul_f32_dpp v2, v176, v2 quad_perm:[2,2,2,2] row_mask:0xf bank_mask:0xf
  v_mul_f32_dpp v3, v177, v3 quad_perm:[2,2,2,2] row_mask:0xf bank_mask:0xf
  v_mul_f32_dpp v4, v178, v4 quad_perm:[2,2,2,2] row_mask:0xf bank_mask:0xf
  v_mul_f32_dpp v5, v179, v5 quad_perm:[2,2,2,2] row_mask:0xf bank_mask:0xf
  v_mul_f32_dpp v6, v176, v6 quad_perm:[3,3,3,3] row_mask:0xf bank_mask:0xf
  v_mul_f32_dpp v7, v177, v7 quad_perm:[3,3,3,3] row_mask:0xf bank_mask:0xf
  v_mul_f32_dpp v8, v178, v8 quad_perm:[3,3,3,3] row_mask:0xf bank_mask:0xf
  v_mul_f32_dpp v9, v179, v9 quad_perm:[3,3,3,3] row_mask:0xf bank_mask:0xf
  v_cvt_pk_bf16_f32 v164, v2, v3
  v_lshlrev_b32 v2, 16, v164
  v_and_b32 v3, 0xffff0000, v164
  v_cvt_pk_bf16_f32 v165, v4, v5
  v_lshlrev_b32 v4, 16, v165
  v_and_b32 v5, 0xffff0000, v165
  v_cvt_pk_bf16_f32 v166, v6, v7
  v_lshlrev_b32 v6, 16, v166
  v_and_b32 v7, 0xffff0000, v166
  v_cvt_pk_bf16_f32 v167, v8, v9
  v_lshlrev_b32 v8, 16, v167
  v_and_b32 v9, 0xffff0000, v167
  v_add_f32_dpp v2, v176, v2 quad_perm:[0,0,0,0] row_mask:0xf bank_mask:0xf
  v_add_f32_dpp v3, v177, v3 quad_perm:[0,0,0,0] row_mask:0xf bank_mask:0xf
  v_add_f32_dpp v4, v178, v4 quad_perm:[0,0,0,0] row_mask:0xf bank_mask:0xf
  v_add_f32_dpp v5, v179, v5 quad_perm:[0,0,0,0] row_mask:0xf bank_mask:0xf
  v_add_f32_dpp v6, v176, v6 quad_perm:[1,1,1,1] row_mask:0xf bank_mask:0xf
  v_add_f32_dpp v7, v177, v7 quad_perm:[1,1,1,1] row_mask:0xf bank_mask:0xf
  v_add_f32_dpp v8, v178, v8 quad_perm:[1,1,1,1] row_mask:0xf bank_mask:0xf
  v_add_f32_dpp v9, v179, v9 quad_perm:[1,1,1,1] row_mask:0xf bank_mask:0xf
  v_cvt_pk_bf16_f32 v196, v2, v3
  v_cvt_pk_bf16_f32 v197, v4, v5
  v_cvt_pk_bf16_f32 v198, v6, v7
  v_cvt_pk_bf16_f32 v199, v8, v9
  s_add_u32 s35, s38, 0
  buffer_store_dwordx4 v[196:199], v161, s[8:11], s35 offen sc1
  v_mul_f32_dpp v10, v180, v10 quad_perm:[2,2,2,2] row_mask:0xf bank_mask:0xf
  v_mul_f32_dpp v11, v181, v11 quad_perm:[2,2,2,2] row_mask:0xf bank_mask:0xf
  v_mul_f32_dpp v12, v182, v12 quad_perm:[2,2,2,2] row_mask:0xf bank_mask:0xf
  v_mul_f32_dpp v13, v183, v13 quad_perm:[2,2,2,2] row_mask:0xf bank_mask:0xf
  v_mul_f32_dpp v14, v180, v14 quad_perm:[3,3,3,3] row_mask:0xf bank_mask:0xf
  v_mul_f32_dpp v15, v181, v15 quad_perm:[3,3,3,3] row_mask:0xf bank_mask:0xf
  v_mul_f32_dpp v16, v182, v16 quad_perm:[3,3,3,3] row_mask:0xf bank_mask:0xf
  v_mul_f32_dpp v17, v183, v17 quad_perm:[3,3,3,3] row_mask:0xf bank_mask:0xf
  v_cvt_pk_bf16_f32 v164, v10, v11
  v_lshlrev_b32 v10, 16, v164
  v_and_b32 v11, 0xffff0000, v164
  v_cvt_pk_bf16_f32 v165, v12, v13
  v_lshlrev_b32 v12, 16, v165
  v_and_b32 v13, 0xffff0000, v165
  v_cvt_pk_bf16_f32 v166, v14, v15
  v_lshlrev_b32 v14, 16, v166
  v_and_b32 v15, 0xffff0000, v166
  v_cvt_pk_bf16_f32 v167, v16, v17
  v_lshlrev_b32 v16, 16, v167
  v_and_b32 v17, 0xffff0000, v167
  v_add_f32_dpp v10, v180, v10 quad_perm:[0,0,0,0] row_mask:0xf bank_mask:0xf
  v_add_f32_dpp v11, v181, v11 quad_perm:[0,0,0,0] row_mask:0xf bank_mask:0xf
  v_add_f32_dpp v12, v182, v12 quad_perm:[0,0,0,0] row_mask:0xf bank_mask:0xf
  v_add_f32_dpp v13, v183, v13 quad_perm:[0,0,0,0] row_mask:0xf bank_mask:0xf
  v_add_f32_dpp v14, v180, v14 quad_perm:[1,1,1,1] row_mask:0xf bank_mask:0xf
  v_add_f32_dpp v15, v181, v15 quad_perm:[1,1,1,1] row_mask:0xf bank_mask:0xf
  v_add_f32_dpp v16, v182, v16 quad_perm:[1,1,1,1] row_mask:0xf bank_mask:0xf
  v_add_f32_dpp v17, v183, v17 quad_perm:[1,1,1,1] row_mask:0xf bank_mask:0xf
  v_cvt_pk_bf16_f32 v200, v10, v11
  v_cvt_pk_bf16_f32 v201, v12, v13
  v_cvt_pk_bf16_f32 v202, v14, v15
  v_cvt_pk_bf16_f32 v203, v16, v17
  s_add_u32 s35, s38, 4096
  buffer_store_dwordx4 v[200:203], v161, s[8:11], s35 offen sc1
  v_mul_f32_dpp v18, v184, v18 quad_perm:[2,2,2,2] row_mask:0xf bank_mask:0xf
  v_mul_f32_dpp v19, v185, v19 quad_perm:[2,2,2,2] row_mask:0xf bank_mask:0xf
  v_mul_f32_dpp v20, v186, v20 quad_perm:[2,2,2,2] row_mask:0xf bank_mask:0xf
  v_mul_f32_dpp v21, v187, v21 quad_perm:[2,2,2,2] row_mask:0xf bank_mask:0xf
  v_mul_f32_dpp v22, v184, v22 quad_perm:[3,3,3,3] row_mask:0xf bank_mask:0xf
  v_mul_f32_dpp v23, v185, v23 quad_perm:[3,3,3,3] row_mask:0xf bank_mask:0xf
  v_mul_f32_dpp v24, v186, v24 quad_perm:[3,3,3,3] row_mask:0xf bank_mask:0xf
  v_mul_f32_dpp v25, v187, v25 quad_perm:[3,3,3,3] row_mask:0xf bank_mask:0xf
  v_cvt_pk_bf16_f32 v164, v18, v19
  v_lshlrev_b32 v18, 16, v164
  v_and_b32 v19, 0xffff0000, v164
  v_cvt_pk_bf16_f32 v165, v20, v21
  v_lshlrev_b32 v20, 16, v165
  v_and_b32 v21, 0xffff0000, v165
  v_cvt_pk_bf16_f32 v166, v22, v23
  v_lshlrev_b32 v22, 16, v166
  v_and_b32 v23, 0xffff0000, v166
  v_cvt_pk_bf16_f32 v167, v24, v25
  v_lshlrev_b32 v24, 16, v167
  v_and_b32 v25, 0xffff0000, v167
  v_add_f32_dpp v18, v184, v18 quad_perm:[0,0,0,0] row_mask:0xf bank_mask:0xf
  v_add_f32_dpp v19, v185, v19 quad_perm:[0,0,0,0] row_mask:0xf bank_mask:0xf
  v_add_f32_dpp v20, v186, v20 quad_perm:[0,0,0,0] row_mask:0xf bank_mask:0xf
  v_add_f32_dpp v21, v187, v21 quad_perm:[0,0,0,0] row_mask:0xf bank_mask:0xf
  v_add_f32_dpp v22, v184, v22 quad_perm:[1,1,1,1] row_mask:0xf bank_mask:0xf
  v_add_f32_dpp v23, v185, v23 quad_perm:[1,1,1,1] row_mask:0xf bank_mask:0xf
  v_add_f32_dpp v24, v186, v24 quad_perm:[1,1,1,1] row_mask:0xf bank_mask:0xf
  v_add_f32_dpp v25, v187, v25 quad_perm:[1,1,1,1] row_mask:0xf bank_mask:0xf
  v_cvt_pk_bf16_f32 v204, v18, v19
  v_cvt_pk_bf16_f32 v205, v20, v21
  v_cvt_pk_bf16_f32 v206, v22, v23
  v_cvt_pk_bf16_f32 v207, v24, v25
  s_add_u32 s35, s38, 8192
  buffer_store_dwordx4 v[204:207], v161, s[8:11], s35 offen sc1
  v_mul_f32_dpp v26, v188, v26 quad_perm:[2,2,2,2] row_mask:0xf bank_mask:0xf
  v_mul_f32_dpp v27, v189, v27 quad_perm:[2,2,2,2] row_mask:0xf bank_mask:0xf
  v_mul_f32_dpp v28, v190, v28 quad_perm:[2,2,2,2] row_mask:0xf bank_mask:0xf
  v_mul_f32_dpp v29, v191, v29 quad_perm:[2,2,2,2] row_mask:0xf bank_mask:0xf
  v_mul_f32_dpp v30, v188, v30 quad_perm:[3,3,3,3] row_mask:0xf bank_mask:0xf
  v_mul_f32_dpp v31, v189, v31 quad_perm:[3,3,3,3] row_mask:0xf bank_mask:0xf
  v_mul_f32_dpp v32, v190, v32 quad_perm:[3,3,3,3] row_mask:0xf bank_mask:0xf
  v_mul_f32_dpp v33, v191, v33 quad_perm:[3,3,3,3] row_mask:0xf bank_mask:0xf
  v_cvt_pk_bf16_f32 v164, v26, v27
  v_lshlrev_b32 v26, 16, v164
  v_and_b32 v27, 0xffff0000, v164
  v_cvt_pk_bf16_f32 v165, v28, v29
  v_lshlrev_b32 v28, 16, v165
  v_and_b32 v29, 0xffff0000, v165
  v_cvt_pk_bf16_f32 v166, v30, v31
  v_lshlrev_b32 v30, 16, v166
  v_and_b32 v31, 0xffff0000, v166
  v_cvt_pk_bf16_f32 v167, v32, v33
  v_lshlrev_b32 v32, 16, v167
  v_and_b32 v33, 0xffff0000, v167
  v_add_f32_dpp v26, v188, v26 quad_perm:[0,0,0,0] row_mask:0xf bank_mask:0xf
  v_add_f32_dpp v27, v189, v27 quad_perm:[0,0,0,0] row_mask:0xf bank_mask:0xf
  v_add_f32_dpp v28, v190, v28 quad_perm:[0,0,0,0] row_mask:0xf bank_mask:0xf
  v_add_f32_dpp v29, v191, v29 quad_perm:[0,0,0,0] row_mask:0xf bank_mask:0xf
  v_add_f32_dpp v30, v188, v30 quad_perm:[1,1,1,1] row_mask:0xf bank_mask:0xf
  v_add_f32_dpp v31, v189, v31 quad_perm:[1,1,1,1] row_mask:0xf bank_mask:0xf
  v_add_f32_dpp v32, v190, v32 quad_perm:[1,1,1,1] row_mask:0xf bank_mask:0xf
  v_add_f32_dpp v33, v191, v33 quad_perm:[1,1,1,1] row_mask:0xf bank_mask:0xf
  v_cvt_pk_bf16_f32 v208, v26, v27
  v_cvt_pk_bf16_f32 v209, v28, v29
  v_cvt_pk_bf16_f32 v210, v30, v31
  v_cvt_pk_bf16_f32 v211, v32, v33
  s_add_u32 s35, s38, 12288
  buffer_store_dwordx4 v[208:211], v161, s[8:11], s35 offen sc1
  v_mul_f32_dpp v34, v192, v34 quad_perm:[2,2,2,2] row_mask:0xf bank_mask:0xf
  v_mul_f32_dpp v35, v193, v35 quad_perm:[2,2,2,2] row_mask:0xf bank_mask:0xf
  v_mul_f32_dpp v36, v194, v36 quad_perm:[2,2,2,2] row_mask:0xf bank_mask:0xf
  v_mul_f32_dpp v37, v195, v37 quad_perm:[2,2,2,2] row_mask:0xf bank_mask:0xf
  v_mul_f32_dpp v38, v192, v38 quad_perm:[3,3,3,3] row_mask:0xf bank_mask:0xf
  v_mul_f32_dpp v39, v193, v39 quad_perm:[3,3,3,3] row_mask:0xf bank_mask:0xf
  v_mul_f32_dpp v40, v194, v40 quad_perm:[3,3,3,3] row_mask:0xf bank_mask:0xf
  v_mul_f32_dpp v41, v195, v41 quad_perm:[3,3,3,3] row_mask:0xf bank_mask:0xf
  v_cvt_pk_bf16_f32 v164, v34, v35
  v_lshlrev_b32 v34, 16, v164
  v_and_b32 v35, 0xffff0000, v164
  v_cvt_pk_bf16_f32 v165, v36, v37
  v_lshlrev_b32 v36, 16, v165
  v_and_b32 v37, 0xffff0000, v165
  v_cvt_pk_bf16_f32 v166, v38, v39
  v_lshlrev_b32 v38, 16, v166
  v_and_b32 v39, 0xffff0000, v166
  v_cvt_pk_bf16_f32 v167, v40, v41
  v_lshlrev_b32 v40, 16, v167
  v_and_b32 v41, 0xffff0000, v167
  v_add_f32_dpp v34, v192, v34 quad_perm:[0,0,0,0] row_mask:0xf bank_mask:0xf
  v_add_f32_dpp v35, v193, v35 quad_perm:[0,0,0,0] row_mask:0xf bank_mask:0xf
  v_add_f32_dpp v36, v194, v36 quad_perm:[0,0,0,0] row_mask:0xf bank_mask:0xf
  v_add_f32_dpp v37, v195, v37 quad_perm:[0,0,0,0] row_mask:0xf bank_mask:0xf
  v_add_f32_dpp v38, v192, v38 quad_perm:[1,1,1,1] row_mask:0xf bank_mask:0xf
  v_add_f32_dpp v39, v193, v39 quad_perm:[1,1,1,1] row_mask:0xf bank_mask:0xf
  v_add_f32_dpp v40, v194, v40 quad_perm:[1,1,1,1] row_mask:0xf bank_mask:0xf
  v_add_f32_dpp v41, v195, v41 quad_perm:[1,1,1,1] row_mask:0xf bank_mask:0xf
  v_cvt_pk_bf16_f32 v212, v34, v35
  v_cvt_pk_bf16_f32 v213, v36, v37
  v_cvt_pk_bf16_f32 v214, v38, v39
  v_cvt_pk_bf16_f32 v215, v40, v41
  s_add_u32 s35, s38, 16384
  buffer_store_dwordx4 v[212:215], v161, s[8:11], s35 offen sc1
  s_add_u32 s36, s41, 24
  s_cmp_lt_u32 s41, 24
  s_cselect_b32 s36, s39, s36
  s_add_u32 s41, s41, 3
  s_cmp_lt_u32 s41, 24
  s_cselect_b32 s41, s41, s36
  s_min_u32 s41, s41, 127
  s_mul_i32 s38, s16, 2621440
  s_cmp_lt_u32 s41, 24
  s_cselect_b32 s38, s38, 0
  s_mul_i32 s36, s41, 20480
  s_add_u32 s38, s38, s36
  s_lshl_b32 s36, s17, 6
  s_add_u32 s38, s38, s36
  s_add_u32 s38, s38, 247463936
  s_add_u32 s33, s33, 3
  buffer_load_dwordx2 v[66:67], v160, s[20:23], s37 offen offset:0
  buffer_load_dwordx2 v[68:69], v160, s[20:23], s37 offen offset:32
  buffer_load_dwordx2 v[70:71], v160, s[20:23], s37 offen offset:256
  buffer_load_dwordx2 v[72:73], v160, s[20:23], s37 offen offset:288
  buffer_load_dwordx2 v[74:75], v160, s[20:23], s37 offen offset:512
  buffer_load_dwordx2 v[76:77], v160, s[20:23], s37 offen offset:544
  buffer_load_dwordx2 v[78:79], v160, s[20:23], s37 offen offset:768
  buffer_load_dwordx2 v[80:81], v160, s[20:23], s37 offen offset:800
  buffer_load_dwordx2 v[82:83], v160, s[20:23], s37 offen offset:1024
  buffer_load_dwordx2 v[84:85], v160, s[20:23], s37 offen offset:1056
  s_add_u32 s36, s40, 24
  s_cmp_lt_u32 s40, 24
  s_cselect_b32 s36, s39, s36
  s_add_u32 s40, s40, 3
  s_cmp_lt_u32 s40, 24
  s_cselect_b32 s40, s40, s36
  s_min_u32 s40, s40, 127
  s_mul_i32 s37, s40, 20480
  s_mul_i32 s36, s17, 5120
  s_add_u32 s37, s37, s36
  s_cmp_lt_u32 s33, 39
  s_cbranch_scc0 r_ln1e
  v_lshlrev_b32 v2, 16, v140
  v_and_b32 v3, 0xffff0000, v140
  v_lshlrev_b32 v4, 16, v141
  v_and_b32 v5, 0xffff0000, v141
  v_lshlrev_b32 v6, 16, v142
  v_and_b32 v7, 0xffff0000, v142
  v_lshlrev_b32 v8, 16, v143
  v_and_b32 v9, 0xffff0000, v143
  v_lshlrev_b32 v10, 16, v144
  v_and_b32 v11, 0xffff0000, v144
  v_lshlrev_b32 v12, 16, v145
  v_and_b32 v13, 0xffff0000, v145
  v_lshlrev_b32 v14, 16, v146
  v_and_b32 v15, 0xffff0000, v146
  v_lshlrev_b32 v16, 16, v147
  v_and_b32 v17, 0xffff0000, v147
  v_lshlrev_b32 v18, 16, v148
  v_and_b32 v19, 0xffff0000, v148
  v_lshlrev_b32 v20, 16, v149
  v_and_b32 v21, 0xffff0000, v149
  v_lshlrev_b32 v22, 16, v150
  v_and_b32 v23, 0xffff0000, v150
  v_lshlrev_b32 v24, 16, v151
  v_and_b32 v25, 0xffff0000, v151
  v_lshlrev_b32 v26, 16, v152
  v_and_b32 v27, 0xffff0000, v152
  v_lshlrev_b32 v28, 16, v153
  v_and_b32 v29, 0xffff0000, v153
  v_lshlrev_b32 v30, 16, v154
  v_and_b32 v31, 0xffff0000, v154
  v_lshlrev_b32 v32, 16, v155
  v_and_b32 v33, 0xffff0000, v155
  v_lshlrev_b32 v34, 16, v156
  v_and_b32 v35, 0xffff0000, v156
  v_lshlrev_b32 v36, 16, v157
  v_and_b32 v37, 0xffff0000, v157
  v_lshlrev_b32 v38, 16, v158
  v_and_b32 v39, 0xffff0000, v158
  v_lshlrev_b32 v40, 16, v159
  v_and_b32 v41, 0xffff0000, v159
  v_pk_add_f32 v[86:87], v[2:3], v[4:5]
  v_pk_add_f32 v[88:89], v[6:7], v[8:9]
  v_pk_add_f32 v[86:87], v[86:87], v[10:11]
  v_pk_add_f32 v[88:89], v[88:89], v[12:13]
  v_pk_add_f32 v[86:87], v[86:87], v[14:15]
  v_pk_add_f32 v[88:89], v[88:89], v[16:17]
  v_pk_add_f32 v[86:87], v[86:87], v[18:19]
  v_pk_add_f32 v[88:89], v[88:89], v[20:21]
  v_pk_add_f32 v[86:87], v[86:87], v[22:23]
  v_pk_add_f32 v[88:89], v[88:89], v[24:25]
  v_pk_add_f32 v[86:87], v[86:87], v[26:27]
  v_pk_add_f32 v[88:89], v[88:89], v[28:29]
  v_pk_add_f32 v[86:87], v[86:87], v[30:31]
  v_pk_add_f32 v[88:89], v[88:89], v[32:33]
  v_pk_add_f32 v[86:87], v[86:87], v[34:35]
  v_pk_add_f32 v[88:89], v[88:89], v[36:37]
  v_pk_add_f32 v[86:87], v[86:87], v[38:39]
  v_pk_add_f32 v[88:89], v[88:89], v[40:41]
  v_pk_add_f32 v[86:87], v[86:87], v[88:89]
  v_add_f32 v86, v86, v87
  s_nop 1
  v_add_f32_dpp v86, v86, v86 row_ror:8 row_mask:0xf bank_mask:0xf
  s_nop 1
  v_add_f32_dpp v86, v86, v86 row_ror:4 row_mask:0xf bank_mask:0xf
  v_mov_b32 v90, v86
  s_nop 1
  v_permlane16_swap_b32 v86, v90
  v_add_f32 v86, v86, v90
  v_mov_b32 v90, v86
  s_nop 1
  v_permlane32_swap_b32 v86, v90
  v_add_f32 v86, v86, v90
  v_mul_f32 v88, 0xbacccccd, v86
  v_mul_f32 v89, 0xbacccccd, v86
  v_pk_add_f32 v[164:165], v[2:3], v[88:89]
  v_pk_add_f32 v[166:167], v[4:5], v[88:89]
  v_pk_mul_f32 v[170:171], v[164:165], v[164:165]
  v_pk_add_f32 v[168:169], v[6:7], v[88:89]
  v_pk_mul_f32 v[86:87], v[166:167], v[166:167]
  v_pk_add_f32 v[164:165], v[8:9], v[88:89]
  v_pk_fma_f32 v[170:171], v[168:169], v[168:169], v[170:171]
  v_pk_add_f32 v[166:167], v[10:11], v[88:89]
  v_pk_fma_f32 v[86:87], v[164:165], v[164:165], v[86:87]
  v_pk_add_f32 v[168:169], v[12:13], v[88:89]
  v_pk_fma_f32 v[170:171], v[166:167], v[166:167], v[170:171]
  v_pk_add_f32 v[164:165], v[14:15], v[88:89]
  v_pk_fma_f32 v[86:87], v[168:169], v[168:169], v[86:87]
  v_pk_add_f32 v[166:167], v[16:17], v[88:89]
  v_pk_fma_f32 v[170:171], v[164:165], v[164:165], v[170:171]
  v_pk_add_f32 v[168:169], v[18:19], v[88:89]
  v_pk_fma_f32 v[86:87], v[166:167], v[166:167], v[86:87]
  v_pk_add_f32 v[164:165], v[20:21], v[88:89]
  v_pk_fma_f32 v[170:171], v[168:169], v[168:169], v[170:171]
  v_pk_add_f32 v[166:167], v[22:23], v[88:89]
  v_pk_fma_f32 v[86:87], v[164:165], v[164:165], v[86:87]
  v_pk_add_f32 v[168:169], v[24:25], v[88:89]
  v_pk_fma_f32 v[170:171], v[166:167], v[166:167], v[170:171]
  v_pk_add_f32 v[164:165], v[26:27], v[88:89]
  v_pk_fma_f32 v[86:87], v[168:169], v[168:169], v[86:87]
  v_pk_add_f32 v[166:167], v[28:29], v[88:89]
  v_pk_fma_f32 v[170:171], v[164:165], v[164:165], v[170:171]
  v_pk_add_f32 v[168:169], v[30:31], v[88:89]
  v_pk_fma_f32 v[86:87], v[166:167], v[166:167], v[86:87]
  v_pk_add_f32 v[164:165], v[32:33], v[88:89]
  v_pk_fma_f32 v[170:171], v[168:169], v[168:169], v[170:171]
  v_pk_add_f32 v[166:167], v[34:35], v[88:89]
  v_pk_fma_f32 v[86:87], v[164:165], v[164:165], v[86:87]
  v_pk_add_f32 v[168:169], v[36:37], v[88:89]
  v_pk_fma_f32 v[170:171], v[166:167], v[166:167], v[170:171]
  v_pk_add_f32 v[164:165], v[38:39], v[88:89]
  v_pk_fma_f32 v[86:87], v[168:169], v[168:169], v[86:87]
  v_pk_add_f32 v[166:167], v[40:41], v[88:89]
  v_pk_fma_f32 v[170:171], v[164:165], v[164:165], v[170:171]
  v_pk_fma_f32 v[86:87], v[166:167], v[166:167], v[86:87]
  v_cvt_pk_bf16_f32 v91, v88, v89
  v_lshlrev_b32 v88, 16, v91
  v_and_b32 v89, 0xffff0000, v91
  v_pk_add_f32 v[86:87], v[86:87], v[170:171]
  v_add_f32 v86, v86, v87
  s_nop 1
  v_add_f32_dpp v86, v86, v86 row_ror:8 row_mask:0xf bank_mask:0xf
  s_nop 1
  v_add_f32_dpp v86, v86, v86 row_ror:4 row_mask:0xf bank_mask:0xf
  v_mov_b32 v90, v86
  s_nop 1
  v_permlane16_swap_b32 v86, v90
  v_add_f32 v86, v86, v90
  v_mov_b32 v90, v86
  s_nop 1
  v_permlane32_swap_b32 v86, v90
  v_add_f32 v86, v86, v90
  v_pk_add_f32 v[2:3], v[2:3], v[88:89]
  v_mul_f32 v86, 0x3acccccd, v86
  v_pk_add_f32 v[4:5], v[4:5], v[88:89]
  v_cvt_pk_bf16_f32 v86, v86, v86
  v_pk_add_f32 v[6:7], v[6:7], v[88:89]
  v_lshlrev_b32 v86, 16, v86
  v_pk_add_f32 v[8:9], v[8:9], v[88:89]
  v_add_f32 v86, 0x3727c5ac, v86
  v_pk_add_f32 v[10:11], v[10:11], v[88:89]
  v_cvt_pk_bf16_f32 v86, v86, v86
  v_pk_add_f32 v[12:13], v[12:13], v[88:89]
  v_lshlrev_b32 v86, 16, v86
  v_pk_add_f32 v[14:15], v[14:15], v[88:89]
  v_sqrt_f32 v86, v86
  v_pk_add_f32 v[16:17], v[16:17], v[88:89]
  v_cvt_pk_bf16_f32 v86, v86, v86
  v_pk_add_f32 v[18:19], v[18:19], v[88:89]
  v_lshlrev_b32 v86, 16, v86
  v_pk_add_f32 v[20:21], v[20:21], v[88:89]
  v_rcp_f32 v86, v86
  v_pk_add_f32 v[22:23], v[22:23], v[88:89]
  v_mov_b32 v87, v86
  v_pk_add_f32 v[24:25], v[24:25], v[88:89]
  v_pk_add_f32 v[26:27], v[26:27], v[88:89]
  v_pk_add_f32 v[28:29], v[28:29], v[88:89]
  v_pk_add_f32 v[30:31], v[30:31], v[88:89]
  v_pk_add_f32 v[32:33], v[32:33], v[88:89]
  v_pk_add_f32 v[34:35], v[34:35], v[88:89]
  v_pk_add_f32 v[36:37], v[36:37], v[88:89]
  v_pk_add_f32 v[38:39], v[38:39], v[88:89]
  v_pk_add_f32 v[40:41], v[40:41], v[88:89]
  v_cvt_pk_bf16_f32 v164, v2, v3
  v_lshlrev_b32 v2, 16, v164
  v_and_b32 v3, 0xffff0000, v164
  v_cvt_pk_bf16_f32 v165, v4, v5
  v_lshlrev_b32 v4, 16, v165
  v_and_b32 v5, 0xffff0000, v165
  v_cvt_pk_bf16_f32 v166, v6, v7
  v_lshlrev_b32 v6, 16, v166
  v_and_b32 v7, 0xffff0000, v166
  v_cvt_pk_bf16_f32 v167, v8, v9
  v_lshlrev_b32 v8, 16, v167
  v_and_b32 v9, 0xffff0000, v167
  v_cvt_pk_bf16_f32 v164, v10, v11
  v_lshlrev_b32 v10, 16, v164
  v_and_b32 v11, 0xffff0000, v164
  v_cvt_pk_bf16_f32 v165, v12, v13
  v_lshlrev_b32 v12, 16, v165
  v_and_b32 v13, 0xffff0000, v165
  v_cvt_pk_bf16_f32 v166, v14, v15
  v_lshlrev_b32 v14, 16, v166
  v_and_b32 v15, 0xffff0000, v166
  v_cvt_pk_bf16_f32 v167, v16, v17
  v_lshlrev_b32 v16, 16, v167
  v_and_b32 v17, 0xffff0000, v167
  v_cvt_pk_bf16_f32 v164, v18, v19
  v_lshlrev_b32 v18, 16, v164
  v_and_b32 v19, 0xffff0000, v164
  v_cvt_pk_bf16_f32 v165, v20, v21
  v_lshlrev_b32 v20, 16, v165
  v_and_b32 v21, 0xffff0000, v165
  v_cvt_pk_bf16_f32 v166, v22, v23
  v_lshlrev_b32 v22, 16, v166
  v_and_b32 v23, 0xffff0000, v166
  v_cvt_pk_bf16_f32 v167, v24, v25
  v_lshlrev_b32 v24, 16, v167
  v_and_b32 v25, 0xffff0000, v167
  v_cvt_pk_bf16_f32 v164, v26, v27
  v_lshlrev_b32 v26, 16, v164
  v_and_b32 v27, 0xffff0000, v164
  v_cvt_pk_bf16_f32 v165, v28, v29
  v_lshlrev_b32 v28, 16, v165
  v_and_b32 v29, 0xffff0000, v165
  v_cvt_pk_bf16_f32 v166, v30, v31
  v_lshlrev_b32 v30, 16, v166
  v_and_b32 v31, 0xffff0000, v166
  v_cvt_pk_bf16_f32 v167, v32, v33
  v_lshlrev_b32 v32, 16, v167
  v_and_b32 v33, 0xffff0000, v167
  v_cvt_pk_bf16_f32 v164, v34, v35
  v_lshlrev_b32 v34, 16, v164
  v_and_b32 v35, 0xffff0000, v164
  v_cvt_pk_bf16_f32 v165, v36, v37
  v_lshlrev_b32 v36, 16, v165
  v_and_b32 v37, 0xffff0000, v165
  v_cvt_pk_bf16_f32 v166, v38, v39
  v_lshlrev_b32 v38, 16, v166
  v_and_b32 v39, 0xffff0000, v166
  v_cvt_pk_bf16_f32 v167, v40, v41
  v_lshlrev_b32 v40, 16, v167
  v_and_b32 v41, 0xffff0000, v167
  s_sub_u32 s36, s33, 0
  s_min_u32 s36, s36, 24
  v_mov_b32 v92, s36
  s_waitcnt vmcnt(10)
  buffer_store_dword v92, v228, s[8:11], 0 offen
  v_pk_mul_f32 v[2:3], v[2:3], v[86:87]
  v_pk_mul_f32 v[4:5], v[4:5], v[86:87]
  v_pk_mul_f32 v[6:7], v[6:7], v[86:87]
  v_pk_mul_f32 v[8:9], v[8:9], v[86:87]
  v_pk_mul_f32 v[10:11], v[10:11], v[86:87]
  v_pk_mul_f32 v[12:13], v[12:13], v[86:87]
  v_pk_mul_f32 v[14:15], v[14:15], v[86:87]
  v_pk_mul_f32 v[16:17], v[16:17], v[86:87]
  v_pk_mul_f32 v[18:19], v[18:19], v[86:87]
  v_pk_mul_f32 v[20:21], v[20:21], v[86:87]
  v_pk_mul_f32 v[22:23], v[22:23], v[86:87]
  v_pk_mul_f32 v[24:25], v[24:25], v[86:87]
  v_pk_mul_f32 v[26:27], v[26:27], v[86:87]
  v_pk_mul_f32 v[28:29], v[28:29], v[86:87]
  v_pk_mul_f32 v[30:31], v[30:31], v[86:87]
  v_pk_mul_f32 v[32:33], v[32:33], v[86:87]
  v_pk_mul_f32 v[34:35], v[34:35], v[86:87]
  v_pk_mul_f32 v[36:37], v[36:37], v[86:87]
  v_pk_mul_f32 v[38:39], v[38:39], v[86:87]
  v_pk_mul_f32 v[40:41], v[40:41], v[86:87]
  v_cvt_pk_bf16_f32 v164, v2, v3
  v_lshlrev_b32 v2, 16, v164
  v_and_b32 v3, 0xffff0000, v164
  v_cvt_pk_bf16_f32 v165, v4, v5
  v_lshlrev_b32 v4, 16, v165
  v_and_b32 v5, 0xffff0000, v165
  v_cvt_pk_bf16_f32 v166, v6, v7
  v_lshlrev_b32 v6, 16, v166
  v_and_b32 v7, 0xffff0000, v166
  v_cvt_pk_bf16_f32 v167, v8, v9
  v_lshlrev_b32 v8, 16, v167
  v_and_b32 v9, 0xffff0000, v167
  v_cvt_pk_bf16_f32 v164, v10, v11
  v_lshlrev_b32 v10, 16, v164
  v_and_b32 v11, 0xffff0000, v164
  v_cvt_pk_bf16_f32 v165, v12, v13
  v_lshlrev_b32 v12, 16, v165
  v_and_b32 v13, 0xffff0000, v165
  v_cvt_pk_bf16_f32 v166, v14, v15
  v_lshlrev_b32 v14, 16, v166
  v_and_b32 v15, 0xffff0000, v166
  v_cvt_pk_bf16_f32 v167, v16, v17
  v_lshlrev_b32 v16, 16, v167
  v_and_b32 v17, 0xffff0000, v167
  v_cvt_pk_bf16_f32 v164, v18, v19
  v_lshlrev_b32 v18, 16, v164
  v_and_b32 v19, 0xffff0000, v164
  v_cvt_pk_bf16_f32 v165, v20, v21
  v_lshlrev_b32 v20, 16, v165
  v_and_b32 v21, 0xffff0000, v165
  v_cvt_pk_bf16_f32 v166, v22, v23
  v_lshlrev_b32 v22, 16, v166
  v_and_b32 v23, 0xffff0000, v166
  v_cvt_pk_bf16_f32 v167, v24, v25
  v_lshlrev_b32 v24, 16, v167
  v_and_b32 v25, 0xffff0000, v167
  v_cvt_pk_bf16_f32 v164, v26, v27
  v_lshlrev_b32 v26, 16, v164
  v_and_b32 v27, 0xffff0000, v164
  v_cvt_pk_bf16_f32 v165, v28, v29
  v_lshlrev_b32 v28, 16, v165
  v_and_b32 v29, 0xffff0000, v165
  v_cvt_pk_bf16_f32 v166, v30, v31
  v_lshlrev_b32 v30, 16, v166
  v_and_b32 v31, 0xffff0000, v166
  v_cvt_pk_bf16_f32 v167, v32, v33
  v_lshlrev_b32 v32, 16, v167
  v_and_b32 v33, 0xffff0000, v167
  v_cvt_pk_bf16_f32 v164, v34, v35
  v_lshlrev_b32 v34, 16, v164
  v_and_b32 v35, 0xffff0000, v164
  v_cvt_pk_bf16_f32 v165, v36, v37
  v_lshlrev_b32 v36, 16, v165
  v_and_b32 v37, 0xffff0000, v165
  v_cvt_pk_bf16_f32 v166, v38, v39
  v_lshlrev_b32 v38, 16, v166
  v_and_b32 v39, 0xffff0000, v166
  v_cvt_pk_bf16_f32 v167, v40, v41
  v_lshlrev_b32 v40, 16, v167
  v_and_b32 v41, 0xffff0000, v167
  v_mul_f32_dpp v2, v176, v2 quad_perm:[2,2,2,2] row_mask:0xf bank_mask:0xf
  v_mul_f32_dpp v3, v177, v3 quad_perm:[2,2,2,2] row_mask:0xf bank_mask:0xf
  v_mul_f32_dpp v4, v178, v4 quad_perm:[2,2,2,2] row_mask:0xf bank_mask:0xf
  v_mul_f32_dpp v5, v179, v5 quad_perm:[2,2,2,2] row_mask:0xf bank_mask:0xf
  v_mul_f32_dpp v6, v176, v6 quad_perm:[3,3,3,3] row_mask:0xf bank_mask:0xf
  v_mul_f32_dpp v7, v177, v7 quad_perm:[3,3,3,3] row_mask:0xf bank_mask:0xf
  v_mul_f32_dpp v8, v178, v8 quad_perm:[3,3,3,3] row_mask:0xf bank_mask:0xf
  v_mul_f32_dpp v9, v179, v9 quad_perm:[3,3,3,3] row_mask:0xf bank_mask:0xf
  v_cvt_pk_bf16_f32 v164, v2, v3
  v_lshlrev_b32 v2, 16, v164
  v_and_b32 v3, 0xffff0000, v164
  v_cvt_pk_bf16_f32 v165, v4, v5
  v_lshlrev_b32 v4, 16, v165
  v_and_b32 v5, 0xffff0000, v165
  v_cvt_pk_bf16_f32 v166, v6, v7
  v_lshlrev_b32 v6, 16, v166
  v_and_b32 v7, 0xffff0000, v166
  v_cvt_pk_bf16_f32 v167, v8, v9
  v_lshlrev_b32 v8, 16, v167
  v_and_b32 v9, 0xffff0000, v167
  v_add_f32_dpp v2, v176, v2 quad_perm:[0,0,0,0] row_mask:0xf bank_mask:0xf
  v_add_f32_dpp v3, v177, v3 quad_perm:[0,0,0,0] row_mask:0xf bank_mask:0xf
  v_add_f32_dpp v4, v178, v4 quad_perm:[0,0,0,0] row_mask:0xf bank_mask:0xf
  v_add_f32_dpp v5, v179, v5 quad_perm:[0,0,0,0] row_mask:0xf bank_mask:0xf
  v_add_f32_dpp v6, v176, v6 quad_perm:[1,1,1,1] row_mask:0xf bank_mask:0xf
  v_add_f32_dpp v7, v177, v7 quad_perm:[1,1,1,1] row_mask:0xf bank_mask:0xf
  v_add_f32_dpp v8, v178, v8 quad_perm:[1,1,1,1] row_mask:0xf bank_mask:0xf
  v_add_f32_dpp v9, v179, v9 quad_perm:[1,1,1,1] row_mask:0xf bank_mask:0xf
  v_cvt_pk_bf16_f32 v196, v2, v3
  v_cvt_pk_bf16_f32 v197, v4, v5
  v_cvt_pk_bf16_f32 v198, v6, v7
  v_cvt_pk_bf16_f32 v199, v8, v9
  s_add_u32 s35, s38, 0
  buffer_store_dwordx4 v[196:199], v161, s[8:11], s35 offen sc1
  v_mul_f32_dpp v10, v180, v10 quad_perm:[2,2,2,2] row_mask:0xf bank_mask:0xf
  v_mul_f32_dpp v11, v181, v11 quad_perm:[2,2,2,2] row_mask:0xf bank_mask:0xf
  v_mul_f32_dpp v12, v182, v12 quad_perm:[2,2,2,2] row_mask:0xf bank_mask:0xf
  v_mul_f32_dpp v13, v183, v13 quad_perm:[2,2,2,2] row_mask:0xf bank_mask:0xf
  v_mul_f32_dpp v14, v180, v14 quad_perm:[3,3,3,3] row_mask:0xf bank_mask:0xf
  v_mul_f32_dpp v15, v181, v15 quad_perm:[3,3,3,3] row_mask:0xf bank_mask:0xf
  v_mul_f32_dpp v16, v182, v16 quad_perm:[3,3,3,3] row_mask:0xf bank_mask:0xf
  v_mul_f32_dpp v17, v183, v17 quad_perm:[3,3,3,3] row_mask:0xf bank_mask:0xf
  v_cvt_pk_bf16_f32 v164, v10, v11
  v_lshlrev_b32 v10, 16, v164
  v_and_b32 v11, 0xffff0000, v164
  v_cvt_pk_bf16_f32 v165, v12, v13
  v_lshlrev_b32 v12, 16, v165
  v_and_b32 v13, 0xffff0000, v165
  v_cvt_pk_bf16_f32 v166, v14, v15
  v_lshlrev_b32 v14, 16, v166
  v_and_b32 v15, 0xffff0000, v166
  v_cvt_pk_bf16_f32 v167, v16, v17
  v_lshlrev_b32 v16, 16, v167
  v_and_b32 v17, 0xffff0000, v167
  v_add_f32_dpp v10, v180, v10 quad_perm:[0,0,0,0] row_mask:0xf bank_mask:0xf
  v_add_f32_dpp v11, v181, v11 quad_perm:[0,0,0,0] row_mask:0xf bank_mask:0xf
  v_add_f32_dpp v12, v182, v12 quad_perm:[0,0,0,0] row_mask:0xf bank_mask:0xf
  v_add_f32_dpp v13, v183, v13 quad_perm:[0,0,0,0] row_mask:0xf bank_mask:0xf
  v_add_f32_dpp v14, v180, v14 quad_perm:[1,1,1,1] row_mask:0xf bank_mask:0xf
  v_add_f32_dpp v15, v181, v15 quad_perm:[1,1,1,1] row_mask:0xf bank_mask:0xf
  v_add_f32_dpp v16, v182, v16 quad_perm:[1,1,1,1] row_mask:0xf bank_mask:0xf
  v_add_f32_dpp v17, v183, v17 quad_perm:[1,1,1,1] row_mask:0xf bank_mask:0xf
  v_cvt_pk_bf16_f32 v200, v10, v11
  v_cvt_pk_bf16_f32 v201, v12, v13
  v_cvt_pk_bf16_f32 v202, v14, v15
  v_cvt_pk_bf16_f32 v203, v16, v17
  s_add_u32 s35, s38, 4096
  buffer_store_dwordx4 v[200:203], v161, s[8:11], s35 offen sc1
  v_mul_f32_dpp v18, v184, v18 quad_perm:[2,2,2,2] row_mask:0xf bank_mask:0xf
  v_mul_f32_dpp v19, v185, v19 quad_perm:[2,2,2,2] row_mask:0xf bank_mask:0xf
  v_mul_f32_dpp v20, v186, v20 quad_perm:[2,2,2,2] row_mask:0xf bank_mask:0xf
  v_mul_f32_dpp v21, v187, v21 quad_perm:[2,2,2,2] row_mask:0xf bank_mask:0xf
  v_mul_f32_dpp v22, v184, v22 quad_perm:[3,3,3,3] row_mask:0xf bank_mask:0xf
  v_mul_f32_dpp v23, v185, v23 quad_perm:[3,3,3,3] row_mask:0xf bank_mask:0xf
  v_mul_f32_dpp v24, v186, v24 quad_perm:[3,3,3,3] row_mask:0xf bank_mask:0xf
  v_mul_f32_dpp v25, v187, v25 quad_perm:[3,3,3,3] row_mask:0xf bank_mask:0xf
  v_cvt_pk_bf16_f32 v164, v18, v19
  v_lshlrev_b32 v18, 16, v164
  v_and_b32 v19, 0xffff0000, v164
  v_cvt_pk_bf16_f32 v165, v20, v21
  v_lshlrev_b32 v20, 16, v165
  v_and_b32 v21, 0xffff0000, v165
  v_cvt_pk_bf16_f32 v166, v22, v23
  v_lshlrev_b32 v22, 16, v166
  v_and_b32 v23, 0xffff0000, v166
  v_cvt_pk_bf16_f32 v167, v24, v25
  v_lshlrev_b32 v24, 16, v167
  v_and_b32 v25, 0xffff0000, v167
  v_add_f32_dpp v18, v184, v18 quad_perm:[0,0,0,0] row_mask:0xf bank_mask:0xf
  v_add_f32_dpp v19, v185, v19 quad_perm:[0,0,0,0] row_mask:0xf bank_mask:0xf
  v_add_f32_dpp v20, v186, v20 quad_perm:[0,0,0,0] row_mask:0xf bank_mask:0xf
  v_add_f32_dpp v21, v187, v21 quad_perm:[0,0,0,0] row_mask:0xf bank_mask:0xf
  v_add_f32_dpp v22, v184, v22 quad_perm:[1,1,1,1] row_mask:0xf bank_mask:0xf
  v_add_f32_dpp v23, v185, v23 quad_perm:[1,1,1,1] row_mask:0xf bank_mask:0xf
  v_add_f32_dpp v24, v186, v24 quad_perm:[1,1,1,1] row_mask:0xf bank_mask:0xf
  v_add_f32_dpp v25, v187, v25 quad_perm:[1,1,1,1] row_mask:0xf bank_mask:0xf
  v_cvt_pk_bf16_f32 v204, v18, v19
  v_cvt_pk_bf16_f32 v205, v20, v21
  v_cvt_pk_bf16_f32 v206, v22, v23
  v_cvt_pk_bf16_f32 v207, v24, v25
  s_add_u32 s35, s38, 8192
  buffer_store_dwordx4 v[204:207], v161, s[8:11], s35 offen sc1
  v_mul_f32_dpp v26, v188, v26 quad_perm:[2,2,2,2] row_mask:0xf bank_mask:0xf
  v_mul_f32_dpp v27, v189, v27 quad_perm:[2,2,2,2] row_mask:0xf bank_mask:0xf
  v_mul_f32_dpp v28, v190, v28 quad_perm:[2,2,2,2] row_mask:0xf bank_mask:0xf
  v_mul_f32_dpp v29, v191, v29 quad_perm:[2,2,2,2] row_mask:0xf bank_mask:0xf
  v_mul_f32_dpp v30, v188, v30 quad_perm:[3,3,3,3] row_mask:0xf bank_mask:0xf
  v_mul_f32_dpp v31, v189, v31 quad_perm:[3,3,3,3] row_mask:0xf bank_mask:0xf
  v_mul_f32_dpp v32, v190, v32 quad_perm:[3,3,3,3] row_mask:0xf bank_mask:0xf
  v_mul_f32_dpp v33, v191, v33 quad_perm:[3,3,3,3] row_mask:0xf bank_mask:0xf
  v_cvt_pk_bf16_f32 v164, v26, v27
  v_lshlrev_b32 v26, 16, v164
  v_and_b32 v27, 0xffff0000, v164
  v_cvt_pk_bf16_f32 v165, v28, v29
  v_lshlrev_b32 v28, 16, v165
  v_and_b32 v29, 0xffff0000, v165
  v_cvt_pk_bf16_f32 v166, v30, v31
  v_lshlrev_b32 v30, 16, v166
  v_and_b32 v31, 0xffff0000, v166
  v_cvt_pk_bf16_f32 v167, v32, v33
  v_lshlrev_b32 v32, 16, v167
  v_and_b32 v33, 0xffff0000, v167
  v_add_f32_dpp v26, v188, v26 quad_perm:[0,0,0,0] row_mask:0xf bank_mask:0xf
  v_add_f32_dpp v27, v189, v27 quad_perm:[0,0,0,0] row_mask:0xf bank_mask:0xf
  v_add_f32_dpp v28, v190, v28 quad_perm:[0,0,0,0] row_mask:0xf bank_mask:0xf
  v_add_f32_dpp v29, v191, v29 quad_perm:[0,0,0,0] row_mask:0xf bank_mask:0xf
  v_add_f32_dpp v30, v188, v30 quad_perm:[1,1,1,1] row_mask:0xf bank_mask:0xf
  v_add_f32_dpp v31, v189, v31 quad_perm:[1,1,1,1] row_mask:0xf bank_mask:0xf
  v_add_f32_dpp v32, v190, v32 quad_perm:[1,1,1,1] row_mask:0xf bank_mask:0xf
  v_add_f32_dpp v33, v191, v33 quad_perm:[1,1,1,1] row_mask:0xf bank_mask:0xf
  v_cvt_pk_bf16_f32 v208, v26, v27
  v_cvt_pk_bf16_f32 v209, v28, v29
  v_cvt_pk_bf16_f32 v210, v30, v31
  v_cvt_pk_bf16_f32 v211, v32, v33
  s_add_u32 s35, s38, 12288
  buffer_store_dwordx4 v[208:211], v161, s[8:11], s35 offen sc1
  v_mul_f32_dpp v34, v192, v34 quad_perm:[2,2,2,2] row_mask:0xf bank_mask:0xf
  v_mul_f32_dpp v35, v193, v35 quad_perm:[2,2,2,2] row_mask:0xf bank_mask:0xf
  v_mul_f32_dpp v36, v194, v36 quad_perm:[2,2,2,2] row_mask:0xf bank_mask:0xf
  v_mul_f32_dpp v37, v195, v37 quad_perm:[2,2,2,2] row_mask:0xf bank_mask:0xf
  v_mul_f32_dpp v38, v192, v38 quad_perm:[3,3,3,3] row_mask:0xf bank_mask:0xf
  v_mul_f32_dpp v39, v193, v39 quad_perm:[3,3,3,3] row_mask:0xf bank_mask:0xf
  v_mul_f32_dpp v40, v194, v40 quad_perm:[3,3,3,3] row_mask:0xf bank_mask:0xf
  v_mul_f32_dpp v41, v195, v41 quad_perm:[3,3,3,3] row_mask:0xf bank_mask:0xf
  v_cvt_pk_bf16_f32 v164, v34, v35
  v_lshlrev_b32 v34, 16, v164
  v_and_b32 v35, 0xffff0000, v164
  v_cvt_pk_bf16_f32 v165, v36, v37
  v_lshlrev_b32 v36, 16, v165
  v_and_b32 v37, 0xffff0000, v165
  v_cvt_pk_bf16_f32 v166, v38, v39
  v_lshlrev_b32 v38, 16, v166
  v_and_b32 v39, 0xffff0000, v166
  v_cvt_pk_bf16_f32 v167, v40, v41
  v_lshlrev_b32 v40, 16, v167
  v_and_b32 v41, 0xffff0000, v167
  v_add_f32_dpp v34, v192, v34 quad_perm:[0,0,0,0] row_mask:0xf bank_mask:0xf
  v_add_f32_dpp v35, v193, v35 quad_perm:[0,0,0,0] row_mask:0xf bank_mask:0xf
  v_add_f32_dpp v36, v194, v36 quad_perm:[0,0,0,0] row_mask:0xf bank_mask:0xf
  v_add_f32_dpp v37, v195, v37 quad_perm:[0,0,0,0] row_mask:0xf bank_mask:0xf
  v_add_f32_dpp v38, v192, v38 quad_perm:[1,1,1,1] row_mask:0xf bank_mask:0xf
  v_add_f32_dpp v39, v193, v39 quad_perm:[1,1,1,1] row_mask:0xf bank_mask:0xf
  v_add_f32_dpp v40, v194, v40 quad_perm:[1,1,1,1] row_mask:0xf bank_mask:0xf
  v_add_f32_dpp v41, v195, v41 quad_perm:[1,1,1,1] row_mask:0xf bank_mask:0xf
  v_cvt_pk_bf16_f32 v212, v34, v35
  v_cvt_pk_bf16_f32 v213, v36, v37
  v_cvt_pk_bf16_f32 v214, v38, v39
  v_cvt_pk_bf16_f32 v215, v40, v41
  s_add_u32 s35, s38, 16384
  buffer_store_dwordx4 v[212:215], v161, s[8:11], s35 offen sc1
  s_add_u32 s36, s41, 24
  s_cmp_lt_u32 s41, 24
  s_cselect_b32 s36, s39, s36
  s_add_u32 s41, s41, 3
  s_cmp_lt_u32 s41, 24
  s_cselect_b32 s41, s41, s36
  s_min_u32 s41, s41, 127
  s_mul_i32 s38, s16, 2621440
  s_cmp_lt_u32 s41, 24
  s_cselect_b32 s38, s38, 0
  s_mul_i32 s36, s41, 20480
  s_add_u32 s38, s38, s36
  s_lshl_b32 s36, s17, 6
  s_add_u32 s38, s38, s36
  s_add_u32 s38, s38, 247463936
  s_add_u32 s33, s33, 3
  buffer_load_dwordx2 v[140:141], v160, s[20:23], s37 offen offset:0
  buffer_load_dwordx2 v[142:143], v160, s[20:23], s37 offen offset:32
  buffer_load_dwordx2 v[144:145], v160, s[20:23], s37 offen offset:256
  buffer_load_dwordx2 v[146:147], v160, s[20:23], s37 offen offset:288
  buffer_load_dwordx2 v[148:149], v160, s[20:23], s37 offen offset:512
  buffer_load_dwordx2 v[150:151], v160, s[20:23], s37 offen offset:544
  buffer_load_dwordx2 v[152:153], v160, s[20:23], s37 offen offset:768
  buffer_load_dwordx2 v[154:155], v160, s[20:23], s37 offen offset:800
  buffer_load_dwordx2 v[156:157], v160, s[20:23], s37 offen offset:1024
  buffer_load_dwordx2 v[158:159], v160, s[20:23], s37 offen offset:1056
  s_add_u32 s36, s40, 24
  s_cmp_lt_u32 s40, 24
  s_cselect_b32 s36, s39, s36
  s_add_u32 s40, s40, 3
  s_cmp_lt_u32 s40, 24
  s_cselect_b32 s40, s40, s36
  s_min_u32 s40, s40, 127
  s_mul_i32 s37, s40, 20480
  s_mul_i32 s36, s17, 5120
  s_add_u32 s37, s37, s36
  s_cmp_lt_u32 s33, 39
  s_cbranch_scc0 r_ln1e
  v_lshlrev_b32 v2, 16, v46
  v_and_b32 v3, 0xffff0000, v46
  v_lshlrev_b32 v4, 16, v47
  v_and_b32 v5, 0xffff0000, v47
  v_lshlrev_b32 v6, 16, v48
  v_and_b32 v7, 0xffff0000, v48
  v_lshlrev_b32 v8, 16, v49
  v_and_b32 v9, 0xffff0000, v49
  v_lshlrev_b32 v10, 16, v50
  v_and_b32 v11, 0xffff0000, v50
  v_lshlrev_b32 v12, 16, v51
  v_and_b32 v13, 0xffff0000, v51
  v_lshlrev_b32 v14, 16, v52
  v_and_b32 v15, 0xffff0000, v52
  v_lshlrev_b32 v16, 16, v53
  v_and_b32 v17, 0xffff0000, v53
  v_lshlrev_b32 v18, 16, v54
  v_and_b32 v19, 0xffff0000, v54
  v_lshlrev_b32 v20, 16, v55
  v_and_b32 v21, 0xffff0000, v55
  v_lshlrev_b32 v22, 16, v56
  v_and_b32 v23, 0xffff0000, v56
  v_lshlrev_b32 v24, 16, v57
  v_and_b32 v25, 0xffff0000, v57
  v_lshlrev_b32 v26, 16, v58
  v_and_b32 v27, 0xffff0000, v58
  v_lshlrev_b32 v28, 16, v59
  v_and_b32 v29, 0xffff0000, v59
  v_lshlrev_b32 v30, 16, v60
  v_and_b32 v31, 0xffff0000, v60
  v_lshlrev_b32 v32, 16, v61
  v_and_b32 v33, 0xffff0000, v61
  v_lshlrev_b32 v34, 16, v62
  v_and_b32 v35, 0xffff0000, v62
  v_lshlrev_b32 v36, 16, v63
  v_and_b32 v37, 0xffff0000, v63
  v_lshlrev_b32 v38, 16, v64
  v_and_b32 v39, 0xffff0000, v64
  v_lshlrev_b32 v40, 16, v65
  v_and_b32 v41, 0xffff0000, v65
  v_pk_add_f32 v[86:87], v[2:3], v[4:5]
  v_pk_add_f32 v[88:89], v[6:7], v[8:9]
  v_pk_add_f32 v[86:87], v[86:87], v[10:11]
  v_pk_add_f32 v[88:89], v[88:89], v[12:13]
  v_pk_add_f32 v[86:87], v[86:87], v[14:15]
  v_pk_add_f32 v[88:89], v[88:89], v[16:17]
  v_pk_add_f32 v[86:87], v[86:87], v[18:19]
  v_pk_add_f32 v[88:89], v[88:89], v[20:21]
  v_pk_add_f32 v[86:87], v[86:87], v[22:23]
  v_pk_add_f32 v[88:89], v[88:89], v[24:25]
  v_pk_add_f32 v[86:87], v[86:87], v[26:27]
  v_pk_add_f32 v[88:89], v[88:89], v[28:29]
  v_pk_add_f32 v[86:87], v[86:87], v[30:31]
  v_pk_add_f32 v[88:89], v[88:89], v[32:33]
  v_pk_add_f32 v[86:87], v[86:87], v[34:35]
  v_pk_add_f32 v[88:89], v[88:89], v[36:37]
  v_pk_add_f32 v[86:87], v[86:87], v[38:39]
  v_pk_add_f32 v[88:89], v[88:89], v[40:41]
  v_pk_add_f32 v[86:87], v[86:87], v[88:89]
  v_add_f32 v86, v86, v87
  s_nop 1
  v_add_f32_dpp v86, v86, v86 row_ror:8 row_mask:0xf bank_mask:0xf
  s_nop 1
  v_add_f32_dpp v86, v86, v86 row_ror:4 row_mask:0xf bank_mask:0xf
  v_mov_b32 v90, v86
  s_nop 1
  v_permlane16_swap_b32 v86, v90
  v_add_f32 v86, v86, v90
  v_mov_b32 v90, v86
  s_nop 1
  v_permlane32_swap_b32 v86, v90
  v_add_f32 v86, v86, v90
  v_mul_f32 v88, 0xbacccccd, v86
  v_mul_f32 v89, 0xbacccccd, v86
  v_pk_add_f32 v[164:165], v[2:3], v[88:89]
  v_pk_add_f32 v[166:167], v[4:5], v[88:89]
  v_pk_mul_f32 v[170:171], v[164:165], v[164:165]
  v_pk_add_f32 v[168:169], v[6:7], v[88:89]
  v_pk_mul_f32 v[86:87], v[166:167], v[166:167]
  v_pk_add_f32 v[164:165], v[8:9], v[88:89]
  v_pk_fma_f32 v[170:171], v[168:169], v[168:169], v[170:171]
  v_pk_add_f32 v[166:167], v[10:11], v[88:89]
  v_pk_fma_f32 v[86:87], v[164:165], v[164:165], v[86:87]
  v_pk_add_f32 v[168:169], v[12:13], v[88:89]
  v_pk_fma_f32 v[170:171], v[166:167], v[166:167], v[170:171]
  v_pk_add_f32 v[164:165], v[14:15], v[88:89]
  v_pk_fma_f32 v[86:87], v[168:169], v[168:169], v[86:87]
  v_pk_add_f32 v[166:167], v[16:17], v[88:89]
  v_pk_fma_f32 v[170:171], v[164:165], v[164:165], v[170:171]
  v_pk_add_f32 v[168:169], v[18:19], v[88:89]
  v_pk_fma_f32 v[86:87], v[166:167], v[166:167], v[86:87]
  v_pk_add_f32 v[164:165], v[20:21], v[88:89]
  v_pk_fma_f32 v[170:171], v[168:169], v[168:169], v[170:171]
  v_pk_add_f32 v[166:167], v[22:23], v[88:89]
  v_pk_fma_f32 v[86:87], v[164:165], v[164:165], v[86:87]
  v_pk_add_f32 v[168:169], v[24:25], v[88:89]
  v_pk_fma_f32 v[170:171], v[166:167], v[166:167], v[170:171]
  v_pk_add_f32 v[164:165], v[26:27], v[88:89]
  v_pk_fma_f32 v[86:87], v[168:169], v[168:169], v[86:87]
  v_pk_add_f32 v[166:167], v[28:29], v[88:89]
  v_pk_fma_f32 v[170:171], v[164:165], v[164:165], v[170:171]
  v_pk_add_f32 v[168:169], v[30:31], v[88:89]
  v_pk_fma_f32 v[86:87], v[166:167], v[166:167], v[86:87]
  v_pk_add_f32 v[164:165], v[32:33], v[88:89]
  v_pk_fma_f32 v[170:171], v[168:169], v[168:169], v[170:171]
  v_pk_add_f32 v[166:167], v[34:35], v[88:89]
  v_pk_fma_f32 v[86:87], v[164:165], v[164:165], v[86:87]
  v_pk_add_f32 v[168:169], v[36:37], v[88:89]
  v_pk_fma_f32 v[170:171], v[166:167], v[166:167], v[170:171]
  v_pk_add_f32 v[164:165], v[38:39], v[88:89]
  v_pk_fma_f32 v[86:87], v[168:169], v[168:169], v[86:87]
  v_pk_add_f32 v[166:167], v[40:41], v[88:89]
  v_pk_fma_f32 v[170:171], v[164:165], v[164:165], v[170:171]
  v_pk_fma_f32 v[86:87], v[166:167], v[166:167], v[86:87]
  v_cvt_pk_bf16_f32 v91, v88, v89
  v_lshlrev_b32 v88, 16, v91
  v_and_b32 v89, 0xffff0000, v91
  v_pk_add_f32 v[86:87], v[86:87], v[170:171]
  v_add_f32 v86, v86, v87
  s_nop 1
  v_add_f32_dpp v86, v86, v86 row_ror:8 row_mask:0xf bank_mask:0xf
  s_nop 1
  v_add_f32_dpp v86, v86, v86 row_ror:4 row_mask:0xf bank_mask:0xf
  v_mov_b32 v90, v86
  s_nop 1
  v_permlane16_swap_b32 v86, v90
  v_add_f32 v86, v86, v90
  v_mov_b32 v90, v86
  s_nop 1
  v_permlane32_swap_b32 v86, v90
  v_add_f32 v86, v86, v90
  v_pk_add_f32 v[2:3], v[2:3], v[88:89]
  v_mul_f32 v86, 0x3acccccd, v86
  v_pk_add_f32 v[4:5], v[4:5], v[88:89]
  v_cvt_pk_bf16_f32 v86, v86, v86
  v_pk_add_f32 v[6:7], v[6:7], v[88:89]
  v_lshlrev_b32 v86, 16, v86
  v_pk_add_f32 v[8:9], v[8:9], v[88:89]
  v_add_f32 v86, 0x3727c5ac, v86
  v_pk_add_f32 v[10:11], v[10:11], v[88:89]
  v_cvt_pk_bf16_f32 v86, v86, v86
  v_pk_add_f32 v[12:13], v[12:13], v[88:89]
  v_lshlrev_b32 v86, 16, v86
  v_pk_add_f32 v[14:15], v[14:15], v[88:89]
  v_sqrt_f32 v86, v86
  v_pk_add_f32 v[16:17], v[16:17], v[88:89]
  v_cvt_pk_bf16_f32 v86, v86, v86
  v_pk_add_f32 v[18:19], v[18:19], v[88:89]
  v_lshlrev_b32 v86, 16, v86
  v_pk_add_f32 v[20:21], v[20:21], v[88:89]
  v_rcp_f32 v86, v86
  v_pk_add_f32 v[22:23], v[22:23], v[88:89]
  v_mov_b32 v87, v86
  v_pk_add_f32 v[24:25], v[24:25], v[88:89]
  v_pk_add_f32 v[26:27], v[26:27], v[88:89]
  v_pk_add_f32 v[28:29], v[28:29], v[88:89]
  v_pk_add_f32 v[30:31], v[30:31], v[88:89]
  v_pk_add_f32 v[32:33], v[32:33], v[88:89]
  v_pk_add_f32 v[34:35], v[34:35], v[88:89]
  v_pk_add_f32 v[36:37], v[36:37], v[88:89]
  v_pk_add_f32 v[38:39], v[38:39], v[88:89]
  v_pk_add_f32 v[40:41], v[40:41], v[88:89]
  v_cvt_pk_bf16_f32 v164, v2, v3
  v_lshlrev_b32 v2, 16, v164
  v_and_b32 v3, 0xffff0000, v164
  v_cvt_pk_bf16_f32 v165, v4, v5
  v_lshlrev_b32 v4, 16, v165
  v_and_b32 v5, 0xffff0000, v165
  v_cvt_pk_bf16_f32 v166, v6, v7
  v_lshlrev_b32 v6, 16, v166
  v_and_b32 v7, 0xffff0000, v166
  v_cvt_pk_bf16_f32 v167, v8, v9
  v_lshlrev_b32 v8, 16, v167
  v_and_b32 v9, 0xffff0000, v167
  v_cvt_pk_bf16_f32 v164, v10, v11
  v_lshlrev_b32 v10, 16, v164
  v_and_b32 v11, 0xffff0000, v164
  v_cvt_pk_bf16_f32 v165, v12, v13
  v_lshlrev_b32 v12, 16, v165
  v_and_b32 v13, 0xffff0000, v165
  v_cvt_pk_bf16_f32 v166, v14, v15
  v_lshlrev_b32 v14, 16, v166
  v_and_b32 v15, 0xffff0000, v166
  v_cvt_pk_bf16_f32 v167, v16, v17
  v_lshlrev_b32 v16, 16, v167
  v_and_b32 v17, 0xffff0000, v167
  v_cvt_pk_bf16_f32 v164, v18, v19
  v_lshlrev_b32 v18, 16, v164
  v_and_b32 v19, 0xffff0000, v164
  v_cvt_pk_bf16_f32 v165, v20, v21
  v_lshlrev_b32 v20, 16, v165
  v_and_b32 v21, 0xffff0000, v165
  v_cvt_pk_bf16_f32 v166, v22, v23
  v_lshlrev_b32 v22, 16, v166
  v_and_b32 v23, 0xffff0000, v166
  v_cvt_pk_bf16_f32 v167, v24, v25
  v_lshlrev_b32 v24, 16, v167
  v_and_b32 v25, 0xffff0000, v167
  v_cvt_pk_bf16_f32 v164, v26, v27
  v_lshlrev_b32 v26, 16, v164
  v_and_b32 v27, 0xffff0000, v164
  v_cvt_pk_bf16_f32 v165, v28, v29
  v_lshlrev_b32 v28, 16, v165
  v_and_b32 v29, 0xffff0000, v165
  v_cvt_pk_bf16_f32 v166, v30, v31
  v_lshlrev_b32 v30, 16, v166
  v_and_b32 v31, 0xffff0000, v166
  v_cvt_pk_bf16_f32 v167, v32, v33
  v_lshlrev_b32 v32, 16, v167
  v_and_b32 v33, 0xffff0000, v167
  v_cvt_pk_bf16_f32 v164, v34, v35
  v_lshlrev_b32 v34, 16, v164
  v_and_b32 v35, 0xffff0000, v164
  v_cvt_pk_bf16_f32 v165, v36, v37
  v_lshlrev_b32 v36, 16, v165
  v_and_b32 v37, 0xffff0000, v165
  v_cvt_pk_bf16_f32 v166, v38, v39
  v_lshlrev_b32 v38, 16, v166
  v_and_b32 v39, 0xffff0000, v166
  v_cvt_pk_bf16_f32 v167, v40, v41
  v_lshlrev_b32 v40, 16, v167
  v_and_b32 v41, 0xffff0000, v167
  s_sub_u32 s36, s33, 0
  s_min_u32 s36, s36, 24
  v_mov_b32 v92, s36
  s_waitcnt vmcnt(10)
  buffer_store_dword v92, v228, s[8:11], 0 offen
  v_pk_mul_f32 v[2:3], v[2:3], v[86:87]
  v_pk_mul_f32 v[4:5], v[4:5], v[86:87]
  v_pk_mul_f32 v[6:7], v[6:7], v[86:87]
  v_pk_mul_f32 v[8:9], v[8:9], v[86:87]
  v_pk_mul_f32 v[10:11], v[10:11], v[86:87]
  v_pk_mul_f32 v[12:13], v[12:13], v[86:87]
  v_pk_mul_f32 v[14:15], v[14:15], v[86:87]
  v_pk_mul_f32 v[16:17], v[16:17], v[86:87]
  v_pk_mul_f32 v[18:19], v[18:19], v[86:87]
  v_pk_mul_f32 v[20:21], v[20:21], v[86:87]
  v_pk_mul_f32 v[22:23], v[22:23], v[86:87]
  v_pk_mul_f32 v[24:25], v[24:25], v[86:87]
  v_pk_mul_f32 v[26:27], v[26:27], v[86:87]
  v_pk_mul_f32 v[28:29], v[28:29], v[86:87]
  v_pk_mul_f32 v[30:31], v[30:31], v[86:87]
  v_pk_mul_f32 v[32:33], v[32:33], v[86:87]
  v_pk_mul_f32 v[34:35], v[34:35], v[86:87]
  v_pk_mul_f32 v[36:37], v[36:37], v[86:87]
  v_pk_mul_f32 v[38:39], v[38:39], v[86:87]
  v_pk_mul_f32 v[40:41], v[40:41], v[86:87]
  v_cvt_pk_bf16_f32 v164, v2, v3
  v_lshlrev_b32 v2, 16, v164
  v_and_b32 v3, 0xffff0000, v164
  v_cvt_pk_bf16_f32 v165, v4, v5
  v_lshlrev_b32 v4, 16, v165
  v_and_b32 v5, 0xffff0000, v165
  v_cvt_pk_bf16_f32 v166, v6, v7
  v_lshlrev_b32 v6, 16, v166
  v_and_b32 v7, 0xffff0000, v166
  v_cvt_pk_bf16_f32 v167, v8, v9
  v_lshlrev_b32 v8, 16, v167
  v_and_b32 v9, 0xffff0000, v167
  v_cvt_pk_bf16_f32 v164, v10, v11
  v_lshlrev_b32 v10, 16, v164
  v_and_b32 v11, 0xffff0000, v164
  v_cvt_pk_bf16_f32 v165, v12, v13
  v_lshlrev_b32 v12, 16, v165
  v_and_b32 v13, 0xffff0000, v165
  v_cvt_pk_bf16_f32 v166, v14, v15
  v_lshlrev_b32 v14, 16, v166
  v_and_b32 v15, 0xffff0000, v166
  v_cvt_pk_bf16_f32 v167, v16, v17
  v_lshlrev_b32 v16, 16, v167
  v_and_b32 v17, 0xffff0000, v167
  v_cvt_pk_bf16_f32 v164, v18, v19
  v_lshlrev_b32 v18, 16, v164
  v_and_b32 v19, 0xffff0000, v164
  v_cvt_pk_bf16_f32 v165, v20, v21
  v_lshlrev_b32 v20, 16, v165
  v_and_b32 v21, 0xffff0000, v165
  v_cvt_pk_bf16_f32 v166, v22, v23
  v_lshlrev_b32 v22, 16, v166
  v_and_b32 v23, 0xffff0000, v166
  v_cvt_pk_bf16_f32 v167, v24, v25
  v_lshlrev_b32 v24, 16, v167
  v_and_b32 v25, 0xffff0000, v167
  v_cvt_pk_bf16_f32 v164, v26, v27
  v_lshlrev_b32 v26, 16, v164
  v_and_b32 v27, 0xffff0000, v164
  v_cvt_pk_bf16_f32 v165, v28, v29
  v_lshlrev_b32 v28, 16, v165
  v_and_b32 v29, 0xffff0000, v165
  v_cvt_pk_bf16_f32 v166, v30, v31
  v_lshlrev_b32 v30, 16, v166
  v_and_b32 v31, 0xffff0000, v166
  v_cvt_pk_bf16_f32 v167, v32, v33
  v_lshlrev_b32 v32, 16, v167
  v_and_b32 v33, 0xffff0000, v167
  v_cvt_pk_bf16_f32 v164, v34, v35
  v_lshlrev_b32 v34, 16, v164
  v_and_b32 v35, 0xffff0000, v164
  v_cvt_pk_bf16_f32 v165, v36, v37
  v_lshlrev_b32 v36, 16, v165
  v_and_b32 v37, 0xffff0000, v165
  v_cvt_pk_bf16_f32 v166, v38, v39
  v_lshlrev_b32 v38, 16, v166
  v_and_b32 v39, 0xffff0000, v166
  v_cvt_pk_bf16_f32 v167, v40, v41
  v_lshlrev_b32 v40, 16, v167
  v_and_b32 v41, 0xffff0000, v167
  v_mul_f32_dpp v2, v176, v2 quad_perm:[2,2,2,2] row_mask:0xf bank_mask:0xf
  v_mul_f32_dpp v3, v177, v3 quad_perm:[2,2,2,2] row_mask:0xf bank_mask:0xf
  v_mul_f32_dpp v4, v178, v4 quad_perm:[2,2,2,2] row_mask:0xf bank_mask:0xf
  v_mul_f32_dpp v5, v179, v5 quad_perm:[2,2,2,2] row_mask:0xf bank_mask:0xf
  v_mul_f32_dpp v6, v176, v6 quad_perm:[3,3,3,3] row_mask:0xf bank_mask:0xf
  v_mul_f32_dpp v7, v177, v7 quad_perm:[3,3,3,3] row_mask:0xf bank_mask:0xf
  v_mul_f32_dpp v8, v178, v8 quad_perm:[3,3,3,3] row_mask:0xf bank_mask:0xf
  v_mul_f32_dpp v9, v179, v9 quad_perm:[3,3,3,3] row_mask:0xf bank_mask:0xf
  v_cvt_pk_bf16_f32 v164, v2, v3
  v_lshlrev_b32 v2, 16, v164
  v_and_b32 v3, 0xffff0000, v164
  v_cvt_pk_bf16_f32 v165, v4, v5
  v_lshlrev_b32 v4, 16, v165
  v_and_b32 v5, 0xffff0000, v165
  v_cvt_pk_bf16_f32 v166, v6, v7
  v_lshlrev_b32 v6, 16, v166
  v_and_b32 v7, 0xffff0000, v166
  v_cvt_pk_bf16_f32 v167, v8, v9
  v_lshlrev_b32 v8, 16, v167
  v_and_b32 v9, 0xffff0000, v167
  v_add_f32_dpp v2, v176, v2 quad_perm:[0,0,0,0] row_mask:0xf bank_mask:0xf
  v_add_f32_dpp v3, v177, v3 quad_perm:[0,0,0,0] row_mask:0xf bank_mask:0xf
  v_add_f32_dpp v4, v178, v4 quad_perm:[0,0,0,0] row_mask:0xf bank_mask:0xf
  v_add_f32_dpp v5, v179, v5 quad_perm:[0,0,0,0] row_mask:0xf bank_mask:0xf
  v_add_f32_dpp v6, v176, v6 quad_perm:[1,1,1,1] row_mask:0xf bank_mask:0xf
  v_add_f32_dpp v7, v177, v7 quad_perm:[1,1,1,1] row_mask:0xf bank_mask:0xf
  v_add_f32_dpp v8, v178, v8 quad_perm:[1,1,1,1] row_mask:0xf bank_mask:0xf
  v_add_f32_dpp v9, v179, v9 quad_perm:[1,1,1,1] row_mask:0xf bank_mask:0xf
  v_cvt_pk_bf16_f32 v196, v2, v3
  v_cvt_pk_bf16_f32 v197, v4, v5
  v_cvt_pk_bf16_f32 v198, v6, v7
  v_cvt_pk_bf16_f32 v199, v8, v9
  s_add_u32 s35, s38, 0
  buffer_store_dwordx4 v[196:199], v161, s[8:11], s35 offen sc1
  v_mul_f32_dpp v10, v180, v10 quad_perm:[2,2,2,2] row_mask:0xf bank_mask:0xf
  v_mul_f32_dpp v11, v181, v11 quad_perm:[2,2,2,2] row_mask:0xf bank_mask:0xf
  v_mul_f32_dpp v12, v182, v12 quad_perm:[2,2,2,2] row_mask:0xf bank_mask:0xf
  v_mul_f32_dpp v13, v183, v13 quad_perm:[2,2,2,2] row_mask:0xf bank_mask:0xf
  v_mul_f32_dpp v14, v180, v14 quad_perm:[3,3,3,3] row_mask:0xf bank_mask:0xf
  v_mul_f32_dpp v15, v181, v15 quad_perm:[3,3,3,3] row_mask:0xf bank_mask:0xf
  v_mul_f32_dpp v16, v182, v16 quad_perm:[3,3,3,3] row_mask:0xf bank_mask:0xf
  v_mul_f32_dpp v17, v183, v17 quad_perm:[3,3,3,3] row_mask:0xf bank_mask:0xf
  v_cvt_pk_bf16_f32 v164, v10, v11
  v_lshlrev_b32 v10, 16, v164
  v_and_b32 v11, 0xffff0000, v164
  v_cvt_pk_bf16_f32 v165, v12, v13
  v_lshlrev_b32 v12, 16, v165
  v_and_b32 v13, 0xffff0000, v165
  v_cvt_pk_bf16_f32 v166, v14, v15
  v_lshlrev_b32 v14, 16, v166
  v_and_b32 v15, 0xffff0000, v166
  v_cvt_pk_bf16_f32 v167, v16, v17
  v_lshlrev_b32 v16, 16, v167
  v_and_b32 v17, 0xffff0000, v167
  v_add_f32_dpp v10, v180, v10 quad_perm:[0,0,0,0] row_mask:0xf bank_mask:0xf
  v_add_f32_dpp v11, v181, v11 quad_perm:[0,0,0,0] row_mask:0xf bank_mask:0xf
  v_add_f32_dpp v12, v182, v12 quad_perm:[0,0,0,0] row_mask:0xf bank_mask:0xf
  v_add_f32_dpp v13, v183, v13 quad_perm:[0,0,0,0] row_mask:0xf bank_mask:0xf
  v_add_f32_dpp v14, v180, v14 quad_perm:[1,1,1,1] row_mask:0xf bank_mask:0xf
  v_add_f32_dpp v15, v181, v15 quad_perm:[1,1,1,1] row_mask:0xf bank_mask:0xf
  v_add_f32_dpp v16, v182, v16 quad_perm:[1,1,1,1] row_mask:0xf bank_mask:0xf
  v_add_f32_dpp v17, v183, v17 quad_perm:[1,1,1,1] row_mask:0xf bank_mask:0xf
  v_cvt_pk_bf16_f32 v200, v10, v11
  v_cvt_pk_bf16_f32 v201, v12, v13
  v_cvt_pk_bf16_f32 v202, v14, v15
  v_cvt_pk_bf16_f32 v203, v16, v17
  s_add_u32 s35, s38, 4096
  buffer_store_dwordx4 v[200:203], v161, s[8:11], s35 offen sc1
  v_mul_f32_dpp v18, v184, v18 quad_perm:[2,2,2,2] row_mask:0xf bank_mask:0xf
  v_mul_f32_dpp v19, v185, v19 quad_perm:[2,2,2,2] row_mask:0xf bank_mask:0xf
  v_mul_f32_dpp v20, v186, v20 quad_perm:[2,2,2,2] row_mask:0xf bank_mask:0xf
  v_mul_f32_dpp v21, v187, v21 quad_perm:[2,2,2,2] row_mask:0xf bank_mask:0xf
  v_mul_f32_dpp v22, v184, v22 quad_perm:[3,3,3,3] row_mask:0xf bank_mask:0xf
  v_mul_f32_dpp v23, v185, v23 quad_perm:[3,3,3,3] row_mask:0xf bank_mask:0xf
  v_mul_f32_dpp v24, v186, v24 quad_perm:[3,3,3,3] row_mask:0xf bank_mask:0xf
  v_mul_f32_dpp v25, v187, v25 quad_perm:[3,3,3,3] row_mask:0xf bank_mask:0xf
  v_cvt_pk_bf16_f32 v164, v18, v19
  v_lshlrev_b32 v18, 16, v164
  v_and_b32 v19, 0xffff0000, v164
  v_cvt_pk_bf16_f32 v165, v20, v21
  v_lshlrev_b32 v20, 16, v165
  v_and_b32 v21, 0xffff0000, v165
  v_cvt_pk_bf16_f32 v166, v22, v23
  v_lshlrev_b32 v22, 16, v166
  v_and_b32 v23, 0xffff0000, v166
  v_cvt_pk_bf16_f32 v167, v24, v25
  v_lshlrev_b32 v24, 16, v167
  v_and_b32 v25, 0xffff0000, v167
  v_add_f32_dpp v18, v184, v18 quad_perm:[0,0,0,0] row_mask:0xf bank_mask:0xf
  v_add_f32_dpp v19, v185, v19 quad_perm:[0,0,0,0] row_mask:0xf bank_mask:0xf
  v_add_f32_dpp v20, v186, v20 quad_perm:[0,0,0,0] row_mask:0xf bank_mask:0xf
  v_add_f32_dpp v21, v187, v21 quad_perm:[0,0,0,0] row_mask:0xf bank_mask:0xf
  v_add_f32_dpp v22, v184, v22 quad_perm:[1,1,1,1] row_mask:0xf bank_mask:0xf
  v_add_f32_dpp v23, v185, v23 quad_perm:[1,1,1,1] row_mask:0xf bank_mask:0xf
  v_add_f32_dpp v24, v186, v24 quad_perm:[1,1,1,1] row_mask:0xf bank_mask:0xf
  v_add_f32_dpp v25, v187, v25 quad_perm:[1,1,1,1] row_mask:0xf bank_mask:0xf
  v_cvt_pk_bf16_f32 v204, v18, v19
  v_cvt_pk_bf16_f32 v205, v20, v21
  v_cvt_pk_bf16_f32 v206, v22, v23
  v_cvt_pk_bf16_f32 v207, v24, v25
  s_add_u32 s35, s38, 8192
  buffer_store_dwordx4 v[204:207], v161, s[8:11], s35 offen sc1
  v_mul_f32_dpp v26, v188, v26 quad_perm:[2,2,2,2] row_mask:0xf bank_mask:0xf
  v_mul_f32_dpp v27, v189, v27 quad_perm:[2,2,2,2] row_mask:0xf bank_mask:0xf
  v_mul_f32_dpp v28, v190, v28 quad_perm:[2,2,2,2] row_mask:0xf bank_mask:0xf
  v_mul_f32_dpp v29, v191, v29 quad_perm:[2,2,2,2] row_mask:0xf bank_mask:0xf
  v_mul_f32_dpp v30, v188, v30 quad_perm:[3,3,3,3] row_mask:0xf bank_mask:0xf
  v_mul_f32_dpp v31, v189, v31 quad_perm:[3,3,3,3] row_mask:0xf bank_mask:0xf
  v_mul_f32_dpp v32, v190, v32 quad_perm:[3,3,3,3] row_mask:0xf bank_mask:0xf
  v_mul_f32_dpp v33, v191, v33 quad_perm:[3,3,3,3] row_mask:0xf bank_mask:0xf
  v_cvt_pk_bf16_f32 v164, v26, v27
  v_lshlrev_b32 v26, 16, v164
  v_and_b32 v27, 0xffff0000, v164
  v_cvt_pk_bf16_f32 v165, v28, v29
  v_lshlrev_b32 v28, 16, v165
  v_and_b32 v29, 0xffff0000, v165
  v_cvt_pk_bf16_f32 v166, v30, v31
  v_lshlrev_b32 v30, 16, v166
  v_and_b32 v31, 0xffff0000, v166
  v_cvt_pk_bf16_f32 v167, v32, v33
  v_lshlrev_b32 v32, 16, v167
  v_and_b32 v33, 0xffff0000, v167
  v_add_f32_dpp v26, v188, v26 quad_perm:[0,0,0,0] row_mask:0xf bank_mask:0xf
  v_add_f32_dpp v27, v189, v27 quad_perm:[0,0,0,0] row_mask:0xf bank_mask:0xf
  v_add_f32_dpp v28, v190, v28 quad_perm:[0,0,0,0] row_mask:0xf bank_mask:0xf
  v_add_f32_dpp v29, v191, v29 quad_perm:[0,0,0,0] row_mask:0xf bank_mask:0xf
  v_add_f32_dpp v30, v188, v30 quad_perm:[1,1,1,1] row_mask:0xf bank_mask:0xf
  v_add_f32_dpp v31, v189, v31 quad_perm:[1,1,1,1] row_mask:0xf bank_mask:0xf
  v_add_f32_dpp v32, v190, v32 quad_perm:[1,1,1,1] row_mask:0xf bank_mask:0xf
  v_add_f32_dpp v33, v191, v33 quad_perm:[1,1,1,1] row_mask:0xf bank_mask:0xf
  v_cvt_pk_bf16_f32 v208, v26, v27
  v_cvt_pk_bf16_f32 v209, v28, v29
  v_cvt_pk_bf16_f32 v210, v30, v31
  v_cvt_pk_bf16_f32 v211, v32, v33
  s_add_u32 s35, s38, 12288
  buffer_store_dwordx4 v[208:211], v161, s[8:11], s35 offen sc1
  v_mul_f32_dpp v34, v192, v34 quad_perm:[2,2,2,2] row_mask:0xf bank_mask:0xf
  v_mul_f32_dpp v35, v193, v35 quad_perm:[2,2,2,2] row_mask:0xf bank_mask:0xf
  v_mul_f32_dpp v36, v194, v36 quad_perm:[2,2,2,2] row_mask:0xf bank_mask:0xf
  v_mul_f32_dpp v37, v195, v37 quad_perm:[2,2,2,2] row_mask:0xf bank_mask:0xf
  v_mul_f32_dpp v38, v192, v38 quad_perm:[3,3,3,3] row_mask:0xf bank_mask:0xf
  v_mul_f32_dpp v39, v193, v39 quad_perm:[3,3,3,3] row_mask:0xf bank_mask:0xf
  v_mul_f32_dpp v40, v194, v40 quad_perm:[3,3,3,3] row_mask:0xf bank_mask:0xf
  v_mul_f32_dpp v41, v195, v41 quad_perm:[3,3,3,3] row_mask:0xf bank_mask:0xf
  v_cvt_pk_bf16_f32 v164, v34, v35
  v_lshlrev_b32 v34, 16, v164
  v_and_b32 v35, 0xffff0000, v164
  v_cvt_pk_bf16_f32 v165, v36, v37
  v_lshlrev_b32 v36, 16, v165
  v_and_b32 v37, 0xffff0000, v165
  v_cvt_pk_bf16_f32 v166, v38, v39
  v_lshlrev_b32 v38, 16, v166
  v_and_b32 v39, 0xffff0000, v166
  v_cvt_pk_bf16_f32 v167, v40, v41
  v_lshlrev_b32 v40, 16, v167
  v_and_b32 v41, 0xffff0000, v167
  v_add_f32_dpp v34, v192, v34 quad_perm:[0,0,0,0] row_mask:0xf bank_mask:0xf
  v_add_f32_dpp v35, v193, v35 quad_perm:[0,0,0,0] row_mask:0xf bank_mask:0xf
  v_add_f32_dpp v36, v194, v36 quad_perm:[0,0,0,0] row_mask:0xf bank_mask:0xf
  v_add_f32_dpp v37, v195, v37 quad_perm:[0,0,0,0] row_mask:0xf bank_mask:0xf
  v_add_f32_dpp v38, v192, v38 quad_perm:[1,1,1,1] row_mask:0xf bank_mask:0xf
  v_add_f32_dpp v39, v193, v39 quad_perm:[1,1,1,1] row_mask:0xf bank_mask:0xf
  v_add_f32_dpp v40, v194, v40 quad_perm:[1,1,1,1] row_mask:0xf bank_mask:0xf
  v_add_f32_dpp v41, v195, v41 quad_perm:[1,1,1,1] row_mask:0xf bank_mask:0xf
  v_cvt_pk_bf16_f32 v212, v34, v35
  v_cvt_pk_bf16_f32 v213, v36, v37
  v_cvt_pk_bf16_f32 v214, v38, v39
  v_cvt_pk_bf16_f32 v215, v40, v41
  s_add_u32 s35, s38, 16384
  buffer_store_dwordx4 v[212:215], v161, s[8:11], s35 offen sc1
  s_add_u32 s36, s41, 24
  s_cmp_lt_u32 s41, 24
  s_cselect_b32 s36, s39, s36
  s_add_u32 s41, s41, 3
  s_cmp_lt_u32 s41, 24
  s_cselect_b32 s41, s41, s36
  s_min_u32 s41, s41, 127
  s_mul_i32 s38, s16, 2621440
  s_cmp_lt_u32 s41, 24
  s_cselect_b32 s38, s38, 0
  s_mul_i32 s36, s41, 20480
  s_add_u32 s38, s38, s36
  s_lshl_b32 s36, s17, 6
  s_add_u32 s38, s38, s36
  s_add_u32 s38, s38, 247463936
  s_add_u32 s33, s33, 3
  buffer_load_dwordx2 v[46:47], v160, s[20:23], s37 offen offset:0
  buffer_load_dwordx2 v[48:49], v160, s[20:23], s37 offen offset:32
  buffer_load_dwordx2 v[50:51], v160, s[20:23], s37 offen offset:256
  buffer_load_dwordx2 v[52:53], v160, s[20:23], s37 offen offset:288
  buffer_load_dwordx2 v[54:55], v160, s[20:23], s37 offen offset:512
  buffer_load_dwordx2 v[56:57], v160, s[20:23], s37 offen offset:544
  buffer_load_dwordx2 v[58:59], v160, s[20:23], s37 offen offset:768
  buffer_load_dwordx2 v[60:61], v160, s[20:23], s37 offen offset:800
  buffer_load_dwordx2 v[62:63], v160, s[20:23], s37 offen offset:1024
  buffer_load_dwordx2 v[64:65], v160, s[20:23], s37 offen offset:1056
  s_add_u32 s36, s40, 24
  s_cmp_lt_u32 s40, 24
  s_cselect_b32 s36, s39, s36
  s_add_u32 s40, s40, 3
  s_cmp_lt_u32 s40, 24
  s_cselect_b32 s40, s40, s36
  s_min_u32 s40, s40, 127
  s_mul_i32 s37, s40, 20480
  s_mul_i32 s36, s17, 5120
  s_add_u32 s37, s37, s36
  s_cmp_lt_u32 s33, 39
  s_cbranch_scc1 r_ln1
r_ln1e:
  s_waitcnt vmcnt(0)
  s_barrier
  s_cmp_lg_u32 s17, 0
  s_cbranch_scc1 r_h1
  v_mov_b32 v90, 204
  v_mov_b32 v91, 1
  s_waitcnt vmcnt(0)
  s_mov_b64 exec, 1
  buffer_atomic_add v91, v90, s[12:15], 0 offen sc1
  s_mov_b64 exec, -1
  s_cmp_lg_u32 s54, 0
  s_cbranch_scc1 r_h1
  v_mov_b32 v90, 204
  s_mov_b32 s34, 0
gw_13:
  buffer_load_dword v91, v90, s[12:15], 0 offen sc1
  s_add_u32 s34, s34, 1
  s_cmp_gt_u32 s34, 65536
  s_cbranch_scc1 role_abort
  s_waitcnt vmcnt(0)
  v_cmp_gt_u32 vcc, 24, v91
  s_cbranch_vccz gk_14
  s_sleep 8
  s_branch gw_13
gk_14:
  v_add_u32 v90, v228, v226
  v_mov_b32 v91, 128
  s_mov_b64 exec, 0xfff
  buffer_store_dword v91, v90, s[8:11], 0 offen
  s_mov_b64 exec, -1
r_h1:
  s_add_u32 s52, s52, 20
r_mod2:
  v_lshlrev_b32 v12, 2, v0
  buffer_load_dword v13, v12, s[44:47], 0 offen
  buffer_load_dword v14, v12, s[44:47], 0 offen offset:1024
  v_lshrrev_b32 v20, 3, v0
  v_and_b32 v21, 7, v0
  v_mul_u32_u24 v22, 153600, v20
  v_lshl_add_u32 v22, v21, 4, v22
  s_lshl_b32 s6, s52, 7
  buffer_load_dwordx4 v[28:31], v22, s[48:51], s6 offen nt
  s_add_u32 s6, s6, 7680
  buffer_load_dwordx4 v[32:35], v22, s[48:51], s6 offen nt
  s_add_u32 s6, s6, 7680
  buffer_load_dwordx4 v[36:39], v22, s[48:51], s6 offen nt
  s_add_u32 s6, s6, 7680
  buffer_load_dwordx4 v[40:43], v22, s[48:51], s6 offen nt
  s_add_u32 s6, s6, 7680
  buffer_load_dwordx4 v[44:47], v22, s[48:51], s6 offen nt
  s_add_u32 s6, s6, 7680
  buffer_load_dwordx4 v[48:51], v22, s[48:51], s6 offen nt
  s_add_u32 s6, s6, 7680
  buffer_load_dwordx4 v[52:55], v22, s[48:51], s6 offen nt
  s_add_u32 s6, s6, 7680
  buffer_load_dwordx4 v[56:59], v22, s[48:51], s6 offen nt
  s_add_u32 s6, s6, 7680
  buffer_load_dwordx4 v[60:63], v22, s[48:51], s6 offen nt
  s_add_u32 s6, s6, 7680
  buffer_load_dwordx4 v[64:67], v22, s[48:51], s6 offen nt
  s_add_u32 s6, s6, 7680
  buffer_load_dwordx4 v[68:71], v22, s[48:51], s6 offen nt
  s_add_u32 s6, s6, 7680
  buffer_load_dwordx4 v[72:75], v22, s[48:51], s6 offen nt
  s_add_u32 s6, s6, 7680
  buffer_load_dwordx4 v[76:79], v22, s[48:51], s6 offen nt
  s_add_u32 s6, s6, 7680
  buffer_load_dwordx4 v[80:83], v22, s[48:51], s6 offen nt
  s_add_u32 s6, s6, 7680
  buffer_load_dwordx4 v[84:87], v22, s[48:51], s6 offen nt
  s_add_u32 s6, s6, 7680
  buffer_load_dwordx4 v[88:91], v22, s[48:51], s6 offen nt
  s_add_u32 s6, s6, 7680
  buffer_load_dwordx4 v[92:95], v22, s[48:51], s6 offen nt
  s_add_u32 s6, s6, 7680
  buffer_load_dwordx4 v[96:99], v22, s[48:51], s6 offen nt
  s_add_u32 s6, s6, 7680
  buffer_load_dwordx4 v[100:103], v22, s[48:51], s6 offen nt
  s_add_u32 s6, s6, 7680
  buffer_load_dwordx4 v[104:107], v22, s[48:51], s6 offen nt
  s_add_u32 s6, s6, 7680
  s_waitcnt vmcnt(20)
  v_lshlrev_b32 v24, 16, v13
  v_and_b32 v25, 0xffff0000, v13
  v_mul_f32 v16, 0xbfb8aa3b, v24
  v_mul_f32 v17, 0xbfb8aa3b, v25
  v_exp_f32 v16, v16
  v_exp_f32 v17, v17
  v_add_f32 v16, 1.0, v16
  v_add_f32 v17, 1.0, v17
  v_rcp_f32 v16, v16
  v_rcp_f32 v17, v17
  v_mul_f32 v24, v24, v16
  v_mul_f32 v25, v25, v17
  v_cvt_pk_bf16_f32 v16, v24, v25
  v_lshlrev_b32 v24, 16, v16
  v_and_b32 v25, 0xffff0000, v16
  v_lshlrev_b32 v26, 16, v14
  v_and_b32 v27, 0xffff0000, v14
  v_mul_f32 v16, 0xbfb8aa3b, v26
  v_mul_f32 v17, 0xbfb8aa3b, v27
  v_exp_f32 v16, v16
  v_exp_f32 v17, v17
  v_add_f32 v16, 1.0, v16
  v_add_f32 v17, 1.0, v17
  v_rcp_f32 v16, v16
  v_rcp_f32 v17, v17
  v_mul_f32 v26, v26, v16
  v_mul_f32 v27, v27, v17
  v_cvt_pk_bf16_f32 v16, v26, v27
  v_lshlrev_b32 v26, 16, v16
  v_and_b32 v27, 0xffff0000, v16
  v_lshlrev_b32 v12, 3, v0
  ds_write_b64 v12, v[24:25]
  ds_write_b64 v12, v[26:27] offset:2048
  v_mul_u32_u24 v12, 80, v20
  s_waitcnt lgkmcnt(0)
  s_barrier
  ds_read_b128 v[108:111], v12 offset:0
  ds_read_b128 v[112:115], v12 offset:16
  ds_read_b128 v[116:119], v12 offset:32
  ds_read_b128 v[120:123], v12 offset:48
  ds_read_b128 v[124:127], v12 offset:64
  v_mov_b32 v148, 0
  v_mov_b32 v149, 0
  v_mov_b32 v150, 0
  v_mov_b32 v151, 0
  v_mov_b32 v152, 0
  v_mov_b32 v153, 0
  v_mov_b32 v154, 0
  v_mov_b32 v155, 0
  s_waitcnt lgkmcnt(0)
  v_lshrrev_b32 v128, 16, v108
  v_lshrrev_b32 v129, 16, v109
  v_lshrrev_b32 v130, 16, v110
  v_lshrrev_b32 v131, 16, v111
  v_lshrrev_b32 v132, 16, v112
  v_lshrrev_b32 v133, 16, v113
  v_lshrrev_b32 v134, 16, v114
  v_lshrrev_b32 v135, 16, v115
  v_lshrrev_b32 v136, 16, v116
  v_lshrrev_b32 v137, 16, v117
  v_lshrrev_b32 v138, 16, v118
  v_lshrrev_b32 v139, 16, v119
  v_lshrrev_b32 v140, 16, v120
  v_lshrrev_b32 v141, 16, v121
  v_lshrrev_b32 v142, 16, v122
  v_lshrrev_b32 v143, 16, v123
  v_lshrrev_b32 v144, 16, v124
  v_lshrrev_b32 v145, 16, v125
  v_lshrrev_b32 v146, 16, v126
  v_lshrrev_b32 v147, 16, v127
  s_waitcnt vmcnt(18)
  v_dot2c_f32_bf16 v148, v28, v128
  v_dot2c_f32_bf16 v149, v28, v108
  v_dot2c_f32_bf16 v150, v29, v128
  v_dot2c_f32_bf16 v151, v29, v108
  v_dot2c_f32_bf16 v152, v30, v128
  v_dot2c_f32_bf16 v153, v30, v108
  v_dot2c_f32_bf16 v154, v31, v128
  v_dot2c_f32_bf16 v155, v31, v108
  v_dot2c_f32_bf16 v148, v32, v129
  v_dot2c_f32_bf16 v149, v32, v109
  v_dot2c_f32_bf16 v150, v33, v129
  v_dot2c_f32_bf16 v151, v33, v109
  v_dot2c_f32_bf16 v152, v34, v129
  v_dot2c_f32_bf16 v153, v34, v109
  v_dot2c_f32_bf16 v154, v35, v129
  v_dot2c_f32_bf16 v155, v35, v109
  s_waitcnt vmcnt(16)
  v_dot2c_f32_bf16 v148, v36, v130
  v_dot2c_f32_bf16 v149, v36, v110
  v_dot2c_f32_bf16 v150, v37, v130
  v_dot2c_f32_bf16 v151, v37, v110
  v_dot2c_f32_bf16 v152, v38, v130
  v_dot2c_f32_bf16 v153, v38, v110
  v_dot2c_f32_bf16 v154, v39, v130
  v_dot2c_f32_bf16 v155, v39, v110
  v_dot2c_f32_bf16 v148, v40, v131
  v_dot2c_f32_bf16 v149, v40, v111
  v_dot2c_f32_bf16 v150, v41, v131
  v_dot2c_f32_bf16 v151, v41, v111
  v_dot2c_f32_bf16 v152, v42, v131
  v_dot2c_f32_bf16 v153, v42, v111
  v_dot2c_f32_bf16 v154, v43, v131
  v_dot2c_f32_bf16 v155, v43, v111
  s_waitcnt vmcnt(14)
  v_dot2c_f32_bf16 v148, v44, v132
  v_dot2c_f32_bf16 v149, v44, v112
  v_dot2c_f32_bf16 v150, v45, v132
  v_dot2c_f32_bf16 v151, v45, v112
  v_dot2c_f32_bf16 v152, v46, v132
  v_dot2c_f32_bf16 v153, v46, v112
  v_dot2c_f32_bf16 v154, v47, v132
  v_dot2c_f32_bf16 v155, v47, v112
  v_dot2c_f32_bf16 v148, v48, v133
  v_dot2c_f32_bf16 v149, v48, v113
  v_dot2c_f32_bf16 v150, v49, v133
  v_dot2c_f32_bf16 v151, v49, v113
  v_dot2c_f32_bf16 v152, v50, v133
  v_dot2c_f32_bf16 v153, v50, v113
  v_dot2c_f32_bf16 v154, v51, v133
  v_dot2c_f32_bf16 v155, v51, v113
  s_waitcnt vmcnt(12)
  v_dot2c_f32_bf16 v148, v52, v134
  v_dot2c_f32_bf16 v149, v52, v114
  v_dot2c_f32_bf16 v150, v53, v134
  v_dot2c_f32_bf16 v151, v53, v114
  v_dot2c_f32_bf16 v152, v54, v134
  v_dot2c_f32_bf16 v153, v54, v114
  v_dot2c_f32_bf16 v154, v55, v134
  v_dot2c_f32_bf16 v155, v55, v114
  v_dot2c_f32_bf16 v148, v56, v135
  v_dot2c_f32_bf16 v149, v56, v115
  v_dot2c_f32_bf16 v150, v57, v135
  v_dot2c_f32_bf16 v151, v57, v115
  v_dot2c_f32_bf16 v152, v58, v135
  v_dot2c_f32_bf16 v153, v58, v115
  v_dot2c_f32_bf16 v154, v59, v135
  v_dot2c_f32_bf16 v155, v59, v115
  s_waitcnt vmcnt(10)
  v_dot2c_f32_bf16 v148, v60, v136
  v_dot2c_f32_bf16 v149, v60, v116
  v_dot2c_f32_bf16 v150, v61, v136
  v_dot2c_f32_bf16 v151, v61, v116
  v_dot2c_f32_bf16 v152, v62, v136
  v_dot2c_f32_bf16 v153, v62, v116
  v_dot2c_f32_bf16 v154, v63, v136
  v_dot2c_f32_bf16 v155, v63, v116
  v_dot2c_f32_bf16 v148, v64, v137
  v_dot2c_f32_bf16 v149, v64, v117
  v_dot2c_f32_bf16 v150, v65, v137
  v_dot2c_f32_bf16 v151, v65, v117
  v_dot2c_f32_bf16 v152, v66, v137
  v_dot2c_f32_bf16 v153, v66, v117
  v_dot2c_f32_bf16 v154, v67, v137
  v_dot2c_f32_bf16 v155, v67, v117
  s_waitcnt vmcnt(8)
  v_dot2c_f32_bf16 v148, v68, v138
  v_dot2c_f32_bf16 v149, v68, v118
  v_dot2c_f32_bf16 v150, v69, v138
  v_dot2c_f32_bf16 v151, v69, v118
  v_dot2c_f32_bf16 v152, v70, v138
  v_dot2c_f32_bf16 v153, v70, v118
  v_dot2c_f32_bf16 v154, v71, v138
  v_dot2c_f32_bf16 v155, v71, v118
  v_dot2c_f32_bf16 v148, v72, v139
  v_dot2c_f32_bf16 v149, v72, v119
  v_dot2c_f32_bf16 v150, v73, v139
  v_dot2c_f32_bf16 v151, v73, v119
  v_dot2c_f32_bf16 v152, v74, v139
  v_dot2c_f32_bf16 v153, v74, v119
  v_dot2c_f32_bf16 v154, v75, v139
  v_dot2c_f32_bf16 v155, v75, v119
  s_waitcnt vmcnt(6)
  v_dot2c_f32_bf16 v148, v76, v140
  v_dot2c_f32_bf16 v149, v76, v120
  v_dot2c_f32_bf16 v150, v77, v140
  v_dot2c_f32_bf16 v151, v77, v120
  v_dot2c_f32_bf16 v152, v78, v140
  v_dot2c_f32_bf16 v153, v78, v120
  v_dot2c_f32_bf16 v154, v79, v140
  v_dot2c_f32_bf16 v155, v79, v120
  v_dot2c_f32_bf16 v148, v80, v141
  v_dot2c_f32_bf16 v149, v80, v121
  v_dot2c_f32_bf16 v150, v81, v141
  v_dot2c_f32_bf16 v151, v81, v121
  v_dot2c_f32_bf16 v152, v82, v141
  v_dot2c_f32_bf16 v153, v82, v121
  v_dot2c_f32_bf16 v154, v83, v141
  v_dot2c_f32_bf16 v155, v83, v121
  s_waitcnt vmcnt(4)
  v_dot2c_f32_bf16 v148, v84, v142
  v_dot2c_f32_bf16 v149, v84, v122
  v_dot2c_f32_bf16 v150, v85, v142
  v_dot2c_f32_bf16 v151, v85, v122
  v_dot2c_f32_bf16 v152, v86, v142
  v_dot2c_f32_bf16 v153, v86, v122
  v_dot2c_f32_bf16 v154, v87, v142
  v_dot2c_f32_bf16 v155, v87, v122
  v_dot2c_f32_bf16 v148, v88, v143
  v_dot2c_f32_bf16 v149, v88, v123
  v_dot2c_f32_bf16 v150, v89, v143
  v_dot2c_f32_bf16 v151, v89, v123
  v_dot2c_f32_bf16 v152, v90, v143
  v_dot2c_f32_bf16 v153, v90, v123
  v_dot2c_f32_bf16 v154, v91, v143
  v_dot2c_f32_bf16 v155, v91, v123
  s_waitcnt vmcnt(2)
  v_dot2c_f32_bf16 v148, v92, v144
  v_dot2c_f32_bf16 v149, v92, v124
  v_dot2c_f32_bf16 v150, v93, v144
  v_dot2c_f32_bf16 v151, v93, v124
  v_dot2c_f32_bf16 v152, v94, v144
  v_dot2c_f32_bf16 v153, v94, v124
  v_dot2c_f32_bf16 v154, v95, v144
  v_dot2c_f32_bf16 v155, v95, v124
  v_dot2c_f32_bf16 v148, v96, v145
  v_dot2c_f32_bf16 v149, v96, v125
  v_dot2c_f32_bf16 v150, v97, v145
  v_dot2c_f32_bf16 v151, v97, v125
  v_dot2c_f32_bf16 v152, v98, v145
  v_dot2c_f32_bf16 v153, v98, v125
  v_dot2c_f32_bf16 v154, v99, v145
  v_dot2c_f32_bf16 v155, v99, v125
  s_waitcnt vmcnt(0)
  v_dot2c_f32_bf16 v148, v100, v146
  v_dot2c_f32_bf16 v149, v100, v126
  v_dot2c_f32_bf16 v150, v101, v146
  v_dot2c_f32_bf16 v151, v101, v126
  v_dot2c_f32_bf16 v152, v102, v146
  v_dot2c_f32_bf16 v153, v102, v126
  v_dot2c_f32_bf16 v154, v103, v146
  v_dot2c_f32_bf16 v155, v103, v126
  v_dot2c_f32_bf16 v148, v104, v147
  v_dot2c_f32_bf16 v149, v104, v127
  v_dot2c_f32_bf16 v150, v105, v147
  v_dot2c_f32_bf16 v151, v105, v127
  v_dot2c_f32_bf16 v152, v106, v147
  v_dot2c_f32_bf16 v153, v106, v127
  v_dot2c_f32_bf16 v154, v107, v147
  v_dot2c_f32_bf16 v155, v107, v127
  v_lshlrev_b32 v12, 5, v0
  ds_write_b128 v12, v[148:151] offset:4096
  s_nop 0
  ds_write_b128 v12, v[152:155] offset:4112
  v_lshlrev_b32 v12, 2, v0
  s_waitcnt lgkmcnt(0)
  s_barrier
  s_cmp_lg_u32 s17, 0
  s_cbranch_scc1 mod_endb
  ds_read2st64_b32 v[28:29], v12 offset0:16 offset1:17
  ds_read2st64_b32 v[30:31], v12 offset0:18 offset1:19
  ds_read2st64_b32 v[32:33], v12 offset0:20 offset1:21
  ds_read2st64_b32 v[34:35], v12 offset0:22 offset1:23
  ds_read2st64_b32 v[36:37], v12 offset0:24 offset1:25
  ds_read2st64_b32 v[38:39], v12 offset0:26 offset1:27
  ds_read2st64_b32 v[40:41], v12 offset0:28 offset1:29
  ds_read2st64_b32 v[42:43], v12 offset0:30 offset1:31
  ds_read2st64_b32 v[44:45], v12 offset0:32 offset1:33
  ds_read2st64_b32 v[46:47], v12 offset0:34 offset1:35
  ds_read2st64_b32 v[48:49], v12 offset0:36 offset1:37
  ds_read2st64_b32 v[50:51], v12 offset0:38 offset1:39
  ds_read2st64_b32 v[52:53], v12 offset0:40 offset1:41
  ds_read2st64_b32 v[54:55], v12 offset0:42 offset1:43
  ds_read2st64_b32 v[56:57], v12 offset0:44 offset1:45
  ds_read2st64_b32 v[58:59], v12 offset0:46 offset1:47
  s_waitcnt lgkmcnt(11)
  v_pk_add_f32 v[28:29], v[28:29], v[30:31]
  v_pk_add_f32 v[28:29], v[28:29], v[32:33]
  v_pk_add_f32 v[28:29], v[28:29], v[34:35]
  v_pk_add_f32 v[28:29], v[28:29], v[36:37]
  s_waitcnt lgkmcnt(7)
  v_pk_add_f32 v[28:29], v[28:29], v[38:39]
  v_pk_add_f32 v[28:29], v[28:29], v[40:41]
  v_pk_add_f32 v[28:29], v[28:29], v[42:43]
  v_pk_add_f32 v[28:29], v[28:29], v[44:45]
  s_waitcnt lgkmcnt(3)
  v_pk_add_f32 v[28:29], v[28:29], v[46:47]
  v_pk_add_f32 v[28:29], v[28:29], v[48:49]
  v_pk_add_f32 v[28:29], v[28:29], v[50:51]
  v_pk_add_f32 v[28:29], v[28:29], v[52:53]
  s_waitcnt lgkmcnt(0)
  v_pk_add_f32 v[28:29], v[28:29], v[54:55]
  v_pk_add_f32 v[28:29], v[28:29], v[56:57]
  v_pk_add_f32 v[28:29], v[28:29], v[58:59]
  v_add_f32 v28, v28, v29
  v_cvt_pk_bf16_f32 v28, v28, v28
  v_lshlrev_b32 v28, 16, v28
  s_lshl_b32 s6, s52, 8
  s_add_u32 s6, s6, 65536
  buffer_store_dword v28, v12, s[8:11], s6 offen sc1
  v_mov_b32 v16, 196
  v_mov_b32 v17, 1
  s_waitcnt vmcnt(0)
  s_mov_b64 exec, 1
  buffer_atomic_add v17, v16, s[12:15], 0 offen sc1
  s_mov_b64 exec, -1
mod_endb:
  s_barrier
  s_add_u32 s52, s52, 24
  s_cmp_lt_u32 s52, 60
  s_cbranch_scc1 r_mod2
  v_mov_b32 v233, 0
  v_mov_b32 v234, 0
  v_mov_b32 v235, 0
  v_mov_b32 v236, 0
  v_mov_b32 v237, 0
  s_load_dwordx2 s[56:57], s[0:1], 72
  s_mov_b32 s58, 1966080
  s_mov_b32 s59, 0x00020000
  s_load_dwordx2 s[60:61], s[0:1], 80
  s_mov_b32 s62, 1966080
  s_mov_b32 s63, 0x00020000
  s_load_dwordx2 s[64:65], s[0:1], 88
  s_mov_b32 s66, 1966080
  s_mov_b32 s67, 0x00020000
  s_mul_i32 s68, s16, 3
  s_add_u32 s68, s68, s18
  s_sub_u32 s68, s68, 29
  s_mul_i32 s73, s17, 40960
  v_lshrrev_b32 v124, 4, v1
  v_and_b32 v124, 3, v124
  v_lshlrev_b32 v124, 1, v124
  v_and_b32 v4, 7, v1
  v_xor_b32 v4, v4, v124
  v_lshlrev_b32 v4, 4, v4
  v_lshrrev_b32 v124, 3, v1
  v_mul_u32_u24 v124, 0, v124
  v_add_u32 v4, v4, v124
  v_lshrrev_b32 v124, 4, v1
  v_and_b32 v124, 3, v124
  v_lshlrev_b32 v124, 1, v124
  v_and_b32 v5, 7, v1
  v_xor_b32 v5, v5, v124
  v_lshlrev_b32 v5, 4, v5
  v_lshrrev_b32 v124, 3, v1
  v_mul_u32_u24 v124, 1280, v124
  v_add_u32 v5, v5, v124
  v_bfe_u32 v124, v1, 3, 2
  v_bfe_u32 v125, v1, 5, 1
  v_lshl_add_u32 v124, v125, 3, v124
  v_mul_u32_u24 v124, 3072, v124
  v_add_u32 v4, v4, v124
  v_lshrrev_b32 v124, 2, v1
  v_lshrrev_b32 v125, 1, v124
  v_and_b32 v125, 3, v125
  v_lshlrev_b32 v125, 1, v125
  v_bfe_u32 v144, v1, 1, 1
  v_add_u32 v144, 0, v144
  v_xor_b32 v144, v144, v125
  v_lshlrev_b32 v144, 4, v144
  v_lshlrev_b32 v124, 7, v124
  v_add_u32 v144, v144, v124
  v_and_b32 v124, 1, v1
  v_lshlrev_b32 v124, 3, v124
  v_add_u32 v144, v144, v124
  v_add_u32 v144, s73, v144
  v_lshrrev_b32 v124, 2, v1
  v_lshrrev_b32 v125, 1, v124
  v_and_b32 v125, 3, v125
  v_lshlrev_b32 v125, 1, v125
  v_bfe_u32 v145, v1, 1, 1
  v_add_u32 v145, 2, v145
  v_xor_b32 v145, v145, v125
  v_lshlrev_b32 v145, 4, v145
  v_lshlrev_b32 v124, 7, v124
  v_add_u32 v145, v145, v124
  v_and_b32 v124, 1, v1
  v_lshlrev_b32 v124, 3, v124
  v_add_u32 v145, v145, v124
  v_add_u32 v145, s73, v145
  v_lshrrev_b32 v124, 2, v1
  v_lshrrev_b32 v125, 1, v124
  v_and_b32 v125, 3, v125
  v_lshlrev_b32 v125, 1, v125
  v_bfe_u32 v146, v1, 1, 1
  v_add_u32 v146, 4, v146
  v_xor_b32 v146, v146, v125
  v_lshlrev_b32 v146, 4, v146
  v_lshlrev_b32 v124, 7, v124
  v_add_u32 v146, v146, v124
  v_and_b32 v124, 1, v1
  v_lshlrev_b32 v124, 3, v124
  v_add_u32 v146, v146, v124
  v_add_u32 v146, s73, v146
  v_lshrrev_b32 v124, 2, v1
  v_lshrrev_b32 v125, 1, v124
  v_and_b32 v125, 3, v125
  v_lshlrev_b32 v125, 1, v125
  v_bfe_u32 v147, v1, 1, 1
  v_add_u32 v147, 6, v147
  v_xor_b32 v147, v147, v125
  v_lshlrev_b32 v147, 4, v147
  v_lshlrev_b32 v124, 7, v124
  v_add_u32 v147, v147, v124
  v_and_b32 v124, 1, v1
  v_lshlrev_b32 v124, 3, v124
  v_add_u32 v147, v147, v124
  v_add_u32 v147, s73, v147
  s_mul_i32 s72, s17, 491520
  s_lshl_b32 s70, s68, 7
  s_add_u32 s72, s72, s70
  s_waitcnt lgkmcnt(0)
  s_barrier
  s_add_u32 m0, s73, 0
  s_add_u32 s70, s72, 0
  buffer_load_dwordx4 v4, s[56:59], s70 offen nt lds
  s_add_u32 m0, s73, 1024
  s_add_u32 s70, s72, 49152
  buffer_load_dwordx4 v4, s[56:59], s70 offen nt lds
  s_add_u32 m0, s73, 2048
  s_add_u32 s70, s72, 12288
  buffer_load_dwordx4 v4, s[56:59], s70 offen nt lds
  s_add_u32 m0, s73, 3072
  s_add_u32 s70, s72, 61440
  buffer_load_dwordx4 v4, s[56:59], s70 offen nt lds
  s_add_u32 m0, s73, 4096
  s_add_u32 s70, s72, 98304
  buffer_load_dwordx4 v4, s[56:59], s70 offen nt lds
  s_add_u32 m0, s73, 5120
  s_add_u32 s70, s72, 147456
  buffer_load_dwordx4 v4, s[56:59], s70 offen nt lds
  s_add_u32 m0, s73, 6144
  s_add_u32 s70, s72, 110592
  buffer_load_dwordx4 v4, s[56:59], s70 offen nt lds
  s_add_u32 m0, s73, 7168
  s_add_u32 s70, s72, 159744
  buffer_load_dwordx4 v4, s[56:59], s70 offen nt lds
  s_add_u32 m0, s73, 8192
  s_add_u32 s70, s72, 196608
  buffer_load_dwordx4 v4, s[56:59], s70 offen nt lds
  s_add_u32 m0, s73, 9216
  s_add_u32 s70, s72, 245760
  buffer_load_dwordx4 v4, s[56:59], s70 offen nt lds
  s_add_u32 m0, s73, 10240
  s_add_u32 s70, s72, 208896
  buffer_load_dwordx4 v4, s[56:59], s70 offen nt lds
  s_add_u32 m0, s73, 11264
  s_add_u32 s70, s72, 258048
  buffer_load_dwordx4 v4, s[56:59], s70 offen nt lds
  s_add_u32 m0, s73, 12288
  s_add_u32 s70, s72, 294912
  buffer_load_dwordx4 v4, s[56:59], s70 offen nt lds
  s_add_u32 m0, s73, 13312
  s_add_u32 s70, s72, 344064
  buffer_load_dwordx4 v4, s[56:59], s70 offen nt lds
  s_add_u32 m0, s73, 14336
  s_add_u32 s70, s72, 307200
  buffer_load_dwordx4 v4, s[56:59], s70 offen nt lds
  s_add_u32 m0, s73, 15360
  s_add_u32 s70, s72, 356352
  buffer_load_dwordx4 v4, s[56:59], s70 offen nt lds
  s_add_u32 m0, s73, 16384
  s_add_u32 s70, s72, 393216
  buffer_load_dwordx4 v4, s[56:59], s70 offen nt lds
  s_add_u32 m0, s73, 17408
  s_add_u32 s70, s72, 442368
  buffer_load_dwordx4 v4, s[56:59], s70 offen nt lds
  s_add_u32 m0, s73, 18432
  s_add_u32 s70, s72, 405504
  buffer_load_dwordx4 v4, s[56:59], s70 offen nt lds
  s_add_u32 m0, s73, 19456
  s_add_u32 s70, s72, 454656
  buffer_load_dwordx4 v4, s[56:59], s70 offen nt lds
  s_add_u32 m0, s73, 20480
  s_add_u32 s70, s72, 0
  buffer_load_dwordx4 v4, s[60:63], s70 offen nt lds
  s_add_u32 m0, s73, 21504
  s_add_u32 s70, s72, 49152
  buffer_load_dwordx4 v4, s[60:63], s70 offen nt lds
  s_add_u32 m0, s73, 22528
  s_add_u32 s70, s72, 12288
  buffer_load_dwordx4 v4, s[60:63], s70 offen nt lds
  s_add_u32 m0, s73, 23552
  s_add_u32 s70, s72, 61440
  buffer_load_dwordx4 v4, s[60:63], s70 offen nt lds
  s_add_u32 m0, s73, 24576
  s_add_u32 s70, s72, 98304
  buffer_load_dwordx4 v4, s[60:63], s70 offen nt lds
  s_add_u32 m0, s73, 25600
  s_add_u32 s70, s72, 147456
  buffer_load_dwordx4 v4, s[60:63], s70 offen nt lds
  s_add_u32 m0, s73, 26624
  s_add_u32 s70, s72, 110592
  buffer_load_dwordx4 v4, s[60:63], s70 offen nt lds
  s_add_u32 m0, s73, 27648
  s_add_u32 s70, s72, 159744
  buffer_load_dwordx4 v4, s[60:63], s70 offen nt lds
  s_add_u32 m0, s73, 28672
  s_add_u32 s70, s72, 196608
  buffer_load_dwordx4 v4, s[60:63], s70 offen nt lds
  s_add_u32 m0, s73, 29696
  s_add_u32 s70, s72, 245760
  buffer_load_dwordx4 v4, s[60:63], s70 offen nt lds
  s_add_u32 m0, s73, 30720
  s_add_u32 s70, s72, 208896
  buffer_load_dwordx4 v4, s[60:63], s70 offen nt lds
  s_add_u32 m0, s73, 31744
  s_add_u32 s70, s72, 258048
  buffer_load_dwordx4 v4, s[60:63], s70 offen nt lds
  s_add_u32 m0, s73, 32768
  s_add_u32 s70, s72, 294912
  buffer_load_dwordx4 v4, s[60:63], s70 offen nt lds
  s_add_u32 m0, s73, 33792
  s_add_u32 s70, s72, 344064
  buffer_load_dwordx4 v4, s[60:63], s70 offen nt lds
  s_add_u32 m0, s73, 34816
  s_add_u32 s70, s72, 307200
  buffer_load_dwordx4 v4, s[60:63], s70 offen nt lds
  s_add_u32 m0, s73, 35840
  s_add_u32 s70, s72, 356352
  buffer_load_dwordx4 v4, s[60:63], s70 offen nt lds
  s_add_u32 m0, s73, 36864
  s_add_u32 s70, s72, 393216
  buffer_load_dwordx4 v4, s[60:63], s70 offen nt lds
  s_add_u32 m0, s73, 37888
  s_add_u32 s70, s72, 442368
  buffer_load_dwordx4 v4, s[60:63], s70 offen nt lds
  s_add_u32 m0, s73, 38912
  s_add_u32 s70, s72, 405504
  buffer_load_dwordx4 v4, s[60:63], s70 offen nt lds
  s_add_u32 m0, s73, 39936
  s_add_u32 s70, s72, 454656
  buffer_load_dwordx4 v4, s[60:63], s70 offen nt lds
  s_waitcnt vmcnt(36)
  ds_read_b64_tr_b16 a[0:1], v144 offset:0
  ds_read_b64_tr_b16 a[2:3], v144 offset:2048
  ds_read_b64_tr_b16 a[20:21], v145 offset:0
  ds_read_b64_tr_b16 a[22:23], v145 offset:2048
  ds_read_b64_tr_b16 a[40:41], v146 offset:0
  ds_read_b64_tr_b16 a[42:43], v146 offset:2048
  ds_read_b64_tr_b16 a[60:61], v147 offset:0
  ds_read_b64_tr_b16 a[62:63], v147 offset:2048
  s_waitcnt vmcnt(32)
  ds_read_b64_tr_b16 a[4:5], v144 offset:4096
  ds_read_b64_tr_b16 a[6:7], v144 offset:6144
  ds_read_b64_tr_b16 a[24:25], v145 offset:4096
  ds_read_b64_tr_b16 a[26:27], v145 offset:6144
  ds_read_b64_tr_b16 a[44:45], v146 offset:4096
  ds_read_b64_tr_b16 a[46:47], v146 offset:6144
  ds_read_b64_tr_b16 a[64:65], v147 offset:4096
  ds_read_b64_tr_b16 a[66:67], v147 offset:6144
  s_waitcnt lgkmcnt(0)
  s_waitcnt vmcnt(28)
  ds_read_b64_tr_b16 a[8:9], v144 offset:8192
  ds_read_b64_tr_b16 a[10:11], v144 offset:10240
  ds_read_b64_tr_b16 a[28:29], v145 offset:8192
  ds_read_b64_tr_b16 a[30:31], v145 offset:10240
  ds_read_b64_tr_b16 a[48:49], v146 offset:8192
  ds_read_b64_tr_b16 a[50:51], v146 offset:10240
  ds_read_b64_tr_b16 a[68:69], v147 offset:8192
  ds_read_b64_tr_b16 a[70:71], v147 offset:10240
  s_waitcnt vmcnt(24)
  ds_read_b64_tr_b16 a[12:13], v144 offset:12288
  ds_read_b64_tr_b16 a[14:15], v144 offset:14336
  ds_read_b64_tr_b16 a[32:33], v145 offset:12288
  ds_read_b64_tr_b16 a[34:35], v145 offset:14336
  ds_read_b64_tr_b16 a[52:53], v146 offset:12288
  ds_read_b64_tr_b16 a[54:55], v146 offset:14336
  ds_read_b64_tr_b16 a[72:73], v147 offset:12288
  ds_read_b64_tr_b16 a[74:75], v147 offset:14336
  s_waitcnt lgkmcnt(0)
  s_waitcnt vmcnt(20)
  ds_read_b64_tr_b16 a[16:17], v144 offset:16384
  ds_read_b64_tr_b16 a[18:19], v144 offset:18432
  ds_read_b64_tr_b16 a[36:37], v145 offset:16384
  ds_read_b64_tr_b16 a[38:39], v145 offset:18432
  ds_read_b64_tr_b16 a[56:57], v146 offset:16384
  ds_read_b64_tr_b16 a[58:59], v146 offset:18432
  ds_read_b64_tr_b16 a[76:77], v147 offset:16384
  ds_read_b64_tr_b16 a[78:79], v147 offset:18432
  s_waitcnt vmcnt(16)
  ds_read_b64_tr_b16 a[80:81], v144 offset:20480
  ds_read_b64_tr_b16 a[82:83], v144 offset:22528
  ds_read_b64_tr_b16 a[100:101], v145 offset:20480
  ds_read_b64_tr_b16 a[102:103], v145 offset:22528
  ds_read_b64_tr_b16 a[120:121], v146 offset:20480
  ds_read_b64_tr_b16 a[122:123], v146 offset:22528
  ds_read_b64_tr_b16 a[140:141], v147 offset:20480
  ds_read_b64_tr_b16 a[142:143], v147 offset:22528
  s_waitcnt lgkmcnt(0)
  s_waitcnt vmcnt(12)
  ds_read_b64_tr_b16 a[84:85], v144 offset:24576
  ds_read_b64_tr_b16 a[86:87], v144 offset:26624
  ds_read_b64_tr_b16 a[104:105], v145 offset:24576
  ds_read_b64_tr_b16 a[106:107], v145 offset:26624
  ds_read_b64_tr_b16 a[124:125], v146 offset:24576
  ds_read_b64_tr_b16 a[126:127], v146 offset:26624
  ds_read_b64_tr_b16 a[144:145], v147 offset:24576
  ds_read_b64_tr_b16 a[146:147], v147 offset:26624
  s_waitcnt vmcnt(8)
  ds_read_b64_tr_b16 a[88:89], v144 offset:28672
  ds_read_b64_tr_b16 a[90:91], v144 offset:30720
  ds_read_b64_tr_b16 a[108:109], v145 offset:28672
  ds_read_b64_tr_b16 a[110:111], v145 offset:30720
  ds_read_b64_tr_b16 a[128:129], v146 offset:28672
  ds_read_b64_tr_b16 a[130:131], v146 offset:30720
  ds_read_b64_tr_b16 a[148:149], v147 offset:28672
  ds_read_b64_tr_b16 a[150:151], v147 offset:30720
  s_waitcnt lgkmcnt(0)
  s_waitcnt vmcnt(4)
  ds_read_b64_tr_b16 a[92:93], v144 offset:32768
  ds_read_b64_tr_b16 a[94:95], v144 offset:34816
  ds_read_b64_tr_b16 a[112:113], v145 offset:32768
  ds_read_b64_tr_b16 a[114:115], v145 offset:34816
  ds_read_b64_tr_b16 a[132:133], v146 offset:32768
  ds_read_b64_tr_b16 a[134:135], v146 offset:34816
  ds_read_b64_tr_b16 a[152:153], v147 offset:32768
  ds_read_b64_tr_b16 a[154:155], v147 offset:34816
  s_waitcnt vmcnt(0)
  ds_read_b64_tr_b16 a[96:97], v144 offset:36864
  ds_read_b64_tr_b16 a[98:99], v144 offset:38912
  ds_read_b64_tr_b16 a[116:117], v145 offset:36864
  ds_read_b64_tr_b16 a[118:119], v145 offset:38912
  ds_read_b64_tr_b16 a[136:137], v146 offset:36864
  ds_read_b64_tr_b16 a[138:139], v146 offset:38912
  ds_read_b64_tr_b16 a[156:157], v147 offset:36864
  ds_read_b64_tr_b16 a[158:159], v147 offset:38912
  s_waitcnt lgkmcnt(0)
  s_mul_i32 s72, s68, 81920
  s_mul_i32 s70, s17, 320
  s_add_u32 s72, s72, s70
  s_add_u32 m0, s73, 0
  s_add_u32 s70, s72, 0
  buffer_load_dwordx4 v5, s[64:67], s70 offen nt lds
  s_add_u32 m0, s73, 1024
  s_add_u32 s70, s72, 10240
  buffer_load_dwordx4 v5, s[64:67], s70 offen nt lds
  s_add_u32 m0, s73, 2048
  s_add_u32 s70, s72, 20480
  buffer_load_dwordx4 v5, s[64:67], s70 offen nt lds
  s_add_u32 m0, s73, 3072
  s_add_u32 s70, s72, 30720
  buffer_load_dwordx4 v5, s[64:67], s70 offen nt lds
  s_add_u32 m0, s73, 4096
  s_add_u32 s70, s72, 40960
  buffer_load_dwordx4 v5, s[64:67], s70 offen nt lds
  s_add_u32 m0, s73, 5120
  s_add_u32 s70, s72, 51200
  buffer_load_dwordx4 v5, s[64:67], s70 offen nt lds
  s_add_u32 m0, s73, 6144
  s_add_u32 s70, s72, 61440
  buffer_load_dwordx4 v5, s[64:67], s70 offen nt lds
  s_add_u32 m0, s73, 7168
  s_add_u32 s70, s72, 71680
  buffer_load_dwordx4 v5, s[64:67], s70 offen nt lds
  s_add_u32 m0, s73, 8192
  s_add_u32 s70, s72, 128
  buffer_load_dwordx4 v5, s[64:67], s70 offen nt lds
  s_add_u32 m0, s73, 9216
  s_add_u32 s70, s72, 10368
  buffer_load_dwordx4 v5, s[64:67], s70 offen nt lds
  s_add_u32 m0, s73, 10240
  s_add_u32 s70, s72, 20608
  buffer_load_dwordx4 v5, s[64:67], s70 offen nt lds
  s_add_u32 m0, s73, 11264
  s_add_u32 s70, s72, 30848
  buffer_load_dwordx4 v5, s[64:67], s70 offen nt lds
  s_add_u32 m0, s73, 12288
  s_add_u32 s70, s72, 41088
  buffer_load_dwordx4 v5, s[64:67], s70 offen nt lds
  s_add_u32 m0, s73, 13312
  s_add_u32 s70, s72, 51328
  buffer_load_dwordx4 v5, s[64:67], s70 offen nt lds
  s_add_u32 m0, s73, 14336
  s_add_u32 s70, s72, 61568
  buffer_load_dwordx4 v5, s[64:67], s70 offen nt lds
  s_add_u32 m0, s73, 15360
  s_add_u32 s70, s72, 71808
  buffer_load_dwordx4 v5, s[64:67], s70 offen nt lds
  s_add_u32 m0, s73, 16384
  s_add_u32 s70, s72, 256
  buffer_load_dwordx4 v5, s[64:67], s70 offen nt lds
  s_add_u32 m0, s73, 17408
  s_add_u32 s70, s72, 10496
  buffer_load_dwordx4 v5, s[64:67], s70 offen nt lds
  s_add_u32 m0, s73, 18432
  s_add_u32 s70, s72, 20736
  buffer_load_dwordx4 v5, s[64:67], s70 offen nt lds
  s_add_u32 m0, s73, 19456
  s_add_u32 s70, s72, 30976
  buffer_load_dwordx4 v5, s[64:67], s70 offen nt lds
  s_add_u32 m0, s73, 20480
  s_add_u32 s70, s72, 41216
  buffer_load_dwordx4 v5, s[64:67], s70 offen nt lds
  s_add_u32 m0, s73, 21504
  s_add_u32 s70, s72, 51456
  buffer_load_dwordx4 v5, s[64:67], s70 offen nt lds
  s_add_u32 m0, s73, 22528
  s_add_u32 s70, s72, 61696
  buffer_load_dwordx4 v5, s[64:67], s70 offen nt lds
  s_add_u32 m0, s73, 23552
  s_add_u32 s70, s72, 71936
  buffer_load_dwordx4 v5, s[64:67], s70 offen nt lds
  s_waitcnt vmcnt(0)
  ds_read_b64_tr_b16 a[160:161], v144 offset:0
  ds_read_b64_tr_b16 a[162:163], v144 offset:2048
  ds_read_b64_tr_b16 a[164:165], v144 offset:4096
  ds_read_b64_tr_b16 a[166:167], v144 offset:6144
  ds_read_b64_tr_b16 a[168:169], v145 offset:0
  ds_read_b64_tr_b16 a[170:171], v145 offset:2048
  ds_read_b64_tr_b16 a[172:173], v145 offset:4096
  ds_read_b64_tr_b16 a[174:175], v145 offset:6144
  ds_read_b64_tr_b16 a[176:177], v146 offset:0
  ds_read_b64_tr_b16 a[178:179], v146 offset:2048
  ds_read_b64_tr_b16 a[180:181], v146 offset:4096
  ds_read_b64_tr_b16 a[182:183], v146 offset:6144
  s_waitcnt lgkmcnt(0)
  ds_read_b64_tr_b16 a[184:185], v147 offset:0
  ds_read_b64_tr_b16 a[186:187], v147 offset:2048
  ds_read_b64_tr_b16 a[188:189], v147 offset:4096
  ds_read_b64_tr_b16 a[190:191], v147 offset:6144
  ds_read_b64_tr_b16 a[192:193], v144 offset:8192
  ds_read_b64_tr_b16 a[194:195], v144 offset:10240
  ds_read_b64_tr_b16 a[196:197], v144 offset:12288
  ds_read_b64_tr_b16 a[198:199], v144 offset:14336
  ds_read_b64_tr_b16 a[200:201], v145 offset:8192
  ds_read_b64_tr_b16 a[202:203], v145 offset:10240
  ds_read_b64_tr_b16 a[204:205], v145 offset:12288
  ds_read_b64_tr_b16 a[206:207], v145 offset:14336
  s_waitcnt lgkmcnt(0)
  ds_read_b64_tr_b16 a[208:209], v146 offset:8192
  ds_read_b64_tr_b16 a[210:211], v146 offset:10240
  ds_read_b64_tr_b16 a[212:213], v146 offset:12288
  ds_read_b64_tr_b16 a[214:215], v146 offset:14336
  ds_read_b64_tr_b16 a[216:217], v147 offset:8192
  ds_read_b64_tr_b16 a[218:219], v147 offset:10240
  ds_read_b64_tr_b16 a[220:221], v147 offset:12288
  ds_read_b64_tr_b16 a[222:223], v147 offset:14336
  ds_read_b64_tr_b16 a[224:225], v144 offset:16384
  ds_read_b64_tr_b16 a[226:227], v144 offset:18432
  ds_read_b64_tr_b16 a[228:229], v144 offset:20480
  ds_read_b64_tr_b16 a[230:231], v144 offset:22528
  s_waitcnt lgkmcnt(0)
  ds_read_b64_tr_b16 a[232:233], v145 offset:16384
  ds_read_b64_tr_b16 a[234:235], v145 offset:18432
  ds_read_b64_tr_b16 a[236:237], v145 offset:20480
  ds_read_b64_tr_b16 a[238:239], v145 offset:22528
  v_lshlrev_b32 v233, 4, v1
  v_lshrrev_b32 v124, 2, v1
  v_and_b32 v125, 3, v1
  v_lshlrev_b32 v125, 2, v125
  v_lshl_add_u32 v234, v124, 7, v125
  v_lshrrev_b32 v124, 4, v1
  v_and_b32 v125, 7, v1
  v_lshlrev_b32 v125, 4, v125
  v_lshl_add_u32 v236, v124, 7, v125
  v_lshrrev_b32 v124, 5, v1
  v_mul_u32_u24 v124, 20480, v124
  v_and_b32 v125, 31, v1
  v_lshl_add_u32 v237, v125, 4, v124
  s_mul_i32 s78, s17, 24
  s_add_u32 s78, s78, s68
  s_mov_b32 s74, 0
  s_mov_b32 s75, 2097152
  s_waitcnt lgkmcnt(0)
  s_barrier
  s_mov_b32 s79, 0
  s_mov_b32 s80, 0
  s_mov_b32 s81, 0
  s_mov_b32 s82, 0
  s_mov_b32 s83, 0
  s_mov_b32 s84, 0
  s_mov_b32 s85, 0
  s_mov_b32 s86, 0
  v_mov_b32 v90, 196
  s_mov_b32 s34, 0
gw_15:
  buffer_load_dword v91, v90, s[12:15], 0 offen sc1
  s_add_u32 s34, s34, 1
  s_cmp_gt_u32 s34, 65536
  s_cbranch_scc1 role_abort
  s_waitcnt vmcnt(0)
  v_cmp_gt_u32 vcc, 104, v91
  s_cbranch_vccz gk_16
  s_sleep 8
  s_branch gw_15
gk_16:
  s_mov_b32 s35, 70656
  buffer_load_dwordx2 v[196:197], v227, s[8:11], s35 offen offset:0 sc1
  buffer_load_dwordx2 v[198:199], v227, s[8:11], s35 offen offset:512 sc1
  buffer_load_dwordx2 v[200:201], v227, s[8:11], s35 offen offset:1024 sc1
  buffer_load_dwordx2 v[202:203], v227, s[8:11], s35 offen offset:1536 sc1
  buffer_load_dwordx2 v[204:205], v227, s[8:11], s35 offen offset:2048 sc1
  s_mov_b32 s35, 73216
  buffer_load_dwordx2 v[186:187], v227, s[8:11], s35 offen offset:0 sc1
  buffer_load_dwordx2 v[188:189], v227, s[8:11], s35 offen offset:512 sc1
  buffer_load_dwordx2 v[190:191], v227, s[8:11], s35 offen offset:1024 sc1
  buffer_load_dwordx2 v[192:193], v227, s[8:11], s35 offen offset:1536 sc1
  buffer_load_dwordx2 v[194:195], v227, s[8:11], s35 offen offset:2048 sc1
  s_mov_b32 s35, 75776
  buffer_load_dwordx2 v[176:177], v227, s[8:11], s35 offen offset:0 sc1
  buffer_load_dwordx2 v[178:179], v227, s[8:11], s35 offen offset:512 sc1
  buffer_load_dwordx2 v[180:181], v227, s[8:11], s35 offen offset:1024 sc1
  buffer_load_dwordx2 v[182:183], v227, s[8:11], s35 offen offset:1536 sc1
  buffer_load_dwordx2 v[184:185], v227, s[8:11], s35 offen offset:2048 sc1
  s_mov_b32 s35, 78336
  buffer_load_dwordx2 v[206:207], v227, s[8:11], s35 offen offset:0 sc1
  buffer_load_dwordx2 v[208:209], v227, s[8:11], s35 offen offset:512 sc1
  buffer_load_dwordx2 v[210:211], v227, s[8:11], s35 offen offset:1024 sc1
  buffer_load_dwordx2 v[212:213], v227, s[8:11], s35 offen offset:1536 sc1
  buffer_load_dwordx2 v[214:215], v227, s[8:11], s35 offen offset:2048 sc1
  buffer_load_dword v22, v226, s[28:31], 0 offen offset:0
  buffer_load_dword v23, v226, s[28:31], 0 offen offset:256
  buffer_load_dword v24, v226, s[28:31], 0 offen offset:512
  buffer_load_dword v25, v226, s[28:31], 0 offen offset:768
  buffer_load_dword v26, v226, s[28:31], 0 offen offset:1024
  v_lshlrev_b32 v229, 7, v1
  s_lshl_b32 s35, s16, 8
  s_add_u32 s36, s35, 48
  s_add_u32 s35, s35, 4192
  v_and_b32 v90, 3, v1
  v_lshl_add_u32 v232, v90, 2, s35
  v_mov_b32 v228, s36
  s_waitcnt vmcnt(0)
  v_add_f32 v176, 1.0, v176
  v_add_f32 v177, 1.0, v177
  v_cvt_pk_bf16_f32 v90, v176, v177
  v_lshlrev_b32 v176, 16, v90
  v_and_b32 v177, 0xffff0000, v90
  v_add_f32 v178, 1.0, v178
  v_add_f32 v179, 1.0, v179
  v_cvt_pk_bf16_f32 v90, v178, v179
  v_lshlrev_b32 v178, 16, v90
  v_and_b32 v179, 0xffff0000, v90
  v_add_f32 v180, 1.0, v180
  v_add_f32 v181, 1.0, v181
  v_cvt_pk_bf16_f32 v90, v180, v181
  v_lshlrev_b32 v180, 16, v90
  v_and_b32 v181, 0xffff0000, v90
  v_add_f32 v182, 1.0, v182
  v_add_f32 v183, 1.0, v183
  v_cvt_pk_bf16_f32 v90, v182, v183
  v_lshlrev_b32 v182, 16, v90
  v_and_b32 v183, 0xffff0000, v90
  v_add_f32 v184, 1.0, v184
  v_add_f32 v185, 1.0, v185
  v_cvt_pk_bf16_f32 v90, v184, v185
  v_lshlrev_b32 v184, 16, v90
  v_and_b32 v185, 0xffff0000, v90
  v_lshlrev_b32 v216, 16, v22
  v_and_b32 v217, 0xffff0000, v22
  v_lshlrev_b32 v218, 16, v23
  v_and_b32 v219, 0xffff0000, v23
  v_lshlrev_b32 v220, 16, v24
  v_and_b32 v221, 0xffff0000, v24
  v_lshlrev_b32 v222, 16, v25
  v_and_b32 v223, 0xffff0000, v25
  v_lshlrev_b32 v224, 16, v26
  v_and_b32 v225, 0xffff0000, v26
  s_mov_b32 s39, s54
  s_lshl_b32 s32, s16, 2
  s_add_u32 s32, s32, s17
r_loop:
  s_lshl_b32 s40, s39, 5
  s_add_u32 s40, s40, s32
  s_mul_i32 s37, s40, 1280
  s_mul_i32 s38, s39, 327680
  s_mul_i32 s35, s32, 1280
  s_add_u32 s38, s38, s35
  s_add_u32 s38, s38, 226492416
  s_add_u32 s41, s39, 6
  s_min_u32 s41, s41, 64
  s_max_u32 s36, s39, 60
  s_lshl_b32 s36, s36, 14
  s_add_u32 s36, s36, 1179648
  s_add_u32 s53, s36, 8192
  buffer_load_dword v22, v226, s[20:23], s37 offen offset:0
  buffer_load_dword v23, v226, s[20:23], s37 offen offset:256
  buffer_load_dword v24, v226, s[20:23], s37 offen offset:512
  buffer_load_dword v25, v226, s[20:23], s37 offen offset:768
  buffer_load_dword v26, v226, s[20:23], s37 offen offset:1024
  s_cmp_ge_u32 s39, 57
  s_cbranch_scc1 r_km
  s_mov_b32 s34, 0
pw_17:
  buffer_load_dword v93, v232, s[8:11], 0 offen sc1
  s_add_u32 s34, s34, 1
  s_cmp_gt_u32 s34, 65536
  s_cbranch_scc1 role_abort
  s_waitcnt vmcnt(0)
pc_19:
  v_cmp_gt_u32 vcc, s41, v93
  s_nop 0
  s_and_b32 vcc_lo, vcc_lo, 0xf
  s_and_b32 vcc_hi, vcc_hi, 0x0
  s_cmp_eq_u64 vcc, 0
  s_cbranch_scc1 po_18
  s_sleep 8
  s_branch pw_17
po_18:
  s_branch r_go
r_km:
  s_mov_b64 exec, 1
  s_mov_b32 s34, 0
pw_20:
  buffer_load_dword v93, v228, s[8:11], 0 offen sc1
  s_add_u32 s34, s34, 1
  s_cmp_gt_u32 s34, 65536
  s_cbranch_scc1 role_abort
  s_waitcnt vmcnt(0)
pc_22:
  v_cmp_gt_u32 vcc, s41, v93
  s_nop 0
  s_and_b32 vcc_lo, vcc_lo, 0x1
  s_and_b32 vcc_hi, vcc_hi, 0x0
  s_cmp_eq_u64 vcc, 0
  s_cbranch_scc1 po_21
  s_sleep 8
  s_branch pw_20
po_21:
  s_mov_b64 exec, -1
  s_cmp_lt_u32 s39, 59
  s_cbranch_scc1 r_go
  s_cmp_lt_u32 s39, 63
  s_cbranch_scc1 r_p0
  s_mov_b32 s34, 0
pw_23:
  buffer_load_dword v93, v232, s[8:11], 0 offen sc1
  s_add_u32 s34, s34, 1
  s_cmp_gt_u32 s34, 65536
  s_cbranch_scc1 role_abort
  s_waitcnt vmcnt(0)
pc_25:
  v_cmp_gt_u32 vcc, s41, v93
  s_nop 0
  s_and_b32 vcc_lo, vcc_lo, 0xf
  s_and_b32 vcc_hi, vcc_hi, 0x0
  s_cmp_eq_u64 vcc, 0
  s_cbranch_scc1 po_24
  s_sleep 4
  s_branch pw_23
po_24:
  s_sleep 8
r_p0:
  s_mov_b32 s34, 0
r_poll:
  buffer_load_dwordx4 v[96:99], v229, s[8:11], s36 offen sc1
  buffer_load_dwordx4 v[46:49], v229, s[8:11], s53 offen sc1
  s_add_u32 s34, s34, 1
  s_cmp_gt_u32 s34, 65536
  s_cbranch_scc1 role_abort
  s_waitcnt vmcnt(0)
  v_or3_b32 v90, v96, v97, v98
  v_or3_b32 v90, v90, v99, v46
  v_or3_b32 v90, v90, v47, v48
  v_or_b32 v90, v90, v49
  v_cmp_ne_u32 vcc, 0, v90
  s_nop 0
  s_and_b32 vcc_lo, vcc_lo, 0x03ff03ff
  s_and_b32 vcc_hi, vcc_hi, 0x03ff03ff
  s_cmp_eq_u64 vcc, 0
  s_cbranch_scc1 r_go
  s_sleep 4
  s_branch r_poll
r_go:
  buffer_load_dword v46, v226, s[8:11], s38 offen offset:0 sc1
  buffer_load_dword v47, v226, s[8:11], s38 offen offset:256 sc1
  buffer_load_dword v48, v226, s[8:11], s38 offen offset:512 sc1
  buffer_load_dword v49, v226, s[8:11], s38 offen offset:768 sc1
  buffer_load_dword v50, v226, s[8:11], s38 offen offset:1024 sc1
  s_add_u32 s38, s38, 40960
  buffer_load_dword v51, v226, s[8:11], s38 offen offset:0 sc1
  buffer_load_dword v52, v226, s[8:11], s38 offen offset:256 sc1
  buffer_load_dword v53, v226, s[8:11], s38 offen offset:512 sc1
  buffer_load_dword v54, v226, s[8:11], s38 offen offset:768 sc1
  buffer_load_dword v55, v226, s[8:11], s38 offen offset:1024 sc1
  s_add_u32 s38, s38, 40960
  buffer_load_dword v56, v226, s[8:11], s38 offen offset:0 sc1
  buffer_load_dword v57, v226, s[8:11], s38 offen offset:256 sc1
  buffer_load_dword v58, v226, s[8:11], s38 offen offset:512 sc1
  buffer_load_dword v59, v226, s[8:11], s38 offen offset:768 sc1
  buffer_load_dword v60, v226, s[8:11], s38 offen offset:1024 sc1
  s_add_u32 s38, s38, 40960
  buffer_load_dword v61, v226, s[8:11], s38 offen offset:0 sc1
  buffer_load_dword v62, v226, s[8:11], s38 offen offset:256 sc1
  buffer_load_dword v63, v226, s[8:11], s38 offen offset:512 sc1
  buffer_load_dword v64, v226, s[8:11], s38 offen offset:768 sc1
  buffer_load_dword v65, v226, s[8:11], s38 offen offset:1024 sc1
  s_add_u32 s38, s38, 40960
  buffer_load_dword v66, v226, s[8:11], s38 offen offset:0 sc1
  buffer_load_dword v67, v226, s[8:11], s38 offen offset:256 sc1
  buffer_load_dword v68, v226, s[8:11], s38 offen offset:512 sc1
  buffer_load_dword v69, v226, s[8:11], s38 offen offset:768 sc1
  buffer_load_dword v70, v226, s[8:11], s38 offen offset:1024 sc1
  s_add_u32 s38, s38, 40960
  buffer_load_dword v71, v226, s[8:11], s38 offen offset:0 sc1
  buffer_load_dword v72, v226, s[8:11], s38 offen offset:256 sc1
  buffer_load_dword v73, v226, s[8:11], s38 offen offset:512 sc1
  buffer_load_dword v74, v226, s[8:11], s38 offen offset:768 sc1
  buffer_load_dword v75, v226, s[8:11], s38 offen offset:1024 sc1
  s_add_u32 s38, s38, 40960
  buffer_load_dword v76, v226, s[8:11], s38 offen offset:0 sc1
  buffer_load_dword v77, v226, s[8:11], s38 offen offset:256 sc1
  buffer_load_dword v78, v226, s[8:11], s38 offen offset:512 sc1
  buffer_load_dword v79, v226, s[8:11], s38 offen offset:768 sc1
  buffer_load_dword v80, v226, s[8:11], s38 offen offset:1024 sc1
  s_add_u32 s38, s38, 40960
  buffer_load_dword v81, v226, s[8:11], s38 offen offset:0 sc1
  buffer_load_dword v82, v226, s[8:11], s38 offen offset:256 sc1
  buffer_load_dword v83, v226, s[8:11], s38 offen offset:512 sc1
  buffer_load_dword v84, v226, s[8:11], s38 offen offset:768 sc1
  buffer_load_dword v85, v226, s[8:11], s38 offen offset:1024 sc1
  s_add_u32 s38, s38, 40960
  v_lshlrev_b32 v2, 16, v22
  v_and_b32 v3, 0xffff0000, v22
  v_lshlrev_b32 v4, 16, v23
  v_and_b32 v5, 0xffff0000, v23
  v_lshlrev_b32 v6, 16, v24
  v_and_b32 v7, 0xffff0000, v24
  v_lshlrev_b32 v8, 16, v25
  v_and_b32 v9, 0xffff0000, v25
  v_lshlrev_b32 v10, 16, v26
  v_and_b32 v11, 0xffff0000, v26
  s_waitcnt vmcnt(35)
  v_lshlrev_b32 v12, 16, v46
  v_and_b32 v13, 0xffff0000, v46
  v_lshlrev_b32 v14, 16, v47
  v_and_b32 v15, 0xffff0000, v47
  v_lshlrev_b32 v16, 16, v48
  v_and_b32 v17, 0xffff0000, v48
  v_lshlrev_b32 v18, 16, v49
  v_and_b32 v19, 0xffff0000, v49
  v_lshlrev_b32 v20, 16, v50
  v_and_b32 v21, 0xffff0000, v50
  s_waitcnt vmcnt(30)
  v_dot2c_f32_bf16 v12, v51, v230
  v_dot2c_f32_bf16 v13, v51, v231
  v_dot2c_f32_bf16 v14, v52, v230
  v_dot2c_f32_bf16 v15, v52, v231
  v_dot2c_f32_bf16 v16, v53, v230
  v_dot2c_f32_bf16 v17, v53, v231
  v_dot2c_f32_bf16 v18, v54, v230
  v_dot2c_f32_bf16 v19, v54, v231
  v_dot2c_f32_bf16 v20, v55, v230
  v_dot2c_f32_bf16 v21, v55, v231
  s_waitcnt vmcnt(25)
  v_dot2c_f32_bf16 v12, v56, v230
  v_dot2c_f32_bf16 v13, v56, v231
  v_dot2c_f32_bf16 v14, v57, v230
  v_dot2c_f32_bf16 v15, v57, v231
  v_dot2c_f32_bf16 v16, v58, v230
  v_dot2c_f32_bf16 v17, v58, v231
  v_dot2c_f32_bf16 v18, v59, v230
  v_dot2c_f32_bf16 v19, v59, v231
  v_dot2c_f32_bf16 v20, v60, v230
  v_dot2c_f32_bf16 v21, v60, v231
  s_waitcnt vmcnt(20)
  v_dot2c_f32_bf16 v12, v61, v230
  v_dot2c_f32_bf16 v13, v61, v231
  v_dot2c_f32_bf16 v14, v62, v230
  v_dot2c_f32_bf16 v15, v62, v231
  v_dot2c_f32_bf16 v16, v63, v230
  v_dot2c_f32_bf16 v17, v63, v231
  v_dot2c_f32_bf16 v18, v64, v230
  v_dot2c_f32_bf16 v19, v64, v231
  v_dot2c_f32_bf16 v20, v65, v230
  v_dot2c_f32_bf16 v21, v65, v231
  s_waitcnt vmcnt(15)
  v_dot2c_f32_bf16 v12, v66, v230
  v_dot2c_f32_bf16 v13, v66, v231
  v_dot2c_f32_bf16 v14, v67, v230
  v_dot2c_f32_bf16 v15, v67, v231
  v_dot2c_f32_bf16 v16, v68, v230
  v_dot2c_f32_bf16 v17, v68, v231
  v_dot2c_f32_bf16 v18, v69, v230
  v_dot2c_f32_bf16 v19, v69, v231
  v_dot2c_f32_bf16 v20, v70, v230
  v_dot2c_f32_bf16 v21, v70, v231
  s_waitcnt vmcnt(10)
  v_dot2c_f32_bf16 v12, v71, v230
  v_dot2c_f32_bf16 v13, v71, v231
  v_dot2c_f32_bf16 v14, v72, v230
  v_dot2c_f32_bf16 v15, v72, v231
  v_dot2c_f32_bf16 v16, v73, v230
  v_dot2c_f32_bf16 v17, v73, v231
  v_dot2c_f32_bf16 v18, v74, v230
  v_dot2c_f32_bf16 v19, v74, v231
  v_dot2c_f32_bf16 v20, v75, v230
  v_dot2c_f32_bf16 v21, v75, v231
  s_waitcnt vmcnt(5)
  v_dot2c_f32_bf16 v12, v76, v230
  v_dot2c_f32_bf16 v13, v76, v231
  v_dot2c_f32_bf16 v14, v77, v230
  v_dot2c_f32_bf16 v15, v77, v231
  v_dot2c_f32_bf16 v16, v78, v230
  v_dot2c_f32_bf16 v17, v78, v231
  v_dot2c_f32_bf16 v18, v79, v230
  v_dot2c_f32_bf16 v19, v79, v231
  v_dot2c_f32_bf16 v20, v80, v230
  v_dot2c_f32_bf16 v21, v80, v231
  s_waitcnt vmcnt(0)
  v_dot2c_f32_bf16 v12, v81, v230
  v_dot2c_f32_bf16 v13, v81, v231
  v_dot2c_f32_bf16 v14, v82, v230
  v_dot2c_f32_bf16 v15, v82, v231
  v_dot2c_f32_bf16 v16, v83, v230
  v_dot2c_f32_bf16 v17, v83, v231
  v_dot2c_f32_bf16 v18, v84, v230
  v_dot2c_f32_bf16 v19, v84, v231
  v_dot2c_f32_bf16 v20, v85, v230
  v_dot2c_f32_bf16 v21, v85, v231
  v_cvt_pk_bf16_f32 v90, v12, v13
  v_lshlrev_b32 v12, 16, v90
  v_and_b32 v13, 0xffff0000, v90
  v_cvt_pk_bf16_f32 v90, v14, v15
  v_lshlrev_b32 v14, 16, v90
  v_and_b32 v15, 0xffff0000, v90
  v_cvt_pk_bf16_f32 v90, v16, v17
  v_lshlrev_b32 v16, 16, v90
  v_and_b32 v17, 0xffff0000, v90
  v_cvt_pk_bf16_f32 v90, v18, v19
  v_lshlrev_b32 v18, 16, v90
  v_and_b32 v19, 0xffff0000, v90
  v_cvt_pk_bf16_f32 v90, v20, v21
  v_lshlrev_b32 v20, 16, v90
  v_and_b32 v21, 0xffff0000, v90
  v_pk_mul_f32 v[12:13], v[12:13], v[196:197]
  v_cvt_pk_bf16_f32 v90, v12, v13
  v_lshlrev_b32 v12, 16, v90
  v_and_b32 v13, 0xffff0000, v90
  v_pk_mul_f32 v[14:15], v[14:15], v[198:199]
  v_cvt_pk_bf16_f32 v90, v14, v15
  v_lshlrev_b32 v14, 16, v90
  v_and_b32 v15, 0xffff0000, v90
  v_pk_mul_f32 v[16:17], v[16:17], v[200:201]
  v_cvt_pk_bf16_f32 v90, v16, v17
  v_lshlrev_b32 v16, 16, v90
  v_and_b32 v17, 0xffff0000, v90
  v_pk_mul_f32 v[18:19], v[18:19], v[202:203]
  v_cvt_pk_bf16_f32 v90, v18, v19
  v_lshlrev_b32 v18, 16, v90
  v_and_b32 v19, 0xffff0000, v90
  v_pk_mul_f32 v[20:21], v[20:21], v[204:205]
  v_cvt_pk_bf16_f32 v90, v20, v21
  v_lshlrev_b32 v20, 16, v90
  v_and_b32 v21, 0xffff0000, v90
  v_pk_add_f32 v[2:3], v[2:3], v[12:13]
  v_cvt_pk_bf16_f32 v34, v2, v3
  v_lshlrev_b32 v2, 16, v34
  v_and_b32 v3, 0xffff0000, v34
  v_pk_add_f32 v[4:5], v[4:5], v[14:15]
  v_cvt_pk_bf16_f32 v35, v4, v5
  v_lshlrev_b32 v4, 16, v35
  v_and_b32 v5, 0xffff0000, v35
  v_pk_add_f32 v[6:7], v[6:7], v[16:17]
  v_cvt_pk_bf16_f32 v36, v6, v7
  v_lshlrev_b32 v6, 16, v36
  v_and_b32 v7, 0xffff0000, v36
  v_pk_add_f32 v[8:9], v[8:9], v[18:19]
  v_cvt_pk_bf16_f32 v37, v8, v9
  v_lshlrev_b32 v8, 16, v37
  v_and_b32 v9, 0xffff0000, v37
  v_pk_add_f32 v[10:11], v[10:11], v[20:21]
  v_cvt_pk_bf16_f32 v38, v10, v11
  v_lshlrev_b32 v10, 16, v38
  v_and_b32 v11, 0xffff0000, v38
  s_add_u32 s35, s37, 5242880
  buffer_store_dword v34, v226, s[8:11], s35 offen offset:0 sc1
  buffer_store_dword v35, v226, s[8:11], s35 offen offset:256 sc1
  buffer_store_dword v36, v226, s[8:11], s35 offen offset:512 sc1
  buffer_store_dword v37, v226, s[8:11], s35 offen offset:768 sc1
  buffer_store_dword v38, v226, s[8:11], s35 offen offset:1024 sc1
  v_pk_add_f32 v[86:87], v[2:3], v[4:5]
  v_pk_add_f32 v[88:89], v[6:7], v[8:9]
  v_pk_add_f32 v[86:87], v[86:87], v[10:11]
  v_pk_add_f32 v[86:87], v[86:87], v[88:89]
  v_add_f32 v86, v86, v87
  s_nop 1
  v_add_f32_dpp v86, v86, v86 row_ror:8 row_mask:0xf bank_mask:0xf
  s_nop 1
  v_add_f32_dpp v86, v86, v86 row_ror:4 row_mask:0xf bank_mask:0xf
  s_nop 1
  v_add_f32_dpp v86, v86, v86 row_ror:2 row_mask:0xf bank_mask:0xf
  s_nop 1
  v_add_f32_dpp v86, v86, v86 row_ror:1 row_mask:0xf bank_mask:0xf
  v_mov_b32 v90, v86
  s_nop 1
  v_permlane16_swap_b32 v86, v90
  v_add_f32 v86, v86, v90
  v_mov_b32 v90, v86
  s_nop 1
  v_permlane32_swap_b32 v86, v90
  v_add_f32 v86, v86, v90
  v_mul_f32 v88, 0xbacccccd, v86
  v_mul_f32 v89, 0xbacccccd, v86
  v_pk_add_f32 v[12:13], v[2:3], v[88:89]
  v_pk_add_f32 v[14:15], v[4:5], v[88:89]
  v_pk_add_f32 v[16:17], v[6:7], v[88:89]
  v_pk_add_f32 v[18:19], v[8:9], v[88:89]
  v_pk_add_f32 v[20:21], v[10:11], v[88:89]
  v_pk_mul_f32 v[86:87], v[12:13], v[12:13]
  v_pk_fma_f32 v[86:87], v[14:15], v[14:15], v[86:87]
  v_pk_fma_f32 v[86:87], v[16:17], v[16:17], v[86:87]
  v_pk_fma_f32 v[86:87], v[18:19], v[18:19], v[86:87]
  v_pk_fma_f32 v[86:87], v[20:21], v[20:21], v[86:87]
  v_add_f32 v86, v86, v87
  v_cvt_pk_bf16_f32 v91, v88, v89
  v_lshlrev_b32 v88, 16, v91
  v_and_b32 v89, 0xffff0000, v91
  v_add_f32_dpp v86, v86, v86 row_ror:8 row_mask:0xf bank_mask:0xf
  s_nop 1
  v_add_f32_dpp v86, v86, v86 row_ror:4 row_mask:0xf bank_mask:0xf
  s_nop 1
  v_add_f32_dpp v86, v86, v86 row_ror:2 row_mask:0xf bank_mask:0xf
  s_nop 1
  v_add_f32_dpp v86, v86, v86 row_ror:1 row_mask:0xf bank_mask:0xf
  v_mov_b32 v90, v86
  s_nop 1
  v_permlane16_swap_b32 v86, v90
  v_add_f32 v86, v86, v90
  v_mov_b32 v90, v86
  s_nop 1
  v_permlane32_swap_b32 v86, v90
  v_add_f32 v86, v86, v90
  v_pk_add_f32 v[12:13], v[2:3], v[88:89]
  v_pk_add_f32 v[14:15], v[4:5], v[88:89]
  v_pk_add_f32 v[16:17], v[6:7], v[88:89]
  v_pk_add_f32 v[18:19], v[8:9], v[88:89]
  v_pk_add_f32 v[20:21], v[10:11], v[88:89]
  v_mul_f32 v86, 0x3acccccd, v86
  v_cvt_pk_bf16_f32 v86, v86, v86
  v_lshlrev_b32 v86, 16, v86
  v_add_f32 v86, 0x3727c5ac, v86
  v_cvt_pk_bf16_f32 v86, v86, v86
  v_lshlrev_b32 v86, 16, v86
  v_sqrt_f32 v86, v86
  v_cvt_pk_bf16_f32 v90, v12, v13
  v_lshlrev_b32 v12, 16, v90
  v_and_b32 v13, 0xffff0000, v90
  v_cvt_pk_bf16_f32 v86, v86, v86
  v_lshlrev_b32 v86, 16, v86
  v_rcp_f32 v86, v86
  v_cvt_pk_bf16_f32 v90, v14, v15
  v_lshlrev_b32 v14, 16, v90
  v_and_b32 v15, 0xffff0000, v90
  v_cvt_pk_bf16_f32 v90, v16, v17
  v_lshlrev_b32 v16, 16, v90
  v_and_b32 v17, 0xffff0000, v90
  v_cvt_pk_bf16_f32 v90, v18, v19
  v_lshlrev_b32 v18, 16, v90
  v_and_b32 v19, 0xffff0000, v90
  v_cvt_pk_bf16_f32 v90, v20, v21
  v_lshlrev_b32 v20, 16, v90
  v_and_b32 v21, 0xffff0000, v90
  v_mov_b32 v87, v86
  v_pk_mul_f32 v[12:13], v[12:13], v[86:87]
  v_cvt_pk_bf16_f32 v90, v12, v13
  v_lshlrev_b32 v12, 16, v90
  v_and_b32 v13, 0xffff0000, v90
  v_pk_mul_f32 v[14:15], v[14:15], v[86:87]
  v_cvt_pk_bf16_f32 v90, v14, v15
  v_lshlrev_b32 v14, 16, v90
  v_and_b32 v15, 0xffff0000, v90
  v_pk_mul_f32 v[16:17], v[16:17], v[86:87]
  v_cvt_pk_bf16_f32 v90, v16, v17
  v_lshlrev_b32 v16, 16, v90
  v_and_b32 v17, 0xffff0000, v90
  v_pk_mul_f32 v[18:19], v[18:19], v[86:87]
  v_cvt_pk_bf16_f32 v90, v18, v19
  v_lshlrev_b32 v18, 16, v90
  v_and_b32 v19, 0xffff0000, v90
  v_pk_mul_f32 v[20:21], v[20:21], v[86:87]
  v_cvt_pk_bf16_f32 v90, v20, v21
  v_lshlrev_b32 v20, 16, v90
  v_and_b32 v21, 0xffff0000, v90
  v_pk_mul_f32 v[12:13], v[12:13], v[176:177]
  v_cvt_pk_bf16_f32 v90, v12, v13
  v_lshlrev_b32 v12, 16, v90
  v_and_b32 v13, 0xffff0000, v90
  v_pk_mul_f32 v[14:15], v[14:15], v[178:179]
  v_cvt_pk_bf16_f32 v90, v14, v15
  v_lshlrev_b32 v14, 16, v90
  v_and_b32 v15, 0xffff0000, v90
  v_pk_mul_f32 v[16:17], v[16:17], v[180:181]
  v_cvt_pk_bf16_f32 v90, v16, v17
  v_lshlrev_b32 v16, 16, v90
  v_and_b32 v17, 0xffff0000, v90
  v_pk_mul_f32 v[18:19], v[18:19], v[182:183]
  v_cvt_pk_bf16_f32 v90, v18, v19
  v_lshlrev_b32 v18, 16, v90
  v_and_b32 v19, 0xffff0000, v90
  v_pk_mul_f32 v[20:21], v[20:21], v[184:185]
  v_cvt_pk_bf16_f32 v90, v20, v21
  v_lshlrev_b32 v20, 16, v90
  v_and_b32 v21, 0xffff0000, v90
  v_pk_add_f32 v[12:13], v[12:13], v[186:187]
  v_cvt_pk_bf16_f32 v28, v12, v13
  v_pk_add_f32 v[14:15], v[14:15], v[188:189]
  v_cvt_pk_bf16_f32 v29, v14, v15
  v_pk_add_f32 v[16:17], v[16:17], v[190:191]
  v_cvt_pk_bf16_f32 v30, v16, v17
  v_pk_add_f32 v[18:19], v[18:19], v[192:193]
  v_cvt_pk_bf16_f32 v31, v18, v19
  v_pk_add_f32 v[20:21], v[20:21], v[194:195]
  v_cvt_pk_bf16_f32 v32, v20, v21
  s_add_u32 s35, s37, 8388608
  buffer_store_dword v28, v226, s[8:11], s35 offen offset:0 sc1
  buffer_store_dword v29, v226, s[8:11], s35 offen offset:256 sc1
  buffer_store_dword v30, v226, s[8:11], s35 offen offset:512 sc1
  buffer_store_dword v31, v226, s[8:11], s35 offen offset:768 sc1
  buffer_store_dword v32, v226, s[8:11], s35 offen offset:1024 sc1
  v_lshlrev_b32 v12, 16, v28
  v_and_b32 v13, 0xffff0000, v28
  v_lshlrev_b32 v14, 16, v29
  v_and_b32 v15, 0xffff0000, v29
  v_lshlrev_b32 v16, 16, v30
  v_and_b32 v17, 0xffff0000, v30
  v_lshlrev_b32 v18, 16, v31
  v_and_b32 v19, 0xffff0000, v31
  v_lshlrev_b32 v20, 16, v32
  v_and_b32 v21, 0xffff0000, v32
  v_pk_mul_f32 v[86:87], v[12:13], v[216:217]
  v_pk_fma_f32 v[86:87], v[14:15], v[218:219], v[86:87]
  v_pk_fma_f32 v[86:87], v[16:17], v[220:221], v[86:87]
  v_pk_fma_f32 v[86:87], v[18:19], v[222:223], v[86:87]
  v_pk_fma_f32 v[86:87], v[20:21], v[224:225], v[86:87]
  v_add_f32 v86, v86, v87
  v_pk_mul_f32 v[12:13], v[12:13], v[206:207]
  v_cvt_pk_bf16_f32 v90, v12, v13
  v_lshlrev_b32 v12, 16, v90
  v_and_b32 v13, 0xffff0000, v90
  v_pk_mul_f32 v[14:15], v[14:15], v[208:209]
  v_cvt_pk_bf16_f32 v90, v14, v15
  v_lshlrev_b32 v14, 16, v90
  v_and_b32 v15, 0xffff0000, v90
  v_pk_mul_f32 v[16:17], v[16:17], v[210:211]
  v_cvt_pk_bf16_f32 v90, v16, v17
  v_lshlrev_b32 v16, 16, v90
  v_and_b32 v17, 0xffff0000, v90
  v_pk_mul_f32 v[18:19], v[18:19], v[212:213]
  v_cvt_pk_bf16_f32 v90, v18, v19
  v_lshlrev_b32 v18, 16, v90
  v_and_b32 v19, 0xffff0000, v90
  v_pk_mul_f32 v[20:21], v[20:21], v[214:215]
  v_cvt_pk_bf16_f32 v90, v20, v21
  v_lshlrev_b32 v20, 16, v90
  v_and_b32 v21, 0xffff0000, v90
  v_pk_add_f32 v[12:13], v[12:13], v[2:3]
  v_cvt_pk_bf16_f32 v40, v12, v13
  v_pk_add_f32 v[14:15], v[14:15], v[4:5]
  v_cvt_pk_bf16_f32 v41, v14, v15
  v_pk_add_f32 v[16:17], v[16:17], v[6:7]
  v_cvt_pk_bf16_f32 v42, v16, v17
  v_pk_add_f32 v[18:19], v[18:19], v[8:9]
  v_cvt_pk_bf16_f32 v43, v18, v19
  v_pk_add_f32 v[20:21], v[20:21], v[10:11]
  v_cvt_pk_bf16_f32 v44, v20, v21
  buffer_store_dword v40, v226, s[24:27], s37 offen offset:0 sc1
  buffer_store_dword v41, v226, s[24:27], s37 offen offset:256 sc1
  buffer_store_dword v42, v226, s[24:27], s37 offen offset:512 sc1
  buffer_store_dword v43, v226, s[24:27], s37 offen offset:768 sc1
  buffer_store_dword v44, v226, s[24:27], s37 offen offset:1024 sc1
  v_add_f32_dpp v86, v86, v86 row_ror:8 row_mask:0xf bank_mask:0xf
  s_nop 1
  v_add_f32_dpp v86, v86, v86 row_ror:4 row_mask:0xf bank_mask:0xf
  s_nop 1
  v_add_f32_dpp v86, v86, v86 row_ror:2 row_mask:0xf bank_mask:0xf
  s_nop 1
  v_add_f32_dpp v86, v86, v86 row_ror:1 row_mask:0xf bank_mask:0xf
  v_mov_b32 v90, v86
  s_nop 1
  v_permlane16_swap_b32 v86, v90
  v_add_f32 v86, v86, v90
  v_mov_b32 v90, v86
  s_nop 1
  v_permlane32_swap_b32 v86, v90
  v_add_f32 v86, v86, v90
  v_cvt_pk_bf16_f32 v86, v86, v86
  v_lshlrev_b32 v86, 16, v86
  v_ashrrev_i32 v90, 31, v86
  v_or_b32 v90, 0x80000000, v90
  v_xor_b32 v86, v86, v90
  v_and_b32 v86, 0xffff0000, v86
  s_sub_u32 s35, 2047, s40
  v_or_b32 v86, s35, v86
  s_lshr_b32 s35, s40, 2
  s_lshl_b32 s35, s35, 7
  s_lshl_b32 s36, s17, 2
  s_add_u32 s35, s35, s36
  s_add_u32 s35, s35, 2097152
  v_mov_b32 v91, s35
  s_waitcnt vmcnt(0)
  s_mov_b64 exec, 1
  buffer_store_dword v86, v91, s[8:11], 0 offen sc1
  s_mov_b64 exec, -1
  s_sub_u32 s53, s39, 3
  s_ashr_i32 s53, s53, 1
mc_26_chunk:
  s_cmp_ge_i32 s74, s53
  s_cbranch_scc1 mc_26_done
  s_mov_b32 s69, 0
mc_26_kp:
  buffer_load_dword v235, v234, s[8:11], s75 offen sc1
  s_add_u32 s69, s69, 1
  s_cmp_gt_u32 s69, 65536
  s_cbranch_scc1 role_abort
  s_waitcnt vmcnt(0)
  v_cmp_eq_u32 vcc, -1, v235
  s_cbranch_vccz mc_26_ins
  s_sleep 4
  s_branch mc_26_kp
mc_26_ins:
  v_cmp_lt_u32 vcc, s86, v235
  s_cbranch_vccz mc_26_nx
  s_ff1_i32_b64 s70, vcc
  v_readlane_b32 s76, v235, s70
  v_writelane_b32 v235, 0, s70
  s_min_u32 s77, s79, s76
  s_max_u32 s79, s79, s76
  s_min_u32 s76, s80, s77
  s_max_u32 s80, s80, s77
  s_min_u32 s77, s81, s76
  s_max_u32 s81, s81, s76
  s_min_u32 s76, s82, s77
  s_max_u32 s82, s82, s77
  s_min_u32 s77, s83, s76
  s_max_u32 s83, s83, s76
  s_min_u32 s76, s84, s77
  s_max_u32 s84, s84, s77
  s_min_u32 s77, s85, s76
  s_max_u32 s85, s85, s76
  s_min_u32 s76, s86, s77
  s_max_u32 s86, s86, s77
  s_branch mc_26_ins
mc_26_nx:
  s_add_u32 s75, s75, 2048
  s_add_u32 s74, s74, 1
  s_branch mc_26_chunk
mc_26_done:
  s_add_u32 s39, s39, 3
  s_cmp_lt_u32 s39, 64
  s_cbranch_scc1 r_loop
mc_27_chunk:
  s_cmp_ge_i32 s74, 30
  s_cbranch_scc1 mc_27_done
  s_mov_b32 s69, 0
mc_27_kp:
  buffer_load_dword v235, v234, s[8:11], s75 offen sc1
  s_add_u32 s69, s69, 1
  s_cmp_gt_u32 s69, 65536
  s_cbranch_scc1 role_abort
  s_waitcnt vmcnt(0)
  v_cmp_eq_u32 vcc, -1, v235
  s_cbranch_vccz mc_27_ins
  s_sleep 4
  s_branch mc_27_kp
mc_27_ins:
  v_cmp_lt_u32 vcc, s86, v235
  s_cbranch_vccz mc_27_nx
  s_ff1_i32_b64 s70, vcc
  v_readlane_b32 s76, v235, s70
  v_writelane_b32 v235, 0, s70
  s_min_u32 s77, s79, s76
  s_max_u32 s79, s79, s76
  s_min_u32 s76, s80, s77
  s_max_u32 s80, s80, s77
  s_min_u32 s77, s81, s76
  s_max_u32 s81, s81, s76
  s_min_u32 s76, s82, s77
  s_max_u32 s82, s82, s77
  s_min_u32 s77, s83, s76
  s_max_u32 s83, s83, s76
  s_min_u32 s76, s84, s77
  s_max_u32 s84, s84, s77
  s_min_u32 s77, s85, s76
  s_max_u32 s85, s85, s76
  s_min_u32 s76, s86, s77
  s_max_u32 s86, s86, s77
  s_branch mc_27_ins
mc_27_nx:
  s_add_u32 s75, s75, 2048
  s_add_u32 s74, s74, 1
  s_branch mc_27_chunk
mc_27_done:
  s_cmp_lg_u32 s54, 1
  s_cbranch_scc1 r_c30
  s_sleep 8
r_c30:
mc_28_chunk:
  s_cmp_ge_i32 s74, 31
  s_cbranch_scc1 mc_28_done
  s_mov_b32 s69, 0
mc_28_kp:
  buffer_load_dword v235, v234, s[8:11], s75 offen sc1
  s_add_u32 s69, s69, 1
  s_cmp_gt_u32 s69, 65536
  s_cbranch_scc1 role_abort
  s_waitcnt vmcnt(0)
  v_cmp_eq_u32 vcc, -1, v235
  s_cbranch_vccz mc_28_ins
  s_sleep 4
  s_branch mc_28_kp
mc_28_ins:
  v_cmp_lt_u32 vcc, s86, v235
  s_cbranch_vccz mc_28_nx
  s_ff1_i32_b64 s70, vcc
  v_readlane_b32 s76, v235, s70
  v_writelane_b32 v235, 0, s70
  s_min_u32 s77, s79, s76
  s_max_u32 s79, s79, s76
  s_min_u32 s76, s80, s77
  s_max_u32 s80, s80, s77
  s_min_u32 s77, s81, s76
  s_max_u32 s81, s81, s76
  s_min_u32 s76, s82, s77
  s_max_u32 s82, s82, s77
  s_min_u32 s77, s83, s76
  s_max_u32 s83, s83, s76
  s_min_u32 s76, s84, s77
  s_max_u32 s84, s84, s77
  s_min_u32 s77, s85, s76
  s_max_u32 s85, s85, s76
  s_min_u32 s76, s86, s77
  s_max_u32 s86, s86, s77
  s_branch mc_28_ins
mc_28_nx:
  s_add_u32 s75, s75, 2048
  s_add_u32 s74, s74, 1
  s_branch mc_28_chunk
mc_28_done:
  s_cmp_eq_u32 s54, 0
  s_cbranch_scc1 r_c31
  s_sleep 16
r_c31:
mc_29_chunk:
  s_cmp_ge_i32 s74, 32
  s_cbranch_scc1 mc_29_done
  s_mov_b32 s69, 0
mc_29_kp:
  buffer_load_dword v235, v234, s[8:11], s75 offen sc1
  s_add_u32 s69, s69, 1
  s_cmp_gt_u32 s69, 65536
  s_cbranch_scc1 role_abort
  s_waitcnt vmcnt(0)
  v_cmp_eq_u32 vcc, -1, v235
  s_cbranch_vccz mc_29_ins
  s_sleep 4
  s_branch mc_29_kp
mc_29_ins:
  v_cmp_lt_u32 vcc, s86, v235
  s_cbranch_vccz mc_29_nx
  s_ff1_i32_b64 s70, vcc
  v_readlane_b32 s76, v235, s70
  v_writelane_b32 v235, 0, s70
  s_min_u32 s77, s79, s76
  s_max_u32 s79, s79, s76
  s_min_u32 s76, s80, s77
  s_max_u32 s80, s80, s77
  s_min_u32 s77, s81, s76
  s_max_u32 s81, s81, s76
  s_min_u32 s76, s82, s77
  s_max_u32 s82, s82, s77
  s_min_u32 s77, s83, s76
  s_max_u32 s83, s83, s76
  s_min_u32 s76, s84, s77
  s_max_u32 s84, s84, s77
  s_min_u32 s77, s85, s76
  s_max_u32 s85, s85, s76
  s_min_u32 s76, s86, s77
  s_max_u32 s86, s86, s77
  s_branch mc_29_ins
mc_29_nx:
  s_add_u32 s75, s75, 2048
  s_add_u32 s74, s74, 1
  s_branch mc_29_chunk
mc_29_done:
  s_mov_b32 exec_lo, 0x1010101
  s_mov_b32 exec_hi, 0x1010101
  v_mov_b32 v120, s79
  s_mov_b32 exec_lo, 0x2020202
  s_mov_b32 exec_hi, 0x2020202
  v_mov_b32 v120, s80
  s_mov_b32 exec_lo, 0x4040404
  s_mov_b32 exec_hi, 0x4040404
  v_mov_b32 v120, s81
  s_mov_b32 exec_lo, 0x8080808
  s_mov_b32 exec_hi, 0x8080808
  v_mov_b32 v120, s82
  s_mov_b32 exec_lo, 0x10101010
  s_mov_b32 exec_hi, 0x10101010
  v_mov_b32 v120, s83
  s_mov_b32 exec_lo, 0x20202020
  s_mov_b32 exec_hi, 0x20202020
  v_mov_b32 v120, s84
  s_mov_b32 exec_lo, 0x40404040
  s_mov_b32 exec_hi, 0x40404040
  v_mov_b32 v120, s85
  s_mov_b32 exec_lo, 0x80808080
  s_mov_b32 exec_hi, 0x80808080
  v_mov_b32 v120, s86
  s_mov_b64 exec, -1
  v_and_b32 v124, 0x7ff, v120
  v_sub_u32 v124, 2047, v124
  v_mul_u32_u24 v122, 1280, v124
  v_lshrrev_b32 v125, 4, v1
  v_lshl_add_u32 v121, v125, 4, v122
  s_mul_i32 s70, s17, 320
  s_add_u32 s70, s70, 8388608
  buffer_load_dwordx4 v[4:7], v121, s[8:11], s70 offen offset:0 sc1
  buffer_load_dwordx4 v[8:11], v121, s[8:11], s70 offen offset:64 sc1
  buffer_load_dwordx4 v[12:15], v121, s[8:11], s70 offen offset:128 sc1
  buffer_load_dwordx4 v[16:19], v121, s[8:11], s70 offen offset:192 sc1
  buffer_load_dwordx4 v[20:23], v121, s[8:11], s70 offen offset:256 sc1
  v_bfe_u32 v125, v1, 3, 2
  s_min_u32 s72, s78, 39
  s_lshl_b32 s71, s72, 5
  v_lshl_add_u32 v126, v125, 3, s71
  v_add_u32 v122, v122, v126
  v_lshlrev_b32 v126, 1, v126
  s_mov_b32 s70, 5242880
  s_mov_b32 s71, 8388608
  s_mov_b32 s76, 78336
  buffer_load_dwordx2 v[128:129], v122, s[8:11], s70 offen sc1
  buffer_load_dwordx2 v[130:131], v122, s[8:11], s71 offen sc1
  buffer_load_dwordx4 v[132:135], v126, s[8:11], s76 offen sc1
  v_and_b32 v124, 0xffff0000, v120
  v_ashrrev_i32 v125, 31, v124
  v_not_b32 v125, v125
  v_or_b32 v125, 0x80000000, v125
  v_and_b32 v125, 0xffff0000, v125
  v_xor_b32 v124, v124, v125
  v_mul_f32 v124, 0xbfb8aa3b, v124
  v_exp_f32 v124, v124
  s_nop 0
  v_add_f32 v124, 1.0, v124
  v_rcp_f32 v124, v124
  s_nop 0
  v_cvt_pk_bf16_f32 v124, v124, v124
  v_lshlrev_b32 v123, 16, v124
  s_lshl_b32 s70, s17, 13
  v_add_u32 v126, s70, v233
  s_lshl_b32 s70, s17, 10
  v_add_u32 v127, s70, v233
  s_waitcnt vmcnt(7)
  v_mfma_f32_16x16x32_bf16 v[24:27], a[0:3], v[4:7], 0
  v_mfma_f32_16x16x32_bf16 v[28:31], a[20:23], v[4:7], 0
  v_mfma_f32_16x16x32_bf16 v[32:35], a[40:43], v[4:7], 0
  v_mfma_f32_16x16x32_bf16 v[36:39], a[60:63], v[4:7], 0
  v_mfma_f32_16x16x32_bf16 v[40:43], a[80:83], v[4:7], 0
  v_mfma_f32_16x16x32_bf16 v[44:47], a[100:103], v[4:7], 0
  v_mfma_f32_16x16x32_bf16 v[48:51], a[120:123], v[4:7], 0
  v_mfma_f32_16x16x32_bf16 v[52:55], a[140:143], v[4:7], 0
  s_waitcnt vmcnt(6)
  v_mfma_f32_16x16x32_bf16 v[24:27], a[4:7], v[8:11], v[24:27]
  v_mfma_f32_16x16x32_bf16 v[28:31], a[24:27], v[8:11], v[28:31]
  v_mfma_f32_16x16x32_bf16 v[32:35], a[44:47], v[8:11], v[32:35]
  v_mfma_f32_16x16x32_bf16 v[36:39], a[64:67], v[8:11], v[36:39]
  v_mfma_f32_16x16x32_bf16 v[40:43], a[84:87], v[8:11], v[40:43]
  v_mfma_f32_16x16x32_bf16 v[44:47], a[104:107], v[8:11], v[44:47]
  v_mfma_f32_16x16x32_bf16 v[48:51], a[124:127], v[8:11], v[48:51]
  v_mfma_f32_16x16x32_bf16 v[52:55], a[144:147], v[8:11], v[52:55]
  s_waitcnt vmcnt(5)
  v_mfma_f32_16x16x32_bf16 v[24:27], a[8:11], v[12:15], v[24:27]
  v_mfma_f32_16x16x32_bf16 v[28:31], a[28:31], v[12:15], v[28:31]
  v_mfma_f32_16x16x32_bf16 v[32:35], a[48:51], v[12:15], v[32:35]
  v_mfma_f32_16x16x32_bf16 v[36:39], a[68:71], v[12:15], v[36:39]
  v_mfma_f32_16x16x32_bf16 v[40:43], a[88:91], v[12:15], v[40:43]
  v_mfma_f32_16x16x32_bf16 v[44:47], a[108:111], v[12:15], v[44:47]
  v_mfma_f32_16x16x32_bf16 v[48:51], a[128:131], v[12:15], v[48:51]
  v_mfma_f32_16x16x32_bf16 v[52:55], a[148:151], v[12:15], v[52:55]
  s_waitcnt vmcnt(4)
  v_mfma_f32_16x16x32_bf16 v[24:27], a[12:15], v[16:19], v[24:27]
  v_mfma_f32_16x16x32_bf16 v[28:31], a[32:35], v[16:19], v[28:31]
  v_mfma_f32_16x16x32_bf16 v[32:35], a[52:55], v[16:19], v[32:35]
  v_mfma_f32_16x16x32_bf16 v[36:39], a[72:75], v[16:19], v[36:39]
  v_mfma_f32_16x16x32_bf16 v[40:43], a[92:95], v[16:19], v[40:43]
  v_mfma_f32_16x16x32_bf16 v[44:47], a[112:115], v[16:19], v[44:47]
  v_mfma_f32_16x16x32_bf16 v[48:51], a[132:135], v[16:19], v[48:51]
  v_mfma_f32_16x16x32_bf16 v[52:55], a[152:155], v[16:19], v[52:55]
  s_waitcnt vmcnt(3)
  v_mfma_f32_16x16x32_bf16 v[24:27], a[16:19], v[20:23], v[24:27]
  v_mfma_f32_16x16x32_bf16 v[28:31], a[36:39], v[20:23], v[28:31]
  v_mfma_f32_16x16x32_bf16 v[32:35], a[56:59], v[20:23], v[32:35]
  v_mfma_f32_16x16x32_bf16 v[36:39], a[76:79], v[20:23], v[36:39]
  v_mfma_f32_16x16x32_bf16 v[40:43], a[96:99], v[20:23], v[40:43]
  v_mfma_f32_16x16x32_bf16 v[44:47], a[116:119], v[20:23], v[44:47]
  v_mfma_f32_16x16x32_bf16 v[48:51], a[136:139], v[20:23], v[48:51]
  v_mfma_f32_16x16x32_bf16 v[52:55], a[156:159], v[20:23], v[52:55]
  s_nop 0
  ds_write_b128 v126, v[24:27] offset:0
  ds_write_b128 v126, v[28:31] offset:1024
  ds_write_b128 v126, v[32:35] offset:2048
  ds_write_b128 v126, v[36:39] offset:3072
  ds_write_b128 v126, v[40:43] offset:4096
  ds_write_b128 v126, v[44:47] offset:5120
  ds_write_b128 v126, v[48:51] offset:6144
  ds_write_b128 v126, v[52:55] offset:7168
  s_waitcnt lgkmcnt(0)
  s_barrier
  ds_read_b128 v[64:67], v127 offset:0
  ds_read_b128 v[80:83], v127 offset:4096
  ds_read_b128 v[68:71], v127 offset:8192
  ds_read_b128 v[84:87], v127 offset:12288
  ds_read_b128 v[72:75], v127 offset:16384
  ds_read_b128 v[88:91], v127 offset:20480
  ds_read_b128 v[76:79], v127 offset:24576
  ds_read_b128 v[92:95], v127 offset:28672
  s_waitcnt lgkmcnt(0)
  v_pk_add_f32 v[64:65], v[64:65], v[68:69]
  v_pk_add_f32 v[72:73], v[72:73], v[76:77]
  v_pk_add_f32 v[66:67], v[66:67], v[70:71]
  v_pk_add_f32 v[74:75], v[74:75], v[78:79]
  v_pk_add_f32 v[64:65], v[64:65], v[72:73]
  v_cvt_pk_bf16_f32 v124, v64, v65
  v_lshlrev_b32 v64, 16, v124
  v_and_b32 v65, 0xffff0000, v124
  v_pk_add_f32 v[66:67], v[66:67], v[74:75]
  v_cvt_pk_bf16_f32 v124, v66, v67
  v_lshlrev_b32 v66, 16, v124
  v_and_b32 v67, 0xffff0000, v124
  v_pk_add_f32 v[80:81], v[80:81], v[84:85]
  v_pk_add_f32 v[88:89], v[88:89], v[92:93]
  v_pk_add_f32 v[82:83], v[82:83], v[86:87]
  v_pk_add_f32 v[90:91], v[90:91], v[94:95]
  v_pk_add_f32 v[80:81], v[80:81], v[88:89]
  v_cvt_pk_bf16_f32 v124, v80, v81
  v_lshlrev_b32 v80, 16, v124
  v_and_b32 v81, 0xffff0000, v124
  v_pk_add_f32 v[82:83], v[82:83], v[90:91]
  v_cvt_pk_bf16_f32 v124, v82, v83
  v_lshlrev_b32 v82, 16, v124
  v_and_b32 v83, 0xffff0000, v124
  v_mul_f32 v140, 0xbfb8aa3b, v64
  v_mul_f32 v141, 0xbfb8aa3b, v65
  v_mul_f32 v142, 0xbfb8aa3b, v66
  v_mul_f32 v143, 0xbfb8aa3b, v67
  v_exp_f32 v140, v140
  v_exp_f32 v141, v141
  v_exp_f32 v142, v142
  v_exp_f32 v143, v143
  v_add_f32 v140, 1.0, v140
  v_add_f32 v141, 1.0, v141
  v_add_f32 v142, 1.0, v142
  v_add_f32 v143, 1.0, v143
  v_rcp_f32 v140, v140
  v_rcp_f32 v141, v141
  v_rcp_f32 v142, v142
  v_rcp_f32 v143, v143
  v_pk_mul_f32 v[64:65], v[64:65], v[140:141]
  v_cvt_pk_bf16_f32 v124, v64, v65
  v_lshlrev_b32 v64, 16, v124
  v_and_b32 v65, 0xffff0000, v124
  v_pk_mul_f32 v[64:65], v[64:65], v[80:81]
  v_cvt_pk_bf16_f32 v140, v64, v65
  v_pk_mul_f32 v[66:67], v[66:67], v[142:143]
  v_cvt_pk_bf16_f32 v124, v66, v67
  v_lshlrev_b32 v66, 16, v124
  v_and_b32 v67, 0xffff0000, v124
  v_pk_mul_f32 v[66:67], v[66:67], v[82:83]
  v_cvt_pk_bf16_f32 v141, v66, v67
  s_lshr_b32 s70, s17, 1
  s_lshl_b32 s70, s70, 10
  s_and_b32 s71, s17, 1
  s_lshl_b32 s71, s71, 3
  s_add_u32 s70, s70, s71
  v_add_u32 v126, s70, v233
  ds_write_b64 v126, v[140:141] offset:32768
  s_waitcnt lgkmcnt(0)
  s_barrier
  ds_read_b128 v[112:115], v233 offset:32768
  ds_read_b128 v[116:119], v233 offset:33792
  s_mul_i32 s70, s68, 20480
  s_mul_i32 s71, s17, 5120
  s_add_u32 s70, s70, s71
  s_add_u32 s70, s70, 2326528
  s_add_u32 s71, s70, 4096
  s_waitcnt lgkmcnt(0)
  v_mfma_f32_16x16x32_bf16 v[24:27], a[160:163], v[112:115], 0
  v_mfma_f32_16x16x32_bf16 v[28:31], a[168:171], v[112:115], 0
  v_mfma_f32_16x16x32_bf16 v[32:35], a[176:179], v[112:115], 0
  v_mfma_f32_16x16x32_bf16 v[36:39], a[184:187], v[112:115], 0
  v_mfma_f32_16x16x32_bf16 v[40:43], a[192:195], v[112:115], 0
  v_mfma_f32_16x16x32_bf16 v[44:47], a[200:203], v[112:115], 0
  v_mfma_f32_16x16x32_bf16 v[48:51], a[208:211], v[112:115], 0
  v_mfma_f32_16x16x32_bf16 v[52:55], a[216:219], v[112:115], 0
  v_mfma_f32_16x16x32_bf16 v[56:59], a[224:227], v[112:115], 0
  v_mfma_f32_16x16x32_bf16 v[60:63], a[232:235], v[112:115], 0
  v_mfma_f32_16x16x32_bf16 v[24:27], a[164:167], v[116:119], v[24:27]
  v_mfma_f32_16x16x32_bf16 v[28:31], a[172:175], v[116:119], v[28:31]
  v_mfma_f32_16x16x32_bf16 v[32:35], a[180:183], v[116:119], v[32:35]
  v_mfma_f32_16x16x32_bf16 v[36:39], a[188:191], v[116:119], v[36:39]
  v_mfma_f32_16x16x32_bf16 v[40:43], a[196:199], v[116:119], v[40:43]
  v_mfma_f32_16x16x32_bf16 v[44:47], a[204:207], v[116:119], v[44:47]
  v_mfma_f32_16x16x32_bf16 v[48:51], a[212:215], v[116:119], v[48:51]
  v_mfma_f32_16x16x32_bf16 v[52:55], a[220:223], v[116:119], v[52:55]
  v_mfma_f32_16x16x32_bf16 v[56:59], a[228:231], v[116:119], v[56:59]
  v_mfma_f32_16x16x32_bf16 v[60:63], a[236:239], v[116:119], v[60:63]
  s_mov_b32 exec_lo, 0x00ff00ff
  s_mov_b32 exec_hi, 0x00ff00ff
  buffer_store_dwordx4 v[24:27], v236, s[8:11], s70 offen offset:0 sc1
  buffer_store_dwordx4 v[28:31], v236, s[8:11], s70 offen offset:512 sc1
  buffer_store_dwordx4 v[32:35], v236, s[8:11], s70 offen offset:1024 sc1
  buffer_store_dwordx4 v[36:39], v236, s[8:11], s70 offen offset:1536 sc1
  buffer_store_dwordx4 v[40:43], v236, s[8:11], s70 offen offset:2048 sc1
  buffer_store_dwordx4 v[44:47], v236, s[8:11], s70 offen offset:2560 sc1
  buffer_store_dwordx4 v[48:51], v236, s[8:11], s70 offen offset:3072 sc1
  buffer_store_dwordx4 v[52:55], v236, s[8:11], s70 offen offset:3584 sc1
  buffer_store_dwordx4 v[56:59], v236, s[8:11], s71 offen offset:0 sc1
  buffer_store_dwordx4 v[60:63], v236, s[8:11], s71 offen offset:512 sc1
  s_mov_b64 exec, -1
  s_cmp_ge_u32 s78, 40
  s_cbranch_scc1 moe_end
  s_lshl_b32 s72, s78, 9
  s_add_u32 s72, s72, 2326528
  s_sleep 8
  s_mov_b32 s69, 0
moe_yp:
  s_mov_b32 s70, s72
  buffer_load_dwordx4 v[64:67], v237, s[8:11], s70 offen sc1
  s_add_u32 s70, s70, 40960
  buffer_load_dwordx4 v[68:71], v237, s[8:11], s70 offen sc1
  s_add_u32 s70, s70, 40960
  buffer_load_dwordx4 v[72:75], v237, s[8:11], s70 offen sc1
  s_add_u32 s70, s70, 40960
  buffer_load_dwordx4 v[76:79], v237, s[8:11], s70 offen sc1
  s_add_u32 s70, s70, 40960
  buffer_load_dwordx4 v[80:83], v237, s[8:11], s70 offen sc1
  s_add_u32 s70, s70, 40960
  buffer_load_dwordx4 v[84:87], v237, s[8:11], s70 offen sc1
  s_add_u32 s70, s70, 40960
  buffer_load_dwordx4 v[88:91], v237, s[8:11], s70 offen sc1
  s_add_u32 s70, s70, 40960
  buffer_load_dwordx4 v[92:95], v237, s[8:11], s70 offen sc1
  s_add_u32 s70, s70, 40960
  buffer_load_dwordx4 v[96:99], v237, s[8:11], s70 offen sc1
  s_add_u32 s70, s70, 40960
  buffer_load_dwordx4 v[100:103], v237, s[8:11], s70 offen sc1
  s_add_u32 s70, s70, 40960
  buffer_load_dwordx4 v[104:107], v237, s[8:11], s70 offen sc1
  s_add_u32 s70, s70, 40960
  buffer_load_dwordx4 v[108:111], v237, s[8:11], s70 offen sc1
  s_add_u32 s70, s70, 40960
  s_add_u32 s69, s69, 1
  s_cmp_gt_u32 s69, 65536
  s_cbranch_scc1 role_abort
  s_waitcnt vmcnt(10)
  v_pk_add_f32 v[136:137], v[64:65], v[68:69]
  v_pk_add_f32 v[138:139], v[66:67], v[70:71]
  s_waitcnt vmcnt(9)
  v_pk_add_f32 v[136:137], v[136:137], v[72:73]
  v_pk_add_f32 v[138:139], v[138:139], v[74:75]
  s_waitcnt vmcnt(8)
  v_pk_add_f32 v[136:137], v[136:137], v[76:77]
  v_pk_add_f32 v[138:139], v[138:139], v[78:79]
  s_waitcnt vmcnt(7)
  v_pk_add_f32 v[136:137], v[136:137], v[80:81]
  v_pk_add_f32 v[138:139], v[138:139], v[82:83]
  s_waitcnt vmcnt(6)
  v_pk_add_f32 v[136:137], v[136:137], v[84:85]
  v_pk_add_f32 v[138:139], v[138:139], v[86:87]
  s_waitcnt vmcnt(5)
  v_pk_add_f32 v[136:137], v[136:137], v[88:89]
  v_pk_add_f32 v[138:139], v[138:139], v[90:91]
  s_waitcnt vmcnt(4)
  v_pk_add_f32 v[136:137], v[136:137], v[92:93]
  v_pk_add_f32 v[138:139], v[138:139], v[94:95]
  s_waitcnt vmcnt(3)
  v_pk_add_f32 v[136:137], v[136:137], v[96:97]
  v_pk_add_f32 v[138:139], v[138:139], v[98:99]
  s_waitcnt vmcnt(2)
  v_pk_add_f32 v[136:137], v[136:137], v[100:101]
  v_pk_add_f32 v[138:139], v[138:139], v[102:103]
  s_waitcnt vmcnt(1)
  v_pk_add_f32 v[136:137], v[136:137], v[104:105]
  v_pk_add_f32 v[138:139], v[138:139], v[106:107]
  s_waitcnt vmcnt(0)
  v_pk_add_f32 v[136:137], v[136:137], v[108:109]
  v_pk_add_f32 v[138:139], v[138:139], v[110:111]
  v_add_f32 v124, v136, v137
  v_add_f32 v125, v138, v139
  v_cmp_u_f32 vcc, v124, v125
  s_cbranch_vccz moe_yok
  s_sleep 2
  s_branch moe_yp
moe_yok:
  v_mov_b32 v140, v136
  v_mov_b32 v141, v137
  v_mov_b32 v142, v138
  v_mov_b32 v143, v139
  v_permlane32_swap_b32 v136, v140
  v_permlane32_swap_b32 v137, v141
  v_permlane32_swap_b32 v138, v142
  v_permlane32_swap_b32 v139, v143
  v_lshlrev_b32 v64, 16, v128
  v_and_b32 v65, 0xffff0000, v128
  v_lshlrev_b32 v68, 16, v130
  v_and_b32 v69, 0xffff0000, v130
  v_lshlrev_b32 v66, 16, v129
  v_and_b32 v67, 0xffff0000, v129
  v_lshlrev_b32 v70, 16, v131
  v_and_b32 v71, 0xffff0000, v131
  v_pk_add_f32 v[136:137], v[136:137], v[140:141]
  v_cvt_pk_bf16_f32 v124, v136, v137
  v_lshlrev_b32 v136, 16, v124
  v_and_b32 v137, 0xffff0000, v124
  v_mul_f32 v136, v136, v123
  v_mul_f32 v137, v137, v123
  v_cvt_pk_bf16_f32 v124, v136, v137
  v_lshlrev_b32 v136, 16, v124
  v_and_b32 v137, 0xffff0000, v124
  v_pk_add_f32 v[136:137], v[136:137], v[68:69]
  v_cvt_pk_bf16_f32 v124, v136, v137
  v_lshlrev_b32 v136, 16, v124
  v_and_b32 v137, 0xffff0000, v124
  v_pk_mul_f32 v[136:137], v[136:137], v[132:133]
  v_cvt_pk_bf16_f32 v124, v136, v137
  v_lshlrev_b32 v136, 16, v124
  v_and_b32 v137, 0xffff0000, v124
  v_pk_add_f32 v[136:137], v[136:137], v[64:65]
  v_cvt_pk_bf16_f32 v140, v136, v137
  v_pk_add_f32 v[138:139], v[138:139], v[142:143]
  v_cvt_pk_bf16_f32 v124, v138, v139
  v_lshlrev_b32 v138, 16, v124
  v_and_b32 v139, 0xffff0000, v124
  v_mul_f32 v138, v138, v123
  v_mul_f32 v139, v139, v123
  v_cvt_pk_bf16_f32 v124, v138, v139
  v_lshlrev_b32 v138, 16, v124
  v_and_b32 v139, 0xffff0000, v124
  v_pk_add_f32 v[138:139], v[138:139], v[70:71]
  v_cvt_pk_bf16_f32 v124, v138, v139
  v_lshlrev_b32 v138, 16, v124
  v_and_b32 v139, 0xffff0000, v124
  v_pk_mul_f32 v[138:139], v[138:139], v[134:135]
  v_cvt_pk_bf16_f32 v124, v138, v139
  v_lshlrev_b32 v138, 16, v124
  v_and_b32 v139, 0xffff0000, v124
  v_pk_add_f32 v[138:139], v[138:139], v[66:67]
  v_cvt_pk_bf16_f32 v141, v138, v139
  s_mov_b32 exec_hi, 0
  buffer_store_dwordx2 v[140:141], v122, s[24:27], 0 offen sc1
moe_end:
  s_endpgm
role_b:
  s_load_dwordx2 s[20:21], s[0:1], 16
  s_load_dwordx2 s[4:5], s[0:1], 24
  s_load_dwordx2 s[6:7], s[0:1], 32
  s_mov_b32 s22, 7864320
  s_mov_b32 s23, 0x00020000
  s_and_b32 s31, s17, 1
  s_lshl_b32 s24, s18, 1
  s_add_u32 s24, s24, s31
  s_lshl_b32 s32, s18, 2
  s_add_u32 s32, s32, s17
  s_sub_u32 s32, s32, 48
  s_lshr_b32 s27, s17, 1
  s_cmp_lt_u32 s18, 12
  s_cselect_b32 s24, s24, s32
  s_cselect_b32 s27, s27, 2
  s_mul_i32 s25, s24, 43
  s_lshr_b32 s25, s25, 8
  s_mul_i32 s32, s25, 6
  s_sub_u32 s26, s24, s32
  s_mul_i32 s33, s16, 1536
  s_lshr_b32 s32, s24, 1
  s_lshl_b32 s32, s32, 7
  s_add_u32 s33, s33, s32
  s_mul_i32 s32, s31, 983040
  s_add_u32 s33, s33, s32
  s_lshr_b32 s32, s17, 1
  s_mul_i32 s44, s32, 81920
  s_mul_i32 s34, s31, 10240
  s_add_u32 s34, s34, s44
  v_lshrrev_b32 v167, 4, v1
  v_and_b32 v167, 3, v167
  v_lshlrev_b32 v167, 1, v167
  v_and_b32 v4, 7, v1
  v_xor_b32 v4, v4, v167
  v_lshlrev_b32 v4, 4, v4
  v_lshrrev_b32 v167, 3, v1
  v_mul_u32_u24 v167, 12288, v167
  v_add_u32 v4, v4, v167
  s_waitcnt lgkmcnt(0)
  s_cmp_eq_u32 s27, 1
  s_cselect_b64 s[20:21], s[4:5], s[20:21]
  s_cmp_eq_u32 s27, 2
  s_cselect_b64 s[20:21], s[6:7], s[20:21]
  s_add_u32 m0, s34, 0
  s_add_u32 s32, s33, 0
  buffer_load_dwordx4 v4, s[20:23], s32 offen nt lds
  s_add_u32 m0, s34, 1024
  s_add_u32 s32, s33, 98304
  buffer_load_dwordx4 v4, s[20:23], s32 offen nt lds
  s_add_u32 m0, s34, 2048
  s_add_u32 s32, s33, 196608
  buffer_load_dwordx4 v4, s[20:23], s32 offen nt lds
  s_add_u32 m0, s34, 3072
  s_add_u32 s32, s33, 294912
  buffer_load_dwordx4 v4, s[20:23], s32 offen nt lds
  s_add_u32 m0, s34, 4096
  s_add_u32 s32, s33, 393216
  buffer_load_dwordx4 v4, s[20:23], s32 offen nt lds
  s_add_u32 m0, s34, 5120
  s_add_u32 s32, s33, 491520
  buffer_load_dwordx4 v4, s[20:23], s32 offen nt lds
  s_add_u32 m0, s34, 6144
  s_add_u32 s32, s33, 589824
  buffer_load_dwordx4 v4, s[20:23], s32 offen nt lds
  s_add_u32 m0, s34, 7168
  s_add_u32 s32, s33, 688128
  buffer_load_dwordx4 v4, s[20:23], s32 offen nt lds
  s_add_u32 m0, s34, 8192
  s_add_u32 s32, s33, 786432
  buffer_load_dwordx4 v4, s[20:23], s32 offen nt lds
  s_add_u32 m0, s34, 9216
  s_add_u32 s32, s33, 884736
  buffer_load_dwordx4 v4, s[20:23], s32 offen nt lds
  s_add_u32 m0, s34, 20480
  s_add_u32 s32, s33, 1966080
  buffer_load_dwordx4 v4, s[20:23], s32 offen nt lds
  s_add_u32 m0, s34, 21504
  s_add_u32 s32, s33, 2064384
  buffer_load_dwordx4 v4, s[20:23], s32 offen nt lds
  s_add_u32 m0, s34, 22528
  s_add_u32 s32, s33, 2162688
  buffer_load_dwordx4 v4, s[20:23], s32 offen nt lds
  s_add_u32 m0, s34, 23552
  s_add_u32 s32, s33, 2260992
  buffer_load_dwordx4 v4, s[20:23], s32 offen nt lds
  s_add_u32 m0, s34, 24576
  s_add_u32 s32, s33, 2359296
  buffer_load_dwordx4 v4, s[20:23], s32 offen nt lds
  s_add_u32 m0, s34, 25600
  s_add_u32 s32, s33, 2457600
  buffer_load_dwordx4 v4, s[20:23], s32 offen nt lds
  s_add_u32 m0, s34, 26624
  s_add_u32 s32, s33, 2555904
  buffer_load_dwordx4 v4, s[20:23], s32 offen nt lds
  s_add_u32 m0, s34, 27648
  s_add_u32 s32, s33, 2654208
  buffer_load_dwordx4 v4, s[20:23], s32 offen nt lds
  s_add_u32 m0, s34, 28672
  s_add_u32 s32, s33, 2752512
  buffer_load_dwordx4 v4, s[20:23], s32 offen nt lds
  s_add_u32 m0, s34, 29696
  s_add_u32 s32, s33, 2850816
  buffer_load_dwordx4 v4, s[20:23], s32 offen nt lds
  s_add_u32 m0, s34, 40960
  s_add_u32 s32, s33, 3932160
  buffer_load_dwordx4 v4, s[20:23], s32 offen nt lds
  s_add_u32 m0, s34, 41984
  s_add_u32 s32, s33, 4030464
  buffer_load_dwordx4 v4, s[20:23], s32 offen nt lds
  s_add_u32 m0, s34, 43008
  s_add_u32 s32, s33, 4128768
  buffer_load_dwordx4 v4, s[20:23], s32 offen nt lds
  s_add_u32 m0, s34, 44032
  s_add_u32 s32, s33, 4227072
  buffer_load_dwordx4 v4, s[20:23], s32 offen nt lds
  s_add_u32 m0, s34, 45056
  s_add_u32 s32, s33, 4325376
  buffer_load_dwordx4 v4, s[20:23], s32 offen nt lds
  s_add_u32 m0, s34, 46080
  s_add_u32 s32, s33, 4423680
  buffer_load_dwordx4 v4, s[20:23], s32 offen nt lds
  s_add_u32 m0, s34, 47104
  s_add_u32 s32, s33, 4521984
  buffer_load_dwordx4 v4, s[20:23], s32 offen nt lds
  s_add_u32 m0, s34, 48128
  s_add_u32 s32, s33, 4620288
  buffer_load_dwordx4 v4, s[20:23], s32 offen nt lds
  s_add_u32 m0, s34, 49152
  s_add_u32 s32, s33, 4718592
  buffer_load_dwordx4 v4, s[20:23], s32 offen nt lds
  s_add_u32 m0, s34, 50176
  s_add_u32 s32, s33, 4816896
  buffer_load_dwordx4 v4, s[20:23], s32 offen nt lds
  s_lshl_b32 s32, s31, 2
  s_xor_b32 s32, s32, 0
  v_lshrrev_b32 v167, 2, v1
  v_lshrrev_b32 v168, 1, v167
  v_and_b32 v168, 3, v168
  v_lshlrev_b32 v168, 1, v168
  v_bfe_u32 v172, v1, 1, 1
  v_add_u32 v172, s32, v172
  v_xor_b32 v172, v172, v168
  v_lshlrev_b32 v172, 4, v172
  v_lshlrev_b32 v167, 7, v167
  v_add_u32 v172, v172, v167
  v_and_b32 v167, 1, v1
  v_lshlrev_b32 v167, 3, v167
  v_add_u32 v172, v172, v167
  v_add_u32 v172, s44, v172
  s_lshl_b32 s32, s31, 2
  s_xor_b32 s32, s32, 2
  v_lshrrev_b32 v167, 2, v1
  v_lshrrev_b32 v168, 1, v167
  v_and_b32 v168, 3, v168
  v_lshlrev_b32 v168, 1, v168
  v_bfe_u32 v173, v1, 1, 1
  v_add_u32 v173, s32, v173
  v_xor_b32 v173, v173, v168
  v_lshlrev_b32 v173, 4, v173
  v_lshlrev_b32 v167, 7, v167
  v_add_u32 v173, v173, v167
  v_and_b32 v167, 1, v1
  v_lshlrev_b32 v167, 3, v167
  v_add_u32 v173, v173, v167
  v_add_u32 v173, s44, v173
  s_lshl_b32 s32, s31, 2
  s_xor_b32 s32, s32, 4
  v_lshrrev_b32 v167, 2, v1
  v_lshrrev_b32 v168, 1, v167
  v_and_b32 v168, 3, v168
  v_lshlrev_b32 v168, 1, v168
  v_bfe_u32 v174, v1, 1, 1
  v_add_u32 v174, s32, v174
  v_xor_b32 v174, v174, v168
  v_lshlrev_b32 v174, 4, v174
  v_lshlrev_b32 v167, 7, v167
  v_add_u32 v174, v174, v167
  v_and_b32 v167, 1, v1
  v_lshlrev_b32 v167, 3, v167
  v_add_u32 v174, v174, v167
  v_add_u32 v174, s44, v174
  s_lshl_b32 s32, s31, 2
  s_xor_b32 s32, s32, 6
  v_lshrrev_b32 v167, 2, v1
  v_lshrrev_b32 v168, 1, v167
  v_and_b32 v168, 3, v168
  v_lshlrev_b32 v168, 1, v168
  v_bfe_u32 v175, v1, 1, 1
  v_add_u32 v175, s32, v175
  v_xor_b32 v175, v175, v168
  v_lshlrev_b32 v175, 4, v175
  v_lshlrev_b32 v167, 7, v167
  v_add_u32 v175, v175, v167
  v_and_b32 v167, 1, v1
  v_lshlrev_b32 v167, 3, v167
  v_add_u32 v175, v175, v167
  v_add_u32 v175, s44, v175
  v_lshlrev_b32 v144, 4, v1
  v_lshlrev_b32 v145, 3, v1
  v_lshlrev_b32 v146, 2, v1
  s_mul_i32 s32, s17, 2560
  v_add_u32 v147, s32, v144
  s_add_u32 s32, s32, 2048
  v_add_u32 v148, s32, v146
  v_lshrrev_b32 v52, 4, v1
  v_and_b32 v53, 15, v1
  v_bfe_u32 v167, v1, 1, 1
  v_mul_u32_u24 v167, 0xaaaa, v167
  v_add_u32 v151, 0x4444, v167
  v_and_b32 v167, 1, v1
  v_mov_b32 v152, 0x05040100
  v_mov_b32 v168, 0x03020706
  v_cmp_eq_u32 vcc, 1, v167
  s_nop 1
  v_cndmask_b32 v152, v152, v168, vcc
  s_lshl_b32 s32, s17, 10
  s_add_u32 s32, s32, 10240
  v_lshl_add_u32 v149, v53, 5, s32
  s_lshr_b32 s32, s17, 1
  s_add_u32 s32, s32, 2
  v_lshlrev_b32 v167, s32, v52
  v_add_u32 v149, v149, v167
  v_and_b32 v167, 3, v1
  v_lshl_add_u32 v167, v52, 2, v167
  v_lshlrev_b32 v167, 4, v167
  v_bfe_u32 v168, v1, 3, 1
  v_lshl_add_u32 v167, v168, 8, v167
  v_bfe_u32 v168, v1, 2, 1
  v_lshl_add_u32 v150, v168, 3, v167
  v_bfe_u32 v167, v1, 2, 2
  v_lshlrev_b32 v167, 1, v167
  v_and_b32 v168, 1, v1
  v_add_u32 v167, v167, v168
  v_lshl_add_u32 v167, v52, 3, v167
  v_lshlrev_b32 v153, 4, v167
  v_lshlrev_b32 v167, 11, v52
  v_lshl_add_u32 v164, v53, 4, v167
  v_and_b32 v167, 7, v1
  v_lshlrev_b32 v167, 7, v167
  v_bfe_u32 v168, v1, 3, 1
  v_mul_u32_u24 v168, 6144, v168
  v_add_u32 v165, v167, v168
  s_mul_i32 s32, s31, 3072
  s_add_u32 s32, s32, 65536
  v_add_u32 v160, s32, v144
  s_mul_i32 s51, s31, 6144
  s_lshl_b32 s50, s31, 11
  s_sub_u32 s50, 1024, s50
  s_mul_i32 s32, s31, 20480
  v_add_u32 v159, s32, v144
  s_lshl_b32 s32, s31, 11
  s_add_u32 s32, s32, 65536
  v_add_u32 v161, s32, v144
  s_mov_b32 s54, 0xff00ff00
  s_mov_b32 s55, 0xff00ff00
  s_not_b64 s[52:53], s[54:55]
  s_cmp_eq_u32 s17, 0
  s_cselect_b64 s[52:53], s[52:53], s[54:55]
  s_mul_i32 s35, s16, 10240
  s_add_u32 s35, s35, 131072
  s_lshl_b32 s37, s16, 17
  s_lshl_b32 s32, s25, 13
  s_add_u32 s37, s37, s32
  s_add_u32 s37, s37, 3407872
  s_lshl_b32 s41, s16, 22
  s_add_u32 s41, s41, 67108864
  s_lshr_b32 s32, s24, 1
  s_lshl_b32 s39, s32, 10
  s_add_u32 s39, s39, s41
  s_add_u32 s39, s39, 589824
  s_mul_i32 s32, s27, 49152
  s_add_u32 s41, s41, s32
  s_mul_i32 s32, s25, 12288
  s_add_u32 s41, s41, s32
  s_lshl_b32 s32, s26, 10
  s_add_u32 s41, s41, s32
  s_mul_i32 s43, s16, 2621440
  s_add_u32 s43, s43, 247463936
  s_mul_i32 s32, s17, 10240
  s_add_u32 s43, s43, s32
  s_add_u32 s49, s32, 16384
  s_lshl_b32 s46, s16, 8
  v_add_u32 v157, s46, v146
  s_lshl_b32 s32, s25, 6
  s_add_u32 s32, s32, s46
  s_lshr_b32 s45, s26, 1
  s_lshl_b32 s45, s45, 2
  s_add_u32 s45, s45, s32
  s_add_u32 s48, s45, 48
  v_mov_b32 v155, s48
  s_add_u32 s45, s45, 12288
  s_lshl_b32 s48, s26, 2
  s_add_u32 s32, s32, s48
  s_add_u32 s48, s32, 12300
  s_cmp_lt_u32 s18, 12
  s_cselect_b32 s45, s45, s48
  v_mov_b32 v156, s45
  s_mul_i32 s48, s27, 24
  s_add_u32 s32, s32, s48
  s_add_u32 s32, s32, 0
  s_lshl_b32 s48, s24, 2
  s_add_u32 s48, s48, s46
  s_add_u32 s48, s48, 4096
  s_cmp_lt_u32 s18, 12
  s_cselect_b32 s32, s32, s48
  v_mov_b32 v154, s32
  s_lshl_b32 s47, s24, 13
  s_add_u32 s47, s47, s46
  s_add_u32 s47, s47, 16777216
  s_mov_b32 s28, 0
  s_mov_b32 s29, 0
  v_mov_b32 v169, 0
  v_mov_b32 v170, 0
  v_mov_b32 v72, -1
  v_mov_b32 v73, -1
  v_mov_b32 v74, -1
  v_mov_b32 v75, -1
  s_and_b32 s57, s24, 15
  s_add_u32 s57, s57, 24
  s_cmp_lt_u32 s18, 12
  s_cselect_b32 s57, s57, s24
  s_lshr_b32 s56, s57, 2
  s_mul_i32 s56, s56, 16384
  s_and_b32 s32, s57, 3
  s_lshl_b32 s32, s32, 11
  s_add_u32 s56, s56, s32
  s_add_u32 s56, s56, 16769024
  s_lshl_b32 s57, s57, 8
  v_and_b32 v168, 3, v1
  v_mov_b32 v132, 0x3f80
  v_cmp_eq_u32 vcc, 0, v168
  s_nop 1
  v_cndmask_b32 v133, v169, v132, vcc
  v_mov_b32 v132, 0x3f800000
  v_cmp_eq_u32 vcc, 1, v168
  s_nop 1
  v_cndmask_b32 v133, v133, v132, vcc
  v_lshrrev_b32 v167, 2, v53
  v_cmp_eq_u32 vcc, 0, v167
  s_nop 1
  v_cndmask_b32 v180, v169, v133, vcc
  v_cmp_eq_u32 vcc, 1, v167
  s_nop 1
  v_cndmask_b32 v181, v169, v133, vcc
  v_cmp_eq_u32 vcc, 2, v167
  s_nop 1
  v_cndmask_b32 v182, v169, v133, vcc
  v_cmp_eq_u32 vcc, 3, v167
  s_nop 1
  v_cndmask_b32 v183, v169, v133, vcc
  s_waitcnt vmcnt(20)
  s_add_u32 m0, s34, 61440
  s_add_u32 s32, s33, 5898240
  buffer_load_dwordx4 v4, s[20:23], s32 offen nt lds
  s_add_u32 m0, s34, 62464
  s_add_u32 s32, s33, 5996544
  buffer_load_dwordx4 v4, s[20:23], s32 offen nt lds
  s_add_u32 m0, s34, 63488
  s_add_u32 s32, s33, 6094848
  buffer_load_dwordx4 v4, s[20:23], s32 offen nt lds
  s_add_u32 m0, s34, 64512
  s_add_u32 s32, s33, 6193152
  buffer_load_dwordx4 v4, s[20:23], s32 offen nt lds
  s_add_u32 m0, s34, 65536
  s_add_u32 s32, s33, 6291456
  buffer_load_dwordx4 v4, s[20:23], s32 offen nt lds
  s_add_u32 m0, s34, 66560
  s_add_u32 s32, s33, 6389760
  buffer_load_dwordx4 v4, s[20:23], s32 offen nt lds
  s_add_u32 m0, s34, 67584
  s_add_u32 s32, s33, 6488064
  buffer_load_dwordx4 v4, s[20:23], s32 offen nt lds
  s_add_u32 m0, s34, 68608
  s_add_u32 s32, s33, 6586368
  buffer_load_dwordx4 v4, s[20:23], s32 offen nt lds
  s_add_u32 m0, s34, 69632
  s_add_u32 s32, s33, 6684672
  buffer_load_dwordx4 v4, s[20:23], s32 offen nt lds
  s_add_u32 m0, s34, 70656
  s_add_u32 s32, s33, 6782976
  buffer_load_dwordx4 v4, s[20:23], s32 offen nt lds
  s_barrier
  ds_read_b64_tr_b16 v[192:193], v172 offset:0
  ds_read_b64_tr_b16 v[194:195], v172 offset:2048
  ds_read_b64_tr_b16 a[16:17], v173 offset:0
  ds_read_b64_tr_b16 a[18:19], v173 offset:2048
  ds_read_b64_tr_b16 a[96:97], v174 offset:0
  ds_read_b64_tr_b16 a[98:99], v174 offset:2048
  ds_read_b64_tr_b16 a[176:177], v175 offset:0
  ds_read_b64_tr_b16 a[178:179], v175 offset:2048
  s_waitcnt lgkmcnt(6)
  ds_read_b64_tr_b16 v[196:197], v172 offset:4096
  ds_read_b64_tr_b16 v[198:199], v172 offset:6144
  ds_read_b64_tr_b16 a[20:21], v173 offset:4096
  ds_read_b64_tr_b16 a[22:23], v173 offset:6144
  ds_read_b64_tr_b16 a[100:101], v174 offset:4096
  ds_read_b64_tr_b16 a[102:103], v174 offset:6144
  ds_read_b64_tr_b16 a[180:181], v175 offset:4096
  ds_read_b64_tr_b16 a[182:183], v175 offset:6144
  s_waitcnt lgkmcnt(6)
  ds_read_b64_tr_b16 v[200:201], v172 offset:8192
  ds_read_b64_tr_b16 v[202:203], v172 offset:10240
  ds_read_b64_tr_b16 a[24:25], v173 offset:8192
  ds_read_b64_tr_b16 a[26:27], v173 offset:10240
  ds_read_b64_tr_b16 a[104:105], v174 offset:8192
  ds_read_b64_tr_b16 a[106:107], v174 offset:10240
  ds_read_b64_tr_b16 a[184:185], v175 offset:8192
  ds_read_b64_tr_b16 a[186:187], v175 offset:10240
  s_waitcnt lgkmcnt(6)
  ds_read_b64_tr_b16 v[204:205], v172 offset:12288
  ds_read_b64_tr_b16 v[206:207], v172 offset:14336
  ds_read_b64_tr_b16 a[28:29], v173 offset:12288
  ds_read_b64_tr_b16 a[30:31], v173 offset:14336
  ds_read_b64_tr_b16 a[108:109], v174 offset:12288
  ds_read_b64_tr_b16 a[110:111], v174 offset:14336
  ds_read_b64_tr_b16 a[188:189], v175 offset:12288
  ds_read_b64_tr_b16 a[190:191], v175 offset:14336
  s_waitcnt lgkmcnt(6)
  ds_read_b64_tr_b16 v[208:209], v172 offset:16384
  ds_read_b64_tr_b16 v[210:211], v172 offset:18432
  ds_read_b64_tr_b16 a[32:33], v173 offset:16384
  ds_read_b64_tr_b16 a[34:35], v173 offset:18432
  ds_read_b64_tr_b16 a[112:113], v174 offset:16384
  ds_read_b64_tr_b16 a[114:115], v174 offset:18432
  ds_read_b64_tr_b16 a[192:193], v175 offset:16384
  ds_read_b64_tr_b16 a[194:195], v175 offset:18432
  s_waitcnt lgkmcnt(6)
  s_waitcnt vmcnt(20)
  s_barrier
  ds_read_b64_tr_b16 v[212:213], v172 offset:20480
  ds_read_b64_tr_b16 v[214:215], v172 offset:22528
  ds_read_b64_tr_b16 a[36:37], v173 offset:20480
  ds_read_b64_tr_b16 a[38:39], v173 offset:22528
  ds_read_b64_tr_b16 a[116:117], v174 offset:20480
  ds_read_b64_tr_b16 a[118:119], v174 offset:22528
  ds_read_b64_tr_b16 a[196:197], v175 offset:20480
  ds_read_b64_tr_b16 a[198:199], v175 offset:22528
  s_waitcnt lgkmcnt(6)
  ds_read_b64_tr_b16 v[216:217], v172 offset:24576
  ds_read_b64_tr_b16 v[218:219], v172 offset:26624
  ds_read_b64_tr_b16 a[40:41], v173 offset:24576
  ds_read_b64_tr_b16 a[42:43], v173 offset:26624
  ds_read_b64_tr_b16 a[120:121], v174 offset:24576
  ds_read_b64_tr_b16 a[122:123], v174 offset:26624
  ds_read_b64_tr_b16 a[200:201], v175 offset:24576
  ds_read_b64_tr_b16 a[202:203], v175 offset:26624
  s_waitcnt lgkmcnt(6)
  ds_read_b64_tr_b16 v[220:221], v172 offset:28672
  ds_read_b64_tr_b16 v[222:223], v172 offset:30720
  ds_read_b64_tr_b16 a[44:45], v173 offset:28672
  ds_read_b64_tr_b16 a[46:47], v173 offset:30720
  ds_read_b64_tr_b16 a[124:125], v174 offset:28672
  ds_read_b64_tr_b16 a[126:127], v174 offset:30720
  ds_read_b64_tr_b16 a[204:205], v175 offset:28672
  ds_read_b64_tr_b16 a[206:207], v175 offset:30720
  s_waitcnt lgkmcnt(6)
  ds_read_b64_tr_b16 v[224:225], v172 offset:32768
  ds_read_b64_tr_b16 v[226:227], v172 offset:34816
  ds_read_b64_tr_b16 a[48:49], v173 offset:32768
  ds_read_b64_tr_b16 a[50:51], v173 offset:34816
  ds_read_b64_tr_b16 a[128:129], v174 offset:32768
  ds_read_b64_tr_b16 a[130:131], v174 offset:34816
  ds_read_b64_tr_b16 a[208:209], v175 offset:32768
  ds_read_b64_tr_b16 a[210:211], v175 offset:34816
  s_waitcnt lgkmcnt(6)
  ds_read_b64_tr_b16 v[228:229], v172 offset:36864
  ds_read_b64_tr_b16 v[230:231], v172 offset:38912
  ds_read_b64_tr_b16 a[52:53], v173 offset:36864
  ds_read_b64_tr_b16 a[54:55], v173 offset:38912
  ds_read_b64_tr_b16 a[132:133], v174 offset:36864
  ds_read_b64_tr_b16 a[134:135], v174 offset:38912
  ds_read_b64_tr_b16 a[212:213], v175 offset:36864
  ds_read_b64_tr_b16 a[214:215], v175 offset:38912
  s_waitcnt lgkmcnt(6)
  s_waitcnt vmcnt(10)
  s_barrier
  v_add_u32 v172, 40960, v172
  v_add_u32 v173, 40960, v173
  v_add_u32 v174, 40960, v174
  v_add_u32 v175, 40960, v175
  ds_read_b64_tr_b16 v[232:233], v172 offset:0
  ds_read_b64_tr_b16 v[234:235], v172 offset:2048
  ds_read_b64_tr_b16 a[56:57], v173 offset:0
  ds_read_b64_tr_b16 a[58:59], v173 offset:2048
  ds_read_b64_tr_b16 a[136:137], v174 offset:0
  ds_read_b64_tr_b16 a[138:139], v174 offset:2048
  ds_read_b64_tr_b16 a[216:217], v175 offset:0
  ds_read_b64_tr_b16 a[218:219], v175 offset:2048
  s_waitcnt lgkmcnt(6)
  ds_read_b64_tr_b16 v[236:237], v172 offset:4096
  ds_read_b64_tr_b16 v[238:239], v172 offset:6144
  ds_read_b64_tr_b16 a[60:61], v173 offset:4096
  ds_read_b64_tr_b16 a[62:63], v173 offset:6144
  ds_read_b64_tr_b16 a[140:141], v174 offset:4096
  ds_read_b64_tr_b16 a[142:143], v174 offset:6144
  ds_read_b64_tr_b16 a[220:221], v175 offset:4096
  ds_read_b64_tr_b16 a[222:223], v175 offset:6144
  s_waitcnt lgkmcnt(6)
  ds_read_b64_tr_b16 v[240:241], v172 offset:8192
  ds_read_b64_tr_b16 v[242:243], v172 offset:10240
  ds_read_b64_tr_b16 a[64:65], v173 offset:8192
  ds_read_b64_tr_b16 a[66:67], v173 offset:10240
  ds_read_b64_tr_b16 a[144:145], v174 offset:8192
  ds_read_b64_tr_b16 a[146:147], v174 offset:10240
  ds_read_b64_tr_b16 a[224:225], v175 offset:8192
  ds_read_b64_tr_b16 a[226:227], v175 offset:10240
  s_waitcnt lgkmcnt(6)
  ds_read_b64_tr_b16 v[244:245], v172 offset:12288
  ds_read_b64_tr_b16 v[246:247], v172 offset:14336
  ds_read_b64_tr_b16 a[68:69], v173 offset:12288
  ds_read_b64_tr_b16 a[70:71], v173 offset:14336
  ds_read_b64_tr_b16 a[148:149], v174 offset:12288
  ds_read_b64_tr_b16 a[150:151], v174 offset:14336
  ds_read_b64_tr_b16 a[228:229], v175 offset:12288
  ds_read_b64_tr_b16 a[230:231], v175 offset:14336
  s_waitcnt lgkmcnt(6)
  ds_read_b64_tr_b16 v[248:249], v172 offset:16384
  ds_read_b64_tr_b16 v[250:251], v172 offset:18432
  ds_read_b64_tr_b16 a[72:73], v173 offset:16384
  ds_read_b64_tr_b16 a[74:75], v173 offset:18432
  ds_read_b64_tr_b16 a[152:153], v174 offset:16384
  ds_read_b64_tr_b16 a[154:155], v174 offset:18432
  ds_read_b64_tr_b16 a[232:233], v175 offset:16384
  ds_read_b64_tr_b16 a[234:235], v175 offset:18432
  s_waitcnt lgkmcnt(6)
  s_waitcnt vmcnt(0)
  s_barrier
  ds_read_b64_tr_b16 v[252:253], v172 offset:20480
  ds_read_b64_tr_b16 v[254:255], v172 offset:22528
  ds_read_b64_tr_b16 a[76:77], v173 offset:20480
  ds_read_b64_tr_b16 a[78:79], v173 offset:22528
  ds_read_b64_tr_b16 a[156:157], v174 offset:20480
  ds_read_b64_tr_b16 a[158:159], v174 offset:22528
  ds_read_b64_tr_b16 a[236:237], v175 offset:20480
  ds_read_b64_tr_b16 a[238:239], v175 offset:22528
  s_waitcnt lgkmcnt(6)
  ds_read_b64_tr_b16 a[0:1], v172 offset:24576
  ds_read_b64_tr_b16 a[2:3], v172 offset:26624
  ds_read_b64_tr_b16 a[80:81], v173 offset:24576
  ds_read_b64_tr_b16 a[82:83], v173 offset:26624
  ds_read_b64_tr_b16 a[160:161], v174 offset:24576
  ds_read_b64_tr_b16 a[162:163], v174 offset:26624
  ds_read_b64_tr_b16 a[240:241], v175 offset:24576
  ds_read_b64_tr_b16 a[242:243], v175 offset:26624
  s_waitcnt lgkmcnt(6)
  ds_read_b64_tr_b16 a[4:5], v172 offset:28672
  ds_read_b64_tr_b16 a[6:7], v172 offset:30720
  ds_read_b64_tr_b16 a[84:85], v173 offset:28672
  ds_read_b64_tr_b16 a[86:87], v173 offset:30720
  ds_read_b64_tr_b16 a[164:165], v174 offset:28672
  ds_read_b64_tr_b16 a[166:167], v174 offset:30720
  ds_read_b64_tr_b16 a[244:245], v175 offset:28672
  ds_read_b64_tr_b16 a[246:247], v175 offset:30720
  s_waitcnt lgkmcnt(6)
  ds_read_b64_tr_b16 a[8:9], v172 offset:32768
  ds_read_b64_tr_b16 a[10:11], v172 offset:34816
  ds_read_b64_tr_b16 a[88:89], v173 offset:32768
  ds_read_b64_tr_b16 a[90:91], v173 offset:34816
  ds_read_b64_tr_b16 a[168:169], v174 offset:32768
  ds_read_b64_tr_b16 a[170:171], v174 offset:34816
  ds_read_b64_tr_b16 a[248:249], v175 offset:32768
  ds_read_b64_tr_b16 a[250:251], v175 offset:34816
  s_waitcnt lgkmcnt(6)
  ds_read_b64_tr_b16 a[12:13], v172 offset:36864
  ds_read_b64_tr_b16 a[14:15], v172 offset:38912
  ds_read_b64_tr_b16 a[92:93], v173 offset:36864
  ds_read_b64_tr_b16 a[94:95], v173 offset:38912
  ds_read_b64_tr_b16 a[172:173], v174 offset:36864
  ds_read_b64_tr_b16 a[174:175], v174 offset:38912
  ds_read_b64_tr_b16 a[252:253], v175 offset:36864
  ds_read_b64_tr_b16 a[254:255], v175 offset:38912
  s_waitcnt lgkmcnt(6)
  s_mov_b32 s44, s49
  s_waitcnt lgkmcnt(0)
  s_barrier
  s_lshl_b32 s30, s16, 2
  s_add_u32 s30, s30, 32
  v_mov_b32 v167, s30
  s_mov_b32 s30, 0
  s_mov_b64 exec, 1
gw_30:
  buffer_load_dword v168, v167, s[12:15], 0 offen sc1
  s_add_u32 s30, s30, 1
  s_cmp_gt_u32 s30, 65536
  s_cbranch_scc1 role_abort
  s_waitcnt vmcnt(0)
  v_cmp_gt_u32 vcc, 2, v168
  s_cbranch_vccz gk_31
  s_sleep 4
  s_branch gw_30
gk_31:
  s_mov_b64 exec, -1
  s_mov_b32 s33, 8192
  s_mov_b32 s30, 0
pw_32:
  buffer_load_dword v158, v157, s[8:11], s33 offen sc1
  s_add_u32 s30, s30, 1
  s_cmp_gt_u32 s30, 65536
  s_cbranch_scc1 role_abort
  s_waitcnt vmcnt(0)
pc_34:
  v_cmp_gt_u32 vcc, 2, v158
  s_nop 0
  s_and_b32 vcc_lo, vcc_lo, 0xfff
  s_and_b32 vcc_hi, vcc_hi, 0x0
  s_cmp_eq_u64 vcc, 0
  s_cbranch_scc1 po_33
  s_sleep 2
  s_branch pw_32
po_33:
  s_add_u32 m0, s44, 0
  s_add_u32 s31, s43, 0
  buffer_load_dwordx4 v144, s[8:11], s31 offen offset:0 sc1 lds
  buffer_load_dwordx4 v144, s[8:11], s31 offen offset:1024 sc1 lds
  buffer_load_dwordx4 v144, s[8:11], s31 offen offset:2048 sc1 lds
  buffer_load_dwordx4 v144, s[8:11], s31 offen offset:3072 sc1 lds
  s_add_u32 m0, s44, 4096
  s_add_u32 s31, s43, 4096
  buffer_load_dwordx4 v144, s[8:11], s31 offen offset:0 sc1 lds
  buffer_load_dwordx4 v144, s[8:11], s31 offen offset:1024 sc1 lds
  buffer_load_dwordx4 v144, s[8:11], s31 offen offset:2048 sc1 lds
  buffer_load_dwordx4 v144, s[8:11], s31 offen offset:3072 sc1 lds
  s_add_u32 m0, s44, 8192
  s_add_u32 s31, s43, 8192
  buffer_load_dwordx4 v144, s[8:11], s31 offen offset:0 sc1 lds
  buffer_load_dwordx4 v144, s[8:11], s31 offen offset:1024 sc1 lds
  s_xor_b32 s44, s44, 0x10000
  s_add_u32 s43, s43, 40960
  s_waitcnt vmcnt(0)
  s_barrier
  s_cmp_ge_u32 s18, 12
  s_cbranch_scc1 b_pro3
  s_cmp_lt_u32 s17, 2
  s_cbranch_scc1 b_pro0
  s_cmp_eq_u32 s17, 2
  s_cbranch_scc1 b_pro1
  s_branch b_pro2
b_pro0:
  s_lshr_b32 s31, s26, 1
  s_lshl_b32 s31, s31, 10
  s_cmp_eq_u32 s17, 0
  s_cselect_b32 s46, s31, 3072
  s_add_u32 s46, s46, s37
  s_add_u32 s37, s37, s31
b_top0:
  s_add_u32 s31, s28, 3
  s_and_b32 s31, s31, 3
  s_mul_i32 s31, s31, 163840
  s_add_u32 s58, s56, s31
  s_add_u32 s59, s58, 16384
  s_add_u32 s60, s58, 32768
  s_cmp_ge_u32 s29, 64
  s_cbranch_scc1 b_step00
  ds_read_b128 v[116:119], v159 offset:16384
  ds_read_b128 v[120:123], v159 offset:17408
  ds_read_b128 v[124:127], v159 offset:18432
  s_and_b32 s31, s29, 3
  s_mul_i32 s31, s31, 147456
  s_add_u32 s42, s41, s31
  s_add_u32 s42, s42, s51
  s_add_u32 s49, s29, 2
  s_lshl_b32 s48, s49, 1
  s_min_u32 s48, s48, 128
  s_and_b32 s31, s29, 3
  s_lshl_b32 s31, s31, 12
  v_add_u32 v162, s31, v160
  v_xor_b32 v176, 1024, v162
  s_add_u32 s29, s29, 1
  s_mov_b32 s33, 8192
  s_waitcnt lgkmcnt(2)
  v_mfma_f32_16x16x32_bf16 v[100:103], v[192:195], v[116:119], 0
  ds_read_b128 v[128:131], v159 offset:19456
  v_mfma_f32_16x16x32_bf16 v[104:107], a[16:19], v[116:119], 0
  v_mfma_f32_16x16x32_bf16 v[108:111], a[96:99], v[116:119], 0
  v_mfma_f32_16x16x32_bf16 v[112:115], a[176:179], v[116:119], 0
  s_waitcnt lgkmcnt(2)
  v_mfma_f32_16x16x32_bf16 v[100:103], v[196:199], v[120:123], v[100:103]
  ds_read_b128 v[116:119], v159 offset:20480
  v_mfma_f32_16x16x32_bf16 v[104:107], a[20:23], v[120:123], v[104:107]
  v_mfma_f32_16x16x32_bf16 v[108:111], a[100:103], v[120:123], v[108:111]
  v_mfma_f32_16x16x32_bf16 v[112:115], a[180:183], v[120:123], v[112:115]
  s_waitcnt lgkmcnt(2)
  v_mfma_f32_16x16x32_bf16 v[100:103], v[200:203], v[124:127], v[100:103]
  ds_read_b128 v[120:123], v159 offset:21504
  v_mfma_f32_16x16x32_bf16 v[104:107], a[24:27], v[124:127], v[104:107]
  s_mov_b32 s30, 0
  s_branch pc_37
pw_35:
  buffer_load_dword v158, v157, s[8:11], s33 offen sc1
  s_add_u32 s30, s30, 1
  s_cmp_gt_u32 s30, 65536
  s_cbranch_scc1 role_abort
  s_waitcnt vmcnt(0)
pc_37:
  v_cmp_gt_u32 vcc, s48, v158
  s_nop 0
  s_and_b32 vcc_lo, vcc_lo, 0xfff
  s_and_b32 vcc_hi, vcc_hi, 0x0
  s_cmp_eq_u64 vcc, 0
  s_cbranch_scc1 po_36
  s_sleep 4
  s_branch pw_35
po_36:
  v_mfma_f32_16x16x32_bf16 v[108:111], a[104:107], v[124:127], v[108:111]
  v_mfma_f32_16x16x32_bf16 v[112:115], a[184:187], v[124:127], v[112:115]
  s_add_u32 m0, s44, 0
  s_add_u32 s31, s43, 0
  buffer_load_dwordx4 v144, s[8:11], s31 offen offset:0 sc1 lds
  s_waitcnt lgkmcnt(2)
  v_mfma_f32_16x16x32_bf16 v[100:103], v[204:207], v[128:131], v[100:103]
  ds_read_b128 v[124:127], v159 offset:22528
  v_mfma_f32_16x16x32_bf16 v[104:107], a[28:31], v[128:131], v[104:107]
  v_mfma_f32_16x16x32_bf16 v[108:111], a[108:111], v[128:131], v[108:111]
  v_mfma_f32_16x16x32_bf16 v[112:115], a[188:191], v[128:131], v[112:115]
  buffer_load_dwordx4 v144, s[8:11], s31 offen offset:1024 sc1 lds
  s_waitcnt lgkmcnt(2)
  v_mfma_f32_16x16x32_bf16 v[100:103], v[208:211], v[116:119], v[100:103]
  ds_read_b128 v[128:131], v159 offset:23552
  v_mfma_f32_16x16x32_bf16 v[104:107], a[32:35], v[116:119], v[104:107]
  v_mfma_f32_16x16x32_bf16 v[108:111], a[112:115], v[116:119], v[108:111]
  v_mfma_f32_16x16x32_bf16 v[112:115], a[192:195], v[116:119], v[112:115]
  buffer_load_dwordx4 v144, s[8:11], s31 offen offset:2048 sc1 lds
  s_waitcnt lgkmcnt(2)
  v_mfma_f32_16x16x32_bf16 v[100:103], v[212:215], v[120:123], v[100:103]
  ds_read_b128 v[116:119], v159 offset:24576
  v_mfma_f32_16x16x32_bf16 v[104:107], a[36:39], v[120:123], v[104:107]
  v_mfma_f32_16x16x32_bf16 v[108:111], a[116:119], v[120:123], v[108:111]
  v_mfma_f32_16x16x32_bf16 v[112:115], a[196:199], v[120:123], v[112:115]
  buffer_load_dwordx4 v144, s[8:11], s31 offen offset:3072 sc1 lds
  s_waitcnt lgkmcnt(2)
  v_mfma_f32_16x16x32_bf16 v[100:103], v[216:219], v[124:127], v[100:103]
  ds_read_b128 v[120:123], v159 offset:25600
  v_mfma_f32_16x16x32_bf16 v[104:107], a[40:43], v[124:127], v[104:107]
  v_mfma_f32_16x16x32_bf16 v[108:111], a[120:123], v[124:127], v[108:111]
  v_mfma_f32_16x16x32_bf16 v[112:115], a[200:203], v[124:127], v[112:115]
  s_add_u32 m0, s44, 4096
  s_add_u32 s31, s43, 4096
  buffer_load_dwordx4 v144, s[8:11], s31 offen offset:0 sc1 lds
  s_waitcnt lgkmcnt(2)
  v_mfma_f32_16x16x32_bf16 v[100:103], v[220:223], v[128:131], v[100:103]
  ds_read_b128 v[124:127], v159 offset:26624
  v_mfma_f32_16x16x32_bf16 v[104:107], a[44:47], v[128:131], v[104:107]
  v_mfma_f32_16x16x32_bf16 v[108:111], a[124:127], v[128:131], v[108:111]
  v_mfma_f32_16x16x32_bf16 v[112:115], a[204:207], v[128:131], v[112:115]
  buffer_load_dwordx4 v144, s[8:11], s31 offen offset:1024 sc1 lds
  s_waitcnt lgkmcnt(2)
  v_mfma_f32_16x16x32_bf16 v[100:103], v[224:227], v[116:119], v[100:103]
  ds_read_b128 v[128:131], v159 offset:27648
  v_mfma_f32_16x16x32_bf16 v[104:107], a[48:51], v[116:119], v[104:107]
  v_mfma_f32_16x16x32_bf16 v[108:111], a[128:131], v[116:119], v[108:111]
  v_mfma_f32_16x16x32_bf16 v[112:115], a[208:211], v[116:119], v[112:115]
  buffer_load_dwordx4 v144, s[8:11], s31 offen offset:2048 sc1 lds
  s_waitcnt lgkmcnt(2)
  v_mfma_f32_16x16x32_bf16 v[100:103], v[228:231], v[120:123], v[100:103]
  ds_read_b128 v[116:119], v159 offset:28672
  v_mfma_f32_16x16x32_bf16 v[104:107], a[52:55], v[120:123], v[104:107]
  v_mfma_f32_16x16x32_bf16 v[108:111], a[132:135], v[120:123], v[108:111]
  v_mfma_f32_16x16x32_bf16 v[112:115], a[212:215], v[120:123], v[112:115]
  buffer_load_dwordx4 v144, s[8:11], s31 offen offset:3072 sc1 lds
  s_waitcnt lgkmcnt(2)
  v_mfma_f32_16x16x32_bf16 v[100:103], v[232:235], v[124:127], v[100:103]
  ds_read_b128 v[120:123], v159 offset:29696
  v_mfma_f32_16x16x32_bf16 v[104:107], a[56:59], v[124:127], v[104:107]
  v_mfma_f32_16x16x32_bf16 v[108:111], a[136:139], v[124:127], v[108:111]
  v_mfma_f32_16x16x32_bf16 v[112:115], a[216:219], v[124:127], v[112:115]
  s_add_u32 m0, s44, 8192
  s_add_u32 s31, s43, 8192
  buffer_load_dwordx4 v144, s[8:11], s31 offen offset:0 sc1 lds
  s_waitcnt lgkmcnt(2)
  v_mfma_f32_16x16x32_bf16 v[100:103], v[236:239], v[128:131], v[100:103]
  ds_read_b128 v[124:127], v159 offset:30720
  v_mfma_f32_16x16x32_bf16 v[104:107], a[60:63], v[128:131], v[104:107]
  v_mfma_f32_16x16x32_bf16 v[108:111], a[140:143], v[128:131], v[108:111]
  v_mfma_f32_16x16x32_bf16 v[112:115], a[220:223], v[128:131], v[112:115]
  buffer_load_dwordx4 v144, s[8:11], s31 offen offset:1024 sc1 lds
  s_waitcnt lgkmcnt(2)
  v_mfma_f32_16x16x32_bf16 v[100:103], v[240:243], v[116:119], v[100:103]
  ds_read_b128 v[128:131], v159 offset:31744
  v_mfma_f32_16x16x32_bf16 v[104:107], a[64:67], v[116:119], v[104:107]
  v_mfma_f32_16x16x32_bf16 v[108:111], a[144:147], v[116:119], v[108:111]
  v_mfma_f32_16x16x32_bf16 v[112:115], a[224:227], v[116:119], v[112:115]
  buffer_load_dword v158, v157, s[8:11], s33 offen sc1
  s_waitcnt lgkmcnt(2)
  v_mfma_f32_16x16x32_bf16 v[100:103], v[244:247], v[120:123], v[100:103]
  ds_read_b128 v[116:119], v159 offset:32768
  v_mfma_f32_16x16x32_bf16 v[104:107], a[68:71], v[120:123], v[104:107]
  v_mfma_f32_16x16x32_bf16 v[108:111], a[148:151], v[120:123], v[108:111]
  v_mfma_f32_16x16x32_bf16 v[112:115], a[228:231], v[120:123], v[112:115]
  s_waitcnt lgkmcnt(2)
  v_mfma_f32_16x16x32_bf16 v[100:103], v[248:251], v[124:127], v[100:103]
  ds_read_b128 v[120:123], v159 offset:33792
  v_mfma_f32_16x16x32_bf16 v[104:107], a[72:75], v[124:127], v[104:107]
  v_mfma_f32_16x16x32_bf16 v[108:111], a[152:155], v[124:127], v[108:111]
  v_mfma_f32_16x16x32_bf16 v[112:115], a[232:235], v[124:127], v[112:115]
  s_waitcnt lgkmcnt(2)
  v_mfma_f32_16x16x32_bf16 v[100:103], v[252:255], v[128:131], v[100:103]
  ds_read_b128 v[124:127], v159 offset:34816
  v_mfma_f32_16x16x32_bf16 v[104:107], a[76:79], v[128:131], v[104:107]
  v_mfma_f32_16x16x32_bf16 v[108:111], a[156:159], v[128:131], v[108:111]
  v_mfma_f32_16x16x32_bf16 v[112:115], a[236:239], v[128:131], v[112:115]
  s_waitcnt lgkmcnt(2)
  v_mfma_f32_16x16x32_bf16 v[100:103], a[0:3], v[116:119], v[100:103]
  ds_read_b128 v[128:131], v159 offset:35840
  v_mfma_f32_16x16x32_bf16 v[104:107], a[80:83], v[116:119], v[104:107]
  v_mfma_f32_16x16x32_bf16 v[108:111], a[160:163], v[116:119], v[108:111]
  v_mfma_f32_16x16x32_bf16 v[112:115], a[240:243], v[116:119], v[112:115]
  s_waitcnt lgkmcnt(2)
  v_mfma_f32_16x16x32_bf16 v[100:103], a[4:7], v[120:123], v[100:103]
  v_mfma_f32_16x16x32_bf16 v[104:107], a[84:87], v[120:123], v[104:107]
  v_mfma_f32_16x16x32_bf16 v[108:111], a[164:167], v[120:123], v[108:111]
  v_mfma_f32_16x16x32_bf16 v[112:115], a[244:247], v[120:123], v[112:115]
  s_waitcnt lgkmcnt(1)
  v_mfma_f32_16x16x32_bf16 v[100:103], a[8:11], v[124:127], v[100:103]
  v_mfma_f32_16x16x32_bf16 v[104:107], a[88:91], v[124:127], v[104:107]
  v_mfma_f32_16x16x32_bf16 v[108:111], a[168:171], v[124:127], v[108:111]
  v_mfma_f32_16x16x32_bf16 v[112:115], a[248:251], v[124:127], v[112:115]
  s_waitcnt lgkmcnt(0)
  v_mfma_f32_16x16x32_bf16 v[100:103], a[12:15], v[128:131], v[100:103]
  v_mfma_f32_16x16x32_bf16 v[104:107], a[92:95], v[128:131], v[104:107]
  v_mfma_f32_16x16x32_bf16 v[108:111], a[172:175], v[128:131], v[108:111]
  v_mfma_f32_16x16x32_bf16 v[112:115], a[252:255], v[128:131], v[112:115]
  s_xor_b32 s44, s44, 0x10000
  v_xor_b32 v159, 0x10000, v159
  s_cmp_lt_u32 s29, 63
  s_cselect_b32 s31, 40960, 0
  s_add_u32 s43, s43, s31
  s_mul_i32 s31, s16, 2621440
  s_cmp_eq_u32 s29, 11
  s_cselect_b32 s31, s31, 0
  s_sub_u32 s43, s43, s31
  v_mov_b32 v169, s29
  v_cvt_pk_bf16_f32 v132, v100, v101
  v_cvt_pk_bf16_f32 v133, v102, v103
  v_cvt_pk_bf16_f32 v134, v104, v105
  v_cvt_pk_bf16_f32 v135, v106, v107
  buffer_store_dwordx4 v[132:135], v144, s[8:11], s42 offen
  s_add_u32 s42, s42, s50
  v_cvt_pk_bf16_f32 v136, v108, v109
  v_cvt_pk_bf16_f32 v137, v110, v111
  v_cvt_pk_bf16_f32 v138, v112, v113
  v_cvt_pk_bf16_f32 v139, v114, v115
  buffer_store_dwordx4 v[136:139], v144, s[8:11], s42 offen
  s_add_u32 s42, s42, s50
  s_cmp_gt_u32 s29, 2
  s_cbranch_scc1 b_step03
  s_waitcnt vmcnt(0) lgkmcnt(0)
  buffer_store_dword v169, v154, s[8:11], 0 offen
  s_cmp_eq_u32 s29, 2
  s_barrier
  s_cbranch_scc1 b_top0
  s_mov_b32 s33, 4096
  s_mov_b32 s30, 0
pw_38:
  buffer_load_dword v166, v157, s[8:11], s33 offen sc1
  s_add_u32 s30, s30, 1
  s_cmp_gt_u32 s30, 65536
  s_cbranch_scc1 role_abort
  s_waitcnt vmcnt(0)
pc_40:
  v_cmp_gt_u32 vcc, 1, v166
  s_nop 0
  s_and_b32 vcc_lo, vcc_lo, 0x10000000
  s_and_b32 vcc_hi, vcc_hi, 0x0
  s_cmp_eq_u64 vcc, 0
  s_cbranch_scc1 po_39
  s_sleep 2
  s_branch pw_38
po_39:
  v_readlane_b32 s31, v166, 28
  s_nop 0
  s_lshl_b32 s31, s31, 13
  s_add_u32 s56, s56, s31
  s_branch b_step02
b_step00:
  s_sleep 24
b_step03:
  s_waitcnt vmcnt(2) lgkmcnt(0)
  s_barrier
  s_nop 7
  buffer_load_dwordx4 v[116:119], v144, s[8:11], s58 offen sc1
  buffer_load_dwordx4 v[120:123], v144, s[8:11], s58 offen offset:1024 sc1
  s_and_b32 s31, s28, 3
  s_mul_i32 s36, s31, 81920
  s_add_u32 s36, s36, s35
  s_lshl_b32 s32, s31, 15
  s_add_u32 s38, s37, s32
  s_add_u32 s28, s28, 1
  v_mov_b32 v170, s28
  s_lshl_b32 s32, s31, 12
  v_add_u32 v163, s32, v161
  ds_read_b128 v[44:47], v163
  ds_read_b128 v[48:51], v163 offset:1024
  v_mov_b32 v60, 0
  v_mov_b32 v61, 0
  v_mov_b32 v62, 0
  v_mov_b32 v63, 0
  v_mov_b32 v64, 0
  v_mov_b32 v65, 0
  v_mov_b32 v66, 0
  v_mov_b32 v67, 0
  s_mov_b32 s30, 0
  s_add_u32 s31, s36, s57
  s_waitcnt vmcnt(0)
  v_mfma_f32_16x16x32_bf16 v[108:111], v[180:183], v[116:119], 0
  v_mfma_f32_16x16x32_bf16 v[108:111], v[180:183], v[120:123], v[108:111]
  s_nop 7
  v_cmp_u_f32 vcc, v108, v109
  v_cvt_pk_bf16_f32 v168, v108, v109
  s_cbranch_vccnz b_step0xr
b_step0x:
  buffer_store_dword v168, v146, s[8:11], s31 offen
  buffer_store_dword v169, v154, s[8:11], 0 offen
  s_branch b_step0P
b_step0S:
  s_sleep 4
b_step02:
  s_and_b32 s31, s28, 3
  s_mul_i32 s36, s31, 81920
  s_add_u32 s36, s36, s35
  s_lshl_b32 s32, s31, 15
  s_add_u32 s38, s37, s32
  s_add_u32 s28, s28, 1
  v_mov_b32 v170, s28
  s_lshl_b32 s32, s31, 12
  v_add_u32 v163, s32, v161
  ds_read_b128 v[44:47], v163
  ds_read_b128 v[48:51], v163 offset:1024
  v_mov_b32 v60, 0
  v_mov_b32 v61, 0
  v_mov_b32 v62, 0
  v_mov_b32 v63, 0
  v_mov_b32 v64, 0
  v_mov_b32 v65, 0
  v_mov_b32 v66, 0
  v_mov_b32 v67, 0
b_step0P:
  s_mov_b32 s30, 0
  buffer_load_dwordx4 v[76:79], v147, s[8:11], s36 offen sc1
  buffer_load_dwordx4 v[80:83], v147, s[8:11], s36 offen offset:1024 sc1
  buffer_load_dword v84, v148, s[8:11], s36 offen sc1
  buffer_load_dword v85, v148, s[8:11], s36 offen offset:256 sc1
  s_nop 15
  s_nop 15
mq_41:
  buffer_load_dwordx4 v[88:91], v147, s[8:11], s36 offen sc1
  buffer_load_dwordx4 v[92:95], v147, s[8:11], s36 offen offset:1024 sc1
  buffer_load_dword v96, v148, s[8:11], s36 offen sc1
  buffer_load_dword v97, v148, s[8:11], s36 offen offset:256 sc1
  s_add_u32 s30, s30, 1
  s_cmp_gt_u32 s30, 65536
  s_cbranch_scc1 chain_abort
  s_waitcnt vmcnt(4)
  buffer_store_dword v169, v154, s[8:11], 0 offen
  v_max3_u32 v167, v76, v80, v84
  v_max_u32 v167, v167, v85
  v_cmp_eq_u32 vcc, -1, v167
  ds_write_b128 v147, v[76:79]
  ds_write_b128 v147, v[80:83] offset:1024
  ds_write2st64_b32 v148, v84, v85 offset0:0 offset1:1
  s_cbranch_vccz mq_41_ok
  buffer_load_dwordx4 v[76:79], v147, s[8:11], s36 offen sc1
  buffer_load_dwordx4 v[80:83], v147, s[8:11], s36 offen offset:1024 sc1
  buffer_load_dword v84, v148, s[8:11], s36 offen sc1
  buffer_load_dword v85, v148, s[8:11], s36 offen offset:256 sc1
  s_waitcnt vmcnt(5)
  v_max3_u32 v167, v88, v92, v96
  v_max_u32 v167, v167, v97
  v_cmp_eq_u32 vcc, -1, v167
  ds_write_b128 v147, v[88:91]
  ds_write_b128 v147, v[92:95] offset:1024
  ds_write2st64_b32 v148, v96, v97 offset0:0 offset1:1
  s_cbranch_vccz mq_41_ok
  s_branch mq_41
mq_41_ok:
  s_waitcnt lgkmcnt(0)
  s_barrier
  ds_read_b128 v[4:7], v144 offset:0
  ds_read_b128 v[8:11], v144 offset:1024
  ds_read_b128 v[12:15], v144 offset:2048
  ds_read_b128 v[16:19], v144 offset:3072
  ds_read_b128 v[20:23], v144 offset:4096
  ds_read_b128 v[24:27], v144 offset:5120
  ds_read_b128 v[28:31], v144 offset:6144
  ds_read_b128 v[32:35], v144 offset:7168
  ds_read_b128 v[36:39], v144 offset:8192
  ds_read_b128 v[40:43], v144 offset:9216
  s_waitcnt lgkmcnt(9)
  v_smfmac_f32_16x16x64_bf16 v[60:63], v[4:7], v[192:199], v151
  v_smfmac_f32_16x16x64_bf16 v[64:67], v[4:7], a[16:23], v151
  s_waitcnt lgkmcnt(8)
  v_smfmac_f32_16x16x64_bf16 v[60:63], v[8:11], v[200:207], v151
  v_smfmac_f32_16x16x64_bf16 v[64:67], v[8:11], a[24:31], v151
  s_waitcnt lgkmcnt(7)
  v_smfmac_f32_16x16x64_bf16 v[60:63], v[12:15], v[208:215], v151
  v_smfmac_f32_16x16x64_bf16 v[64:67], v[12:15], a[32:39], v151
  s_waitcnt lgkmcnt(6)
  v_smfmac_f32_16x16x64_bf16 v[60:63], v[16:19], v[216:223], v151
  v_smfmac_f32_16x16x64_bf16 v[64:67], v[16:19], a[40:47], v151
  s_waitcnt lgkmcnt(5)
  v_smfmac_f32_16x16x64_bf16 v[60:63], v[20:23], v[224:231], v151
  v_smfmac_f32_16x16x64_bf16 v[64:67], v[20:23], a[48:55], v151
  s_waitcnt lgkmcnt(4)
  v_smfmac_f32_16x16x64_bf16 v[60:63], v[24:27], v[232:239], v151
  v_smfmac_f32_16x16x64_bf16 v[64:67], v[24:27], a[56:63], v151
  s_waitcnt lgkmcnt(3)
  v_smfmac_f32_16x16x64_bf16 v[60:63], v[28:31], v[240:247], v151
  v_smfmac_f32_16x16x64_bf16 v[64:67], v[28:31], a[64:71], v151
  s_waitcnt lgkmcnt(2)
  v_smfmac_f32_16x16x64_bf16 v[60:63], v[32:35], v[248:255], v151
  s_waitcnt lgkmcnt(1)
  v_smfmac_f32_16x16x64_bf16 v[60:63], v[36:39], a[0:7], v151
  s_waitcnt lgkmcnt(0)
  v_smfmac_f32_16x16x64_bf16 v[60:63], v[40:43], a[8:15], v151
  s_nop 2
  v_smfmac_f32_16x16x64_bf16 v[64:67], v[32:35], a[72:79], v151
  s_nop 2
  v_smfmac_f32_16x16x64_bf16 v[64:67], v[36:39], a[80:87], v151
  v_add_f32 v60, v60, v62
  v_add_f32 v61, v61, v63
  v_cvt_pk_bf16_f32 v140, v60, v61
  ds_write2_b32 v149, v140, v140 offset0:0 offset1:4
  v_smfmac_f32_16x16x64_bf16 v[64:67], v[40:43], a[88:95], v151
  s_nop 7
  v_add_f32 v64, v64, v66
  v_add_f32 v65, v65, v67
  v_cvt_pk_bf16_f32 v141, v64, v65
  ds_write2_b32 v149, v141, v141 offset0:128 offset1:132
  s_mov_b32 s30, 0
  s_nop 5
sx_42:
  ds_read_b64_tr_b16 v[52:53], v145 offset:10240
  ds_read_b64_tr_b16 v[54:55], v145 offset:10752
  ds_read_b64_tr_b16 v[56:57], v145 offset:11264
  ds_read_b64_tr_b16 v[58:59], v145 offset:11776
  s_waitcnt lgkmcnt(2)
  v_mfma_f32_16x16x32_bf16 v[68:71], v[44:47], v[52:55], 0
  s_waitcnt lgkmcnt(0)
  v_mfma_f32_16x16x32_bf16 v[68:71], v[48:51], v[56:59], v[68:71]
  s_nop 7
  v_cmp_u_f32 vcc, v68, v69
  s_mov_b64 exec, s[52:53]
  s_cbranch_vccnz sx_42_r
  buffer_store_dwordx4 v[68:71], v144, s[8:11], s38 offen
  s_mov_b64 exec, -1
  s_add_u32 s31, s28, 2
  s_and_b32 s31, s31, 3
  s_cmp_eq_u32 s28, 64
  s_cbranch_scc1 b_end
  s_lshl_b32 s31, s31, 15
  s_add_u32 s31, s31, s46
  buffer_store_dwordx4 v[72:75], v144, s[8:11], s31 offen
  s_branch b_top0
b_step0xr:
  buffer_load_dwordx4 v[116:119], v144, s[8:11], s58 offen sc1
  buffer_load_dwordx4 v[120:123], v144, s[8:11], s58 offen offset:1024 sc1
  s_add_u32 s30, s30, 1
  s_cmp_gt_u32 s30, 65536
  s_cbranch_scc1 chain_abort
  s_waitcnt vmcnt(0)
  v_mfma_f32_16x16x32_bf16 v[108:111], v[180:183], v[116:119], 0
  v_mfma_f32_16x16x32_bf16 v[108:111], v[180:183], v[120:123], v[108:111]
  s_nop 7
  v_cmp_u_f32 vcc, v108, v109
  v_cvt_pk_bf16_f32 v168, v108, v109
  s_cbranch_vccz b_step0x
  s_branch b_step0xr
sx_42_r:
  s_mov_b64 exec, -1
  s_add_u32 s30, s30, 1
  s_cmp_gt_u32 s30, 65536
  s_cbranch_scc1 chain_abort
  s_branch sx_42
b_pro1:
  s_lshl_b32 s31, s26, 7
  s_add_u32 s37, s37, s31
  s_add_u32 s37, s37, 3072
  s_min_u32 s31, s18, 9
  s_lshl_b32 s31, s31, 10
  s_add_u32 s46, s35, s31
  ds_write_b128 v144, v[72:75] offset:10240
  ds_write_b128 v144, v[72:75] offset:11264
b_top1:
  s_cmp_ge_u32 s29, 64
  s_cbranch_scc1 b_step10
  ds_read_b128 v[116:119], v159 offset:16384
  ds_read_b128 v[120:123], v159 offset:17408
  ds_read_b128 v[124:127], v159 offset:18432
  s_and_b32 s31, s29, 3
  s_mul_i32 s31, s31, 147456
  s_add_u32 s42, s41, s31
  s_add_u32 s42, s42, s51
  s_add_u32 s49, s29, 2
  s_lshl_b32 s48, s49, 1
  s_min_u32 s48, s48, 128
  s_and_b32 s31, s29, 3
  s_lshl_b32 s31, s31, 12
  v_add_u32 v162, s31, v160
  v_xor_b32 v176, 1024, v162
  s_add_u32 s29, s29, 1
  s_mov_b32 s33, 8192
  s_waitcnt lgkmcnt(2)
  v_mfma_f32_16x16x32_bf16 v[100:103], v[192:195], v[116:119], 0
  ds_read_b128 v[128:131], v159 offset:19456
  v_mfma_f32_16x16x32_bf16 v[104:107], a[16:19], v[116:119], 0
  v_mfma_f32_16x16x32_bf16 v[108:111], a[96:99], v[116:119], 0
  v_mfma_f32_16x16x32_bf16 v[112:115], a[176:179], v[116:119], 0
  s_waitcnt lgkmcnt(2)
  v_mfma_f32_16x16x32_bf16 v[100:103], v[196:199], v[120:123], v[100:103]
  ds_read_b128 v[116:119], v159 offset:20480
  v_mfma_f32_16x16x32_bf16 v[104:107], a[20:23], v[120:123], v[104:107]
  v_mfma_f32_16x16x32_bf16 v[108:111], a[100:103], v[120:123], v[108:111]
  v_mfma_f32_16x16x32_bf16 v[112:115], a[180:183], v[120:123], v[112:115]
  s_waitcnt lgkmcnt(2)
  v_mfma_f32_16x16x32_bf16 v[100:103], v[200:203], v[124:127], v[100:103]
  ds_read_b128 v[120:123], v159 offset:21504
  v_mfma_f32_16x16x32_bf16 v[104:107], a[24:27], v[124:127], v[104:107]
  s_mov_b32 s30, 0
  s_branch pc_45
pw_43:
  buffer_load_dword v158, v157, s[8:11], s33 offen sc1
  s_add_u32 s30, s30, 1
  s_cmp_gt_u32 s30, 65536
  s_cbranch_scc1 role_abort
  s_waitcnt vmcnt(0)
pc_45:
  v_cmp_gt_u32 vcc, s48, v158
  s_nop 0
  s_and_b32 vcc_lo, vcc_lo, 0xfff
  s_and_b32 vcc_hi, vcc_hi, 0x0
  s_cmp_eq_u64 vcc, 0
  s_cbranch_scc1 po_44
  s_sleep 4
  s_branch pw_43
po_44:
  v_mfma_f32_16x16x32_bf16 v[108:111], a[104:107], v[124:127], v[108:111]
  v_mfma_f32_16x16x32_bf16 v[112:115], a[184:187], v[124:127], v[112:115]
  s_add_u32 m0, s44, 0
  s_add_u32 s31, s43, 0
  buffer_load_dwordx4 v144, s[8:11], s31 offen offset:0 sc1 lds
  s_waitcnt lgkmcnt(2)
  v_mfma_f32_16x16x32_bf16 v[100:103], v[204:207], v[128:131], v[100:103]
  ds_read_b128 v[124:127], v159 offset:22528
  v_mfma_f32_16x16x32_bf16 v[104:107], a[28:31], v[128:131], v[104:107]
  v_mfma_f32_16x16x32_bf16 v[108:111], a[108:111], v[128:131], v[108:111]
  v_mfma_f32_16x16x32_bf16 v[112:115], a[188:191], v[128:131], v[112:115]
  buffer_load_dwordx4 v144, s[8:11], s31 offen offset:1024 sc1 lds
  s_waitcnt lgkmcnt(2)
  v_mfma_f32_16x16x32_bf16 v[100:103], v[208:211], v[116:119], v[100:103]
  ds_read_b128 v[128:131], v159 offset:23552
  v_mfma_f32_16x16x32_bf16 v[104:107], a[32:35], v[116:119], v[104:107]
  v_mfma_f32_16x16x32_bf16 v[108:111], a[112:115], v[116:119], v[108:111]
  v_mfma_f32_16x16x32_bf16 v[112:115], a[192:195], v[116:119], v[112:115]
  buffer_load_dwordx4 v144, s[8:11], s31 offen offset:2048 sc1 lds
  s_waitcnt lgkmcnt(2)
  v_mfma_f32_16x16x32_bf16 v[100:103], v[212:215], v[120:123], v[100:103]
  ds_read_b128 v[116:119], v159 offset:24576
  v_mfma_f32_16x16x32_bf16 v[104:107], a[36:39], v[120:123], v[104:107]
  v_mfma_f32_16x16x32_bf16 v[108:111], a[116:119], v[120:123], v[108:111]
  v_mfma_f32_16x16x32_bf16 v[112:115], a[196:199], v[120:123], v[112:115]
  buffer_load_dwordx4 v144, s[8:11], s31 offen offset:3072 sc1 lds
  s_waitcnt lgkmcnt(2)
  v_mfma_f32_16x16x32_bf16 v[100:103], v[216:219], v[124:127], v[100:103]
  ds_read_b128 v[120:123], v159 offset:25600
  v_mfma_f32_16x16x32_bf16 v[104:107], a[40:43], v[124:127], v[104:107]
  v_mfma_f32_16x16x32_bf16 v[108:111], a[120:123], v[124:127], v[108:111]
  v_mfma_f32_16x16x32_bf16 v[112:115], a[200:203], v[124:127], v[112:115]
  s_add_u32 m0, s44, 4096
  s_add_u32 s31, s43, 4096
  buffer_load_dwordx4 v144, s[8:11], s31 offen offset:0 sc1 lds
  s_waitcnt lgkmcnt(2)
  v_mfma_f32_16x16x32_bf16 v[100:103], v[220:223], v[128:131], v[100:103]
  ds_read_b128 v[124:127], v159 offset:26624
  v_mfma_f32_16x16x32_bf16 v[104:107], a[44:47], v[128:131], v[104:107]
  v_mfma_f32_16x16x32_bf16 v[108:111], a[124:127], v[128:131], v[108:111]
  v_mfma_f32_16x16x32_bf16 v[112:115], a[204:207], v[128:131], v[112:115]
  buffer_load_dwordx4 v144, s[8:11], s31 offen offset:1024 sc1 lds
  s_waitcnt lgkmcnt(2)
  v_mfma_f32_16x16x32_bf16 v[100:103], v[224:227], v[116:119], v[100:103]
  ds_read_b128 v[128:131], v159 offset:27648
  v_mfma_f32_16x16x32_bf16 v[104:107], a[48:51], v[116:119], v[104:107]
  v_mfma_f32_16x16x32_bf16 v[108:111], a[128:131], v[116:119], v[108:111]
  v_mfma_f32_16x16x32_bf16 v[112:115], a[208:211], v[116:119], v[112:115]
  buffer_load_dwordx4 v144, s[8:11], s31 offen offset:2048 sc1 lds
  s_waitcnt lgkmcnt(2)
  v_mfma_f32_16x16x32_bf16 v[100:103], v[228:231], v[120:123], v[100:103]
  ds_read_b128 v[116:119], v159 offset:28672
  v_mfma_f32_16x16x32_bf16 v[104:107], a[52:55], v[120:123], v[104:107]
  v_mfma_f32_16x16x32_bf16 v[108:111], a[132:135], v[120:123], v[108:111]
  v_mfma_f32_16x16x32_bf16 v[112:115], a[212:215], v[120:123], v[112:115]
  buffer_load_dwordx4 v144, s[8:11], s31 offen offset:3072 sc1 lds
  s_waitcnt lgkmcnt(2)
  v_mfma_f32_16x16x32_bf16 v[100:103], v[232:235], v[124:127], v[100:103]
  ds_read_b128 v[120:123], v159 offset:29696
  v_mfma_f32_16x16x32_bf16 v[104:107], a[56:59], v[124:127], v[104:107]
  v_mfma_f32_16x16x32_bf16 v[108:111], a[136:139], v[124:127], v[108:111]
  v_mfma_f32_16x16x32_bf16 v[112:115], a[216:219], v[124:127], v[112:115]
  s_add_u32 m0, s44, 8192
  s_add_u32 s31, s43, 8192
  buffer_load_dwordx4 v144, s[8:11], s31 offen offset:0 sc1 lds
  s_waitcnt lgkmcnt(2)
  v_mfma_f32_16x16x32_bf16 v[100:103], v[236:239], v[128:131], v[100:103]
  ds_read_b128 v[124:127], v159 offset:30720
  v_mfma_f32_16x16x32_bf16 v[104:107], a[60:63], v[128:131], v[104:107]
  v_mfma_f32_16x16x32_bf16 v[108:111], a[140:143], v[128:131], v[108:111]
  v_mfma_f32_16x16x32_bf16 v[112:115], a[220:223], v[128:131], v[112:115]
  buffer_load_dwordx4 v144, s[8:11], s31 offen offset:1024 sc1 lds
  s_waitcnt lgkmcnt(2)
  v_mfma_f32_16x16x32_bf16 v[100:103], v[240:243], v[116:119], v[100:103]
  ds_read_b128 v[128:131], v159 offset:31744
  v_mfma_f32_16x16x32_bf16 v[104:107], a[64:67], v[116:119], v[104:107]
  v_mfma_f32_16x16x32_bf16 v[108:111], a[144:147], v[116:119], v[108:111]
  v_mfma_f32_16x16x32_bf16 v[112:115], a[224:227], v[116:119], v[112:115]
  buffer_load_dword v158, v157, s[8:11], s33 offen sc1
  s_waitcnt lgkmcnt(2)
  v_mfma_f32_16x16x32_bf16 v[100:103], v[244:247], v[120:123], v[100:103]
  ds_read_b128 v[116:119], v159 offset:32768
  v_mfma_f32_16x16x32_bf16 v[104:107], a[68:71], v[120:123], v[104:107]
  v_mfma_f32_16x16x32_bf16 v[108:111], a[148:151], v[120:123], v[108:111]
  v_mfma_f32_16x16x32_bf16 v[112:115], a[228:231], v[120:123], v[112:115]
  s_waitcnt lgkmcnt(2)
  v_mfma_f32_16x16x32_bf16 v[100:103], v[248:251], v[124:127], v[100:103]
  ds_read_b128 v[120:123], v159 offset:33792
  v_mfma_f32_16x16x32_bf16 v[104:107], a[72:75], v[124:127], v[104:107]
  v_mfma_f32_16x16x32_bf16 v[108:111], a[152:155], v[124:127], v[108:111]
  v_mfma_f32_16x16x32_bf16 v[112:115], a[232:235], v[124:127], v[112:115]
  s_waitcnt lgkmcnt(2)
  v_mfma_f32_16x16x32_bf16 v[100:103], v[252:255], v[128:131], v[100:103]
  ds_read_b128 v[124:127], v159 offset:34816
  v_mfma_f32_16x16x32_bf16 v[104:107], a[76:79], v[128:131], v[104:107]
  v_mfma_f32_16x16x32_bf16 v[108:111], a[156:159], v[128:131], v[108:111]
  v_mfma_f32_16x16x32_bf16 v[112:115], a[236:239], v[128:131], v[112:115]
  s_waitcnt lgkmcnt(2)
  v_mfma_f32_16x16x32_bf16 v[100:103], a[0:3], v[116:119], v[100:103]
  ds_read_b128 v[128:131], v159 offset:35840
  v_mfma_f32_16x16x32_bf16 v[104:107], a[80:83], v[116:119], v[104:107]
  v_mfma_f32_16x16x32_bf16 v[108:111], a[160:163], v[116:119], v[108:111]
  v_mfma_f32_16x16x32_bf16 v[112:115], a[240:243], v[116:119], v[112:115]
  s_waitcnt lgkmcnt(2)
  v_mfma_f32_16x16x32_bf16 v[100:103], a[4:7], v[120:123], v[100:103]
  v_mfma_f32_16x16x32_bf16 v[104:107], a[84:87], v[120:123], v[104:107]
  v_mfma_f32_16x16x32_bf16 v[108:111], a[164:167], v[120:123], v[108:111]
  v_mfma_f32_16x16x32_bf16 v[112:115], a[244:247], v[120:123], v[112:115]
  s_waitcnt lgkmcnt(1)
  v_mfma_f32_16x16x32_bf16 v[100:103], a[8:11], v[124:127], v[100:103]
  v_mfma_f32_16x16x32_bf16 v[104:107], a[88:91], v[124:127], v[104:107]
  v_mfma_f32_16x16x32_bf16 v[108:111], a[168:171], v[124:127], v[108:111]
  v_mfma_f32_16x16x32_bf16 v[112:115], a[248:251], v[124:127], v[112:115]
  s_waitcnt lgkmcnt(0)
  v_mfma_f32_16x16x32_bf16 v[100:103], a[12:15], v[128:131], v[100:103]
  v_mfma_f32_16x16x32_bf16 v[104:107], a[92:95], v[128:131], v[104:107]
  v_mfma_f32_16x16x32_bf16 v[108:111], a[172:175], v[128:131], v[108:111]
  v_mfma_f32_16x16x32_bf16 v[112:115], a[252:255], v[128:131], v[112:115]
  s_xor_b32 s44, s44, 0x10000
  v_xor_b32 v159, 0x10000, v159
  s_cmp_lt_u32 s29, 63
  s_cselect_b32 s31, 40960, 0
  s_add_u32 s43, s43, s31
  s_mul_i32 s31, s16, 2621440
  s_cmp_eq_u32 s29, 11
  s_cselect_b32 s31, s31, 0
  s_sub_u32 s43, s43, s31
  v_mov_b32 v169, s29
  v_cvt_pk_bf16_f32 v132, v100, v101
  v_cvt_pk_bf16_f32 v133, v102, v103
  v_cvt_pk_bf16_f32 v134, v104, v105
  v_cvt_pk_bf16_f32 v135, v106, v107
  buffer_store_dwordx4 v[132:135], v144, s[8:11], s42 offen
  s_add_u32 s42, s42, s50
  ds_write_b128 v162, v[132:135]
  v_cvt_pk_bf16_f32 v136, v108, v109
  v_cvt_pk_bf16_f32 v137, v110, v111
  v_cvt_pk_bf16_f32 v138, v112, v113
  v_cvt_pk_bf16_f32 v139, v114, v115
  buffer_store_dwordx4 v[136:139], v144, s[8:11], s42 offen
  s_add_u32 s42, s42, s50
  ds_write_b128 v176, v[136:139]
  s_cmp_gt_u32 s29, 2
  s_cbranch_scc1 b_step13
  s_waitcnt vmcnt(0) lgkmcnt(0)
  buffer_store_dword v169, v154, s[8:11], 0 offen
  s_cmp_eq_u32 s29, 2
  s_barrier
  s_cbranch_scc1 b_top1
  s_mov_b32 s33, 4096
  s_mov_b32 s30, 0
pw_46:
  buffer_load_dword v166, v157, s[8:11], s33 offen sc1
  s_add_u32 s30, s30, 1
  s_cmp_gt_u32 s30, 65536
  s_cbranch_scc1 role_abort
  s_waitcnt vmcnt(0)
pc_48:
  v_cmp_gt_u32 vcc, 1, v166
  s_nop 0
  s_and_b32 vcc_lo, vcc_lo, 0x10000000
  s_and_b32 vcc_hi, vcc_hi, 0x0
  s_cmp_eq_u64 vcc, 0
  s_cbranch_scc1 po_47
  s_sleep 2
  s_branch pw_46
po_47:
  v_readlane_b32 s31, v166, 28
  s_nop 0
  s_lshl_b32 s31, s31, 13
  s_add_u32 s56, s56, s31
  s_branch b_step12
b_step10:
  s_sleep 24
b_step13:
  s_waitcnt vmcnt(2) lgkmcnt(0)
  s_barrier
  ds_write_b128 v144, v[72:75] offset:10240
  ds_write_b128 v144, v[72:75] offset:11264
b_step1S:
  s_sleep 4
b_step12:
  s_and_b32 s31, s28, 3
  s_mul_i32 s36, s31, 81920
  s_add_u32 s36, s36, s35
  s_lshl_b32 s32, s31, 15
  s_add_u32 s38, s37, s32
  s_add_u32 s28, s28, 1
  v_mov_b32 v170, s28
  v_mov_b32 v60, 0
  v_mov_b32 v61, 0
  v_mov_b32 v62, 0
  v_mov_b32 v63, 0
  v_mov_b32 v64, 0
  v_mov_b32 v65, 0
  v_mov_b32 v66, 0
  v_mov_b32 v67, 0
b_step1P:
  s_mov_b32 s30, 0
  buffer_load_dwordx4 v[76:79], v147, s[8:11], s36 offen sc1
  buffer_load_dwordx4 v[80:83], v147, s[8:11], s36 offen offset:1024 sc1
  buffer_load_dword v84, v148, s[8:11], s36 offen sc1
  buffer_load_dword v85, v148, s[8:11], s36 offen offset:256 sc1
  s_nop 15
  s_nop 15
mq_49:
  buffer_load_dwordx4 v[88:91], v147, s[8:11], s36 offen sc1
  buffer_load_dwordx4 v[92:95], v147, s[8:11], s36 offen offset:1024 sc1
  buffer_load_dword v96, v148, s[8:11], s36 offen sc1
  buffer_load_dword v97, v148, s[8:11], s36 offen offset:256 sc1
  s_add_u32 s30, s30, 1
  s_cmp_gt_u32 s30, 65536
  s_cbranch_scc1 chain_abort
  s_waitcnt vmcnt(4)
  buffer_store_dword v169, v154, s[8:11], 0 offen
  v_max3_u32 v167, v76, v80, v84
  v_max_u32 v167, v167, v85
  v_cmp_eq_u32 vcc, -1, v167
  ds_write_b128 v147, v[76:79]
  ds_write_b128 v147, v[80:83] offset:1024
  ds_write2st64_b32 v148, v84, v85 offset0:0 offset1:1
  s_cbranch_vccz mq_49_ok
  buffer_load_dwordx4 v[76:79], v147, s[8:11], s36 offen sc1
  buffer_load_dwordx4 v[80:83], v147, s[8:11], s36 offen offset:1024 sc1
  buffer_load_dword v84, v148, s[8:11], s36 offen sc1
  buffer_load_dword v85, v148, s[8:11], s36 offen offset:256 sc1
  s_waitcnt vmcnt(5)
  v_max3_u32 v167, v88, v92, v96
  v_max_u32 v167, v167, v97
  v_cmp_eq_u32 vcc, -1, v167
  ds_write_b128 v147, v[88:91]
  ds_write_b128 v147, v[92:95] offset:1024
  ds_write2st64_b32 v148, v96, v97 offset0:0 offset1:1
  s_cbranch_vccz mq_49_ok
  s_branch mq_49
mq_49_ok:
  s_waitcnt lgkmcnt(0)
  s_barrier
  ds_read_b128 v[4:7], v144 offset:0
  ds_read_b128 v[8:11], v144 offset:1024
  ds_read_b128 v[12:15], v144 offset:2048
  ds_read_b128 v[16:19], v144 offset:3072
  ds_read_b128 v[20:23], v144 offset:4096
  ds_read_b128 v[24:27], v144 offset:5120
  ds_read_b128 v[28:31], v144 offset:6144
  ds_read_b128 v[32:35], v144 offset:7168
  ds_read_b128 v[36:39], v144 offset:8192
  ds_read_b128 v[40:43], v144 offset:9216
  s_waitcnt lgkmcnt(9)
  v_smfmac_f32_16x16x64_bf16 v[60:63], v[4:7], v[192:199], v151
  v_smfmac_f32_16x16x64_bf16 v[64:67], v[4:7], a[16:23], v151
  s_waitcnt lgkmcnt(8)
  v_smfmac_f32_16x16x64_bf16 v[60:63], v[8:11], v[200:207], v151
  v_smfmac_f32_16x16x64_bf16 v[64:67], v[8:11], a[24:31], v151
  s_waitcnt lgkmcnt(7)
  v_smfmac_f32_16x16x64_bf16 v[60:63], v[12:15], v[208:215], v151
  v_smfmac_f32_16x16x64_bf16 v[64:67], v[12:15], a[32:39], v151
  s_waitcnt lgkmcnt(6)
  v_smfmac_f32_16x16x64_bf16 v[60:63], v[16:19], v[216:223], v151
  v_smfmac_f32_16x16x64_bf16 v[64:67], v[16:19], a[40:47], v151
  s_waitcnt lgkmcnt(5)
  v_smfmac_f32_16x16x64_bf16 v[60:63], v[20:23], v[224:231], v151
  v_smfmac_f32_16x16x64_bf16 v[64:67], v[20:23], a[48:55], v151
  s_waitcnt lgkmcnt(4)
  v_smfmac_f32_16x16x64_bf16 v[60:63], v[24:27], v[232:239], v151
  v_smfmac_f32_16x16x64_bf16 v[64:67], v[24:27], a[56:63], v151
  s_waitcnt lgkmcnt(3)
  v_smfmac_f32_16x16x64_bf16 v[60:63], v[28:31], v[240:247], v151
  v_smfmac_f32_16x16x64_bf16 v[64:67], v[28:31], a[64:71], v151
  s_waitcnt lgkmcnt(2)
  v_smfmac_f32_16x16x64_bf16 v[60:63], v[32:35], v[248:255], v151
  s_waitcnt lgkmcnt(1)
  v_smfmac_f32_16x16x64_bf16 v[60:63], v[36:39], a[0:7], v151
  s_waitcnt lgkmcnt(0)
  v_smfmac_f32_16x16x64_bf16 v[60:63], v[40:43], a[8:15], v151
  s_nop 2
  v_smfmac_f32_16x16x64_bf16 v[64:67], v[32:35], a[72:79], v151
  s_nop 2
  v_smfmac_f32_16x16x64_bf16 v[64:67], v[36:39], a[80:87], v151
  v_add_f32 v60, v60, v62
  v_add_f32 v61, v61, v63
  v_cvt_pk_bf16_f32 v140, v60, v61
  ds_write2_b32 v149, v140, v140 offset0:0 offset1:1
  v_smfmac_f32_16x16x64_bf16 v[64:67], v[40:43], a[88:95], v151
  s_nop 7
  v_add_f32 v64, v64, v66
  v_add_f32 v65, v65, v67
  v_cvt_pk_bf16_f32 v141, v64, v65
  ds_write2_b32 v149, v141, v141 offset0:128 offset1:129
  s_mov_b32 s30, 0
  s_nop 5
sx_50:
  ds_read_b64_tr_b16 v[52:53], v145 offset:10240
  ds_read_b64_tr_b16 v[54:55], v145 offset:10752
  ds_read_b64_tr_b16 v[44:45], v145 offset:12288
  ds_read_b64_tr_b16 v[46:47], v145 offset:12800
  ds_read_b64_tr_b16 v[56:57], v145 offset:11264
  ds_read_b64_tr_b16 v[58:59], v145 offset:11776
  ds_read_b64_tr_b16 v[48:49], v145 offset:13312
  ds_read_b64_tr_b16 v[50:51], v145 offset:13824
  s_waitcnt lgkmcnt(4)
  v_mfma_f32_16x16x32_bf16 v[68:71], v[44:47], v[52:55], 0
  s_waitcnt lgkmcnt(0)
  v_mfma_f32_16x16x32_bf16 v[68:71], v[48:51], v[56:59], v[68:71]
  s_nop 7
  v_cmp_u_f32 vcc, v68, v69
  v_cndmask_b32 v167, v68, v69, s[54:55]
  s_cbranch_vccnz sx_50_r
  buffer_store_dword v167, v146, s[8:11], s38 offen
  s_add_u32 s31, s28, 2
  s_and_b32 s31, s31, 3
  s_cmp_eq_u32 s28, 64
  s_cbranch_scc1 b_end
  s_mul_i32 s31, s31, 81920
  s_add_u32 s31, s31, s46
  buffer_store_dwordx4 v[72:75], v144, s[8:11], s31 offen
  s_branch b_top1
sx_50_r:
  s_mov_b64 exec, -1
  s_add_u32 s30, s30, 1
  s_cmp_gt_u32 s30, 65536
  s_cbranch_scc1 chain_abort
  s_branch sx_50
b_pro2:
  ds_write_b128 v144, v[72:75] offset:12288
  ds_write_b128 v144, v[72:75] offset:13312
b_top2:
  s_cmp_ge_u32 s29, 64
  s_cbranch_scc1 b_step20
  ds_read_b128 v[116:119], v159 offset:16384
  ds_read_b128 v[120:123], v159 offset:17408
  ds_read_b128 v[124:127], v159 offset:18432
  s_and_b32 s31, s29, 3
  s_mul_i32 s31, s31, 147456
  s_add_u32 s42, s41, s31
  s_add_u32 s42, s42, s51
  s_add_u32 s49, s29, 2
  s_lshl_b32 s48, s49, 1
  s_min_u32 s48, s48, 128
  s_and_b32 s31, s29, 3
  s_lshl_b32 s31, s31, 12
  v_add_u32 v162, s31, v160
  v_xor_b32 v176, 1024, v162
  s_add_u32 s29, s29, 1
  s_mov_b32 s33, 8192
  s_waitcnt lgkmcnt(2)
  v_mfma_f32_16x16x32_bf16 v[100:103], v[192:195], v[116:119], 0
  ds_read_b128 v[128:131], v159 offset:19456
  v_mfma_f32_16x16x32_bf16 v[104:107], a[16:19], v[116:119], 0
  v_mfma_f32_16x16x32_bf16 v[108:111], a[96:99], v[116:119], 0
  v_mfma_f32_16x16x32_bf16 v[112:115], a[176:179], v[116:119], 0
  s_waitcnt lgkmcnt(2)
  v_mfma_f32_16x16x32_bf16 v[100:103], v[196:199], v[120:123], v[100:103]
  ds_read_b128 v[116:119], v159 offset:20480
  v_mfma_f32_16x16x32_bf16 v[104:107], a[20:23], v[120:123], v[104:107]
  v_mfma_f32_16x16x32_bf16 v[108:111], a[100:103], v[120:123], v[108:111]
  v_mfma_f32_16x16x32_bf16 v[112:115], a[180:183], v[120:123], v[112:115]
  s_waitcnt lgkmcnt(2)
  v_mfma_f32_16x16x32_bf16 v[100:103], v[200:203], v[124:127], v[100:103]
  ds_read_b128 v[120:123], v159 offset:21504
  v_mfma_f32_16x16x32_bf16 v[104:107], a[24:27], v[124:127], v[104:107]
  v_mfma_f32_16x16x32_bf16 v[108:111], a[104:107], v[124:127], v[108:111]
  v_mfma_f32_16x16x32_bf16 v[112:115], a[184:187], v[124:127], v[112:115]
  s_waitcnt lgkmcnt(2)
  v_mfma_f32_16x16x32_bf16 v[100:103], v[204:207], v[128:131], v[100:103]
  ds_read_b128 v[124:127], v159 offset:22528
  v_mfma_f32_16x16x32_bf16 v[104:107], a[28:31], v[128:131], v[104:107]
  v_mfma_f32_16x16x32_bf16 v[108:111], a[108:111], v[128:131], v[108:111]
  v_mfma_f32_16x16x32_bf16 v[112:115], a[188:191], v[128:131], v[112:115]
  s_waitcnt lgkmcnt(2)
  v_mfma_f32_16x16x32_bf16 v[100:103], v[208:211], v[116:119], v[100:103]
  ds_read_b128 v[128:131], v159 offset:23552
  v_mfma_f32_16x16x32_bf16 v[104:107], a[32:35], v[116:119], v[104:107]
  v_mfma_f32_16x16x32_bf16 v[108:111], a[112:115], v[116:119], v[108:111]
  v_mfma_f32_16x16x32_bf16 v[112:115], a[192:195], v[116:119], v[112:115]
  s_waitcnt lgkmcnt(2)
  v_mfma_f32_16x16x32_bf16 v[100:103], v[212:215], v[120:123], v[100:103]
  ds_read_b128 v[116:119], v159 offset:24576
  v_mfma_f32_16x16x32_bf16 v[104:107], a[36:39], v[120:123], v[104:107]
  s_waitcnt vmcnt(0)
  buffer_store_dword v170, v155, s[8:11], 0 offen
  v_mfma_f32_16x16x32_bf16 v[108:111], a[116:119], v[120:123], v[108:111]
  v_mfma_f32_16x16x32_bf16 v[112:115], a[196:199], v[120:123], v[112:115]
  s_mov_b32 s30, 0
  s_branch pc_53
pw_51:
  buffer_load_dword v158, v157, s[8:11], s33 offen sc1
  s_add_u32 s30, s30, 1
  s_cmp_gt_u32 s30, 65536
  s_cbranch_scc1 role_abort
  s_waitcnt vmcnt(0)
pc_53:
  v_cmp_gt_u32 vcc, s48, v158
  s_nop 0
  s_and_b32 vcc_lo, vcc_lo, 0xfff
  s_and_b32 vcc_hi, vcc_hi, 0x0
  s_cmp_eq_u64 vcc, 0
  s_cbranch_scc1 po_52
  s_sleep 4
  s_branch pw_51
po_52:
  s_waitcnt lgkmcnt(2)
  v_mfma_f32_16x16x32_bf16 v[100:103], v[216:219], v[124:127], v[100:103]
  ds_read_b128 v[120:123], v159 offset:25600
  v_mfma_f32_16x16x32_bf16 v[104:107], a[40:43], v[124:127], v[104:107]
  s_add_u32 m0, s44, 0
  s_add_u32 s31, s43, 0
  buffer_load_dwordx4 v144, s[8:11], s31 offen offset:0 sc1 lds
  v_mfma_f32_16x16x32_bf16 v[108:111], a[120:123], v[124:127], v[108:111]
  v_mfma_f32_16x16x32_bf16 v[112:115], a[200:203], v[124:127], v[112:115]
  s_waitcnt lgkmcnt(2)
  v_mfma_f32_16x16x32_bf16 v[100:103], v[220:223], v[128:131], v[100:103]
  ds_read_b128 v[124:127], v159 offset:26624
  v_mfma_f32_16x16x32_bf16 v[104:107], a[44:47], v[128:131], v[104:107]
  buffer_load_dwordx4 v144, s[8:11], s31 offen offset:1024 sc1 lds
  v_mfma_f32_16x16x32_bf16 v[108:111], a[124:127], v[128:131], v[108:111]
  v_mfma_f32_16x16x32_bf16 v[112:115], a[204:207], v[128:131], v[112:115]
  s_waitcnt lgkmcnt(2)
  v_mfma_f32_16x16x32_bf16 v[100:103], v[224:227], v[116:119], v[100:103]
  ds_read_b128 v[128:131], v159 offset:27648
  v_mfma_f32_16x16x32_bf16 v[104:107], a[48:51], v[116:119], v[104:107]
  buffer_load_dwordx4 v144, s[8:11], s31 offen offset:2048 sc1 lds
  v_mfma_f32_16x16x32_bf16 v[108:111], a[128:131], v[116:119], v[108:111]
  v_mfma_f32_16x16x32_bf16 v[112:115], a[208:211], v[116:119], v[112:115]
  s_waitcnt lgkmcnt(2)
  v_mfma_f32_16x16x32_bf16 v[100:103], v[228:231], v[120:123], v[100:103]
  ds_read_b128 v[116:119], v159 offset:28672
  v_mfma_f32_16x16x32_bf16 v[104:107], a[52:55], v[120:123], v[104:107]
  buffer_load_dwordx4 v144, s[8:11], s31 offen offset:3072 sc1 lds
  v_mfma_f32_16x16x32_bf16 v[108:111], a[132:135], v[120:123], v[108:111]
  v_mfma_f32_16x16x32_bf16 v[112:115], a[212:215], v[120:123], v[112:115]
  s_waitcnt lgkmcnt(2)
  v_mfma_f32_16x16x32_bf16 v[100:103], v[232:235], v[124:127], v[100:103]
  ds_read_b128 v[120:123], v159 offset:29696
  v_mfma_f32_16x16x32_bf16 v[104:107], a[56:59], v[124:127], v[104:107]
  s_add_u32 m0, s44, 4096
  s_add_u32 s31, s43, 4096
  buffer_load_dwordx4 v144, s[8:11], s31 offen offset:0 sc1 lds
  v_mfma_f32_16x16x32_bf16 v[108:111], a[136:139], v[124:127], v[108:111]
  v_mfma_f32_16x16x32_bf16 v[112:115], a[216:219], v[124:127], v[112:115]
  s_waitcnt lgkmcnt(2)
  v_mfma_f32_16x16x32_bf16 v[100:103], v[236:239], v[128:131], v[100:103]
  ds_read_b128 v[124:127], v159 offset:30720
  v_mfma_f32_16x16x32_bf16 v[104:107], a[60:63], v[128:131], v[104:107]
  buffer_load_dwordx4 v144, s[8:11], s31 offen offset:1024 sc1 lds
  v_mfma_f32_16x16x32_bf16 v[108:111], a[140:143], v[128:131], v[108:111]
  v_mfma_f32_16x16x32_bf16 v[112:115], a[220:223], v[128:131], v[112:115]
  s_waitcnt lgkmcnt(2)
  v_mfma_f32_16x16x32_bf16 v[100:103], v[240:243], v[116:119], v[100:103]
  ds_read_b128 v[128:131], v159 offset:31744
  v_mfma_f32_16x16x32_bf16 v[104:107], a[64:67], v[116:119], v[104:107]
  buffer_load_dwordx4 v144, s[8:11], s31 offen offset:2048 sc1 lds
  v_mfma_f32_16x16x32_bf16 v[108:111], a[144:147], v[116:119], v[108:111]
  v_mfma_f32_16x16x32_bf16 v[112:115], a[224:227], v[116:119], v[112:115]
  s_waitcnt lgkmcnt(2)
  v_mfma_f32_16x16x32_bf16 v[100:103], v[244:247], v[120:123], v[100:103]
  ds_read_b128 v[116:119], v159 offset:32768
  v_mfma_f32_16x16x32_bf16 v[104:107], a[68:71], v[120:123], v[104:107]
  buffer_load_dwordx4 v144, s[8:11], s31 offen offset:3072 sc1 lds
  v_mfma_f32_16x16x32_bf16 v[108:111], a[148:151], v[120:123], v[108:111]
  v_mfma_f32_16x16x32_bf16 v[112:115], a[228:231], v[120:123], v[112:115]
  s_waitcnt lgkmcnt(2)
  v_mfma_f32_16x16x32_bf16 v[100:103], v[248:251], v[124:127], v[100:103]
  ds_read_b128 v[120:123], v159 offset:33792
  v_mfma_f32_16x16x32_bf16 v[104:107], a[72:75], v[124:127], v[104:107]
  s_add_u32 m0, s44, 8192
  s_add_u32 s31, s43, 8192
  buffer_load_dwordx4 v144, s[8:11], s31 offen offset:0 sc1 lds
  v_mfma_f32_16x16x32_bf16 v[108:111], a[152:155], v[124:127], v[108:111]
  v_mfma_f32_16x16x32_bf16 v[112:115], a[232:235], v[124:127], v[112:115]
  s_waitcnt lgkmcnt(2)
  v_mfma_f32_16x16x32_bf16 v[100:103], v[252:255], v[128:131], v[100:103]
  ds_read_b128 v[124:127], v159 offset:34816
  v_mfma_f32_16x16x32_bf16 v[104:107], a[76:79], v[128:131], v[104:107]
  buffer_load_dwordx4 v144, s[8:11], s31 offen offset:1024 sc1 lds
  v_mfma_f32_16x16x32_bf16 v[108:111], a[156:159], v[128:131], v[108:111]
  v_mfma_f32_16x16x32_bf16 v[112:115], a[236:239], v[128:131], v[112:115]
  s_waitcnt lgkmcnt(2)
  v_mfma_f32_16x16x32_bf16 v[100:103], a[0:3], v[116:119], v[100:103]
  ds_read_b128 v[128:131], v159 offset:35840
  v_mfma_f32_16x16x32_bf16 v[104:107], a[80:83], v[116:119], v[104:107]
  buffer_load_dword v158, v157, s[8:11], s33 offen sc1
  v_mfma_f32_16x16x32_bf16 v[108:111], a[160:163], v[116:119], v[108:111]
  v_mfma_f32_16x16x32_bf16 v[112:115], a[240:243], v[116:119], v[112:115]
  s_waitcnt lgkmcnt(2)
  v_mfma_f32_16x16x32_bf16 v[100:103], a[4:7], v[120:123], v[100:103]
  v_mfma_f32_16x16x32_bf16 v[104:107], a[84:87], v[120:123], v[104:107]
  v_mfma_f32_16x16x32_bf16 v[108:111], a[164:167], v[120:123], v[108:111]
  v_mfma_f32_16x16x32_bf16 v[112:115], a[244:247], v[120:123], v[112:115]
  s_waitcnt lgkmcnt(1)
  v_mfma_f32_16x16x32_bf16 v[100:103], a[8:11], v[124:127], v[100:103]
  v_mfma_f32_16x16x32_bf16 v[104:107], a[88:91], v[124:127], v[104:107]
  v_mfma_f32_16x16x32_bf16 v[108:111], a[168:171], v[124:127], v[108:111]
  v_mfma_f32_16x16x32_bf16 v[112:115], a[248:251], v[124:127], v[112:115]
  s_waitcnt lgkmcnt(0)
  v_mfma_f32_16x16x32_bf16 v[100:103], a[12:15], v[128:131], v[100:103]
  v_mfma_f32_16x16x32_bf16 v[104:107], a[92:95], v[128:131], v[104:107]
  v_mfma_f32_16x16x32_bf16 v[108:111], a[172:175], v[128:131], v[108:111]
  v_mfma_f32_16x16x32_bf16 v[112:115], a[252:255], v[128:131], v[112:115]
  s_xor_b32 s44, s44, 0x10000
  v_xor_b32 v159, 0x10000, v159
  s_cmp_lt_u32 s29, 63
  s_cselect_b32 s31, 40960, 0
  s_add_u32 s43, s43, s31
  s_mul_i32 s31, s16, 2621440
  s_cmp_eq_u32 s29, 11
  s_cselect_b32 s31, s31, 0
  s_sub_u32 s43, s43, s31
  v_mov_b32 v169, s29
  v_cvt_pk_bf16_f32 v132, v100, v101
  v_cvt_pk_bf16_f32 v133, v102, v103
  v_cvt_pk_bf16_f32 v134, v104, v105
  v_cvt_pk_bf16_f32 v135, v106, v107
  buffer_store_dwordx4 v[132:135], v144, s[8:11], s42 offen
  s_add_u32 s42, s42, s50
  ds_write_b128 v162, v[132:135]
  v_cvt_pk_bf16_f32 v136, v108, v109
  v_cvt_pk_bf16_f32 v137, v110, v111
  v_cvt_pk_bf16_f32 v138, v112, v113
  v_cvt_pk_bf16_f32 v139, v114, v115
  buffer_store_dwordx4 v[136:139], v144, s[8:11], s42 offen
  s_add_u32 s42, s42, s50
  ds_write_b128 v176, v[136:139]
  s_cmp_gt_u32 s29, 2
  s_cbranch_scc1 b_step23
  s_waitcnt vmcnt(0) lgkmcnt(0)
  buffer_store_dword v169, v154, s[8:11], 0 offen
  s_cmp_eq_u32 s29, 2
  s_barrier
  s_cbranch_scc1 b_top2
  s_mov_b32 s33, 4096
  s_mov_b32 s30, 0
pw_54:
  buffer_load_dword v166, v157, s[8:11], s33 offen sc1
  s_add_u32 s30, s30, 1
  s_cmp_gt_u32 s30, 65536
  s_cbranch_scc1 role_abort
  s_waitcnt vmcnt(0)
pc_56:
  v_cmp_gt_u32 vcc, 1, v166
  s_nop 0
  s_and_b32 vcc_lo, vcc_lo, 0x10000000
  s_and_b32 vcc_hi, vcc_hi, 0x0
  s_cmp_eq_u64 vcc, 0
  s_cbranch_scc1 po_55
  s_sleep 2
  s_branch pw_54
po_55:
  v_readlane_b32 s31, v166, 28
  s_nop 0
  s_lshl_b32 s31, s31, 13
  s_add_u32 s56, s56, s31
  s_branch b_step22
b_step20:
  s_waitcnt vmcnt(0)
  buffer_store_dword v170, v155, s[8:11], 0 offen
  s_sleep 24
b_step23:
  s_waitcnt vmcnt(2) lgkmcnt(0)
  s_barrier
  ds_write_b128 v144, v[72:75] offset:12288
  ds_write_b128 v144, v[72:75] offset:13312
b_step2S:
  s_sleep 4
b_step22:
  s_and_b32 s31, s28, 3
  s_mul_i32 s36, s31, 81920
  s_add_u32 s36, s36, s35
  s_lshl_b32 s32, s31, 15
  s_add_u32 s38, s37, s32
  s_add_u32 s28, s28, 1
  v_mov_b32 v170, s28
  s_mul_i32 s40, s31, 24576
  s_add_u32 s40, s40, s39
  v_mov_b32 v60, 0
  v_mov_b32 v61, 0
  v_mov_b32 v62, 0
  v_mov_b32 v63, 0
  v_mov_b32 v64, 0
  v_mov_b32 v65, 0
  v_mov_b32 v66, 0
  v_mov_b32 v67, 0
b_step2P:
  s_mov_b32 s30, 0
  buffer_load_dwordx4 v[76:79], v147, s[8:11], s36 offen sc1
  buffer_load_dwordx4 v[80:83], v147, s[8:11], s36 offen offset:1024 sc1
  buffer_load_dword v84, v148, s[8:11], s36 offen sc1
  buffer_load_dword v85, v148, s[8:11], s36 offen offset:256 sc1
  s_nop 15
  s_nop 15
mq_57:
  buffer_load_dwordx4 v[88:91], v147, s[8:11], s36 offen sc1
  buffer_load_dwordx4 v[92:95], v147, s[8:11], s36 offen offset:1024 sc1
  buffer_load_dword v96, v148, s[8:11], s36 offen sc1
  buffer_load_dword v97, v148, s[8:11], s36 offen offset:256 sc1
  s_add_u32 s30, s30, 1
  s_cmp_gt_u32 s30, 65536
  s_cbranch_scc1 chain_abort
  s_waitcnt vmcnt(4)
  buffer_store_dword v169, v154, s[8:11], 0 offen
  v_max3_u32 v167, v76, v80, v84
  v_max_u32 v167, v167, v85
  v_cmp_eq_u32 vcc, -1, v167
  ds_write_b128 v147, v[76:79]
  ds_write_b128 v147, v[80:83] offset:1024
  ds_write2st64_b32 v148, v84, v85 offset0:0 offset1:1
  s_cbranch_vccz mq_57_ok
  buffer_load_dwordx4 v[76:79], v147, s[8:11], s36 offen sc1
  buffer_load_dwordx4 v[80:83], v147, s[8:11], s36 offen offset:1024 sc1
  buffer_load_dword v84, v148, s[8:11], s36 offen sc1
  buffer_load_dword v85, v148, s[8:11], s36 offen offset:256 sc1
  s_waitcnt vmcnt(5)
  v_max3_u32 v167, v88, v92, v96
  v_max_u32 v167, v167, v97
  v_cmp_eq_u32 vcc, -1, v167
  ds_write_b128 v147, v[88:91]
  ds_write_b128 v147, v[92:95] offset:1024
  ds_write2st64_b32 v148, v96, v97 offset0:0 offset1:1
  s_cbranch_vccz mq_57_ok
  s_branch mq_57
mq_57_ok:
  s_waitcnt lgkmcnt(0)
  s_barrier
  ds_read_b128 v[4:7], v144 offset:0
  ds_read_b128 v[8:11], v144 offset:1024
  ds_read_b128 v[12:15], v144 offset:2048
  ds_read_b128 v[16:19], v144 offset:3072
  ds_read_b128 v[20:23], v144 offset:4096
  ds_read_b128 v[24:27], v144 offset:5120
  ds_read_b128 v[28:31], v144 offset:6144
  ds_read_b128 v[32:35], v144 offset:7168
  ds_read_b128 v[36:39], v144 offset:8192
  ds_read_b128 v[40:43], v144 offset:9216
  s_waitcnt lgkmcnt(9)
  v_smfmac_f32_16x16x64_bf16 v[60:63], v[4:7], v[192:199], v151
  v_smfmac_f32_16x16x64_bf16 v[64:67], v[4:7], a[16:23], v151
  s_waitcnt lgkmcnt(8)
  v_smfmac_f32_16x16x64_bf16 v[60:63], v[8:11], v[200:207], v151
  v_smfmac_f32_16x16x64_bf16 v[64:67], v[8:11], a[24:31], v151
  s_waitcnt lgkmcnt(7)
  v_smfmac_f32_16x16x64_bf16 v[60:63], v[12:15], v[208:215], v151
  v_smfmac_f32_16x16x64_bf16 v[64:67], v[12:15], a[32:39], v151
  s_waitcnt lgkmcnt(6)
  v_smfmac_f32_16x16x64_bf16 v[60:63], v[16:19], v[216:223], v151
  buffer_store_dword v170, v156, s[8:11], 0 offen
  v_smfmac_f32_16x16x64_bf16 v[64:67], v[16:19], a[40:47], v151
  s_waitcnt lgkmcnt(5)
  v_smfmac_f32_16x16x64_bf16 v[60:63], v[20:23], v[224:231], v151
  v_smfmac_f32_16x16x64_bf16 v[64:67], v[20:23], a[48:55], v151
  s_waitcnt lgkmcnt(4)
  v_smfmac_f32_16x16x64_bf16 v[60:63], v[24:27], v[232:239], v151
  v_smfmac_f32_16x16x64_bf16 v[64:67], v[24:27], a[56:63], v151
  s_waitcnt lgkmcnt(3)
  v_smfmac_f32_16x16x64_bf16 v[60:63], v[28:31], v[240:247], v151
  v_smfmac_f32_16x16x64_bf16 v[64:67], v[28:31], a[64:71], v151
  s_waitcnt lgkmcnt(2)
  v_smfmac_f32_16x16x64_bf16 v[60:63], v[32:35], v[248:255], v151
  s_waitcnt lgkmcnt(1)
  v_smfmac_f32_16x16x64_bf16 v[60:63], v[36:39], a[0:7], v151
  s_waitcnt lgkmcnt(0)
  v_smfmac_f32_16x16x64_bf16 v[60:63], v[40:43], a[8:15], v151
  s_nop 2
  v_smfmac_f32_16x16x64_bf16 v[64:67], v[32:35], a[72:79], v151
  s_nop 2
  v_smfmac_f32_16x16x64_bf16 v[64:67], v[36:39], a[80:87], v151
  v_add_f32 v60, v60, v62
  v_add_f32 v61, v61, v63
  v_cvt_pk_bf16_f32 v140, v60, v61
  ds_write2_b32 v149, v140, v140 offset0:0 offset1:1
  v_smfmac_f32_16x16x64_bf16 v[64:67], v[40:43], a[88:95], v151
  s_nop 7
  v_add_f32 v64, v64, v66
  v_add_f32 v65, v65, v67
  v_cvt_pk_bf16_f32 v141, v64, v65
  ds_write2_b32 v149, v141, v141 offset0:128 offset1:129
  s_mov_b32 s30, 0
  s_nop 15
  s_nop 7
sx_58:
  ds_read_b64_tr_b16 v[44:45], v145 offset:12288
  ds_read_b64_tr_b16 v[46:47], v145 offset:12800
  ds_read_b64_tr_b16 v[48:49], v145 offset:13312
  ds_read_b64_tr_b16 v[50:51], v145 offset:13824
  s_waitcnt lgkmcnt(0)
  v_pk_max_u16 v167, v44, v45
  v_pk_max_u16 v168, v46, v47
  v_pk_max_u16 v167, v167, v48
  v_pk_max_u16 v168, v168, v49
  v_pk_max_u16 v167, v167, v50
  v_pk_max_u16 v168, v168, v51
  v_pk_max_u16 v167, v167, v168
  v_lshlrev_b32 v168, 16, v167
  v_max_u32 v167, v167, v168
  v_cmp_le_u32 vcc, 0xffff0000, v167
  s_cbranch_vccnz sx_58_r
  buffer_store_dwordx4 v[44:47], v153, s[8:11], s40 offen
  buffer_store_dwordx4 v[48:51], v153, s[8:11], s40 offen offset:512
  s_add_u32 s31, s28, 2
  s_and_b32 s31, s31, 3
  s_cmp_lg_u32 s28, 64
  s_cbranch_scc1 b_top2
  s_waitcnt vmcnt(0)
  buffer_store_dword v170, v155, s[8:11], 0 offen
  s_cmp_eq_u32 s28, 64
  s_cbranch_scc1 b_end
  s_branch b_top2
sx_58_r:
  s_add_u32 s30, s30, 1
  s_cmp_gt_u32 s30, 65536
  s_cbranch_scc1 chain_abort
  s_branch sx_58
b_pro3:
  s_lshl_b32 s31, s26, 9
  s_add_u32 s37, s37, s31
  s_add_u32 s37, s37, 4096
  s_cmp_lt_u32 s24, 20
  s_cselect_b32 s31, 0, 32768
  s_sub_u32 s47, s47, s31
  s_cmp_lt_u32 s24, 20
  s_cselect_b32 s46, 0, 0
b_top3:
  s_add_u32 s31, s28, 3
  s_and_b32 s31, s31, 3
  s_mul_i32 s31, s31, 163840
  s_add_u32 s58, s56, s31
  s_add_u32 s59, s58, 16384
  s_add_u32 s60, s58, 32768
  s_cmp_ge_u32 s29, 64
  s_cbranch_scc1 b_step30
  ds_read_b128 v[116:119], v159 offset:16384
  ds_read_b128 v[120:123], v159 offset:17408
  ds_read_b128 v[124:127], v159 offset:18432
  s_and_b32 s31, s29, 3
  s_mul_i32 s31, s31, 147456
  s_add_u32 s42, s41, s31
  s_add_u32 s42, s42, s51
  s_add_u32 s49, s29, 2
  s_lshl_b32 s48, s49, 1
  s_min_u32 s48, s48, 128
  s_and_b32 s31, s29, 3
  s_lshl_b32 s31, s31, 12
  v_add_u32 v162, s31, v160
  v_xor_b32 v176, 1024, v162
  s_add_u32 s29, s29, 1
  s_mov_b32 s33, 8192
  s_waitcnt lgkmcnt(2)
  v_mfma_f32_16x16x32_bf16 v[100:103], v[192:195], v[116:119], 0
  ds_read_b128 v[128:131], v159 offset:19456
  v_mfma_f32_16x16x32_bf16 v[104:107], a[16:19], v[116:119], 0
  v_mfma_f32_16x16x32_bf16 v[108:111], a[96:99], v[116:119], 0
  v_mfma_f32_16x16x32_bf16 v[112:115], a[176:179], v[116:119], 0
  s_waitcnt lgkmcnt(2)
  v_mfma_f32_16x16x32_bf16 v[100:103], v[196:199], v[120:123], v[100:103]
  ds_read_b128 v[116:119], v159 offset:20480
  v_mfma_f32_16x16x32_bf16 v[104:107], a[20:23], v[120:123], v[104:107]
  v_mfma_f32_16x16x32_bf16 v[108:111], a[100:103], v[120:123], v[108:111]
  v_mfma_f32_16x16x32_bf16 v[112:115], a[180:183], v[120:123], v[112:115]
  s_waitcnt lgkmcnt(2)
  v_mfma_f32_16x16x32_bf16 v[100:103], v[200:203], v[124:127], v[100:103]
  ds_read_b128 v[120:123], v159 offset:21504
  v_mfma_f32_16x16x32_bf16 v[104:107], a[24:27], v[124:127], v[104:107]
  s_mov_b32 s30, 0
  s_branch pc_61
pw_59:
  buffer_load_dword v158, v157, s[8:11], s33 offen sc1
  s_add_u32 s30, s30, 1
  s_cmp_gt_u32 s30, 65536
  s_cbranch_scc1 role_abort
  s_waitcnt vmcnt(0)
pc_61:
  v_cmp_gt_u32 vcc, s48, v158
  s_nop 0
  s_and_b32 vcc_lo, vcc_lo, 0xfff
  s_and_b32 vcc_hi, vcc_hi, 0x0
  s_cmp_eq_u64 vcc, 0
  s_cbranch_scc1 po_60
  s_sleep 4
  s_branch pw_59
po_60:
  v_mfma_f32_16x16x32_bf16 v[108:111], a[104:107], v[124:127], v[108:111]
  v_mfma_f32_16x16x32_bf16 v[112:115], a[184:187], v[124:127], v[112:115]
  s_add_u32 m0, s44, 0
  s_add_u32 s31, s43, 0
  buffer_load_dwordx4 v144, s[8:11], s31 offen offset:0 sc1 lds
  s_waitcnt lgkmcnt(2)
  v_mfma_f32_16x16x32_bf16 v[100:103], v[204:207], v[128:131], v[100:103]
  ds_read_b128 v[124:127], v159 offset:22528
  v_mfma_f32_16x16x32_bf16 v[104:107], a[28:31], v[128:131], v[104:107]
  v_mfma_f32_16x16x32_bf16 v[108:111], a[108:111], v[128:131], v[108:111]
  v_mfma_f32_16x16x32_bf16 v[112:115], a[188:191], v[128:131], v[112:115]
  buffer_load_dwordx4 v144, s[8:11], s31 offen offset:1024 sc1 lds
  s_waitcnt lgkmcnt(2)
  v_mfma_f32_16x16x32_bf16 v[100:103], v[208:211], v[116:119], v[100:103]
  ds_read_b128 v[128:131], v159 offset:23552
  v_mfma_f32_16x16x32_bf16 v[104:107], a[32:35], v[116:119], v[104:107]
  v_mfma_f32_16x16x32_bf16 v[108:111], a[112:115], v[116:119], v[108:111]
  v_mfma_f32_16x16x32_bf16 v[112:115], a[192:195], v[116:119], v[112:115]
  buffer_load_dwordx4 v144, s[8:11], s31 offen offset:2048 sc1 lds
  s_waitcnt lgkmcnt(2)
  v_mfma_f32_16x16x32_bf16 v[100:103], v[212:215], v[120:123], v[100:103]
  ds_read_b128 v[116:119], v159 offset:24576
  v_mfma_f32_16x16x32_bf16 v[104:107], a[36:39], v[120:123], v[104:107]
  v_mfma_f32_16x16x32_bf16 v[108:111], a[116:119], v[120:123], v[108:111]
  v_mfma_f32_16x16x32_bf16 v[112:115], a[196:199], v[120:123], v[112:115]
  buffer_load_dwordx4 v144, s[8:11], s31 offen offset:3072 sc1 lds
  s_waitcnt lgkmcnt(2)
  v_mfma_f32_16x16x32_bf16 v[100:103], v[216:219], v[124:127], v[100:103]
  ds_read_b128 v[120:123], v159 offset:25600
  v_mfma_f32_16x16x32_bf16 v[104:107], a[40:43], v[124:127], v[104:107]
  v_mfma_f32_16x16x32_bf16 v[108:111], a[120:123], v[124:127], v[108:111]
  v_mfma_f32_16x16x32_bf16 v[112:115], a[200:203], v[124:127], v[112:115]
  s_add_u32 m0, s44, 4096
  s_add_u32 s31, s43, 4096
  buffer_load_dwordx4 v144, s[8:11], s31 offen offset:0 sc1 lds
  s_waitcnt lgkmcnt(2)
  v_mfma_f32_16x16x32_bf16 v[100:103], v[220:223], v[128:131], v[100:103]
  ds_read_b128 v[124:127], v159 offset:26624
  v_mfma_f32_16x16x32_bf16 v[104:107], a[44:47], v[128:131], v[104:107]
  v_mfma_f32_16x16x32_bf16 v[108:111], a[124:127], v[128:131], v[108:111]
  v_mfma_f32_16x16x32_bf16 v[112:115], a[204:207], v[128:131], v[112:115]
  buffer_load_dwordx4 v144, s[8:11], s31 offen offset:1024 sc1 lds
  s_waitcnt lgkmcnt(2)
  v_mfma_f32_16x16x32_bf16 v[100:103], v[224:227], v[116:119], v[100:103]
  ds_read_b128 v[128:131], v159 offset:27648
  v_mfma_f32_16x16x32_bf16 v[104:107], a[48:51], v[116:119], v[104:107]
  v_mfma_f32_16x16x32_bf16 v[108:111], a[128:131], v[116:119], v[108:111]
  v_mfma_f32_16x16x32_bf16 v[112:115], a[208:211], v[116:119], v[112:115]
  buffer_load_dwordx4 v144, s[8:11], s31 offen offset:2048 sc1 lds
  s_waitcnt lgkmcnt(2)
  v_mfma_f32_16x16x32_bf16 v[100:103], v[228:231], v[120:123], v[100:103]
  ds_read_b128 v[116:119], v159 offset:28672
  v_mfma_f32_16x16x32_bf16 v[104:107], a[52:55], v[120:123], v[104:107]
  v_mfma_f32_16x16x32_bf16 v[108:111], a[132:135], v[120:123], v[108:111]
  v_mfma_f32_16x16x32_bf16 v[112:115], a[212:215], v[120:123], v[112:115]
  buffer_load_dwordx4 v144, s[8:11], s31 offen offset:3072 sc1 lds
  s_waitcnt lgkmcnt(2)
  v_mfma_f32_16x16x32_bf16 v[100:103], v[232:235], v[124:127], v[100:103]
  ds_read_b128 v[120:123], v159 offset:29696
  v_mfma_f32_16x16x32_bf16 v[104:107], a[56:59], v[124:127], v[104:107]
  v_mfma_f32_16x16x32_bf16 v[108:111], a[136:139], v[124:127], v[108:111]
  v_mfma_f32_16x16x32_bf16 v[112:115], a[216:219], v[124:127], v[112:115]
  s_add_u32 m0, s44, 8192
  s_add_u32 s31, s43, 8192
  buffer_load_dwordx4 v144, s[8:11], s31 offen offset:0 sc1 lds
  s_waitcnt lgkmcnt(2)
  v_mfma_f32_16x16x32_bf16 v[100:103], v[236:239], v[128:131], v[100:103]
  ds_read_b128 v[124:127], v159 offset:30720
  v_mfma_f32_16x16x32_bf16 v[104:107], a[60:63], v[128:131], v[104:107]
  v_mfma_f32_16x16x32_bf16 v[108:111], a[140:143], v[128:131], v[108:111]
  v_mfma_f32_16x16x32_bf16 v[112:115], a[220:223], v[128:131], v[112:115]
  buffer_load_dwordx4 v144, s[8:11], s31 offen offset:1024 sc1 lds
  s_waitcnt lgkmcnt(2)
  v_mfma_f32_16x16x32_bf16 v[100:103], v[240:243], v[116:119], v[100:103]
  ds_read_b128 v[128:131], v159 offset:31744
  v_mfma_f32_16x16x32_bf16 v[104:107], a[64:67], v[116:119], v[104:107]
  v_mfma_f32_16x16x32_bf16 v[108:111], a[144:147], v[116:119], v[108:111]
  v_mfma_f32_16x16x32_bf16 v[112:115], a[224:227], v[116:119], v[112:115]
  buffer_load_dword v158, v157, s[8:11], s33 offen sc1
  s_waitcnt lgkmcnt(2)
  v_mfma_f32_16x16x32_bf16 v[100:103], v[244:247], v[120:123], v[100:103]
  ds_read_b128 v[116:119], v159 offset:32768
  v_mfma_f32_16x16x32_bf16 v[104:107], a[68:71], v[120:123], v[104:107]
  v_mfma_f32_16x16x32_bf16 v[108:111], a[148:151], v[120:123], v[108:111]
  v_mfma_f32_16x16x32_bf16 v[112:115], a[228:231], v[120:123], v[112:115]
  s_waitcnt lgkmcnt(2)
  v_mfma_f32_16x16x32_bf16 v[100:103], v[248:251], v[124:127], v[100:103]
  ds_read_b128 v[120:123], v159 offset:33792
  v_mfma_f32_16x16x32_bf16 v[104:107], a[72:75], v[124:127], v[104:107]
  v_mfma_f32_16x16x32_bf16 v[108:111], a[152:155], v[124:127], v[108:111]
  v_mfma_f32_16x16x32_bf16 v[112:115], a[232:235], v[124:127], v[112:115]
  s_waitcnt lgkmcnt(2)
  v_mfma_f32_16x16x32_bf16 v[100:103], v[252:255], v[128:131], v[100:103]
  ds_read_b128 v[124:127], v159 offset:34816
  v_mfma_f32_16x16x32_bf16 v[104:107], a[76:79], v[128:131], v[104:107]
  v_mfma_f32_16x16x32_bf16 v[108:111], a[156:159], v[128:131], v[108:111]
  v_mfma_f32_16x16x32_bf16 v[112:115], a[236:239], v[128:131], v[112:115]
  s_waitcnt lgkmcnt(2)
  v_mfma_f32_16x16x32_bf16 v[100:103], a[0:3], v[116:119], v[100:103]
  ds_read_b128 v[128:131], v159 offset:35840
  v_mfma_f32_16x16x32_bf16 v[104:107], a[80:83], v[116:119], v[104:107]
  v_mfma_f32_16x16x32_bf16 v[108:111], a[160:163], v[116:119], v[108:111]
  v_mfma_f32_16x16x32_bf16 v[112:115], a[240:243], v[116:119], v[112:115]
  s_waitcnt lgkmcnt(2)
  v_mfma_f32_16x16x32_bf16 v[100:103], a[4:7], v[120:123], v[100:103]
  v_mfma_f32_16x16x32_bf16 v[104:107], a[84:87], v[120:123], v[104:107]
  v_mfma_f32_16x16x32_bf16 v[108:111], a[164:167], v[120:123], v[108:111]
  v_mfma_f32_16x16x32_bf16 v[112:115], a[244:247], v[120:123], v[112:115]
  s_waitcnt lgkmcnt(1)
  v_mfma_f32_16x16x32_bf16 v[100:103], a[8:11], v[124:127], v[100:103]
  v_mfma_f32_16x16x32_bf16 v[104:107], a[88:91], v[124:127], v[104:107]
  v_mfma_f32_16x16x32_bf16 v[108:111], a[168:171], v[124:127], v[108:111]
  v_mfma_f32_16x16x32_bf16 v[112:115], a[248:251], v[124:127], v[112:115]
  s_waitcnt lgkmcnt(0)
  v_mfma_f32_16x16x32_bf16 v[100:103], a[12:15], v[128:131], v[100:103]
  v_mfma_f32_16x16x32_bf16 v[104:107], a[92:95], v[128:131], v[104:107]
  v_mfma_f32_16x16x32_bf16 v[108:111], a[172:175], v[128:131], v[108:111]
  v_mfma_f32_16x16x32_bf16 v[112:115], a[252:255], v[128:131], v[112:115]
  s_xor_b32 s44, s44, 0x10000
  v_xor_b32 v159, 0x10000, v159
  s_cmp_lt_u32 s29, 63
  s_cselect_b32 s31, 40960, 0
  s_add_u32 s43, s43, s31
  s_mul_i32 s31, s16, 2621440
  s_cmp_eq_u32 s29, 11
  s_cselect_b32 s31, s31, 0
  s_sub_u32 s43, s43, s31
  v_mov_b32 v169, s29
  v_cvt_pk_bf16_f32 v132, v100, v101
  v_cvt_pk_bf16_f32 v133, v102, v103
  v_cvt_pk_bf16_f32 v134, v104, v105
  v_cvt_pk_bf16_f32 v135, v106, v107
  buffer_store_dwordx4 v[132:135], v144, s[8:11], s42 offen
  s_add_u32 s42, s42, s50
  v_cvt_pk_bf16_f32 v136, v108, v109
  v_cvt_pk_bf16_f32 v137, v110, v111
  v_cvt_pk_bf16_f32 v138, v112, v113
  v_cvt_pk_bf16_f32 v139, v114, v115
  buffer_store_dwordx4 v[136:139], v144, s[8:11], s42 offen
  s_add_u32 s42, s42, s50
  s_cmp_gt_u32 s29, 2
  s_cbranch_scc1 b_step33
  s_waitcnt vmcnt(0) lgkmcnt(0)
  buffer_store_dword v169, v154, s[8:11], 0 offen
  s_cmp_eq_u32 s29, 2
  s_barrier
  s_cbranch_scc1 b_top3
  s_mov_b32 s33, 4096
  s_mov_b32 s30, 0
pw_62:
  buffer_load_dword v166, v157, s[8:11], s33 offen sc1
  s_add_u32 s30, s30, 1
  s_cmp_gt_u32 s30, 65536
  s_cbranch_scc1 role_abort
  s_waitcnt vmcnt(0)
pc_64:
  v_cmp_gt_u32 vcc, 1, v166
  s_nop 0
  s_and_b32 vcc_lo, vcc_lo, 0x10000000
  s_and_b32 vcc_hi, vcc_hi, 0x0
  s_cmp_eq_u64 vcc, 0
  s_cbranch_scc1 po_63
  s_sleep 2
  s_branch pw_62
po_63:
  v_readlane_b32 s31, v166, 28
  s_nop 0
  s_lshl_b32 s31, s31, 13
  s_add_u32 s56, s56, s31
  s_branch b_step32
b_step30:
  s_sleep 24
b_step33:
  s_waitcnt vmcnt(2) lgkmcnt(0)
  s_barrier
  s_nop 15
  s_nop 11
  buffer_load_dwordx4 v[116:119], v144, s[8:11], s58 offen sc1
  buffer_load_dwordx4 v[120:123], v144, s[8:11], s58 offen offset:1024 sc1
  s_and_b32 s31, s28, 3
  s_mul_i32 s36, s31, 81920
  s_add_u32 s36, s36, s35
  s_lshl_b32 s32, s31, 15
  s_add_u32 s38, s37, s32
  s_add_u32 s28, s28, 1
  v_mov_b32 v170, s28
  v_mov_b32 v60, 0
  v_mov_b32 v61, 0
  v_mov_b32 v62, 0
  v_mov_b32 v63, 0
  v_mov_b32 v64, 0
  v_mov_b32 v65, 0
  v_mov_b32 v66, 0
  v_mov_b32 v67, 0
  s_mov_b32 s30, 0
  s_add_u32 s31, s36, s57
  s_waitcnt vmcnt(0)
  v_mfma_f32_16x16x32_bf16 v[108:111], v[180:183], v[116:119], 0
  v_mfma_f32_16x16x32_bf16 v[108:111], v[180:183], v[120:123], v[108:111]
  s_nop 7
  v_cmp_u_f32 vcc, v108, v109
  v_cvt_pk_bf16_f32 v168, v108, v109
  s_cbranch_vccnz b_step3xr
b_step3x:
  buffer_store_dword v168, v146, s[8:11], s31 offen
  buffer_store_dword v169, v154, s[8:11], 0 offen
  s_branch b_step3P
b_step3S:
  s_sleep 4
b_step32:
  s_and_b32 s31, s28, 3
  s_mul_i32 s36, s31, 81920
  s_add_u32 s36, s36, s35
  s_lshl_b32 s32, s31, 15
  s_add_u32 s38, s37, s32
  s_add_u32 s28, s28, 1
  v_mov_b32 v170, s28
  v_mov_b32 v60, 0
  v_mov_b32 v61, 0
  v_mov_b32 v62, 0
  v_mov_b32 v63, 0
  v_mov_b32 v64, 0
  v_mov_b32 v65, 0
  v_mov_b32 v66, 0
  v_mov_b32 v67, 0
b_step3P:
  s_mov_b32 s30, 0
  buffer_load_dwordx4 v[76:79], v147, s[8:11], s36 offen sc1
  buffer_load_dwordx4 v[80:83], v147, s[8:11], s36 offen offset:1024 sc1
  buffer_load_dword v84, v148, s[8:11], s36 offen sc1
  buffer_load_dword v85, v148, s[8:11], s36 offen offset:256 sc1
  s_nop 15
  s_nop 15
mq_65:
  buffer_load_dwordx4 v[88:91], v147, s[8:11], s36 offen sc1
  buffer_load_dwordx4 v[92:95], v147, s[8:11], s36 offen offset:1024 sc1
  buffer_load_dword v96, v148, s[8:11], s36 offen sc1
  buffer_load_dword v97, v148, s[8:11], s36 offen offset:256 sc1
  s_add_u32 s30, s30, 1
  s_cmp_gt_u32 s30, 65536
  s_cbranch_scc1 chain_abort
  s_waitcnt vmcnt(4)
  buffer_store_dword v169, v154, s[8:11], 0 offen
  v_max3_u32 v167, v76, v80, v84
  v_max_u32 v167, v167, v85
  v_cmp_eq_u32 vcc, -1, v167
  ds_write_b128 v147, v[76:79]
  ds_write_b128 v147, v[80:83] offset:1024
  ds_write2st64_b32 v148, v84, v85 offset0:0 offset1:1
  s_cbranch_vccz mq_65_ok
  buffer_load_dwordx4 v[76:79], v147, s[8:11], s36 offen sc1
  buffer_load_dwordx4 v[80:83], v147, s[8:11], s36 offen offset:1024 sc1
  buffer_load_dword v84, v148, s[8:11], s36 offen sc1
  buffer_load_dword v85, v148, s[8:11], s36 offen offset:256 sc1
  s_waitcnt vmcnt(5)
  v_max3_u32 v167, v88, v92, v96
  v_max_u32 v167, v167, v97
  v_cmp_eq_u32 vcc, -1, v167
  ds_write_b128 v147, v[88:91]
  ds_write_b128 v147, v[92:95] offset:1024
  ds_write2st64_b32 v148, v96, v97 offset0:0 offset1:1
  s_cbranch_vccz mq_65_ok
  s_branch mq_65
mq_65_ok:
  s_waitcnt lgkmcnt(0)
  s_barrier
  ds_read_b128 v[4:7], v144 offset:0
  ds_read_b128 v[8:11], v144 offset:1024
  ds_read_b128 v[12:15], v144 offset:2048
  ds_read_b128 v[16:19], v144 offset:3072
  ds_read_b128 v[20:23], v144 offset:4096
  ds_read_b128 v[24:27], v144 offset:5120
  ds_read_b128 v[28:31], v144 offset:6144
  ds_read_b128 v[32:35], v144 offset:7168
  ds_read_b128 v[36:39], v144 offset:8192
  ds_read_b128 v[40:43], v144 offset:9216
  s_waitcnt lgkmcnt(9)
  v_smfmac_f32_16x16x64_bf16 v[60:63], v[4:7], v[192:199], v151
  v_smfmac_f32_16x16x64_bf16 v[64:67], v[4:7], a[16:23], v151
  s_waitcnt lgkmcnt(8)
  v_smfmac_f32_16x16x64_bf16 v[60:63], v[8:11], v[200:207], v151
  v_smfmac_f32_16x16x64_bf16 v[64:67], v[8:11], a[24:31], v151
  s_waitcnt lgkmcnt(7)
  v_smfmac_f32_16x16x64_bf16 v[60:63], v[12:15], v[208:215], v151
  v_smfmac_f32_16x16x64_bf16 v[64:67], v[12:15], a[32:39], v151
  s_waitcnt lgkmcnt(6)
  v_smfmac_f32_16x16x64_bf16 v[60:63], v[16:19], v[216:223], v151
  buffer_store_dword v170, v156, s[8:11], 0 offen
  v_smfmac_f32_16x16x64_bf16 v[64:67], v[16:19], a[40:47], v151
  s_waitcnt lgkmcnt(5)
  v_smfmac_f32_16x16x64_bf16 v[60:63], v[20:23], v[224:231], v151
  v_smfmac_f32_16x16x64_bf16 v[64:67], v[20:23], a[48:55], v151
  s_waitcnt lgkmcnt(4)
  v_smfmac_f32_16x16x64_bf16 v[60:63], v[24:27], v[232:239], v151
  v_smfmac_f32_16x16x64_bf16 v[64:67], v[24:27], a[56:63], v151
  s_waitcnt lgkmcnt(3)
  v_smfmac_f32_16x16x64_bf16 v[60:63], v[28:31], v[240:247], v151
  v_smfmac_f32_16x16x64_bf16 v[64:67], v[28:31], a[64:71], v151
  s_waitcnt lgkmcnt(2)
  v_smfmac_f32_16x16x64_bf16 v[60:63], v[32:35], v[248:255], v151
  s_waitcnt lgkmcnt(1)
  v_smfmac_f32_16x16x64_bf16 v[60:63], v[36:39], a[0:7], v151
  s_waitcnt lgkmcnt(0)
  v_smfmac_f32_16x16x64_bf16 v[60:63], v[40:43], a[8:15], v151
  s_nop 2
  v_smfmac_f32_16x16x64_bf16 v[64:67], v[32:35], a[72:79], v151
  s_nop 2
  v_smfmac_f32_16x16x64_bf16 v[64:67], v[36:39], a[80:87], v151
  v_add_f32 v60, v60, v62
  v_add_f32 v61, v61, v63
  v_cvt_pk_bf16_f32 v140, v60, v61
  s_nop 1
  v_mov_b32_dpp v142, v140 quad_perm:[1,0,3,2] row_mask:0xf bank_mask:0xf
  v_perm_b32 v140, v142, v140, v152
  v_smfmac_f32_16x16x64_bf16 v[64:67], v[40:43], a[88:95], v151
  s_nop 7
  v_add_f32 v64, v64, v66
  v_add_f32 v65, v65, v67
  v_cvt_pk_bf16_f32 v141, v64, v65
  s_nop 1
  v_mov_b32_dpp v143, v141 quad_perm:[1,0,3,2] row_mask:0xf bank_mask:0xf
  v_perm_b32 v141, v143, v141, v152
  buffer_store_dwordx2 v[140:141], v150, s[8:11], s38 offen
  s_add_u32 s31, s28, 2
  s_and_b32 s31, s31, 3
  s_cmp_eq_u32 s28, 64
  s_cbranch_scc1 b_end
  s_lshl_b32 s31, s31, 15
  s_add_u32 s31, s31, s37
  buffer_store_dwordx2 v[72:73], v150, s[8:11], s31 offen
  s_add_u32 s31, s28, 1
  s_and_b32 s31, s31, 3
  s_mul_i32 s31, s31, 163840
  s_add_u32 s31, s31, s47
  s_add_u32 s32, s31, s46
  buffer_store_dwordx4 v[72:75], v164, s[8:11], s31 offen sc1
  s_add_u32 s31, s31, 196608
  s_branch b_top3
b_step3xr:
  buffer_load_dwordx4 v[116:119], v144, s[8:11], s58 offen sc1
  buffer_load_dwordx4 v[120:123], v144, s[8:11], s58 offen offset:1024 sc1
  s_add_u32 s30, s30, 1
  s_cmp_gt_u32 s30, 65536
  s_cbranch_scc1 chain_abort
  s_waitcnt vmcnt(0)
  v_mfma_f32_16x16x32_bf16 v[108:111], v[180:183], v[116:119], 0
  v_mfma_f32_16x16x32_bf16 v[108:111], v[180:183], v[120:123], v[108:111]
  s_nop 7
  v_cmp_u_f32 vcc, v108, v109
  v_cvt_pk_bf16_f32 v168, v108, v109
  s_cbranch_vccz b_step3x
  s_branch b_step3xr
b_end:
  s_endpgm
chain_abort:
  v_mov_b32 v167, 128
  v_mov_b32 v168, 1
  s_mov_b64 exec, 1
  buffer_atomic_add v168, v167, s[12:15], 0 offen
  s_endpgm
role_w:
  s_load_dwordx2 s[20:21], s[0:1], 40
  s_mov_b32 s22, 7864320
  s_mov_b32 s23, 0x00020000
  s_load_dwordx2 s[88:89], s[0:1], 96
  s_mov_b32 s90, 1280
  s_mov_b32 s91, 0x00020000
  s_load_dwordx2 s[92:93], s[0:1], 104
  s_mov_b32 s94, 4915200
  s_mov_b32 s95, 0x00020000
  v_lshrrev_b32 v203, 4, v1
  v_and_b32 v203, 3, v203
  v_lshlrev_b32 v203, 1, v203
  v_and_b32 v207, 7, v1
  v_xor_b32 v207, v207, v203
  v_lshlrev_b32 v207, 4, v207
  v_lshrrev_b32 v203, 3, v1
  v_mul_u32_u24 v203, 1280, v203
  v_add_u32 v207, v207, v203
  s_sub_u32 s24, s18, 18
  s_lshl_b32 s27, s16, 2
  s_add_u32 s27, s27, s17
  s_mul_i32 s29, s27, 245760
  s_lshl_b32 s27, s24, 7
  s_add_u32 s29, s29, s27
  s_mul_i32 s30, s17, 24576
  s_add_u32 s30, s30, 16384
  s_sub_u32 s27, 7, s24
  s_lshl_b32 s27, s27, 3
  s_add_u32 s27, s27, s16
  s_cmp_ge_u32 s27, 20
  s_waitcnt lgkmcnt(0)
  s_cbranch_scc1 w_nm
  v_lshlrev_b32 v12, 2, v0
  buffer_load_dword v13, v12, s[88:91], 0 offen
  buffer_load_dword v14, v12, s[88:91], 0 offen offset:1024
  v_lshrrev_b32 v20, 3, v0
  v_and_b32 v21, 7, v0
  v_mul_u32_u24 v22, 153600, v20
  v_lshl_add_u32 v22, v21, 4, v22
  s_lshl_b32 s6, s27, 7
  buffer_load_dwordx4 v[28:31], v22, s[92:95], s6 offen nt
  s_add_u32 s6, s6, 7680
  buffer_load_dwordx4 v[32:35], v22, s[92:95], s6 offen nt
  s_add_u32 s6, s6, 7680
  buffer_load_dwordx4 v[36:39], v22, s[92:95], s6 offen nt
  s_add_u32 s6, s6, 7680
  buffer_load_dwordx4 v[40:43], v22, s[92:95], s6 offen nt
  s_add_u32 s6, s6, 7680
  buffer_load_dwordx4 v[44:47], v22, s[92:95], s6 offen nt
  s_add_u32 s6, s6, 7680
  buffer_load_dwordx4 v[48:51], v22, s[92:95], s6 offen nt
  s_add_u32 s6, s6, 7680
  buffer_load_dwordx4 v[52:55], v22, s[92:95], s6 offen nt
  s_add_u32 s6, s6, 7680
  buffer_load_dwordx4 v[56:59], v22, s[92:95], s6 offen nt
  s_add_u32 s6, s6, 7680
  buffer_load_dwordx4 v[60:63], v22, s[92:95], s6 offen nt
  s_add_u32 s6, s6, 7680
  buffer_load_dwordx4 v[64:67], v22, s[92:95], s6 offen nt
  s_add_u32 s6, s6, 7680
  buffer_load_dwordx4 v[68:71], v22, s[92:95], s6 offen nt
  s_add_u32 s6, s6, 7680
  buffer_load_dwordx4 v[72:75], v22, s[92:95], s6 offen nt
  s_add_u32 s6, s6, 7680
  buffer_load_dwordx4 v[76:79], v22, s[92:95], s6 offen nt
  s_add_u32 s6, s6, 7680
  buffer_load_dwordx4 v[80:83], v22, s[92:95], s6 offen nt
  s_add_u32 s6, s6, 7680
  buffer_load_dwordx4 v[84:87], v22, s[92:95], s6 offen nt
  s_add_u32 s6, s6, 7680
  buffer_load_dwordx4 v[88:91], v22, s[92:95], s6 offen nt
  s_add_u32 s6, s6, 7680
  buffer_load_dwordx4 v[92:95], v22, s[92:95], s6 offen nt
  s_add_u32 s6, s6, 7680
  buffer_load_dwordx4 v[96:99], v22, s[92:95], s6 offen nt
  s_add_u32 s6, s6, 7680
  buffer_load_dwordx4 v[100:103], v22, s[92:95], s6 offen nt
  s_add_u32 s6, s6, 7680
  buffer_load_dwordx4 v[104:107], v22, s[92:95], s6 offen nt
  s_add_u32 s6, s6, 7680
  s_add_u32 m0, s30, 0
  s_add_u32 s28, s29, 0
  buffer_load_dwordx4 v207, s[20:23], s28 offen nt lds
  s_add_u32 m0, s30, 1024
  s_add_u32 s28, s29, 10240
  buffer_load_dwordx4 v207, s[20:23], s28 offen nt lds
  s_add_u32 m0, s30, 2048
  s_add_u32 s28, s29, 20480
  buffer_load_dwordx4 v207, s[20:23], s28 offen nt lds
  s_add_u32 m0, s30, 3072
  s_add_u32 s28, s29, 30720
  buffer_load_dwordx4 v207, s[20:23], s28 offen nt lds
  s_add_u32 m0, s30, 4096
  s_add_u32 s28, s29, 40960
  buffer_load_dwordx4 v207, s[20:23], s28 offen nt lds
  s_add_u32 m0, s30, 5120
  s_add_u32 s28, s29, 51200
  buffer_load_dwordx4 v207, s[20:23], s28 offen nt lds
  s_add_u32 m0, s30, 6144
  s_add_u32 s28, s29, 61440
  buffer_load_dwordx4 v207, s[20:23], s28 offen nt lds
  s_add_u32 m0, s30, 7168
  s_add_u32 s28, s29, 71680
  buffer_load_dwordx4 v207, s[20:23], s28 offen nt lds
  s_add_u32 m0, s30, 8192
  s_add_u32 s28, s29, 81920
  buffer_load_dwordx4 v207, s[20:23], s28 offen nt lds
  s_add_u32 m0, s30, 9216
  s_add_u32 s28, s29, 92160
  buffer_load_dwordx4 v207, s[20:23], s28 offen nt lds
  s_add_u32 m0, s30, 10240
  s_add_u32 s28, s29, 102400
  buffer_load_dwordx4 v207, s[20:23], s28 offen nt lds
  s_add_u32 m0, s30, 11264
  s_add_u32 s28, s29, 112640
  buffer_load_dwordx4 v207, s[20:23], s28 offen nt lds
  s_add_u32 m0, s30, 12288
  s_add_u32 s28, s29, 122880
  buffer_load_dwordx4 v207, s[20:23], s28 offen nt lds
  s_add_u32 m0, s30, 13312
  s_add_u32 s28, s29, 133120
  buffer_load_dwordx4 v207, s[20:23], s28 offen nt lds
  s_add_u32 m0, s30, 14336
  s_add_u32 s28, s29, 143360
  buffer_load_dwordx4 v207, s[20:23], s28 offen nt lds
  s_add_u32 m0, s30, 15360
  s_add_u32 s28, s29, 153600
  buffer_load_dwordx4 v207, s[20:23], s28 offen nt lds
  s_add_u32 m0, s30, 16384
  s_add_u32 s28, s29, 163840
  buffer_load_dwordx4 v207, s[20:23], s28 offen nt lds
  s_add_u32 m0, s30, 17408
  s_add_u32 s28, s29, 174080
  buffer_load_dwordx4 v207, s[20:23], s28 offen nt lds
  s_add_u32 m0, s30, 18432
  s_add_u32 s28, s29, 184320
  buffer_load_dwordx4 v207, s[20:23], s28 offen nt lds
  s_add_u32 m0, s30, 19456
  s_add_u32 s28, s29, 194560
  buffer_load_dwordx4 v207, s[20:23], s28 offen nt lds
  s_add_u32 m0, s30, 20480
  s_add_u32 s28, s29, 204800
  buffer_load_dwordx4 v207, s[20:23], s28 offen nt lds
  s_add_u32 m0, s30, 21504
  s_add_u32 s28, s29, 215040
  buffer_load_dwordx4 v207, s[20:23], s28 offen nt lds
  s_add_u32 m0, s30, 22528
  s_add_u32 s28, s29, 225280
  buffer_load_dwordx4 v207, s[20:23], s28 offen nt lds
  s_add_u32 m0, s30, 23552
  s_add_u32 s28, s29, 235520
  buffer_load_dwordx4 v207, s[20:23], s28 offen nt lds
  s_waitcnt vmcnt(44)
  v_lshlrev_b32 v24, 16, v13
  v_and_b32 v25, 0xffff0000, v13
  v_mul_f32 v16, 0xbfb8aa3b, v24
  v_mul_f32 v17, 0xbfb8aa3b, v25
  v_exp_f32 v16, v16
  v_exp_f32 v17, v17
  v_add_f32 v16, 1.0, v16
  v_add_f32 v17, 1.0, v17
  v_rcp_f32 v16, v16
  v_rcp_f32 v17, v17
  v_mul_f32 v24, v24, v16
  v_mul_f32 v25, v25, v17
  v_cvt_pk_bf16_f32 v16, v24, v25
  v_lshlrev_b32 v24, 16, v16
  v_and_b32 v25, 0xffff0000, v16
  v_lshlrev_b32 v26, 16, v14
  v_and_b32 v27, 0xffff0000, v14
  v_mul_f32 v16, 0xbfb8aa3b, v26
  v_mul_f32 v17, 0xbfb8aa3b, v27
  v_exp_f32 v16, v16
  v_exp_f32 v17, v17
  v_add_f32 v16, 1.0, v16
  v_add_f32 v17, 1.0, v17
  v_rcp_f32 v16, v16
  v_rcp_f32 v17, v17
  v_mul_f32 v26, v26, v16
  v_mul_f32 v27, v27, v17
  v_cvt_pk_bf16_f32 v16, v26, v27
  v_lshlrev_b32 v26, 16, v16
  v_and_b32 v27, 0xffff0000, v16
  v_lshlrev_b32 v12, 3, v0
  ds_write_b64 v12, v[24:25]
  ds_write_b64 v12, v[26:27] offset:2048
  v_mul_u32_u24 v12, 80, v20
  s_waitcnt lgkmcnt(0)
  s_barrier
  ds_read_b128 v[108:111], v12 offset:0
  ds_read_b128 v[112:115], v12 offset:16
  ds_read_b128 v[116:119], v12 offset:32
  ds_read_b128 v[120:123], v12 offset:48
  ds_read_b128 v[124:127], v12 offset:64
  v_mov_b32 v148, 0
  v_mov_b32 v149, 0
  v_mov_b32 v150, 0
  v_mov_b32 v151, 0
  v_mov_b32 v152, 0
  v_mov_b32 v153, 0
  v_mov_b32 v154, 0
  v_mov_b32 v155, 0
  s_waitcnt lgkmcnt(0)
  v_lshrrev_b32 v128, 16, v108
  v_lshrrev_b32 v129, 16, v109
  v_lshrrev_b32 v130, 16, v110
  v_lshrrev_b32 v131, 16, v111
  v_lshrrev_b32 v132, 16, v112
  v_lshrrev_b32 v133, 16, v113
  v_lshrrev_b32 v134, 16, v114
  v_lshrrev_b32 v135, 16, v115
  v_lshrrev_b32 v136, 16, v116
  v_lshrrev_b32 v137, 16, v117
  v_lshrrev_b32 v138, 16, v118
  v_lshrrev_b32 v139, 16, v119
  v_lshrrev_b32 v140, 16, v120
  v_lshrrev_b32 v141, 16, v121
  v_lshrrev_b32 v142, 16, v122
  v_lshrrev_b32 v143, 16, v123
  v_lshrrev_b32 v144, 16, v124
  v_lshrrev_b32 v145, 16, v125
  v_lshrrev_b32 v146, 16, v126
  v_lshrrev_b32 v147, 16, v127
  s_waitcnt vmcnt(42)
  v_dot2c_f32_bf16 v148, v28, v128
  v_dot2c_f32_bf16 v149, v28, v108
  v_dot2c_f32_bf16 v150, v29, v128
  v_dot2c_f32_bf16 v151, v29, v108
  v_dot2c_f32_bf16 v152, v30, v128
  v_dot2c_f32_bf16 v153, v30, v108
  v_dot2c_f32_bf16 v154, v31, v128
  v_dot2c_f32_bf16 v155, v31, v108
  v_dot2c_f32_bf16 v148, v32, v129
  v_dot2c_f32_bf16 v149, v32, v109
  v_dot2c_f32_bf16 v150, v33, v129
  v_dot2c_f32_bf16 v151, v33, v109
  v_dot2c_f32_bf16 v152, v34, v129
  v_dot2c_f32_bf16 v153, v34, v109
  v_dot2c_f32_bf16 v154, v35, v129
  v_dot2c_f32_bf16 v155, v35, v109
  s_waitcnt vmcnt(40)
  v_dot2c_f32_bf16 v148, v36, v130
  v_dot2c_f32_bf16 v149, v36, v110
  v_dot2c_f32_bf16 v150, v37, v130
  v_dot2c_f32_bf16 v151, v37, v110
  v_dot2c_f32_bf16 v152, v38, v130
  v_dot2c_f32_bf16 v153, v38, v110
  v_dot2c_f32_bf16 v154, v39, v130
  v_dot2c_f32_bf16 v155, v39, v110
  v_dot2c_f32_bf16 v148, v40, v131
  v_dot2c_f32_bf16 v149, v40, v111
  v_dot2c_f32_bf16 v150, v41, v131
  v_dot2c_f32_bf16 v151, v41, v111
  v_dot2c_f32_bf16 v152, v42, v131
  v_dot2c_f32_bf16 v153, v42, v111
  v_dot2c_f32_bf16 v154, v43, v131
  v_dot2c_f32_bf16 v155, v43, v111
  s_waitcnt vmcnt(38)
  v_dot2c_f32_bf16 v148, v44, v132
  v_dot2c_f32_bf16 v149, v44, v112
  v_dot2c_f32_bf16 v150, v45, v132
  v_dot2c_f32_bf16 v151, v45, v112
  v_dot2c_f32_bf16 v152, v46, v132
  v_dot2c_f32_bf16 v153, v46, v112
  v_dot2c_f32_bf16 v154, v47, v132
  v_dot2c_f32_bf16 v155, v47, v112
  v_dot2c_f32_bf16 v148, v48, v133
  v_dot2c_f32_bf16 v149, v48, v113
  v_dot2c_f32_bf16 v150, v49, v133
  v_dot2c_f32_bf16 v151, v49, v113
  v_dot2c_f32_bf16 v152, v50, v133
  v_dot2c_f32_bf16 v153, v50, v113
  v_dot2c_f32_bf16 v154, v51, v133
  v_dot2c_f32_bf16 v155, v51, v113
  s_waitcnt vmcnt(36)
  v_dot2c_f32_bf16 v148, v52, v134
  v_dot2c_f32_bf16 v149, v52, v114
  v_dot2c_f32_bf16 v150, v53, v134
  v_dot2c_f32_bf16 v151, v53, v114
  v_dot2c_f32_bf16 v152, v54, v134
  v_dot2c_f32_bf16 v153, v54, v114
  v_dot2c_f32_bf16 v154, v55, v134
  v_dot2c_f32_bf16 v155, v55, v114
  v_dot2c_f32_bf16 v148, v56, v135
  v_dot2c_f32_bf16 v149, v56, v115
  v_dot2c_f32_bf16 v150, v57, v135
  v_dot2c_f32_bf16 v151, v57, v115
  v_dot2c_f32_bf16 v152, v58, v135
  v_dot2c_f32_bf16 v153, v58, v115
  v_dot2c_f32_bf16 v154, v59, v135
  v_dot2c_f32_bf16 v155, v59, v115
  s_waitcnt vmcnt(34)
  v_dot2c_f32_bf16 v148, v60, v136
  v_dot2c_f32_bf16 v149, v60, v116
  v_dot2c_f32_bf16 v150, v61, v136
  v_dot2c_f32_bf16 v151, v61, v116
  v_dot2c_f32_bf16 v152, v62, v136
  v_dot2c_f32_bf16 v153, v62, v116
  v_dot2c_f32_bf16 v154, v63, v136
  v_dot2c_f32_bf16 v155, v63, v116
  v_dot2c_f32_bf16 v148, v64, v137
  v_dot2c_f32_bf16 v149, v64, v117
  v_dot2c_f32_bf16 v150, v65, v137
  v_dot2c_f32_bf16 v151, v65, v117
  v_dot2c_f32_bf16 v152, v66, v137
  v_dot2c_f32_bf16 v153, v66, v117
  v_dot2c_f32_bf16 v154, v67, v137
  v_dot2c_f32_bf16 v155, v67, v117
  s_waitcnt vmcnt(32)
  v_dot2c_f32_bf16 v148, v68, v138
  v_dot2c_f32_bf16 v149, v68, v118
  v_dot2c_f32_bf16 v150, v69, v138
  v_dot2c_f32_bf16 v151, v69, v118
  v_dot2c_f32_bf16 v152, v70, v138
  v_dot2c_f32_bf16 v153, v70, v118
  v_dot2c_f32_bf16 v154, v71, v138
  v_dot2c_f32_bf16 v155, v71, v118
  v_dot2c_f32_bf16 v148, v72, v139
  v_dot2c_f32_bf16 v149, v72, v119
  v_dot2c_f32_bf16 v150, v73, v139
  v_dot2c_f32_bf16 v151, v73, v119
  v_dot2c_f32_bf16 v152, v74, v139
  v_dot2c_f32_bf16 v153, v74, v119
  v_dot2c_f32_bf16 v154, v75, v139
  v_dot2c_f32_bf16 v155, v75, v119
  s_waitcnt vmcnt(30)
  v_dot2c_f32_bf16 v148, v76, v140
  v_dot2c_f32_bf16 v149, v76, v120
  v_dot2c_f32_bf16 v150, v77, v140
  v_dot2c_f32_bf16 v151, v77, v120
  v_dot2c_f32_bf16 v152, v78, v140
  v_dot2c_f32_bf16 v153, v78, v120
  v_dot2c_f32_bf16 v154, v79, v140
  v_dot2c_f32_bf16 v155, v79, v120
  v_dot2c_f32_bf16 v148, v80, v141
  v_dot2c_f32_bf16 v149, v80, v121
  v_dot2c_f32_bf16 v150, v81, v141
  v_dot2c_f32_bf16 v151, v81, v121
  v_dot2c_f32_bf16 v152, v82, v141
  v_dot2c_f32_bf16 v153, v82, v121
  v_dot2c_f32_bf16 v154, v83, v141
  v_dot2c_f32_bf16 v155, v83, v121
  s_waitcnt vmcnt(28)
  v_dot2c_f32_bf16 v148, v84, v142
  v_dot2c_f32_bf16 v149, v84, v122
  v_dot2c_f32_bf16 v150, v85, v142
  v_dot2c_f32_bf16 v151, v85, v122
  v_dot2c_f32_bf16 v152, v86, v142
  v_dot2c_f32_bf16 v153, v86, v122
  v_dot2c_f32_bf16 v154, v87, v142
  v_dot2c_f32_bf16 v155, v87, v122
  v_dot2c_f32_bf16 v148, v88, v143
  v_dot2c_f32_bf16 v149, v88, v123
  v_dot2c_f32_bf16 v150, v89, v143
  v_dot2c_f32_bf16 v151, v89, v123
  v_dot2c_f32_bf16 v152, v90, v143
  v_dot2c_f32_bf16 v153, v90, v123
  v_dot2c_f32_bf16 v154, v91, v143
  v_dot2c_f32_bf16 v155, v91, v123
  s_waitcnt vmcnt(26)
  v_dot2c_f32_bf16 v148, v92, v144
  v_dot2c_f32_bf16 v149, v92, v124
  v_dot2c_f32_bf16 v150, v93, v144
  v_dot2c_f32_bf16 v151, v93, v124
  v_dot2c_f32_bf16 v152, v94, v144
  v_dot2c_f32_bf16 v153, v94, v124
  v_dot2c_f32_bf16 v154, v95, v144
  v_dot2c_f32_bf16 v155, v95, v124
  v_dot2c_f32_bf16 v148, v96, v145
  v_dot2c_f32_bf16 v149, v96, v125
  v_dot2c_f32_bf16 v150, v97, v145
  v_dot2c_f32_bf16 v151, v97, v125
  v_dot2c_f32_bf16 v152, v98, v145
  v_dot2c_f32_bf16 v153, v98, v125
  v_dot2c_f32_bf16 v154, v99, v145
  v_dot2c_f32_bf16 v155, v99, v125
  s_waitcnt vmcnt(24)
  v_dot2c_f32_bf16 v148, v100, v146
  v_dot2c_f32_bf16 v149, v100, v126
  v_dot2c_f32_bf16 v150, v101, v146
  v_dot2c_f32_bf16 v151, v101, v126
  v_dot2c_f32_bf16 v152, v102, v146
  v_dot2c_f32_bf16 v153, v102, v126
  v_dot2c_f32_bf16 v154, v103, v146
  v_dot2c_f32_bf16 v155, v103, v126
  v_dot2c_f32_bf16 v148, v104, v147
  v_dot2c_f32_bf16 v149, v104, v127
  v_dot2c_f32_bf16 v150, v105, v147
  v_dot2c_f32_bf16 v151, v105, v127
  v_dot2c_f32_bf16 v152, v106, v147
  v_dot2c_f32_bf16 v153, v106, v127
  v_dot2c_f32_bf16 v154, v107, v147
  v_dot2c_f32_bf16 v155, v107, v127
  v_lshlrev_b32 v12, 5, v0
  ds_write_b128 v12, v[148:151] offset:4096
  s_nop 0
  ds_write_b128 v12, v[152:155] offset:4112
  v_lshlrev_b32 v12, 2, v0
  s_waitcnt lgkmcnt(0)
  s_barrier
  s_cmp_lg_u32 s17, 0
  s_cbranch_scc1 mod_enda
  ds_read2st64_b32 v[28:29], v12 offset0:16 offset1:17
  ds_read2st64_b32 v[30:31], v12 offset0:18 offset1:19
  ds_read2st64_b32 v[32:33], v12 offset0:20 offset1:21
  ds_read2st64_b32 v[34:35], v12 offset0:22 offset1:23
  ds_read2st64_b32 v[36:37], v12 offset0:24 offset1:25
  ds_read2st64_b32 v[38:39], v12 offset0:26 offset1:27
  ds_read2st64_b32 v[40:41], v12 offset0:28 offset1:29
  ds_read2st64_b32 v[42:43], v12 offset0:30 offset1:31
  ds_read2st64_b32 v[44:45], v12 offset0:32 offset1:33
  ds_read2st64_b32 v[46:47], v12 offset0:34 offset1:35
  ds_read2st64_b32 v[48:49], v12 offset0:36 offset1:37
  ds_read2st64_b32 v[50:51], v12 offset0:38 offset1:39
  ds_read2st64_b32 v[52:53], v12 offset0:40 offset1:41
  ds_read2st64_b32 v[54:55], v12 offset0:42 offset1:43
  ds_read2st64_b32 v[56:57], v12 offset0:44 offset1:45
  ds_read2st64_b32 v[58:59], v12 offset0:46 offset1:47
  s_waitcnt lgkmcnt(11)
  v_pk_add_f32 v[28:29], v[28:29], v[30:31]
  v_pk_add_f32 v[28:29], v[28:29], v[32:33]
  v_pk_add_f32 v[28:29], v[28:29], v[34:35]
  v_pk_add_f32 v[28:29], v[28:29], v[36:37]
  s_waitcnt lgkmcnt(7)
  v_pk_add_f32 v[28:29], v[28:29], v[38:39]
  v_pk_add_f32 v[28:29], v[28:29], v[40:41]
  v_pk_add_f32 v[28:29], v[28:29], v[42:43]
  v_pk_add_f32 v[28:29], v[28:29], v[44:45]
  s_waitcnt lgkmcnt(3)
  v_pk_add_f32 v[28:29], v[28:29], v[46:47]
  v_pk_add_f32 v[28:29], v[28:29], v[48:49]
  v_pk_add_f32 v[28:29], v[28:29], v[50:51]
  v_pk_add_f32 v[28:29], v[28:29], v[52:53]
  s_waitcnt lgkmcnt(0)
  v_pk_add_f32 v[28:29], v[28:29], v[54:55]
  v_pk_add_f32 v[28:29], v[28:29], v[56:57]
  v_pk_add_f32 v[28:29], v[28:29], v[58:59]
  v_add_f32 v28, v28, v29
  v_cvt_pk_bf16_f32 v28, v28, v28
  v_lshlrev_b32 v28, 16, v28
  s_lshl_b32 s6, s27, 8
  s_add_u32 s6, s6, 65536
  buffer_store_dword v28, v12, s[8:11], s6 offen sc1
  v_mov_b32 v16, 200
  v_mov_b32 v17, 1
  s_waitcnt vmcnt(0)
  s_mov_b64 exec, 1
  buffer_atomic_add v17, v16, s[12:15], 0 offen sc1
  s_mov_b64 exec, -1
mod_enda:
  s_branch w_md
w_nm:
  s_lshl_b32 s27, s24, 2
  s_add_u32 s27, s27, s17
  s_cmp_lg_u32 s27, 32
  s_cbranch_scc1 w_nc
  s_lshl_b32 s92, s16, 8
  s_add_u32 s92, s92, 17268736
  s_mov_b32 s93, 0
  s_mov_b32 s94, -1
  s_mov_b32 s95, -1
  v_lshlrev_b32 v12, 2, v1
  v_mov_b32 v13, -1
  s_waitcnt vmcnt(0)
boot_cal:
  s_memtime s[88:89]
  s_waitcnt lgkmcnt(0)
  buffer_store_dword v13, v12, s[8:11], s92 offen sc1
  s_waitcnt vmcnt(0)
  s_memtime s[90:91]
  s_waitcnt lgkmcnt(0)
  s_sub_u32 s88, s90, s88
  s_min_u32 s88, s88, s94
  s_mov_b32 s94, s95
  s_mov_b32 s95, s88
  s_xor_b32 s92, s92, 8192
  s_add_u32 s93, s93, 1
  s_cmp_lt_u32 s93, 10
  s_cbranch_scc1 boot_cal
  v_mov_b32 v12, 192
  s_mov_b32 s93, 0
gw_67:
  buffer_load_dword v13, v12, s[12:15], 0 offen sc1
  s_add_u32 s93, s93, 1
  s_cmp_gt_u32 s93, 65536
  s_cbranch_scc1 role_abort
  s_waitcnt vmcnt(0)
  v_cmp_gt_u32 vcc, 16, v13
  s_cbranch_vccz gk_68
  s_sleep 8
  s_branch gw_67
gk_68:
  s_cmp_lt_u32 s94, s95
  s_cselect_b32 s93, 1, 2
  s_lshl_b32 s92, s16, 8
  s_add_u32 s92, s92, 4208
  v_mov_b32 v12, s93
  v_mov_b32 v13, s92
  s_mov_b64 exec, 1
  buffer_store_dword v12, v13, s[8:11], 0 offen
  s_mov_b64 exec, -1
w_nc:
  s_add_u32 m0, s30, 0
  s_add_u32 s28, s29, 0
  buffer_load_dwordx4 v207, s[20:23], s28 offen nt lds
  s_add_u32 m0, s30, 1024
  s_add_u32 s28, s29, 10240
  buffer_load_dwordx4 v207, s[20:23], s28 offen nt lds
  s_add_u32 m0, s30, 2048
  s_add_u32 s28, s29, 20480
  buffer_load_dwordx4 v207, s[20:23], s28 offen nt lds
  s_add_u32 m0, s30, 3072
  s_add_u32 s28, s29, 30720
  buffer_load_dwordx4 v207, s[20:23], s28 offen nt lds
  s_add_u32 m0, s30, 4096
  s_add_u32 s28, s29, 40960
  buffer_load_dwordx4 v207, s[20:23], s28 offen nt lds
  s_add_u32 m0, s30, 5120
  s_add_u32 s28, s29, 51200
  buffer_load_dwordx4 v207, s[20:23], s28 offen nt lds
  s_add_u32 m0, s30, 6144
  s_add_u32 s28, s29, 61440
  buffer_load_dwordx4 v207, s[20:23], s28 offen nt lds
  s_add_u32 m0, s30, 7168
  s_add_u32 s28, s29, 71680
  buffer_load_dwordx4 v207, s[20:23], s28 offen nt lds
  s_add_u32 m0, s30, 8192
  s_add_u32 s28, s29, 81920
  buffer_load_dwordx4 v207, s[20:23], s28 offen nt lds
  s_add_u32 m0, s30, 9216
  s_add_u32 s28, s29, 92160
  buffer_load_dwordx4 v207, s[20:23], s28 offen nt lds
  s_add_u32 m0, s30, 10240
  s_add_u32 s28, s29, 102400
  buffer_load_dwordx4 v207, s[20:23], s28 offen nt lds
  s_add_u32 m0, s30, 11264
  s_add_u32 s28, s29, 112640
  buffer_load_dwordx4 v207, s[20:23], s28 offen nt lds
  s_add_u32 m0, s30, 12288
  s_add_u32 s28, s29, 122880
  buffer_load_dwordx4 v207, s[20:23], s28 offen nt lds
  s_add_u32 m0, s30, 13312
  s_add_u32 s28, s29, 133120
  buffer_load_dwordx4 v207, s[20:23], s28 offen nt lds
  s_add_u32 m0, s30, 14336
  s_add_u32 s28, s29, 143360
  buffer_load_dwordx4 v207, s[20:23], s28 offen nt lds
  s_add_u32 m0, s30, 15360
  s_add_u32 s28, s29, 153600
  buffer_load_dwordx4 v207, s[20:23], s28 offen nt lds
  s_add_u32 m0, s30, 16384
  s_add_u32 s28, s29, 163840
  buffer_load_dwordx4 v207, s[20:23], s28 offen nt lds
  s_add_u32 m0, s30, 17408
  s_add_u32 s28, s29, 174080
  buffer_load_dwordx4 v207, s[20:23], s28 offen nt lds
  s_add_u32 m0, s30, 18432
  s_add_u32 s28, s29, 184320
  buffer_load_dwordx4 v207, s[20:23], s28 offen nt lds
  s_add_u32 m0, s30, 19456
  s_add_u32 s28, s29, 194560
  buffer_load_dwordx4 v207, s[20:23], s28 offen nt lds
  s_add_u32 m0, s30, 20480
  s_add_u32 s28, s29, 204800
  buffer_load_dwordx4 v207, s[20:23], s28 offen nt lds
  s_add_u32 m0, s30, 21504
  s_add_u32 s28, s29, 215040
  buffer_load_dwordx4 v207, s[20:23], s28 offen nt lds
  s_add_u32 m0, s30, 22528
  s_add_u32 s28, s29, 225280
  buffer_load_dwordx4 v207, s[20:23], s28 offen nt lds
  s_add_u32 m0, s30, 23552
  s_add_u32 s28, s29, 235520
  buffer_load_dwordx4 v207, s[20:23], s28 offen nt lds
w_md:
  v_lshrrev_b32 v203, 2, v1
  v_lshrrev_b32 v204, 1, v203
  v_and_b32 v204, 3, v204
  v_lshlrev_b32 v204, 1, v204
  v_bfe_u32 v220, v1, 1, 1
  v_add_u32 v220, 0, v220
  v_xor_b32 v220, v220, v204
  v_lshlrev_b32 v220, 4, v220
  v_lshlrev_b32 v203, 7, v203
  v_add_u32 v220, v220, v203
  v_and_b32 v203, 1, v1
  v_lshlrev_b32 v203, 3, v203
  v_add_u32 v220, v220, v203
  v_add_u32 v220, s30, v220
  v_lshrrev_b32 v203, 2, v1
  v_lshrrev_b32 v204, 1, v203
  v_and_b32 v204, 3, v204
  v_lshlrev_b32 v204, 1, v204
  v_bfe_u32 v221, v1, 1, 1
  v_add_u32 v221, 2, v221
  v_xor_b32 v221, v221, v204
  v_lshlrev_b32 v221, 4, v221
  v_lshlrev_b32 v203, 7, v203
  v_add_u32 v221, v221, v203
  v_and_b32 v203, 1, v1
  v_lshlrev_b32 v203, 3, v203
  v_add_u32 v221, v221, v203
  v_add_u32 v221, s30, v221
  v_lshrrev_b32 v203, 2, v1
  v_lshrrev_b32 v204, 1, v203
  v_and_b32 v204, 3, v204
  v_lshlrev_b32 v204, 1, v204
  v_bfe_u32 v222, v1, 1, 1
  v_add_u32 v222, 4, v222
  v_xor_b32 v222, v222, v204
  v_lshlrev_b32 v222, 4, v222
  v_lshlrev_b32 v203, 7, v203
  v_add_u32 v222, v222, v203
  v_and_b32 v203, 1, v1
  v_lshlrev_b32 v203, 3, v203
  v_add_u32 v222, v222, v203
  v_add_u32 v222, s30, v222
  v_lshrrev_b32 v203, 2, v1
  v_lshrrev_b32 v204, 1, v203
  v_and_b32 v204, 3, v204
  v_lshlrev_b32 v204, 1, v204
  v_bfe_u32 v223, v1, 1, 1
  v_add_u32 v223, 6, v223
  v_xor_b32 v223, v223, v204
  v_lshlrev_b32 v223, 4, v223
  v_lshlrev_b32 v203, 7, v203
  v_add_u32 v223, v223, v203
  v_and_b32 v203, 1, v1
  v_lshlrev_b32 v203, 3, v203
  v_add_u32 v223, v223, v203
  v_add_u32 v223, s30, v223
  v_mov_b32 v80, 0x3f803f80
  v_mov_b32 v81, 0x3f803f80
  v_mov_b32 v82, 0x3f803f80
  v_mov_b32 v83, 0x3f803f80
  v_mov_b32 v108, 0
  v_mov_b32 v109, 0
  v_mov_b32 v110, 0
  v_mov_b32 v111, 0
  v_mov_b32 v112, 0
  v_mov_b32 v113, 0
  v_mov_b32 v114, 0
  v_mov_b32 v115, 0
  v_mov_b32 v116, 0
  v_mov_b32 v117, 0
  v_mov_b32 v118, 0
  v_mov_b32 v119, 0
  v_mov_b32 v84, 0
  v_mov_b32 v85, 0
  v_mov_b32 v86, 0
  v_mov_b32 v87, 0
  v_mov_b32 v88, 0
  v_mov_b32 v89, 0
  v_mov_b32 v90, 0
  v_mov_b32 v91, 0
  v_mov_b32 v92, 0
  v_mov_b32 v93, 0
  v_mov_b32 v94, 0
  v_mov_b32 v95, 0
  v_mov_b32 v96, 0
  v_mov_b32 v97, 0
  v_mov_b32 v98, 0
  v_mov_b32 v99, 0
  v_lshlrev_b32 v184, 4, v1
  v_lshlrev_b32 v185, 2, v1
  v_lshrrev_b32 v32, 4, v1
  v_and_b32 v33, 15, v1
  v_mov_b32 v202, 0
  v_bfe_u32 v203, v1, 1, 1
  v_mul_u32_u24 v203, 0xaaaa, v203
  v_add_u32 v190, 0x4444, v203
  s_lshl_b32 s27, s17, 8
  s_lshl_b32 s28, s24, 10
  s_add_u32 s27, s27, s28
  v_add_u32 v188, s27, v185
  s_lshl_b32 s27, s17, 11
  s_add_u32 s27, s27, 81920
  v_add_u32 v186, s27, v184
  s_lshl_b32 s27, s17, 2
  s_add_u32 s27, s27, 90112
  v_lshl_add_u32 v192, v33, 4, s27
  s_lshl_b32 s27, s17, 9
  s_add_u32 s27, s27, 81920
  v_and_b32 v203, 3, v1
  v_lshlrev_b32 v203, 5, v203
  v_bfe_u32 v204, v1, 4, 1
  v_lshl_add_u32 v203, v204, 4, v203
  v_add_u32 v193, 90112, v203
  v_bfe_u32 v204, v1, 5, 1
  v_lshl_add_u32 v203, v204, 3, v203
  v_bfe_u32 v204, v1, 2, 2
  v_lshl_add_u32 v203, v204, 7, v203
  v_add_u32 v187, s27, v203
  s_mov_b32 s58, 0x00ff00ff
  s_mov_b32 s59, 0x00ff00ff
  s_mov_b32 s60, 0x3dd53b95
  s_mov_b32 s61, s60
  s_mul_i32 s31, s16, 10240
  s_add_u32 s31, s31, 131072
  s_lshl_b32 s33, s16, 17
  s_lshl_b32 s28, s17, 13
  s_add_u32 s33, s33, s28
  s_add_u32 s33, s33, 3407872
  s_lshl_b32 s27, s16, 22
  s_add_u32 s27, s27, 67108864
  s_mul_i32 s38, s17, 12288
  s_add_u32 s38, s38, s27
  s_add_u32 s38, s38, 98304
  s_lshr_b32 s28, s17, 1
  s_lshl_b32 s28, s28, 10
  s_add_u32 s27, s27, s28
  s_add_u32 s39, s27, 602112
  s_add_u32 s40, s27, 610304
  s_mul_i32 s36, s24, 16384
  s_lshl_b32 s27, s17, 11
  s_add_u32 s36, s36, s27
  s_add_u32 s36, s36, 16777216
  v_lshlrev_b32 v194, 2, v32
  v_lshl_add_u32 v194, v33, 4, v194
  s_lshr_b32 s37, s16, 2
  s_lshl_b32 s37, s37, 10
  s_and_b32 s27, s16, 3
  s_lshl_b32 s27, s27, 4
  s_mov_b64 s[56:57], 0xffff
  s_lshl_b64 s[56:57], s[56:57], s27
  s_not_b64 s[56:57], s[56:57]
  s_lshl_b32 s27, s16, 8
  s_mul_i32 s28, s17, 24
  v_mov_b32 v203, 72
  v_mov_b32 v204, s28
  v_cmp_gt_u32 vcc, 6, v1
  s_nop 1
  v_cndmask_b32 v203, v203, v204, vcc
  v_min_u32 v204, 40, v185
  v_add3_u32 v189, v203, v204, s27
  v_add_u32 v189, 4096, v189
  s_lshl_b32 s28, s17, 6
  s_add_u32 s27, s27, s28
  s_add_u32 s27, s27, 12288
  v_add_u32 v195, s27, v185
  v_subrev_u32 v203, 64, v185
  ds_bpermute_b32 v204, v203, v189
  v_cmp_gt_u32 vcc, 22, v1
  s_nop 1
  v_cndmask_b32 v218, 0, 2, vcc
  v_cmp_gt_u32 vcc, 16, v1
  s_nop 1
  v_cndmask_b32 v218, v218, 1, vcc
  s_waitcnt lgkmcnt(0)
  v_cndmask_b32 v195, v204, v195, vcc
  v_bfe_u32 v203, v1, 2, 1
  v_and_b32 v204, 3, v1
  v_lshl_add_u32 v203, v203, 3, v204
  v_lshl_add_u32 v203, v32, 4, v203
  v_lshlrev_b32 v203, 4, v203
  v_bfe_u32 v204, v1, 3, 1
  v_mul_u32_u24 v205, 1088, v204
  s_and_b32 s28, s17, 1
  s_lshl_b32 s27, s28, 11
  v_add3_u32 v212, v203, v205, s27
  v_xor_b32 v213, 64, v212
  s_lshl_b32 s27, s17, 12
  v_add_u32 v214, s27, v184
  v_xor_b32 v215, 64, v214
  s_lshl_b32 s27, s28, 3
  s_add_u32 s27, s27, 65536
  v_lshl_add_u32 v203, v204, 2, v203
  v_add_u32 v198, s27, v203
  v_add_u32 v217, 64, v198
  s_lshl_b32 s27, s17, 10
  s_add_u32 s27, s27, 65536
  v_add_u32 v200, s27, v184
  v_mul_u32_u24 v203, 1280, v33
  v_lshl_add_u32 v197, v32, 4, v203
  s_lshl_b32 s41, s16, 1
  s_lshr_b32 s27, s17, 1
  s_add_u32 s41, s41, s27
  s_mul_i32 s41, s41, 20480
  s_lshl_b32 s27, s24, 7
  s_add_u32 s41, s41, s27
  s_lshl_b32 s27, s28, 6
  s_add_u32 s41, s41, s27
  s_add_u32 s41, s41, 226492416
  s_lshl_b32 s27, s16, 11
  s_lshl_b32 s28, s24, 7
  s_add_u32 s27, s27, s28
  s_lshl_b32 s28, s17, 2
  s_add_u32 s27, s27, s28
  v_mov_b32 v196, s27
  s_mov_b32 s42, 2162688
  s_mov_b32 s25, 0
  v_and_b32 v204, 3, v1
  v_mov_b32 v205, 0
  v_mov_b32 v206, 0x3f80
  v_cmp_eq_u32 vcc, 0, v204
  s_nop 1
  v_cndmask_b32 v205, v205, v206, vcc
  v_mov_b32 v206, 0x3f800000
  v_cmp_eq_u32 vcc, 1, v204
  s_nop 1
  v_cndmask_b32 v205, v205, v206, vcc
  v_lshrrev_b32 v203, 2, v33
  v_mov_b32 v206, 0
  v_mov_b32 v122, 0x3f803f80
  v_mov_b32 v123, 0
  v_mov_b32 v158, 0
  v_mov_b32 v159, 0
  v_cmp_eq_u32 vcc, 0, v203
  s_nop 1
  v_cndmask_b32 v76, v206, v205, vcc
  v_cmp_eq_u32 vcc, 1, v203
  s_nop 1
  v_cndmask_b32 v77, v206, v205, vcc
  v_cmp_eq_u32 vcc, 2, v203
  s_nop 1
  v_cndmask_b32 v78, v206, v205, vcc
  v_cmp_eq_u32 vcc, 3, v203
  s_nop 1
  v_cndmask_b32 v79, v206, v205, vcc
  v_mov_b32 v144, 0
  v_mov_b32 v145, 0
  v_mov_b32 v146, 0
  v_mov_b32 v147, 0
  s_waitcnt vmcnt(0)
  ds_read_b64_tr_b16 a[0:1], v220 offset:0
  ds_read_b64_tr_b16 a[2:3], v220 offset:2048
  ds_read_b64_tr_b16 a[24:25], v221 offset:0
  ds_read_b64_tr_b16 a[26:27], v221 offset:2048
  ds_read_b64_tr_b16 a[48:49], v222 offset:0
  ds_read_b64_tr_b16 a[50:51], v222 offset:2048
  ds_read_b64_tr_b16 a[72:73], v223 offset:0
  ds_read_b64_tr_b16 a[74:75], v223 offset:2048
  s_waitcnt lgkmcnt(8)
  ds_read_b64_tr_b16 a[4:5], v220 offset:4096
  ds_read_b64_tr_b16 a[6:7], v220 offset:6144
  ds_read_b64_tr_b16 a[28:29], v221 offset:4096
  ds_read_b64_tr_b16 a[30:31], v221 offset:6144
  ds_read_b64_tr_b16 a[52:53], v222 offset:4096
  ds_read_b64_tr_b16 a[54:55], v222 offset:6144
  ds_read_b64_tr_b16 a[76:77], v223 offset:4096
  ds_read_b64_tr_b16 a[78:79], v223 offset:6144
  s_waitcnt lgkmcnt(8)
  ds_read_b64_tr_b16 a[8:9], v220 offset:8192
  ds_read_b64_tr_b16 a[10:11], v220 offset:10240
  ds_read_b64_tr_b16 a[32:33], v221 offset:8192
  ds_read_b64_tr_b16 a[34:35], v221 offset:10240
  ds_read_b64_tr_b16 a[56:57], v222 offset:8192
  ds_read_b64_tr_b16 a[58:59], v222 offset:10240
  ds_read_b64_tr_b16 a[80:81], v223 offset:8192
  ds_read_b64_tr_b16 a[82:83], v223 offset:10240
  s_waitcnt lgkmcnt(8)
  ds_read_b64_tr_b16 a[12:13], v220 offset:12288
  ds_read_b64_tr_b16 a[14:15], v220 offset:14336
  ds_read_b64_tr_b16 a[36:37], v221 offset:12288
  ds_read_b64_tr_b16 a[38:39], v221 offset:14336
  ds_read_b64_tr_b16 a[60:61], v222 offset:12288
  ds_read_b64_tr_b16 a[62:63], v222 offset:14336
  ds_read_b64_tr_b16 a[84:85], v223 offset:12288
  ds_read_b64_tr_b16 a[86:87], v223 offset:14336
  s_waitcnt lgkmcnt(8)
  ds_read_b64_tr_b16 a[16:17], v220 offset:16384
  ds_read_b64_tr_b16 a[18:19], v220 offset:18432
  ds_read_b64_tr_b16 a[40:41], v221 offset:16384
  ds_read_b64_tr_b16 a[42:43], v221 offset:18432
  ds_read_b64_tr_b16 a[64:65], v222 offset:16384
  ds_read_b64_tr_b16 a[66:67], v222 offset:18432
  ds_read_b64_tr_b16 a[88:89], v223 offset:16384
  ds_read_b64_tr_b16 a[90:91], v223 offset:18432
  s_waitcnt lgkmcnt(8)
  ds_read_b64_tr_b16 a[20:21], v220 offset:20480
  ds_read_b64_tr_b16 a[22:23], v220 offset:22528
  ds_read_b64_tr_b16 a[44:45], v221 offset:20480
  ds_read_b64_tr_b16 a[46:47], v221 offset:22528
  ds_read_b64_tr_b16 a[68:69], v222 offset:20480
  ds_read_b64_tr_b16 a[70:71], v222 offset:22528
  ds_read_b64_tr_b16 a[92:93], v223 offset:20480
  ds_read_b64_tr_b16 a[94:95], v223 offset:22528
  s_waitcnt lgkmcnt(8)
  s_waitcnt lgkmcnt(0)
  s_barrier
  s_lshl_b32 s26, s16, 2
  s_add_u32 s26, s26, 32
  v_mov_b32 v203, s26
  s_mov_b32 s26, 0
  s_mov_b64 exec, 1
gw_69:
  buffer_load_dword v204, v203, s[12:15], 0 offen sc1
  s_add_u32 s26, s26, 1
  s_cmp_gt_u32 s26, 65536
  s_cbranch_scc1 role_abort
  s_waitcnt vmcnt(0)
  v_cmp_gt_u32 vcc, 2, v204
  s_cbranch_vccz gk_70
  s_sleep 4
  s_branch gw_69
gk_70:
  s_mov_b64 exec, -1
  s_mov_b32 s26, 0
pw_71:
  buffer_load_dword v191, v189, s[8:11], 0 offen sc1
  s_add_u32 s26, s26, 1
  s_cmp_gt_u32 s26, 65536
  s_cbranch_scc1 role_abort
  s_waitcnt vmcnt(0)
pc_73:
  v_cmp_gt_u32 vcc, 1, v191
  s_nop 0
  s_and_b32 vcc_lo, vcc_lo, 0x400
  s_and_b32 vcc_hi, vcc_hi, 0x0
  s_cmp_eq_u64 vcc, 0
  s_cbranch_scc1 po_72
  s_sleep 2
  s_branch pw_71
po_72:
  v_readlane_b32 s27, v191, 10
  s_nop 0
  s_sub_u32 s27, s27, 1
  s_lshl_b32 s27, s27, 13
  s_add_u32 s36, s36, s27
w_pro:
  s_add_u32 s43, s25, 1
  s_mov_b32 s26, 0
  s_waitcnt vmcnt(0)
we_74:
  v_cmp_gt_u32 vcc, s43, v191
  s_nop 0
  s_and_b32 vcc_lo, vcc_lo, 0x3f
  s_cbranch_scc1 we_74_r
  s_add_u32 s27, s25, 0
  s_and_b32 s27, s27, 3
  s_mul_i32 s27, s27, 147456
  s_add_u32 s45, s38, s27
  s_add_u32 s46, s45, 4096
  s_add_u32 s47, s45, 6144
  s_add_u32 s48, s45, 10240
  buffer_load_dwordx4 a[96:99], v184, s[8:11], s45 offen offset:0 sc1
  buffer_load_dwordx4 a[100:103], v184, s[8:11], s45 offen offset:1024 sc1
  buffer_load_dwordx4 a[104:107], v184, s[8:11], s45 offen offset:2048 sc1
  buffer_load_dwordx4 a[108:111], v184, s[8:11], s45 offen offset:3072 sc1
  buffer_load_dwordx4 a[112:115], v184, s[8:11], s46 offen offset:0 sc1
  buffer_load_dwordx4 a[116:119], v184, s[8:11], s46 offen offset:1024 sc1
  buffer_load_dwordx4 a[120:123], v184, s[8:11], s47 offen offset:0 sc1
  buffer_load_dwordx4 a[124:127], v184, s[8:11], s47 offen offset:1024 sc1
  buffer_load_dwordx4 a[128:131], v184, s[8:11], s47 offen offset:2048 sc1
  buffer_load_dwordx4 a[132:135], v184, s[8:11], s47 offen offset:3072 sc1
  buffer_load_dwordx4 a[136:139], v184, s[8:11], s48 offen offset:0 sc1
  buffer_load_dwordx4 a[140:143], v184, s[8:11], s48 offen offset:1024 sc1
  s_waitcnt vmcnt(11)
  v_mfma_f32_16x16x32_bf16 v[48:51], a[96:99], a[0:3], 0
  v_mfma_f32_16x16x32_bf16 v[52:55], a[96:99], a[24:27], 0
  v_mfma_f32_16x16x32_bf16 v[56:59], a[96:99], a[48:51], 0
  v_mfma_f32_16x16x32_bf16 v[60:63], a[96:99], a[72:75], 0
  s_waitcnt vmcnt(10)
  v_mfma_f32_16x16x32_bf16 v[48:51], a[100:103], a[4:7], v[48:51]
  v_mfma_f32_16x16x32_bf16 v[52:55], a[100:103], a[28:31], v[52:55]
  v_mfma_f32_16x16x32_bf16 v[56:59], a[100:103], a[52:55], v[56:59]
  v_mfma_f32_16x16x32_bf16 v[60:63], a[100:103], a[76:79], v[60:63]
  s_waitcnt vmcnt(9)
  v_mfma_f32_16x16x32_bf16 v[48:51], a[104:107], a[8:11], v[48:51]
  v_mfma_f32_16x16x32_bf16 v[52:55], a[104:107], a[32:35], v[52:55]
  v_mfma_f32_16x16x32_bf16 v[56:59], a[104:107], a[56:59], v[56:59]
  v_mfma_f32_16x16x32_bf16 v[60:63], a[104:107], a[80:83], v[60:63]
  s_waitcnt vmcnt(8)
  v_mfma_f32_16x16x32_bf16 v[48:51], a[108:111], a[12:15], v[48:51]
  v_mfma_f32_16x16x32_bf16 v[52:55], a[108:111], a[36:39], v[52:55]
  v_mfma_f32_16x16x32_bf16 v[56:59], a[108:111], a[60:63], v[56:59]
  v_mfma_f32_16x16x32_bf16 v[60:63], a[108:111], a[84:87], v[60:63]
  s_waitcnt vmcnt(7)
  v_mfma_f32_16x16x32_bf16 v[48:51], a[112:115], a[16:19], v[48:51]
  v_mfma_f32_16x16x32_bf16 v[52:55], a[112:115], a[40:43], v[52:55]
  v_mfma_f32_16x16x32_bf16 v[56:59], a[112:115], a[64:67], v[56:59]
  v_mfma_f32_16x16x32_bf16 v[60:63], a[112:115], a[88:91], v[60:63]
  s_waitcnt vmcnt(6)
  v_mfma_f32_16x16x32_bf16 v[48:51], a[116:119], a[20:23], v[48:51]
  v_mfma_f32_16x16x32_bf16 v[52:55], a[116:119], a[44:47], v[52:55]
  v_mfma_f32_16x16x32_bf16 v[56:59], a[116:119], a[68:71], v[56:59]
  v_mfma_f32_16x16x32_bf16 v[60:63], a[116:119], a[92:95], v[60:63]
  s_nop 4
  v_cvt_pk_bf16_f32 v32, v48, v49
  v_cvt_pk_bf16_f32 v33, v50, v51
  v_cvt_pk_bf16_f32 v36, v52, v53
  v_cvt_pk_bf16_f32 v37, v54, v55
  v_cvt_pk_bf16_f32 v40, v56, v57
  v_cvt_pk_bf16_f32 v41, v58, v59
  v_cvt_pk_bf16_f32 v44, v60, v61
  v_cvt_pk_bf16_f32 v45, v62, v63
  s_waitcnt vmcnt(0)
w_loop:
  v_mfma_f32_16x16x32_bf16 v[48:51], a[120:123], a[0:3], 0
  s_add_u32 s27, s25, 2
  s_and_b32 s27, s27, 3
  s_mul_i32 s28, s27, 24576
  v_mfma_f32_16x16x32_bf16 v[52:55], a[120:123], a[24:27], 0
  s_add_u32 s49, s39, s28
  s_add_u32 s50, s49, 4096
  s_add_u32 s51, s40, s28
  v_mfma_f32_16x16x32_bf16 v[56:59], a[120:123], a[48:51], 0
  s_lshl_b32 s28, s27, 14
  v_add_u32 v208, s28, v212
  v_add_u32 v209, s28, v213
  v_mfma_f32_16x16x32_bf16 v[60:63], a[120:123], a[72:75], 0
  s_lshl_b32 s28, s27, 12
  v_add_u32 v199, s28, v198
  v_add_u32 v216, s28, v217
  v_mfma_f32_16x16x32_bf16 v[48:51], a[124:127], a[4:7], v[48:51]
  ds_read_b128 a[144:147], v208 offset:0
  ds_read_b128 a[148:151], v209 offset:0
  ds_read_b128 a[152:155], v208 offset:4096
  buffer_load_dwordx4 a[176:179], v184, s[8:11], s49 offen offset:0 sc1
  v_mfma_f32_16x16x32_bf16 v[52:55], a[124:127], a[28:31], v[52:55]
  ds_read_b128 a[156:159], v209 offset:4096
  ds_read_b128 a[160:163], v208 offset:8192
  v_mfma_f32_16x16x32_bf16 v[56:59], a[124:127], a[52:55], v[56:59]
  ds_read_b128 a[164:167], v209 offset:8192
  ds_read_b128 a[168:171], v208 offset:12288
  ds_read_b128 a[172:175], v209 offset:12288
  v_mfma_f32_16x16x32_bf16 v[60:63], a[124:127], a[76:79], v[60:63]
  ds_read2st64_b32 v[160:161], v199 offset0:0 offset1:4
  ds_read2st64_b32 v[162:163], v199 offset0:8 offset1:12
  ds_read2st64_b32 v[164:165], v216 offset0:0 offset1:4
  v_mfma_f32_16x16x32_bf16 v[48:51], a[128:131], a[8:11], v[48:51]
  ds_read2st64_b32 v[166:167], v216 offset0:8 offset1:12
  s_cmp_ge_u32 s25, 4
  s_cselect_b32 s27, 327680, 0
  buffer_load_dwordx4 a[180:183], v184, s[8:11], s49 offen offset:2048 sc1
  v_mfma_f32_16x16x32_bf16 v[52:55], a[128:131], a[32:35], v[52:55]
  s_add_u32 s41, s41, s27
  v_add_u32 v219, s25, v218
  v_mfma_f32_16x16x32_bf16 v[56:59], a[128:131], a[56:59], v[56:59]
  v_min_u32 v219, 64, v219
  s_and_b32 s27, s25, 3
  s_lshl_b32 s28, s27, 15
  v_mfma_f32_16x16x32_bf16 v[60:63], a[128:131], a[80:83], v[60:63]
  s_add_u32 s34, s33, s28
  s_add_u32 s35, s34, 4096
  s_lshl_b32 s28, s27, 14
  v_mfma_f32_16x16x32_bf16 v[48:51], a[132:135], a[12:15], v[48:51]
  v_add_u32 v210, s28, v214
  v_add_u32 v211, s28, v215
  s_lshl_b32 s28, s27, 12
  buffer_load_dwordx4 a[184:187], v184, s[8:11], s50 offen offset:0 sc1
  v_mfma_f32_16x16x32_bf16 v[52:55], a[132:135], a[36:39], v[52:55]
  v_add_u32 v201, s28, v200
  s_mul_i32 s27, s27, 163840
  v_mfma_f32_16x16x32_bf16 v[56:59], a[132:135], a[60:63], v[56:59]
  s_add_u32 s27, s27, s36
  s_lshl_b32 s28, s16, 8
  s_add_u32 s52, s27, s28
  v_mfma_f32_16x16x32_bf16 v[60:63], a[132:135], a[84:87], v[60:63]
  s_xor_b32 s53, s52, 8192
  s_add_u32 s54, s27, s37
  s_xor_b32 s55, s54, 1024
  v_mfma_f32_16x16x32_bf16 v[48:51], a[136:139], a[16:19], v[48:51]
  s_add_u32 s44, s25, 1
  s_and_b32 s27, s44, 3
  s_mul_i32 s32, s27, 81920
  buffer_load_dwordx4 a[188:191], v184, s[8:11], s50 offen offset:2048 sc1
  v_mfma_f32_16x16x32_bf16 v[52:55], a[136:139], a[40:43], v[52:55]
  s_add_u32 s32, s32, s31
  s_add_u32 s43, s25, 2
  v_mfma_f32_16x16x32_bf16 v[56:59], a[136:139], a[64:67], v[56:59]
  s_min_u32 s43, s43, 64
  s_cmp_eq_u32 s25, 0
  s_cselect_b32 s43, 0, s43
  v_mfma_f32_16x16x32_bf16 v[60:63], a[136:139], a[88:91], v[60:63]
  s_add_u32 s27, s25, 1
  s_and_b32 s27, s27, 3
  s_mul_i32 s27, s27, 147456
  v_mfma_f32_16x16x32_bf16 v[48:51], a[140:143], a[20:23], v[48:51]
  s_add_u32 s45, s38, s27
  s_add_u32 s46, s45, 4096
  s_add_u32 s47, s45, 6144
  buffer_load_dwordx4 a[192:195], v184, s[8:11], s51 offen sc1
  v_mfma_f32_16x16x32_bf16 v[52:55], a[140:143], a[44:47], v[52:55]
  s_add_u32 s48, s45, 10240
  v_mfma_f32_16x16x32_bf16 v[56:59], a[140:143], a[68:71], v[56:59]
  v_mfma_f32_16x16x32_bf16 v[60:63], a[140:143], a[92:95], v[60:63]
  v_cvt_pk_bf16_f32 v34, v48, v49
  v_cvt_pk_bf16_f32 v35, v50, v51
  ds_write_b128 v210, v[32:35] offset:0
  s_nop 1
  v_cvt_pk_bf16_f32 v38, v52, v53
  v_cvt_pk_bf16_f32 v39, v54, v55
  ds_write_b128 v211, v[36:39] offset:1024
  s_mov_b64 exec, 0x3ff01ff
  buffer_load_dword v180, v195, s[8:11], 0 offen sc1
  s_mov_b64 exec, -1
  v_cvt_pk_bf16_f32 v42, v56, v57
  v_cvt_pk_bf16_f32 v43, v58, v59
  ds_write_b128 v210, v[40:43] offset:2048
  v_cvt_pk_bf16_f32 v46, v60, v61
  v_cvt_pk_bf16_f32 v47, v62, v63
  ds_write_b128 v211, v[44:47] offset:3072
  s_mov_b32 s26, 0
  s_mov_b64 exec, 0x3ff01ff
  buffer_load_dword v181, v195, s[8:11], 0 offen sc1
  s_nop 15
  buffer_load_dword v182, v195, s[8:11], 0 offen sc1
  s_nop 15
w_mk:
  buffer_load_dword v183, v195, s[8:11], 0 offen sc1
  s_add_u32 s26, s26, 1
  s_cmp_gt_u32 s26, 65536
  s_cbranch_scc1 chain_abort
  s_waitcnt vmcnt(3)
  v_cmp_gt_u32 vcc, v219, v180
  s_cbranch_vccz w_mk_ok
  buffer_load_dword v180, v195, s[8:11], 0 offen sc1
  s_waitcnt vmcnt(3)
  v_cmp_gt_u32 vcc, v219, v181
  s_cbranch_vccz w_mk_ok
  buffer_load_dword v181, v195, s[8:11], 0 offen sc1
  s_waitcnt vmcnt(3)
  v_cmp_gt_u32 vcc, v219, v182
  s_cbranch_vccz w_mk_ok
  buffer_load_dword v182, v195, s[8:11], 0 offen sc1
  s_waitcnt vmcnt(3)
  v_cmp_gt_u32 vcc, v219, v183
  s_cbranch_vccz w_mk_ok
  s_branch w_mk
w_mk_ok:
  s_mov_b64 exec, -1
  s_mov_b32 s26, 0
  s_nop 15
  s_nop 11
  buffer_load_dwordx4 v[4:7], v184, s[8:11], s35 offen offset:0 sc1
  buffer_load_dwordx4 v[8:11], v184, s[8:11], s35 offen offset:1024 sc1
  buffer_load_dwordx4 v[12:15], v184, s[8:11], s35 offen offset:2048 sc1
  s_nop 15
  s_nop 15
  s_nop 15
  s_nop 5
  buffer_load_dwordx4 v[20:23], v184, s[8:11], s34 offen offset:0 sc1
  buffer_load_dwordx4 v[24:27], v184, s[8:11], s34 offen offset:1024 sc1
  buffer_load_dwordx4 v[28:31], v184, s[8:11], s34 offen offset:2048 sc1
  buffer_load_dword v16, v185, s[8:11], s34 offen offset:3072 sc1
  buffer_load_dword v17, v185, s[8:11], s34 offen offset:3328 sc1
  buffer_load_dword v18, v185, s[8:11], s34 offen offset:3584 sc1
  s_waitcnt vmcnt(6)
w_gv:
  v_max3_u32 v203, v4, v8, v12
  v_cmp_eq_u32 vcc, -1, v203
  s_cbranch_vccnz w_gv_r
  v_smfmac_f32_16x16x64_bf16 v[84:87], v[4:7], a[0:7], v190
  v_smfmac_f32_16x16x64_bf16 v[88:91], v[4:7], a[24:31], v190
  v_smfmac_f32_16x16x64_bf16 v[92:95], v[4:7], a[48:55], v190
  buffer_load_dwordx4 a[96:99], v184, s[8:11], s45 offen offset:0 sc1
  v_smfmac_f32_16x16x64_bf16 v[96:99], v[4:7], a[72:79], v190
  v_smfmac_f32_16x16x64_bf16 v[84:87], v[8:11], a[8:15], v190
  v_smfmac_f32_16x16x64_bf16 v[88:91], v[8:11], a[32:39], v190
  v_smfmac_f32_16x16x64_bf16 v[92:95], v[8:11], a[56:63], v190
  buffer_load_dwordx4 a[100:103], v184, s[8:11], s45 offen offset:1024 sc1
  v_smfmac_f32_16x16x64_bf16 v[96:99], v[8:11], a[80:87], v190
  v_smfmac_f32_16x16x64_bf16 v[84:87], v[12:15], a[16:23], v190
  v_smfmac_f32_16x16x64_bf16 v[88:91], v[12:15], a[40:47], v190
  v_smfmac_f32_16x16x64_bf16 v[92:95], v[12:15], a[64:71], v190
  buffer_load_dwordx4 a[104:107], v184, s[8:11], s45 offen offset:2048 sc1
  v_smfmac_f32_16x16x64_bf16 v[96:99], v[12:15], a[88:95], v190
  s_cmp_eq_u32 s25, 63
  s_cbranch_scc1 w_last
  s_nop 1
  v_cvt_pk_bf16_f32 v100, v84, v85
  v_cvt_pk_bf16_f32 v101, v86, v87
  v_cvt_pk_bf16_f32 v104, v92, v93
  v_cvt_pk_bf16_f32 v105, v94, v95
  v_cvt_pk_bf16_f32 v102, v88, v89
  v_cvt_pk_bf16_f32 v103, v90, v91
  v_cvt_pk_bf16_f32 v106, v96, v97
  v_cvt_pk_bf16_f32 v107, v98, v99
  buffer_load_dwordx4 a[108:111], v184, s[8:11], s45 offen offset:3072 sc1
  s_waitcnt vmcnt(7)
w_gx:
  v_pk_add_f32 v[64:65], v[20:21], v[24:25]
  v_pk_add_f32 v[66:67], v[22:23], v[26:27]
  v_pk_add_f32 v[64:65], v[64:65], v[28:29]
  v_pk_add_f32 v[66:67], v[66:67], v[30:31]
  v_cmp_u_f32 vcc, v64, v64
  v_pk_mul_f32 v[64:65], v[64:65], s[60:61]
  v_pk_mul_f32 v[66:67], v[66:67], s[60:61]
  v_exp_f32 v64, v64
  s_cbranch_vccnz w_gx_r
  v_exp_f32 v65, v65
  v_exp_f32 v66, v66
  v_exp_f32 v67, v67
  s_waitcnt vmcnt(4)
w_gm:
  v_add_f32 v68, v16, v17
  v_cvt_pk_bf16_f32 v140, v64, v65
  v_cvt_pk_bf16_f32 v141, v66, v67
  v_add_f32 v68, v68, v18
  v_cmp_u_f32 vcc, v68, v68
  v_mov_b32_dpp v108, v140 quad_perm:[0,1,2,3] row_mask:0xf bank_mask:0x3
  v_mov_b32_dpp v109, v141 quad_perm:[0,1,2,3] row_mask:0xf bank_mask:0x3
  v_mul_f32 v68, s60, v68
  v_mov_b32_dpp v110, v140 row_ror:8 row_mask:0xf bank_mask:0x3
  v_mov_b32_dpp v111, v141 row_ror:8 row_mask:0xf bank_mask:0x3
  v_exp_f32 v68, v68
  s_cbranch_vccnz w_gm_r
  v_mfma_f32_16x16x32_bf16 v[72:75], v[80:83], v[108:111], 0
  buffer_load_dwordx4 a[112:115], v184, s[8:11], s46 offen offset:0 sc1
  v_mov_b32_dpp v112, v140 row_ror:8 row_mask:0xf bank_mask:0xc
  v_mov_b32_dpp v113, v141 row_ror:8 row_mask:0xf bank_mask:0xc
  v_mov_b32_dpp v114, v140 quad_perm:[0,1,2,3] row_mask:0xf bank_mask:0xc
  v_mov_b32_dpp v115, v141 quad_perm:[0,1,2,3] row_mask:0xf bank_mask:0xc
  v_mfma_f32_16x16x32_bf16 v[132:135], v[32:35], v[108:111], 0
  v_mov_b32_dpp v69, v68 row_ror:8 row_mask:0xf bank_mask:0xf
  v_cvt_pk_bf16_f32 v142, v68, v69
  v_mfma_f32_16x16x32_bf16 v[136:139], v[40:43], v[108:111], 0
  s_nop 0
  v_mov_b32_dpp v116, v142 quad_perm:[0,1,2,3] row_mask:0xf bank_mask:0x3
  v_mov_b32_dpp v117, v142 quad_perm:[0,1,2,3] row_mask:0xf bank_mask:0x3
  v_mfma_f32_16x16x32_bf16 v[132:135], v[36:39], v[112:115], v[132:135]
  v_mov_b32_dpp v118, v142 row_ror:8 row_mask:0xf bank_mask:0xc
  v_mov_b32_dpp v119, v142 row_ror:8 row_mask:0xf bank_mask:0xc
  v_mfma_f32_16x16x32_bf16 v[136:139], v[44:47], v[112:115], v[136:139]
  v_mfma_f32_16x16x16_bf16 v[72:75], v[122:123], v[116:117], v[72:75]
  buffer_load_dwordx4 a[116:119], v184, s[8:11], s46 offen offset:1024 sc1
  buffer_store_dwordx4 v[176:179], v197, s[8:11], s41 offen sc1
  v_mfma_f32_16x16x16_bf16 v[132:135], v[100:101], v[116:117], v[132:135]
  s_nop 1
  v_mfma_f32_16x16x16_bf16 v[136:139], v[104:105], v[116:117], v[136:139]
  v_mfma_f32_16x16x16_bf16 v[132:135], v[102:103], v[118:119], v[132:135]
  s_nop 0
  v_subrev_u32 v203, 0x21800000, v72
  v_rcp_f32 v120, v72
  v_mfma_f32_16x16x16_bf16 v[136:139], v[106:107], v[118:119], v[136:139]
  v_cmp_lt_u32 vcc, 0x50000000, v203
  ds_write_b32 v192, v120
  s_and_b64 vcc, vcc, s[58:59]
  s_cbranch_vccnz w_gz_r
w_gz:
  s_nop 0
  ds_write_b128 v186, v[132:135] offset:0
  s_nop 2
  ds_write_b128 v186, v[136:139] offset:1024
  s_waitcnt lgkmcnt(0)
  s_barrier
  ds_read_b128 v[100:103], v193
  ds_read_b64 v[124:125], v187 offset:0
  ds_read_b64 v[126:127], v187 offset:2048
  ds_read_b64 v[128:129], v187 offset:4096
  ds_read_b64 v[130:131], v187 offset:6144
  s_waitcnt lgkmcnt(3)
  v_pk_mul_f32 v[120:121], v[124:125], v[100:101] op_sel_hi:[1,0]
  s_waitcnt lgkmcnt(2)
  v_pk_fma_f32 v[120:121], v[126:127], v[100:101], v[120:121] op_sel:[0,1,0]
  s_waitcnt lgkmcnt(1)
  v_pk_fma_f32 v[120:121], v[128:129], v[102:103], v[120:121] op_sel_hi:[1,0,1]
  s_waitcnt lgkmcnt(0)
  v_pk_fma_f32 v[120:121], v[130:131], v[102:103], v[120:121] op_sel:[0,1,0]
  v_cvt_pk_bf16_f32 v120, v120, v121
  buffer_store_dword v120, v185, s[8:11], s53 offen sc1
  buffer_store_dword v120, v185, s[8:11], s52 offen sc1
  v_mfma_f32_16x16x32_bf16 v[168:171], a[144:147], a[176:179], 0
  v_pk_add_f32 v[84:85], v[84:85], v[86:87]
  v_pk_add_f32 v[88:89], v[88:89], v[90:91]
  v_pk_add_f32 v[92:93], v[92:93], v[94:95]
  v_mfma_f32_16x16x32_bf16 v[172:175], a[148:151], a[176:179], 0
  v_pk_add_f32 v[96:97], v[96:97], v[98:99]
  v_cvt_pk_bf16_f32 v72, v84, v85
  v_cvt_pk_bf16_f32 v73, v88, v89
  buffer_load_dwordx4 a[120:123], v184, s[8:11], s47 offen offset:0 sc1
  v_mfma_f32_16x16x32_bf16 v[168:171], a[152:155], a[180:183], v[168:171]
  v_cvt_pk_bf16_f32 v74, v92, v93
  v_cvt_pk_bf16_f32 v75, v96, v97
  v_mfma_f32_16x16x32_bf16 v[172:175], a[156:159], a[180:183], v[172:175]
  ds_write_b128 v201, v[72:75]
  v_mov_b32 v84, 0
  v_mov_b32 v85, 0
  v_mfma_f32_16x16x32_bf16 v[168:171], a[160:163], a[184:187], v[168:171]
  v_mov_b32 v86, 0
  v_mov_b32 v87, 0
  v_mov_b32 v88, 0
  v_mfma_f32_16x16x32_bf16 v[172:175], a[164:167], a[184:187], v[172:175]
  v_mov_b32 v89, 0
  v_mov_b32 v90, 0
  v_mov_b32 v91, 0
  buffer_load_dwordx4 a[124:127], v184, s[8:11], s47 offen offset:1024 sc1
  v_mfma_f32_16x16x32_bf16 v[168:171], a[168:171], a[188:191], v[168:171]
  v_mov_b32 v92, 0
  v_mov_b32 v93, 0
  v_mfma_f32_16x16x32_bf16 v[172:175], a[172:175], a[188:191], v[172:175]
  v_mov_b32 v94, 0
  v_mov_b32 v95, 0
  v_mov_b32 v96, 0
  v_mfma_f32_16x16x32_bf16 v[168:171], v[160:163], a[192:195], v[168:171]
  v_mov_b32 v97, 0
  v_mov_b32 v98, 0
  v_mov_b32 v99, 0
  v_mfma_f32_16x16x32_bf16 v[172:175], v[164:167], a[192:195], v[172:175]
  s_waitcnt vmcnt(5)
  buffer_load_dwordx4 a[128:131], v184, s[8:11], s47 offen offset:2048 sc1
  v_mfma_f32_16x16x32_bf16 v[48:51], a[96:99], a[0:3], 0
  v_mfma_f32_16x16x32_bf16 v[52:55], a[96:99], a[24:27], 0
  v_cvt_pk_bf16_f32 v176, v168, v169
  v_cvt_pk_bf16_f32 v177, v170, v171
  v_mfma_f32_16x16x32_bf16 v[56:59], a[96:99], a[48:51], 0
  s_nop 0
  v_cvt_pk_bf16_f32 v178, v172, v173
  v_cvt_pk_bf16_f32 v179, v174, v175
  v_mfma_f32_16x16x32_bf16 v[60:63], a[96:99], a[72:75], 0
  buffer_load_dwordx4 a[132:135], v184, s[8:11], s47 offen offset:3072 sc1
  v_mfma_f32_16x16x32_bf16 v[48:51], a[100:103], a[4:7], v[48:51]
  v_mfma_f32_16x16x32_bf16 v[52:55], a[100:103], a[28:31], v[52:55]
  v_mfma_f32_16x16x32_bf16 v[56:59], a[100:103], a[52:55], v[56:59]
  v_mfma_f32_16x16x32_bf16 v[60:63], a[100:103], a[76:79], v[60:63]
  buffer_load_dwordx4 a[136:139], v184, s[8:11], s48 offen offset:0 sc1
  v_mfma_f32_16x16x32_bf16 v[48:51], a[104:107], a[8:11], v[48:51]
  v_mfma_f32_16x16x32_bf16 v[52:55], a[104:107], a[32:35], v[52:55]
  v_mfma_f32_16x16x32_bf16 v[56:59], a[104:107], a[56:59], v[56:59]
  v_mfma_f32_16x16x32_bf16 v[60:63], a[104:107], a[80:83], v[60:63]
  buffer_load_dwordx4 a[140:143], v184, s[8:11], s48 offen offset:1024 sc1
  v_mfma_f32_16x16x32_bf16 v[48:51], a[108:111], a[12:15], v[48:51]
  v_mfma_f32_16x16x32_bf16 v[52:55], a[108:111], a[36:39], v[52:55]
  v_mfma_f32_16x16x32_bf16 v[56:59], a[108:111], a[60:63], v[56:59]
  v_mfma_f32_16x16x32_bf16 v[60:63], a[108:111], a[84:87], v[60:63]
  v_mfma_f32_16x16x32_bf16 v[48:51], a[112:115], a[16:19], v[48:51]
  v_mfma_f32_16x16x32_bf16 v[52:55], a[112:115], a[40:43], v[52:55]
  v_mfma_f32_16x16x32_bf16 v[56:59], a[112:115], a[64:67], v[56:59]
  v_mfma_f32_16x16x32_bf16 v[60:63], a[112:115], a[88:91], v[60:63]
  v_mfma_f32_16x16x32_bf16 v[48:51], a[116:119], a[20:23], v[48:51]
  v_mfma_f32_16x16x32_bf16 v[52:55], a[116:119], a[44:47], v[52:55]
  v_mfma_f32_16x16x32_bf16 v[56:59], a[116:119], a[68:71], v[56:59]
  v_mfma_f32_16x16x32_bf16 v[60:63], a[116:119], a[92:95], v[60:63]
  s_nop 2
  s_nop 3
  v_cvt_pk_bf16_f32 v32, v48, v49
  v_cvt_pk_bf16_f32 v33, v50, v51
  s_nop 1
  v_cvt_pk_bf16_f32 v36, v52, v53
  v_cvt_pk_bf16_f32 v37, v54, v55
  s_nop 1
  v_cvt_pk_bf16_f32 v40, v56, v57
  v_cvt_pk_bf16_f32 v41, v58, v59
  s_nop 1
  v_cvt_pk_bf16_f32 v44, v60, v61
  v_cvt_pk_bf16_f32 v45, v62, v63
  s_add_u32 s25, s25, 1
  s_waitcnt vmcnt(0)
  s_cmp_lg_u32 s25, 63
  s_cbranch_scc1 w_loop
  s_add_u32 s27, s41, 327680
  s_nop 15
  buffer_store_dwordx4 v[176:179], v197, s[8:11], s27 offen sc1
  s_branch w_loop
w_last:
  s_add_u32 s41, s41, 327680
  s_nop 0
  v_pk_add_f32 v[84:85], v[84:85], v[86:87]
  v_pk_add_f32 v[88:89], v[88:89], v[90:91]
  v_pk_add_f32 v[92:93], v[92:93], v[94:95]
  s_nop 0
  v_pk_add_f32 v[96:97], v[96:97], v[98:99]
  v_cvt_pk_bf16_f32 v72, v84, v85
  v_cvt_pk_bf16_f32 v73, v88, v89
  v_cvt_pk_bf16_f32 v74, v92, v93
  v_cvt_pk_bf16_f32 v75, v96, v97
  ds_write_b128 v201, v[72:75]
  s_waitcnt vmcnt(0) lgkmcnt(0)
  s_barrier
  s_branch w_tail1
w_tail:
  s_add_u32 s27, s25, 2
  s_and_b32 s27, s27, 3
  s_mul_i32 s28, s27, 24576
  s_add_u32 s49, s39, s28
  s_add_u32 s50, s49, 4096
  s_add_u32 s51, s40, s28
  s_lshl_b32 s28, s27, 14
  v_add_u32 v208, s28, v212
  v_add_u32 v209, s28, v213
  s_lshl_b32 s28, s27, 12
  v_add_u32 v199, s28, v198
  v_add_u32 v216, s28, v217
  ds_read_b128 a[144:147], v208 offset:0
  ds_read_b128 a[148:151], v209 offset:0
  ds_read_b128 a[152:155], v208 offset:4096
  ds_read_b128 a[156:159], v209 offset:4096
  ds_read_b128 a[160:163], v208 offset:8192
  ds_read_b128 a[164:167], v209 offset:8192
  ds_read_b128 a[168:171], v208 offset:12288
  ds_read_b128 a[172:175], v209 offset:12288
  ds_read2st64_b32 v[160:161], v199 offset0:0 offset1:4
  ds_read2st64_b32 v[162:163], v199 offset0:8 offset1:12
  ds_read2st64_b32 v[164:165], v216 offset0:0 offset1:4
  ds_read2st64_b32 v[166:167], v216 offset0:8 offset1:12
  s_sub_u32 s43, s25, 1
  s_mov_b32 s26, 0
pw_75:
  buffer_load_dword v191, v189, s[8:11], 0 offen sc1
  s_add_u32 s26, s26, 1
  s_cmp_gt_u32 s26, 65536
  s_cbranch_scc1 role_abort
  s_waitcnt vmcnt(0)
pc_77:
  v_cmp_gt_u32 vcc, s43, v191
  s_nop 0
  s_and_b32 vcc_lo, vcc_lo, 0x3c0
  s_and_b32 vcc_hi, vcc_hi, 0x0
  s_cmp_eq_u64 vcc, 0
  s_cbranch_scc1 po_76
  s_sleep 1
  s_branch pw_75
po_76:
  buffer_load_dwordx4 a[176:179], v184, s[8:11], s49 offen offset:0 sc1
  buffer_load_dwordx4 a[180:183], v184, s[8:11], s49 offen offset:2048 sc1
  buffer_load_dwordx4 a[184:187], v184, s[8:11], s50 offen offset:0 sc1
  buffer_load_dwordx4 a[188:191], v184, s[8:11], s50 offen offset:2048 sc1
  buffer_load_dwordx4 a[192:195], v184, s[8:11], s51 offen sc1
w_tail1:
  s_mov_b64 exec, 1
  buffer_store_dword v202, v196, s[8:11], s42 offen sc1
  s_mov_b64 exec, -1
  s_add_u32 s42, s42, 16384
  s_waitcnt lgkmcnt(0)
  s_waitcnt vmcnt(5)
  v_mfma_f32_16x16x32_bf16 v[168:171], a[144:147], a[176:179], 0
  v_mfma_f32_16x16x32_bf16 v[172:175], a[148:151], a[176:179], 0
  s_waitcnt vmcnt(4)
  v_mfma_f32_16x16x32_bf16 v[168:171], a[152:155], a[180:183], v[168:171]
  v_mfma_f32_16x16x32_bf16 v[172:175], a[156:159], a[180:183], v[172:175]
  s_waitcnt vmcnt(3)
  v_mfma_f32_16x16x32_bf16 v[168:171], a[160:163], a[184:187], v[168:171]
  v_mfma_f32_16x16x32_bf16 v[172:175], a[164:167], a[184:187], v[172:175]
  s_waitcnt vmcnt(2)
  v_mfma_f32_16x16x32_bf16 v[168:171], a[168:171], a[188:191], v[168:171]
  v_mfma_f32_16x16x32_bf16 v[172:175], a[172:175], a[188:191], v[172:175]
  s_waitcnt vmcnt(1)
  v_mfma_f32_16x16x32_bf16 v[168:171], v[160:163], a[192:195], v[168:171]
  v_mfma_f32_16x16x32_bf16 v[172:175], v[164:167], a[192:195], v[172:175]
  s_nop 6
  v_cvt_pk_bf16_f32 v176, v168, v169
  v_cvt_pk_bf16_f32 v177, v170, v171
  v_cvt_pk_bf16_f32 v178, v172, v173
  v_cvt_pk_bf16_f32 v179, v174, v175
  buffer_store_dwordx4 v[176:179], v197, s[8:11], s41 offen sc1
  s_add_u32 s41, s41, 327680
  s_add_u32 s25, s25, 1
  s_cmp_lt_u32 s25, 66
  s_cbranch_scc1 w_tail
  s_waitcnt vmcnt(0)
  s_mov_b64 exec, 1
  buffer_store_dword v202, v196, s[8:11], s42 offen sc1
  s_mov_b64 exec, -1
  s_endpgm
we_74_r:
  s_sleep 1
  buffer_load_dword v191, v189, s[8:11], 0 offen sc1
  s_add_u32 s26, s26, 1
  s_cmp_gt_u32 s26, 65536
  s_cbranch_scc1 chain_abort
  s_waitcnt vmcnt(0)
  s_branch we_74
w_gx_r:
  v_max3_u32 v205, v20, v21, v22
  v_max_u32 v205, v205, v23
  v_cmp_eq_u32 vcc, -1, v205
  s_cbranch_vccz w_gx_s0
  s_mov_b64 exec, vcc
  buffer_load_dwordx4 v[20:23], v184, s[8:11], s34 offen offset:0 sc1
  s_mov_b64 exec, -1
w_gx_s0:
  v_max3_u32 v205, v24, v25, v26
  v_max_u32 v205, v205, v27
  v_cmp_eq_u32 vcc, -1, v205
  s_cbranch_vccz w_gx_s1
  s_mov_b64 exec, vcc
  buffer_load_dwordx4 v[24:27], v184, s[8:11], s34 offen offset:1024 sc1
  s_mov_b64 exec, -1
w_gx_s1:
  v_max3_u32 v205, v28, v29, v30
  v_max_u32 v205, v205, v31
  v_cmp_eq_u32 vcc, -1, v205
  s_cbranch_vccz w_gx_s2
  s_mov_b64 exec, vcc
  buffer_load_dwordx4 v[28:31], v184, s[8:11], s34 offen offset:2048 sc1
  s_mov_b64 exec, -1
w_gx_s2:
  buffer_load_dword v16, v185, s[8:11], s34 offen offset:3072 sc1
  buffer_load_dword v17, v185, s[8:11], s34 offen offset:3328 sc1
  buffer_load_dword v18, v185, s[8:11], s34 offen offset:3584 sc1
  s_add_u32 s26, s26, 1
  s_cmp_gt_u32 s26, 65536
  s_cbranch_scc1 chain_abort
  s_waitcnt vmcnt(0)
  s_branch w_gx
w_gm_r:
  v_max3_u32 v205, v16, v17, v18
  v_cmp_eq_u32 vcc, -1, v205
  s_cbranch_vccz w_gm_s0
  s_mov_b64 exec, vcc
  buffer_load_dword v16, v185, s[8:11], s34 offen offset:3072 sc1
  buffer_load_dword v17, v185, s[8:11], s34 offen offset:3328 sc1
  buffer_load_dword v18, v185, s[8:11], s34 offen offset:3584 sc1
  s_mov_b64 exec, -1
w_gm_s0:
  s_add_u32 s26, s26, 1
  s_cmp_gt_u32 s26, 65536
  s_cbranch_scc1 chain_abort
  s_waitcnt vmcnt(0)
  s_branch w_gm
w_gv_r:
  v_max3_u32 v205, v4, v5, v6
  v_max_u32 v205, v205, v7
  v_cmp_eq_u32 vcc, -1, v205
  s_cbranch_vccz w_gv_s0
  s_mov_b64 exec, vcc
  buffer_load_dwordx4 v[4:7], v184, s[8:11], s35 offen offset:0 sc1
  s_mov_b64 exec, -1
w_gv_s0:
  v_max3_u32 v205, v8, v9, v10
  v_max_u32 v205, v205, v11
  v_cmp_eq_u32 vcc, -1, v205
  s_cbranch_vccz w_gv_s1
  s_mov_b64 exec, vcc
  buffer_load_dwordx4 v[8:11], v184, s[8:11], s35 offen offset:1024 sc1
  s_mov_b64 exec, -1
w_gv_s1:
  v_max3_u32 v205, v12, v13, v14
  v_max_u32 v205, v205, v15
  v_cmp_eq_u32 vcc, -1, v205
  s_cbranch_vccz w_gv_s2
  s_mov_b64 exec, vcc
  buffer_load_dwordx4 v[12:15], v184, s[8:11], s35 offen offset:2048 sc1
  s_mov_b64 exec, -1
w_gv_s2:
  buffer_load_dwordx4 v[20:23], v184, s[8:11], s34 offen offset:0 sc1
  buffer_load_dwordx4 v[24:27], v184, s[8:11], s34 offen offset:1024 sc1
  buffer_load_dwordx4 v[28:31], v184, s[8:11], s34 offen offset:2048 sc1
  buffer_load_dword v16, v185, s[8:11], s34 offen offset:3072 sc1
  buffer_load_dword v17, v185, s[8:11], s34 offen offset:3328 sc1
  buffer_load_dword v18, v185, s[8:11], s34 offen offset:3584 sc1
  s_add_u32 s26, s26, 1
  s_cmp_gt_u32 s26, 65536
  s_cbranch_scc1 chain_abort
  s_waitcnt vmcnt(0)
  s_branch w_gv
w_gz_r:
  v_pk_add_f32 v[64:65], v[20:21], v[24:25]
  v_pk_add_f32 v[66:67], v[22:23], v[26:27]
  v_pk_add_f32 v[64:65], v[64:65], v[28:29]
  v_pk_add_f32 v[66:67], v[66:67], v[30:31]
  v_add_f32 v68, v16, v17
  v_add_f32 v68, v68, v18
  v_max3_f32 v203, v64, v65, v66
  v_max3_f32 v203, v203, v67, v68
  s_nop 1
  v_max_f32_dpp v203, v203, v203 row_ror:8 row_mask:0xf bank_mask:0xf
  v_mov_b32 v204, v203
  s_nop 1
  v_permlane16_swap_b32 v203, v204
  v_max_f32 v203, v203, v204
  v_mov_b32 v204, v203
  s_nop 1
  v_permlane32_swap_b32 v203, v204
  v_max_f32 v203, v203, v204
  v_sub_f32 v64, v64, v203
  v_mul_f32 v64, s60, v64
  v_exp_f32 v64, v64
  v_sub_f32 v65, v65, v203
  v_mul_f32 v65, s60, v65
  v_exp_f32 v65, v65
  v_sub_f32 v66, v66, v203
  v_mul_f32 v66, s60, v66
  v_exp_f32 v66, v66
  v_sub_f32 v67, v67, v203
  v_mul_f32 v67, s60, v67
  v_exp_f32 v67, v67
  v_sub_f32 v68, v68, v203
  v_mul_f32 v68, s60, v68
  v_exp_f32 v68, v68
  v_cvt_pk_bf16_f32 v140, v64, v65
  v_cvt_pk_bf16_f32 v141, v66, v67
  s_nop 0
  v_mov_b32_dpp v108, v140 quad_perm:[0,1,2,3] row_mask:0xf bank_mask:0x3
  v_mov_b32_dpp v109, v141 quad_perm:[0,1,2,3] row_mask:0xf bank_mask:0x3
  v_mov_b32_dpp v110, v140 row_ror:8 row_mask:0xf bank_mask:0x3
  v_mov_b32_dpp v111, v141 row_ror:8 row_mask:0xf bank_mask:0x3
  v_mov_b32_dpp v112, v140 row_ror:8 row_mask:0xf bank_mask:0xc
  v_mov_b32_dpp v113, v141 row_ror:8 row_mask:0xf bank_mask:0xc
  v_mov_b32_dpp v114, v140 quad_perm:[0,1,2,3] row_mask:0xf bank_mask:0xc
  v_mov_b32_dpp v115, v141 quad_perm:[0,1,2,3] row_mask:0xf bank_mask:0xc
  v_mov_b32_dpp v69, v68 row_ror:8 row_mask:0xf bank_mask:0xf
  v_cvt_pk_bf16_f32 v142, v68, v69
  s_nop 1
  v_mov_b32_dpp v116, v142 quad_perm:[0,1,2,3] row_mask:0xf bank_mask:0x3
  v_mov_b32_dpp v117, v142 quad_perm:[0,1,2,3] row_mask:0xf bank_mask:0x3
  v_mov_b32_dpp v118, v142 row_ror:8 row_mask:0xf bank_mask:0xc
  v_mov_b32_dpp v119, v142 row_ror:8 row_mask:0xf bank_mask:0xc
  v_mfma_f32_16x16x32_bf16 v[72:75], v[80:83], v[108:111], 0
  v_mfma_f32_16x16x32_bf16 v[132:135], v[32:35], v[108:111], 0
  v_mfma_f32_16x16x32_bf16 v[136:139], v[40:43], v[108:111], 0
  v_mfma_f32_16x16x32_bf16 v[132:135], v[36:39], v[112:115], v[132:135]
  v_mfma_f32_16x16x32_bf16 v[136:139], v[44:47], v[112:115], v[136:139]
  s_nop 1
  v_mfma_f32_16x16x16_bf16 v[72:75], v[122:123], v[116:117], v[72:75]
  s_nop 1
  v_mfma_f32_16x16x16_bf16 v[132:135], v[100:101], v[116:117], v[132:135]
  v_mfma_f32_16x16x16_bf16 v[136:139], v[104:105], v[116:117], v[136:139]
  v_mfma_f32_16x16x16_bf16 v[132:135], v[102:103], v[118:119], v[132:135]
  v_mfma_f32_16x16x16_bf16 v[136:139], v[106:107], v[118:119], v[136:139]
  s_nop 1
  v_rcp_f32 v120, v72
  s_nop 0
  ds_write_b32 v192, v120
  s_branch w_gz
.section .rodata,"a"
.p2align 6
.amdhsa_kernel main_kernel
  .amdhsa_next_free_vgpr 512
  .amdhsa_next_free_sgpr 102
  .amdhsa_accum_offset 256
  .amdhsa_group_segment_fixed_size 0
  .amdhsa_kernarg_size 136
  .amdhsa_user_sgpr_count 2
  .amdhsa_user_sgpr_kernarg_segment_ptr 1
  .amdhsa_system_sgpr_workgroup_id_x 1
.end_amdhsa_kernel
```

```asm
; @launch kernel=main_kernel grid=(256,1,1) block=(256,1,1) lds=163840
.amdgcn_target "amdgcn-amd-amdhsa--gfx950"
.text
.globl main_kernel
.p2align 8
.type main_kernel,@function
main_kernel:
  s_load_dwordx2 s[8:9], s[0:1], 128
  s_mov_b32 s10, 268435456
  s_mov_b32 s11, 0x00020000
  s_load_dwordx2 s[12:13], s[0:1], 120
  s_mov_b32 s14, 256
  s_mov_b32 s15, 0x00020000
  s_load_dword s4, s[0:1], 0
  s_load_dword s5, s[0:1], 64
  s_getreg_b32 s16, hwreg(HW_REG_XCC_ID)
  s_and_b32 s16, s16, 7
  v_and_b32 v1, 63, v0
  v_lshrrev_b32 v2, 6, v0
  s_nop 0
  v_readfirstlane_b32 s17, v2
  v_mov_b32 v3, 1
  s_lshl_b32 s3, s16, 2
  v_mov_b32 v4, s3
  v_mov_b32 v5, 0
  s_waitcnt lgkmcnt(0)
  v_cmp_eq_u32 vcc, 0, v0
  s_nop 0
  s_and_b64 exec, exec, vcc
  s_cbranch_execz main_tk
  buffer_atomic_add v3, v4, s[12:15], 0 offen sc0
  s_waitcnt vmcnt(0)
  ds_write_b32 v5, v3
  s_waitcnt lgkmcnt(0)
main_tk:
  s_mov_b64 exec, -1
  s_barrier
  ds_read_b32 v3, v5
  s_waitcnt lgkmcnt(0)
  v_readfirstlane_b32 s18, v3
  s_barrier
  s_cmp_ge_u32 s18, 32
  s_cbranch_scc1 role_none
  s_sub_u32 s18, 31, s18
  s_cmp_lt_u32 s18, 18
  s_cbranch_scc1 role_b
  s_cmp_lt_u32 s18, 27
  s_cbranch_scc1 role_w
  s_cmp_gt_u32 s18, 28
  s_cbranch_scc1 role_r
  s_sub_u32 s20, 28, s18
  s_lshl_b32 s20, s20, 2
  s_add_u32 s20, s20, s17
  s_load_dwordx2 s[24:25], s[0:1], 8
  s_mov_b32 s26, 10240
  s_mov_b32 s27, 0x00020000
  v_lshlrev_b32 v2, 4, v1
  v_lshlrev_b32 v3, 7, v1
  v_mov_b32 v4, -1
  v_mov_b32 v5, -1
  v_mov_b32 v6, -1
  v_mov_b32 v7, -1
  v_mov_b32 v8, 0
  v_mov_b32 v9, 0
  v_mov_b32 v10, 0
  v_mov_b32 v11, 0
  v_lshrrev_b32 v12, 4, v1
  v_and_b32 v13, 15, v1
  v_lshlrev_b32 v13, 4, v13
  v_lshl_add_u32 v14, v12, 12, v13
  v_lshl_add_u32 v15, v12, 11, v13
  s_lshl_b32 s28, s16, 8
  s_cmp_lg_u32 s20, 4
  s_cbranch_scc1 boot_nf
  buffer_load_dwordx4 v[40:43], v14, s[8:11], s28 offen sc1
  s_waitcnt vmcnt(0)
  buffer_store_dwordx4 v[8:11], v14, s[8:11], s28 offen
  s_lshl_b32 s30, s16, 2
  s_add_u32 s30, s30, 32
  v_mov_b32 v16, s30
  v_mov_b32 v17, 1
  s_waitcnt vmcnt(0)
  s_mov_b64 exec, 1
  buffer_atomic_add v17, v16, s[12:15], 0 offen
  s_mov_b64 exec, -1
boot_nf:
  s_lshl_b32 s29, s16, 17
  s_lshl_b32 s30, s20, 14
  s_add_u32 s29, s29, s30
  s_add_u32 s29, s29, 3407872
  buffer_load_dword v44, v3, s[8:11], s29 offen sc1
  s_add_u32 s30, s29, 8192
  buffer_load_dword v45, v3, s[8:11], s30 offen sc1
  v_bfe_u32 v13, v1, 5, 1
  v_lshlrev_b32 v12, 6, v13
  v_bfe_u32 v13, v1, 4, 1
  v_lshl_add_u32 v12, v13, 4, v12
  v_bfe_u32 v13, v1, 1, 1
  v_lshl_add_u32 v12, v13, 2, v12
  v_bfe_u32 v13, v1, 2, 2
  v_lshlrev_b32 v13, 1, v13
  v_and_b32 v18, 1, v1
  v_add_u32 v13, v13, v18
  v_mul_u32_u24 v13, 1280, v13
  v_add_u32 v12, v12, v13
  s_waitcnt lgkmcnt(0)
  s_mov_b32 s31, s20
  s_lshl_b32 s30, s31, 7
  buffer_load_dword v20, v12, s[24:27], s30 offen
  buffer_load_dword v21, v12, s[24:27], s30 offen offset:32
  buffer_load_dword v22, v12, s[24:27], s30 offen offset:8
  buffer_load_dword v23, v12, s[24:27], s30 offen offset:40
  s_lshl_b32 s31, s31, 10
  s_mul_i32 s30, s16, 10240
  s_add_u32 s32, s31, s30
  s_add_u32 s32, s32, 131072
  s_add_u32 s33, s32, 81920
  buffer_load_dwordx4 v[46:49], v2, s[8:11], s32 offen sc1
  buffer_load_dwordx4 v[50:53], v2, s[8:11], s33 offen sc1
  s_add_u32 s36, s32, 163840
  s_add_u32 s37, s32, 245760
  buffer_load_dwordx4 v[46:49], v2, s[8:11], s36 offen sc1
  buffer_load_dwordx4 v[50:53], v2, s[8:11], s37 offen sc1
  s_add_u32 s31, s20, 8
  s_min_u32 s31, s31, 9
  s_lshl_b32 s30, s31, 7
  buffer_load_dword v24, v12, s[24:27], s30 offen
  buffer_load_dword v25, v12, s[24:27], s30 offen offset:32
  buffer_load_dword v26, v12, s[24:27], s30 offen offset:8
  buffer_load_dword v27, v12, s[24:27], s30 offen offset:40
  s_lshl_b32 s31, s31, 10
  s_mul_i32 s30, s16, 10240
  s_add_u32 s34, s31, s30
  s_add_u32 s34, s34, 131072
  s_add_u32 s35, s34, 81920
  buffer_load_dwordx4 v[46:49], v2, s[8:11], s34 offen sc1
  buffer_load_dwordx4 v[50:53], v2, s[8:11], s35 offen sc1
  s_add_u32 s38, s34, 163840
  s_add_u32 s39, s34, 245760
  buffer_load_dwordx4 v[46:49], v2, s[8:11], s38 offen sc1
  buffer_load_dwordx4 v[50:53], v2, s[8:11], s39 offen sc1
  s_waitcnt vmcnt(0)
  buffer_store_dwordx4 v[20:23], v2, s[8:11], s32 offen
  buffer_store_dwordx4 v[4:7], v2, s[8:11], s33 offen
  buffer_store_dwordx4 v[4:7], v2, s[8:11], s36 offen
  buffer_store_dwordx4 v[4:7], v2, s[8:11], s37 offen
  buffer_store_dwordx4 v[24:27], v2, s[8:11], s34 offen
  buffer_store_dwordx4 v[4:7], v2, s[8:11], s35 offen
  buffer_store_dwordx4 v[4:7], v2, s[8:11], s38 offen
  buffer_store_dwordx4 v[4:7], v2, s[8:11], s39 offen
  buffer_store_dwordx4 v[4:7], v2, s[8:11], s29 offen offset:0
  buffer_store_dwordx4 v[4:7], v2, s[8:11], s29 offen offset:1024
  buffer_store_dwordx4 v[4:7], v2, s[8:11], s29 offen offset:2048
  buffer_store_dwordx4 v[4:7], v2, s[8:11], s29 offen offset:3072
  s_add_u32 s29, s29, 4096
  buffer_store_dwordx4 v[4:7], v2, s[8:11], s29 offen offset:0
  buffer_store_dwordx4 v[4:7], v2, s[8:11], s29 offen offset:1024
  buffer_store_dwordx4 v[4:7], v2, s[8:11], s29 offen offset:2048
  buffer_store_dwordx4 v[4:7], v2, s[8:11], s29 offen offset:3072
  s_add_u32 s29, s29, 4096
  buffer_store_dwordx4 v[4:7], v2, s[8:11], s29 offen offset:0
  buffer_store_dwordx4 v[4:7], v2, s[8:11], s29 offen offset:1024
  buffer_store_dwordx4 v[4:7], v2, s[8:11], s29 offen offset:2048
  buffer_store_dwordx4 v[4:7], v2, s[8:11], s29 offen offset:3072
  s_add_u32 s29, s29, 4096
  buffer_store_dwordx4 v[4:7], v2, s[8:11], s29 offen offset:0
  buffer_store_dwordx4 v[4:7], v2, s[8:11], s29 offen offset:1024
  buffer_store_dwordx4 v[4:7], v2, s[8:11], s29 offen offset:2048
  buffer_store_dwordx4 v[4:7], v2, s[8:11], s29 offen offset:3072
  s_add_u32 s29, s29, 4096
  s_mul_i32 s30, s20, 81920
  s_add_u32 s30, s30, s28
  s_add_u32 s30, s30, 16777216
  buffer_store_dwordx4 v[4:7], v15, s[8:11], s30 offen sc1
  s_add_u32 s30, s30, 8192
  buffer_store_dwordx4 v[4:7], v15, s[8:11], s30 offen sc1
  s_add_u32 s30, s30, 8192
  buffer_store_dwordx4 v[4:7], v15, s[8:11], s30 offen sc1
  s_add_u32 s30, s30, 8192
  buffer_store_dwordx4 v[4:7], v15, s[8:11], s30 offen sc1
  s_add_u32 s30, s30, 8192
  buffer_store_dwordx4 v[4:7], v15, s[8:11], s30 offen sc1
  s_add_u32 s30, s30, 8192
  buffer_store_dwordx4 v[4:7], v15, s[8:11], s30 offen sc1
  s_add_u32 s30, s30, 8192
  buffer_store_dwordx4 v[4:7], v15, s[8:11], s30 offen sc1
  s_add_u32 s30, s30, 8192
  buffer_store_dwordx4 v[4:7], v15, s[8:11], s30 offen sc1
  s_add_u32 s30, s30, 8192
  buffer_store_dwordx4 v[4:7], v15, s[8:11], s30 offen sc1
  s_add_u32 s30, s30, 8192
  buffer_store_dwordx4 v[4:7], v15, s[8:11], s30 offen sc1
  s_add_u32 s30, s30, 8192
  v_lshrrev_b32 v12, 3, v1
  v_and_b32 v13, 7, v1
  v_lshlrev_b32 v13, 4, v13
  v_lshl_add_u32 v12, v12, 10, v13
  s_lshl_b32 s30, s20, 13
  s_lshl_b32 s31, s16, 7
  s_add_u32 s30, s30, s31
  s_add_u32 s30, s30, 2162688
  buffer_store_dwordx4 v[4:7], v12, s[8:11], s30 offen sc1
  s_waitcnt vmcnt(0)
  s_barrier
  s_cmp_lg_u32 s17, 0
  s_cbranch_scc1 boot_ng
  v_mov_b32 v16, 192
  v_mov_b32 v17, 1
  s_waitcnt vmcnt(0)
  s_mov_b64 exec, 1
  buffer_atomic_add v17, v16, s[12:15], 0 offen sc1
  s_mov_b64 exec, -1
boot_ng:
  s_lshl_b32 s28, s16, 22
  s_lshl_b32 s29, s20, 13
  s_add_u32 s28, s28, s29
  s_add_u32 s28, s28, 67108864
  s_cmp_ge_u32 s20, 4
  s_cbranch_scc1 boot_nt
  s_add_u32 s29, s28, 622592
  buffer_load_dword v20, v3, s[8:11], s29 offen sc1
  s_add_u32 s29, s28, 655360
  buffer_load_dword v21, v3, s[8:11], s29 offen sc1
  s_waitcnt vmcnt(2)
  s_add_u32 s29, s28, 557056
  buffer_load_dword v22, v3, s[8:11], s29 offen sc1
  s_add_u32 s29, s28, 589824
  buffer_load_dword v23, v3, s[8:11], s29 offen sc1
  s_waitcnt vmcnt(2)
  s_add_u32 s29, s28, 294912
  buffer_load_dword v24, v3, s[8:11], s29 offen sc1
  s_add_u32 s29, s28, 327680
  buffer_load_dword v25, v3, s[8:11], s29 offen sc1
  s_waitcnt vmcnt(2)
  s_add_u32 s29, s28, 360448
  buffer_load_dword v26, v3, s[8:11], s29 offen sc1
  s_add_u32 s29, s28, 393216
  buffer_load_dword v27, v3, s[8:11], s29 offen sc1
  s_waitcnt vmcnt(2)
  s_add_u32 s29, s28, 425984
  buffer_load_dword v28, v3, s[8:11], s29 offen sc1
  s_add_u32 s29, s28, 458752
  buffer_load_dword v29, v3, s[8:11], s29 offen sc1
  s_waitcnt vmcnt(2)
  s_add_u32 s29, s28, 491520
  buffer_load_dword v30, v3, s[8:11], s29 offen sc1
  s_add_u32 s29, s28, 524288
  buffer_load_dword v31, v3, s[8:11], s29 offen sc1
  s_waitcnt vmcnt(2)
boot_nt:
  s_cmp_eq_u32 s18, 27
  s_cbranch_scc1 role_w
  s_branch role_sm
role_none:
  s_endpgm
role_abort:
  v_mov_b32 v2, 132
  v_mov_b32 v3, 1
  s_mov_b64 exec, 1
  buffer_atomic_add v3, v2, s[12:15], 0 offen
  s_endpgm
role_sm:
  v_lshlrev_b32 v166, 4, v1
  v_bfe_u32 v171, v1, 2, 2
  v_and_b32 v172, 1, v1
  v_lshl_add_u32 v171, v171, 1, v172
  v_lshrrev_b32 v172, 4, v1
  v_lshl_add_u32 v171, v172, 3, v171
  v_lshlrev_b32 v167, 4, v171
  v_and_b32 v171, 15, v1
  v_lshlrev_b32 v172, 2, v172
  v_sub_u32 v171, v171, v172
  v_mov_b32 v172, 0
  v_mov_b32 v170, 0xf149f2ca
  v_cmp_le_i32 vcc, 0, v171
  s_nop 1
  v_cndmask_b32 v148, v170, v172, vcc
  v_cmp_le_i32 vcc, 1, v171
  s_nop 1
  v_cndmask_b32 v149, v170, v172, vcc
  v_cmp_le_i32 vcc, 2, v171
  s_nop 1
  v_cndmask_b32 v150, v170, v172, vcc
  v_cmp_le_i32 vcc, 3, v171
  s_nop 1
  v_cndmask_b32 v151, v170, v172, vcc
  v_mov_b32 v160, 0x3d93cd3a
  v_mov_b32 v161, 0x3d93cd3a
  v_mov_b32 v154, 0
  v_mov_b32 v155, 0
  s_lshl_b32 s23, s16, 8
  s_lshl_b32 s24, s17, 6
  s_add_u32 s24, s24, s23
  v_and_b32 v171, 15, v1
  v_lshl_add_u32 v168, v171, 2, s24
  s_lshl_b32 s24, s17, 2
  s_add_u32 s23, s23, s24
  s_add_u32 s23, s23, 4192
  v_mov_b32 v169, s23
  s_lshl_b32 s25, s16, 22
  s_add_u32 s25, s25, 67108864
  s_mul_i32 s33, s17, 12288
  s_add_u32 s33, s33, s25
  s_mul_i32 s34, s17, 3072
  s_add_u32 s34, s34, s25
  s_add_u32 s34, s34, 589824
  s_lshl_b32 s35, s17, 11
  s_add_u32 s35, s35, s25
  s_add_u32 s35, s35, 602112
  s_add_u32 s36, s24, s25
  s_add_u32 s36, s36, 610304
  s_mov_b32 s32, 1
  v_lshlrev_b32 v179, 7, v1
  s_lshl_b32 s37, s16, 2
  s_add_u32 s37, s37, s17
  s_mul_i32 s37, s37, 10240
  s_add_u32 s37, s37, 226492416
  v_mov_b32 v170, 0
  s_waitcnt vmcnt(0)
  s_lshl_b32 s22, s16, 2
  s_add_u32 s22, s22, 32
  v_mov_b32 v171, s22
  s_mov_b32 s22, 0
  s_mov_b64 exec, 1
gw_1:
  buffer_load_dword v172, v171, s[12:15], 0 offen sc1
  s_add_u32 s22, s22, 1
  s_cmp_gt_u32 s22, 65536
  s_cbranch_scc1 role_abort
  s_waitcnt vmcnt(0)
  v_cmp_gt_u32 vcc, 1, v172
  s_cbranch_vccz gk_2
  s_sleep 8
  s_branch gw_1
gk_2:
  s_mov_b64 exec, -1
sm_loop:
  s_sub_u32 s21, s32, 1
  s_and_b32 s23, s21, 3
  s_mul_i32 s23, s23, 147456
  s_add_u32 s27, s33, s23
  s_add_u32 s28, s27, 49152
  s_and_b32 s23, s21, 3
  s_mul_i32 s23, s23, 24576
  s_add_u32 s29, s34, s23
  s_add_u32 s30, s35, s23
  s_add_u32 s31, s36, s23
  s_mov_b32 s22, 0
  s_branch pc_5
pw_3:
  buffer_load_dword v170, v168, s[8:11], 0 offen sc1
  s_add_u32 s22, s22, 1
  s_cmp_gt_u32 s22, 65536
  s_cbranch_scc1 role_abort
  s_waitcnt vmcnt(0)
pc_5:
  v_cmp_gt_u32 vcc, s32, v170
  s_nop 0
  s_and_b32 vcc_lo, vcc_lo, 0xfff
  s_and_b32 vcc_hi, vcc_hi, 0x0
  s_cmp_eq_u64 vcc, 0
  s_cbranch_scc1 po_4
  s_sleep 4
  s_branch pw_3
po_4:
  s_add_u32 s23, s28, 4096
  s_add_u32 s24, s28, 8192
  s_add_u32 s25, s27, 4096
  s_add_u32 s26, s27, 8192
  buffer_load_dwordx4 v[4:7], v166, s[8:11], s27 offen offset:0 sc1
  buffer_load_dwordx4 v[28:31], v166, s[8:11], s25 offen offset:2048 sc1
  buffer_load_dwordx4 v[52:55], v166, s[8:11], s28 offen offset:0 sc1
  buffer_load_dwordx4 v[76:79], v166, s[8:11], s23 offen offset:2048 sc1
  buffer_load_dwordx4 v[8:11], v166, s[8:11], s27 offen offset:1024 sc1
  buffer_load_dwordx4 v[32:35], v166, s[8:11], s25 offen offset:3072 sc1
  buffer_load_dwordx4 v[56:59], v166, s[8:11], s28 offen offset:1024 sc1
  buffer_load_dwordx4 v[80:83], v166, s[8:11], s23 offen offset:3072 sc1
  buffer_load_dwordx4 v[12:15], v166, s[8:11], s27 offen offset:2048 sc1
  buffer_load_dwordx4 v[36:39], v166, s[8:11], s26 offen offset:0 sc1
  buffer_load_dwordx4 v[60:63], v166, s[8:11], s28 offen offset:2048 sc1
  buffer_load_dwordx4 v[84:87], v166, s[8:11], s24 offen offset:0 sc1
  buffer_load_dwordx4 v[16:19], v166, s[8:11], s27 offen offset:3072 sc1
  buffer_load_dwordx4 v[40:43], v166, s[8:11], s26 offen offset:1024 sc1
  buffer_load_dwordx4 v[64:67], v166, s[8:11], s28 offen offset:3072 sc1
  buffer_load_dwordx4 v[88:91], v166, s[8:11], s24 offen offset:1024 sc1
  buffer_load_dwordx4 v[20:23], v166, s[8:11], s25 offen offset:0 sc1
  buffer_load_dwordx4 v[44:47], v166, s[8:11], s26 offen offset:2048 sc1
  buffer_load_dwordx4 v[68:71], v166, s[8:11], s23 offen offset:0 sc1
  buffer_load_dwordx4 v[92:95], v166, s[8:11], s24 offen offset:2048 sc1
  buffer_load_dwordx4 v[24:27], v166, s[8:11], s25 offen offset:1024 sc1
  buffer_load_dwordx4 v[48:51], v166, s[8:11], s26 offen offset:3072 sc1
  buffer_load_dwordx4 v[72:75], v166, s[8:11], s23 offen offset:1024 sc1
  buffer_load_dwordx4 v[96:99], v166, s[8:11], s24 offen offset:3072 sc1
  s_waitcnt vmcnt(20)
  v_mfma_f32_16x16x32_bf16 v[124:127], v[52:55], v[4:7], 0
  v_mfma_f32_16x16x32_bf16 v[132:135], v[52:55], v[28:31], 0
  v_mfma_f32_16x16x32_bf16 v[136:139], v[76:79], v[28:31], 0
  s_waitcnt vmcnt(16)
  v_mfma_f32_16x16x32_bf16 v[124:127], v[56:59], v[8:11], v[124:127]
  v_mfma_f32_16x16x32_bf16 v[132:135], v[56:59], v[32:35], v[132:135]
  v_mfma_f32_16x16x32_bf16 v[136:139], v[80:83], v[32:35], v[136:139]
  s_waitcnt vmcnt(12)
  v_mfma_f32_16x16x32_bf16 v[124:127], v[60:63], v[12:15], v[124:127]
  v_mfma_f32_16x16x32_bf16 v[132:135], v[60:63], v[36:39], v[132:135]
  v_mfma_f32_16x16x32_bf16 v[136:139], v[84:87], v[36:39], v[136:139]
  s_waitcnt vmcnt(8)
  v_mfma_f32_16x16x32_bf16 v[124:127], v[64:67], v[16:19], v[124:127]
  v_mfma_f32_16x16x32_bf16 v[132:135], v[64:67], v[40:43], v[132:135]
  v_mfma_f32_16x16x32_bf16 v[136:139], v[88:91], v[40:43], v[136:139]
  s_waitcnt vmcnt(4)
  v_mfma_f32_16x16x32_bf16 v[124:127], v[68:71], v[20:23], v[124:127]
  v_mfma_f32_16x16x32_bf16 v[132:135], v[68:71], v[44:47], v[132:135]
  v_mfma_f32_16x16x32_bf16 v[136:139], v[92:95], v[44:47], v[136:139]
  s_waitcnt vmcnt(0)
  v_mfma_f32_16x16x32_bf16 v[124:127], v[72:75], v[24:27], v[124:127]
  v_mfma_f32_16x16x32_bf16 v[132:135], v[72:75], v[48:51], v[132:135]
  v_mfma_f32_16x16x32_bf16 v[136:139], v[96:99], v[48:51], v[136:139]
  s_nop 5
  v_cvt_pk_bf16_f32 v173, v124, v125
  v_lshlrev_b32 v124, 16, v173
  v_and_b32 v125, 0xffff0000, v173
  v_cvt_pk_bf16_f32 v173, v126, v127
  v_lshlrev_b32 v126, 16, v173
  v_and_b32 v127, 0xffff0000, v173
  v_cvt_pk_bf16_f32 v174, v132, v133
  v_lshlrev_b32 v132, 16, v174
  v_and_b32 v133, 0xffff0000, v174
  v_cvt_pk_bf16_f32 v174, v134, v135
  v_lshlrev_b32 v134, 16, v174
  v_and_b32 v135, 0xffff0000, v174
  v_cvt_pk_bf16_f32 v174, v136, v137
  v_lshlrev_b32 v136, 16, v174
  v_and_b32 v137, 0xffff0000, v174
  v_cvt_pk_bf16_f32 v174, v138, v139
  v_lshlrev_b32 v138, 16, v174
  v_and_b32 v139, 0xffff0000, v174
  v_pk_fma_f32 v[124:125], v[124:125], v[160:161], v[148:149]
  v_cvt_pk_bf16_f32 v173, v124, v125
  v_lshlrev_b32 v124, 16, v173
  v_and_b32 v125, 0xffff0000, v173
  v_pk_fma_f32 v[126:127], v[126:127], v[160:161], v[150:151]
  v_cvt_pk_bf16_f32 v173, v126, v127
  v_lshlrev_b32 v126, 16, v173
  v_and_b32 v127, 0xffff0000, v173
  v_pk_mul_f32 v[132:133], v[132:133], v[160:161]
  v_cvt_pk_bf16_f32 v174, v132, v133
  v_lshlrev_b32 v132, 16, v174
  v_and_b32 v133, 0xffff0000, v174
  v_pk_mul_f32 v[134:135], v[134:135], v[160:161]
  v_cvt_pk_bf16_f32 v174, v134, v135
  v_lshlrev_b32 v134, 16, v174
  v_and_b32 v135, 0xffff0000, v174
  v_pk_fma_f32 v[136:137], v[136:137], v[160:161], v[148:149]
  v_cvt_pk_bf16_f32 v174, v136, v137
  v_lshlrev_b32 v136, 16, v174
  v_and_b32 v137, 0xffff0000, v174
  v_pk_fma_f32 v[138:139], v[138:139], v[160:161], v[150:151]
  v_cvt_pk_bf16_f32 v174, v138, v139
  v_lshlrev_b32 v138, 16, v174
  v_and_b32 v139, 0xffff0000, v174
  v_max3_f32 v175, v124, v125, v126
  v_max3_f32 v176, v132, v133, v134
  v_max_f32 v175, v175, v127
  v_max3_f32 v176, v176, v135, v136
  v_max3_f32 v176, v176, v137, v138
  v_max_f32 v176, v176, v139
sm_b2r:
  s_mov_b32 s22, 0
pw_6:
  buffer_load_dword v170, v168, s[8:11], 0 offen sc1
  s_add_u32 s22, s22, 1
  s_cmp_gt_u32 s22, 65536
  s_cbranch_scc1 role_abort
  s_waitcnt vmcnt(0)
pc_8:
  v_cmp_gt_u32 vcc, s32, v170
  s_nop 0
  s_and_b32 vcc_lo, vcc_lo, 0x7000
  s_and_b32 vcc_hi, vcc_hi, 0x0
  s_cmp_eq_u64 vcc, 0
  s_cbranch_scc1 po_7
  s_sleep 2
  s_branch pw_6
po_7:
  buffer_load_dwordx4 v[100:103], v167, s[8:11], s29 offen offset:0 sc1
  buffer_load_dwordx4 v[104:107], v167, s[8:11], s29 offen offset:512 sc1
  buffer_load_dwordx4 v[108:111], v167, s[8:11], s29 offen offset:1024 sc1
  buffer_load_dwordx4 v[112:115], v167, s[8:11], s29 offen offset:1536 sc1
  buffer_load_dwordx4 v[116:119], v167, s[8:11], s29 offen offset:2048 sc1
  buffer_load_dwordx4 v[120:123], v167, s[8:11], s29 offen offset:2560 sc1
  s_waitcnt vmcnt(5)
  v_mfma_f32_16x16x32_bf16 v[140:143], v[100:103], v[4:7], 0
  v_mfma_f32_16x16x32_bf16 v[144:147], v[100:103], v[28:31], 0
  s_waitcnt vmcnt(4)
  v_mfma_f32_16x16x32_bf16 v[140:143], v[104:107], v[8:11], v[140:143]
  v_mfma_f32_16x16x32_bf16 v[144:147], v[104:107], v[32:35], v[144:147]
  s_waitcnt vmcnt(3)
  v_mfma_f32_16x16x32_bf16 v[140:143], v[108:111], v[12:15], v[140:143]
  v_mfma_f32_16x16x32_bf16 v[144:147], v[108:111], v[36:39], v[144:147]
  s_waitcnt vmcnt(2)
  v_mfma_f32_16x16x32_bf16 v[140:143], v[112:115], v[16:19], v[140:143]
  v_mfma_f32_16x16x32_bf16 v[144:147], v[112:115], v[40:43], v[144:147]
  s_waitcnt vmcnt(1)
  v_mfma_f32_16x16x32_bf16 v[140:143], v[116:119], v[20:23], v[140:143]
  v_mfma_f32_16x16x32_bf16 v[144:147], v[116:119], v[44:47], v[144:147]
  s_waitcnt vmcnt(0)
  v_mfma_f32_16x16x32_bf16 v[140:143], v[120:123], v[24:27], v[140:143]
  v_mfma_f32_16x16x32_bf16 v[144:147], v[120:123], v[48:51], v[144:147]
  s_nop 6
  v_cvt_pk_bf16_f32 v173, v140, v141
  v_cvt_pk_bf16_f32 v174, v144, v145
  v_lshlrev_b32 v140, 16, v173
  v_lshlrev_b32 v144, 16, v174
  v_and_b32 v141, 0xffff0000, v173
  v_and_b32 v145, 0xffff0000, v174
  v_pk_mul_f32 v[140:141], v[140:141], v[160:161]
  v_pk_mul_f32 v[144:145], v[144:145], v[160:161]
  v_cvt_pk_bf16_f32 v173, v140, v141
  v_cvt_pk_bf16_f32 v174, v144, v145
  v_lshlrev_b32 v140, 16, v173
  v_lshlrev_b32 v144, 16, v174
  v_and_b32 v141, 0xffff0000, v173
  v_and_b32 v145, 0xffff0000, v174
  v_max3_f32 v175, v175, v140, v141
  v_max3_f32 v176, v176, v144, v145
  v_mov_b32 v173, v175
  v_mov_b32 v174, v176
  s_nop 0
  v_permlane16_swap_b32 v175, v173
  v_permlane16_swap_b32 v176, v174
  v_max_f32 v175, v175, v173
  v_max_f32 v176, v176, v174
  v_mov_b32 v173, v175
  v_mov_b32 v174, v176
  s_nop 0
  v_permlane32_swap_b32 v175, v173
  v_permlane32_swap_b32 v176, v174
  v_max_f32 v175, v175, v173
  v_max_f32 v176, v176, v174
  v_sub_f32 v124, v124, v175
  v_sub_f32 v125, v125, v175
  v_sub_f32 v126, v126, v175
  v_sub_f32 v127, v127, v175
  v_sub_f32 v132, v132, v176
  v_sub_f32 v133, v133, v176
  v_sub_f32 v134, v134, v176
  v_sub_f32 v135, v135, v176
  v_sub_f32 v136, v136, v176
  v_sub_f32 v137, v137, v176
  v_sub_f32 v138, v138, v176
  v_sub_f32 v139, v139, v176
  v_sub_f32 v140, v140, v175
  v_sub_f32 v141, v141, v175
  v_sub_f32 v144, v144, v176
  v_sub_f32 v145, v145, v176
  v_mul_f32 v124, 0x3fb8aa3b, v124
  v_mul_f32 v125, 0x3fb8aa3b, v125
  v_mul_f32 v126, 0x3fb8aa3b, v126
  v_mul_f32 v127, 0x3fb8aa3b, v127
  v_mul_f32 v132, 0x3fb8aa3b, v132
  v_mul_f32 v133, 0x3fb8aa3b, v133
  v_mul_f32 v134, 0x3fb8aa3b, v134
  v_mul_f32 v135, 0x3fb8aa3b, v135
  v_mul_f32 v136, 0x3fb8aa3b, v136
  v_mul_f32 v137, 0x3fb8aa3b, v137
  v_mul_f32 v138, 0x3fb8aa3b, v138
  v_mul_f32 v139, 0x3fb8aa3b, v139
  v_mul_f32 v140, 0x3fb8aa3b, v140
  v_mul_f32 v141, 0x3fb8aa3b, v141
  v_mul_f32 v144, 0x3fb8aa3b, v144
  v_mul_f32 v145, 0x3fb8aa3b, v145
  v_exp_f32 v124, v124
  v_exp_f32 v125, v125
  v_exp_f32 v126, v126
  v_exp_f32 v127, v127
  v_exp_f32 v132, v132
  v_exp_f32 v133, v133
  v_exp_f32 v134, v134
  v_exp_f32 v135, v135
  v_exp_f32 v136, v136
  v_exp_f32 v137, v137
  v_exp_f32 v138, v138
  v_exp_f32 v139, v139
  v_exp_f32 v140, v140
  v_exp_f32 v141, v141
  v_exp_f32 v144, v144
  v_exp_f32 v145, v145
  v_pk_add_f32 v[162:163], v[124:125], v[126:127]
  v_pk_add_f32 v[164:165], v[132:133], v[134:135]
  v_pk_add_f32 v[146:147], v[136:137], v[138:139]
  v_pk_add_f32 v[162:163], v[162:163], v[140:141]
  v_pk_add_f32 v[164:165], v[164:165], v[144:145]
  v_pk_add_f32 v[164:165], v[164:165], v[146:147]
  v_add_f32 v175, v162, v163
  v_add_f32 v176, v164, v165
  v_mov_b32 v173, v175
  v_mov_b32 v174, v176
  s_nop 0
  v_permlane16_swap_b32 v175, v173
  v_permlane16_swap_b32 v176, v174
  v_add_f32 v175, v175, v173
  v_add_f32 v176, v176, v174
  v_mov_b32 v173, v175
  v_mov_b32 v174, v176
  s_nop 0
  v_permlane32_swap_b32 v175, v173
  v_permlane32_swap_b32 v176, v174
  v_add_f32 v175, v175, v173
  v_add_f32 v176, v176, v174
  v_rcp_f32 v162, v175
  v_rcp_f32 v164, v176
  v_mov_b32 v163, v162
  v_mov_b32 v165, v164
  v_pk_mul_f32 v[124:125], v[124:125], v[162:163]
  v_cvt_pk_bf16_f32 v152, v124, v125
  v_pk_mul_f32 v[126:127], v[126:127], v[162:163]
  v_cvt_pk_bf16_f32 v153, v126, v127
  v_pk_mul_f32 v[140:141], v[140:141], v[162:163]
  buffer_store_dwordx4 v[152:155], v166, s[8:11], s30 offen offset:0
  v_cvt_pk_bf16_f32 v177, v140, v141
  buffer_store_dword v177, v166, s[8:11], s31 offen offset:0
  v_pk_mul_f32 v[132:133], v[132:133], v[164:165]
  v_cvt_pk_bf16_f32 v156, v132, v133
  v_pk_mul_f32 v[134:135], v[134:135], v[164:165]
  v_cvt_pk_bf16_f32 v157, v134, v135
  v_pk_mul_f32 v[136:137], v[136:137], v[164:165]
  v_cvt_pk_bf16_f32 v158, v136, v137
  v_pk_mul_f32 v[138:139], v[138:139], v[164:165]
  v_cvt_pk_bf16_f32 v159, v138, v139
  v_pk_mul_f32 v[144:145], v[144:145], v[164:165]
  buffer_store_dwordx4 v[156:159], v166, s[8:11], s30 offen offset:1024
  v_cvt_pk_bf16_f32 v178, v144, v145
  buffer_store_dword v178, v166, s[8:11], s31 offen offset:1024
  v_mov_b32 v171, s32
  s_add_u32 s32, s32, 1
  s_waitcnt vmcnt(0)
  buffer_store_dword v171, v169, s[8:11], 0 offen
  s_cmp_le_u32 s32, 64
  s_cbranch_scc1 sm_loop
  s_endpgm
sm_boot2:
  s_add_u32 s25, s17, 0
  v_mov_b32 v100, -1
  v_mov_b32 v101, -1
  v_mov_b32 v102, -1
  v_mov_b32 v103, -1
  s_lshl_b32 s24, s16, 3
  s_add_u32 s24, s24, s25
  s_lshl_b32 s23, s24, 10
  s_add_u32 s23, s23, 2097152
  buffer_store_dwordx4 v[100:103], v166, s[8:11], s23 offen sc1
  s_mul_i32 s23, s24, 15360
  s_add_u32 s23, s23, 2326528
  buffer_store_dwordx4 v[100:103], v166, s[8:11], s23 offen sc1
  s_add_u32 s23, s23, 1024
  buffer_store_dwordx4 v[100:103], v166, s[8:11], s23 offen sc1
  s_add_u32 s23, s23, 1024
  buffer_store_dwordx4 v[100:103], v166, s[8:11], s23 offen sc1
  s_add_u32 s23, s23, 1024
  buffer_store_dwordx4 v[100:103], v166, s[8:11], s23 offen sc1
  s_add_u32 s23, s23, 1024
  buffer_store_dwordx4 v[100:103], v166, s[8:11], s23 offen sc1
  s_add_u32 s23, s23, 1024
  buffer_store_dwordx4 v[100:103], v166, s[8:11], s23 offen sc1
  s_add_u32 s23, s23, 1024
  buffer_store_dwordx4 v[100:103], v166, s[8:11], s23 offen sc1
  s_add_u32 s23, s23, 1024
  buffer_store_dwordx4 v[100:103], v166, s[8:11], s23 offen sc1
  s_add_u32 s23, s23, 1024
  buffer_store_dwordx4 v[100:103], v166, s[8:11], s23 offen sc1
  s_add_u32 s23, s23, 1024
  buffer_store_dwordx4 v[100:103], v166, s[8:11], s23 offen sc1
  s_add_u32 s23, s23, 1024
  buffer_store_dwordx4 v[100:103], v166, s[8:11], s23 offen sc1
  s_add_u32 s23, s23, 1024
  buffer_store_dwordx4 v[100:103], v166, s[8:11], s23 offen sc1
  s_add_u32 s23, s23, 1024
  buffer_store_dwordx4 v[100:103], v166, s[8:11], s23 offen sc1
  s_add_u32 s23, s23, 1024
  buffer_store_dwordx4 v[100:103], v166, s[8:11], s23 offen sc1
  s_add_u32 s23, s23, 1024
  buffer_store_dwordx4 v[100:103], v166, s[8:11], s23 offen sc1
  s_add_u32 s23, s23, 1024
  v_mov_b32 v171, 196
  v_mov_b32 v172, 1
  s_waitcnt vmcnt(0)
  s_mov_b64 exec, 1
  buffer_atomic_add v172, v171, s[12:15], 0 offen sc1
  s_mov_b64 exec, -1
  s_add_u32 s25, s17, 4
  v_mov_b32 v100, -1
  v_mov_b32 v101, -1
  v_mov_b32 v102, -1
  v_mov_b32 v103, -1
  s_lshl_b32 s24, s16, 3
  s_add_u32 s24, s24, s25
  s_lshl_b32 s23, s24, 10
  s_add_u32 s23, s23, 2097152
  buffer_store_dwordx4 v[100:103], v166, s[8:11], s23 offen sc1
  s_mul_i32 s23, s24, 15360
  s_add_u32 s23, s23, 2326528
  buffer_store_dwordx4 v[100:103], v166, s[8:11], s23 offen sc1
  s_add_u32 s23, s23, 1024
  buffer_store_dwordx4 v[100:103], v166, s[8:11], s23 offen sc1
  s_add_u32 s23, s23, 1024
  buffer_store_dwordx4 v[100:103], v166, s[8:11], s23 offen sc1
  s_add_u32 s23, s23, 1024
  buffer_store_dwordx4 v[100:103], v166, s[8:11], s23 offen sc1
  s_add_u32 s23, s23, 1024
  buffer_store_dwordx4 v[100:103], v166, s[8:11], s23 offen sc1
  s_add_u32 s23, s23, 1024
  buffer_store_dwordx4 v[100:103], v166, s[8:11], s23 offen sc1
  s_add_u32 s23, s23, 1024
  buffer_store_dwordx4 v[100:103], v166, s[8:11], s23 offen sc1
  s_add_u32 s23, s23, 1024
  buffer_store_dwordx4 v[100:103], v166, s[8:11], s23 offen sc1
  s_add_u32 s23, s23, 1024
  buffer_store_dwordx4 v[100:103], v166, s[8:11], s23 offen sc1
  s_add_u32 s23, s23, 1024
  buffer_store_dwordx4 v[100:103], v166, s[8:11], s23 offen sc1
  s_add_u32 s23, s23, 1024
  buffer_store_dwordx4 v[100:103], v166, s[8:11], s23 offen sc1
  s_add_u32 s23, s23, 1024
  buffer_store_dwordx4 v[100:103], v166, s[8:11], s23 offen sc1
  s_add_u32 s23, s23, 1024
  buffer_store_dwordx4 v[100:103], v166, s[8:11], s23 offen sc1
  s_add_u32 s23, s23, 1024
  buffer_store_dwordx4 v[100:103], v166, s[8:11], s23 offen sc1
  s_add_u32 s23, s23, 1024
  buffer_store_dwordx4 v[100:103], v166, s[8:11], s23 offen sc1
  s_add_u32 s23, s23, 1024
  v_mov_b32 v171, 196
  v_mov_b32 v172, 1
  s_waitcnt vmcnt(0)
  s_mov_b64 exec, 1
  buffer_atomic_add v172, v171, s[12:15], 0 offen sc1
  s_mov_b64 exec, -1
  s_branch sm_b2r
role_r:
  s_load_dwordx2 s[20:21], s[0:1], 0
  s_mov_b32 s22, 2621440
  s_mov_b32 s23, 0x00020000
  s_load_dwordx2 s[24:25], s[0:1], 112
  s_mov_b32 s26, 2621440
  s_mov_b32 s27, 0x00020000
  s_load_dwordx2 s[28:29], s[0:1], 64
  s_mov_b32 s30, 1280
  s_mov_b32 s31, 0x00020000
  s_load_dwordx2 s[44:45], s[0:1], 96
  s_mov_b32 s46, 1280
  s_mov_b32 s47, 0x00020000
  s_load_dwordx2 s[48:49], s[0:1], 104
  s_mov_b32 s50, 4915200
  s_mov_b32 s51, 0x00020000
  s_sub_u32 s54, s18, 29
  s_sub_u32 s52, 2, s54
  s_lshl_b32 s52, s52, 3
  s_add_u32 s52, s52, s16
  s_lshl_b32 s32, s54, 2
  s_add_u32 s32, s32, s17
  s_mul_i32 s38, s16, 2621440
  s_lshl_b32 s35, s32, 13
  s_add_u32 s35, s35, s38
  s_add_u32 s35, s35, 247463936
  v_lshlrev_b32 v2, 7, v1
  s_waitcnt lgkmcnt(0)
  s_mov_b32 s40, s54
  s_mov_b32 s41, s54
  s_mul_i32 s39, s16, 3
  s_add_u32 s39, s39, s54
  s_add_u32 s39, s39, 24
  v_lshlrev_b32 v226, 2, v1
  s_mul_i32 s37, s32, 5120
  v_and_b32 v90, 3, v1
  v_lshrrev_b32 v91, 2, v1
  v_mul_u32_u24 v160, 1280, v90
  v_lshrrev_b32 v92, 4, v1
  v_bfe_u32 v93, v1, 2, 2
  v_lshl_add_u32 v93, v92, 3, v93
  v_lshl_add_u32 v160, v93, 3, v160
  buffer_load_dwordx2 v[100:101], v160, s[20:23], s37 offen offset:0
  buffer_load_dwordx2 v[102:103], v160, s[20:23], s37 offen offset:32
  buffer_load_dwordx2 v[104:105], v160, s[20:23], s37 offen offset:256
  buffer_load_dwordx2 v[106:107], v160, s[20:23], s37 offen offset:288
  buffer_load_dwordx2 v[108:109], v160, s[20:23], s37 offen offset:512
  buffer_load_dwordx2 v[110:111], v160, s[20:23], s37 offen offset:544
  buffer_load_dwordx2 v[112:113], v160, s[20:23], s37 offen offset:768
  buffer_load_dwordx2 v[114:115], v160, s[20:23], s37 offen offset:800
  buffer_load_dwordx2 v[116:117], v160, s[20:23], s37 offen offset:1024
  buffer_load_dwordx2 v[118:119], v160, s[20:23], s37 offen offset:1056
  s_add_u32 s36, s40, 24
  s_cmp_lt_u32 s40, 24
  s_cselect_b32 s36, s39, s36
  s_add_u32 s40, s40, 3
  s_cmp_lt_u32 s40, 24
  s_cselect_b32 s40, s40, s36
  s_min_u32 s40, s40, 127
  s_mul_i32 s37, s40, 20480
  s_mul_i32 s36, s17, 5120
  s_add_u32 s37, s37, s36
  buffer_load_dwordx2 v[120:121], v160, s[20:23], s37 offen offset:0
  buffer_load_dwordx2 v[122:123], v160, s[20:23], s37 offen offset:32
  buffer_load_dwordx2 v[124:125], v160, s[20:23], s37 offen offset:256
  buffer_load_dwordx2 v[126:127], v160, s[20:23], s37 offen offset:288
  buffer_load_dwordx2 v[128:129], v160, s[20:23], s37 offen offset:512
  buffer_load_dwordx2 v[130:131], v160, s[20:23], s37 offen offset:544
  buffer_load_dwordx2 v[132:133], v160, s[20:23], s37 offen offset:768
  buffer_load_dwordx2 v[134:135], v160, s[20:23], s37 offen offset:800
  buffer_load_dwordx2 v[136:137], v160, s[20:23], s37 offen offset:1024
  buffer_load_dwordx2 v[138:139], v160, s[20:23], s37 offen offset:1056
  s_add_u32 s36, s40, 24
  s_cmp_lt_u32 s40, 24
  s_cselect_b32 s36, s39, s36
  s_add_u32 s40, s40, 3
  s_cmp_lt_u32 s40, 24
  s_cselect_b32 s40, s40, s36
  s_min_u32 s40, s40, 127
  s_mul_i32 s37, s40, 20480
  s_mul_i32 s36, s17, 5120
  s_add_u32 s37, s37, s36
  buffer_load_dwordx2 v[46:47], v160, s[20:23], s37 offen offset:0
  buffer_load_dwordx2 v[48:49], v160, s[20:23], s37 offen offset:32
  buffer_load_dwordx2 v[50:51], v160, s[20:23], s37 offen offset:256
  buffer_load_dwordx2 v[52:53], v160, s[20:23], s37 offen offset:288
  buffer_load_dwordx2 v[54:55], v160, s[20:23], s37 offen offset:512
  buffer_load_dwordx2 v[56:57], v160, s[20:23], s37 offen offset:544
  buffer_load_dwordx2 v[58:59], v160, s[20:23], s37 offen offset:768
  buffer_load_dwordx2 v[60:61], v160, s[20:23], s37 offen offset:800
  buffer_load_dwordx2 v[62:63], v160, s[20:23], s37 offen offset:1024
  buffer_load_dwordx2 v[64:65], v160, s[20:23], s37 offen offset:1056
  s_add_u32 s36, s40, 24
  s_cmp_lt_u32 s40, 24
  s_cselect_b32 s36, s39, s36
  s_add_u32 s40, s40, 3
  s_cmp_lt_u32 s40, 24
  s_cselect_b32 s40, s40, s36
  s_min_u32 s40, s40, 127
  s_mul_i32 s37, s40, 20480
  s_mul_i32 s36, s17, 5120
  s_add_u32 s37, s37, s36
  s_add_u32 s35, s35, 98304
  v_lshlrev_b32 v161, 4, v90
  v_lshl_add_u32 v161, v91, 8, v161
  v_lshrrev_b32 v92, 1, v90
  v_mul_u32_u24 v162, 2432, v92
  v_lshl_add_u32 v162, v90, 6, v162
  v_lshl_add_u32 v162, v93, 4, v162
  v_cvt_f32_u32 v163, v92
  s_lshl_b32 s35, s16, 22
  s_lshl_b32 s36, s32, 13
  s_add_u32 s35, s35, s36
  s_add_u32 s35, s35, 67108864
  v_lshlrev_b32 v227, 3, v1
  s_lshl_b32 s35, s16, 8
  s_lshl_b32 s36, s32, 2
  s_add_u32 s35, s35, s36
  s_add_u32 s35, s35, 8192
  v_mov_b32 v228, s35
  v_mov_b32 v230, 0x00003f80
  v_mov_b32 v231, 0x3f800000
  s_mul_i32 s38, s16, 2621440
  s_add_u32 s38, s38, 247463936
  s_mul_i32 s35, s54, 20480
  s_add_u32 s38, s38, s35
  s_lshl_b32 s35, s17, 6
  s_add_u32 s38, s38, s35
  s_waitcnt lgkmcnt(0)
  s_waitcnt vmcnt(20)
  v_lshlrev_b32 v2, 16, v100
  v_and_b32 v3, 0xffff0000, v100
  v_lshlrev_b32 v4, 16, v101
  v_and_b32 v5, 0xffff0000, v101
  v_lshlrev_b32 v6, 16, v102
  v_and_b32 v7, 0xffff0000, v102
  v_lshlrev_b32 v8, 16, v103
  v_and_b32 v9, 0xffff0000, v103
  v_lshlrev_b32 v10, 16, v104
  v_and_b32 v11, 0xffff0000, v104
  v_lshlrev_b32 v12, 16, v105
  v_and_b32 v13, 0xffff0000, v105
  v_lshlrev_b32 v14, 16, v106
  v_and_b32 v15, 0xffff0000, v106
  v_lshlrev_b32 v16, 16, v107
  v_and_b32 v17, 0xffff0000, v107
  v_lshlrev_b32 v18, 16, v108
  v_and_b32 v19, 0xffff0000, v108
  v_lshlrev_b32 v20, 16, v109
  v_and_b32 v21, 0xffff0000, v109
  v_lshlrev_b32 v22, 16, v110
  v_and_b32 v23, 0xffff0000, v110
  v_lshlrev_b32 v24, 16, v111
  v_and_b32 v25, 0xffff0000, v111
  v_lshlrev_b32 v26, 16, v112
  v_and_b32 v27, 0xffff0000, v112
  v_lshlrev_b32 v28, 16, v113
  v_and_b32 v29, 0xffff0000, v113
  v_lshlrev_b32 v30, 16, v114
  v_and_b32 v31, 0xffff0000, v114
  v_lshlrev_b32 v32, 16, v115
  v_and_b32 v33, 0xffff0000, v115
  v_lshlrev_b32 v34, 16, v116
  v_and_b32 v35, 0xffff0000, v116
  v_lshlrev_b32 v36, 16, v117
  v_and_b32 v37, 0xffff0000, v117
  v_lshlrev_b32 v38, 16, v118
  v_and_b32 v39, 0xffff0000, v118
  v_lshlrev_b32 v40, 16, v119
  v_and_b32 v41, 0xffff0000, v119
  v_pk_add_f32 v[86:87], v[2:3], v[4:5]
  v_pk_add_f32 v[88:89], v[6:7], v[8:9]
  v_pk_add_f32 v[86:87], v[86:87], v[10:11]
  v_pk_add_f32 v[88:89], v[88:89], v[12:13]
  v_pk_add_f32 v[86:87], v[86:87], v[14:15]
  v_pk_add_f32 v[88:89], v[88:89], v[16:17]
  v_pk_add_f32 v[86:87], v[86:87], v[18:19]
  v_pk_add_f32 v[88:89], v[88:89], v[20:21]
  v_pk_add_f32 v[86:87], v[86:87], v[22:23]
  v_pk_add_f32 v[88:89], v[88:89], v[24:25]
  v_pk_add_f32 v[86:87], v[86:87], v[26:27]
  v_pk_add_f32 v[88:89], v[88:89], v[28:29]
  v_pk_add_f32 v[86:87], v[86:87], v[30:31]
  v_pk_add_f32 v[88:89], v[88:89], v[32:33]
  v_pk_add_f32 v[86:87], v[86:87], v[34:35]
  v_pk_add_f32 v[88:89], v[88:89], v[36:37]
  v_pk_add_f32 v[86:87], v[86:87], v[38:39]
  v_pk_add_f32 v[88:89], v[88:89], v[40:41]
  v_pk_add_f32 v[86:87], v[86:87], v[88:89]
  v_add_f32 v86, v86, v87
  s_nop 1
  v_add_f32_dpp v86, v86, v86 row_ror:8 row_mask:0xf bank_mask:0xf
  s_nop 1
  v_add_f32_dpp v86, v86, v86 row_ror:4 row_mask:0xf bank_mask:0xf
  v_mov_b32 v90, v86
  s_nop 1
  v_permlane16_swap_b32 v86, v90
  v_add_f32 v86, v86, v90
  v_mov_b32 v90, v86
  s_nop 1
  v_permlane32_swap_b32 v86, v90
  v_add_f32 v86, v86, v90
  v_mul_f32 v88, 0xbacccccd, v86
  v_mul_f32 v89, 0xbacccccd, v86
  v_pk_add_f32 v[164:165], v[2:3], v[88:89]
  v_pk_add_f32 v[166:167], v[4:5], v[88:89]
  v_pk_mul_f32 v[170:171], v[164:165], v[164:165]
  v_pk_add_f32 v[168:169], v[6:7], v[88:89]
  v_pk_mul_f32 v[86:87], v[166:167], v[166:167]
  v_pk_add_f32 v[164:165], v[8:9], v[88:89]
  v_pk_fma_f32 v[170:171], v[168:169], v[168:169], v[170:171]
  v_pk_add_f32 v[166:167], v[10:11], v[88:89]
  v_pk_fma_f32 v[86:87], v[164:165], v[164:165], v[86:87]
  v_pk_add_f32 v[168:169], v[12:13], v[88:89]
  v_pk_fma_f32 v[170:171], v[166:167], v[166:167], v[170:171]
  v_pk_add_f32 v[164:165], v[14:15], v[88:89]
  v_pk_fma_f32 v[86:87], v[168:169], v[168:169], v[86:87]
  v_pk_add_f32 v[166:167], v[16:17], v[88:89]
  v_pk_fma_f32 v[170:171], v[164:165], v[164:165], v[170:171]
  v_pk_add_f32 v[168:169], v[18:19], v[88:89]
  v_pk_fma_f32 v[86:87], v[166:167], v[166:167], v[86:87]
  v_pk_add_f32 v[164:165], v[20:21], v[88:89]
  v_pk_fma_f32 v[170:171], v[168:169], v[168:169], v[170:171]
  v_pk_add_f32 v[166:167], v[22:23], v[88:89]
  v_pk_fma_f32 v[86:87], v[164:165], v[164:165], v[86:87]
  v_pk_add_f32 v[168:169], v[24:25], v[88:89]
  v_pk_fma_f32 v[170:171], v[166:167], v[166:167], v[170:171]
  v_pk_add_f32 v[164:165], v[26:27], v[88:89]
  v_pk_fma_f32 v[86:87], v[168:169], v[168:169], v[86:87]
  v_pk_add_f32 v[166:167], v[28:29], v[88:89]
  v_pk_fma_f32 v[170:171], v[164:165], v[164:165], v[170:171]
  v_pk_add_f32 v[168:169], v[30:31], v[88:89]
  v_pk_fma_f32 v[86:87], v[166:167], v[166:167], v[86:87]
  v_pk_add_f32 v[164:165], v[32:33], v[88:89]
  v_pk_fma_f32 v[170:171], v[168:169], v[168:169], v[170:171]
  v_pk_add_f32 v[166:167], v[34:35], v[88:89]
  v_pk_fma_f32 v[86:87], v[164:165], v[164:165], v[86:87]
  v_pk_add_f32 v[168:169], v[36:37], v[88:89]
  v_pk_fma_f32 v[170:171], v[166:167], v[166:167], v[170:171]
  v_pk_add_f32 v[164:165], v[38:39], v[88:89]
  v_pk_fma_f32 v[86:87], v[168:169], v[168:169], v[86:87]
  v_pk_add_f32 v[166:167], v[40:41], v[88:89]
  v_pk_fma_f32 v[170:171], v[164:165], v[164:165], v[170:171]
  v_pk_fma_f32 v[86:87], v[166:167], v[166:167], v[86:87]
  v_cvt_pk_bf16_f32 v91, v88, v89
  v_lshlrev_b32 v88, 16, v91
  v_and_b32 v89, 0xffff0000, v91
  v_pk_add_f32 v[86:87], v[86:87], v[170:171]
  v_add_f32 v86, v86, v87
  s_nop 1
  v_add_f32_dpp v86, v86, v86 row_ror:8 row_mask:0xf bank_mask:0xf
  s_nop 1
  v_add_f32_dpp v86, v86, v86 row_ror:4 row_mask:0xf bank_mask:0xf
  v_mov_b32 v90, v86
  s_nop 1
  v_permlane16_swap_b32 v86, v90
  v_add_f32 v86, v86, v90
  v_mov_b32 v90, v86
  s_nop 1
  v_permlane32_swap_b32 v86, v90
  v_add_f32 v86, v86, v90
  v_pk_add_f32 v[2:3], v[2:3], v[88:89]
  v_mul_f32 v86, 0x3acccccd, v86
  v_pk_add_f32 v[4:5], v[4:5], v[88:89]
  v_cvt_pk_bf16_f32 v86, v86, v86
  v_pk_add_f32 v[6:7], v[6:7], v[88:89]
  v_lshlrev_b32 v86, 16, v86
  v_pk_add_f32 v[8:9], v[8:9], v[88:89]
  v_add_f32 v86, 0x3727c5ac, v86
  v_pk_add_f32 v[10:11], v[10:11], v[88:89]
  v_cvt_pk_bf16_f32 v86, v86, v86
  v_pk_add_f32 v[12:13], v[12:13], v[88:89]
  v_lshlrev_b32 v86, 16, v86
  v_pk_add_f32 v[14:15], v[14:15], v[88:89]
  v_sqrt_f32 v86, v86
  v_pk_add_f32 v[16:17], v[16:17], v[88:89]
  v_cvt_pk_bf16_f32 v86, v86, v86
  v_pk_add_f32 v[18:19], v[18:19], v[88:89]
  v_lshlrev_b32 v86, 16, v86
  v_pk_add_f32 v[20:21], v[20:21], v[88:89]
  v_rcp_f32 v86, v86
  v_pk_add_f32 v[22:23], v[22:23], v[88:89]
  v_mov_b32 v87, v86
  v_pk_add_f32 v[24:25], v[24:25], v[88:89]
  v_pk_add_f32 v[26:27], v[26:27], v[88:89]
  v_pk_add_f32 v[28:29], v[28:29], v[88:89]
  v_pk_add_f32 v[30:31], v[30:31], v[88:89]
  v_pk_add_f32 v[32:33], v[32:33], v[88:89]
  v_pk_add_f32 v[34:35], v[34:35], v[88:89]
  v_pk_add_f32 v[36:37], v[36:37], v[88:89]
  v_pk_add_f32 v[38:39], v[38:39], v[88:89]
  v_pk_add_f32 v[40:41], v[40:41], v[88:89]
  v_cvt_pk_bf16_f32 v164, v2, v3
  v_lshlrev_b32 v2, 16, v164
  v_and_b32 v3, 0xffff0000, v164
  v_cvt_pk_bf16_f32 v165, v4, v5
  v_lshlrev_b32 v4, 16, v165
  v_and_b32 v5, 0xffff0000, v165
  v_cvt_pk_bf16_f32 v166, v6, v7
  v_lshlrev_b32 v6, 16, v166
  v_and_b32 v7, 0xffff0000, v166
  v_cvt_pk_bf16_f32 v167, v8, v9
  v_lshlrev_b32 v8, 16, v167
  v_and_b32 v9, 0xffff0000, v167
  v_cvt_pk_bf16_f32 v164, v10, v11
  v_lshlrev_b32 v10, 16, v164
  v_and_b32 v11, 0xffff0000, v164
  v_cvt_pk_bf16_f32 v165, v12, v13
  v_lshlrev_b32 v12, 16, v165
  v_and_b32 v13, 0xffff0000, v165
  v_cvt_pk_bf16_f32 v166, v14, v15
  v_lshlrev_b32 v14, 16, v166
  v_and_b32 v15, 0xffff0000, v166
  v_cvt_pk_bf16_f32 v167, v16, v17
  v_lshlrev_b32 v16, 16, v167
  v_and_b32 v17, 0xffff0000, v167
  v_cvt_pk_bf16_f32 v164, v18, v19
  v_lshlrev_b32 v18, 16, v164
  v_and_b32 v19, 0xffff0000, v164
  v_cvt_pk_bf16_f32 v165, v20, v21
  v_lshlrev_b32 v20, 16, v165
  v_and_b32 v21, 0xffff0000, v165
  v_cvt_pk_bf16_f32 v166, v22, v23
  v_lshlrev_b32 v22, 16, v166
  v_and_b32 v23, 0xffff0000, v166
  v_cvt_pk_bf16_f32 v167, v24, v25
  v_lshlrev_b32 v24, 16, v167
  v_and_b32 v25, 0xffff0000, v167
  v_cvt_pk_bf16_f32 v164, v26, v27
  v_lshlrev_b32 v26, 16, v164
  v_and_b32 v27, 0xffff0000, v164
  v_cvt_pk_bf16_f32 v165, v28, v29
  v_lshlrev_b32 v28, 16, v165
  v_and_b32 v29, 0xffff0000, v165
  v_cvt_pk_bf16_f32 v166, v30, v31
  v_lshlrev_b32 v30, 16, v166
  v_and_b32 v31, 0xffff0000, v166
  v_cvt_pk_bf16_f32 v167, v32, v33
  v_lshlrev_b32 v32, 16, v167
  v_and_b32 v33, 0xffff0000, v167
  v_cvt_pk_bf16_f32 v164, v34, v35
  v_lshlrev_b32 v34, 16, v164
  v_and_b32 v35, 0xffff0000, v164
  v_cvt_pk_bf16_f32 v165, v36, v37
  v_lshlrev_b32 v36, 16, v165
  v_and_b32 v37, 0xffff0000, v165
  v_cvt_pk_bf16_f32 v166, v38, v39
  v_lshlrev_b32 v38, 16, v166
  v_and_b32 v39, 0xffff0000, v166
  v_cvt_pk_bf16_f32 v167, v40, v41
  v_lshlrev_b32 v40, 16, v167
  v_and_b32 v41, 0xffff0000, v167
  v_pk_mul_f32 v[2:3], v[2:3], v[86:87]
  v_pk_mul_f32 v[4:5], v[4:5], v[86:87]
  v_pk_mul_f32 v[6:7], v[6:7], v[86:87]
  v_pk_mul_f32 v[8:9], v[8:9], v[86:87]
  v_pk_mul_f32 v[10:11], v[10:11], v[86:87]
  v_pk_mul_f32 v[12:13], v[12:13], v[86:87]
  v_pk_mul_f32 v[14:15], v[14:15], v[86:87]
  v_pk_mul_f32 v[16:17], v[16:17], v[86:87]
  v_pk_mul_f32 v[18:19], v[18:19], v[86:87]
  v_pk_mul_f32 v[20:21], v[20:21], v[86:87]
  v_pk_mul_f32 v[22:23], v[22:23], v[86:87]
  v_pk_mul_f32 v[24:25], v[24:25], v[86:87]
  v_pk_mul_f32 v[26:27], v[26:27], v[86:87]
  v_pk_mul_f32 v[28:29], v[28:29], v[86:87]
  v_pk_mul_f32 v[30:31], v[30:31], v[86:87]
  v_pk_mul_f32 v[32:33], v[32:33], v[86:87]
  v_pk_mul_f32 v[34:35], v[34:35], v[86:87]
  v_pk_mul_f32 v[36:37], v[36:37], v[86:87]
  v_pk_mul_f32 v[38:39], v[38:39], v[86:87]
  v_pk_mul_f32 v[40:41], v[40:41], v[86:87]
  v_cvt_pk_bf16_f32 v100, v2, v3
  v_cvt_pk_bf16_f32 v101, v4, v5
  v_cvt_pk_bf16_f32 v102, v6, v7
  v_cvt_pk_bf16_f32 v103, v8, v9
  v_cvt_pk_bf16_f32 v104, v10, v11
  v_cvt_pk_bf16_f32 v105, v12, v13
  v_cvt_pk_bf16_f32 v106, v14, v15
  v_cvt_pk_bf16_f32 v107, v16, v17
  v_cvt_pk_bf16_f32 v108, v18, v19
  v_cvt_pk_bf16_f32 v109, v20, v21
  v_cvt_pk_bf16_f32 v110, v22, v23
  v_cvt_pk_bf16_f32 v111, v24, v25
  v_cvt_pk_bf16_f32 v112, v26, v27
  v_cvt_pk_bf16_f32 v113, v28, v29
  v_cvt_pk_bf16_f32 v114, v30, v31
  v_cvt_pk_bf16_f32 v115, v32, v33
  v_cvt_pk_bf16_f32 v116, v34, v35
  v_cvt_pk_bf16_f32 v117, v36, v37
  v_cvt_pk_bf16_f32 v118, v38, v39
  v_cvt_pk_bf16_f32 v119, v40, v41
  s_waitcnt vmcnt(10)
  v_lshlrev_b32 v2, 16, v120
  v_and_b32 v3, 0xffff0000, v120
  v_lshlrev_b32 v4, 16, v121
  v_and_b32 v5, 0xffff0000, v121
  v_lshlrev_b32 v6, 16, v122
  v_and_b32 v7, 0xffff0000, v122
  v_lshlrev_b32 v8, 16, v123
  v_and_b32 v9, 0xffff0000, v123
  v_lshlrev_b32 v10, 16, v124
  v_and_b32 v11, 0xffff0000, v124
  v_lshlrev_b32 v12, 16, v125
  v_and_b32 v13, 0xffff0000, v125
  v_lshlrev_b32 v14, 16, v126
  v_and_b32 v15, 0xffff0000, v126
  v_lshlrev_b32 v16, 16, v127
  v_and_b32 v17, 0xffff0000, v127
  v_lshlrev_b32 v18, 16, v128
  v_and_b32 v19, 0xffff0000, v128
  v_lshlrev_b32 v20, 16, v129
  v_and_b32 v21, 0xffff0000, v129
  v_lshlrev_b32 v22, 16, v130
  v_and_b32 v23, 0xffff0000, v130
  v_lshlrev_b32 v24, 16, v131
  v_and_b32 v25, 0xffff0000, v131
  v_lshlrev_b32 v26, 16, v132
  v_and_b32 v27, 0xffff0000, v132
  v_lshlrev_b32 v28, 16, v133
  v_and_b32 v29, 0xffff0000, v133
  v_lshlrev_b32 v30, 16, v134
  v_and_b32 v31, 0xffff0000, v134
  v_lshlrev_b32 v32, 16, v135
  v_and_b32 v33, 0xffff0000, v135
  v_lshlrev_b32 v34, 16, v136
  v_and_b32 v35, 0xffff0000, v136
  v_lshlrev_b32 v36, 16, v137
  v_and_b32 v37, 0xffff0000, v137
  v_lshlrev_b32 v38, 16, v138
  v_and_b32 v39, 0xffff0000, v138
  v_lshlrev_b32 v40, 16, v139
  v_and_b32 v41, 0xffff0000, v139
  v_pk_add_f32 v[86:87], v[2:3], v[4:5]
  v_pk_add_f32 v[88:89], v[6:7], v[8:9]
  v_pk_add_f32 v[86:87], v[86:87], v[10:11]
  v_pk_add_f32 v[88:89], v[88:89], v[12:13]
  v_pk_add_f32 v[86:87], v[86:87], v[14:15]
  v_pk_add_f32 v[88:89], v[88:89], v[16:17]
  v_pk_add_f32 v[86:87], v[86:87], v[18:19]
  v_pk_add_f32 v[88:89], v[88:89], v[20:21]
  v_pk_add_f32 v[86:87], v[86:87], v[22:23]
  v_pk_add_f32 v[88:89], v[88:89], v[24:25]
  v_pk_add_f32 v[86:87], v[86:87], v[26:27]
  v_pk_add_f32 v[88:89], v[88:89], v[28:29]
  v_pk_add_f32 v[86:87], v[86:87], v[30:31]
  v_pk_add_f32 v[88:89], v[88:89], v[32:33]
  v_pk_add_f32 v[86:87], v[86:87], v[34:35]
  v_pk_add_f32 v[88:89], v[88:89], v[36:37]
  v_pk_add_f32 v[86:87], v[86:87], v[38:39]
  v_pk_add_f32 v[88:89], v[88:89], v[40:41]
  v_pk_add_f32 v[86:87], v[86:87], v[88:89]
  v_add_f32 v86, v86, v87
  s_nop 1
  v_add_f32_dpp v86, v86, v86 row_ror:8 row_mask:0xf bank_mask:0xf
  s_nop 1
  v_add_f32_dpp v86, v86, v86 row_ror:4 row_mask:0xf bank_mask:0xf
  v_mov_b32 v90, v86
  s_nop 1
  v_permlane16_swap_b32 v86, v90
  v_add_f32 v86, v86, v90
  v_mov_b32 v90, v86
  s_nop 1
  v_permlane32_swap_b32 v86, v90
  v_add_f32 v86, v86, v90
  v_mul_f32 v88, 0xbacccccd, v86
  v_mul_f32 v89, 0xbacccccd, v86
  v_pk_add_f32 v[164:165], v[2:3], v[88:89]
  v_pk_add_f32 v[166:167], v[4:5], v[88:89]
  v_pk_mul_f32 v[170:171], v[164:165], v[164:165]
  v_pk_add_f32 v[168:169], v[6:7], v[88:89]
  v_pk_mul_f32 v[86:87], v[166:167], v[166:167]
  v_pk_add_f32 v[164:165], v[8:9], v[88:89]
  v_pk_fma_f32 v[170:171], v[168:169], v[168:169], v[170:171]
  v_pk_add_f32 v[166:167], v[10:11], v[88:89]
  v_pk_fma_f32 v[86:87], v[164:165], v[164:165], v[86:87]
  v_pk_add_f32 v[168:169], v[12:13], v[88:89]
  v_pk_fma_f32 v[170:171], v[166:167], v[166:167], v[170:171]
  v_pk_add_f32 v[164:165], v[14:15], v[88:89]
  v_pk_fma_f32 v[86:87], v[168:169], v[168:169], v[86:87]
  v_pk_add_f32 v[166:167], v[16:17], v[88:89]
  v_pk_fma_f32 v[170:171], v[164:165], v[164:165], v[170:171]
  v_pk_add_f32 v[168:169], v[18:19], v[88:89]
  v_pk_fma_f32 v[86:87], v[166:167], v[166:167], v[86:87]
  v_pk_add_f32 v[164:165], v[20:21], v[88:89]
  v_pk_fma_f32 v[170:171], v[168:169], v[168:169], v[170:171]
  v_pk_add_f32 v[166:167], v[22:23], v[88:89]
  v_pk_fma_f32 v[86:87], v[164:165], v[164:165], v[86:87]
  v_pk_add_f32 v[168:169], v[24:25], v[88:89]
  v_pk_fma_f32 v[170:171], v[166:167], v[166:167], v[170:171]
  v_pk_add_f32 v[164:165], v[26:27], v[88:89]
  v_pk_fma_f32 v[86:87], v[168:169], v[168:169], v[86:87]
  v_pk_add_f32 v[166:167], v[28:29], v[88:89]
  v_pk_fma_f32 v[170:171], v[164:165], v[164:165], v[170:171]
  v_pk_add_f32 v[168:169], v[30:31], v[88:89]
  v_pk_fma_f32 v[86:87], v[166:167], v[166:167], v[86:87]
  v_pk_add_f32 v[164:165], v[32:33], v[88:89]
  v_pk_fma_f32 v[170:171], v[168:169], v[168:169], v[170:171]
  v_pk_add_f32 v[166:167], v[34:35], v[88:89]
  v_pk_fma_f32 v[86:87], v[164:165], v[164:165], v[86:87]
  v_pk_add_f32 v[168:169], v[36:37], v[88:89]
  v_pk_fma_f32 v[170:171], v[166:167], v[166:167], v[170:171]
  v_pk_add_f32 v[164:165], v[38:39], v[88:89]
  v_pk_fma_f32 v[86:87], v[168:169], v[168:169], v[86:87]
  v_pk_add_f32 v[166:167], v[40:41], v[88:89]
  v_pk_fma_f32 v[170:171], v[164:165], v[164:165], v[170:171]
  v_pk_fma_f32 v[86:87], v[166:167], v[166:167], v[86:87]
  v_cvt_pk_bf16_f32 v91, v88, v89
  v_lshlrev_b32 v88, 16, v91
  v_and_b32 v89, 0xffff0000, v91
  v_pk_add_f32 v[86:87], v[86:87], v[170:171]
  v_add_f32 v86, v86, v87
  s_nop 1
  v_add_f32_dpp v86, v86, v86 row_ror:8 row_mask:0xf bank_mask:0xf
  s_nop 1
  v_add_f32_dpp v86, v86, v86 row_ror:4 row_mask:0xf bank_mask:0xf
  v_mov_b32 v90, v86
  s_nop 1
  v_permlane16_swap_b32 v86, v90
  v_add_f32 v86, v86, v90
  v_mov_b32 v90, v86
  s_nop 1
  v_permlane32_swap_b32 v86, v90
  v_add_f32 v86, v86, v90
  v_pk_add_f32 v[2:3], v[2:3], v[88:89]
  v_mul_f32 v86, 0x3acccccd, v86
  v_pk_add_f32 v[4:5], v[4:5], v[88:89]
  v_cvt_pk_bf16_f32 v86, v86, v86
  v_pk_add_f32 v[6:7], v[6:7], v[88:89]
  v_lshlrev_b32 v86, 16, v86
  v_pk_add_f32 v[8:9], v[8:9], v[88:89]
  v_add_f32 v86, 0x3727c5ac, v86
  v_pk_add_f32 v[10:11], v[10:11], v[88:89]
  v_cvt_pk_bf16_f32 v86, v86, v86
  v_pk_add_f32 v[12:13], v[12:13], v[88:89]
  v_lshlrev_b32 v86, 16, v86
  v_pk_add_f32 v[14:15], v[14:15], v[88:89]
  v_sqrt_f32 v86, v86
  v_pk_add_f32 v[16:17], v[16:17], v[88:89]
  v_cvt_pk_bf16_f32 v86, v86, v86
  v_pk_add_f32 v[18:19], v[18:19], v[88:89]
  v_lshlrev_b32 v86, 16, v86
  v_pk_add_f32 v[20:21], v[20:21], v[88:89]
  v_rcp_f32 v86, v86
  v_pk_add_f32 v[22:23], v[22:23], v[88:89]
  v_mov_b32 v87, v86
  v_pk_add_f32 v[24:25], v[24:25], v[88:89]
  v_pk_add_f32 v[26:27], v[26:27], v[88:89]
  v_pk_add_f32 v[28:29], v[28:29], v[88:89]
  v_pk_add_f32 v[30:31], v[30:31], v[88:89]
  v_pk_add_f32 v[32:33], v[32:33], v[88:89]
  v_pk_add_f32 v[34:35], v[34:35], v[88:89]
  v_pk_add_f32 v[36:37], v[36:37], v[88:89]
  v_pk_add_f32 v[38:39], v[38:39], v[88:89]
  v_pk_add_f32 v[40:41], v[40:41], v[88:89]
  v_cvt_pk_bf16_f32 v164, v2, v3
  v_lshlrev_b32 v2, 16, v164
  v_and_b32 v3, 0xffff0000, v164
  v_cvt_pk_bf16_f32 v165, v4, v5
  v_lshlrev_b32 v4, 16, v165
  v_and_b32 v5, 0xffff0000, v165
  v_cvt_pk_bf16_f32 v166, v6, v7
  v_lshlrev_b32 v6, 16, v166
  v_and_b32 v7, 0xffff0000, v166
  v_cvt_pk_bf16_f32 v167, v8, v9
  v_lshlrev_b32 v8, 16, v167
  v_and_b32 v9, 0xffff0000, v167
  v_cvt_pk_bf16_f32 v164, v10, v11
  v_lshlrev_b32 v10, 16, v164
  v_and_b32 v11, 0xffff0000, v164
  v_cvt_pk_bf16_f32 v165, v12, v13
  v_lshlrev_b32 v12, 16, v165
  v_and_b32 v13, 0xffff0000, v165
  v_cvt_pk_bf16_f32 v166, v14, v15
  v_lshlrev_b32 v14, 16, v166
  v_and_b32 v15, 0xffff0000, v166
  v_cvt_pk_bf16_f32 v167, v16, v17
  v_lshlrev_b32 v16, 16, v167
  v_and_b32 v17, 0xffff0000, v167
  v_cvt_pk_bf16_f32 v164, v18, v19
  v_lshlrev_b32 v18, 16, v164
  v_and_b32 v19, 0xffff0000, v164
  v_cvt_pk_bf16_f32 v165, v20, v21
  v_lshlrev_b32 v20, 16, v165
  v_and_b32 v21, 0xffff0000, v165
  v_cvt_pk_bf16_f32 v166, v22, v23
  v_lshlrev_b32 v22, 16, v166
  v_and_b32 v23, 0xffff0000, v166
  v_cvt_pk_bf16_f32 v167, v24, v25
  v_lshlrev_b32 v24, 16, v167
  v_and_b32 v25, 0xffff0000, v167
  v_cvt_pk_bf16_f32 v164, v26, v27
  v_lshlrev_b32 v26, 16, v164
  v_and_b32 v27, 0xffff0000, v164
  v_cvt_pk_bf16_f32 v165, v28, v29
  v_lshlrev_b32 v28, 16, v165
  v_and_b32 v29, 0xffff0000, v165
  v_cvt_pk_bf16_f32 v166, v30, v31
  v_lshlrev_b32 v30, 16, v166
  v_and_b32 v31, 0xffff0000, v166
  v_cvt_pk_bf16_f32 v167, v32, v33
  v_lshlrev_b32 v32, 16, v167
  v_and_b32 v33, 0xffff0000, v167
  v_cvt_pk_bf16_f32 v164, v34, v35
  v_lshlrev_b32 v34, 16, v164
  v_and_b32 v35, 0xffff0000, v164
  v_cvt_pk_bf16_f32 v165, v36, v37
  v_lshlrev_b32 v36, 16, v165
  v_and_b32 v37, 0xffff0000, v165
  v_cvt_pk_bf16_f32 v166, v38, v39
  v_lshlrev_b32 v38, 16, v166
  v_and_b32 v39, 0xffff0000, v166
  v_cvt_pk_bf16_f32 v167, v40, v41
  v_lshlrev_b32 v40, 16, v167
  v_and_b32 v41, 0xffff0000, v167
  v_pk_mul_f32 v[2:3], v[2:3], v[86:87]
  v_pk_mul_f32 v[4:5], v[4:5], v[86:87]
  v_pk_mul_f32 v[6:7], v[6:7], v[86:87]
  v_pk_mul_f32 v[8:9], v[8:9], v[86:87]
  v_pk_mul_f32 v[10:11], v[10:11], v[86:87]
  v_pk_mul_f32 v[12:13], v[12:13], v[86:87]
  v_pk_mul_f32 v[14:15], v[14:15], v[86:87]
  v_pk_mul_f32 v[16:17], v[16:17], v[86:87]
  v_pk_mul_f32 v[18:19], v[18:19], v[86:87]
  v_pk_mul_f32 v[20:21], v[20:21], v[86:87]
  v_pk_mul_f32 v[22:23], v[22:23], v[86:87]
  v_pk_mul_f32 v[24:25], v[24:25], v[86:87]
  v_pk_mul_f32 v[26:27], v[26:27], v[86:87]
  v_pk_mul_f32 v[28:29], v[28:29], v[86:87]
  v_pk_mul_f32 v[30:31], v[30:31], v[86:87]
  v_pk_mul_f32 v[32:33], v[32:33], v[86:87]
  v_pk_mul_f32 v[34:35], v[34:35], v[86:87]
  v_pk_mul_f32 v[36:37], v[36:37], v[86:87]
  v_pk_mul_f32 v[38:39], v[38:39], v[86:87]
  v_pk_mul_f32 v[40:41], v[40:41], v[86:87]
  v_cvt_pk_bf16_f32 v120, v2, v3
  v_cvt_pk_bf16_f32 v121, v4, v5
  v_cvt_pk_bf16_f32 v122, v6, v7
  v_cvt_pk_bf16_f32 v123, v8, v9
  v_cvt_pk_bf16_f32 v124, v10, v11
  v_cvt_pk_bf16_f32 v125, v12, v13
  v_cvt_pk_bf16_f32 v126, v14, v15
  v_cvt_pk_bf16_f32 v127, v16, v17
  v_cvt_pk_bf16_f32 v128, v18, v19
  v_cvt_pk_bf16_f32 v129, v20, v21
  v_cvt_pk_bf16_f32 v130, v22, v23
  v_cvt_pk_bf16_f32 v131, v24, v25
  v_cvt_pk_bf16_f32 v132, v26, v27
  v_cvt_pk_bf16_f32 v133, v28, v29
  v_cvt_pk_bf16_f32 v134, v30, v31
  v_cvt_pk_bf16_f32 v135, v32, v33
  v_cvt_pk_bf16_f32 v136, v34, v35
  v_cvt_pk_bf16_f32 v137, v36, v37
  v_cvt_pk_bf16_f32 v138, v38, v39
  v_cvt_pk_bf16_f32 v139, v40, v41
  s_cmp_lg_u32 s17, 0
  s_cbranch_scc1 r_g1
  s_lshl_b32 s35, s16, 2
  s_add_u32 s35, s35, 32
  v_mov_b32 v90, 200
  v_mov_b32 v92, 20
  v_writelane_b32 v90, s35, 0
  v_writelane_b32 v92, 1, 0
  s_mov_b32 s34, 0
  s_mov_b64 exec, 3
  s_cmp_eq_u32 s18, 31
  s_cselect_b64 exec, 3, 1
r_gp:
  buffer_load_dword v91, v90, s[12:15], 0 offen sc1
  s_add_u32 s34, s34, 1
  s_cmp_gt_u32 s34, 65536
  s_cbranch_scc1 role_abort
  s_waitcnt vmcnt(0)
  v_cmp_gt_u32 vcc, v92, v91
  s_cbranch_vccz r_gq
  s_sleep 8
  s_branch r_gp
r_gq:
  s_mov_b64 exec, -1
  s_lshl_b32 s35, s16, 8
  s_add_u32 s35, s35, 8320
  v_mov_b32 v90, s35
  v_mov_b32 v92, 1
  s_cmp_lg_u32 s18, 31
  s_cbranch_scc1 r_g2
  buffer_store_dword v92, v90, s[8:11], 0 offen
  s_branch r_g1
r_g2:
  s_mov_b32 s34, 0
pw_9:
  buffer_load_dword v91, v90, s[8:11], 0 offen sc1
  s_add_u32 s34, s34, 1
  s_cmp_gt_u32 s34, 65536
  s_cbranch_scc1 role_abort
  s_waitcnt vmcnt(0)
pc_11:
  v_cmp_gt_u32 vcc, 1, v91
  s_nop 0
  s_and_b32 vcc_lo, vcc_lo, 0x1
  s_and_b32 vcc_hi, vcc_hi, 0x0
  s_cmp_eq_u64 vcc, 0
  s_cbranch_scc1 po_10
  s_sleep 1
  s_branch pw_9
po_10:
r_g1:
  s_barrier
  s_cmp_lg_u32 s32, 9
  s_cbranch_scc1 r_g0
r_g0:
  s_mov_b32 s35, 65536
  s_mov_b32 s33, s54
  buffer_load_dwordx4 v[176:179], v162, s[8:11], s35 offen offset:0 sc1
  buffer_load_dwordx4 v[180:183], v162, s[8:11], s35 offen offset:512 sc1
  buffer_load_dwordx4 v[184:187], v162, s[8:11], s35 offen offset:1024 sc1
  buffer_load_dwordx4 v[188:191], v162, s[8:11], s35 offen offset:1536 sc1
  buffer_load_dwordx4 v[192:195], v162, s[8:11], s35 offen offset:2048 sc1
  s_waitcnt vmcnt(4)
  v_add_f32 v176, v163, v176
  v_add_f32 v177, v163, v177
  v_add_f32 v178, v163, v178
  v_add_f32 v179, v163, v179
  v_cvt_pk_bf16_f32 v90, v176, v177
  v_lshlrev_b32 v176, 16, v90
  v_and_b32 v177, 0xffff0000, v90
  v_cvt_pk_bf16_f32 v91, v178, v179
  v_lshlrev_b32 v178, 16, v91
  v_and_b32 v179, 0xffff0000, v91
  s_waitcnt vmcnt(3)
  v_add_f32 v180, v163, v180
  v_add_f32 v181, v163, v181
  v_add_f32 v182, v163, v182
  v_add_f32 v183, v163, v183
  v_cvt_pk_bf16_f32 v90, v180, v181
  v_lshlrev_b32 v180, 16, v90
  v_and_b32 v181, 0xffff0000, v90
  v_cvt_pk_bf16_f32 v91, v182, v183
  v_lshlrev_b32 v182, 16, v91
  v_and_b32 v183, 0xffff0000, v91
  s_waitcnt vmcnt(2)
  v_add_f32 v184, v163, v184
  v_add_f32 v185, v163, v185
  v_add_f32 v186, v163, v186
  v_add_f32 v187, v163, v187
  v_cvt_pk_bf16_f32 v90, v184, v185
  v_lshlrev_b32 v184, 16, v90
  v_and_b32 v185, 0xffff0000, v90
  v_cvt_pk_bf16_f32 v91, v186, v187
  v_lshlrev_b32 v186, 16, v91
  v_and_b32 v187, 0xffff0000, v91
  s_waitcnt vmcnt(1)
  v_add_f32 v188, v163, v188
  v_add_f32 v189, v163, v189
  v_add_f32 v190, v163, v190
  v_add_f32 v191, v163, v191
  v_cvt_pk_bf16_f32 v90, v188, v189
  v_lshlrev_b32 v188, 16, v90
  v_and_b32 v189, 0xffff0000, v90
  v_cvt_pk_bf16_f32 v91, v190, v191
  v_lshlrev_b32 v190, 16, v91
  v_and_b32 v191, 0xffff0000, v91
  s_waitcnt vmcnt(0)
  v_add_f32 v192, v163, v192
  v_add_f32 v193, v163, v193
  v_add_f32 v194, v163, v194
  v_add_f32 v195, v163, v195
  v_cvt_pk_bf16_f32 v90, v192, v193
  v_lshlrev_b32 v192, 16, v90
  v_and_b32 v193, 0xffff0000, v90
  v_cvt_pk_bf16_f32 v91, v194, v195
  v_lshlrev_b32 v194, 16, v91
  v_and_b32 v195, 0xffff0000, v91
  v_lshlrev_b32 v2, 16, v100
  v_and_b32 v3, 0xffff0000, v100
  v_lshlrev_b32 v4, 16, v101
  v_and_b32 v5, 0xffff0000, v101
  v_lshlrev_b32 v6, 16, v102
  v_and_b32 v7, 0xffff0000, v102
  v_lshlrev_b32 v8, 16, v103
  v_and_b32 v9, 0xffff0000, v103
  v_mul_f32_dpp v2, v176, v2 quad_perm:[2,2,2,2] row_mask:0xf bank_mask:0xf
  v_mul_f32_dpp v3, v177, v3 quad_perm:[2,2,2,2] row_mask:0xf bank_mask:0xf
  v_mul_f32_dpp v4, v178, v4 quad_perm:[2,2,2,2] row_mask:0xf bank_mask:0xf
  v_mul_f32_dpp v5, v179, v5 quad_perm:[2,2,2,2] row_mask:0xf bank_mask:0xf
  v_mul_f32_dpp v6, v176, v6 quad_perm:[3,3,3,3] row_mask:0xf bank_mask:0xf
  v_mul_f32_dpp v7, v177, v7 quad_perm:[3,3,3,3] row_mask:0xf bank_mask:0xf
  v_mul_f32_dpp v8, v178, v8 quad_perm:[3,3,3,3] row_mask:0xf bank_mask:0xf
  v_mul_f32_dpp v9, v179, v9 quad_perm:[3,3,3,3] row_mask:0xf bank_mask:0xf
  v_cvt_pk_bf16_f32 v164, v2, v3
  v_lshlrev_b32 v2, 16, v164
  v_and_b32 v3, 0xffff0000, v164
  v_cvt_pk_bf16_f32 v165, v4, v5
  v_lshlrev_b32 v4, 16, v165
  v_and_b32 v5, 0xffff0000, v165
  v_cvt_pk_bf16_f32 v166, v6, v7
  v_lshlrev_b32 v6, 16, v166
  v_and_b32 v7, 0xffff0000, v166
  v_cvt_pk_bf16_f32 v167, v8, v9
  v_lshlrev_b32 v8, 16, v167
  v_and_b32 v9, 0xffff0000, v167
  v_add_f32_dpp v2, v176, v2 quad_perm:[0,0,0,0] row_mask:0xf bank_mask:0xf
  v_add_f32_dpp v3, v177, v3 quad_perm:[0,0,0,0] row_mask:0xf bank_mask:0xf
  v_add_f32_dpp v4, v178, v4 quad_perm:[0,0,0,0] row_mask:0xf bank_mask:0xf
  v_add_f32_dpp v5, v179, v5 quad_perm:[0,0,0,0] row_mask:0xf bank_mask:0xf
  v_add_f32_dpp v6, v176, v6 quad_perm:[1,1,1,1] row_mask:0xf bank_mask:0xf
  v_add_f32_dpp v7, v177, v7 quad_perm:[1,1,1,1] row_mask:0xf bank_mask:0xf
  v_add_f32_dpp v8, v178, v8 quad_perm:[1,1,1,1] row_mask:0xf bank_mask:0xf
  v_add_f32_dpp v9, v179, v9 quad_perm:[1,1,1,1] row_mask:0xf bank_mask:0xf
  v_cvt_pk_bf16_f32 v196, v2, v3
  v_cvt_pk_bf16_f32 v197, v4, v5
  v_cvt_pk_bf16_f32 v198, v6, v7
  v_cvt_pk_bf16_f32 v199, v8, v9
  s_add_u32 s35, s38, 0
  buffer_store_dwordx4 v[196:199], v161, s[8:11], s35 offen
  v_lshlrev_b32 v10, 16, v104
  v_and_b32 v11, 0xffff0000, v104
  v_lshlrev_b32 v12, 16, v105
  v_and_b32 v13, 0xffff0000, v105
  v_lshlrev_b32 v14, 16, v106
  v_and_b32 v15, 0xffff0000, v106
  v_lshlrev_b32 v16, 16, v107
  v_and_b32 v17, 0xffff0000, v107
  v_mul_f32_dpp v10, v180, v10 quad_perm:[2,2,2,2] row_mask:0xf bank_mask:0xf
  v_mul_f32_dpp v11, v181, v11 quad_perm:[2,2,2,2] row_mask:0xf bank_mask:0xf
  v_mul_f32_dpp v12, v182, v12 quad_perm:[2,2,2,2] row_mask:0xf bank_mask:0xf
  v_mul_f32_dpp v13, v183, v13 quad_perm:[2,2,2,2] row_mask:0xf bank_mask:0xf
  v_mul_f32_dpp v14, v180, v14 quad_perm:[3,3,3,3] row_mask:0xf bank_mask:0xf
  v_mul_f32_dpp v15, v181, v15 quad_perm:[3,3,3,3] row_mask:0xf bank_mask:0xf
  v_mul_f32_dpp v16, v182, v16 quad_perm:[3,3,3,3] row_mask:0xf bank_mask:0xf
  v_mul_f32_dpp v17, v183, v17 quad_perm:[3,3,3,3] row_mask:0xf bank_mask:0xf
  v_cvt_pk_bf16_f32 v164, v10, v11
  v_lshlrev_b32 v10, 16, v164
  v_and_b32 v11, 0xffff0000, v164
  v_cvt_pk_bf16_f32 v165, v12, v13
  v_lshlrev_b32 v12, 16, v165
  v_and_b32 v13, 0xffff0000, v165
  v_cvt_pk_bf16_f32 v166, v14, v15
  v_lshlrev_b32 v14, 16, v166
  v_and_b32 v15, 0xffff0000, v166
  v_cvt_pk_bf16_f32 v167, v16, v17
  v_lshlrev_b32 v16, 16, v167
  v_and_b32 v17, 0xffff0000, v167
  v_add_f32_dpp v10, v180, v10 quad_perm:[0,0,0,0] row_mask:0xf bank_mask:0xf
  v_add_f32_dpp v11, v181, v11 quad_perm:[0,0,0,0] row_mask:0xf bank_mask:0xf
  v_add_f32_dpp v12, v182, v12 quad_perm:[0,0,0,0] row_mask:0xf bank_mask:0xf
  v_add_f32_dpp v13, v183, v13 quad_perm:[0,0,0,0] row_mask:0xf bank_mask:0xf
  v_add_f32_dpp v14, v180, v14 quad_perm:[1,1,1,1] row_mask:0xf bank_mask:0xf
  v_add_f32_dpp v15, v181, v15 quad_perm:[1,1,1,1] row_mask:0xf bank_mask:0xf
  v_add_f32_dpp v16, v182, v16 quad_perm:[1,1,1,1] row_mask:0xf bank_mask:0xf
  v_add_f32_dpp v17, v183, v17 quad_perm:[1,1,1,1] row_mask:0xf bank_mask:0xf
  v_cvt_pk_bf16_f32 v200, v10, v11
  v_cvt_pk_bf16_f32 v201, v12, v13
  v_cvt_pk_bf16_f32 v202, v14, v15
  v_cvt_pk_bf16_f32 v203, v16, v17
  s_add_u32 s35, s38, 4096
  buffer_store_dwordx4 v[200:203], v161, s[8:11], s35 offen
  v_lshlrev_b32 v18, 16, v108
  v_and_b32 v19, 0xffff0000, v108
  v_lshlrev_b32 v20, 16, v109
  v_and_b32 v21, 0xffff0000, v109
  v_lshlrev_b32 v22, 16, v110
  v_and_b32 v23, 0xffff0000, v110
  v_lshlrev_b32 v24, 16, v111
  v_and_b32 v25, 0xffff0000, v111
  v_mul_f32_dpp v18, v184, v18 quad_perm:[2,2,2,2] row_mask:0xf bank_mask:0xf
  v_mul_f32_dpp v19, v185, v19 quad_perm:[2,2,2,2] row_mask:0xf bank_mask:0xf
  v_mul_f32_dpp v20, v186, v20 quad_perm:[2,2,2,2] row_mask:0xf bank_mask:0xf
  v_mul_f32_dpp v21, v187, v21 quad_perm:[2,2,2,2] row_mask:0xf bank_mask:0xf
  v_mul_f32_dpp v22, v184, v22 quad_perm:[3,3,3,3] row_mask:0xf bank_mask:0xf
  v_mul_f32_dpp v23, v185, v23 quad_perm:[3,3,3,3] row_mask:0xf bank_mask:0xf
  v_mul_f32_dpp v24, v186, v24 quad_perm:[3,3,3,3] row_mask:0xf bank_mask:0xf
  v_mul_f32_dpp v25, v187, v25 quad_perm:[3,3,3,3] row_mask:0xf bank_mask:0xf
  v_cvt_pk_bf16_f32 v164, v18, v19
  v_lshlrev_b32 v18, 16, v164
  v_and_b32 v19, 0xffff0000, v164
  v_cvt_pk_bf16_f32 v165, v20, v21
  v_lshlrev_b32 v20, 16, v165
  v_and_b32 v21, 0xffff0000, v165
  v_cvt_pk_bf16_f32 v166, v22, v23
  v_lshlrev_b32 v22, 16, v166
  v_and_b32 v23, 0xffff0000, v166
  v_cvt_pk_bf16_f32 v167, v24, v25
  v_lshlrev_b32 v24, 16, v167
  v_and_b32 v25, 0xffff0000, v167
  v_add_f32_dpp v18, v184, v18 quad_perm:[0,0,0,0] row_mask:0xf bank_mask:0xf
  v_add_f32_dpp v19, v185, v19 quad_perm:[0,0,0,0] row_mask:0xf bank_mask:0xf
  v_add_f32_dpp v20, v186, v20 quad_perm:[0,0,0,0] row_mask:0xf bank_mask:0xf
  v_add_f32_dpp v21, v187, v21 quad_perm:[0,0,0,0] row_mask:0xf bank_mask:0xf
  v_add_f32_dpp v22, v184, v22 quad_perm:[1,1,1,1] row_mask:0xf bank_mask:0xf
  v_add_f32_dpp v23, v185, v23 quad_perm:[1,1,1,1] row_mask:0xf bank_mask:0xf
  v_add_f32_dpp v24, v186, v24 quad_perm:[1,1,1,1] row_mask:0xf bank_mask:0xf
  v_add_f32_dpp v25, v187, v25 quad_perm:[1,1,1,1] row_mask:0xf bank_mask:0xf
  v_cvt_pk_bf16_f32 v204, v18, v19
  v_cvt_pk_bf16_f32 v205, v20, v21
  v_cvt_pk_bf16_f32 v206, v22, v23
  v_cvt_pk_bf16_f32 v207, v24, v25
  s_add_u32 s35, s38, 8192
  buffer_store_dwordx4 v[204:207], v161, s[8:11], s35 offen
  v_lshlrev_b32 v26, 16, v112
  v_and_b32 v27, 0xffff0000, v112
  v_lshlrev_b32 v28, 16, v113
  v_and_b32 v29, 0xffff0000, v113
  v_lshlrev_b32 v30, 16, v114
  v_and_b32 v31, 0xffff0000, v114
  v_lshlrev_b32 v32, 16, v115
  v_and_b32 v33, 0xffff0000, v115
  v_mul_f32_dpp v26, v188, v26 quad_perm:[2,2,2,2] row_mask:0xf bank_mask:0xf
  v_mul_f32_dpp v27, v189, v27 quad_perm:[2,2,2,2] row_mask:0xf bank_mask:0xf
  v_mul_f32_dpp v28, v190, v28 quad_perm:[2,2,2,2] row_mask:0xf bank_mask:0xf
  v_mul_f32_dpp v29, v191, v29 quad_perm:[2,2,2,2] row_mask:0xf bank_mask:0xf
  v_mul_f32_dpp v30, v188, v30 quad_perm:[3,3,3,3] row_mask:0xf bank_mask:0xf
  v_mul_f32_dpp v31, v189, v31 quad_perm:[3,3,3,3] row_mask:0xf bank_mask:0xf
  v_mul_f32_dpp v32, v190, v32 quad_perm:[3,3,3,3] row_mask:0xf bank_mask:0xf
  v_mul_f32_dpp v33, v191, v33 quad_perm:[3,3,3,3] row_mask:0xf bank_mask:0xf
  v_cvt_pk_bf16_f32 v164, v26, v27
  v_lshlrev_b32 v26, 16, v164
  v_and_b32 v27, 0xffff0000, v164
  v_cvt_pk_bf16_f32 v165, v28, v29
  v_lshlrev_b32 v28, 16, v165
  v_and_b32 v29, 0xffff0000, v165
  v_cvt_pk_bf16_f32 v166, v30, v31
  v_lshlrev_b32 v30, 16, v166
  v_and_b32 v31, 0xffff0000, v166
  v_cvt_pk_bf16_f32 v167, v32, v33
  v_lshlrev_b32 v32, 16, v167
  v_and_b32 v33, 0xffff0000, v167
  v_add_f32_dpp v26, v188, v26 quad_perm:[0,0,0,0] row_mask:0xf bank_mask:0xf
  v_add_f32_dpp v27, v189, v27 quad_perm:[0,0,0,0] row_mask:0xf bank_mask:0xf
  v_add_f32_dpp v28, v190, v28 quad_perm:[0,0,0,0] row_mask:0xf bank_mask:0xf
  v_add_f32_dpp v29, v191, v29 quad_perm:[0,0,0,0] row_mask:0xf bank_mask:0xf
  v_add_f32_dpp v30, v188, v30 quad_perm:[1,1,1,1] row_mask:0xf bank_mask:0xf
  v_add_f32_dpp v31, v189, v31 quad_perm:[1,1,1,1] row_mask:0xf bank_mask:0xf
  v_add_f32_dpp v32, v190, v32 quad_perm:[1,1,1,1] row_mask:0xf bank_mask:0xf
  v_add_f32_dpp v33, v191, v33 quad_perm:[1,1,1,1] row_mask:0xf bank_mask:0xf
  v_cvt_pk_bf16_f32 v208, v26, v27
  v_cvt_pk_bf16_f32 v209, v28, v29
  v_cvt_pk_bf16_f32 v210, v30, v31
  v_cvt_pk_bf16_f32 v211, v32, v33
  s_add_u32 s35, s38, 12288
  buffer_store_dwordx4 v[208:211], v161, s[8:11], s35 offen
  v_lshlrev_b32 v34, 16, v116
  v_and_b32 v35, 0xffff0000, v116
  v_lshlrev_b32 v36, 16, v117
  v_and_b32 v37, 0xffff0000, v117
  v_lshlrev_b32 v38, 16, v118
  v_and_b32 v39, 0xffff0000, v118
  v_lshlrev_b32 v40, 16, v119
  v_and_b32 v41, 0xffff0000, v119
  v_mul_f32_dpp v34, v192, v34 quad_perm:[2,2,2,2] row_mask:0xf bank_mask:0xf
  v_mul_f32_dpp v35, v193, v35 quad_perm:[2,2,2,2] row_mask:0xf bank_mask:0xf
  v_mul_f32_dpp v36, v194, v36 quad_perm:[2,2,2,2] row_mask:0xf bank_mask:0xf
  v_mul_f32_dpp v37, v195, v37 quad_perm:[2,2,2,2] row_mask:0xf bank_mask:0xf
  v_mul_f32_dpp v38, v192, v38 quad_perm:[3,3,3,3] row_mask:0xf bank_mask:0xf
  v_mul_f32_dpp v39, v193, v39 quad_perm:[3,3,3,3] row_mask:0xf bank_mask:0xf
  v_mul_f32_dpp v40, v194, v40 quad_perm:[3,3,3,3] row_mask:0xf bank_mask:0xf
  v_mul_f32_dpp v41, v195, v41 quad_perm:[3,3,3,3] row_mask:0xf bank_mask:0xf
  v_cvt_pk_bf16_f32 v164, v34, v35
  v_lshlrev_b32 v34, 16, v164
  v_and_b32 v35, 0xffff0000, v164
  v_cvt_pk_bf16_f32 v165, v36, v37
  v_lshlrev_b32 v36, 16, v165
  v_and_b32 v37, 0xffff0000, v165
  v_cvt_pk_bf16_f32 v166, v38, v39
  v_lshlrev_b32 v38, 16, v166
  v_and_b32 v39, 0xffff0000, v166
  v_cvt_pk_bf16_f32 v167, v40, v41
  v_lshlrev_b32 v40, 16, v167
  v_and_b32 v41, 0xffff0000, v167
  v_add_f32_dpp v34, v192, v34 quad_perm:[0,0,0,0] row_mask:0xf bank_mask:0xf
  v_add_f32_dpp v35, v193, v35 quad_perm:[0,0,0,0] row_mask:0xf bank_mask:0xf
  v_add_f32_dpp v36, v194, v36 quad_perm:[0,0,0,0] row_mask:0xf bank_mask:0xf
  v_add_f32_dpp v37, v195, v37 quad_perm:[0,0,0,0] row_mask:0xf bank_mask:0xf
  v_add_f32_dpp v38, v192, v38 quad_perm:[1,1,1,1] row_mask:0xf bank_mask:0xf
  v_add_f32_dpp v39, v193, v39 quad_perm:[1,1,1,1] row_mask:0xf bank_mask:0xf
  v_add_f32_dpp v40, v194, v40 quad_perm:[1,1,1,1] row_mask:0xf bank_mask:0xf
  v_add_f32_dpp v41, v195, v41 quad_perm:[1,1,1,1] row_mask:0xf bank_mask:0xf
  v_cvt_pk_bf16_f32 v212, v34, v35
  v_cvt_pk_bf16_f32 v213, v36, v37
  v_cvt_pk_bf16_f32 v214, v38, v39
  v_cvt_pk_bf16_f32 v215, v40, v41
  s_add_u32 s35, s38, 16384
  buffer_store_dwordx4 v[212:215], v161, s[8:11], s35 offen
  s_add_u32 s36, s41, 24
  s_cmp_lt_u32 s41, 24
  s_cselect_b32 s36, s39, s36
  s_add_u32 s41, s41, 3
  s_cmp_lt_u32 s41, 24
  s_cselect_b32 s41, s41, s36
  s_min_u32 s41, s41, 127
  s_mul_i32 s38, s16, 2621440
  s_cmp_lt_u32 s41, 24
  s_cselect_b32 s38, s38, 0
  s_mul_i32 s36, s41, 20480
  s_add_u32 s38, s38, s36
  s_lshl_b32 s36, s17, 6
  s_add_u32 s38, s38, s36
  s_add_u32 s38, s38, 247463936
  s_add_u32 s33, s33, 3
  v_lshlrev_b32 v2, 16, v120
  v_and_b32 v3, 0xffff0000, v120
  v_lshlrev_b32 v4, 16, v121
  v_and_b32 v5, 0xffff0000, v121
  v_lshlrev_b32 v6, 16, v122
  v_and_b32 v7, 0xffff0000, v122
  v_lshlrev_b32 v8, 16, v123
  v_and_b32 v9, 0xffff0000, v123
  v_mul_f32_dpp v2, v176, v2 quad_perm:[2,2,2,2] row_mask:0xf bank_mask:0xf
  v_mul_f32_dpp v3, v177, v3 quad_perm:[2,2,2,2] row_mask:0xf bank_mask:0xf
  v_mul_f32_dpp v4, v178, v4 quad_perm:[2,2,2,2] row_mask:0xf bank_mask:0xf
  v_mul_f32_dpp v5, v179, v5 quad_perm:[2,2,2,2] row_mask:0xf bank_mask:0xf
  v_mul_f32_dpp v6, v176, v6 quad_perm:[3,3,3,3] row_mask:0xf bank_mask:0xf
  v_mul_f32_dpp v7, v177, v7 quad_perm:[3,3,3,3] row_mask:0xf bank_mask:0xf
  v_mul_f32_dpp v8, v178, v8 quad_perm:[3,3,3,3] row_mask:0xf bank_mask:0xf
  v_mul_f32_dpp v9, v179, v9 quad_perm:[3,3,3,3] row_mask:0xf bank_mask:0xf
  v_cvt_pk_bf16_f32 v164, v2, v3
  v_lshlrev_b32 v2, 16, v164
  v_and_b32 v3, 0xffff0000, v164
  v_cvt_pk_bf16_f32 v165, v4, v5
  v_lshlrev_b32 v4, 16, v165
  v_and_b32 v5, 0xffff0000, v165
  v_cvt_pk_bf16_f32 v166, v6, v7
  v_lshlrev_b32 v6, 16, v166
  v_and_b32 v7, 0xffff0000, v166
  v_cvt_pk_bf16_f32 v167, v8, v9
  v_lshlrev_b32 v8, 16, v167
  v_and_b32 v9, 0xffff0000, v167
  v_add_f32_dpp v2, v176, v2 quad_perm:[0,0,0,0] row_mask:0xf bank_mask:0xf
  v_add_f32_dpp v3, v177, v3 quad_perm:[0,0,0,0] row_mask:0xf bank_mask:0xf
  v_add_f32_dpp v4, v178, v4 quad_perm:[0,0,0,0] row_mask:0xf bank_mask:0xf
  v_add_f32_dpp v5, v179, v5 quad_perm:[0,0,0,0] row_mask:0xf bank_mask:0xf
  v_add_f32_dpp v6, v176, v6 quad_perm:[1,1,1,1] row_mask:0xf bank_mask:0xf
  v_add_f32_dpp v7, v177, v7 quad_perm:[1,1,1,1] row_mask:0xf bank_mask:0xf
  v_add_f32_dpp v8, v178, v8 quad_perm:[1,1,1,1] row_mask:0xf bank_mask:0xf
  v_add_f32_dpp v9, v179, v9 quad_perm:[1,1,1,1] row_mask:0xf bank_mask:0xf
  v_cvt_pk_bf16_f32 v196, v2, v3
  v_cvt_pk_bf16_f32 v197, v4, v5
  v_cvt_pk_bf16_f32 v198, v6, v7
  v_cvt_pk_bf16_f32 v199, v8, v9
  s_sub_u32 s36, s33, 0
  s_min_u32 s36, s36, 24
  v_mov_b32 v92, s36
  s_waitcnt vmcnt(0)
  buffer_store_dword v92, v228, s[8:11], 0 offen
  s_add_u32 s35, s38, 0
  buffer_store_dwordx4 v[196:199], v161, s[8:11], s35 offen
  v_lshlrev_b32 v10, 16, v124
  v_and_b32 v11, 0xffff0000, v124
  v_lshlrev_b32 v12, 16, v125
  v_and_b32 v13, 0xffff0000, v125
  v_lshlrev_b32 v14, 16, v126
  v_and_b32 v15, 0xffff0000, v126
  v_lshlrev_b32 v16, 16, v127
  v_and_b32 v17, 0xffff0000, v127
  v_mul_f32_dpp v10, v180, v10 quad_perm:[2,2,2,2] row_mask:0xf bank_mask:0xf
  v_mul_f32_dpp v11, v181, v11 quad_perm:[2,2,2,2] row_mask:0xf bank_mask:0xf
  v_mul_f32_dpp v12, v182, v12 quad_perm:[2,2,2,2] row_mask:0xf bank_mask:0xf
  v_mul_f32_dpp v13, v183, v13 quad_perm:[2,2,2,2] row_mask:0xf bank_mask:0xf
  v_mul_f32_dpp v14, v180, v14 quad_perm:[3,3,3,3] row_mask:0xf bank_mask:0xf
  v_mul_f32_dpp v15, v181, v15 quad_perm:[3,3,3,3] row_mask:0xf bank_mask:0xf
  v_mul_f32_dpp v16, v182, v16 quad_perm:[3,3,3,3] row_mask:0xf bank_mask:0xf
  v_mul_f32_dpp v17, v183, v17 quad_perm:[3,3,3,3] row_mask:0xf bank_mask:0xf
  v_cvt_pk_bf16_f32 v164, v10, v11
  v_lshlrev_b32 v10, 16, v164
  v_and_b32 v11, 0xffff0000, v164
  v_cvt_pk_bf16_f32 v165, v12, v13
  v_lshlrev_b32 v12, 16, v165
  v_and_b32 v13, 0xffff0000, v165
  v_cvt_pk_bf16_f32 v166, v14, v15
  v_lshlrev_b32 v14, 16, v166
  v_and_b32 v15, 0xffff0000, v166
  v_cvt_pk_bf16_f32 v167, v16, v17
  v_lshlrev_b32 v16, 16, v167
  v_and_b32 v17, 0xffff0000, v167
  v_add_f32_dpp v10, v180, v10 quad_perm:[0,0,0,0] row_mask:0xf bank_mask:0xf
  v_add_f32_dpp v11, v181, v11 quad_perm:[0,0,0,0] row_mask:0xf bank_mask:0xf
  v_add_f32_dpp v12, v182, v12 quad_perm:[0,0,0,0] row_mask:0xf bank_mask:0xf
  v_add_f32_dpp v13, v183, v13 quad_perm:[0,0,0,0] row_mask:0xf bank_mask:0xf
  v_add_f32_dpp v14, v180, v14 quad_perm:[1,1,1,1] row_mask:0xf bank_mask:0xf
  v_add_f32_dpp v15, v181, v15 quad_perm:[1,1,1,1] row_mask:0xf bank_mask:0xf
  v_add_f32_dpp v16, v182, v16 quad_perm:[1,1,1,1] row_mask:0xf bank_mask:0xf
  v_add_f32_dpp v17, v183, v17 quad_perm:[1,1,1,1] row_mask:0xf bank_mask:0xf
  v_cvt_pk_bf16_f32 v200, v10, v11
  v_cvt_pk_bf16_f32 v201, v12, v13
  v_cvt_pk_bf16_f32 v202, v14, v15
  v_cvt_pk_bf16_f32 v203, v16, v17
  s_add_u32 s35, s38, 4096
  buffer_store_dwordx4 v[200:203], v161, s[8:11], s35 offen
  v_lshlrev_b32 v18, 16, v128
  v_and_b32 v19, 0xffff0000, v128
  v_lshlrev_b32 v20, 16, v129
  v_and_b32 v21, 0xffff0000, v129
  v_lshlrev_b32 v22, 16, v130
  v_and_b32 v23, 0xffff0000, v130
  v_lshlrev_b32 v24, 16, v131
  v_and_b32 v25, 0xffff0000, v131
  v_mul_f32_dpp v18, v184, v18 quad_perm:[2,2,2,2] row_mask:0xf bank_mask:0xf
  v_mul_f32_dpp v19, v185, v19 quad_perm:[2,2,2,2] row_mask:0xf bank_mask:0xf
  v_mul_f32_dpp v20, v186, v20 quad_perm:[2,2,2,2] row_mask:0xf bank_mask:0xf
  v_mul_f32_dpp v21, v187, v21 quad_perm:[2,2,2,2] row_mask:0xf bank_mask:0xf
  v_mul_f32_dpp v22, v184, v22 quad_perm:[3,3,3,3] row_mask:0xf bank_mask:0xf
  v_mul_f32_dpp v23, v185, v23 quad_perm:[3,3,3,3] row_mask:0xf bank_mask:0xf
  v_mul_f32_dpp v24, v186, v24 quad_perm:[3,3,3,3] row_mask:0xf bank_mask:0xf
  v_mul_f32_dpp v25, v187, v25 quad_perm:[3,3,3,3] row_mask:0xf bank_mask:0xf
  v_cvt_pk_bf16_f32 v164, v18, v19
  v_lshlrev_b32 v18, 16, v164
  v_and_b32 v19, 0xffff0000, v164
  v_cvt_pk_bf16_f32 v165, v20, v21
  v_lshlrev_b32 v20, 16, v165
  v_and_b32 v21, 0xffff0000, v165
  v_cvt_pk_bf16_f32 v166, v22, v23
  v_lshlrev_b32 v22, 16, v166
  v_and_b32 v23, 0xffff0000, v166
  v_cvt_pk_bf16_f32 v167, v24, v25
  v_lshlrev_b32 v24, 16, v167
  v_and_b32 v25, 0xffff0000, v167
  v_add_f32_dpp v18, v184, v18 quad_perm:[0,0,0,0] row_mask:0xf bank_mask:0xf
  v_add_f32_dpp v19, v185, v19 quad_perm:[0,0,0,0] row_mask:0xf bank_mask:0xf
  v_add_f32_dpp v20, v186, v20 quad_perm:[0,0,0,0] row_mask:0xf bank_mask:0xf
  v_add_f32_dpp v21, v187, v21 quad_perm:[0,0,0,0] row_mask:0xf bank_mask:0xf
  v_add_f32_dpp v22, v184, v22 quad_perm:[1,1,1,1] row_mask:0xf bank_mask:0xf
  v_add_f32_dpp v23, v185, v23 quad_perm:[1,1,1,1] row_mask:0xf bank_mask:0xf
  v_add_f32_dpp v24, v186, v24 quad_perm:[1,1,1,1] row_mask:0xf bank_mask:0xf
  v_add_f32_dpp v25, v187, v25 quad_perm:[1,1,1,1] row_mask:0xf bank_mask:0xf
  v_cvt_pk_bf16_f32 v204, v18, v19
  v_cvt_pk_bf16_f32 v205, v20, v21
  v_cvt_pk_bf16_f32 v206, v22, v23
  v_cvt_pk_bf16_f32 v207, v24, v25
  s_add_u32 s35, s38, 8192
  buffer_store_dwordx4 v[204:207], v161, s[8:11], s35 offen
  v_lshlrev_b32 v26, 16, v132
  v_and_b32 v27, 0xffff0000, v132
  v_lshlrev_b32 v28, 16, v133
  v_and_b32 v29, 0xffff0000, v133
  v_lshlrev_b32 v30, 16, v134
  v_and_b32 v31, 0xffff0000, v134
  v_lshlrev_b32 v32, 16, v135
  v_and_b32 v33, 0xffff0000, v135
  v_mul_f32_dpp v26, v188, v26 quad_perm:[2,2,2,2] row_mask:0xf bank_mask:0xf
  v_mul_f32_dpp v27, v189, v27 quad_perm:[2,2,2,2] row_mask:0xf bank_mask:0xf
  v_mul_f32_dpp v28, v190, v28 quad_perm:[2,2,2,2] row_mask:0xf bank_mask:0xf
  v_mul_f32_dpp v29, v191, v29 quad_perm:[2,2,2,2] row_mask:0xf bank_mask:0xf
  v_mul_f32_dpp v30, v188, v30 quad_perm:[3,3,3,3] row_mask:0xf bank_mask:0xf
  v_mul_f32_dpp v31, v189, v31 quad_perm:[3,3,3,3] row_mask:0xf bank_mask:0xf
  v_mul_f32_dpp v32, v190, v32 quad_perm:[3,3,3,3] row_mask:0xf bank_mask:0xf
  v_mul_f32_dpp v33, v191, v33 quad_perm:[3,3,3,3] row_mask:0xf bank_mask:0xf
  v_cvt_pk_bf16_f32 v164, v26, v27
  v_lshlrev_b32 v26, 16, v164
  v_and_b32 v27, 0xffff0000, v164
  v_cvt_pk_bf16_f32 v165, v28, v29
  v_lshlrev_b32 v28, 16, v165
  v_and_b32 v29, 0xffff0000, v165
  v_cvt_pk_bf16_f32 v166, v30, v31
  v_lshlrev_b32 v30, 16, v166
  v_and_b32 v31, 0xffff0000, v166
  v_cvt_pk_bf16_f32 v167, v32, v33
  v_lshlrev_b32 v32, 16, v167
  v_and_b32 v33, 0xffff0000, v167
  v_add_f32_dpp v26, v188, v26 quad_perm:[0,0,0,0] row_mask:0xf bank_mask:0xf
  v_add_f32_dpp v27, v189, v27 quad_perm:[0,0,0,0] row_mask:0xf bank_mask:0xf
  v_add_f32_dpp v28, v190, v28 quad_perm:[0,0,0,0] row_mask:0xf bank_mask:0xf
  v_add_f32_dpp v29, v191, v29 quad_perm:[0,0,0,0] row_mask:0xf bank_mask:0xf
  v_add_f32_dpp v30, v188, v30 quad_perm:[1,1,1,1] row_mask:0xf bank_mask:0xf
  v_add_f32_dpp v31, v189, v31 quad_perm:[1,1,1,1] row_mask:0xf bank_mask:0xf
  v_add_f32_dpp v32, v190, v32 quad_perm:[1,1,1,1] row_mask:0xf bank_mask:0xf
  v_add_f32_dpp v33, v191, v33 quad_perm:[1,1,1,1] row_mask:0xf bank_mask:0xf
  v_cvt_pk_bf16_f32 v208, v26, v27
  v_cvt_pk_bf16_f32 v209, v28, v29
  v_cvt_pk_bf16_f32 v210, v30, v31
  v_cvt_pk_bf16_f32 v211, v32, v33
  s_add_u32 s35, s38, 12288
  buffer_store_dwordx4 v[208:211], v161, s[8:11], s35 offen
  v_lshlrev_b32 v34, 16, v136
  v_and_b32 v35, 0xffff0000, v136
  v_lshlrev_b32 v36, 16, v137
  v_and_b32 v37, 0xffff0000, v137
  v_lshlrev_b32 v38, 16, v138
  v_and_b32 v39, 0xffff0000, v138
  v_lshlrev_b32 v40, 16, v139
  v_and_b32 v41, 0xffff0000, v139
  v_mul_f32_dpp v34, v192, v34 quad_perm:[2,2,2,2] row_mask:0xf bank_mask:0xf
  v_mul_f32_dpp v35, v193, v35 quad_perm:[2,2,2,2] row_mask:0xf bank_mask:0xf
  v_mul_f32_dpp v36, v194, v36 quad_perm:[2,2,2,2] row_mask:0xf bank_mask:0xf
  v_mul_f32_dpp v37, v195, v37 quad_perm:[2,2,2,2] row_mask:0xf bank_mask:0xf
  v_mul_f32_dpp v38, v192, v38 quad_perm:[3,3,3,3] row_mask:0xf bank_mask:0xf
  v_mul_f32_dpp v39, v193, v39 quad_perm:[3,3,3,3] row_mask:0xf bank_mask:0xf
  v_mul_f32_dpp v40, v194, v40 quad_perm:[3,3,3,3] row_mask:0xf bank_mask:0xf
  v_mul_f32_dpp v41, v195, v41 quad_perm:[3,3,3,3] row_mask:0xf bank_mask:0xf
  v_cvt_pk_bf16_f32 v164, v34, v35
  v_lshlrev_b32 v34, 16, v164
  v_and_b32 v35, 0xffff0000, v164
  v_cvt_pk_bf16_f32 v165, v36, v37
  v_lshlrev_b32 v36, 16, v165
  v_and_b32 v37, 0xffff0000, v165
  v_cvt_pk_bf16_f32 v166, v38, v39
  v_lshlrev_b32 v38, 16, v166
  v_and_b32 v39, 0xffff0000, v166
  v_cvt_pk_bf16_f32 v167, v40, v41
  v_lshlrev_b32 v40, 16, v167
  v_and_b32 v41, 0xffff0000, v167
  v_add_f32_dpp v34, v192, v34 quad_perm:[0,0,0,0] row_mask:0xf bank_mask:0xf
  v_add_f32_dpp v35, v193, v35 quad_perm:[0,0,0,0] row_mask:0xf bank_mask:0xf
  v_add_f32_dpp v36, v194, v36 quad_perm:[0,0,0,0] row_mask:0xf bank_mask:0xf
  v_add_f32_dpp v37, v195, v37 quad_perm:[0,0,0,0] row_mask:0xf bank_mask:0xf
  v_add_f32_dpp v38, v192, v38 quad_perm:[1,1,1,1] row_mask:0xf bank_mask:0xf
  v_add_f32_dpp v39, v193, v39 quad_perm:[1,1,1,1] row_mask:0xf bank_mask:0xf
  v_add_f32_dpp v40, v194, v40 quad_perm:[1,1,1,1] row_mask:0xf bank_mask:0xf
  v_add_f32_dpp v41, v195, v41 quad_perm:[1,1,1,1] row_mask:0xf bank_mask:0xf
  v_cvt_pk_bf16_f32 v212, v34, v35
  v_cvt_pk_bf16_f32 v213, v36, v37
  v_cvt_pk_bf16_f32 v214, v38, v39
  v_cvt_pk_bf16_f32 v215, v40, v41
  s_add_u32 s35, s38, 16384
  buffer_store_dwordx4 v[212:215], v161, s[8:11], s35 offen
  s_add_u32 s36, s41, 24
  s_cmp_lt_u32 s41, 24
  s_cselect_b32 s36, s39, s36
  s_add_u32 s41, s41, 3
  s_cmp_lt_u32 s41, 24
  s_cselect_b32 s41, s41, s36
  s_min_u32 s41, s41, 127
  s_mul_i32 s38, s16, 2621440
  s_cmp_lt_u32 s41, 24
  s_cselect_b32 s38, s38, 0
  s_mul_i32 s36, s41, 20480
  s_add_u32 s38, s38, s36
  s_lshl_b32 s36, s17, 6
  s_add_u32 s38, s38, s36
  s_add_u32 s38, s38, 247463936
  s_add_u32 s33, s33, 3
  s_sub_u32 s36, s33, 0
  s_min_u32 s36, s36, 24
  v_mov_b32 v92, s36
  s_waitcnt vmcnt(0)
  buffer_store_dword v92, v228, s[8:11], 0 offen
  buffer_load_dwordx2 v[66:67], v160, s[20:23], s37 offen offset:0
  buffer_load_dwordx2 v[68:69], v160, s[20:23], s37 offen offset:32
  buffer_load_dwordx2 v[70:71], v160, s[20:23], s37 offen offset:256
  buffer_load_dwordx2 v[72:73], v160, s[20:23], s37 offen offset:288
  buffer_load_dwordx2 v[74:75], v160, s[20:23], s37 offen offset:512
  buffer_load_dwordx2 v[76:77], v160, s[20:23], s37 offen offset:544
  buffer_load_dwordx2 v[78:79], v160, s[20:23], s37 offen offset:768
  buffer_load_dwordx2 v[80:81], v160, s[20:23], s37 offen offset:800
  buffer_load_dwordx2 v[82:83], v160, s[20:23], s37 offen offset:1024
  buffer_load_dwordx2 v[84:85], v160, s[20:23], s37 offen offset:1056
  s_add_u32 s36, s40, 24
  s_cmp_lt_u32 s40, 24
  s_cselect_b32 s36, s39, s36
  s_add_u32 s40, s40, 3
  s_cmp_lt_u32 s40, 24
  s_cselect_b32 s40, s40, s36
  s_min_u32 s40, s40, 127
  s_mul_i32 s37, s40, 20480
  s_mul_i32 s36, s17, 5120
  s_add_u32 s37, s37, s36
  v_lshlrev_b32 v2, 16, v46
  v_and_b32 v3, 0xffff0000, v46
  v_lshlrev_b32 v4, 16, v47
  v_and_b32 v5, 0xffff0000, v47
  v_lshlrev_b32 v6, 16, v48
  v_and_b32 v7, 0xffff0000, v48
  v_lshlrev_b32 v8, 16, v49
  v_and_b32 v9, 0xffff0000, v49
  v_lshlrev_b32 v10, 16, v50
  v_and_b32 v11, 0xffff0000, v50
  v_lshlrev_b32 v12, 16, v51
  v_and_b32 v13, 0xffff0000, v51
  v_lshlrev_b32 v14, 16, v52
  v_and_b32 v15, 0xffff0000, v52
  v_lshlrev_b32 v16, 16, v53
  v_and_b32 v17, 0xffff0000, v53
  v_lshlrev_b32 v18, 16, v54
  v_and_b32 v19, 0xffff0000, v54
  v_lshlrev_b32 v20, 16, v55
  v_and_b32 v21, 0xffff0000, v55
  v_lshlrev_b32 v22, 16, v56
  v_and_b32 v23, 0xffff0000, v56
  v_lshlrev_b32 v24, 16, v57
  v_and_b32 v25, 0xffff0000, v57
  v_lshlrev_b32 v26, 16, v58
  v_and_b32 v27, 0xffff0000, v58
  v_lshlrev_b32 v28, 16, v59
  v_and_b32 v29, 0xffff0000, v59
  v_lshlrev_b32 v30, 16, v60
  v_and_b32 v31, 0xffff0000, v60
  v_lshlrev_b32 v32, 16, v61
  v_and_b32 v33, 0xffff0000, v61
  v_lshlrev_b32 v34, 16, v62
  v_and_b32 v35, 0xffff0000, v62
  v_lshlrev_b32 v36, 16, v63
  v_and_b32 v37, 0xffff0000, v63
  v_lshlrev_b32 v38, 16, v64
  v_and_b32 v39, 0xffff0000, v64
  v_lshlrev_b32 v40, 16, v65
  v_and_b32 v41, 0xffff0000, v65
  v_pk_add_f32 v[86:87], v[2:3], v[4:5]
  v_pk_add_f32 v[88:89], v[6:7], v[8:9]
  v_pk_add_f32 v[86:87], v[86:87], v[10:11]
  v_pk_add_f32 v[88:89], v[88:89], v[12:13]
  v_pk_add_f32 v[86:87], v[86:87], v[14:15]
  v_pk_add_f32 v[88:89], v[88:89], v[16:17]
  v_pk_add_f32 v[86:87], v[86:87], v[18:19]
  v_pk_add_f32 v[88:89], v[88:89], v[20:21]
  v_pk_add_f32 v[86:87], v[86:87], v[22:23]
  v_pk_add_f32 v[88:89], v[88:89], v[24:25]
  v_pk_add_f32 v[86:87], v[86:87], v[26:27]
  v_pk_add_f32 v[88:89], v[88:89], v[28:29]
  v_pk_add_f32 v[86:87], v[86:87], v[30:31]
  v_pk_add_f32 v[88:89], v[88:89], v[32:33]
  v_pk_add_f32 v[86:87], v[86:87], v[34:35]
  v_pk_add_f32 v[88:89], v[88:89], v[36:37]
  v_pk_add_f32 v[86:87], v[86:87], v[38:39]
  v_pk_add_f32 v[88:89], v[88:89], v[40:41]
  v_pk_add_f32 v[86:87], v[86:87], v[88:89]
  v_add_f32 v86, v86, v87
  s_nop 1
  v_add_f32_dpp v86, v86, v86 row_ror:8 row_mask:0xf bank_mask:0xf
  s_nop 1
  v_add_f32_dpp v86, v86, v86 row_ror:4 row_mask:0xf bank_mask:0xf
  v_mov_b32 v90, v86
  s_nop 1
  v_permlane16_swap_b32 v86, v90
  v_add_f32 v86, v86, v90
  v_mov_b32 v90, v86
  s_nop 1
  v_permlane32_swap_b32 v86, v90
  v_add_f32 v86, v86, v90
  v_mul_f32 v88, 0xbacccccd, v86
  v_mul_f32 v89, 0xbacccccd, v86
  v_pk_add_f32 v[164:165], v[2:3], v[88:89]
  v_pk_add_f32 v[166:167], v[4:5], v[88:89]
  v_pk_mul_f32 v[170:171], v[164:165], v[164:165]
  v_pk_add_f32 v[168:169], v[6:7], v[88:89]
  v_pk_mul_f32 v[86:87], v[166:167], v[166:167]
  v_pk_add_f32 v[164:165], v[8:9], v[88:89]
  v_pk_fma_f32 v[170:171], v[168:169], v[168:169], v[170:171]
  v_pk_add_f32 v[166:167], v[10:11], v[88:89]
  v_pk_fma_f32 v[86:87], v[164:165], v[164:165], v[86:87]
  v_pk_add_f32 v[168:169], v[12:13], v[88:89]
  v_pk_fma_f32 v[170:171], v[166:167], v[166:167], v[170:171]
  v_pk_add_f32 v[164:165], v[14:15], v[88:89]
  v_pk_fma_f32 v[86:87], v[168:169], v[168:169], v[86:87]
  v_pk_add_f32 v[166:167], v[16:17], v[88:89]
  v_pk_fma_f32 v[170:171], v[164:165], v[164:165], v[170:171]
  v_pk_add_f32 v[168:169], v[18:19], v[88:89]
  v_pk_fma_f32 v[86:87], v[166:167], v[166:167], v[86:87]
  v_pk_add_f32 v[164:165], v[20:21], v[88:89]
  v_pk_fma_f32 v[170:171], v[168:169], v[168:169], v[170:171]
  v_pk_add_f32 v[166:167], v[22:23], v[88:89]
  v_pk_fma_f32 v[86:87], v[164:165], v[164:165], v[86:87]
  v_pk_add_f32 v[168:169], v[24:25], v[88:89]
  v_pk_fma_f32 v[170:171], v[166:167], v[166:167], v[170:171]
  v_pk_add_f32 v[164:165], v[26:27], v[88:89]
  v_pk_fma_f32 v[86:87], v[168:169], v[168:169], v[86:87]
  v_pk_add_f32 v[166:167], v[28:29], v[88:89]
  v_pk_fma_f32 v[170:171], v[164:165], v[164:165], v[170:171]
  v_pk_add_f32 v[168:169], v[30:31], v[88:89]
  v_pk_fma_f32 v[86:87], v[166:167], v[166:167], v[86:87]
  v_pk_add_f32 v[164:165], v[32:33], v[88:89]
  v_pk_fma_f32 v[170:171], v[168:169], v[168:169], v[170:171]
  v_pk_add_f32 v[166:167], v[34:35], v[88:89]
  v_pk_fma_f32 v[86:87], v[164:165], v[164:165], v[86:87]
  v_pk_add_f32 v[168:169], v[36:37], v[88:89]
  v_pk_fma_f32 v[170:171], v[166:167], v[166:167], v[170:171]
  v_pk_add_f32 v[164:165], v[38:39], v[88:89]
  v_pk_fma_f32 v[86:87], v[168:169], v[168:169], v[86:87]
  v_pk_add_f32 v[166:167], v[40:41], v[88:89]
  v_pk_fma_f32 v[170:171], v[164:165], v[164:165], v[170:171]
  v_pk_fma_f32 v[86:87], v[166:167], v[166:167], v[86:87]
  v_cvt_pk_bf16_f32 v91, v88, v89
  v_lshlrev_b32 v88, 16, v91
  v_and_b32 v89, 0xffff0000, v91
  v_pk_add_f32 v[86:87], v[86:87], v[170:171]
  v_add_f32 v86, v86, v87
  s_nop 1
  v_add_f32_dpp v86, v86, v86 row_ror:8 row_mask:0xf bank_mask:0xf
  s_nop 1
  v_add_f32_dpp v86, v86, v86 row_ror:4 row_mask:0xf bank_mask:0xf
  v_mov_b32 v90, v86
  s_nop 1
  v_permlane16_swap_b32 v86, v90
  v_add_f32 v86, v86, v90
  v_mov_b32 v90, v86
  s_nop 1
  v_permlane32_swap_b32 v86, v90
  v_add_f32 v86, v86, v90
  v_pk_add_f32 v[2:3], v[2:3], v[88:89]
  v_mul_f32 v86, 0x3acccccd, v86
  v_pk_add_f32 v[4:5], v[4:5], v[88:89]
  v_cvt_pk_bf16_f32 v86, v86, v86
  v_pk_add_f32 v[6:7], v[6:7], v[88:89]
  v_lshlrev_b32 v86, 16, v86
  v_pk_add_f32 v[8:9], v[8:9], v[88:89]
  v_add_f32 v86, 0x3727c5ac, v86
  v_pk_add_f32 v[10:11], v[10:11], v[88:89]
  v_cvt_pk_bf16_f32 v86, v86, v86
  v_pk_add_f32 v[12:13], v[12:13], v[88:89]
  v_lshlrev_b32 v86, 16, v86
  v_pk_add_f32 v[14:15], v[14:15], v[88:89]
  v_sqrt_f32 v86, v86
  v_pk_add_f32 v[16:17], v[16:17], v[88:89]
  v_cvt_pk_bf16_f32 v86, v86, v86
  v_pk_add_f32 v[18:19], v[18:19], v[88:89]
  v_lshlrev_b32 v86, 16, v86
  v_pk_add_f32 v[20:21], v[20:21], v[88:89]
  v_rcp_f32 v86, v86
  v_pk_add_f32 v[22:23], v[22:23], v[88:89]
  v_mov_b32 v87, v86
  v_pk_add_f32 v[24:25], v[24:25], v[88:89]
  v_pk_add_f32 v[26:27], v[26:27], v[88:89]
  v_pk_add_f32 v[28:29], v[28:29], v[88:89]
  v_pk_add_f32 v[30:31], v[30:31], v[88:89]
  v_pk_add_f32 v[32:33], v[32:33], v[88:89]
  v_pk_add_f32 v[34:35], v[34:35], v[88:89]
  v_pk_add_f32 v[36:37], v[36:37], v[88:89]
  v_pk_add_f32 v[38:39], v[38:39], v[88:89]
  v_pk_add_f32 v[40:41], v[40:41], v[88:89]
  v_cvt_pk_bf16_f32 v164, v2, v3
  v_lshlrev_b32 v2, 16, v164
  v_and_b32 v3, 0xffff0000, v164
  v_cvt_pk_bf16_f32 v165, v4, v5
  v_lshlrev_b32 v4, 16, v165
  v_and_b32 v5, 0xffff0000, v165
  v_cvt_pk_bf16_f32 v166, v6, v7
  v_lshlrev_b32 v6, 16, v166
  v_and_b32 v7, 0xffff0000, v166
  v_cvt_pk_bf16_f32 v167, v8, v9
  v_lshlrev_b32 v8, 16, v167
  v_and_b32 v9, 0xffff0000, v167
  v_cvt_pk_bf16_f32 v164, v10, v11
  v_lshlrev_b32 v10, 16, v164
  v_and_b32 v11, 0xffff0000, v164
  v_cvt_pk_bf16_f32 v165, v12, v13
  v_lshlrev_b32 v12, 16, v165
  v_and_b32 v13, 0xffff0000, v165
  v_cvt_pk_bf16_f32 v166, v14, v15
  v_lshlrev_b32 v14, 16, v166
  v_and_b32 v15, 0xffff0000, v166
  v_cvt_pk_bf16_f32 v167, v16, v17
  v_lshlrev_b32 v16, 16, v167
  v_and_b32 v17, 0xffff0000, v167
  v_cvt_pk_bf16_f32 v164, v18, v19
  v_lshlrev_b32 v18, 16, v164
  v_and_b32 v19, 0xffff0000, v164
  v_cvt_pk_bf16_f32 v165, v20, v21
  v_lshlrev_b32 v20, 16, v165
  v_and_b32 v21, 0xffff0000, v165
  v_cvt_pk_bf16_f32 v166, v22, v23
  v_lshlrev_b32 v22, 16, v166
  v_and_b32 v23, 0xffff0000, v166
  v_cvt_pk_bf16_f32 v167, v24, v25
  v_lshlrev_b32 v24, 16, v167
  v_and_b32 v25, 0xffff0000, v167
  v_cvt_pk_bf16_f32 v164, v26, v27
  v_lshlrev_b32 v26, 16, v164
  v_and_b32 v27, 0xffff0000, v164
  v_cvt_pk_bf16_f32 v165, v28, v29
  v_lshlrev_b32 v28, 16, v165
  v_and_b32 v29, 0xffff0000, v165
  v_cvt_pk_bf16_f32 v166, v30, v31
  v_lshlrev_b32 v30, 16, v166
  v_and_b32 v31, 0xffff0000, v166
  v_cvt_pk_bf16_f32 v167, v32, v33
  v_lshlrev_b32 v32, 16, v167
  v_and_b32 v33, 0xffff0000, v167
  v_cvt_pk_bf16_f32 v164, v34, v35
  v_lshlrev_b32 v34, 16, v164
  v_and_b32 v35, 0xffff0000, v164
  v_cvt_pk_bf16_f32 v165, v36, v37
  v_lshlrev_b32 v36, 16, v165
  v_and_b32 v37, 0xffff0000, v165
  v_cvt_pk_bf16_f32 v166, v38, v39
  v_lshlrev_b32 v38, 16, v166
  v_and_b32 v39, 0xffff0000, v166
  v_cvt_pk_bf16_f32 v167, v40, v41
  v_lshlrev_b32 v40, 16, v167
  v_and_b32 v41, 0xffff0000, v167
  v_pk_mul_f32 v[2:3], v[2:3], v[86:87]
  v_pk_mul_f32 v[4:5], v[4:5], v[86:87]
  v_pk_mul_f32 v[6:7], v[6:7], v[86:87]
  v_pk_mul_f32 v[8:9], v[8:9], v[86:87]
  v_pk_mul_f32 v[10:11], v[10:11], v[86:87]
  v_pk_mul_f32 v[12:13], v[12:13], v[86:87]
  v_pk_mul_f32 v[14:15], v[14:15], v[86:87]
  v_pk_mul_f32 v[16:17], v[16:17], v[86:87]
  v_pk_mul_f32 v[18:19], v[18:19], v[86:87]
  v_pk_mul_f32 v[20:21], v[20:21], v[86:87]
  v_pk_mul_f32 v[22:23], v[22:23], v[86:87]
  v_pk_mul_f32 v[24:25], v[24:25], v[86:87]
  v_pk_mul_f32 v[26:27], v[26:27], v[86:87]
  v_pk_mul_f32 v[28:29], v[28:29], v[86:87]
  v_pk_mul_f32 v[30:31], v[30:31], v[86:87]
  v_pk_mul_f32 v[32:33], v[32:33], v[86:87]
  v_pk_mul_f32 v[34:35], v[34:35], v[86:87]
  v_pk_mul_f32 v[36:37], v[36:37], v[86:87]
  v_pk_mul_f32 v[38:39], v[38:39], v[86:87]
  v_pk_mul_f32 v[40:41], v[40:41], v[86:87]
  v_cvt_pk_bf16_f32 v164, v2, v3
  v_lshlrev_b32 v2, 16, v164
  v_and_b32 v3, 0xffff0000, v164
  v_cvt_pk_bf16_f32 v165, v4, v5
  v_lshlrev_b32 v4, 16, v165
  v_and_b32 v5, 0xffff0000, v165
  v_cvt_pk_bf16_f32 v166, v6, v7
  v_lshlrev_b32 v6, 16, v166
  v_and_b32 v7, 0xffff0000, v166
  v_cvt_pk_bf16_f32 v167, v8, v9
  v_lshlrev_b32 v8, 16, v167
  v_and_b32 v9, 0xffff0000, v167
  v_cvt_pk_bf16_f32 v164, v10, v11
  v_lshlrev_b32 v10, 16, v164
  v_and_b32 v11, 0xffff0000, v164
  v_cvt_pk_bf16_f32 v165, v12, v13
  v_lshlrev_b32 v12, 16, v165
  v_and_b32 v13, 0xffff0000, v165
  v_cvt_pk_bf16_f32 v166, v14, v15
  v_lshlrev_b32 v14, 16, v166
  v_and_b32 v15, 0xffff0000, v166
  v_cvt_pk_bf16_f32 v167, v16, v17
  v_lshlrev_b32 v16, 16, v167
  v_and_b32 v17, 0xffff0000, v167
  v_cvt_pk_bf16_f32 v164, v18, v19
  v_lshlrev_b32 v18, 16, v164
  v_and_b32 v19, 0xffff0000, v164
  v_cvt_pk_bf16_f32 v165, v20, v21
  v_lshlrev_b32 v20, 16, v165
  v_and_b32 v21, 0xffff0000, v165
  v_cvt_pk_bf16_f32 v166, v22, v23
  v_lshlrev_b32 v22, 16, v166
  v_and_b32 v23, 0xffff0000, v166
  v_cvt_pk_bf16_f32 v167, v24, v25
  v_lshlrev_b32 v24, 16, v167
  v_and_b32 v25, 0xffff0000, v167
  v_cvt_pk_bf16_f32 v164, v26, v27
  v_lshlrev_b32 v26, 16, v164
  v_and_b32 v27, 0xffff0000, v164
  v_cvt_pk_bf16_f32 v165, v28, v29
  v_lshlrev_b32 v28, 16, v165
  v_and_b32 v29, 0xffff0000, v165
  v_cvt_pk_bf16_f32 v166, v30, v31
  v_lshlrev_b32 v30, 16, v166
  v_and_b32 v31, 0xffff0000, v166
  v_cvt_pk_bf16_f32 v167, v32, v33
  v_lshlrev_b32 v32, 16, v167
  v_and_b32 v33, 0xffff0000, v167
  v_cvt_pk_bf16_f32 v164, v34, v35
  v_lshlrev_b32 v34, 16, v164
  v_and_b32 v35, 0xffff0000, v164
  v_cvt_pk_bf16_f32 v165, v36, v37
  v_lshlrev_b32 v36, 16, v165
  v_and_b32 v37, 0xffff0000, v165
  v_cvt_pk_bf16_f32 v166, v38, v39
  v_lshlrev_b32 v38, 16, v166
  v_and_b32 v39, 0xffff0000, v166
  v_cvt_pk_bf16_f32 v167, v40, v41
  v_lshlrev_b32 v40, 16, v167
  v_and_b32 v41, 0xffff0000, v167
  v_mul_f32_dpp v2, v176, v2 quad_perm:[2,2,2,2] row_mask:0xf bank_mask:0xf
  v_mul_f32_dpp v3, v177, v3 quad_perm:[2,2,2,2] row_mask:0xf bank_mask:0xf
  v_mul_f32_dpp v4, v178, v4 quad_perm:[2,2,2,2] row_mask:0xf bank_mask:0xf
  v_mul_f32_dpp v5, v179, v5 quad_perm:[2,2,2,2] row_mask:0xf bank_mask:0xf
  v_mul_f32_dpp v6, v176, v6 quad_perm:[3,3,3,3] row_mask:0xf bank_mask:0xf
  v_mul_f32_dpp v7, v177, v7 quad_perm:[3,3,3,3] row_mask:0xf bank_mask:0xf
  v_mul_f32_dpp v8, v178, v8 quad_perm:[3,3,3,3] row_mask:0xf bank_mask:0xf
  v_mul_f32_dpp v9, v179, v9 quad_perm:[3,3,3,3] row_mask:0xf bank_mask:0xf
  v_cvt_pk_bf16_f32 v164, v2, v3
  v_lshlrev_b32 v2, 16, v164
  v_and_b32 v3, 0xffff0000, v164
  v_cvt_pk_bf16_f32 v165, v4, v5
  v_lshlrev_b32 v4, 16, v165
  v_and_b32 v5, 0xffff0000, v165
  v_cvt_pk_bf16_f32 v166, v6, v7
  v_lshlrev_b32 v6, 16, v166
  v_and_b32 v7, 0xffff0000, v166
  v_cvt_pk_bf16_f32 v167, v8, v9
  v_lshlrev_b32 v8, 16, v167
  v_and_b32 v9, 0xffff0000, v167
  v_add_f32_dpp v2, v176, v2 quad_perm:[0,0,0,0] row_mask:0xf bank_mask:0xf
  v_add_f32_dpp v3, v177, v3 quad_perm:[0,0,0,0] row_mask:0xf bank_mask:0xf
  v_add_f32_dpp v4, v178, v4 quad_perm:[0,0,0,0] row_mask:0xf bank_mask:0xf
  v_add_f32_dpp v5, v179, v5 quad_perm:[0,0,0,0] row_mask:0xf bank_mask:0xf
  v_add_f32_dpp v6, v176, v6 quad_perm:[1,1,1,1] row_mask:0xf bank_mask:0xf
  v_add_f32_dpp v7, v177, v7 quad_perm:[1,1,1,1] row_mask:0xf bank_mask:0xf
  v_add_f32_dpp v8, v178, v8 quad_perm:[1,1,1,1] row_mask:0xf bank_mask:0xf
  v_add_f32_dpp v9, v179, v9 quad_perm:[1,1,1,1] row_mask:0xf bank_mask:0xf
  v_cvt_pk_bf16_f32 v196, v2, v3
  v_cvt_pk_bf16_f32 v197, v4, v5
  v_cvt_pk_bf16_f32 v198, v6, v7
  v_cvt_pk_bf16_f32 v199, v8, v9
  s_add_u32 s35, s38, 0
  buffer_store_dwordx4 v[196:199], v161, s[8:11], s35 offen sc1
  v_mul_f32_dpp v10, v180, v10 quad_perm:[2,2,2,2] row_mask:0xf bank_mask:0xf
  v_mul_f32_dpp v11, v181, v11 quad_perm:[2,2,2,2] row_mask:0xf bank_mask:0xf
  v_mul_f32_dpp v12, v182, v12 quad_perm:[2,2,2,2] row_mask:0xf bank_mask:0xf
  v_mul_f32_dpp v13, v183, v13 quad_perm:[2,2,2,2] row_mask:0xf bank_mask:0xf
  v_mul_f32_dpp v14, v180, v14 quad_perm:[3,3,3,3] row_mask:0xf bank_mask:0xf
  v_mul_f32_dpp v15, v181, v15 quad_perm:[3,3,3,3] row_mask:0xf bank_mask:0xf
  v_mul_f32_dpp v16, v182, v16 quad_perm:[3,3,3,3] row_mask:0xf bank_mask:0xf
  v_mul_f32_dpp v17, v183, v17 quad_perm:[3,3,3,3] row_mask:0xf bank_mask:0xf
  v_cvt_pk_bf16_f32 v164, v10, v11
  v_lshlrev_b32 v10, 16, v164
  v_and_b32 v11, 0xffff0000, v164
  v_cvt_pk_bf16_f32 v165, v12, v13
  v_lshlrev_b32 v12, 16, v165
  v_and_b32 v13, 0xffff0000, v165
  v_cvt_pk_bf16_f32 v166, v14, v15
  v_lshlrev_b32 v14, 16, v166
  v_and_b32 v15, 0xffff0000, v166
  v_cvt_pk_bf16_f32 v167, v16, v17
  v_lshlrev_b32 v16, 16, v167
  v_and_b32 v17, 0xffff0000, v167
  v_add_f32_dpp v10, v180, v10 quad_perm:[0,0,0,0] row_mask:0xf bank_mask:0xf
  v_add_f32_dpp v11, v181, v11 quad_perm:[0,0,0,0] row_mask:0xf bank_mask:0xf
  v_add_f32_dpp v12, v182, v12 quad_perm:[0,0,0,0] row_mask:0xf bank_mask:0xf
  v_add_f32_dpp v13, v183, v13 quad_perm:[0,0,0,0] row_mask:0xf bank_mask:0xf
  v_add_f32_dpp v14, v180, v14 quad_perm:[1,1,1,1] row_mask:0xf bank_mask:0xf
  v_add_f32_dpp v15, v181, v15 quad_perm:[1,1,1,1] row_mask:0xf bank_mask:0xf
  v_add_f32_dpp v16, v182, v16 quad_perm:[1,1,1,1] row_mask:0xf bank_mask:0xf
  v_add_f32_dpp v17, v183, v17 quad_perm:[1,1,1,1] row_mask:0xf bank_mask:0xf
  v_cvt_pk_bf16_f32 v200, v10, v11
  v_cvt_pk_bf16_f32 v201, v12, v13
  v_cvt_pk_bf16_f32 v202, v14, v15
  v_cvt_pk_bf16_f32 v203, v16, v17
  s_add_u32 s35, s38, 4096
  buffer_store_dwordx4 v[200:203], v161, s[8:11], s35 offen sc1
  v_mul_f32_dpp v18, v184, v18 quad_perm:[2,2,2,2] row_mask:0xf bank_mask:0xf
  v_mul_f32_dpp v19, v185, v19 quad_perm:[2,2,2,2] row_mask:0xf bank_mask:0xf
  v_mul_f32_dpp v20, v186, v20 quad_perm:[2,2,2,2] row_mask:0xf bank_mask:0xf
  v_mul_f32_dpp v21, v187, v21 quad_perm:[2,2,2,2] row_mask:0xf bank_mask:0xf
  v_mul_f32_dpp v22, v184, v22 quad_perm:[3,3,3,3] row_mask:0xf bank_mask:0xf
  v_mul_f32_dpp v23, v185, v23 quad_perm:[3,3,3,3] row_mask:0xf bank_mask:0xf
  v_mul_f32_dpp v24, v186, v24 quad_perm:[3,3,3,3] row_mask:0xf bank_mask:0xf
  v_mul_f32_dpp v25, v187, v25 quad_perm:[3,3,3,3] row_mask:0xf bank_mask:0xf
  v_cvt_pk_bf16_f32 v164, v18, v19
  v_lshlrev_b32 v18, 16, v164
  v_and_b32 v19, 0xffff0000, v164
  v_cvt_pk_bf16_f32 v165, v20, v21
  v_lshlrev_b32 v20, 16, v165
  v_and_b32 v21, 0xffff0000, v165
  v_cvt_pk_bf16_f32 v166, v22, v23
  v_lshlrev_b32 v22, 16, v166
  v_and_b32 v23, 0xffff0000, v166
  v_cvt_pk_bf16_f32 v167, v24, v25
  v_lshlrev_b32 v24, 16, v167
  v_and_b32 v25, 0xffff0000, v167
  v_add_f32_dpp v18, v184, v18 quad_perm:[0,0,0,0] row_mask:0xf bank_mask:0xf
  v_add_f32_dpp v19, v185, v19 quad_perm:[0,0,0,0] row_mask:0xf bank_mask:0xf
  v_add_f32_dpp v20, v186, v20 quad_perm:[0,0,0,0] row_mask:0xf bank_mask:0xf
  v_add_f32_dpp v21, v187, v21 quad_perm:[0,0,0,0] row_mask:0xf bank_mask:0xf
  v_add_f32_dpp v22, v184, v22 quad_perm:[1,1,1,1] row_mask:0xf bank_mask:0xf
  v_add_f32_dpp v23, v185, v23 quad_perm:[1,1,1,1] row_mask:0xf bank_mask:0xf
  v_add_f32_dpp v24, v186, v24 quad_perm:[1,1,1,1] row_mask:0xf bank_mask:0xf
  v_add_f32_dpp v25, v187, v25 quad_perm:[1,1,1,1] row_mask:0xf bank_mask:0xf
  v_cvt_pk_bf16_f32 v204, v18, v19
  v_cvt_pk_bf16_f32 v205, v20, v21
  v_cvt_pk_bf16_f32 v206, v22, v23
  v_cvt_pk_bf16_f32 v207, v24, v25
  s_add_u32 s35, s38, 8192
  buffer_store_dwordx4 v[204:207], v161, s[8:11], s35 offen sc1
  v_mul_f32_dpp v26, v188, v26 quad_perm:[2,2,2,2] row_mask:0xf bank_mask:0xf
  v_mul_f32_dpp v27, v189, v27 quad_perm:[2,2,2,2] row_mask:0xf bank_mask:0xf
  v_mul_f32_dpp v28, v190, v28 quad_perm:[2,2,2,2] row_mask:0xf bank_mask:0xf
  v_mul_f32_dpp v29, v191, v29 quad_perm:[2,2,2,2] row_mask:0xf bank_mask:0xf
  v_mul_f32_dpp v30, v188, v30 quad_perm:[3,3,3,3] row_mask:0xf bank_mask:0xf
  v_mul_f32_dpp v31, v189, v31 quad_perm:[3,3,3,3] row_mask:0xf bank_mask:0xf
  v_mul_f32_dpp v32, v190, v32 quad_perm:[3,3,3,3] row_mask:0xf bank_mask:0xf
  v_mul_f32_dpp v33, v191, v33 quad_perm:[3,3,3,3] row_mask:0xf bank_mask:0xf
  v_cvt_pk_bf16_f32 v164, v26, v27
  v_lshlrev_b32 v26, 16, v164
  v_and_b32 v27, 0xffff0000, v164
  v_cvt_pk_bf16_f32 v165, v28, v29
  v_lshlrev_b32 v28, 16, v165
  v_and_b32 v29, 0xffff0000, v165
  v_cvt_pk_bf16_f32 v166, v30, v31
  v_lshlrev_b32 v30, 16, v166
  v_and_b32 v31, 0xffff0000, v166
  v_cvt_pk_bf16_f32 v167, v32, v33
  v_lshlrev_b32 v32, 16, v167
  v_and_b32 v33, 0xffff0000, v167
  v_add_f32_dpp v26, v188, v26 quad_perm:[0,0,0,0] row_mask:0xf bank_mask:0xf
  v_add_f32_dpp v27, v189, v27 quad_perm:[0,0,0,0] row_mask:0xf bank_mask:0xf
  v_add_f32_dpp v28, v190, v28 quad_perm:[0,0,0,0] row_mask:0xf bank_mask:0xf
  v_add_f32_dpp v29, v191, v29 quad_perm:[0,0,0,0] row_mask:0xf bank_mask:0xf
  v_add_f32_dpp v30, v188, v30 quad_perm:[1,1,1,1] row_mask:0xf bank_mask:0xf
  v_add_f32_dpp v31, v189, v31 quad_perm:[1,1,1,1] row_mask:0xf bank_mask:0xf
  v_add_f32_dpp v32, v190, v32 quad_perm:[1,1,1,1] row_mask:0xf bank_mask:0xf
  v_add_f32_dpp v33, v191, v33 quad_perm:[1,1,1,1] row_mask:0xf bank_mask:0xf
  v_cvt_pk_bf16_f32 v208, v26, v27
  v_cvt_pk_bf16_f32 v209, v28, v29
  v_cvt_pk_bf16_f32 v210, v30, v31
  v_cvt_pk_bf16_f32 v211, v32, v33
  s_add_u32 s35, s38, 12288
  buffer_store_dwordx4 v[208:211], v161, s[8:11], s35 offen sc1
  v_mul_f32_dpp v34, v192, v34 quad_perm:[2,2,2,2] row_mask:0xf bank_mask:0xf
  v_mul_f32_dpp v35, v193, v35 quad_perm:[2,2,2,2] row_mask:0xf bank_mask:0xf
  v_mul_f32_dpp v36, v194, v36 quad_perm:[2,2,2,2] row_mask:0xf bank_mask:0xf
  v_mul_f32_dpp v37, v195, v37 quad_perm:[2,2,2,2] row_mask:0xf bank_mask:0xf
  v_mul_f32_dpp v38, v192, v38 quad_perm:[3,3,3,3] row_mask:0xf bank_mask:0xf
  v_mul_f32_dpp v39, v193, v39 quad_perm:[3,3,3,3] row_mask:0xf bank_mask:0xf
  v_mul_f32_dpp v40, v194, v40 quad_perm:[3,3,3,3] row_mask:0xf bank_mask:0xf
  v_mul_f32_dpp v41, v195, v41 quad_perm:[3,3,3,3] row_mask:0xf bank_mask:0xf
  v_cvt_pk_bf16_f32 v164, v34, v35
  v_lshlrev_b32 v34, 16, v164
  v_and_b32 v35, 0xffff0000, v164
  v_cvt_pk_bf16_f32 v165, v36, v37
  v_lshlrev_b32 v36, 16, v165
  v_and_b32 v37, 0xffff0000, v165
  v_cvt_pk_bf16_f32 v166, v38, v39
  v_lshlrev_b32 v38, 16, v166
  v_and_b32 v39, 0xffff0000, v166
  v_cvt_pk_bf16_f32 v167, v40, v41
  v_lshlrev_b32 v40, 16, v167
  v_and_b32 v41, 0xffff0000, v167
  v_add_f32_dpp v34, v192, v34 quad_perm:[0,0,0,0] row_mask:0xf bank_mask:0xf
  v_add_f32_dpp v35, v193, v35 quad_perm:[0,0,0,0] row_mask:0xf bank_mask:0xf
  v_add_f32_dpp v36, v194, v36 quad_perm:[0,0,0,0] row_mask:0xf bank_mask:0xf
  v_add_f32_dpp v37, v195, v37 quad_perm:[0,0,0,0] row_mask:0xf bank_mask:0xf
  v_add_f32_dpp v38, v192, v38 quad_perm:[1,1,1,1] row_mask:0xf bank_mask:0xf
  v_add_f32_dpp v39, v193, v39 quad_perm:[1,1,1,1] row_mask:0xf bank_mask:0xf
  v_add_f32_dpp v40, v194, v40 quad_perm:[1,1,1,1] row_mask:0xf bank_mask:0xf
  v_add_f32_dpp v41, v195, v41 quad_perm:[1,1,1,1] row_mask:0xf bank_mask:0xf
  v_cvt_pk_bf16_f32 v212, v34, v35
  v_cvt_pk_bf16_f32 v213, v36, v37
  v_cvt_pk_bf16_f32 v214, v38, v39
  v_cvt_pk_bf16_f32 v215, v40, v41
  s_add_u32 s35, s38, 16384
  buffer_store_dwordx4 v[212:215], v161, s[8:11], s35 offen sc1
  s_add_u32 s36, s41, 24
  s_cmp_lt_u32 s41, 24
  s_cselect_b32 s36, s39, s36
  s_add_u32 s41, s41, 3
  s_cmp_lt_u32 s41, 24
  s_cselect_b32 s41, s41, s36
  s_min_u32 s41, s41, 127
  s_mul_i32 s38, s16, 2621440
  s_cmp_lt_u32 s41, 24
  s_cselect_b32 s38, s38, 0
  s_mul_i32 s36, s41, 20480
  s_add_u32 s38, s38, s36
  s_lshl_b32 s36, s17, 6
  s_add_u32 s38, s38, s36
  s_add_u32 s38, s38, 247463936
  s_add_u32 s33, s33, 3
  s_sub_u32 s36, s33, 0
  s_min_u32 s36, s36, 24
  v_mov_b32 v92, s36
  s_waitcnt vmcnt(0)
  buffer_store_dword v92, v228, s[8:11], 0 offen
  buffer_load_dwordx2 v[140:141], v160, s[20:23], s37 offen offset:0
  buffer_load_dwordx2 v[142:143], v160, s[20:23], s37 offen offset:32
  buffer_load_dwordx2 v[144:145], v160, s[20:23], s37 offen offset:256
  buffer_load_dwordx2 v[146:147], v160, s[20:23], s37 offen offset:288
  buffer_load_dwordx2 v[148:149], v160, s[20:23], s37 offen offset:512
  buffer_load_dwordx2 v[150:151], v160, s[20:23], s37 offen offset:544
  buffer_load_dwordx2 v[152:153], v160, s[20:23], s37 offen offset:768
  buffer_load_dwordx2 v[154:155], v160, s[20:23], s37 offen offset:800
  buffer_load_dwordx2 v[156:157], v160, s[20:23], s37 offen offset:1024
  buffer_load_dwordx2 v[158:159], v160, s[20:23], s37 offen offset:1056
  s_add_u32 s36, s40, 24
  s_cmp_lt_u32 s40, 24
  s_cselect_b32 s36, s39, s36
  s_add_u32 s40, s40, 3
  s_cmp_lt_u32 s40, 24
  s_cselect_b32 s40, s40, s36
  s_min_u32 s40, s40, 127
  s_mul_i32 s37, s40, 20480
  s_mul_i32 s36, s17, 5120
  s_add_u32 s37, s37, s36
  buffer_load_dwordx2 v[46:47], v160, s[20:23], s37 offen offset:0
  buffer_load_dwordx2 v[48:49], v160, s[20:23], s37 offen offset:32
  buffer_load_dwordx2 v[50:51], v160, s[20:23], s37 offen offset:256
  buffer_load_dwordx2 v[52:53], v160, s[20:23], s37 offen offset:288
  buffer_load_dwordx2 v[54:55], v160, s[20:23], s37 offen offset:512
  buffer_load_dwordx2 v[56:57], v160, s[20:23], s37 offen offset:544
  buffer_load_dwordx2 v[58:59], v160, s[20:23], s37 offen offset:768
  buffer_load_dwordx2 v[60:61], v160, s[20:23], s37 offen offset:800
  buffer_load_dwordx2 v[62:63], v160, s[20:23], s37 offen offset:1024
  buffer_load_dwordx2 v[64:65], v160, s[20:23], s37 offen offset:1056
  s_add_u32 s36, s40, 24
  s_cmp_lt_u32 s40, 24
  s_cselect_b32 s36, s39, s36
  s_add_u32 s40, s40, 3
  s_cmp_lt_u32 s40, 24
  s_cselect_b32 s40, s40, s36
  s_min_u32 s40, s40, 127
  s_mul_i32 s37, s40, 20480
  s_mul_i32 s36, s17, 5120
  s_add_u32 s37, s37, s36
r_ln1:
  v_lshlrev_b32 v2, 16, v66
  v_and_b32 v3, 0xffff0000, v66
  v_lshlrev_b32 v4, 16, v67
  v_and_b32 v5, 0xffff0000, v67
  v_lshlrev_b32 v6, 16, v68
  v_and_b32 v7, 0xffff0000, v68
  v_lshlrev_b32 v8, 16, v69
  v_and_b32 v9, 0xffff0000, v69
  v_lshlrev_b32 v10, 16, v70
  v_and_b32 v11, 0xffff0000, v70
  v_lshlrev_b32 v12, 16, v71
  v_and_b32 v13, 0xffff0000, v71
  v_lshlrev_b32 v14, 16, v72
  v_and_b32 v15, 0xffff0000, v72
  v_lshlrev_b32 v16, 16, v73
  v_and_b32 v17, 0xffff0000, v73
  v_lshlrev_b32 v18, 16, v74
  v_and_b32 v19, 0xffff0000, v74
  v_lshlrev_b32 v20, 16, v75
  v_and_b32 v21, 0xffff0000, v75
  v_lshlrev_b32 v22, 16, v76
  v_and_b32 v23, 0xffff0000, v76
  v_lshlrev_b32 v24, 16, v77
  v_and_b32 v25, 0xffff0000, v77
  v_lshlrev_b32 v26, 16, v78
  v_and_b32 v27, 0xffff0000, v78
  v_lshlrev_b32 v28, 16, v79
  v_and_b32 v29, 0xffff0000, v79
  v_lshlrev_b32 v30, 16, v80
  v_and_b32 v31, 0xffff0000, v80
  v_lshlrev_b32 v32, 16, v81
  v_and_b32 v33, 0xffff0000, v81
  v_lshlrev_b32 v34, 16, v82
  v_and_b32 v35, 0xffff0000, v82
  v_lshlrev_b32 v36, 16, v83
  v_and_b32 v37, 0xffff0000, v83
  v_lshlrev_b32 v38, 16, v84
  v_and_b32 v39, 0xffff0000, v84
  v_lshlrev_b32 v40, 16, v85
  v_and_b32 v41, 0xffff0000, v85
  v_pk_add_f32 v[86:87], v[2:3], v[4:5]
  v_pk_add_f32 v[88:89], v[6:7], v[8:9]
  v_pk_add_f32 v[86:87], v[86:87], v[10:11]
  v_pk_add_f32 v[88:89], v[88:89], v[12:13]
  v_pk_add_f32 v[86:87], v[86:87], v[14:15]
  v_pk_add_f32 v[88:89], v[88:89], v[16:17]
  v_pk_add_f32 v[86:87], v[86:87], v[18:19]
  v_pk_add_f32 v[88:89], v[88:89], v[20:21]
  v_pk_add_f32 v[86:87], v[86:87], v[22:23]
  v_pk_add_f32 v[88:89], v[88:89], v[24:25]
  v_pk_add_f32 v[86:87], v[86:87], v[26:27]
  v_pk_add_f32 v[88:89], v[88:89], v[28:29]
  v_pk_add_f32 v[86:87], v[86:87], v[30:31]
  v_pk_add_f32 v[88:89], v[88:89], v[32:33]
  v_pk_add_f32 v[86:87], v[86:87], v[34:35]
  v_pk_add_f32 v[88:89], v[88:89], v[36:37]
  v_pk_add_f32 v[86:87], v[86:87], v[38:39]
  v_pk_add_f32 v[88:89], v[88:89], v[40:41]
  v_pk_add_f32 v[86:87], v[86:87], v[88:89]
  v_add_f32 v86, v86, v87
  s_nop 1
  v_add_f32_dpp v86, v86, v86 row_ror:8 row_mask:0xf bank_mask:0xf
  s_nop 1
  v_add_f32_dpp v86, v86, v86 row_ror:4 row_mask:0xf bank_mask:0xf
  v_mov_b32 v90, v86
  s_nop 1
  v_permlane16_swap_b32 v86, v90
  v_add_f32 v86, v86, v90
  v_mov_b32 v90, v86
  s_nop 1
  v_permlane32_swap_b32 v86, v90
  v_add_f32 v86, v86, v90
  v_mul_f32 v88, 0xbacccccd, v86
  v_mul_f32 v89, 0xbacccccd, v86
  v_pk_add_f32 v[164:165], v[2:3], v[88:89]
  v_pk_add_f32 v[166:167], v[4:5], v[88:89]
  v_pk_mul_f32 v[170:171], v[164:165], v[164:165]
  v_pk_add_f32 v[168:169], v[6:7], v[88:89]
  v_pk_mul_f32 v[86:87], v[166:167], v[166:167]
  v_pk_add_f32 v[164:165], v[8:9], v[88:89]
  v_pk_fma_f32 v[170:171], v[168:169], v[168:169], v[170:171]
  v_pk_add_f32 v[166:167], v[10:11], v[88:89]
  v_pk_fma_f32 v[86:87], v[164:165], v[164:165], v[86:87]
  v_pk_add_f32 v[168:169], v[12:13], v[88:89]
  v_pk_fma_f32 v[170:171], v[166:167], v[166:167], v[170:171]
  v_pk_add_f32 v[164:165], v[14:15], v[88:89]
  v_pk_fma_f32 v[86:87], v[168:169], v[168:169], v[86:87]
  v_pk_add_f32 v[166:167], v[16:17], v[88:89]
  v_pk_fma_f32 v[170:171], v[164:165], v[164:165], v[170:171]
  v_pk_add_f32 v[168:169], v[18:19], v[88:89]
  v_pk_fma_f32 v[86:87], v[166:167], v[166:167], v[86:87]
  v_pk_add_f32 v[164:165], v[20:21], v[88:89]
  v_pk_fma_f32 v[170:171], v[168:169], v[168:169], v[170:171]
  v_pk_add_f32 v[166:167], v[22:23], v[88:89]
  v_pk_fma_f32 v[86:87], v[164:165], v[164:165], v[86:87]
  v_pk_add_f32 v[168:169], v[24:25], v[88:89]
  v_pk_fma_f32 v[170:171], v[166:167], v[166:167], v[170:171]
  v_pk_add_f32 v[164:165], v[26:27], v[88:89]
  v_pk_fma_f32 v[86:87], v[168:169], v[168:169], v[86:87]
  v_pk_add_f32 v[166:167], v[28:29], v[88:89]
  v_pk_fma_f32 v[170:171], v[164:165], v[164:165], v[170:171]
  v_pk_add_f32 v[168:169], v[30:31], v[88:89]
  v_pk_fma_f32 v[86:87], v[166:167], v[166:167], v[86:87]
  v_pk_add_f32 v[164:165], v[32:33], v[88:89]
  v_pk_fma_f32 v[170:171], v[168:169], v[168:169], v[170:171]
  v_pk_add_f32 v[166:167], v[34:35], v[88:89]
  v_pk_fma_f32 v[86:87], v[164:165], v[164:165], v[86:87]
  v_pk_add_f32 v[168:169], v[36:37], v[88:89]
  v_pk_fma_f32 v[170:171], v[166:167], v[166:167], v[170:171]
  v_pk_add_f32 v[164:165], v[38:39], v[88:89]
  v_pk_fma_f32 v[86:87], v[168:169], v[168:169], v[86:87]
  v_pk_add_f32 v[166:167], v[40:41], v[88:89]
  v_pk_fma_f32 v[170:171], v[164:165], v[164:165], v[170:171]
  v_pk_fma_f32 v[86:87], v[166:167], v[166:167], v[86:87]
  v_cvt_pk_bf16_f32 v91, v88, v89
  v_lshlrev_b32 v88, 16, v91
  v_and_b32 v89, 0xffff0000, v91
  v_pk_add_f32 v[86:87], v[86:87], v[170:171]
  v_add_f32 v86, v86, v87
  s_nop 1
  v_add_f32_dpp v86, v86, v86 row_ror:8 row_mask:0xf bank_mask:0xf
  s_nop 1
  v_add_f32_dpp v86, v86, v86 row_ror:4 row_mask:0xf bank_mask:0xf
  v_mov_b32 v90, v86
  s_nop 1
  v_permlane16_swap_b32 v86, v90
  v_add_f32 v86, v86, v90
  v_mov_b32 v90, v86
  s_nop 1
  v_permlane32_swap_b32 v86, v90
  v_add_f32 v86, v86, v90
  v_pk_add_f32 v[2:3], v[2:3], v[88:89]
  v_mul_f32 v86, 0x3acccccd, v86
  v_pk_add_f32 v[4:5], v[4:5], v[88:89]
  v_cvt_pk_bf16_f32 v86, v86, v86
  v_pk_add_f32 v[6:7], v[6:7], v[88:89]
  v_lshlrev_b32 v86, 16, v86
  v_pk_add_f32 v[8:9], v[8:9], v[88:89]
  v_add_f32 v86, 0x3727c5ac, v86
  v_pk_add_f32 v[10:11], v[10:11], v[88:89]
  v_cvt_pk_bf16_f32 v86, v86, v86
  v_pk_add_f32 v[12:13], v[12:13], v[88:89]
  v_lshlrev_b32 v86, 16, v86
  v_pk_add_f32 v[14:15], v[14:15], v[88:89]
  v_sqrt_f32 v86, v86
  v_pk_add_f32 v[16:17], v[16:17], v[88:89]
  v_cvt_pk_bf16_f32 v86, v86, v86
  v_pk_add_f32 v[18:19], v[18:19], v[88:89]
  v_lshlrev_b32 v86, 16, v86
  v_pk_add_f32 v[20:21], v[20:21], v[88:89]
  v_rcp_f32 v86, v86
  v_pk_add_f32 v[22:23], v[22:23], v[88:89]
  v_mov_b32 v87, v86
  v_pk_add_f32 v[24:25], v[24:25], v[88:89]
  v_pk_add_f32 v[26:27], v[26:27], v[88:89]
  v_pk_add_f32 v[28:29], v[28:29], v[88:89]
  v_pk_add_f32 v[30:31], v[30:31], v[88:89]
  v_pk_add_f32 v[32:33], v[32:33], v[88:89]
  v_pk_add_f32 v[34:35], v[34:35], v[88:89]
  v_pk_add_f32 v[36:37], v[36:37], v[88:89]
  v_pk_add_f32 v[38:39], v[38:39], v[88:89]
  v_pk_add_f32 v[40:41], v[40:41], v[88:89]
  v_cvt_pk_bf16_f32 v164, v2, v3
  v_lshlrev_b32 v2, 16, v164
  v_and_b32 v3, 0xffff0000, v164
  v_cvt_pk_bf16_f32 v165, v4, v5
  v_lshlrev_b32 v4, 16, v165
  v_and_b32 v5, 0xffff0000, v165
  v_cvt_pk_bf16_f32 v166, v6, v7
  v_lshlrev_b32 v6, 16, v166
  v_and_b32 v7, 0xffff0000, v166
  v_cvt_pk_bf16_f32 v167, v8, v9
  v_lshlrev_b32 v8, 16, v167
  v_and_b32 v9, 0xffff0000, v167
  v_cvt_pk_bf16_f32 v164, v10, v11
  v_lshlrev_b32 v10, 16, v164
  v_and_b32 v11, 0xffff0000, v164
  v_cvt_pk_bf16_f32 v165, v12, v13
  v_lshlrev_b32 v12, 16, v165
  v_and_b32 v13, 0xffff0000, v165
  v_cvt_pk_bf16_f32 v166, v14, v15
  v_lshlrev_b32 v14, 16, v166
  v_and_b32 v15, 0xffff0000, v166
  v_cvt_pk_bf16_f32 v167, v16, v17
  v_lshlrev_b32 v16, 16, v167
  v_and_b32 v17, 0xffff0000, v167
  v_cvt_pk_bf16_f32 v164, v18, v19
  v_lshlrev_b32 v18, 16, v164
  v_and_b32 v19, 0xffff0000, v164
  v_cvt_pk_bf16_f32 v165, v20, v21
  v_lshlrev_b32 v20, 16, v165
  v_and_b32 v21, 0xffff0000, v165
  v_cvt_pk_bf16_f32 v166, v22, v23
  v_lshlrev_b32 v22, 16, v166
  v_and_b32 v23, 0xffff0000, v166
  v_cvt_pk_bf16_f32 v167, v24, v25
  v_lshlrev_b32 v24, 16, v167
  v_and_b32 v25, 0xffff0000, v167
  v_cvt_pk_bf16_f32 v164, v26, v27
  v_lshlrev_b32 v26, 16, v164
  v_and_b32 v27, 0xffff0000, v164
  v_cvt_pk_bf16_f32 v165, v28, v29
  v_lshlrev_b32 v28, 16, v165
  v_and_b32 v29, 0xffff0000, v165
  v_cvt_pk_bf16_f32 v166, v30, v31
  v_lshlrev_b32 v30, 16, v166
  v_and_b32 v31, 0xffff0000, v166
  v_cvt_pk_bf16_f32 v167, v32, v33
  v_lshlrev_b32 v32, 16, v167
  v_and_b32 v33, 0xffff0000, v167
  v_cvt_pk_bf16_f32 v164, v34, v35
  v_lshlrev_b32 v34, 16, v164
  v_and_b32 v35, 0xffff0000, v164
  v_cvt_pk_bf16_f32 v165, v36, v37
  v_lshlrev_b32 v36, 16, v165
  v_and_b32 v37, 0xffff0000, v165
  v_cvt_pk_bf16_f32 v166, v38, v39
  v_lshlrev_b32 v38, 16, v166
  v_and_b32 v39, 0xffff0000, v166
  v_cvt_pk_bf16_f32 v167, v40, v41
  v_lshlrev_b32 v40, 16, v167
  v_and_b32 v41, 0xffff0000, v167
  s_sub_u32 s36, s33, 0
  s_min_u32 s36, s36, 24
  v_mov_b32 v92, s36
  s_waitcnt vmcnt(10)
  buffer_store_dword v92, v228, s[8:11], 0 offen
  v_pk_mul_f32 v[2:3], v[2:3], v[86:87]
  v_pk_mul_f32 v[4:5], v[4:5], v[86:87]
  v_pk_mul_f32 v[6:7], v[6:7], v[86:87]
  v_pk_mul_f32 v[8:9], v[8:9], v[86:87]
  v_pk_mul_f32 v[10:11], v[10:11], v[86:87]
  v_pk_mul_f32 v[12:13], v[12:13], v[86:87]
  v_pk_mul_f32 v[14:15], v[14:15], v[86:87]
  v_pk_mul_f32 v[16:17], v[16:17], v[86:87]
  v_pk_mul_f32 v[18:19], v[18:19], v[86:87]
  v_pk_mul_f32 v[20:21], v[20:21], v[86:87]
  v_pk_mul_f32 v[22:23], v[22:23], v[86:87]
  v_pk_mul_f32 v[24:25], v[24:25], v[86:87]
  v_pk_mul_f32 v[26:27], v[26:27], v[86:87]
  v_pk_mul_f32 v[28:29], v[28:29], v[86:87]
  v_pk_mul_f32 v[30:31], v[30:31], v[86:87]
  v_pk_mul_f32 v[32:33], v[32:33], v[86:87]
  v_pk_mul_f32 v[34:35], v[34:35], v[86:87]
  v_pk_mul_f32 v[36:37], v[36:37], v[86:87]
  v_pk_mul_f32 v[38:39], v[38:39], v[86:87]
  v_pk_mul_f32 v[40:41], v[40:41], v[86:87]
  v_cvt_pk_bf16_f32 v164, v2, v3
  v_lshlrev_b32 v2, 16, v164
  v_and_b32 v3, 0xffff0000, v164
  v_cvt_pk_bf16_f32 v165, v4, v5
  v_lshlrev_b32 v4, 16, v165
  v_and_b32 v5, 0xffff0000, v165
  v_cvt_pk_bf16_f32 v166, v6, v7
  v_lshlrev_b32 v6, 16, v166
  v_and_b32 v7, 0xffff0000, v166
  v_cvt_pk_bf16_f32 v167, v8, v9
  v_lshlrev_b32 v8, 16, v167
  v_and_b32 v9, 0xffff0000, v167
  v_cvt_pk_bf16_f32 v164, v10, v11
  v_lshlrev_b32 v10, 16, v164
  v_and_b32 v11, 0xffff0000, v164
  v_cvt_pk_bf16_f32 v165, v12, v13
  v_lshlrev_b32 v12, 16, v165
  v_and_b32 v13, 0xffff0000, v165
  v_cvt_pk_bf16_f32 v166, v14, v15
  v_lshlrev_b32 v14, 16, v166
  v_and_b32 v15, 0xffff0000, v166
  v_cvt_pk_bf16_f32 v167, v16, v17
  v_lshlrev_b32 v16, 16, v167
  v_and_b32 v17, 0xffff0000, v167
  v_cvt_pk_bf16_f32 v164, v18, v19
  v_lshlrev_b32 v18, 16, v164
  v_and_b32 v19, 0xffff0000, v164
  v_cvt_pk_bf16_f32 v165, v20, v21
  v_lshlrev_b32 v20, 16, v165
  v_and_b32 v21, 0xffff0000, v165
  v_cvt_pk_bf16_f32 v166, v22, v23
  v_lshlrev_b32 v22, 16, v166
  v_and_b32 v23, 0xffff0000, v166
  v_cvt_pk_bf16_f32 v167, v24, v25
  v_lshlrev_b32 v24, 16, v167
  v_and_b32 v25, 0xffff0000, v167
  v_cvt_pk_bf16_f32 v164, v26, v27
  v_lshlrev_b32 v26, 16, v164
  v_and_b32 v27, 0xffff0000, v164
  v_cvt_pk_bf16_f32 v165, v28, v29
  v_lshlrev_b32 v28, 16, v165
  v_and_b32 v29, 0xffff0000, v165
  v_cvt_pk_bf16_f32 v166, v30, v31
  v_lshlrev_b32 v30, 16, v166
  v_and_b32 v31, 0xffff0000, v166
  v_cvt_pk_bf16_f32 v167, v32, v33
  v_lshlrev_b32 v32, 16, v167
  v_and_b32 v33, 0xffff0000, v167
  v_cvt_pk_bf16_f32 v164, v34, v35
  v_lshlrev_b32 v34, 16, v164
  v_and_b32 v35, 0xffff0000, v164
  v_cvt_pk_bf16_f32 v165, v36, v37
  v_lshlrev_b32 v36, 16, v165
  v_and_b32 v37, 0xffff0000, v165
  v_cvt_pk_bf16_f32 v166, v38, v39
  v_lshlrev_b32 v38, 16, v166
  v_and_b32 v39, 0xffff0000, v166
  v_cvt_pk_bf16_f32 v167, v40, v41
  v_lshlrev_b32 v40, 16, v167
  v_and_b32 v41, 0xffff0000, v167
  v_mul_f32_dpp v2, v176, v2 quad_perm:[2,2,2,2] row_mask:0xf bank_mask:0xf
  v_mul_f32_dpp v3, v177, v3 quad_perm:[2,2,2,2] row_mask:0xf bank_mask:0xf
  v_mul_f32_dpp v4, v178, v4 quad_perm:[2,2,2,2] row_mask:0xf bank_mask:0xf
  v_mul_f32_dpp v5, v179, v5 quad_perm:[2,2,2,2] row_mask:0xf bank_mask:0xf
  v_mul_f32_dpp v6, v176, v6 quad_perm:[3,3,3,3] row_mask:0xf bank_mask:0xf
  v_mul_f32_dpp v7, v177, v7 quad_perm:[3,3,3,3] row_mask:0xf bank_mask:0xf
  v_mul_f32_dpp v8, v178, v8 quad_perm:[3,3,3,3] row_mask:0xf bank_mask:0xf
  v_mul_f32_dpp v9, v179, v9 quad_perm:[3,3,3,3] row_mask:0xf bank_mask:0xf
  v_cvt_pk_bf16_f32 v164, v2, v3
  v_lshlrev_b32 v2, 16, v164
  v_and_b32 v3, 0xffff0000, v164
  v_cvt_pk_bf16_f32 v165, v4, v5
  v_lshlrev_b32 v4, 16, v165
  v_and_b32 v5, 0xffff0000, v165
  v_cvt_pk_bf16_f32 v166, v6, v7
  v_lshlrev_b32 v6, 16, v166
  v_and_b32 v7, 0xffff0000, v166
  v_cvt_pk_bf16_f32 v167, v8, v9
  v_lshlrev_b32 v8, 16, v167
  v_and_b32 v9, 0xffff0000, v167
  v_add_f32_dpp v2, v176, v2 quad_perm:[0,0,0,0] row_mask:0xf bank_mask:0xf
  v_add_f32_dpp v3, v177, v3 quad_perm:[0,0,0,0] row_mask:0xf bank_mask:0xf
  v_add_f32_dpp v4, v178, v4 quad_perm:[0,0,0,0] row_mask:0xf bank_mask:0xf
  v_add_f32_dpp v5, v179, v5 quad_perm:[0,0,0,0] row_mask:0xf bank_mask:0xf
  v_add_f32_dpp v6, v176, v6 quad_perm:[1,1,1,1] row_mask:0xf bank_mask:0xf
  v_add_f32_dpp v7, v177, v7 quad_perm:[1,1,1,1] row_mask:0xf bank_mask:0xf
  v_add_f32_dpp v8, v178, v8 quad_perm:[1,1,1,1] row_mask:0xf bank_mask:0xf
  v_add_f32_dpp v9, v179, v9 quad_perm:[1,1,1,1] row_mask:0xf bank_mask:0xf
  v_cvt_pk_bf16_f32 v196, v2, v3
  v_cvt_pk_bf16_f32 v197, v4, v5
  v_cvt_pk_bf16_f32 v198, v6, v7
  v_cvt_pk_bf16_f32 v199, v8, v9
  s_add_u32 s35, s38, 0
  buffer_store_dwordx4 v[196:199], v161, s[8:11], s35 offen sc1
  v_mul_f32_dpp v10, v180, v10 quad_perm:[2,2,2,2] row_mask:0xf bank_mask:0xf
  v_mul_f32_dpp v11, v181, v11 quad_perm:[2,2,2,2] row_mask:0xf bank_mask:0xf
  v_mul_f32_dpp v12, v182, v12 quad_perm:[2,2,2,2] row_mask:0xf bank_mask:0xf
  v_mul_f32_dpp v13, v183, v13 quad_perm:[2,2,2,2] row_mask:0xf bank_mask:0xf
  v_mul_f32_dpp v14, v180, v14 quad_perm:[3,3,3,3] row_mask:0xf bank_mask:0xf
  v_mul_f32_dpp v15, v181, v15 quad_perm:[3,3,3,3] row_mask:0xf bank_mask:0xf
  v_mul_f32_dpp v16, v182, v16 quad_perm:[3,3,3,3] row_mask:0xf bank_mask:0xf
  v_mul_f32_dpp v17, v183, v17 quad_perm:[3,3,3,3] row_mask:0xf bank_mask:0xf
  v_cvt_pk_bf16_f32 v164, v10, v11
  v_lshlrev_b32 v10, 16, v164
  v_and_b32 v11, 0xffff0000, v164
  v_cvt_pk_bf16_f32 v165, v12, v13
  v_lshlrev_b32 v12, 16, v165
  v_and_b32 v13, 0xffff0000, v165
  v_cvt_pk_bf16_f32 v166, v14, v15
  v_lshlrev_b32 v14, 16, v166
  v_and_b32 v15, 0xffff0000, v166
  v_cvt_pk_bf16_f32 v167, v16, v17
  v_lshlrev_b32 v16, 16, v167
  v_and_b32 v17, 0xffff0000, v167
  v_add_f32_dpp v10, v180, v10 quad_perm:[0,0,0,0] row_mask:0xf bank_mask:0xf
  v_add_f32_dpp v11, v181, v11 quad_perm:[0,0,0,0] row_mask:0xf bank_mask:0xf
  v_add_f32_dpp v12, v182, v12 quad_perm:[0,0,0,0] row_mask:0xf bank_mask:0xf
  v_add_f32_dpp v13, v183, v13 quad_perm:[0,0,0,0] row_mask:0xf bank_mask:0xf
  v_add_f32_dpp v14, v180, v14 quad_perm:[1,1,1,1] row_mask:0xf bank_mask:0xf
  v_add_f32_dpp v15, v181, v15 quad_perm:[1,1,1,1] row_mask:0xf bank_mask:0xf
  v_add_f32_dpp v16, v182, v16 quad_perm:[1,1,1,1] row_mask:0xf bank_mask:0xf
  v_add_f32_dpp v17, v183, v17 quad_perm:[1,1,1,1] row_mask:0xf bank_mask:0xf
  v_cvt_pk_bf16_f32 v200, v10, v11
  v_cvt_pk_bf16_f32 v201, v12, v13
  v_cvt_pk_bf16_f32 v202, v14, v15
  v_cvt_pk_bf16_f32 v203, v16, v17
  s_add_u32 s35, s38, 4096
  buffer_store_dwordx4 v[200:203], v161, s[8:11], s35 offen sc1
  v_mul_f32_dpp v18, v184, v18 quad_perm:[2,2,2,2] row_mask:0xf bank_mask:0xf
  v_mul_f32_dpp v19, v185, v19 quad_perm:[2,2,2,2] row_mask:0xf bank_mask:0xf
  v_mul_f32_dpp v20, v186, v20 quad_perm:[2,2,2,2] row_mask:0xf bank_mask:0xf
  v_mul_f32_dpp v21, v187, v21 quad_perm:[2,2,2,2] row_mask:0xf bank_mask:0xf
  v_mul_f32_dpp v22, v184, v22 quad_perm:[3,3,3,3] row_mask:0xf bank_mask:0xf
  v_mul_f32_dpp v23, v185, v23 quad_perm:[3,3,3,3] row_mask:0xf bank_mask:0xf
  v_mul_f32_dpp v24, v186, v24 quad_perm:[3,3,3,3] row_mask:0xf bank_mask:0xf
  v_mul_f32_dpp v25, v187, v25 quad_perm:[3,3,3,3] row_mask:0xf bank_mask:0xf
  v_cvt_pk_bf16_f32 v164, v18, v19
  v_lshlrev_b32 v18, 16, v164
  v_and_b32 v19, 0xffff0000, v164
  v_cvt_pk_bf16_f32 v165, v20, v21
  v_lshlrev_b32 v20, 16, v165
  v_and_b32 v21, 0xffff0000, v165
  v_cvt_pk_bf16_f32 v166, v22, v23
  v_lshlrev_b32 v22, 16, v166
  v_and_b32 v23, 0xffff0000, v166
  v_cvt_pk_bf16_f32 v167, v24, v25
  v_lshlrev_b32 v24, 16, v167
  v_and_b32 v25, 0xffff0000, v167
  v_add_f32_dpp v18, v184, v18 quad_perm:[0,0,0,0] row_mask:0xf bank_mask:0xf
  v_add_f32_dpp v19, v185, v19 quad_perm:[0,0,0,0] row_mask:0xf bank_mask:0xf
  v_add_f32_dpp v20, v186, v20 quad_perm:[0,0,0,0] row_mask:0xf bank_mask:0xf
  v_add_f32_dpp v21, v187, v21 quad_perm:[0,0,0,0] row_mask:0xf bank_mask:0xf
  v_add_f32_dpp v22, v184, v22 quad_perm:[1,1,1,1] row_mask:0xf bank_mask:0xf
  v_add_f32_dpp v23, v185, v23 quad_perm:[1,1,1,1] row_mask:0xf bank_mask:0xf
  v_add_f32_dpp v24, v186, v24 quad_perm:[1,1,1,1] row_mask:0xf bank_mask:0xf
  v_add_f32_dpp v25, v187, v25 quad_perm:[1,1,1,1] row_mask:0xf bank_mask:0xf
  v_cvt_pk_bf16_f32 v204, v18, v19
  v_cvt_pk_bf16_f32 v205, v20, v21
  v_cvt_pk_bf16_f32 v206, v22, v23
  v_cvt_pk_bf16_f32 v207, v24, v25
  s_add_u32 s35, s38, 8192
  buffer_store_dwordx4 v[204:207], v161, s[8:11], s35 offen sc1
  v_mul_f32_dpp v26, v188, v26 quad_perm:[2,2,2,2] row_mask:0xf bank_mask:0xf
  v_mul_f32_dpp v27, v189, v27 quad_perm:[2,2,2,2] row_mask:0xf bank_mask:0xf
  v_mul_f32_dpp v28, v190, v28 quad_perm:[2,2,2,2] row_mask:0xf bank_mask:0xf
  v_mul_f32_dpp v29, v191, v29 quad_perm:[2,2,2,2] row_mask:0xf bank_mask:0xf
  v_mul_f32_dpp v30, v188, v30 quad_perm:[3,3,3,3] row_mask:0xf bank_mask:0xf
  v_mul_f32_dpp v31, v189, v31 quad_perm:[3,3,3,3] row_mask:0xf bank_mask:0xf
  v_mul_f32_dpp v32, v190, v32 quad_perm:[3,3,3,3] row_mask:0xf bank_mask:0xf
  v_mul_f32_dpp v33, v191, v33 quad_perm:[3,3,3,3] row_mask:0xf bank_mask:0xf
  v_cvt_pk_bf16_f32 v164, v26, v27
  v_lshlrev_b32 v26, 16, v164
  v_and_b32 v27, 0xffff0000, v164
  v_cvt_pk_bf16_f32 v165, v28, v29
  v_lshlrev_b32 v28, 16, v165
  v_and_b32 v29, 0xffff0000, v165
  v_cvt_pk_bf16_f32 v166, v30, v31
  v_lshlrev_b32 v30, 16, v166
  v_and_b32 v31, 0xffff0000, v166
  v_cvt_pk_bf16_f32 v167, v32, v33
  v_lshlrev_b32 v32, 16, v167
  v_and_b32 v33, 0xffff0000, v167
  v_add_f32_dpp v26, v188, v26 quad_perm:[0,0,0,0] row_mask:0xf bank_mask:0xf
  v_add_f32_dpp v27, v189, v27 quad_perm:[0,0,0,0] row_mask:0xf bank_mask:0xf
  v_add_f32_dpp v28, v190, v28 quad_perm:[0,0,0,0] row_mask:0xf bank_mask:0xf
  v_add_f32_dpp v29, v191, v29 quad_perm:[0,0,0,0] row_mask:0xf bank_mask:0xf
  v_add_f32_dpp v30, v188, v30 quad_perm:[1,1,1,1] row_mask:0xf bank_mask:0xf
  v_add_f32_dpp v31, v189, v31 quad_perm:[1,1,1,1] row_mask:0xf bank_mask:0xf
  v_add_f32_dpp v32, v190, v32 quad_perm:[1,1,1,1] row_mask:0xf bank_mask:0xf
  v_add_f32_dpp v33, v191, v33 quad_perm:[1,1,1,1] row_mask:0xf bank_mask:0xf
  v_cvt_pk_bf16_f32 v208, v26, v27
  v_cvt_pk_bf16_f32 v209, v28, v29
  v_cvt_pk_bf16_f32 v210, v30, v31
  v_cvt_pk_bf16_f32 v211, v32, v33
  s_add_u32 s35, s38, 12288
  buffer_store_dwordx4 v[208:211], v161, s[8:11], s35 offen sc1
  v_mul_f32_dpp v34, v192, v34 quad_perm:[2,2,2,2] row_mask:0xf bank_mask:0xf
  v_mul_f32_dpp v35, v193, v35 quad_perm:[2,2,2,2] row_mask:0xf bank_mask:0xf
  v_mul_f32_dpp v36, v194, v36 quad_perm:[2,2,2,2] row_mask:0xf bank_mask:0xf
  v_mul_f32_dpp v37, v195, v37 quad_perm:[2,2,2,2] row_mask:0xf bank_mask:0xf
  v_mul_f32_dpp v38, v192, v38 quad_perm:[3,3,3,3] row_mask:0xf bank_mask:0xf
  v_mul_f32_dpp v39, v193, v39 quad_perm:[3,3,3,3] row_mask:0xf bank_mask:0xf
  v_mul_f32_dpp v40, v194, v40 quad_perm:[3,3,3,3] row_mask:0xf bank_mask:0xf
  v_mul_f32_dpp v41, v195, v41 quad_perm:[3,3,3,3] row_mask:0xf bank_mask:0xf
  v_cvt_pk_bf16_f32 v164, v34, v35
  v_lshlrev_b32 v34, 16, v164
  v_and_b32 v35, 0xffff0000, v164
  v_cvt_pk_bf16_f32 v165, v36, v37
  v_lshlrev_b32 v36, 16, v165
  v_and_b32 v37, 0xffff0000, v165
  v_cvt_pk_bf16_f32 v166, v38, v39
  v_lshlrev_b32 v38, 16, v166
  v_and_b32 v39, 0xffff0000, v166
  v_cvt_pk_bf16_f32 v167, v40, v41
  v_lshlrev_b32 v40, 16, v167
  v_and_b32 v41, 0xffff0000, v167
  v_add_f32_dpp v34, v192, v34 quad_perm:[0,0,0,0] row_mask:0xf bank_mask:0xf
  v_add_f32_dpp v35, v193, v35 quad_perm:[0,0,0,0] row_mask:0xf bank_mask:0xf
  v_add_f32_dpp v36, v194, v36 quad_perm:[0,0,0,0] row_mask:0xf bank_mask:0xf
  v_add_f32_dpp v37, v195, v37 quad_perm:[0,0,0,0] row_mask:0xf bank_mask:0xf
  v_add_f32_dpp v38, v192, v38 quad_perm:[1,1,1,1] row_mask:0xf bank_mask:0xf
  v_add_f32_dpp v39, v193, v39 quad_perm:[1,1,1,1] row_mask:0xf bank_mask:0xf
  v_add_f32_dpp v40, v194, v40 quad_perm:[1,1,1,1] row_mask:0xf bank_mask:0xf
  v_add_f32_dpp v41, v195, v41 quad_perm:[1,1,1,1] row_mask:0xf bank_mask:0xf
  v_cvt_pk_bf16_f32 v212, v34, v35
  v_cvt_pk_bf16_f32 v213, v36, v37
  v_cvt_pk_bf16_f32 v214, v38, v39
  v_cvt_pk_bf16_f32 v215, v40, v41
  s_add_u32 s35, s38, 16384
  buffer_store_dwordx4 v[212:215], v161, s[8:11], s35 offen sc1
  s_add_u32 s36, s41, 24
  s_cmp_lt_u32 s41, 24
  s_cselect_b32 s36, s39, s36
  s_add_u32 s41, s41, 3
  s_cmp_lt_u32 s41, 24
  s_cselect_b32 s41, s41, s36
  s_min_u32 s41, s41, 127
  s_mul_i32 s38, s16, 2621440
  s_cmp_lt_u32 s41, 24
  s_cselect_b32 s38, s38, 0
  s_mul_i32 s36, s41, 20480
  s_add_u32 s38, s38, s36
  s_lshl_b32 s36, s17, 6
  s_add_u32 s38, s38, s36
  s_add_u32 s38, s38, 247463936
  s_add_u32 s33, s33, 3
  buffer_load_dwordx2 v[66:67], v160, s[20:23], s37 offen offset:0
  buffer_load_dwordx2 v[68:69], v160, s[20:23], s37 offen offset:32
  buffer_load_dwordx2 v[70:71], v160, s[20:23], s37 offen offset:256
  buffer_load_dwordx2 v[72:73], v160, s[20:23], s37 offen offset:288
  buffer_load_dwordx2 v[74:75], v160, s[20:23], s37 offen offset:512
  buffer_load_dwordx2 v[76:77], v160, s[20:23], s37 offen offset:544
  buffer_load_dwordx2 v[78:79], v160, s[20:23], s37 offen offset:768
  buffer_load_dwordx2 v[80:81], v160, s[20:23], s37 offen offset:800
  buffer_load_dwordx2 v[82:83], v160, s[20:23], s37 offen offset:1024
  buffer_load_dwordx2 v[84:85], v160, s[20:23], s37 offen offset:1056
  s_add_u32 s36, s40, 24
  s_cmp_lt_u32 s40, 24
  s_cselect_b32 s36, s39, s36
  s_add_u32 s40, s40, 3
  s_cmp_lt_u32 s40, 24
  s_cselect_b32 s40, s40, s36
  s_min_u32 s40, s40, 127
  s_mul_i32 s37, s40, 20480
  s_mul_i32 s36, s17, 5120
  s_add_u32 s37, s37, s36
  s_cmp_lt_u32 s33, 39
  s_cbranch_scc0 r_ln1e
  v_lshlrev_b32 v2, 16, v140
  v_and_b32 v3, 0xffff0000, v140
  v_lshlrev_b32 v4, 16, v141
  v_and_b32 v5, 0xffff0000, v141
  v_lshlrev_b32 v6, 16, v142
  v_and_b32 v7, 0xffff0000, v142
  v_lshlrev_b32 v8, 16, v143
  v_and_b32 v9, 0xffff0000, v143
  v_lshlrev_b32 v10, 16, v144
  v_and_b32 v11, 0xffff0000, v144
  v_lshlrev_b32 v12, 16, v145
  v_and_b32 v13, 0xffff0000, v145
  v_lshlrev_b32 v14, 16, v146
  v_and_b32 v15, 0xffff0000, v146
  v_lshlrev_b32 v16, 16, v147
  v_and_b32 v17, 0xffff0000, v147
  v_lshlrev_b32 v18, 16, v148
  v_and_b32 v19, 0xffff0000, v148
  v_lshlrev_b32 v20, 16, v149
  v_and_b32 v21, 0xffff0000, v149
  v_lshlrev_b32 v22, 16, v150
  v_and_b32 v23, 0xffff0000, v150
  v_lshlrev_b32 v24, 16, v151
  v_and_b32 v25, 0xffff0000, v151
  v_lshlrev_b32 v26, 16, v152
  v_and_b32 v27, 0xffff0000, v152
  v_lshlrev_b32 v28, 16, v153
  v_and_b32 v29, 0xffff0000, v153
  v_lshlrev_b32 v30, 16, v154
  v_and_b32 v31, 0xffff0000, v154
  v_lshlrev_b32 v32, 16, v155
  v_and_b32 v33, 0xffff0000, v155
  v_lshlrev_b32 v34, 16, v156
  v_and_b32 v35, 0xffff0000, v156
  v_lshlrev_b32 v36, 16, v157
  v_and_b32 v37, 0xffff0000, v157
  v_lshlrev_b32 v38, 16, v158
  v_and_b32 v39, 0xffff0000, v158
  v_lshlrev_b32 v40, 16, v159
  v_and_b32 v41, 0xffff0000, v159
  v_pk_add_f32 v[86:87], v[2:3], v[4:5]
  v_pk_add_f32 v[88:89], v[6:7], v[8:9]
  v_pk_add_f32 v[86:87], v[86:87], v[10:11]
  v_pk_add_f32 v[88:89], v[88:89], v[12:13]
  v_pk_add_f32 v[86:87], v[86:87], v[14:15]
  v_pk_add_f32 v[88:89], v[88:89], v[16:17]
  v_pk_add_f32 v[86:87], v[86:87], v[18:19]
  v_pk_add_f32 v[88:89], v[88:89], v[20:21]
  v_pk_add_f32 v[86:87], v[86:87], v[22:23]
  v_pk_add_f32 v[88:89], v[88:89], v[24:25]
  v_pk_add_f32 v[86:87], v[86:87], v[26:27]
  v_pk_add_f32 v[88:89], v[88:89], v[28:29]
  v_pk_add_f32 v[86:87], v[86:87], v[30:31]
  v_pk_add_f32 v[88:89], v[88:89], v[32:33]
  v_pk_add_f32 v[86:87], v[86:87], v[34:35]
  v_pk_add_f32 v[88:89], v[88:89], v[36:37]
  v_pk_add_f32 v[86:87], v[86:87], v[38:39]
  v_pk_add_f32 v[88:89], v[88:89], v[40:41]
  v_pk_add_f32 v[86:87], v[86:87], v[88:89]
  v_add_f32 v86, v86, v87
  s_nop 1
  v_add_f32_dpp v86, v86, v86 row_ror:8 row_mask:0xf bank_mask:0xf
  s_nop 1
  v_add_f32_dpp v86, v86, v86 row_ror:4 row_mask:0xf bank_mask:0xf
  v_mov_b32 v90, v86
  s_nop 1
  v_permlane16_swap_b32 v86, v90
  v_add_f32 v86, v86, v90
  v_mov_b32 v90, v86
  s_nop 1
  v_permlane32_swap_b32 v86, v90
  v_add_f32 v86, v86, v90
  v_mul_f32 v88, 0xbacccccd, v86
  v_mul_f32 v89, 0xbacccccd, v86
  v_pk_add_f32 v[164:165], v[2:3], v[88:89]
  v_pk_add_f32 v[166:167], v[4:5], v[88:89]
  v_pk_mul_f32 v[170:171], v[164:165], v[164:165]
  v_pk_add_f32 v[168:169], v[6:7], v[88:89]
  v_pk_mul_f32 v[86:87], v[166:167], v[166:167]
  v_pk_add_f32 v[164:165], v[8:9], v[88:89]
  v_pk_fma_f32 v[170:171], v[168:169], v[168:169], v[170:171]
  v_pk_add_f32 v[166:167], v[10:11], v[88:89]
  v_pk_fma_f32 v[86:87], v[164:165], v[164:165], v[86:87]
  v_pk_add_f32 v[168:169], v[12:13], v[88:89]
  v_pk_fma_f32 v[170:171], v[166:167], v[166:167], v[170:171]
  v_pk_add_f32 v[164:165], v[14:15], v[88:89]
  v_pk_fma_f32 v[86:87], v[168:169], v[168:169], v[86:87]
  v_pk_add_f32 v[166:167], v[16:17], v[88:89]
  v_pk_fma_f32 v[170:171], v[164:165], v[164:165], v[170:171]
  v_pk_add_f32 v[168:169], v[18:19], v[88:89]
  v_pk_fma_f32 v[86:87], v[166:167], v[166:167], v[86:87]
  v_pk_add_f32 v[164:165], v[20:21], v[88:89]
  v_pk_fma_f32 v[170:171], v[168:169], v[168:169], v[170:171]
  v_pk_add_f32 v[166:167], v[22:23], v[88:89]
  v_pk_fma_f32 v[86:87], v[164:165], v[164:165], v[86:87]
  v_pk_add_f32 v[168:169], v[24:25], v[88:89]
  v_pk_fma_f32 v[170:171], v[166:167], v[166:167], v[170:171]
  v_pk_add_f32 v[164:165], v[26:27], v[88:89]
  v_pk_fma_f32 v[86:87], v[168:169], v[168:169], v[86:87]
  v_pk_add_f32 v[166:167], v[28:29], v[88:89]
  v_pk_fma_f32 v[170:171], v[164:165], v[164:165], v[170:171]
  v_pk_add_f32 v[168:169], v[30:31], v[88:89]
  v_pk_fma_f32 v[86:87], v[166:167], v[166:167], v[86:87]
  v_pk_add_f32 v[164:165], v[32:33], v[88:89]
  v_pk_fma_f32 v[170:171], v[168:169], v[168:169], v[170:171]
  v_pk_add_f32 v[166:167], v[34:35], v[88:89]
  v_pk_fma_f32 v[86:87], v[164:165], v[164:165], v[86:87]
  v_pk_add_f32 v[168:169], v[36:37], v[88:89]
  v_pk_fma_f32 v[170:171], v[166:167], v[166:167], v[170:171]
  v_pk_add_f32 v[164:165], v[38:39], v[88:89]
  v_pk_fma_f32 v[86:87], v[168:169], v[168:169], v[86:87]
  v_pk_add_f32 v[166:167], v[40:41], v[88:89]
  v_pk_fma_f32 v[170:171], v[164:165], v[164:165], v[170:171]
  v_pk_fma_f32 v[86:87], v[166:167], v[166:167], v[86:87]
  v_cvt_pk_bf16_f32 v91, v88, v89
  v_lshlrev_b32 v88, 16, v91
  v_and_b32 v89, 0xffff0000, v91
  v_pk_add_f32 v[86:87], v[86:87], v[170:171]
  v_add_f32 v86, v86, v87
  s_nop 1
  v_add_f32_dpp v86, v86, v86 row_ror:8 row_mask:0xf bank_mask:0xf
  s_nop 1
  v_add_f32_dpp v86, v86, v86 row_ror:4 row_mask:0xf bank_mask:0xf
  v_mov_b32 v90, v86
  s_nop 1
  v_permlane16_swap_b32 v86, v90
  v_add_f32 v86, v86, v90
  v_mov_b32 v90, v86
  s_nop 1
  v_permlane32_swap_b32 v86, v90
  v_add_f32 v86, v86, v90
  v_pk_add_f32 v[2:3], v[2:3], v[88:89]
  v_mul_f32 v86, 0x3acccccd, v86
  v_pk_add_f32 v[4:5], v[4:5], v[88:89]
  v_cvt_pk_bf16_f32 v86, v86, v86
  v_pk_add_f32 v[6:7], v[6:7], v[88:89]
  v_lshlrev_b32 v86, 16, v86
  v_pk_add_f32 v[8:9], v[8:9], v[88:89]
  v_add_f32 v86, 0x3727c5ac, v86
  v_pk_add_f32 v[10:11], v[10:11], v[88:89]
  v_cvt_pk_bf16_f32 v86, v86, v86
  v_pk_add_f32 v[12:13], v[12:13], v[88:89]
  v_lshlrev_b32 v86, 16, v86
  v_pk_add_f32 v[14:15], v[14:15], v[88:89]
  v_sqrt_f32 v86, v86
  v_pk_add_f32 v[16:17], v[16:17], v[88:89]
  v_cvt_pk_bf16_f32 v86, v86, v86
  v_pk_add_f32 v[18:19], v[18:19], v[88:89]
  v_lshlrev_b32 v86, 16, v86
  v_pk_add_f32 v[20:21], v[20:21], v[88:89]
  v_rcp_f32 v86, v86
  v_pk_add_f32 v[22:23], v[22:23], v[88:89]
  v_mov_b32 v87, v86
  v_pk_add_f32 v[24:25], v[24:25], v[88:89]
  v_pk_add_f32 v[26:27], v[26:27], v[88:89]
  v_pk_add_f32 v[28:29], v[28:29], v[88:89]
  v_pk_add_f32 v[30:31], v[30:31], v[88:89]
  v_pk_add_f32 v[32:33], v[32:33], v[88:89]
  v_pk_add_f32 v[34:35], v[34:35], v[88:89]
  v_pk_add_f32 v[36:37], v[36:37], v[88:89]
  v_pk_add_f32 v[38:39], v[38:39], v[88:89]
  v_pk_add_f32 v[40:41], v[40:41], v[88:89]
  v_cvt_pk_bf16_f32 v164, v2, v3
  v_lshlrev_b32 v2, 16, v164
  v_and_b32 v3, 0xffff0000, v164
  v_cvt_pk_bf16_f32 v165, v4, v5
  v_lshlrev_b32 v4, 16, v165
  v_and_b32 v5, 0xffff0000, v165
  v_cvt_pk_bf16_f32 v166, v6, v7
  v_lshlrev_b32 v6, 16, v166
  v_and_b32 v7, 0xffff0000, v166
  v_cvt_pk_bf16_f32 v167, v8, v9
  v_lshlrev_b32 v8, 16, v167
  v_and_b32 v9, 0xffff0000, v167
  v_cvt_pk_bf16_f32 v164, v10, v11
  v_lshlrev_b32 v10, 16, v164
  v_and_b32 v11, 0xffff0000, v164
  v_cvt_pk_bf16_f32 v165, v12, v13
  v_lshlrev_b32 v12, 16, v165
  v_and_b32 v13, 0xffff0000, v165
  v_cvt_pk_bf16_f32 v166, v14, v15
  v_lshlrev_b32 v14, 16, v166
  v_and_b32 v15, 0xffff0000, v166
  v_cvt_pk_bf16_f32 v167, v16, v17
  v_lshlrev_b32 v16, 16, v167
  v_and_b32 v17, 0xffff0000, v167
  v_cvt_pk_bf16_f32 v164, v18, v19
  v_lshlrev_b32 v18, 16, v164
  v_and_b32 v19, 0xffff0000, v164
  v_cvt_pk_bf16_f32 v165, v20, v21
  v_lshlrev_b32 v20, 16, v165
  v_and_b32 v21, 0xffff0000, v165
  v_cvt_pk_bf16_f32 v166, v22, v23
  v_lshlrev_b32 v22, 16, v166
  v_and_b32 v23, 0xffff0000, v166
  v_cvt_pk_bf16_f32 v167, v24, v25
  v_lshlrev_b32 v24, 16, v167
  v_and_b32 v25, 0xffff0000, v167
  v_cvt_pk_bf16_f32 v164, v26, v27
  v_lshlrev_b32 v26, 16, v164
  v_and_b32 v27, 0xffff0000, v164
  v_cvt_pk_bf16_f32 v165, v28, v29
  v_lshlrev_b32 v28, 16, v165
  v_and_b32 v29, 0xffff0000, v165
  v_cvt_pk_bf16_f32 v166, v30, v31
  v_lshlrev_b32 v30, 16, v166
  v_and_b32 v31, 0xffff0000, v166
  v_cvt_pk_bf16_f32 v167, v32, v33
  v_lshlrev_b32 v32, 16, v167
  v_and_b32 v33, 0xffff0000, v167
  v_cvt_pk_bf16_f32 v164, v34, v35
  v_lshlrev_b32 v34, 16, v164
  v_and_b32 v35, 0xffff0000, v164
  v_cvt_pk_bf16_f32 v165, v36, v37
  v_lshlrev_b32 v36, 16, v165
  v_and_b32 v37, 0xffff0000, v165
  v_cvt_pk_bf16_f32 v166, v38, v39
  v_lshlrev_b32 v38, 16, v166
  v_and_b32 v39, 0xffff0000, v166
  v_cvt_pk_bf16_f32 v167, v40, v41
  v_lshlrev_b32 v40, 16, v167
  v_and_b32 v41, 0xffff0000, v167
  s_sub_u32 s36, s33, 0
  s_min_u32 s36, s36, 24
  v_mov_b32 v92, s36
  s_waitcnt vmcnt(10)
  buffer_store_dword v92, v228, s[8:11], 0 offen
  v_pk_mul_f32 v[2:3], v[2:3], v[86:87]
  v_pk_mul_f32 v[4:5], v[4:5], v[86:87]
  v_pk_mul_f32 v[6:7], v[6:7], v[86:87]
  v_pk_mul_f32 v[8:9], v[8:9], v[86:87]
  v_pk_mul_f32 v[10:11], v[10:11], v[86:87]
  v_pk_mul_f32 v[12:13], v[12:13], v[86:87]
  v_pk_mul_f32 v[14:15], v[14:15], v[86:87]
  v_pk_mul_f32 v[16:17], v[16:17], v[86:87]
  v_pk_mul_f32 v[18:19], v[18:19], v[86:87]
  v_pk_mul_f32 v[20:21], v[20:21], v[86:87]
  v_pk_mul_f32 v[22:23], v[22:23], v[86:87]
  v_pk_mul_f32 v[24:25], v[24:25], v[86:87]
  v_pk_mul_f32 v[26:27], v[26:27], v[86:87]
  v_pk_mul_f32 v[28:29], v[28:29], v[86:87]
  v_pk_mul_f32 v[30:31], v[30:31], v[86:87]
  v_pk_mul_f32 v[32:33], v[32:33], v[86:87]
  v_pk_mul_f32 v[34:35], v[34:35], v[86:87]
  v_pk_mul_f32 v[36:37], v[36:37], v[86:87]
  v_pk_mul_f32 v[38:39], v[38:39], v[86:87]
  v_pk_mul_f32 v[40:41], v[40:41], v[86:87]
  v_cvt_pk_bf16_f32 v164, v2, v3
  v_lshlrev_b32 v2, 16, v164
  v_and_b32 v3, 0xffff0000, v164
  v_cvt_pk_bf16_f32 v165, v4, v5
  v_lshlrev_b32 v4, 16, v165
  v_and_b32 v5, 0xffff0000, v165
  v_cvt_pk_bf16_f32 v166, v6, v7
  v_lshlrev_b32 v6, 16, v166
  v_and_b32 v7, 0xffff0000, v166
  v_cvt_pk_bf16_f32 v167, v8, v9
  v_lshlrev_b32 v8, 16, v167
  v_and_b32 v9, 0xffff0000, v167
  v_cvt_pk_bf16_f32 v164, v10, v11
  v_lshlrev_b32 v10, 16, v164
  v_and_b32 v11, 0xffff0000, v164
  v_cvt_pk_bf16_f32 v165, v12, v13
  v_lshlrev_b32 v12, 16, v165
  v_and_b32 v13, 0xffff0000, v165
  v_cvt_pk_bf16_f32 v166, v14, v15
  v_lshlrev_b32 v14, 16, v166
  v_and_b32 v15, 0xffff0000, v166
  v_cvt_pk_bf16_f32 v167, v16, v17
  v_lshlrev_b32 v16, 16, v167
  v_and_b32 v17, 0xffff0000, v167
  v_cvt_pk_bf16_f32 v164, v18, v19
  v_lshlrev_b32 v18, 16, v164
  v_and_b32 v19, 0xffff0000, v164
  v_cvt_pk_bf16_f32 v165, v20, v21
  v_lshlrev_b32 v20, 16, v165
  v_and_b32 v21, 0xffff0000, v165
  v_cvt_pk_bf16_f32 v166, v22, v23
  v_lshlrev_b32 v22, 16, v166
  v_and_b32 v23, 0xffff0000, v166
  v_cvt_pk_bf16_f32 v167, v24, v25
  v_lshlrev_b32 v24, 16, v167
  v_and_b32 v25, 0xffff0000, v167
  v_cvt_pk_bf16_f32 v164, v26, v27
  v_lshlrev_b32 v26, 16, v164
  v_and_b32 v27, 0xffff0000, v164
  v_cvt_pk_bf16_f32 v165, v28, v29
  v_lshlrev_b32 v28, 16, v165
  v_and_b32 v29, 0xffff0000, v165
  v_cvt_pk_bf16_f32 v166, v30, v31
  v_lshlrev_b32 v30, 16, v166
  v_and_b32 v31, 0xffff0000, v166
  v_cvt_pk_bf16_f32 v167, v32, v33
  v_lshlrev_b32 v32, 16, v167
  v_and_b32 v33, 0xffff0000, v167
  v_cvt_pk_bf16_f32 v164, v34, v35
  v_lshlrev_b32 v34, 16, v164
  v_and_b32 v35, 0xffff0000, v164
  v_cvt_pk_bf16_f32 v165, v36, v37
  v_lshlrev_b32 v36, 16, v165
  v_and_b32 v37, 0xffff0000, v165
  v_cvt_pk_bf16_f32 v166, v38, v39
  v_lshlrev_b32 v38, 16, v166
  v_and_b32 v39, 0xffff0000, v166
  v_cvt_pk_bf16_f32 v167, v40, v41
  v_lshlrev_b32 v40, 16, v167
  v_and_b32 v41, 0xffff0000, v167
  v_mul_f32_dpp v2, v176, v2 quad_perm:[2,2,2,2] row_mask:0xf bank_mask:0xf
  v_mul_f32_dpp v3, v177, v3 quad_perm:[2,2,2,2] row_mask:0xf bank_mask:0xf
  v_mul_f32_dpp v4, v178, v4 quad_perm:[2,2,2,2] row_mask:0xf bank_mask:0xf
  v_mul_f32_dpp v5, v179, v5 quad_perm:[2,2,2,2] row_mask:0xf bank_mask:0xf
  v_mul_f32_dpp v6, v176, v6 quad_perm:[3,3,3,3] row_mask:0xf bank_mask:0xf
  v_mul_f32_dpp v7, v177, v7 quad_perm:[3,3,3,3] row_mask:0xf bank_mask:0xf
  v_mul_f32_dpp v8, v178, v8 quad_perm:[3,3,3,3] row_mask:0xf bank_mask:0xf
  v_mul_f32_dpp v9, v179, v9 quad_perm:[3,3,3,3] row_mask:0xf bank_mask:0xf
  v_cvt_pk_bf16_f32 v164, v2, v3
  v_lshlrev_b32 v2, 16, v164
  v_and_b32 v3, 0xffff0000, v164
  v_cvt_pk_bf16_f32 v165, v4, v5
  v_lshlrev_b32 v4, 16, v165
  v_and_b32 v5, 0xffff0000, v165
  v_cvt_pk_bf16_f32 v166, v6, v7
  v_lshlrev_b32 v6, 16, v166
  v_and_b32 v7, 0xffff0000, v166
  v_cvt_pk_bf16_f32 v167, v8, v9
  v_lshlrev_b32 v8, 16, v167
  v_and_b32 v9, 0xffff0000, v167
  v_add_f32_dpp v2, v176, v2 quad_perm:[0,0,0,0] row_mask:0xf bank_mask:0xf
  v_add_f32_dpp v3, v177, v3 quad_perm:[0,0,0,0] row_mask:0xf bank_mask:0xf
  v_add_f32_dpp v4, v178, v4 quad_perm:[0,0,0,0] row_mask:0xf bank_mask:0xf
  v_add_f32_dpp v5, v179, v5 quad_perm:[0,0,0,0] row_mask:0xf bank_mask:0xf
  v_add_f32_dpp v6, v176, v6 quad_perm:[1,1,1,1] row_mask:0xf bank_mask:0xf
  v_add_f32_dpp v7, v177, v7 quad_perm:[1,1,1,1] row_mask:0xf bank_mask:0xf
  v_add_f32_dpp v8, v178, v8 quad_perm:[1,1,1,1] row_mask:0xf bank_mask:0xf
  v_add_f32_dpp v9, v179, v9 quad_perm:[1,1,1,1] row_mask:0xf bank_mask:0xf
  v_cvt_pk_bf16_f32 v196, v2, v3
  v_cvt_pk_bf16_f32 v197, v4, v5
  v_cvt_pk_bf16_f32 v198, v6, v7
  v_cvt_pk_bf16_f32 v199, v8, v9
  s_add_u32 s35, s38, 0
  buffer_store_dwordx4 v[196:199], v161, s[8:11], s35 offen sc1
  v_mul_f32_dpp v10, v180, v10 quad_perm:[2,2,2,2] row_mask:0xf bank_mask:0xf
  v_mul_f32_dpp v11, v181, v11 quad_perm:[2,2,2,2] row_mask:0xf bank_mask:0xf
  v_mul_f32_dpp v12, v182, v12 quad_perm:[2,2,2,2] row_mask:0xf bank_mask:0xf
  v_mul_f32_dpp v13, v183, v13 quad_perm:[2,2,2,2] row_mask:0xf bank_mask:0xf
  v_mul_f32_dpp v14, v180, v14 quad_perm:[3,3,3,3] row_mask:0xf bank_mask:0xf
  v_mul_f32_dpp v15, v181, v15 quad_perm:[3,3,3,3] row_mask:0xf bank_mask:0xf
  v_mul_f32_dpp v16, v182, v16 quad_perm:[3,3,3,3] row_mask:0xf bank_mask:0xf
  v_mul_f32_dpp v17, v183, v17 quad_perm:[3,3,3,3] row_mask:0xf bank_mask:0xf
  v_cvt_pk_bf16_f32 v164, v10, v11
  v_lshlrev_b32 v10, 16, v164
  v_and_b32 v11, 0xffff0000, v164
  v_cvt_pk_bf16_f32 v165, v12, v13
  v_lshlrev_b32 v12, 16, v165
  v_and_b32 v13, 0xffff0000, v165
  v_cvt_pk_bf16_f32 v166, v14, v15
  v_lshlrev_b32 v14, 16, v166
  v_and_b32 v15, 0xffff0000, v166
  v_cvt_pk_bf16_f32 v167, v16, v17
  v_lshlrev_b32 v16, 16, v167
  v_and_b32 v17, 0xffff0000, v167
  v_add_f32_dpp v10, v180, v10 quad_perm:[0,0,0,0] row_mask:0xf bank_mask:0xf
  v_add_f32_dpp v11, v181, v11 quad_perm:[0,0,0,0] row_mask:0xf bank_mask:0xf
  v_add_f32_dpp v12, v182, v12 quad_perm:[0,0,0,0] row_mask:0xf bank_mask:0xf
  v_add_f32_dpp v13, v183, v13 quad_perm:[0,0,0,0] row_mask:0xf bank_mask:0xf
  v_add_f32_dpp v14, v180, v14 quad_perm:[1,1,1,1] row_mask:0xf bank_mask:0xf
  v_add_f32_dpp v15, v181, v15 quad_perm:[1,1,1,1] row_mask:0xf bank_mask:0xf
  v_add_f32_dpp v16, v182, v16 quad_perm:[1,1,1,1] row_mask:0xf bank_mask:0xf
  v_add_f32_dpp v17, v183, v17 quad_perm:[1,1,1,1] row_mask:0xf bank_mask:0xf
  v_cvt_pk_bf16_f32 v200, v10, v11
  v_cvt_pk_bf16_f32 v201, v12, v13
  v_cvt_pk_bf16_f32 v202, v14, v15
  v_cvt_pk_bf16_f32 v203, v16, v17
  s_add_u32 s35, s38, 4096
  buffer_store_dwordx4 v[200:203], v161, s[8:11], s35 offen sc1
  v_mul_f32_dpp v18, v184, v18 quad_perm:[2,2,2,2] row_mask:0xf bank_mask:0xf
  v_mul_f32_dpp v19, v185, v19 quad_perm:[2,2,2,2] row_mask:0xf bank_mask:0xf
  v_mul_f32_dpp v20, v186, v20 quad_perm:[2,2,2,2] row_mask:0xf bank_mask:0xf
  v_mul_f32_dpp v21, v187, v21 quad_perm:[2,2,2,2] row_mask:0xf bank_mask:0xf
  v_mul_f32_dpp v22, v184, v22 quad_perm:[3,3,3,3] row_mask:0xf bank_mask:0xf
  v_mul_f32_dpp v23, v185, v23 quad_perm:[3,3,3,3] row_mask:0xf bank_mask:0xf
  v_mul_f32_dpp v24, v186, v24 quad_perm:[3,3,3,3] row_mask:0xf bank_mask:0xf
  v_mul_f32_dpp v25, v187, v25 quad_perm:[3,3,3,3] row_mask:0xf bank_mask:0xf
  v_cvt_pk_bf16_f32 v164, v18, v19
  v_lshlrev_b32 v18, 16, v164
  v_and_b32 v19, 0xffff0000, v164
  v_cvt_pk_bf16_f32 v165, v20, v21
  v_lshlrev_b32 v20, 16, v165
  v_and_b32 v21, 0xffff0000, v165
  v_cvt_pk_bf16_f32 v166, v22, v23
  v_lshlrev_b32 v22, 16, v166
  v_and_b32 v23, 0xffff0000, v166
  v_cvt_pk_bf16_f32 v167, v24, v25
  v_lshlrev_b32 v24, 16, v167
  v_and_b32 v25, 0xffff0000, v167
  v_add_f32_dpp v18, v184, v18 quad_perm:[0,0,0,0] row_mask:0xf bank_mask:0xf
  v_add_f32_dpp v19, v185, v19 quad_perm:[0,0,0,0] row_mask:0xf bank_mask:0xf
  v_add_f32_dpp v20, v186, v20 quad_perm:[0,0,0,0] row_mask:0xf bank_mask:0xf
  v_add_f32_dpp v21, v187, v21 quad_perm:[0,0,0,0] row_mask:0xf bank_mask:0xf
  v_add_f32_dpp v22, v184, v22 quad_perm:[1,1,1,1] row_mask:0xf bank_mask:0xf
  v_add_f32_dpp v23, v185, v23 quad_perm:[1,1,1,1] row_mask:0xf bank_mask:0xf
  v_add_f32_dpp v24, v186, v24 quad_perm:[1,1,1,1] row_mask:0xf bank_mask:0xf
  v_add_f32_dpp v25, v187, v25 quad_perm:[1,1,1,1] row_mask:0xf bank_mask:0xf
  v_cvt_pk_bf16_f32 v204, v18, v19
  v_cvt_pk_bf16_f32 v205, v20, v21
  v_cvt_pk_bf16_f32 v206, v22, v23
  v_cvt_pk_bf16_f32 v207, v24, v25
  s_add_u32 s35, s38, 8192
  buffer_store_dwordx4 v[204:207], v161, s[8:11], s35 offen sc1
  v_mul_f32_dpp v26, v188, v26 quad_perm:[2,2,2,2] row_mask:0xf bank_mask:0xf
  v_mul_f32_dpp v27, v189, v27 quad_perm:[2,2,2,2] row_mask:0xf bank_mask:0xf
  v_mul_f32_dpp v28, v190, v28 quad_perm:[2,2,2,2] row_mask:0xf bank_mask:0xf
  v_mul_f32_dpp v29, v191, v29 quad_perm:[2,2,2,2] row_mask:0xf bank_mask:0xf
  v_mul_f32_dpp v30, v188, v30 quad_perm:[3,3,3,3] row_mask:0xf bank_mask:0xf
  v_mul_f32_dpp v31, v189, v31 quad_perm:[3,3,3,3] row_mask:0xf bank_mask:0xf
  v_mul_f32_dpp v32, v190, v32 quad_perm:[3,3,3,3] row_mask:0xf bank_mask:0xf
  v_mul_f32_dpp v33, v191, v33 quad_perm:[3,3,3,3] row_mask:0xf bank_mask:0xf
  v_cvt_pk_bf16_f32 v164, v26, v27
  v_lshlrev_b32 v26, 16, v164
  v_and_b32 v27, 0xffff0000, v164
  v_cvt_pk_bf16_f32 v165, v28, v29
  v_lshlrev_b32 v28, 16, v165
  v_and_b32 v29, 0xffff0000, v165
  v_cvt_pk_bf16_f32 v166, v30, v31
  v_lshlrev_b32 v30, 16, v166
  v_and_b32 v31, 0xffff0000, v166
  v_cvt_pk_bf16_f32 v167, v32, v33
  v_lshlrev_b32 v32, 16, v167
  v_and_b32 v33, 0xffff0000, v167
  v_add_f32_dpp v26, v188, v26 quad_perm:[0,0,0,0] row_mask:0xf bank_mask:0xf
  v_add_f32_dpp v27, v189, v27 quad_perm:[0,0,0,0] row_mask:0xf bank_mask:0xf
  v_add_f32_dpp v28, v190, v28 quad_perm:[0,0,0,0] row_mask:0xf bank_mask:0xf
  v_add_f32_dpp v29, v191, v29 quad_perm:[0,0,0,0] row_mask:0xf bank_mask:0xf
  v_add_f32_dpp v30, v188, v30 quad_perm:[1,1,1,1] row_mask:0xf bank_mask:0xf
  v_add_f32_dpp v31, v189, v31 quad_perm:[1,1,1,1] row_mask:0xf bank_mask:0xf
  v_add_f32_dpp v32, v190, v32 quad_perm:[1,1,1,1] row_mask:0xf bank_mask:0xf
  v_add_f32_dpp v33, v191, v33 quad_perm:[1,1,1,1] row_mask:0xf bank_mask:0xf
  v_cvt_pk_bf16_f32 v208, v26, v27
  v_cvt_pk_bf16_f32 v209, v28, v29
  v_cvt_pk_bf16_f32 v210, v30, v31
  v_cvt_pk_bf16_f32 v211, v32, v33
  s_add_u32 s35, s38, 12288
  buffer_store_dwordx4 v[208:211], v161, s[8:11], s35 offen sc1
  v_mul_f32_dpp v34, v192, v34 quad_perm:[2,2,2,2] row_mask:0xf bank_mask:0xf
  v_mul_f32_dpp v35, v193, v35 quad_perm:[2,2,2,2] row_mask:0xf bank_mask:0xf
  v_mul_f32_dpp v36, v194, v36 quad_perm:[2,2,2,2] row_mask:0xf bank_mask:0xf
  v_mul_f32_dpp v37, v195, v37 quad_perm:[2,2,2,2] row_mask:0xf bank_mask:0xf
  v_mul_f32_dpp v38, v192, v38 quad_perm:[3,3,3,3] row_mask:0xf bank_mask:0xf
  v_mul_f32_dpp v39, v193, v39 quad_perm:[3,3,3,3] row_mask:0xf bank_mask:0xf
  v_mul_f32_dpp v40, v194, v40 quad_perm:[3,3,3,3] row_mask:0xf bank_mask:0xf
  v_mul_f32_dpp v41, v195, v41 quad_perm:[3,3,3,3] row_mask:0xf bank_mask:0xf
  v_cvt_pk_bf16_f32 v164, v34, v35
  v_lshlrev_b32 v34, 16, v164
  v_and_b32 v35, 0xffff0000, v164
  v_cvt_pk_bf16_f32 v165, v36, v37
  v_lshlrev_b32 v36, 16, v165
  v_and_b32 v37, 0xffff0000, v165
  v_cvt_pk_bf16_f32 v166, v38, v39
  v_lshlrev_b32 v38, 16, v166
  v_and_b32 v39, 0xffff0000, v166
  v_cvt_pk_bf16_f32 v167, v40, v41
  v_lshlrev_b32 v40, 16, v167
  v_and_b32 v41, 0xffff0000, v167
  v_add_f32_dpp v34, v192, v34 quad_perm:[0,0,0,0] row_mask:0xf bank_mask:0xf
  v_add_f32_dpp v35, v193, v35 quad_perm:[0,0,0,0] row_mask:0xf bank_mask:0xf
  v_add_f32_dpp v36, v194, v36 quad_perm:[0,0,0,0] row_mask:0xf bank_mask:0xf
  v_add_f32_dpp v37, v195, v37 quad_perm:[0,0,0,0] row_mask:0xf bank_mask:0xf
  v_add_f32_dpp v38, v192, v38 quad_perm:[1,1,1,1] row_mask:0xf bank_mask:0xf
  v_add_f32_dpp v39, v193, v39 quad_perm:[1,1,1,1] row_mask:0xf bank_mask:0xf
  v_add_f32_dpp v40, v194, v40 quad_perm:[1,1,1,1] row_mask:0xf bank_mask:0xf
  v_add_f32_dpp v41, v195, v41 quad_perm:[1,1,1,1] row_mask:0xf bank_mask:0xf
  v_cvt_pk_bf16_f32 v212, v34, v35
  v_cvt_pk_bf16_f32 v213, v36, v37
  v_cvt_pk_bf16_f32 v214, v38, v39
  v_cvt_pk_bf16_f32 v215, v40, v41
  s_add_u32 s35, s38, 16384
  buffer_store_dwordx4 v[212:215], v161, s[8:11], s35 offen sc1
  s_add_u32 s36, s41, 24
  s_cmp_lt_u32 s41, 24
  s_cselect_b32 s36, s39, s36
  s_add_u32 s41, s41, 3
  s_cmp_lt_u32 s41, 24
  s_cselect_b32 s41, s41, s36
  s_min_u32 s41, s41, 127
  s_mul_i32 s38, s16, 2621440
  s_cmp_lt_u32 s41, 24
  s_cselect_b32 s38, s38, 0
  s_mul_i32 s36, s41, 20480
  s_add_u32 s38, s38, s36
  s_lshl_b32 s36, s17, 6
  s_add_u32 s38, s38, s36
  s_add_u32 s38, s38, 247463936
  s_add_u32 s33, s33, 3
  buffer_load_dwordx2 v[140:141], v160, s[20:23], s37 offen offset:0
  buffer_load_dwordx2 v[142:143], v160, s[20:23], s37 offen offset:32
  buffer_load_dwordx2 v[144:145], v160, s[20:23], s37 offen offset:256
  buffer_load_dwordx2 v[146:147], v160, s[20:23], s37 offen offset:288
  buffer_load_dwordx2 v[148:149], v160, s[20:23], s37 offen offset:512
  buffer_load_dwordx2 v[150:151], v160, s[20:23], s37 offen offset:544
  buffer_load_dwordx2 v[152:153], v160, s[20:23], s37 offen offset:768
  buffer_load_dwordx2 v[154:155], v160, s[20:23], s37 offen offset:800
  buffer_load_dwordx2 v[156:157], v160, s[20:23], s37 offen offset:1024
  buffer_load_dwordx2 v[158:159], v160, s[20:23], s37 offen offset:1056
  s_add_u32 s36, s40, 24
  s_cmp_lt_u32 s40, 24
  s_cselect_b32 s36, s39, s36
  s_add_u32 s40, s40, 3
  s_cmp_lt_u32 s40, 24
  s_cselect_b32 s40, s40, s36
  s_min_u32 s40, s40, 127
  s_mul_i32 s37, s40, 20480
  s_mul_i32 s36, s17, 5120
  s_add_u32 s37, s37, s36
  s_cmp_lt_u32 s33, 39
  s_cbranch_scc0 r_ln1e
  v_lshlrev_b32 v2, 16, v46
  v_and_b32 v3, 0xffff0000, v46
  v_lshlrev_b32 v4, 16, v47
  v_and_b32 v5, 0xffff0000, v47
  v_lshlrev_b32 v6, 16, v48
  v_and_b32 v7, 0xffff0000, v48
  v_lshlrev_b32 v8, 16, v49
  v_and_b32 v9, 0xffff0000, v49
  v_lshlrev_b32 v10, 16, v50
  v_and_b32 v11, 0xffff0000, v50
  v_lshlrev_b32 v12, 16, v51
  v_and_b32 v13, 0xffff0000, v51
  v_lshlrev_b32 v14, 16, v52
  v_and_b32 v15, 0xffff0000, v52
  v_lshlrev_b32 v16, 16, v53
  v_and_b32 v17, 0xffff0000, v53
  v_lshlrev_b32 v18, 16, v54
  v_and_b32 v19, 0xffff0000, v54
  v_lshlrev_b32 v20, 16, v55
  v_and_b32 v21, 0xffff0000, v55
  v_lshlrev_b32 v22, 16, v56
  v_and_b32 v23, 0xffff0000, v56
  v_lshlrev_b32 v24, 16, v57
  v_and_b32 v25, 0xffff0000, v57
  v_lshlrev_b32 v26, 16, v58
  v_and_b32 v27, 0xffff0000, v58
  v_lshlrev_b32 v28, 16, v59
  v_and_b32 v29, 0xffff0000, v59
  v_lshlrev_b32 v30, 16, v60
  v_and_b32 v31, 0xffff0000, v60
  v_lshlrev_b32 v32, 16, v61
  v_and_b32 v33, 0xffff0000, v61
  v_lshlrev_b32 v34, 16, v62
  v_and_b32 v35, 0xffff0000, v62
  v_lshlrev_b32 v36, 16, v63
  v_and_b32 v37, 0xffff0000, v63
  v_lshlrev_b32 v38, 16, v64
  v_and_b32 v39, 0xffff0000, v64
  v_lshlrev_b32 v40, 16, v65
  v_and_b32 v41, 0xffff0000, v65
  v_pk_add_f32 v[86:87], v[2:3], v[4:5]
  v_pk_add_f32 v[88:89], v[6:7], v[8:9]
  v_pk_add_f32 v[86:87], v[86:87], v[10:11]
  v_pk_add_f32 v[88:89], v[88:89], v[12:13]
  v_pk_add_f32 v[86:87], v[86:87], v[14:15]
  v_pk_add_f32 v[88:89], v[88:89], v[16:17]
  v_pk_add_f32 v[86:87], v[86:87], v[18:19]
  v_pk_add_f32 v[88:89], v[88:89], v[20:21]
  v_pk_add_f32 v[86:87], v[86:87], v[22:23]
  v_pk_add_f32 v[88:89], v[88:89], v[24:25]
  v_pk_add_f32 v[86:87], v[86:87], v[26:27]
  v_pk_add_f32 v[88:89], v[88:89], v[28:29]
  v_pk_add_f32 v[86:87], v[86:87], v[30:31]
  v_pk_add_f32 v[88:89], v[88:89], v[32:33]
  v_pk_add_f32 v[86:87], v[86:87], v[34:35]
  v_pk_add_f32 v[88:89], v[88:89], v[36:37]
  v_pk_add_f32 v[86:87], v[86:87], v[38:39]
  v_pk_add_f32 v[88:89], v[88:89], v[40:41]
  v_pk_add_f32 v[86:87], v[86:87], v[88:89]
  v_add_f32 v86, v86, v87
  s_nop 1
  v_add_f32_dpp v86, v86, v86 row_ror:8 row_mask:0xf bank_mask:0xf
  s_nop 1
  v_add_f32_dpp v86, v86, v86 row_ror:4 row_mask:0xf bank_mask:0xf
  v_mov_b32 v90, v86
  s_nop 1
  v_permlane16_swap_b32 v86, v90
  v_add_f32 v86, v86, v90
  v_mov_b32 v90, v86
  s_nop 1
  v_permlane32_swap_b32 v86, v90
  v_add_f32 v86, v86, v90
  v_mul_f32 v88, 0xbacccccd, v86
  v_mul_f32 v89, 0xbacccccd, v86
  v_pk_add_f32 v[164:165], v[2:3], v[88:89]
  v_pk_add_f32 v[166:167], v[4:5], v[88:89]
  v_pk_mul_f32 v[170:171], v[164:165], v[164:165]
  v_pk_add_f32 v[168:169], v[6:7], v[88:89]
  v_pk_mul_f32 v[86:87], v[166:167], v[166:167]
  v_pk_add_f32 v[164:165], v[8:9], v[88:89]
  v_pk_fma_f32 v[170:171], v[168:169], v[168:169], v[170:171]
  v_pk_add_f32 v[166:167], v[10:11], v[88:89]
  v_pk_fma_f32 v[86:87], v[164:165], v[164:165], v[86:87]
  v_pk_add_f32 v[168:169], v[12:13], v[88:89]
  v_pk_fma_f32 v[170:171], v[166:167], v[166:167], v[170:171]
  v_pk_add_f32 v[164:165], v[14:15], v[88:89]
  v_pk_fma_f32 v[86:87], v[168:169], v[168:169], v[86:87]
  v_pk_add_f32 v[166:167], v[16:17], v[88:89]
  v_pk_fma_f32 v[170:171], v[164:165], v[164:165], v[170:171]
  v_pk_add_f32 v[168:169], v[18:19], v[88:89]
  v_pk_fma_f32 v[86:87], v[166:167], v[166:167], v[86:87]
  v_pk_add_f32 v[164:165], v[20:21], v[88:89]
  v_pk_fma_f32 v[170:171], v[168:169], v[168:169], v[170:171]
  v_pk_add_f32 v[166:167], v[22:23], v[88:89]
  v_pk_fma_f32 v[86:87], v[164:165], v[164:165], v[86:87]
  v_pk_add_f32 v[168:169], v[24:25], v[88:89]
  v_pk_fma_f32 v[170:171], v[166:167], v[166:167], v[170:171]
  v_pk_add_f32 v[164:165], v[26:27], v[88:89]
  v_pk_fma_f32 v[86:87], v[168:169], v[168:169], v[86:87]
  v_pk_add_f32 v[166:167], v[28:29], v[88:89]
  v_pk_fma_f32 v[170:171], v[164:165], v[164:165], v[170:171]
  v_pk_add_f32 v[168:169], v[30:31], v[88:89]
  v_pk_fma_f32 v[86:87], v[166:167], v[166:167], v[86:87]
  v_pk_add_f32 v[164:165], v[32:33], v[88:89]
  v_pk_fma_f32 v[170:171], v[168:169], v[168:169], v[170:171]
  v_pk_add_f32 v[166:167], v[34:35], v[88:89]
  v_pk_fma_f32 v[86:87], v[164:165], v[164:165], v[86:87]
  v_pk_add_f32 v[168:169], v[36:37], v[88:89]
  v_pk_fma_f32 v[170:171], v[166:167], v[166:167], v[170:171]
  v_pk_add_f32 v[164:165], v[38:39], v[88:89]
  v_pk_fma_f32 v[86:87], v[168:169], v[168:169], v[86:87]
  v_pk_add_f32 v[166:167], v[40:41], v[88:89]
  v_pk_fma_f32 v[170:171], v[164:165], v[164:165], v[170:171]
  v_pk_fma_f32 v[86:87], v[166:167], v[166:167], v[86:87]
  v_cvt_pk_bf16_f32 v91, v88, v89
  v_lshlrev_b32 v88, 16, v91
  v_and_b32 v89, 0xffff0000, v91
  v_pk_add_f32 v[86:87], v[86:87], v[170:171]
  v_add_f32 v86, v86, v87
  s_nop 1
  v_add_f32_dpp v86, v86, v86 row_ror:8 row_mask:0xf bank_mask:0xf
  s_nop 1
  v_add_f32_dpp v86, v86, v86 row_ror:4 row_mask:0xf bank_mask:0xf
  v_mov_b32 v90, v86
  s_nop 1
  v_permlane16_swap_b32 v86, v90
  v_add_f32 v86, v86, v90
  v_mov_b32 v90, v86
  s_nop 1
  v_permlane32_swap_b32 v86, v90
  v_add_f32 v86, v86, v90
  v_pk_add_f32 v[2:3], v[2:3], v[88:89]
  v_mul_f32 v86, 0x3acccccd, v86
  v_pk_add_f32 v[4:5], v[4:5], v[88:89]
  v_cvt_pk_bf16_f32 v86, v86, v86
  v_pk_add_f32 v[6:7], v[6:7], v[88:89]
  v_lshlrev_b32 v86, 16, v86
  v_pk_add_f32 v[8:9], v[8:9], v[88:89]
  v_add_f32 v86, 0x3727c5ac, v86
  v_pk_add_f32 v[10:11], v[10:11], v[88:89]
  v_cvt_pk_bf16_f32 v86, v86, v86
  v_pk_add_f32 v[12:13], v[12:13], v[88:89]
  v_lshlrev_b32 v86, 16, v86
  v_pk_add_f32 v[14:15], v[14:15], v[88:89]
  v_sqrt_f32 v86, v86
  v_pk_add_f32 v[16:17], v[16:17], v[88:89]
  v_cvt_pk_bf16_f32 v86, v86, v86
  v_pk_add_f32 v[18:19], v[18:19], v[88:89]
  v_lshlrev_b32 v86, 16, v86
  v_pk_add_f32 v[20:21], v[20:21], v[88:89]
  v_rcp_f32 v86, v86
  v_pk_add_f32 v[22:23], v[22:23], v[88:89]
  v_mov_b32 v87, v86
  v_pk_add_f32 v[24:25], v[24:25], v[88:89]
  v_pk_add_f32 v[26:27], v[26:27], v[88:89]
  v_pk_add_f32 v[28:29], v[28:29], v[88:89]
  v_pk_add_f32 v[30:31], v[30:31], v[88:89]
  v_pk_add_f32 v[32:33], v[32:33], v[88:89]
  v_pk_add_f32 v[34:35], v[34:35], v[88:89]
  v_pk_add_f32 v[36:37], v[36:37], v[88:89]
  v_pk_add_f32 v[38:39], v[38:39], v[88:89]
  v_pk_add_f32 v[40:41], v[40:41], v[88:89]
  v_cvt_pk_bf16_f32 v164, v2, v3
  v_lshlrev_b32 v2, 16, v164
  v_and_b32 v3, 0xffff0000, v164
  v_cvt_pk_bf16_f32 v165, v4, v5
  v_lshlrev_b32 v4, 16, v165
  v_and_b32 v5, 0xffff0000, v165
  v_cvt_pk_bf16_f32 v166, v6, v7
  v_lshlrev_b32 v6, 16, v166
  v_and_b32 v7, 0xffff0000, v166
  v_cvt_pk_bf16_f32 v167, v8, v9
  v_lshlrev_b32 v8, 16, v167
  v_and_b32 v9, 0xffff0000, v167
  v_cvt_pk_bf16_f32 v164, v10, v11
  v_lshlrev_b32 v10, 16, v164
  v_and_b32 v11, 0xffff0000, v164
  v_cvt_pk_bf16_f32 v165, v12, v13
  v_lshlrev_b32 v12, 16, v165
  v_and_b32 v13, 0xffff0000, v165
  v_cvt_pk_bf16_f32 v166, v14, v15
  v_lshlrev_b32 v14, 16, v166
  v_and_b32 v15, 0xffff0000, v166
  v_cvt_pk_bf16_f32 v167, v16, v17
  v_lshlrev_b32 v16, 16, v167
  v_and_b32 v17, 0xffff0000, v167
  v_cvt_pk_bf16_f32 v164, v18, v19
  v_lshlrev_b32 v18, 16, v164
  v_and_b32 v19, 0xffff0000, v164
  v_cvt_pk_bf16_f32 v165, v20, v21
  v_lshlrev_b32 v20, 16, v165
  v_and_b32 v21, 0xffff0000, v165
  v_cvt_pk_bf16_f32 v166, v22, v23
  v_lshlrev_b32 v22, 16, v166
  v_and_b32 v23, 0xffff0000, v166
  v_cvt_pk_bf16_f32 v167, v24, v25
  v_lshlrev_b32 v24, 16, v167
  v_and_b32 v25, 0xffff0000, v167
  v_cvt_pk_bf16_f32 v164, v26, v27
  v_lshlrev_b32 v26, 16, v164
  v_and_b32 v27, 0xffff0000, v164
  v_cvt_pk_bf16_f32 v165, v28, v29
  v_lshlrev_b32 v28, 16, v165
  v_and_b32 v29, 0xffff0000, v165
  v_cvt_pk_bf16_f32 v166, v30, v31
  v_lshlrev_b32 v30, 16, v166
  v_and_b32 v31, 0xffff0000, v166
  v_cvt_pk_bf16_f32 v167, v32, v33
  v_lshlrev_b32 v32, 16, v167
  v_and_b32 v33, 0xffff0000, v167
  v_cvt_pk_bf16_f32 v164, v34, v35
  v_lshlrev_b32 v34, 16, v164
  v_and_b32 v35, 0xffff0000, v164
  v_cvt_pk_bf16_f32 v165, v36, v37
  v_lshlrev_b32 v36, 16, v165
  v_and_b32 v37, 0xffff0000, v165
  v_cvt_pk_bf16_f32 v166, v38, v39
  v_lshlrev_b32 v38, 16, v166
  v_and_b32 v39, 0xffff0000, v166
  v_cvt_pk_bf16_f32 v167, v40, v41
  v_lshlrev_b32 v40, 16, v167
  v_and_b32 v41, 0xffff0000, v167
  s_sub_u32 s36, s33, 0
  s_min_u32 s36, s36, 24
  v_mov_b32 v92, s36
  s_waitcnt vmcnt(10)
  buffer_store_dword v92, v228, s[8:11], 0 offen
  v_pk_mul_f32 v[2:3], v[2:3], v[86:87]
  v_pk_mul_f32 v[4:5], v[4:5], v[86:87]
  v_pk_mul_f32 v[6:7], v[6:7], v[86:87]
  v_pk_mul_f32 v[8:9], v[8:9], v[86:87]
  v_pk_mul_f32 v[10:11], v[10:11], v[86:87]
  v_pk_mul_f32 v[12:13], v[12:13], v[86:87]
  v_pk_mul_f32 v[14:15], v[14:15], v[86:87]
  v_pk_mul_f32 v[16:17], v[16:17], v[86:87]
  v_pk_mul_f32 v[18:19], v[18:19], v[86:87]
  v_pk_mul_f32 v[20:21], v[20:21], v[86:87]
  v_pk_mul_f32 v[22:23], v[22:23], v[86:87]
  v_pk_mul_f32 v[24:25], v[24:25], v[86:87]
  v_pk_mul_f32 v[26:27], v[26:27], v[86:87]
  v_pk_mul_f32 v[28:29], v[28:29], v[86:87]
  v_pk_mul_f32 v[30:31], v[30:31], v[86:87]
  v_pk_mul_f32 v[32:33], v[32:33], v[86:87]
  v_pk_mul_f32 v[34:35], v[34:35], v[86:87]
  v_pk_mul_f32 v[36:37], v[36:37], v[86:87]
  v_pk_mul_f32 v[38:39], v[38:39], v[86:87]
  v_pk_mul_f32 v[40:41], v[40:41], v[86:87]
  v_cvt_pk_bf16_f32 v164, v2, v3
  v_lshlrev_b32 v2, 16, v164
  v_and_b32 v3, 0xffff0000, v164
  v_cvt_pk_bf16_f32 v165, v4, v5
  v_lshlrev_b32 v4, 16, v165
  v_and_b32 v5, 0xffff0000, v165
  v_cvt_pk_bf16_f32 v166, v6, v7
  v_lshlrev_b32 v6, 16, v166
  v_and_b32 v7, 0xffff0000, v166
  v_cvt_pk_bf16_f32 v167, v8, v9
  v_lshlrev_b32 v8, 16, v167
  v_and_b32 v9, 0xffff0000, v167
  v_cvt_pk_bf16_f32 v164, v10, v11
  v_lshlrev_b32 v10, 16, v164
  v_and_b32 v11, 0xffff0000, v164
  v_cvt_pk_bf16_f32 v165, v12, v13
  v_lshlrev_b32 v12, 16, v165
  v_and_b32 v13, 0xffff0000, v165
  v_cvt_pk_bf16_f32 v166, v14, v15
  v_lshlrev_b32 v14, 16, v166
  v_and_b32 v15, 0xffff0000, v166
  v_cvt_pk_bf16_f32 v167, v16, v17
  v_lshlrev_b32 v16, 16, v167
  v_and_b32 v17, 0xffff0000, v167
  v_cvt_pk_bf16_f32 v164, v18, v19
  v_lshlrev_b32 v18, 16, v164
  v_and_b32 v19, 0xffff0000, v164
  v_cvt_pk_bf16_f32 v165, v20, v21
  v_lshlrev_b32 v20, 16, v165
  v_and_b32 v21, 0xffff0000, v165
  v_cvt_pk_bf16_f32 v166, v22, v23
  v_lshlrev_b32 v22, 16, v166
  v_and_b32 v23, 0xffff0000, v166
  v_cvt_pk_bf16_f32 v167, v24, v25
  v_lshlrev_b32 v24, 16, v167
  v_and_b32 v25, 0xffff0000, v167
  v_cvt_pk_bf16_f32 v164, v26, v27
  v_lshlrev_b32 v26, 16, v164
  v_and_b32 v27, 0xffff0000, v164
  v_cvt_pk_bf16_f32 v165, v28, v29
  v_lshlrev_b32 v28, 16, v165
  v_and_b32 v29, 0xffff0000, v165
  v_cvt_pk_bf16_f32 v166, v30, v31
  v_lshlrev_b32 v30, 16, v166
  v_and_b32 v31, 0xffff0000, v166
  v_cvt_pk_bf16_f32 v167, v32, v33
  v_lshlrev_b32 v32, 16, v167
  v_and_b32 v33, 0xffff0000, v167
  v_cvt_pk_bf16_f32 v164, v34, v35
  v_lshlrev_b32 v34, 16, v164
  v_and_b32 v35, 0xffff0000, v164
  v_cvt_pk_bf16_f32 v165, v36, v37
  v_lshlrev_b32 v36, 16, v165
  v_and_b32 v37, 0xffff0000, v165
  v_cvt_pk_bf16_f32 v166, v38, v39
  v_lshlrev_b32 v38, 16, v166
  v_and_b32 v39, 0xffff0000, v166
  v_cvt_pk_bf16_f32 v167, v40, v41
  v_lshlrev_b32 v40, 16, v167
  v_and_b32 v41, 0xffff0000, v167
  v_mul_f32_dpp v2, v176, v2 quad_perm:[2,2,2,2] row_mask:0xf bank_mask:0xf
  v_mul_f32_dpp v3, v177, v3 quad_perm:[2,2,2,2] row_mask:0xf bank_mask:0xf
  v_mul_f32_dpp v4, v178, v4 quad_perm:[2,2,2,2] row_mask:0xf bank_mask:0xf
  v_mul_f32_dpp v5, v179, v5 quad_perm:[2,2,2,2] row_mask:0xf bank_mask:0xf
  v_mul_f32_dpp v6, v176, v6 quad_perm:[3,3,3,3] row_mask:0xf bank_mask:0xf
  v_mul_f32_dpp v7, v177, v7 quad_perm:[3,3,3,3] row_mask:0xf bank_mask:0xf
  v_mul_f32_dpp v8, v178, v8 quad_perm:[3,3,3,3] row_mask:0xf bank_mask:0xf
  v_mul_f32_dpp v9, v179, v9 quad_perm:[3,3,3,3] row_mask:0xf bank_mask:0xf
  v_cvt_pk_bf16_f32 v164, v2, v3
  v_lshlrev_b32 v2, 16, v164
  v_and_b32 v3, 0xffff0000, v164
  v_cvt_pk_bf16_f32 v165, v4, v5
  v_lshlrev_b32 v4, 16, v165
  v_and_b32 v5, 0xffff0000, v165
  v_cvt_pk_bf16_f32 v166, v6, v7
  v_lshlrev_b32 v6, 16, v166
  v_and_b32 v7, 0xffff0000, v166
  v_cvt_pk_bf16_f32 v167, v8, v9
  v_lshlrev_b32 v8, 16, v167
  v_and_b32 v9, 0xffff0000, v167
  v_add_f32_dpp v2, v176, v2 quad_perm:[0,0,0,0] row_mask:0xf bank_mask:0xf
  v_add_f32_dpp v3, v177, v3 quad_perm:[0,0,0,0] row_mask:0xf bank_mask:0xf
  v_add_f32_dpp v4, v178, v4 quad_perm:[0,0,0,0] row_mask:0xf bank_mask:0xf
  v_add_f32_dpp v5, v179, v5 quad_perm:[0,0,0,0] row_mask:0xf bank_mask:0xf
  v_add_f32_dpp v6, v176, v6 quad_perm:[1,1,1,1] row_mask:0xf bank_mask:0xf
  v_add_f32_dpp v7, v177, v7 quad_perm:[1,1,1,1] row_mask:0xf bank_mask:0xf
  v_add_f32_dpp v8, v178, v8 quad_perm:[1,1,1,1] row_mask:0xf bank_mask:0xf
  v_add_f32_dpp v9, v179, v9 quad_perm:[1,1,1,1] row_mask:0xf bank_mask:0xf
  v_cvt_pk_bf16_f32 v196, v2, v3
  v_cvt_pk_bf16_f32 v197, v4, v5
  v_cvt_pk_bf16_f32 v198, v6, v7
  v_cvt_pk_bf16_f32 v199, v8, v9
  s_add_u32 s35, s38, 0
  buffer_store_dwordx4 v[196:199], v161, s[8:11], s35 offen sc1
  v_mul_f32_dpp v10, v180, v10 quad_perm:[2,2,2,2] row_mask:0xf bank_mask:0xf
  v_mul_f32_dpp v11, v181, v11 quad_perm:[2,2,2,2] row_mask:0xf bank_mask:0xf
  v_mul_f32_dpp v12, v182, v12 quad_perm:[2,2,2,2] row_mask:0xf bank_mask:0xf
  v_mul_f32_dpp v13, v183, v13 quad_perm:[2,2,2,2] row_mask:0xf bank_mask:0xf
  v_mul_f32_dpp v14, v180, v14 quad_perm:[3,3,3,3] row_mask:0xf bank_mask:0xf
  v_mul_f32_dpp v15, v181, v15 quad_perm:[3,3,3,3] row_mask:0xf bank_mask:0xf
  v_mul_f32_dpp v16, v182, v16 quad_perm:[3,3,3,3] row_mask:0xf bank_mask:0xf
  v_mul_f32_dpp v17, v183, v17 quad_perm:[3,3,3,3] row_mask:0xf bank_mask:0xf
  v_cvt_pk_bf16_f32 v164, v10, v11
  v_lshlrev_b32 v10, 16, v164
  v_and_b32 v11, 0xffff0000, v164
  v_cvt_pk_bf16_f32 v165, v12, v13
  v_lshlrev_b32 v12, 16, v165
  v_and_b32 v13, 0xffff0000, v165
  v_cvt_pk_bf16_f32 v166, v14, v15
  v_lshlrev_b32 v14, 16, v166
  v_and_b32 v15, 0xffff0000, v166
  v_cvt_pk_bf16_f32 v167, v16, v17
  v_lshlrev_b32 v16, 16, v167
  v_and_b32 v17, 0xffff0000, v167
  v_add_f32_dpp v10, v180, v10 quad_perm:[0,0,0,0] row_mask:0xf bank_mask:0xf
  v_add_f32_dpp v11, v181, v11 quad_perm:[0,0,0,0] row_mask:0xf bank_mask:0xf
  v_add_f32_dpp v12, v182, v12 quad_perm:[0,0,0,0] row_mask:0xf bank_mask:0xf
  v_add_f32_dpp v13, v183, v13 quad_perm:[0,0,0,0] row_mask:0xf bank_mask:0xf
  v_add_f32_dpp v14, v180, v14 quad_perm:[1,1,1,1] row_mask:0xf bank_mask:0xf
  v_add_f32_dpp v15, v181, v15 quad_perm:[1,1,1,1] row_mask:0xf bank_mask:0xf
  v_add_f32_dpp v16, v182, v16 quad_perm:[1,1,1,1] row_mask:0xf bank_mask:0xf
  v_add_f32_dpp v17, v183, v17 quad_perm:[1,1,1,1] row_mask:0xf bank_mask:0xf
  v_cvt_pk_bf16_f32 v200, v10, v11
  v_cvt_pk_bf16_f32 v201, v12, v13
  v_cvt_pk_bf16_f32 v202, v14, v15
  v_cvt_pk_bf16_f32 v203, v16, v17
  s_add_u32 s35, s38, 4096
  buffer_store_dwordx4 v[200:203], v161, s[8:11], s35 offen sc1
  v_mul_f32_dpp v18, v184, v18 quad_perm:[2,2,2,2] row_mask:0xf bank_mask:0xf
  v_mul_f32_dpp v19, v185, v19 quad_perm:[2,2,2,2] row_mask:0xf bank_mask:0xf
  v_mul_f32_dpp v20, v186, v20 quad_perm:[2,2,2,2] row_mask:0xf bank_mask:0xf
  v_mul_f32_dpp v21, v187, v21 quad_perm:[2,2,2,2] row_mask:0xf bank_mask:0xf
  v_mul_f32_dpp v22, v184, v22 quad_perm:[3,3,3,3] row_mask:0xf bank_mask:0xf
  v_mul_f32_dpp v23, v185, v23 quad_perm:[3,3,3,3] row_mask:0xf bank_mask:0xf
  v_mul_f32_dpp v24, v186, v24 quad_perm:[3,3,3,3] row_mask:0xf bank_mask:0xf
  v_mul_f32_dpp v25, v187, v25 quad_perm:[3,3,3,3] row_mask:0xf bank_mask:0xf
  v_cvt_pk_bf16_f32 v164, v18, v19
  v_lshlrev_b32 v18, 16, v164
  v_and_b32 v19, 0xffff0000, v164
  v_cvt_pk_bf16_f32 v165, v20, v21
  v_lshlrev_b32 v20, 16, v165
  v_and_b32 v21, 0xffff0000, v165
  v_cvt_pk_bf16_f32 v166, v22, v23
  v_lshlrev_b32 v22, 16, v166
  v_and_b32 v23, 0xffff0000, v166
  v_cvt_pk_bf16_f32 v167, v24, v25
  v_lshlrev_b32 v24, 16, v167
  v_and_b32 v25, 0xffff0000, v167
  v_add_f32_dpp v18, v184, v18 quad_perm:[0,0,0,0] row_mask:0xf bank_mask:0xf
  v_add_f32_dpp v19, v185, v19 quad_perm:[0,0,0,0] row_mask:0xf bank_mask:0xf
  v_add_f32_dpp v20, v186, v20 quad_perm:[0,0,0,0] row_mask:0xf bank_mask:0xf
  v_add_f32_dpp v21, v187, v21 quad_perm:[0,0,0,0] row_mask:0xf bank_mask:0xf
  v_add_f32_dpp v22, v184, v22 quad_perm:[1,1,1,1] row_mask:0xf bank_mask:0xf
  v_add_f32_dpp v23, v185, v23 quad_perm:[1,1,1,1] row_mask:0xf bank_mask:0xf
  v_add_f32_dpp v24, v186, v24 quad_perm:[1,1,1,1] row_mask:0xf bank_mask:0xf
  v_add_f32_dpp v25, v187, v25 quad_perm:[1,1,1,1] row_mask:0xf bank_mask:0xf
  v_cvt_pk_bf16_f32 v204, v18, v19
  v_cvt_pk_bf16_f32 v205, v20, v21
  v_cvt_pk_bf16_f32 v206, v22, v23
  v_cvt_pk_bf16_f32 v207, v24, v25
  s_add_u32 s35, s38, 8192
  buffer_store_dwordx4 v[204:207], v161, s[8:11], s35 offen sc1
  v_mul_f32_dpp v26, v188, v26 quad_perm:[2,2,2,2] row_mask:0xf bank_mask:0xf
  v_mul_f32_dpp v27, v189, v27 quad_perm:[2,2,2,2] row_mask:0xf bank_mask:0xf
  v_mul_f32_dpp v28, v190, v28 quad_perm:[2,2,2,2] row_mask:0xf bank_mask:0xf
  v_mul_f32_dpp v29, v191, v29 quad_perm:[2,2,2,2] row_mask:0xf bank_mask:0xf
  v_mul_f32_dpp v30, v188, v30 quad_perm:[3,3,3,3] row_mask:0xf bank_mask:0xf
  v_mul_f32_dpp v31, v189, v31 quad_perm:[3,3,3,3] row_mask:0xf bank_mask:0xf
  v_mul_f32_dpp v32, v190, v32 quad_perm:[3,3,3,3] row_mask:0xf bank_mask:0xf
  v_mul_f32_dpp v33, v191, v33 quad_perm:[3,3,3,3] row_mask:0xf bank_mask:0xf
  v_cvt_pk_bf16_f32 v164, v26, v27
  v_lshlrev_b32 v26, 16, v164
  v_and_b32 v27, 0xffff0000, v164
  v_cvt_pk_bf16_f32 v165, v28, v29
  v_lshlrev_b32 v28, 16, v165
  v_and_b32 v29, 0xffff0000, v165
  v_cvt_pk_bf16_f32 v166, v30, v31
  v_lshlrev_b32 v30, 16, v166
  v_and_b32 v31, 0xffff0000, v166
  v_cvt_pk_bf16_f32 v167, v32, v33
  v_lshlrev_b32 v32, 16, v167
  v_and_b32 v33, 0xffff0000, v167
  v_add_f32_dpp v26, v188, v26 quad_perm:[0,0,0,0] row_mask:0xf bank_mask:0xf
  v_add_f32_dpp v27, v189, v27 quad_perm:[0,0,0,0] row_mask:0xf bank_mask:0xf
  v_add_f32_dpp v28, v190, v28 quad_perm:[0,0,0,0] row_mask:0xf bank_mask:0xf
  v_add_f32_dpp v29, v191, v29 quad_perm:[0,0,0,0] row_mask:0xf bank_mask:0xf
  v_add_f32_dpp v30, v188, v30 quad_perm:[1,1,1,1] row_mask:0xf bank_mask:0xf
  v_add_f32_dpp v31, v189, v31 quad_perm:[1,1,1,1] row_mask:0xf bank_mask:0xf
  v_add_f32_dpp v32, v190, v32 quad_perm:[1,1,1,1] row_mask:0xf bank_mask:0xf
  v_add_f32_dpp v33, v191, v33 quad_perm:[1,1,1,1] row_mask:0xf bank_mask:0xf
  v_cvt_pk_bf16_f32 v208, v26, v27
  v_cvt_pk_bf16_f32 v209, v28, v29
  v_cvt_pk_bf16_f32 v210, v30, v31
  v_cvt_pk_bf16_f32 v211, v32, v33
  s_add_u32 s35, s38, 12288
  buffer_store_dwordx4 v[208:211], v161, s[8:11], s35 offen sc1
  v_mul_f32_dpp v34, v192, v34 quad_perm:[2,2,2,2] row_mask:0xf bank_mask:0xf
  v_mul_f32_dpp v35, v193, v35 quad_perm:[2,2,2,2] row_mask:0xf bank_mask:0xf
  v_mul_f32_dpp v36, v194, v36 quad_perm:[2,2,2,2] row_mask:0xf bank_mask:0xf
  v_mul_f32_dpp v37, v195, v37 quad_perm:[2,2,2,2] row_mask:0xf bank_mask:0xf
  v_mul_f32_dpp v38, v192, v38 quad_perm:[3,3,3,3] row_mask:0xf bank_mask:0xf
  v_mul_f32_dpp v39, v193, v39 quad_perm:[3,3,3,3] row_mask:0xf bank_mask:0xf
  v_mul_f32_dpp v40, v194, v40 quad_perm:[3,3,3,3] row_mask:0xf bank_mask:0xf
  v_mul_f32_dpp v41, v195, v41 quad_perm:[3,3,3,3] row_mask:0xf bank_mask:0xf
  v_cvt_pk_bf16_f32 v164, v34, v35
  v_lshlrev_b32 v34, 16, v164
  v_and_b32 v35, 0xffff0000, v164
  v_cvt_pk_bf16_f32 v165, v36, v37
  v_lshlrev_b32 v36, 16, v165
  v_and_b32 v37, 0xffff0000, v165
  v_cvt_pk_bf16_f32 v166, v38, v39
  v_lshlrev_b32 v38, 16, v166
  v_and_b32 v39, 0xffff0000, v166
  v_cvt_pk_bf16_f32 v167, v40, v41
  v_lshlrev_b32 v40, 16, v167
  v_and_b32 v41, 0xffff0000, v167
  v_add_f32_dpp v34, v192, v34 quad_perm:[0,0,0,0] row_mask:0xf bank_mask:0xf
  v_add_f32_dpp v35, v193, v35 quad_perm:[0,0,0,0] row_mask:0xf bank_mask:0xf
  v_add_f32_dpp v36, v194, v36 quad_perm:[0,0,0,0] row_mask:0xf bank_mask:0xf
  v_add_f32_dpp v37, v195, v37 quad_perm:[0,0,0,0] row_mask:0xf bank_mask:0xf
  v_add_f32_dpp v38, v192, v38 quad_perm:[1,1,1,1] row_mask:0xf bank_mask:0xf
  v_add_f32_dpp v39, v193, v39 quad_perm:[1,1,1,1] row_mask:0xf bank_mask:0xf
  v_add_f32_dpp v40, v194, v40 quad_perm:[1,1,1,1] row_mask:0xf bank_mask:0xf
  v_add_f32_dpp v41, v195, v41 quad_perm:[1,1,1,1] row_mask:0xf bank_mask:0xf
  v_cvt_pk_bf16_f32 v212, v34, v35
  v_cvt_pk_bf16_f32 v213, v36, v37
  v_cvt_pk_bf16_f32 v214, v38, v39
  v_cvt_pk_bf16_f32 v215, v40, v41
  s_add_u32 s35, s38, 16384
  buffer_store_dwordx4 v[212:215], v161, s[8:11], s35 offen sc1
  s_add_u32 s36, s41, 24
  s_cmp_lt_u32 s41, 24
  s_cselect_b32 s36, s39, s36
  s_add_u32 s41, s41, 3
  s_cmp_lt_u32 s41, 24
  s_cselect_b32 s41, s41, s36
  s_min_u32 s41, s41, 127
  s_mul_i32 s38, s16, 2621440
  s_cmp_lt_u32 s41, 24
  s_cselect_b32 s38, s38, 0
  s_mul_i32 s36, s41, 20480
  s_add_u32 s38, s38, s36
  s_lshl_b32 s36, s17, 6
  s_add_u32 s38, s38, s36
  s_add_u32 s38, s38, 247463936
  s_add_u32 s33, s33, 3
  buffer_load_dwordx2 v[46:47], v160, s[20:23], s37 offen offset:0
  buffer_load_dwordx2 v[48:49], v160, s[20:23], s37 offen offset:32
  buffer_load_dwordx2 v[50:51], v160, s[20:23], s37 offen offset:256
  buffer_load_dwordx2 v[52:53], v160, s[20:23], s37 offen offset:288
  buffer_load_dwordx2 v[54:55], v160, s[20:23], s37 offen offset:512
  buffer_load_dwordx2 v[56:57], v160, s[20:23], s37 offen offset:544
  buffer_load_dwordx2 v[58:59], v160, s[20:23], s37 offen offset:768
  buffer_load_dwordx2 v[60:61], v160, s[20:23], s37 offen offset:800
  buffer_load_dwordx2 v[62:63], v160, s[20:23], s37 offen offset:1024
  buffer_load_dwordx2 v[64:65], v160, s[20:23], s37 offen offset:1056
  s_add_u32 s36, s40, 24
  s_cmp_lt_u32 s40, 24
  s_cselect_b32 s36, s39, s36
  s_add_u32 s40, s40, 3
  s_cmp_lt_u32 s40, 24
  s_cselect_b32 s40, s40, s36
  s_min_u32 s40, s40, 127
  s_mul_i32 s37, s40, 20480
  s_mul_i32 s36, s17, 5120
  s_add_u32 s37, s37, s36
  s_cmp_lt_u32 s33, 39
  s_cbranch_scc1 r_ln1
r_ln1e:
  s_waitcnt vmcnt(0)
  s_barrier
  s_cmp_lg_u32 s17, 0
  s_cbranch_scc1 r_h1
  v_mov_b32 v90, 204
  v_mov_b32 v91, 1
  s_waitcnt vmcnt(0)
  s_mov_b64 exec, 1
  buffer_atomic_add v91, v90, s[12:15], 0 offen sc1
  s_mov_b64 exec, -1
  s_cmp_lg_u32 s54, 0
  s_cbranch_scc1 r_h1
  v_mov_b32 v90, 204
  s_mov_b32 s34, 0
gw_12:
  buffer_load_dword v91, v90, s[12:15], 0 offen sc1
  s_add_u32 s34, s34, 1
  s_cmp_gt_u32 s34, 65536
  s_cbranch_scc1 role_abort
  s_waitcnt vmcnt(0)
  v_cmp_gt_u32 vcc, 24, v91
  s_cbranch_vccz gk_13
  s_sleep 8
  s_branch gw_12
gk_13:
  v_add_u32 v90, v228, v226
  v_mov_b32 v91, 128
  s_mov_b64 exec, 0xfff
  buffer_store_dword v91, v90, s[8:11], 0 offen
  s_mov_b64 exec, -1
r_h1:
  s_add_u32 s52, s52, 20
r_mod2:
  v_lshlrev_b32 v12, 2, v0
  buffer_load_dword v13, v12, s[44:47], 0 offen
  buffer_load_dword v14, v12, s[44:47], 0 offen offset:1024
  v_lshrrev_b32 v20, 3, v0
  v_and_b32 v21, 7, v0
  v_mul_u32_u24 v22, 153600, v20
  v_lshl_add_u32 v22, v21, 4, v22
  s_lshl_b32 s6, s52, 7
  buffer_load_dwordx4 v[28:31], v22, s[48:51], s6 offen nt
  s_add_u32 s6, s6, 7680
  buffer_load_dwordx4 v[32:35], v22, s[48:51], s6 offen nt
  s_add_u32 s6, s6, 7680
  buffer_load_dwordx4 v[36:39], v22, s[48:51], s6 offen nt
  s_add_u32 s6, s6, 7680
  buffer_load_dwordx4 v[40:43], v22, s[48:51], s6 offen nt
  s_add_u32 s6, s6, 7680
  buffer_load_dwordx4 v[44:47], v22, s[48:51], s6 offen nt
  s_add_u32 s6, s6, 7680
  buffer_load_dwordx4 v[48:51], v22, s[48:51], s6 offen nt
  s_add_u32 s6, s6, 7680
  buffer_load_dwordx4 v[52:55], v22, s[48:51], s6 offen nt
  s_add_u32 s6, s6, 7680
  buffer_load_dwordx4 v[56:59], v22, s[48:51], s6 offen nt
  s_add_u32 s6, s6, 7680
  buffer_load_dwordx4 v[60:63], v22, s[48:51], s6 offen nt
  s_add_u32 s6, s6, 7680
  buffer_load_dwordx4 v[64:67], v22, s[48:51], s6 offen nt
  s_add_u32 s6, s6, 7680
  buffer_load_dwordx4 v[68:71], v22, s[48:51], s6 offen nt
  s_add_u32 s6, s6, 7680
  buffer_load_dwordx4 v[72:75], v22, s[48:51], s6 offen nt
  s_add_u32 s6, s6, 7680
  buffer_load_dwordx4 v[76:79], v22, s[48:51], s6 offen nt
  s_add_u32 s6, s6, 7680
  buffer_load_dwordx4 v[80:83], v22, s[48:51], s6 offen nt
  s_add_u32 s6, s6, 7680
  buffer_load_dwordx4 v[84:87], v22, s[48:51], s6 offen nt
  s_add_u32 s6, s6, 7680
  buffer_load_dwordx4 v[88:91], v22, s[48:51], s6 offen nt
  s_add_u32 s6, s6, 7680
  buffer_load_dwordx4 v[92:95], v22, s[48:51], s6 offen nt
  s_add_u32 s6, s6, 7680
  buffer_load_dwordx4 v[96:99], v22, s[48:51], s6 offen nt
  s_add_u32 s6, s6, 7680
  buffer_load_dwordx4 v[100:103], v22, s[48:51], s6 offen nt
  s_add_u32 s6, s6, 7680
  buffer_load_dwordx4 v[104:107], v22, s[48:51], s6 offen nt
  s_add_u32 s6, s6, 7680
  s_waitcnt vmcnt(20)
  v_lshlrev_b32 v24, 16, v13
  v_and_b32 v25, 0xffff0000, v13
  v_mul_f32 v16, 0xbfb8aa3b, v24
  v_mul_f32 v17, 0xbfb8aa3b, v25
  v_exp_f32 v16, v16
  v_exp_f32 v17, v17
  v_add_f32 v16, 1.0, v16
  v_add_f32 v17, 1.0, v17
  v_rcp_f32 v16, v16
  v_rcp_f32 v17, v17
  v_mul_f32 v24, v24, v16
  v_mul_f32 v25, v25, v17
  v_cvt_pk_bf16_f32 v16, v24, v25
  v_lshlrev_b32 v24, 16, v16
  v_and_b32 v25, 0xffff0000, v16
  v_lshlrev_b32 v26, 16, v14
  v_and_b32 v27, 0xffff0000, v14
  v_mul_f32 v16, 0xbfb8aa3b, v26
  v_mul_f32 v17, 0xbfb8aa3b, v27
  v_exp_f32 v16, v16
  v_exp_f32 v17, v17
  v_add_f32 v16, 1.0, v16
  v_add_f32 v17, 1.0, v17
  v_rcp_f32 v16, v16
  v_rcp_f32 v17, v17
  v_mul_f32 v26, v26, v16
  v_mul_f32 v27, v27, v17
  v_cvt_pk_bf16_f32 v16, v26, v27
  v_lshlrev_b32 v26, 16, v16
  v_and_b32 v27, 0xffff0000, v16
  v_lshlrev_b32 v12, 3, v0
  ds_write_b64 v12, v[24:25]
  ds_write_b64 v12, v[26:27] offset:2048
  v_mul_u32_u24 v12, 80, v20
  s_waitcnt lgkmcnt(0)
  s_barrier
  ds_read_b128 v[108:111], v12 offset:0
  ds_read_b128 v[112:115], v12 offset:16
  ds_read_b128 v[116:119], v12 offset:32
  ds_read_b128 v[120:123], v12 offset:48
  ds_read_b128 v[124:127], v12 offset:64
  v_mov_b32 v148, 0
  v_mov_b32 v149, 0
  v_mov_b32 v150, 0
  v_mov_b32 v151, 0
  v_mov_b32 v152, 0
  v_mov_b32 v153, 0
  v_mov_b32 v154, 0
  v_mov_b32 v155, 0
  s_waitcnt lgkmcnt(0)
  v_lshrrev_b32 v128, 16, v108
  v_lshrrev_b32 v129, 16, v109
  v_lshrrev_b32 v130, 16, v110
  v_lshrrev_b32 v131, 16, v111
  v_lshrrev_b32 v132, 16, v112
  v_lshrrev_b32 v133, 16, v113
  v_lshrrev_b32 v134, 16, v114
  v_lshrrev_b32 v135, 16, v115
  v_lshrrev_b32 v136, 16, v116
  v_lshrrev_b32 v137, 16, v117
  v_lshrrev_b32 v138, 16, v118
  v_lshrrev_b32 v139, 16, v119
  v_lshrrev_b32 v140, 16, v120
  v_lshrrev_b32 v141, 16, v121
  v_lshrrev_b32 v142, 16, v122
  v_lshrrev_b32 v143, 16, v123
  v_lshrrev_b32 v144, 16, v124
  v_lshrrev_b32 v145, 16, v125
  v_lshrrev_b32 v146, 16, v126
  v_lshrrev_b32 v147, 16, v127
  s_waitcnt vmcnt(18)
  v_dot2c_f32_bf16 v148, v28, v128
  v_dot2c_f32_bf16 v149, v28, v108
  v_dot2c_f32_bf16 v150, v29, v128
  v_dot2c_f32_bf16 v151, v29, v108
  v_dot2c_f32_bf16 v152, v30, v128
  v_dot2c_f32_bf16 v153, v30, v108
  v_dot2c_f32_bf16 v154, v31, v128
  v_dot2c_f32_bf16 v155, v31, v108
  v_dot2c_f32_bf16 v148, v32, v129
  v_dot2c_f32_bf16 v149, v32, v109
  v_dot2c_f32_bf16 v150, v33, v129
  v_dot2c_f32_bf16 v151, v33, v109
  v_dot2c_f32_bf16 v152, v34, v129
  v_dot2c_f32_bf16 v153, v34, v109
  v_dot2c_f32_bf16 v154, v35, v129
  v_dot2c_f32_bf16 v155, v35, v109
  s_waitcnt vmcnt(16)
  v_dot2c_f32_bf16 v148, v36, v130
  v_dot2c_f32_bf16 v149, v36, v110
  v_dot2c_f32_bf16 v150, v37, v130
  v_dot2c_f32_bf16 v151, v37, v110
  v_dot2c_f32_bf16 v152, v38, v130
  v_dot2c_f32_bf16 v153, v38, v110
  v_dot2c_f32_bf16 v154, v39, v130
  v_dot2c_f32_bf16 v155, v39, v110
  v_dot2c_f32_bf16 v148, v40, v131
  v_dot2c_f32_bf16 v149, v40, v111
  v_dot2c_f32_bf16 v150, v41, v131
  v_dot2c_f32_bf16 v151, v41, v111
  v_dot2c_f32_bf16 v152, v42, v131
  v_dot2c_f32_bf16 v153, v42, v111
  v_dot2c_f32_bf16 v154, v43, v131
  v_dot2c_f32_bf16 v155, v43, v111
  s_waitcnt vmcnt(14)
  v_dot2c_f32_bf16 v148, v44, v132
  v_dot2c_f32_bf16 v149, v44, v112
  v_dot2c_f32_bf16 v150, v45, v132
  v_dot2c_f32_bf16 v151, v45, v112
  v_dot2c_f32_bf16 v152, v46, v132
  v_dot2c_f32_bf16 v153, v46, v112
  v_dot2c_f32_bf16 v154, v47, v132
  v_dot2c_f32_bf16 v155, v47, v112
  v_dot2c_f32_bf16 v148, v48, v133
  v_dot2c_f32_bf16 v149, v48, v113
  v_dot2c_f32_bf16 v150, v49, v133
  v_dot2c_f32_bf16 v151, v49, v113
  v_dot2c_f32_bf16 v152, v50, v133
  v_dot2c_f32_bf16 v153, v50, v113
  v_dot2c_f32_bf16 v154, v51, v133
  v_dot2c_f32_bf16 v155, v51, v113
  s_waitcnt vmcnt(12)
  v_dot2c_f32_bf16 v148, v52, v134
  v_dot2c_f32_bf16 v149, v52, v114
  v_dot2c_f32_bf16 v150, v53, v134
  v_dot2c_f32_bf16 v151, v53, v114
  v_dot2c_f32_bf16 v152, v54, v134
  v_dot2c_f32_bf16 v153, v54, v114
  v_dot2c_f32_bf16 v154, v55, v134
  v_dot2c_f32_bf16 v155, v55, v114
  v_dot2c_f32_bf16 v148, v56, v135
  v_dot2c_f32_bf16 v149, v56, v115
  v_dot2c_f32_bf16 v150, v57, v135
  v_dot2c_f32_bf16 v151, v57, v115
  v_dot2c_f32_bf16 v152, v58, v135
  v_dot2c_f32_bf16 v153, v58, v115
  v_dot2c_f32_bf16 v154, v59, v135
  v_dot2c_f32_bf16 v155, v59, v115
  s_waitcnt vmcnt(10)
  v_dot2c_f32_bf16 v148, v60, v136
  v_dot2c_f32_bf16 v149, v60, v116
  v_dot2c_f32_bf16 v150, v61, v136
  v_dot2c_f32_bf16 v151, v61, v116
  v_dot2c_f32_bf16 v152, v62, v136
  v_dot2c_f32_bf16 v153, v62, v116
  v_dot2c_f32_bf16 v154, v63, v136
  v_dot2c_f32_bf16 v155, v63, v116
  v_dot2c_f32_bf16 v148, v64, v137
  v_dot2c_f32_bf16 v149, v64, v117
  v_dot2c_f32_bf16 v150, v65, v137
  v_dot2c_f32_bf16 v151, v65, v117
  v_dot2c_f32_bf16 v152, v66, v137
  v_dot2c_f32_bf16 v153, v66, v117
  v_dot2c_f32_bf16 v154, v67, v137
  v_dot2c_f32_bf16 v155, v67, v117
  s_waitcnt vmcnt(8)
  v_dot2c_f32_bf16 v148, v68, v138
  v_dot2c_f32_bf16 v149, v68, v118
  v_dot2c_f32_bf16 v150, v69, v138
  v_dot2c_f32_bf16 v151, v69, v118
  v_dot2c_f32_bf16 v152, v70, v138
  v_dot2c_f32_bf16 v153, v70, v118
  v_dot2c_f32_bf16 v154, v71, v138
  v_dot2c_f32_bf16 v155, v71, v118
  v_dot2c_f32_bf16 v148, v72, v139
  v_dot2c_f32_bf16 v149, v72, v119
  v_dot2c_f32_bf16 v150, v73, v139
  v_dot2c_f32_bf16 v151, v73, v119
  v_dot2c_f32_bf16 v152, v74, v139
  v_dot2c_f32_bf16 v153, v74, v119
  v_dot2c_f32_bf16 v154, v75, v139
  v_dot2c_f32_bf16 v155, v75, v119
  s_waitcnt vmcnt(6)
  v_dot2c_f32_bf16 v148, v76, v140
  v_dot2c_f32_bf16 v149, v76, v120
  v_dot2c_f32_bf16 v150, v77, v140
  v_dot2c_f32_bf16 v151, v77, v120
  v_dot2c_f32_bf16 v152, v78, v140
  v_dot2c_f32_bf16 v153, v78, v120
  v_dot2c_f32_bf16 v154, v79, v140
  v_dot2c_f32_bf16 v155, v79, v120
  v_dot2c_f32_bf16 v148, v80, v141
  v_dot2c_f32_bf16 v149, v80, v121
  v_dot2c_f32_bf16 v150, v81, v141
  v_dot2c_f32_bf16 v151, v81, v121
  v_dot2c_f32_bf16 v152, v82, v141
  v_dot2c_f32_bf16 v153, v82, v121
  v_dot2c_f32_bf16 v154, v83, v141
  v_dot2c_f32_bf16 v155, v83, v121
  s_waitcnt vmcnt(4)
  v_dot2c_f32_bf16 v148, v84, v142
  v_dot2c_f32_bf16 v149, v84, v122
  v_dot2c_f32_bf16 v150, v85, v142
  v_dot2c_f32_bf16 v151, v85, v122
  v_dot2c_f32_bf16 v152, v86, v142
  v_dot2c_f32_bf16 v153, v86, v122
  v_dot2c_f32_bf16 v154, v87, v142
  v_dot2c_f32_bf16 v155, v87, v122
  v_dot2c_f32_bf16 v148, v88, v143
  v_dot2c_f32_bf16 v149, v88, v123
  v_dot2c_f32_bf16 v150, v89, v143
  v_dot2c_f32_bf16 v151, v89, v123
  v_dot2c_f32_bf16 v152, v90, v143
  v_dot2c_f32_bf16 v153, v90, v123
  v_dot2c_f32_bf16 v154, v91, v143
  v_dot2c_f32_bf16 v155, v91, v123
  s_waitcnt vmcnt(2)
  v_dot2c_f32_bf16 v148, v92, v144
  v_dot2c_f32_bf16 v149, v92, v124
  v_dot2c_f32_bf16 v150, v93, v144
  v_dot2c_f32_bf16 v151, v93, v124
  v_dot2c_f32_bf16 v152, v94, v144
  v_dot2c_f32_bf16 v153, v94, v124
  v_dot2c_f32_bf16 v154, v95, v144
  v_dot2c_f32_bf16 v155, v95, v124
  v_dot2c_f32_bf16 v148, v96, v145
  v_dot2c_f32_bf16 v149, v96, v125
  v_dot2c_f32_bf16 v150, v97, v145
  v_dot2c_f32_bf16 v151, v97, v125
  v_dot2c_f32_bf16 v152, v98, v145
  v_dot2c_f32_bf16 v153, v98, v125
  v_dot2c_f32_bf16 v154, v99, v145
  v_dot2c_f32_bf16 v155, v99, v125
  s_waitcnt vmcnt(0)
  v_dot2c_f32_bf16 v148, v100, v146
  v_dot2c_f32_bf16 v149, v100, v126
  v_dot2c_f32_bf16 v150, v101, v146
  v_dot2c_f32_bf16 v151, v101, v126
  v_dot2c_f32_bf16 v152, v102, v146
  v_dot2c_f32_bf16 v153, v102, v126
  v_dot2c_f32_bf16 v154, v103, v146
  v_dot2c_f32_bf16 v155, v103, v126
  v_dot2c_f32_bf16 v148, v104, v147
  v_dot2c_f32_bf16 v149, v104, v127
  v_dot2c_f32_bf16 v150, v105, v147
  v_dot2c_f32_bf16 v151, v105, v127
  v_dot2c_f32_bf16 v152, v106, v147
  v_dot2c_f32_bf16 v153, v106, v127
  v_dot2c_f32_bf16 v154, v107, v147
  v_dot2c_f32_bf16 v155, v107, v127
  v_lshlrev_b32 v12, 5, v0
  ds_write_b128 v12, v[148:151] offset:4096
  s_nop 0
  ds_write_b128 v12, v[152:155] offset:4112
  v_lshlrev_b32 v12, 2, v0
  s_waitcnt lgkmcnt(0)
  s_barrier
  s_cmp_lg_u32 s17, 0
  s_cbranch_scc1 mod_endb
  ds_read2st64_b32 v[28:29], v12 offset0:16 offset1:17
  ds_read2st64_b32 v[30:31], v12 offset0:18 offset1:19
  ds_read2st64_b32 v[32:33], v12 offset0:20 offset1:21
  ds_read2st64_b32 v[34:35], v12 offset0:22 offset1:23
  ds_read2st64_b32 v[36:37], v12 offset0:24 offset1:25
  ds_read2st64_b32 v[38:39], v12 offset0:26 offset1:27
  ds_read2st64_b32 v[40:41], v12 offset0:28 offset1:29
  ds_read2st64_b32 v[42:43], v12 offset0:30 offset1:31
  ds_read2st64_b32 v[44:45], v12 offset0:32 offset1:33
  ds_read2st64_b32 v[46:47], v12 offset0:34 offset1:35
  ds_read2st64_b32 v[48:49], v12 offset0:36 offset1:37
  ds_read2st64_b32 v[50:51], v12 offset0:38 offset1:39
  ds_read2st64_b32 v[52:53], v12 offset0:40 offset1:41
  ds_read2st64_b32 v[54:55], v12 offset0:42 offset1:43
  ds_read2st64_b32 v[56:57], v12 offset0:44 offset1:45
  ds_read2st64_b32 v[58:59], v12 offset0:46 offset1:47
  s_waitcnt lgkmcnt(11)
  v_pk_add_f32 v[28:29], v[28:29], v[30:31]
  v_pk_add_f32 v[28:29], v[28:29], v[32:33]
  v_pk_add_f32 v[28:29], v[28:29], v[34:35]
  v_pk_add_f32 v[28:29], v[28:29], v[36:37]
  s_waitcnt lgkmcnt(7)
  v_pk_add_f32 v[28:29], v[28:29], v[38:39]
  v_pk_add_f32 v[28:29], v[28:29], v[40:41]
  v_pk_add_f32 v[28:29], v[28:29], v[42:43]
  v_pk_add_f32 v[28:29], v[28:29], v[44:45]
  s_waitcnt lgkmcnt(3)
  v_pk_add_f32 v[28:29], v[28:29], v[46:47]
  v_pk_add_f32 v[28:29], v[28:29], v[48:49]
  v_pk_add_f32 v[28:29], v[28:29], v[50:51]
  v_pk_add_f32 v[28:29], v[28:29], v[52:53]
  s_waitcnt lgkmcnt(0)
  v_pk_add_f32 v[28:29], v[28:29], v[54:55]
  v_pk_add_f32 v[28:29], v[28:29], v[56:57]
  v_pk_add_f32 v[28:29], v[28:29], v[58:59]
  v_add_f32 v28, v28, v29
  v_cvt_pk_bf16_f32 v28, v28, v28
  v_lshlrev_b32 v28, 16, v28
  s_lshl_b32 s6, s52, 8
  s_add_u32 s6, s6, 65536
  buffer_store_dword v28, v12, s[8:11], s6 offen sc1
  v_mov_b32 v16, 196
  v_mov_b32 v17, 1
  s_waitcnt vmcnt(0)
  s_mov_b64 exec, 1
  buffer_atomic_add v17, v16, s[12:15], 0 offen sc1
  s_mov_b64 exec, -1
mod_endb:
  s_barrier
  s_add_u32 s52, s52, 24
  s_cmp_lt_u32 s52, 60
  s_cbranch_scc1 r_mod2
  v_mov_b32 v233, 0
  v_mov_b32 v234, 0
  v_mov_b32 v235, 0
  v_mov_b32 v236, 0
  v_mov_b32 v237, 0
  s_load_dwordx2 s[56:57], s[0:1], 72
  s_mov_b32 s58, 1966080
  s_mov_b32 s59, 0x00020000
  s_load_dwordx2 s[60:61], s[0:1], 80
  s_mov_b32 s62, 1966080
  s_mov_b32 s63, 0x00020000
  s_load_dwordx2 s[64:65], s[0:1], 88
  s_mov_b32 s66, 1966080
  s_mov_b32 s67, 0x00020000
  s_mul_i32 s68, s16, 3
  s_add_u32 s68, s68, s18
  s_sub_u32 s68, s68, 29
  s_mul_i32 s73, s17, 40960
  v_lshrrev_b32 v124, 4, v1
  v_and_b32 v124, 3, v124
  v_lshlrev_b32 v124, 1, v124
  v_and_b32 v4, 7, v1
  v_xor_b32 v4, v4, v124
  v_lshlrev_b32 v4, 4, v4
  v_lshrrev_b32 v124, 3, v1
  v_mul_u32_u24 v124, 0, v124
  v_add_u32 v4, v4, v124
  v_lshrrev_b32 v124, 4, v1
  v_and_b32 v124, 3, v124
  v_lshlrev_b32 v124, 1, v124
  v_and_b32 v5, 7, v1
  v_xor_b32 v5, v5, v124
  v_lshlrev_b32 v5, 4, v5
  v_lshrrev_b32 v124, 3, v1
  v_mul_u32_u24 v124, 1280, v124
  v_add_u32 v5, v5, v124
  v_bfe_u32 v124, v1, 3, 2
  v_bfe_u32 v125, v1, 5, 1
  v_lshl_add_u32 v124, v125, 3, v124
  v_mul_u32_u24 v124, 3072, v124
  v_add_u32 v4, v4, v124
  v_lshrrev_b32 v124, 2, v1
  v_lshrrev_b32 v125, 1, v124
  v_and_b32 v125, 3, v125
  v_lshlrev_b32 v125, 1, v125
  v_bfe_u32 v144, v1, 1, 1
  v_add_u32 v144, 0, v144
  v_xor_b32 v144, v144, v125
  v_lshlrev_b32 v144, 4, v144
  v_lshlrev_b32 v124, 7, v124
  v_add_u32 v144, v144, v124
  v_and_b32 v124, 1, v1
  v_lshlrev_b32 v124, 3, v124
  v_add_u32 v144, v144, v124
  v_add_u32 v144, s73, v144
  v_lshrrev_b32 v124, 2, v1
  v_lshrrev_b32 v125, 1, v124
  v_and_b32 v125, 3, v125
  v_lshlrev_b32 v125, 1, v125
  v_bfe_u32 v145, v1, 1, 1
  v_add_u32 v145, 2, v145
  v_xor_b32 v145, v145, v125
  v_lshlrev_b32 v145, 4, v145
  v_lshlrev_b32 v124, 7, v124
  v_add_u32 v145, v145, v124
  v_and_b32 v124, 1, v1
  v_lshlrev_b32 v124, 3, v124
  v_add_u32 v145, v145, v124
  v_add_u32 v145, s73, v145
  v_lshrrev_b32 v124, 2, v1
  v_lshrrev_b32 v125, 1, v124
  v_and_b32 v125, 3, v125
  v_lshlrev_b32 v125, 1, v125
  v_bfe_u32 v146, v1, 1, 1
  v_add_u32 v146, 4, v146
  v_xor_b32 v146, v146, v125
  v_lshlrev_b32 v146, 4, v146
  v_lshlrev_b32 v124, 7, v124
  v_add_u32 v146, v146, v124
  v_and_b32 v124, 1, v1
  v_lshlrev_b32 v124, 3, v124
  v_add_u32 v146, v146, v124
  v_add_u32 v146, s73, v146
  v_lshrrev_b32 v124, 2, v1
  v_lshrrev_b32 v125, 1, v124
  v_and_b32 v125, 3, v125
  v_lshlrev_b32 v125, 1, v125
  v_bfe_u32 v147, v1, 1, 1
  v_add_u32 v147, 6, v147
  v_xor_b32 v147, v147, v125
  v_lshlrev_b32 v147, 4, v147
  v_lshlrev_b32 v124, 7, v124
  v_add_u32 v147, v147, v124
  v_and_b32 v124, 1, v1
  v_lshlrev_b32 v124, 3, v124
  v_add_u32 v147, v147, v124
  v_add_u32 v147, s73, v147
  s_mul_i32 s72, s17, 491520
  s_lshl_b32 s70, s68, 7
  s_add_u32 s72, s72, s70
  s_waitcnt lgkmcnt(0)
  s_barrier
  s_add_u32 m0, s73, 0
  s_add_u32 s70, s72, 0
  buffer_load_dwordx4 v4, s[56:59], s70 offen nt lds
  s_add_u32 m0, s73, 1024
  s_add_u32 s70, s72, 49152
  buffer_load_dwordx4 v4, s[56:59], s70 offen nt lds
  s_add_u32 m0, s73, 2048
  s_add_u32 s70, s72, 12288
  buffer_load_dwordx4 v4, s[56:59], s70 offen nt lds
  s_add_u32 m0, s73, 3072
  s_add_u32 s70, s72, 61440
  buffer_load_dwordx4 v4, s[56:59], s70 offen nt lds
  s_add_u32 m0, s73, 4096
  s_add_u32 s70, s72, 98304
  buffer_load_dwordx4 v4, s[56:59], s70 offen nt lds
  s_add_u32 m0, s73, 5120
  s_add_u32 s70, s72, 147456
  buffer_load_dwordx4 v4, s[56:59], s70 offen nt lds
  s_add_u32 m0, s73, 6144
  s_add_u32 s70, s72, 110592
  buffer_load_dwordx4 v4, s[56:59], s70 offen nt lds
  s_add_u32 m0, s73, 7168
  s_add_u32 s70, s72, 159744
  buffer_load_dwordx4 v4, s[56:59], s70 offen nt lds
  s_add_u32 m0, s73, 8192
  s_add_u32 s70, s72, 196608
  buffer_load_dwordx4 v4, s[56:59], s70 offen nt lds
  s_add_u32 m0, s73, 9216
  s_add_u32 s70, s72, 245760
  buffer_load_dwordx4 v4, s[56:59], s70 offen nt lds
  s_add_u32 m0, s73, 10240
  s_add_u32 s70, s72, 208896
  buffer_load_dwordx4 v4, s[56:59], s70 offen nt lds
  s_add_u32 m0, s73, 11264
  s_add_u32 s70, s72, 258048
  buffer_load_dwordx4 v4, s[56:59], s70 offen nt lds
  s_add_u32 m0, s73, 12288
  s_add_u32 s70, s72, 294912
  buffer_load_dwordx4 v4, s[56:59], s70 offen nt lds
  s_add_u32 m0, s73, 13312
  s_add_u32 s70, s72, 344064
  buffer_load_dwordx4 v4, s[56:59], s70 offen nt lds
  s_add_u32 m0, s73, 14336
  s_add_u32 s70, s72, 307200
  buffer_load_dwordx4 v4, s[56:59], s70 offen nt lds
  s_add_u32 m0, s73, 15360
  s_add_u32 s70, s72, 356352
  buffer_load_dwordx4 v4, s[56:59], s70 offen nt lds
  s_add_u32 m0, s73, 16384
  s_add_u32 s70, s72, 393216
  buffer_load_dwordx4 v4, s[56:59], s70 offen nt lds
  s_add_u32 m0, s73, 17408
  s_add_u32 s70, s72, 442368
  buffer_load_dwordx4 v4, s[56:59], s70 offen nt lds
  s_add_u32 m0, s73, 18432
  s_add_u32 s70, s72, 405504
  buffer_load_dwordx4 v4, s[56:59], s70 offen nt lds
  s_add_u32 m0, s73, 19456
  s_add_u32 s70, s72, 454656
  buffer_load_dwordx4 v4, s[56:59], s70 offen nt lds
  s_add_u32 m0, s73, 20480
  s_add_u32 s70, s72, 0
  buffer_load_dwordx4 v4, s[60:63], s70 offen nt lds
  s_add_u32 m0, s73, 21504
  s_add_u32 s70, s72, 49152
  buffer_load_dwordx4 v4, s[60:63], s70 offen nt lds
  s_add_u32 m0, s73, 22528
  s_add_u32 s70, s72, 12288
  buffer_load_dwordx4 v4, s[60:63], s70 offen nt lds
  s_add_u32 m0, s73, 23552
  s_add_u32 s70, s72, 61440
  buffer_load_dwordx4 v4, s[60:63], s70 offen nt lds
  s_add_u32 m0, s73, 24576
  s_add_u32 s70, s72, 98304
  buffer_load_dwordx4 v4, s[60:63], s70 offen nt lds
  s_add_u32 m0, s73, 25600
  s_add_u32 s70, s72, 147456
  buffer_load_dwordx4 v4, s[60:63], s70 offen nt lds
  s_add_u32 m0, s73, 26624
  s_add_u32 s70, s72, 110592
  buffer_load_dwordx4 v4, s[60:63], s70 offen nt lds
  s_add_u32 m0, s73, 27648
  s_add_u32 s70, s72, 159744
  buffer_load_dwordx4 v4, s[60:63], s70 offen nt lds
  s_add_u32 m0, s73, 28672
  s_add_u32 s70, s72, 196608
  buffer_load_dwordx4 v4, s[60:63], s70 offen nt lds
  s_add_u32 m0, s73, 29696
  s_add_u32 s70, s72, 245760
  buffer_load_dwordx4 v4, s[60:63], s70 offen nt lds
  s_add_u32 m0, s73, 30720
  s_add_u32 s70, s72, 208896
  buffer_load_dwordx4 v4, s[60:63], s70 offen nt lds
  s_add_u32 m0, s73, 31744
  s_add_u32 s70, s72, 258048
  buffer_load_dwordx4 v4, s[60:63], s70 offen nt lds
  s_add_u32 m0, s73, 32768
  s_add_u32 s70, s72, 294912
  buffer_load_dwordx4 v4, s[60:63], s70 offen nt lds
  s_add_u32 m0, s73, 33792
  s_add_u32 s70, s72, 344064
  buffer_load_dwordx4 v4, s[60:63], s70 offen nt lds
  s_add_u32 m0, s73, 34816
  s_add_u32 s70, s72, 307200
  buffer_load_dwordx4 v4, s[60:63], s70 offen nt lds
  s_add_u32 m0, s73, 35840
  s_add_u32 s70, s72, 356352
  buffer_load_dwordx4 v4, s[60:63], s70 offen nt lds
  s_add_u32 m0, s73, 36864
  s_add_u32 s70, s72, 393216
  buffer_load_dwordx4 v4, s[60:63], s70 offen nt lds
  s_add_u32 m0, s73, 37888
  s_add_u32 s70, s72, 442368
  buffer_load_dwordx4 v4, s[60:63], s70 offen nt lds
  s_add_u32 m0, s73, 38912
  s_add_u32 s70, s72, 405504
  buffer_load_dwordx4 v4, s[60:63], s70 offen nt lds
  s_add_u32 m0, s73, 39936
  s_add_u32 s70, s72, 454656
  buffer_load_dwordx4 v4, s[60:63], s70 offen nt lds
  s_waitcnt vmcnt(36)
  ds_read_b64_tr_b16 a[0:1], v144 offset:0
  ds_read_b64_tr_b16 a[2:3], v144 offset:2048
  ds_read_b64_tr_b16 a[20:21], v145 offset:0
  ds_read_b64_tr_b16 a[22:23], v145 offset:2048
  ds_read_b64_tr_b16 a[40:41], v146 offset:0
  ds_read_b64_tr_b16 a[42:43], v146 offset:2048
  ds_read_b64_tr_b16 a[60:61], v147 offset:0
  ds_read_b64_tr_b16 a[62:63], v147 offset:2048
  s_waitcnt vmcnt(32)
  ds_read_b64_tr_b16 a[4:5], v144 offset:4096
  ds_read_b64_tr_b16 a[6:7], v144 offset:6144
  ds_read_b64_tr_b16 a[24:25], v145 offset:4096
  ds_read_b64_tr_b16 a[26:27], v145 offset:6144
  ds_read_b64_tr_b16 a[44:45], v146 offset:4096
  ds_read_b64_tr_b16 a[46:47], v146 offset:6144
  ds_read_b64_tr_b16 a[64:65], v147 offset:4096
  ds_read_b64_tr_b16 a[66:67], v147 offset:6144
  s_waitcnt lgkmcnt(0)
  s_waitcnt vmcnt(28)
  ds_read_b64_tr_b16 a[8:9], v144 offset:8192
  ds_read_b64_tr_b16 a[10:11], v144 offset:10240
  ds_read_b64_tr_b16 a[28:29], v145 offset:8192
  ds_read_b64_tr_b16 a[30:31], v145 offset:10240
  ds_read_b64_tr_b16 a[48:49], v146 offset:8192
  ds_read_b64_tr_b16 a[50:51], v146 offset:10240
  ds_read_b64_tr_b16 a[68:69], v147 offset:8192
  ds_read_b64_tr_b16 a[70:71], v147 offset:10240
  s_waitcnt vmcnt(24)
  ds_read_b64_tr_b16 a[12:13], v144 offset:12288
  ds_read_b64_tr_b16 a[14:15], v144 offset:14336
  ds_read_b64_tr_b16 a[32:33], v145 offset:12288
  ds_read_b64_tr_b16 a[34:35], v145 offset:14336
  ds_read_b64_tr_b16 a[52:53], v146 offset:12288
  ds_read_b64_tr_b16 a[54:55], v146 offset:14336
  ds_read_b64_tr_b16 a[72:73], v147 offset:12288
  ds_read_b64_tr_b16 a[74:75], v147 offset:14336
  s_waitcnt lgkmcnt(0)
  s_waitcnt vmcnt(20)
  ds_read_b64_tr_b16 a[16:17], v144 offset:16384
  ds_read_b64_tr_b16 a[18:19], v144 offset:18432
  ds_read_b64_tr_b16 a[36:37], v145 offset:16384
  ds_read_b64_tr_b16 a[38:39], v145 offset:18432
  ds_read_b64_tr_b16 a[56:57], v146 offset:16384
  ds_read_b64_tr_b16 a[58:59], v146 offset:18432
  ds_read_b64_tr_b16 a[76:77], v147 offset:16384
  ds_read_b64_tr_b16 a[78:79], v147 offset:18432
  s_waitcnt vmcnt(16)
  ds_read_b64_tr_b16 a[80:81], v144 offset:20480
  ds_read_b64_tr_b16 a[82:83], v144 offset:22528
  ds_read_b64_tr_b16 a[100:101], v145 offset:20480
  ds_read_b64_tr_b16 a[102:103], v145 offset:22528
  ds_read_b64_tr_b16 a[120:121], v146 offset:20480
  ds_read_b64_tr_b16 a[122:123], v146 offset:22528
  ds_read_b64_tr_b16 a[140:141], v147 offset:20480
  ds_read_b64_tr_b16 a[142:143], v147 offset:22528
  s_waitcnt lgkmcnt(0)
  s_waitcnt vmcnt(12)
  ds_read_b64_tr_b16 a[84:85], v144 offset:24576
  ds_read_b64_tr_b16 a[86:87], v144 offset:26624
  ds_read_b64_tr_b16 a[104:105], v145 offset:24576
  ds_read_b64_tr_b16 a[106:107], v145 offset:26624
  ds_read_b64_tr_b16 a[124:125], v146 offset:24576
  ds_read_b64_tr_b16 a[126:127], v146 offset:26624
  ds_read_b64_tr_b16 a[144:145], v147 offset:24576
  ds_read_b64_tr_b16 a[146:147], v147 offset:26624
  s_waitcnt vmcnt(8)
  ds_read_b64_tr_b16 a[88:89], v144 offset:28672
  ds_read_b64_tr_b16 a[90:91], v144 offset:30720
  ds_read_b64_tr_b16 a[108:109], v145 offset:28672
  ds_read_b64_tr_b16 a[110:111], v145 offset:30720
  ds_read_b64_tr_b16 a[128:129], v146 offset:28672
  ds_read_b64_tr_b16 a[130:131], v146 offset:30720
  ds_read_b64_tr_b16 a[148:149], v147 offset:28672
  ds_read_b64_tr_b16 a[150:151], v147 offset:30720
  s_waitcnt lgkmcnt(0)
  s_waitcnt vmcnt(4)
  ds_read_b64_tr_b16 a[92:93], v144 offset:32768
  ds_read_b64_tr_b16 a[94:95], v144 offset:34816
  ds_read_b64_tr_b16 a[112:113], v145 offset:32768
  ds_read_b64_tr_b16 a[114:115], v145 offset:34816
  ds_read_b64_tr_b16 a[132:133], v146 offset:32768
  ds_read_b64_tr_b16 a[134:135], v146 offset:34816
  ds_read_b64_tr_b16 a[152:153], v147 offset:32768
  ds_read_b64_tr_b16 a[154:155], v147 offset:34816
  s_waitcnt vmcnt(0)
  ds_read_b64_tr_b16 a[96:97], v144 offset:36864
  ds_read_b64_tr_b16 a[98:99], v144 offset:38912
  ds_read_b64_tr_b16 a[116:117], v145 offset:36864
  ds_read_b64_tr_b16 a[118:119], v145 offset:38912
  ds_read_b64_tr_b16 a[136:137], v146 offset:36864
  ds_read_b64_tr_b16 a[138:139], v146 offset:38912
  ds_read_b64_tr_b16 a[156:157], v147 offset:36864
  ds_read_b64_tr_b16 a[158:159], v147 offset:38912
  s_waitcnt lgkmcnt(0)
  s_mul_i32 s72, s68, 81920
  s_mul_i32 s70, s17, 320
  s_add_u32 s72, s72, s70
  s_add_u32 m0, s73, 0
  s_add_u32 s70, s72, 0
  buffer_load_dwordx4 v5, s[64:67], s70 offen nt lds
  s_add_u32 m0, s73, 1024
  s_add_u32 s70, s72, 10240
  buffer_load_dwordx4 v5, s[64:67], s70 offen nt lds
  s_add_u32 m0, s73, 2048
  s_add_u32 s70, s72, 20480
  buffer_load_dwordx4 v5, s[64:67], s70 offen nt lds
  s_add_u32 m0, s73, 3072
  s_add_u32 s70, s72, 30720
  buffer_load_dwordx4 v5, s[64:67], s70 offen nt lds
  s_add_u32 m0, s73, 4096
  s_add_u32 s70, s72, 40960
  buffer_load_dwordx4 v5, s[64:67], s70 offen nt lds
  s_add_u32 m0, s73, 5120
  s_add_u32 s70, s72, 51200
  buffer_load_dwordx4 v5, s[64:67], s70 offen nt lds
  s_add_u32 m0, s73, 6144
  s_add_u32 s70, s72, 61440
  buffer_load_dwordx4 v5, s[64:67], s70 offen nt lds
  s_add_u32 m0, s73, 7168
  s_add_u32 s70, s72, 71680
  buffer_load_dwordx4 v5, s[64:67], s70 offen nt lds
  s_add_u32 m0, s73, 8192
  s_add_u32 s70, s72, 128
  buffer_load_dwordx4 v5, s[64:67], s70 offen nt lds
  s_add_u32 m0, s73, 9216
  s_add_u32 s70, s72, 10368
  buffer_load_dwordx4 v5, s[64:67], s70 offen nt lds
  s_add_u32 m0, s73, 10240
  s_add_u32 s70, s72, 20608
  buffer_load_dwordx4 v5, s[64:67], s70 offen nt lds
  s_add_u32 m0, s73, 11264
  s_add_u32 s70, s72, 30848
  buffer_load_dwordx4 v5, s[64:67], s70 offen nt lds
  s_add_u32 m0, s73, 12288
  s_add_u32 s70, s72, 41088
  buffer_load_dwordx4 v5, s[64:67], s70 offen nt lds
  s_add_u32 m0, s73, 13312
  s_add_u32 s70, s72, 51328
  buffer_load_dwordx4 v5, s[64:67], s70 offen nt lds
  s_add_u32 m0, s73, 14336
  s_add_u32 s70, s72, 61568
  buffer_load_dwordx4 v5, s[64:67], s70 offen nt lds
  s_add_u32 m0, s73, 15360
  s_add_u32 s70, s72, 71808
  buffer_load_dwordx4 v5, s[64:67], s70 offen nt lds
  s_add_u32 m0, s73, 16384
  s_add_u32 s70, s72, 256
  buffer_load_dwordx4 v5, s[64:67], s70 offen nt lds
  s_add_u32 m0, s73, 17408
  s_add_u32 s70, s72, 10496
  buffer_load_dwordx4 v5, s[64:67], s70 offen nt lds
  s_add_u32 m0, s73, 18432
  s_add_u32 s70, s72, 20736
  buffer_load_dwordx4 v5, s[64:67], s70 offen nt lds
  s_add_u32 m0, s73, 19456
  s_add_u32 s70, s72, 30976
  buffer_load_dwordx4 v5, s[64:67], s70 offen nt lds
  s_add_u32 m0, s73, 20480
  s_add_u32 s70, s72, 41216
  buffer_load_dwordx4 v5, s[64:67], s70 offen nt lds
  s_add_u32 m0, s73, 21504
  s_add_u32 s70, s72, 51456
  buffer_load_dwordx4 v5, s[64:67], s70 offen nt lds
  s_add_u32 m0, s73, 22528
  s_add_u32 s70, s72, 61696
  buffer_load_dwordx4 v5, s[64:67], s70 offen nt lds
  s_add_u32 m0, s73, 23552
  s_add_u32 s70, s72, 71936
  buffer_load_dwordx4 v5, s[64:67], s70 offen nt lds
  s_waitcnt vmcnt(0)
  ds_read_b64_tr_b16 a[160:161], v144 offset:0
  ds_read_b64_tr_b16 a[162:163], v144 offset:2048
  ds_read_b64_tr_b16 a[164:165], v144 offset:4096
  ds_read_b64_tr_b16 a[166:167], v144 offset:6144
  ds_read_b64_tr_b16 a[168:169], v145 offset:0
  ds_read_b64_tr_b16 a[170:171], v145 offset:2048
  ds_read_b64_tr_b16 a[172:173], v145 offset:4096
  ds_read_b64_tr_b16 a[174:175], v145 offset:6144
  ds_read_b64_tr_b16 a[176:177], v146 offset:0
  ds_read_b64_tr_b16 a[178:179], v146 offset:2048
  ds_read_b64_tr_b16 a[180:181], v146 offset:4096
  ds_read_b64_tr_b16 a[182:183], v146 offset:6144
  s_waitcnt lgkmcnt(0)
  ds_read_b64_tr_b16 a[184:185], v147 offset:0
  ds_read_b64_tr_b16 a[186:187], v147 offset:2048
  ds_read_b64_tr_b16 a[188:189], v147 offset:4096
  ds_read_b64_tr_b16 a[190:191], v147 offset:6144
  ds_read_b64_tr_b16 a[192:193], v144 offset:8192
  ds_read_b64_tr_b16 a[194:195], v144 offset:10240
  ds_read_b64_tr_b16 a[196:197], v144 offset:12288
  ds_read_b64_tr_b16 a[198:199], v144 offset:14336
  ds_read_b64_tr_b16 a[200:201], v145 offset:8192
  ds_read_b64_tr_b16 a[202:203], v145 offset:10240
  ds_read_b64_tr_b16 a[204:205], v145 offset:12288
  ds_read_b64_tr_b16 a[206:207], v145 offset:14336
  s_waitcnt lgkmcnt(0)
  ds_read_b64_tr_b16 a[208:209], v146 offset:8192
  ds_read_b64_tr_b16 a[210:211], v146 offset:10240
  ds_read_b64_tr_b16 a[212:213], v146 offset:12288
  ds_read_b64_tr_b16 a[214:215], v146 offset:14336
  ds_read_b64_tr_b16 a[216:217], v147 offset:8192
  ds_read_b64_tr_b16 a[218:219], v147 offset:10240
  ds_read_b64_tr_b16 a[220:221], v147 offset:12288
  ds_read_b64_tr_b16 a[222:223], v147 offset:14336
  ds_read_b64_tr_b16 a[224:225], v144 offset:16384
  ds_read_b64_tr_b16 a[226:227], v144 offset:18432
  ds_read_b64_tr_b16 a[228:229], v144 offset:20480
  ds_read_b64_tr_b16 a[230:231], v144 offset:22528
  s_waitcnt lgkmcnt(0)
  ds_read_b64_tr_b16 a[232:233], v145 offset:16384
  ds_read_b64_tr_b16 a[234:235], v145 offset:18432
  ds_read_b64_tr_b16 a[236:237], v145 offset:20480
  ds_read_b64_tr_b16 a[238:239], v145 offset:22528
  v_lshlrev_b32 v233, 4, v1
  v_lshrrev_b32 v124, 2, v1
  v_and_b32 v125, 3, v1
  v_lshlrev_b32 v125, 2, v125
  v_lshl_add_u32 v234, v124, 7, v125
  v_lshrrev_b32 v124, 4, v1
  v_and_b32 v125, 7, v1
  v_lshlrev_b32 v125, 4, v125
  v_lshl_add_u32 v236, v124, 7, v125
  v_lshrrev_b32 v124, 5, v1
  v_mul_u32_u24 v124, 20480, v124
  v_and_b32 v125, 31, v1
  v_lshl_add_u32 v237, v125, 4, v124
  s_mul_i32 s78, s17, 24
  s_add_u32 s78, s78, s68
  s_mov_b32 s74, 0
  s_mov_b32 s75, 2097152
  s_waitcnt lgkmcnt(0)
  s_barrier
  s_mov_b32 s79, 0
  s_mov_b32 s80, 0
  s_mov_b32 s81, 0
  s_mov_b32 s82, 0
  s_mov_b32 s83, 0
  s_mov_b32 s84, 0
  s_mov_b32 s85, 0
  s_mov_b32 s86, 0
  s_branch r_par
r_help:
  s_load_dwordx2 s[20:21], s[0:1], 0
  s_mov_b32 s22, 2621440
  s_mov_b32 s23, 0x00020000
  s_load_dwordx2 s[24:25], s[0:1], 112
  s_mov_b32 s26, 2621440
  s_mov_b32 s27, 0x00020000
  s_load_dwordx2 s[28:29], s[0:1], 64
  s_mov_b32 s30, 1280
  s_mov_b32 s31, 0x00020000
  s_add_u32 s54, s18, 60
  v_lshlrev_b32 v226, 2, v1
  v_lshlrev_b32 v227, 3, v1
  v_mov_b32 v230, 0x00003f80
  v_mov_b32 v231, 0x3f800000
  s_waitcnt lgkmcnt(0)
r_par:
  v_mov_b32 v90, 196
  s_mov_b32 s34, 0
gw_14:
  buffer_load_dword v91, v90, s[12:15], 0 offen sc1
  s_add_u32 s34, s34, 1
  s_cmp_gt_u32 s34, 65536
  s_cbranch_scc1 role_abort
  s_waitcnt vmcnt(0)
  v_cmp_gt_u32 vcc, 40, v91
  s_cbranch_vccz gk_15
  s_sleep 8
  s_branch gw_14
gk_15:
  s_mov_b32 s35, 70656
  buffer_load_dwordx2 v[196:197], v227, s[8:11], s35 offen offset:0 sc1
  buffer_load_dwordx2 v[198:199], v227, s[8:11], s35 offen offset:512 sc1
  buffer_load_dwordx2 v[200:201], v227, s[8:11], s35 offen offset:1024 sc1
  buffer_load_dwordx2 v[202:203], v227, s[8:11], s35 offen offset:1536 sc1
  buffer_load_dwordx2 v[204:205], v227, s[8:11], s35 offen offset:2048 sc1
  s_mov_b32 s35, 73216
  buffer_load_dwordx2 v[186:187], v227, s[8:11], s35 offen offset:0 sc1
  buffer_load_dwordx2 v[188:189], v227, s[8:11], s35 offen offset:512 sc1
  buffer_load_dwordx2 v[190:191], v227, s[8:11], s35 offen offset:1024 sc1
  buffer_load_dwordx2 v[192:193], v227, s[8:11], s35 offen offset:1536 sc1
  buffer_load_dwordx2 v[194:195], v227, s[8:11], s35 offen offset:2048 sc1
  s_mov_b32 s35, 75776
  buffer_load_dwordx2 v[176:177], v227, s[8:11], s35 offen offset:0 sc1
  buffer_load_dwordx2 v[178:179], v227, s[8:11], s35 offen offset:512 sc1
  buffer_load_dwordx2 v[180:181], v227, s[8:11], s35 offen offset:1024 sc1
  buffer_load_dwordx2 v[182:183], v227, s[8:11], s35 offen offset:1536 sc1
  buffer_load_dwordx2 v[184:185], v227, s[8:11], s35 offen offset:2048 sc1
  s_mov_b32 s35, 78336
  buffer_load_dwordx2 v[206:207], v227, s[8:11], s35 offen offset:0 sc1
  buffer_load_dwordx2 v[208:209], v227, s[8:11], s35 offen offset:512 sc1
  buffer_load_dwordx2 v[210:211], v227, s[8:11], s35 offen offset:1024 sc1
  buffer_load_dwordx2 v[212:213], v227, s[8:11], s35 offen offset:1536 sc1
  buffer_load_dwordx2 v[214:215], v227, s[8:11], s35 offen offset:2048 sc1
  buffer_load_dword v22, v226, s[28:31], 0 offen offset:0
  buffer_load_dword v23, v226, s[28:31], 0 offen offset:256
  buffer_load_dword v24, v226, s[28:31], 0 offen offset:512
  buffer_load_dword v25, v226, s[28:31], 0 offen offset:768
  buffer_load_dword v26, v226, s[28:31], 0 offen offset:1024
  v_lshlrev_b32 v229, 7, v1
  s_lshl_b32 s35, s16, 8
  s_add_u32 s36, s35, 48
  s_add_u32 s35, s35, 4192
  v_and_b32 v90, 3, v1
  v_lshl_add_u32 v232, v90, 2, s35
  v_mov_b32 v228, s36
  s_waitcnt vmcnt(0)
  v_add_f32 v176, 1.0, v176
  v_add_f32 v177, 1.0, v177
  v_cvt_pk_bf16_f32 v90, v176, v177
  v_lshlrev_b32 v176, 16, v90
  v_and_b32 v177, 0xffff0000, v90
  v_add_f32 v178, 1.0, v178
  v_add_f32 v179, 1.0, v179
  v_cvt_pk_bf16_f32 v90, v178, v179
  v_lshlrev_b32 v178, 16, v90
  v_and_b32 v179, 0xffff0000, v90
  v_add_f32 v180, 1.0, v180
  v_add_f32 v181, 1.0, v181
  v_cvt_pk_bf16_f32 v90, v180, v181
  v_lshlrev_b32 v180, 16, v90
  v_and_b32 v181, 0xffff0000, v90
  v_add_f32 v182, 1.0, v182
  v_add_f32 v183, 1.0, v183
  v_cvt_pk_bf16_f32 v90, v182, v183
  v_lshlrev_b32 v182, 16, v90
  v_and_b32 v183, 0xffff0000, v90
  v_add_f32 v184, 1.0, v184
  v_add_f32 v185, 1.0, v185
  v_cvt_pk_bf16_f32 v90, v184, v185
  v_lshlrev_b32 v184, 16, v90
  v_and_b32 v185, 0xffff0000, v90
  v_lshlrev_b32 v216, 16, v22
  v_and_b32 v217, 0xffff0000, v22
  v_lshlrev_b32 v218, 16, v23
  v_and_b32 v219, 0xffff0000, v23
  v_lshlrev_b32 v220, 16, v24
  v_and_b32 v221, 0xffff0000, v24
  v_lshlrev_b32 v222, 16, v25
  v_and_b32 v223, 0xffff0000, v25
  v_lshlrev_b32 v224, 16, v26
  v_and_b32 v225, 0xffff0000, v26
  s_mov_b32 s39, s54
  s_lshl_b32 s32, s16, 2
  s_add_u32 s32, s32, s17
r_loop:
  s_lshl_b32 s40, s39, 5
  s_add_u32 s40, s40, s32
  s_mul_i32 s37, s40, 1280
  s_mul_i32 s38, s39, 327680
  s_mul_i32 s35, s32, 1280
  s_add_u32 s38, s38, s35
  s_add_u32 s38, s38, 226492416
  s_add_u32 s41, s39, 6
  s_min_u32 s41, s41, 64
  s_max_u32 s36, s39, 60
  s_lshl_b32 s36, s36, 14
  s_add_u32 s36, s36, 1179648
  s_add_u32 s53, s36, 8192
  buffer_load_dword v22, v226, s[20:23], s37 offen offset:0
  buffer_load_dword v23, v226, s[20:23], s37 offen offset:256
  buffer_load_dword v24, v226, s[20:23], s37 offen offset:512
  buffer_load_dword v25, v226, s[20:23], s37 offen offset:768
  buffer_load_dword v26, v226, s[20:23], s37 offen offset:1024
  s_cmp_ge_u32 s39, 54
  s_cbranch_scc1 r_km
  s_mov_b32 s34, 0
pw_16:
  buffer_load_dword v93, v232, s[8:11], 0 offen sc1
  s_add_u32 s34, s34, 1
  s_cmp_gt_u32 s34, 65536
  s_cbranch_scc1 role_abort
  s_waitcnt vmcnt(0)
pc_18:
  v_cmp_gt_u32 vcc, s41, v93
  s_nop 0
  s_and_b32 vcc_lo, vcc_lo, 0xf
  s_and_b32 vcc_hi, vcc_hi, 0x0
  s_cmp_eq_u64 vcc, 0
  s_cbranch_scc1 po_17
  s_sleep 8
  s_branch pw_16
po_17:
  s_branch r_go
r_km:
  s_mov_b32 s53, 0
  s_cmp_eq_u32 s39, 58
  s_cselect_b32 s53, 0, s53
  s_cmp_eq_u32 s39, 59
  s_cselect_b32 s53, 16, s53
  s_cmp_eq_u32 s39, 60
  s_cselect_b32 s53, 36, s53
  s_cmp_eq_u32 s39, 61
  s_cselect_b32 s53, 16, s53
  s_cmp_eq_u32 s39, 62
  s_cselect_b32 s53, 16, s53
  s_cmp_eq_u32 s39, 63
  s_cselect_b32 s53, 2, s53
  s_add_u32 s41, s39, 5
  s_min_u32 s41, s41, 63
  s_cmp_gt_u32 s39, 60
  s_cselect_b32 s41, 64, s41
  s_cmp_eq_u32 s39, 63
  s_cselect_b64 vcc, -1, 0
  v_cndmask_b32 v92, v228, v232, vcc
  s_mov_b32 s34, 0
pw_19:
  buffer_load_dword v93, v92, s[8:11], 0 offen sc1
  s_add_u32 s34, s34, 1
  s_cmp_gt_u32 s34, 65536
  s_cbranch_scc1 role_abort
  s_waitcnt vmcnt(0)
pc_21:
  v_cmp_gt_u32 vcc, s41, v93
  s_nop 0
  s_and_b32 vcc_lo, vcc_lo, 0xf
  s_and_b32 vcc_hi, vcc_hi, 0x0
  s_cmp_eq_u64 vcc, 0
  s_cbranch_scc1 po_20
  s_sleep 4
  s_branch pw_19
po_20:
  s_cmp_lt_u32 s34, 2
  s_cbranch_scc1 r_go
r_z:
  s_sub_u32 s53, s53, 1
  s_cbranch_scc1 r_go
  s_sleep 1
  s_branch r_z
r_go:
  s_mov_b32 s34, 0
r_ld:
  buffer_load_dword v46, v226, s[8:11], s38 offen offset:0 sc1
  buffer_load_dword v47, v226, s[8:11], s38 offen offset:256 sc1
  buffer_load_dword v48, v226, s[8:11], s38 offen offset:512 sc1
  buffer_load_dword v49, v226, s[8:11], s38 offen offset:768 sc1
  buffer_load_dword v50, v226, s[8:11], s38 offen offset:1024 sc1
  s_add_u32 s38, s38, 40960
  buffer_load_dword v51, v226, s[8:11], s38 offen offset:0 sc1
  buffer_load_dword v52, v226, s[8:11], s38 offen offset:256 sc1
  buffer_load_dword v53, v226, s[8:11], s38 offen offset:512 sc1
  buffer_load_dword v54, v226, s[8:11], s38 offen offset:768 sc1
  buffer_load_dword v55, v226, s[8:11], s38 offen offset:1024 sc1
  s_add_u32 s38, s38, 40960
  buffer_load_dword v56, v226, s[8:11], s38 offen offset:0 sc1
  buffer_load_dword v57, v226, s[8:11], s38 offen offset:256 sc1
  buffer_load_dword v58, v226, s[8:11], s38 offen offset:512 sc1
  buffer_load_dword v59, v226, s[8:11], s38 offen offset:768 sc1
  buffer_load_dword v60, v226, s[8:11], s38 offen offset:1024 sc1
  s_add_u32 s38, s38, 40960
  buffer_load_dword v61, v226, s[8:11], s38 offen offset:0 sc1
  buffer_load_dword v62, v226, s[8:11], s38 offen offset:256 sc1
  buffer_load_dword v63, v226, s[8:11], s38 offen offset:512 sc1
  buffer_load_dword v64, v226, s[8:11], s38 offen offset:768 sc1
  buffer_load_dword v65, v226, s[8:11], s38 offen offset:1024 sc1
  s_add_u32 s38, s38, 40960
  buffer_load_dword v66, v226, s[8:11], s38 offen offset:0 sc1
  buffer_load_dword v67, v226, s[8:11], s38 offen offset:256 sc1
  buffer_load_dword v68, v226, s[8:11], s38 offen offset:512 sc1
  buffer_load_dword v69, v226, s[8:11], s38 offen offset:768 sc1
  buffer_load_dword v70, v226, s[8:11], s38 offen offset:1024 sc1
  s_add_u32 s38, s38, 40960
  buffer_load_dword v71, v226, s[8:11], s38 offen offset:0 sc1
  buffer_load_dword v72, v226, s[8:11], s38 offen offset:256 sc1
  buffer_load_dword v73, v226, s[8:11], s38 offen offset:512 sc1
  buffer_load_dword v74, v226, s[8:11], s38 offen offset:768 sc1
  buffer_load_dword v75, v226, s[8:11], s38 offen offset:1024 sc1
  s_add_u32 s38, s38, 40960
  buffer_load_dword v76, v226, s[8:11], s38 offen offset:0 sc1
  buffer_load_dword v77, v226, s[8:11], s38 offen offset:256 sc1
  buffer_load_dword v78, v226, s[8:11], s38 offen offset:512 sc1
  buffer_load_dword v79, v226, s[8:11], s38 offen offset:768 sc1
  buffer_load_dword v80, v226, s[8:11], s38 offen offset:1024 sc1
  s_add_u32 s38, s38, 40960
  buffer_load_dword v81, v226, s[8:11], s38 offen offset:0 sc1
  buffer_load_dword v82, v226, s[8:11], s38 offen offset:256 sc1
  buffer_load_dword v83, v226, s[8:11], s38 offen offset:512 sc1
  buffer_load_dword v84, v226, s[8:11], s38 offen offset:768 sc1
  buffer_load_dword v85, v226, s[8:11], s38 offen offset:1024 sc1
  s_add_u32 s38, s38, 40960
  v_lshlrev_b32 v2, 16, v22
  v_and_b32 v3, 0xffff0000, v22
  v_lshlrev_b32 v4, 16, v23
  v_and_b32 v5, 0xffff0000, v23
  v_lshlrev_b32 v6, 16, v24
  v_and_b32 v7, 0xffff0000, v24
  v_lshlrev_b32 v8, 16, v25
  v_and_b32 v9, 0xffff0000, v25
  v_lshlrev_b32 v10, 16, v26
  v_and_b32 v11, 0xffff0000, v26
  s_waitcnt vmcnt(35)
  v_lshlrev_b32 v12, 16, v46
  v_and_b32 v13, 0xffff0000, v46
  v_lshlrev_b32 v14, 16, v47
  v_and_b32 v15, 0xffff0000, v47
  v_lshlrev_b32 v16, 16, v48
  v_and_b32 v17, 0xffff0000, v48
  v_lshlrev_b32 v18, 16, v49
  v_and_b32 v19, 0xffff0000, v49
  v_lshlrev_b32 v20, 16, v50
  v_and_b32 v21, 0xffff0000, v50
  v_max3_u32 v92, v46, v47, v48
  v_max3_u32 v92, v49, v50, v92
  s_waitcnt vmcnt(30)
  v_dot2c_f32_bf16 v12, v51, v230
  v_dot2c_f32_bf16 v13, v51, v231
  v_dot2c_f32_bf16 v14, v52, v230
  v_dot2c_f32_bf16 v15, v52, v231
  v_dot2c_f32_bf16 v16, v53, v230
  v_dot2c_f32_bf16 v17, v53, v231
  v_dot2c_f32_bf16 v18, v54, v230
  v_dot2c_f32_bf16 v19, v54, v231
  v_dot2c_f32_bf16 v20, v55, v230
  v_dot2c_f32_bf16 v21, v55, v231
  v_max3_u32 v92, v51, v52, v92
  v_max3_u32 v92, v54, v55, v92
  v_max_u32 v92, v53, v92
  s_waitcnt vmcnt(25)
  v_dot2c_f32_bf16 v12, v56, v230
  v_dot2c_f32_bf16 v13, v56, v231
  v_dot2c_f32_bf16 v14, v57, v230
  v_dot2c_f32_bf16 v15, v57, v231
  v_dot2c_f32_bf16 v16, v58, v230
  v_dot2c_f32_bf16 v17, v58, v231
  v_dot2c_f32_bf16 v18, v59, v230
  v_dot2c_f32_bf16 v19, v59, v231
  v_dot2c_f32_bf16 v20, v60, v230
  v_dot2c_f32_bf16 v21, v60, v231
  v_max3_u32 v92, v56, v57, v92
  v_max3_u32 v92, v59, v60, v92
  v_max_u32 v92, v58, v92
  s_waitcnt vmcnt(20)
  v_dot2c_f32_bf16 v12, v61, v230
  v_dot2c_f32_bf16 v13, v61, v231
  v_dot2c_f32_bf16 v14, v62, v230
  v_dot2c_f32_bf16 v15, v62, v231
  v_dot2c_f32_bf16 v16, v63, v230
  v_dot2c_f32_bf16 v17, v63, v231
  v_dot2c_f32_bf16 v18, v64, v230
  v_dot2c_f32_bf16 v19, v64, v231
  v_dot2c_f32_bf16 v20, v65, v230
  v_dot2c_f32_bf16 v21, v65, v231
  v_max3_u32 v92, v61, v62, v92
  v_max3_u32 v92, v64, v65, v92
  v_max_u32 v92, v63, v92
  s_waitcnt vmcnt(15)
  v_dot2c_f32_bf16 v12, v66, v230
  v_dot2c_f32_bf16 v13, v66, v231
  v_dot2c_f32_bf16 v14, v67, v230
  v_dot2c_f32_bf16 v15, v67, v231
  v_dot2c_f32_bf16 v16, v68, v230
  v_dot2c_f32_bf16 v17, v68, v231
  v_dot2c_f32_bf16 v18, v69, v230
  v_dot2c_f32_bf16 v19, v69, v231
  v_dot2c_f32_bf16 v20, v70, v230
  v_dot2c_f32_bf16 v21, v70, v231
  v_max3_u32 v92, v66, v67, v92
  v_max3_u32 v92, v69, v70, v92
  v_max_u32 v92, v68, v92
  s_waitcnt vmcnt(10)
  v_dot2c_f32_bf16 v12, v71, v230
  v_dot2c_f32_bf16 v13, v71, v231
  v_dot2c_f32_bf16 v14, v72, v230
  v_dot2c_f32_bf16 v15, v72, v231
  v_dot2c_f32_bf16 v16, v73, v230
  v_dot2c_f32_bf16 v17, v73, v231
  v_dot2c_f32_bf16 v18, v74, v230
  v_dot2c_f32_bf16 v19, v74, v231
  v_dot2c_f32_bf16 v20, v75, v230
  v_dot2c_f32_bf16 v21, v75, v231
  v_max3_u32 v92, v71, v72, v92
  v_max3_u32 v92, v74, v75, v92
  v_max_u32 v92, v73, v92
  s_waitcnt vmcnt(5)
  v_dot2c_f32_bf16 v12, v76, v230
  v_dot2c_f32_bf16 v13, v76, v231
  v_dot2c_f32_bf16 v14, v77, v230
  v_dot2c_f32_bf16 v15, v77, v231
  v_dot2c_f32_bf16 v16, v78, v230
  v_dot2c_f32_bf16 v17, v78, v231
  v_dot2c_f32_bf16 v18, v79, v230
  v_dot2c_f32_bf16 v19, v79, v231
  v_dot2c_f32_bf16 v20, v80, v230
  v_dot2c_f32_bf16 v21, v80, v231
  v_max3_u32 v92, v76, v77, v92
  v_max3_u32 v92, v79, v80, v92
  v_max_u32 v92, v78, v92
  s_waitcnt vmcnt(0)
  v_dot2c_f32_bf16 v12, v81, v230
  v_dot2c_f32_bf16 v13, v81, v231
  v_dot2c_f32_bf16 v14, v82, v230
  v_dot2c_f32_bf16 v15, v82, v231
  v_dot2c_f32_bf16 v16, v83, v230
  v_dot2c_f32_bf16 v17, v83, v231
  v_dot2c_f32_bf16 v18, v84, v230
  v_dot2c_f32_bf16 v19, v84, v231
  v_dot2c_f32_bf16 v20, v85, v230
  v_dot2c_f32_bf16 v21, v85, v231
  v_max3_u32 v92, v81, v82, v92
  v_max3_u32 v92, v84, v85, v92
  v_max_u32 v92, v83, v92
  v_cmp_eq_u32 vcc, -1, v92
  s_cbranch_vccz r_ok
  s_sub_u32 s38, s38, 327680
  s_add_u32 s34, s34, 1
  s_cmp_gt_u32 s34, 65536
  s_cbranch_scc1 role_abort
  s_sleep 2
  s_branch r_ld
r_ok:
  v_cvt_pk_bf16_f32 v90, v12, v13
  v_lshlrev_b32 v12, 16, v90
  v_and_b32 v13, 0xffff0000, v90
  v_cvt_pk_bf16_f32 v90, v14, v15
  v_lshlrev_b32 v14, 16, v90
  v_and_b32 v15, 0xffff0000, v90
  v_cvt_pk_bf16_f32 v90, v16, v17
  v_lshlrev_b32 v16, 16, v90
  v_and_b32 v17, 0xffff0000, v90
  v_cvt_pk_bf16_f32 v90, v18, v19
  v_lshlrev_b32 v18, 16, v90
  v_and_b32 v19, 0xffff0000, v90
  v_cvt_pk_bf16_f32 v90, v20, v21
  v_lshlrev_b32 v20, 16, v90
  v_and_b32 v21, 0xffff0000, v90
  v_pk_mul_f32 v[12:13], v[12:13], v[196:197]
  v_cvt_pk_bf16_f32 v90, v12, v13
  v_lshlrev_b32 v12, 16, v90
  v_and_b32 v13, 0xffff0000, v90
  v_pk_mul_f32 v[14:15], v[14:15], v[198:199]
  v_cvt_pk_bf16_f32 v90, v14, v15
  v_lshlrev_b32 v14, 16, v90
  v_and_b32 v15, 0xffff0000, v90
  v_pk_mul_f32 v[16:17], v[16:17], v[200:201]
  v_cvt_pk_bf16_f32 v90, v16, v17
  v_lshlrev_b32 v16, 16, v90
  v_and_b32 v17, 0xffff0000, v90
  v_pk_mul_f32 v[18:19], v[18:19], v[202:203]
  v_cvt_pk_bf16_f32 v90, v18, v19
  v_lshlrev_b32 v18, 16, v90
  v_and_b32 v19, 0xffff0000, v90
  v_pk_mul_f32 v[20:21], v[20:21], v[204:205]
  v_cvt_pk_bf16_f32 v90, v20, v21
  v_lshlrev_b32 v20, 16, v90
  v_and_b32 v21, 0xffff0000, v90
  v_pk_add_f32 v[2:3], v[2:3], v[12:13]
  v_cvt_pk_bf16_f32 v34, v2, v3
  v_lshlrev_b32 v2, 16, v34
  v_and_b32 v3, 0xffff0000, v34
  v_pk_add_f32 v[4:5], v[4:5], v[14:15]
  v_cvt_pk_bf16_f32 v35, v4, v5
  v_lshlrev_b32 v4, 16, v35
  v_and_b32 v5, 0xffff0000, v35
  v_pk_add_f32 v[6:7], v[6:7], v[16:17]
  v_cvt_pk_bf16_f32 v36, v6, v7
  v_lshlrev_b32 v6, 16, v36
  v_and_b32 v7, 0xffff0000, v36
  v_pk_add_f32 v[8:9], v[8:9], v[18:19]
  v_cvt_pk_bf16_f32 v37, v8, v9
  v_lshlrev_b32 v8, 16, v37
  v_and_b32 v9, 0xffff0000, v37
  v_pk_add_f32 v[10:11], v[10:11], v[20:21]
  v_cvt_pk_bf16_f32 v38, v10, v11
  v_lshlrev_b32 v10, 16, v38
  v_and_b32 v11, 0xffff0000, v38
  s_add_u32 s35, s37, 5242880
  buffer_store_dword v34, v226, s[8:11], s35 offen offset:0 sc1
  buffer_store_dword v35, v226, s[8:11], s35 offen offset:256 sc1
  buffer_store_dword v36, v226, s[8:11], s35 offen offset:512 sc1
  buffer_store_dword v37, v226, s[8:11], s35 offen offset:768 sc1
  buffer_store_dword v38, v226, s[8:11], s35 offen offset:1024 sc1
  v_pk_add_f32 v[86:87], v[2:3], v[4:5]
  v_pk_add_f32 v[88:89], v[6:7], v[8:9]
  v_pk_add_f32 v[86:87], v[86:87], v[10:11]
  v_pk_add_f32 v[86:87], v[86:87], v[88:89]
  v_add_f32 v86, v86, v87
  s_nop 1
  v_add_f32_dpp v86, v86, v86 row_ror:8 row_mask:0xf bank_mask:0xf
  s_nop 1
  v_add_f32_dpp v86, v86, v86 row_ror:4 row_mask:0xf bank_mask:0xf
  s_nop 1
  v_add_f32_dpp v86, v86, v86 row_ror:2 row_mask:0xf bank_mask:0xf
  s_nop 1
  v_add_f32_dpp v86, v86, v86 row_ror:1 row_mask:0xf bank_mask:0xf
  v_mov_b32 v90, v86
  s_nop 1
  v_permlane16_swap_b32 v86, v90
  v_add_f32 v86, v86, v90
  v_mov_b32 v90, v86
  s_nop 1
  v_permlane32_swap_b32 v86, v90
  v_add_f32 v86, v86, v90
  v_mul_f32 v88, 0xbacccccd, v86
  v_mul_f32 v89, 0xbacccccd, v86
  v_pk_add_f32 v[12:13], v[2:3], v[88:89]
  v_pk_add_f32 v[14:15], v[4:5], v[88:89]
  v_pk_add_f32 v[16:17], v[6:7], v[88:89]
  v_pk_add_f32 v[18:19], v[8:9], v[88:89]
  v_pk_add_f32 v[20:21], v[10:11], v[88:89]
  v_pk_mul_f32 v[86:87], v[12:13], v[12:13]
  v_pk_fma_f32 v[86:87], v[14:15], v[14:15], v[86:87]
  v_pk_fma_f32 v[86:87], v[16:17], v[16:17], v[86:87]
  v_pk_fma_f32 v[86:87], v[18:19], v[18:19], v[86:87]
  v_pk_fma_f32 v[86:87], v[20:21], v[20:21], v[86:87]
  v_add_f32 v86, v86, v87
  v_cvt_pk_bf16_f32 v91, v88, v89
  v_lshlrev_b32 v88, 16, v91
  v_and_b32 v89, 0xffff0000, v91
  v_add_f32_dpp v86, v86, v86 row_ror:8 row_mask:0xf bank_mask:0xf
  s_nop 1
  v_add_f32_dpp v86, v86, v86 row_ror:4 row_mask:0xf bank_mask:0xf
  s_nop 1
  v_add_f32_dpp v86, v86, v86 row_ror:2 row_mask:0xf bank_mask:0xf
  s_nop 1
  v_add_f32_dpp v86, v86, v86 row_ror:1 row_mask:0xf bank_mask:0xf
  v_mov_b32 v90, v86
  s_nop 1
  v_permlane16_swap_b32 v86, v90
  v_add_f32 v86, v86, v90
  v_mov_b32 v90, v86
  s_nop 1
  v_permlane32_swap_b32 v86, v90
  v_add_f32 v86, v86, v90
  v_pk_add_f32 v[12:13], v[2:3], v[88:89]
  v_pk_add_f32 v[14:15], v[4:5], v[88:89]
  v_pk_add_f32 v[16:17], v[6:7], v[88:89]
  v_pk_add_f32 v[18:19], v[8:9], v[88:89]
  v_pk_add_f32 v[20:21], v[10:11], v[88:89]
  v_mul_f32 v86, 0x3acccccd, v86
  v_cvt_pk_bf16_f32 v86, v86, v86
  v_lshlrev_b32 v86, 16, v86
  v_add_f32 v86, 0x3727c5ac, v86
  v_cvt_pk_bf16_f32 v86, v86, v86
  v_lshlrev_b32 v86, 16, v86
  v_sqrt_f32 v86, v86
  v_cvt_pk_bf16_f32 v90, v12, v13
  v_lshlrev_b32 v12, 16, v90
  v_and_b32 v13, 0xffff0000, v90
  v_cvt_pk_bf16_f32 v86, v86, v86
  v_lshlrev_b32 v86, 16, v86
  v_rcp_f32 v86, v86
  v_cvt_pk_bf16_f32 v90, v14, v15
  v_lshlrev_b32 v14, 16, v90
  v_and_b32 v15, 0xffff0000, v90
  v_cvt_pk_bf16_f32 v90, v16, v17
  v_lshlrev_b32 v16, 16, v90
  v_and_b32 v17, 0xffff0000, v90
  v_cvt_pk_bf16_f32 v90, v18, v19
  v_lshlrev_b32 v18, 16, v90
  v_and_b32 v19, 0xffff0000, v90
  v_cvt_pk_bf16_f32 v90, v20, v21
  v_lshlrev_b32 v20, 16, v90
  v_and_b32 v21, 0xffff0000, v90
  v_mov_b32 v87, v86
  v_pk_mul_f32 v[12:13], v[12:13], v[86:87]
  v_cvt_pk_bf16_f32 v90, v12, v13
  v_lshlrev_b32 v12, 16, v90
  v_and_b32 v13, 0xffff0000, v90
  v_pk_mul_f32 v[14:15], v[14:15], v[86:87]
  v_cvt_pk_bf16_f32 v90, v14, v15
  v_lshlrev_b32 v14, 16, v90
  v_and_b32 v15, 0xffff0000, v90
  v_pk_mul_f32 v[16:17], v[16:17], v[86:87]
  v_cvt_pk_bf16_f32 v90, v16, v17
  v_lshlrev_b32 v16, 16, v90
  v_and_b32 v17, 0xffff0000, v90
  v_pk_mul_f32 v[18:19], v[18:19], v[86:87]
  v_cvt_pk_bf16_f32 v90, v18, v19
  v_lshlrev_b32 v18, 16, v90
  v_and_b32 v19, 0xffff0000, v90
  v_pk_mul_f32 v[20:21], v[20:21], v[86:87]
  v_cvt_pk_bf16_f32 v90, v20, v21
  v_lshlrev_b32 v20, 16, v90
  v_and_b32 v21, 0xffff0000, v90
  v_pk_mul_f32 v[12:13], v[12:13], v[176:177]
  v_cvt_pk_bf16_f32 v90, v12, v13
  v_lshlrev_b32 v12, 16, v90
  v_and_b32 v13, 0xffff0000, v90
  v_pk_mul_f32 v[14:15], v[14:15], v[178:179]
  v_cvt_pk_bf16_f32 v90, v14, v15
  v_lshlrev_b32 v14, 16, v90
  v_and_b32 v15, 0xffff0000, v90
  v_pk_mul_f32 v[16:17], v[16:17], v[180:181]
  v_cvt_pk_bf16_f32 v90, v16, v17
  v_lshlrev_b32 v16, 16, v90
  v_and_b32 v17, 0xffff0000, v90
  v_pk_mul_f32 v[18:19], v[18:19], v[182:183]
  v_cvt_pk_bf16_f32 v90, v18, v19
  v_lshlrev_b32 v18, 16, v90
  v_and_b32 v19, 0xffff0000, v90
  v_pk_mul_f32 v[20:21], v[20:21], v[184:185]
  v_cvt_pk_bf16_f32 v90, v20, v21
  v_lshlrev_b32 v20, 16, v90
  v_and_b32 v21, 0xffff0000, v90
  v_pk_add_f32 v[12:13], v[12:13], v[186:187]
  v_cvt_pk_bf16_f32 v28, v12, v13
  v_pk_add_f32 v[14:15], v[14:15], v[188:189]
  v_cvt_pk_bf16_f32 v29, v14, v15
  v_pk_add_f32 v[16:17], v[16:17], v[190:191]
  v_cvt_pk_bf16_f32 v30, v16, v17
  v_pk_add_f32 v[18:19], v[18:19], v[192:193]
  v_cvt_pk_bf16_f32 v31, v18, v19
  v_pk_add_f32 v[20:21], v[20:21], v[194:195]
  v_cvt_pk_bf16_f32 v32, v20, v21
  s_add_u32 s35, s37, 8388608
  buffer_store_dword v28, v226, s[8:11], s35 offen offset:0 sc1
  buffer_store_dword v29, v226, s[8:11], s35 offen offset:256 sc1
  buffer_store_dword v30, v226, s[8:11], s35 offen offset:512 sc1
  buffer_store_dword v31, v226, s[8:11], s35 offen offset:768 sc1
  buffer_store_dword v32, v226, s[8:11], s35 offen offset:1024 sc1
  v_lshlrev_b32 v12, 16, v28
  v_and_b32 v13, 0xffff0000, v28
  v_lshlrev_b32 v14, 16, v29
  v_and_b32 v15, 0xffff0000, v29
  v_lshlrev_b32 v16, 16, v30
  v_and_b32 v17, 0xffff0000, v30
  v_lshlrev_b32 v18, 16, v31
  v_and_b32 v19, 0xffff0000, v31
  v_lshlrev_b32 v20, 16, v32
  v_and_b32 v21, 0xffff0000, v32
  v_pk_mul_f32 v[86:87], v[12:13], v[216:217]
  v_pk_fma_f32 v[86:87], v[14:15], v[218:219], v[86:87]
  v_pk_fma_f32 v[86:87], v[16:17], v[220:221], v[86:87]
  v_pk_fma_f32 v[86:87], v[18:19], v[222:223], v[86:87]
  v_pk_fma_f32 v[86:87], v[20:21], v[224:225], v[86:87]
  v_add_f32 v86, v86, v87
  v_pk_mul_f32 v[12:13], v[12:13], v[206:207]
  v_cvt_pk_bf16_f32 v90, v12, v13
  v_lshlrev_b32 v12, 16, v90
  v_and_b32 v13, 0xffff0000, v90
  v_pk_mul_f32 v[14:15], v[14:15], v[208:209]
  v_cvt_pk_bf16_f32 v90, v14, v15
  v_lshlrev_b32 v14, 16, v90
  v_and_b32 v15, 0xffff0000, v90
  v_pk_mul_f32 v[16:17], v[16:17], v[210:211]
  v_cvt_pk_bf16_f32 v90, v16, v17
  v_lshlrev_b32 v16, 16, v90
  v_and_b32 v17, 0xffff0000, v90
  v_pk_mul_f32 v[18:19], v[18:19], v[212:213]
  v_cvt_pk_bf16_f32 v90, v18, v19
  v_lshlrev_b32 v18, 16, v90
  v_and_b32 v19, 0xffff0000, v90
  v_pk_mul_f32 v[20:21], v[20:21], v[214:215]
  v_cvt_pk_bf16_f32 v90, v20, v21
  v_lshlrev_b32 v20, 16, v90
  v_and_b32 v21, 0xffff0000, v90
  v_pk_add_f32 v[12:13], v[12:13], v[2:3]
  v_cvt_pk_bf16_f32 v40, v12, v13
  v_pk_add_f32 v[14:15], v[14:15], v[4:5]
  v_cvt_pk_bf16_f32 v41, v14, v15
  v_pk_add_f32 v[16:17], v[16:17], v[6:7]
  v_cvt_pk_bf16_f32 v42, v16, v17
  v_pk_add_f32 v[18:19], v[18:19], v[8:9]
  v_cvt_pk_bf16_f32 v43, v18, v19
  v_pk_add_f32 v[20:21], v[20:21], v[10:11]
  v_cvt_pk_bf16_f32 v44, v20, v21
  buffer_store_dword v40, v226, s[24:27], s37 offen offset:0 sc1
  buffer_store_dword v41, v226, s[24:27], s37 offen offset:256 sc1
  buffer_store_dword v42, v226, s[24:27], s37 offen offset:512 sc1
  buffer_store_dword v43, v226, s[24:27], s37 offen offset:768 sc1
  buffer_store_dword v44, v226, s[24:27], s37 offen offset:1024 sc1
  v_add_f32_dpp v86, v86, v86 row_ror:8 row_mask:0xf bank_mask:0xf
  s_nop 1
  v_add_f32_dpp v86, v86, v86 row_ror:4 row_mask:0xf bank_mask:0xf
  s_nop 1
  v_add_f32_dpp v86, v86, v86 row_ror:2 row_mask:0xf bank_mask:0xf
  s_nop 1
  v_add_f32_dpp v86, v86, v86 row_ror:1 row_mask:0xf bank_mask:0xf
  v_mov_b32 v90, v86
  s_nop 1
  v_permlane16_swap_b32 v86, v90
  v_add_f32 v86, v86, v90
  v_mov_b32 v90, v86
  s_nop 1
  v_permlane32_swap_b32 v86, v90
  v_add_f32 v86, v86, v90
  v_cvt_pk_bf16_f32 v86, v86, v86
  v_lshlrev_b32 v86, 16, v86
  v_ashrrev_i32 v90, 31, v86
  v_or_b32 v90, 0x80000000, v90
  v_xor_b32 v86, v86, v90
  v_and_b32 v86, 0xffff0000, v86
  s_sub_u32 s35, 2047, s40
  v_or_b32 v86, s35, v86
  s_lshr_b32 s35, s40, 2
  s_lshl_b32 s35, s35, 7
  s_lshl_b32 s36, s17, 2
  s_add_u32 s35, s35, s36
  s_add_u32 s35, s35, 2097152
  v_mov_b32 v91, s35
  s_waitcnt vmcnt(0)
  s_mov_b64 exec, 1
  buffer_store_dword v86, v91, s[8:11], 0 offen sc1
  s_mov_b64 exec, -1
  s_sub_u32 s53, s39, 3
  s_ashr_i32 s53, s53, 1
  s_cmp_ge_u32 s54, 60
  s_cbranch_scc1 moe_end
mc_22_chunk:
  s_cmp_ge_i32 s74, s53
  s_cbranch_scc1 mc_22_done
  s_mov_b32 s69, 0
mc_22_kp:
  buffer_load_dword v235, v234, s[8:11], s75 offen sc1
  s_add_u32 s69, s69, 1
  s_cmp_gt_u32 s69, 65536
  s_cbranch_scc1 role_abort
  s_waitcnt vmcnt(0)
  v_cmp_eq_u32 vcc, -1, v235
  s_cbranch_vccz mc_22_ins
  s_sleep 4
  s_branch mc_22_kp
mc_22_ins:
  v_cmp_lt_u32 vcc, s86, v235
  s_cbranch_vccz mc_22_nx
  s_ff1_i32_b64 s70, vcc
  v_readlane_b32 s76, v235, s70
  v_writelane_b32 v235, 0, s70
  s_min_u32 s77, s79, s76
  s_max_u32 s79, s79, s76
  s_min_u32 s76, s80, s77
  s_max_u32 s80, s80, s77
  s_min_u32 s77, s81, s76
  s_max_u32 s81, s81, s76
  s_min_u32 s76, s82, s77
  s_max_u32 s82, s82, s77
  s_min_u32 s77, s83, s76
  s_max_u32 s83, s83, s76
  s_min_u32 s76, s84, s77
  s_max_u32 s84, s84, s77
  s_min_u32 s77, s85, s76
  s_max_u32 s85, s85, s76
  s_min_u32 s76, s86, s77
  s_max_u32 s86, s86, s77
  s_branch mc_22_ins
mc_22_nx:
  s_add_u32 s75, s75, 2048
  s_add_u32 s74, s74, 1
  s_branch mc_22_chunk
mc_22_done:
  s_add_u32 s39, s39, 3
  s_cmp_lt_u32 s39, 60
  s_cbranch_scc1 r_loop
mc_23_chunk:
  s_cmp_ge_i32 s74, 29
  s_cbranch_scc1 mc_23_done
  s_mov_b32 s69, 0
mc_23_kp:
  buffer_load_dword v235, v234, s[8:11], s75 offen sc1
  s_add_u32 s69, s69, 1
  s_cmp_gt_u32 s69, 65536
  s_cbranch_scc1 role_abort
  s_waitcnt vmcnt(0)
  v_cmp_eq_u32 vcc, -1, v235
  s_cbranch_vccz mc_23_ins
  s_sleep 4
  s_branch mc_23_kp
mc_23_ins:
  v_cmp_lt_u32 vcc, s86, v235
  s_cbranch_vccz mc_23_nx
  s_ff1_i32_b64 s70, vcc
  v_readlane_b32 s76, v235, s70
  v_writelane_b32 v235, 0, s70
  s_min_u32 s77, s79, s76
  s_max_u32 s79, s79, s76
  s_min_u32 s76, s80, s77
  s_max_u32 s80, s80, s77
  s_min_u32 s77, s81, s76
  s_max_u32 s81, s81, s76
  s_min_u32 s76, s82, s77
  s_max_u32 s82, s82, s77
  s_min_u32 s77, s83, s76
  s_max_u32 s83, s83, s76
  s_min_u32 s76, s84, s77
  s_max_u32 s84, s84, s77
  s_min_u32 s77, s85, s76
  s_max_u32 s85, s85, s76
  s_min_u32 s76, s86, s77
  s_max_u32 s86, s86, s77
  s_branch mc_23_ins
mc_23_nx:
  s_add_u32 s75, s75, 2048
  s_add_u32 s74, s74, 1
  s_branch mc_23_chunk
mc_23_done:
  s_cmp_lg_u32 s54, 0
  s_cbranch_scc1 r_cz0
  s_sleep 40
r_cz0:
  s_cmp_lg_u32 s54, 1
  s_cbranch_scc1 r_cz1
  s_sleep 16
r_cz1:
  s_cmp_lg_u32 s54, 2
  s_cbranch_scc1 r_cz2
  s_sleep 0
r_cz2:
mc_24_chunk:
  s_cmp_ge_i32 s74, 30
  s_cbranch_scc1 mc_24_done
  s_mov_b32 s69, 0
mc_24_kp:
  buffer_load_dword v235, v234, s[8:11], s75 offen sc1
  s_add_u32 s69, s69, 1
  s_cmp_gt_u32 s69, 65536
  s_cbranch_scc1 role_abort
  s_waitcnt vmcnt(0)
  v_cmp_eq_u32 vcc, -1, v235
  s_cbranch_vccz mc_24_ins
  s_sleep 4
  s_branch mc_24_kp
mc_24_ins:
  v_cmp_lt_u32 vcc, s86, v235
  s_cbranch_vccz mc_24_nx
  s_ff1_i32_b64 s70, vcc
  v_readlane_b32 s76, v235, s70
  v_writelane_b32 v235, 0, s70
  s_min_u32 s77, s79, s76
  s_max_u32 s79, s79, s76
  s_min_u32 s76, s80, s77
  s_max_u32 s80, s80, s77
  s_min_u32 s77, s81, s76
  s_max_u32 s81, s81, s76
  s_min_u32 s76, s82, s77
  s_max_u32 s82, s82, s77
  s_min_u32 s77, s83, s76
  s_max_u32 s83, s83, s76
  s_min_u32 s76, s84, s77
  s_max_u32 s84, s84, s77
  s_min_u32 s77, s85, s76
  s_max_u32 s85, s85, s76
  s_min_u32 s76, s86, s77
  s_max_u32 s86, s86, s77
  s_branch mc_24_ins
mc_24_nx:
  s_add_u32 s75, s75, 2048
  s_add_u32 s74, s74, 1
  s_branch mc_24_chunk
mc_24_done:
  s_mov_b32 s87, s79
  s_mov_b32 s88, s80
  s_mov_b32 s89, s81
  s_mov_b32 s90, s82
  s_mov_b32 s91, s83
  s_mov_b32 s92, s84
  s_mov_b32 s93, s85
  s_mov_b32 s94, s86
  s_mov_b32 s95, 2326528
moe_pass:
  s_mov_b32 exec_lo, 0x1010101
  s_mov_b32 exec_hi, 0x1010101
  v_mov_b32 v120, s79
  s_mov_b32 exec_lo, 0x2020202
  s_mov_b32 exec_hi, 0x2020202
  v_mov_b32 v120, s80
  s_mov_b32 exec_lo, 0x4040404
  s_mov_b32 exec_hi, 0x4040404
  v_mov_b32 v120, s81
  s_mov_b32 exec_lo, 0x8080808
  s_mov_b32 exec_hi, 0x8080808
  v_mov_b32 v120, s82
  s_mov_b32 exec_lo, 0x10101010
  s_mov_b32 exec_hi, 0x10101010
  v_mov_b32 v120, s83
  s_mov_b32 exec_lo, 0x20202020
  s_mov_b32 exec_hi, 0x20202020
  v_mov_b32 v120, s84
  s_mov_b32 exec_lo, 0x40404040
  s_mov_b32 exec_hi, 0x40404040
  v_mov_b32 v120, s85
  s_mov_b32 exec_lo, 0x80808080
  s_mov_b32 exec_hi, 0x80808080
  v_mov_b32 v120, s86
  s_mov_b64 exec, -1
  v_and_b32 v124, 0x7ff, v120
  v_sub_u32 v124, 2047, v124
  v_mul_u32_u24 v122, 1280, v124
  v_lshrrev_b32 v125, 4, v1
  v_lshl_add_u32 v121, v125, 4, v122
  s_mul_i32 s70, s17, 320
  s_add_u32 s70, s70, 8388608
  buffer_load_dwordx4 v[4:7], v121, s[8:11], s70 offen offset:0 sc1
  buffer_load_dwordx4 v[8:11], v121, s[8:11], s70 offen offset:64 sc1
  buffer_load_dwordx4 v[12:15], v121, s[8:11], s70 offen offset:128 sc1
  buffer_load_dwordx4 v[16:19], v121, s[8:11], s70 offen offset:192 sc1
  buffer_load_dwordx4 v[20:23], v121, s[8:11], s70 offen offset:256 sc1
  v_bfe_u32 v125, v1, 3, 2
  s_min_u32 s72, s78, 39
  s_lshl_b32 s71, s72, 5
  v_lshl_add_u32 v126, v125, 3, s71
  v_add_u32 v122, v122, v126
  v_lshlrev_b32 v126, 1, v126
  s_mov_b32 s70, 5242880
  s_mov_b32 s71, 8388608
  s_mov_b32 s76, 78336
  buffer_load_dwordx2 v[128:129], v122, s[8:11], s70 offen sc1
  buffer_load_dwordx2 v[130:131], v122, s[8:11], s71 offen sc1
  buffer_load_dwordx4 v[132:135], v126, s[8:11], s76 offen sc1
  v_and_b32 v124, 0xffff0000, v120
  v_ashrrev_i32 v125, 31, v124
  v_not_b32 v125, v125
  v_or_b32 v125, 0x80000000, v125
  v_and_b32 v125, 0xffff0000, v125
  v_xor_b32 v124, v124, v125
  v_mul_f32 v124, 0xbfb8aa3b, v124
  v_exp_f32 v124, v124
  s_nop 0
  v_add_f32 v124, 1.0, v124
  v_rcp_f32 v124, v124
  s_nop 0
  v_cvt_pk_bf16_f32 v124, v124, v124
  v_lshlrev_b32 v123, 16, v124
  s_lshl_b32 s70, s17, 13
  v_add_u32 v126, s70, v233
  s_lshl_b32 s70, s17, 10
  v_add_u32 v127, s70, v233
  s_waitcnt vmcnt(7)
  v_mfma_f32_16x16x32_bf16 v[24:27], a[0:3], v[4:7], 0
  v_mfma_f32_16x16x32_bf16 v[28:31], a[20:23], v[4:7], 0
  v_mfma_f32_16x16x32_bf16 v[32:35], a[40:43], v[4:7], 0
  v_mfma_f32_16x16x32_bf16 v[36:39], a[60:63], v[4:7], 0
  v_mfma_f32_16x16x32_bf16 v[40:43], a[80:83], v[4:7], 0
  v_mfma_f32_16x16x32_bf16 v[44:47], a[100:103], v[4:7], 0
  v_mfma_f32_16x16x32_bf16 v[48:51], a[120:123], v[4:7], 0
  v_mfma_f32_16x16x32_bf16 v[52:55], a[140:143], v[4:7], 0
  s_waitcnt vmcnt(6)
  v_mfma_f32_16x16x32_bf16 v[24:27], a[4:7], v[8:11], v[24:27]
  v_mfma_f32_16x16x32_bf16 v[28:31], a[24:27], v[8:11], v[28:31]
  v_mfma_f32_16x16x32_bf16 v[32:35], a[44:47], v[8:11], v[32:35]
  v_mfma_f32_16x16x32_bf16 v[36:39], a[64:67], v[8:11], v[36:39]
  v_mfma_f32_16x16x32_bf16 v[40:43], a[84:87], v[8:11], v[40:43]
  v_mfma_f32_16x16x32_bf16 v[44:47], a[104:107], v[8:11], v[44:47]
  v_mfma_f32_16x16x32_bf16 v[48:51], a[124:127], v[8:11], v[48:51]
  v_mfma_f32_16x16x32_bf16 v[52:55], a[144:147], v[8:11], v[52:55]
  s_waitcnt vmcnt(5)
  v_mfma_f32_16x16x32_bf16 v[24:27], a[8:11], v[12:15], v[24:27]
  v_mfma_f32_16x16x32_bf16 v[28:31], a[28:31], v[12:15], v[28:31]
  v_mfma_f32_16x16x32_bf16 v[32:35], a[48:51], v[12:15], v[32:35]
  v_mfma_f32_16x16x32_bf16 v[36:39], a[68:71], v[12:15], v[36:39]
  v_mfma_f32_16x16x32_bf16 v[40:43], a[88:91], v[12:15], v[40:43]
  v_mfma_f32_16x16x32_bf16 v[44:47], a[108:111], v[12:15], v[44:47]
  v_mfma_f32_16x16x32_bf16 v[48:51], a[128:131], v[12:15], v[48:51]
  v_mfma_f32_16x16x32_bf16 v[52:55], a[148:151], v[12:15], v[52:55]
  s_waitcnt vmcnt(4)
  v_mfma_f32_16x16x32_bf16 v[24:27], a[12:15], v[16:19], v[24:27]
  v_mfma_f32_16x16x32_bf16 v[28:31], a[32:35], v[16:19], v[28:31]
  v_mfma_f32_16x16x32_bf16 v[32:35], a[52:55], v[16:19], v[32:35]
  v_mfma_f32_16x16x32_bf16 v[36:39], a[72:75], v[16:19], v[36:39]
  v_mfma_f32_16x16x32_bf16 v[40:43], a[92:95], v[16:19], v[40:43]
  v_mfma_f32_16x16x32_bf16 v[44:47], a[112:115], v[16:19], v[44:47]
  v_mfma_f32_16x16x32_bf16 v[48:51], a[132:135], v[16:19], v[48:51]
  v_mfma_f32_16x16x32_bf16 v[52:55], a[152:155], v[16:19], v[52:55]
  s_waitcnt vmcnt(3)
  v_mfma_f32_16x16x32_bf16 v[24:27], a[16:19], v[20:23], v[24:27]
  v_mfma_f32_16x16x32_bf16 v[28:31], a[36:39], v[20:23], v[28:31]
  v_mfma_f32_16x16x32_bf16 v[32:35], a[56:59], v[20:23], v[32:35]
  v_mfma_f32_16x16x32_bf16 v[36:39], a[76:79], v[20:23], v[36:39]
  v_mfma_f32_16x16x32_bf16 v[40:43], a[96:99], v[20:23], v[40:43]
  v_mfma_f32_16x16x32_bf16 v[44:47], a[116:119], v[20:23], v[44:47]
  v_mfma_f32_16x16x32_bf16 v[48:51], a[136:139], v[20:23], v[48:51]
  v_mfma_f32_16x16x32_bf16 v[52:55], a[156:159], v[20:23], v[52:55]
  s_nop 0
  ds_write_b128 v126, v[24:27] offset:0
  ds_write_b128 v126, v[28:31] offset:1024
  ds_write_b128 v126, v[32:35] offset:2048
  ds_write_b128 v126, v[36:39] offset:3072
  ds_write_b128 v126, v[40:43] offset:4096
  ds_write_b128 v126, v[44:47] offset:5120
  ds_write_b128 v126, v[48:51] offset:6144
  ds_write_b128 v126, v[52:55] offset:7168
  s_waitcnt lgkmcnt(0)
  s_barrier
  ds_read_b128 v[64:67], v127 offset:0
  ds_read_b128 v[80:83], v127 offset:4096
  ds_read_b128 v[68:71], v127 offset:8192
  ds_read_b128 v[84:87], v127 offset:12288
  ds_read_b128 v[72:75], v127 offset:16384
  ds_read_b128 v[88:91], v127 offset:20480
  ds_read_b128 v[76:79], v127 offset:24576
  ds_read_b128 v[92:95], v127 offset:28672
  s_waitcnt lgkmcnt(0)
  v_pk_add_f32 v[64:65], v[64:65], v[68:69]
  v_pk_add_f32 v[72:73], v[72:73], v[76:77]
  v_pk_add_f32 v[66:67], v[66:67], v[70:71]
  v_pk_add_f32 v[74:75], v[74:75], v[78:79]
  v_pk_add_f32 v[64:65], v[64:65], v[72:73]
  v_cvt_pk_bf16_f32 v124, v64, v65
  v_lshlrev_b32 v64, 16, v124
  v_and_b32 v65, 0xffff0000, v124
  v_pk_add_f32 v[66:67], v[66:67], v[74:75]
  v_cvt_pk_bf16_f32 v124, v66, v67
  v_lshlrev_b32 v66, 16, v124
  v_and_b32 v67, 0xffff0000, v124
  v_pk_add_f32 v[80:81], v[80:81], v[84:85]
  v_pk_add_f32 v[88:89], v[88:89], v[92:93]
  v_pk_add_f32 v[82:83], v[82:83], v[86:87]
  v_pk_add_f32 v[90:91], v[90:91], v[94:95]
  v_pk_add_f32 v[80:81], v[80:81], v[88:89]
  v_cvt_pk_bf16_f32 v124, v80, v81
  v_lshlrev_b32 v80, 16, v124
  v_and_b32 v81, 0xffff0000, v124
  v_pk_add_f32 v[82:83], v[82:83], v[90:91]
  v_cvt_pk_bf16_f32 v124, v82, v83
  v_lshlrev_b32 v82, 16, v124
  v_and_b32 v83, 0xffff0000, v124
  v_mul_f32 v140, 0xbfb8aa3b, v64
  v_mul_f32 v141, 0xbfb8aa3b, v65
  v_mul_f32 v142, 0xbfb8aa3b, v66
  v_mul_f32 v143, 0xbfb8aa3b, v67
  v_exp_f32 v140, v140
  v_exp_f32 v141, v141
  v_exp_f32 v142, v142
  v_exp_f32 v143, v143
  v_add_f32 v140, 1.0, v140
  v_add_f32 v141, 1.0, v141
  v_add_f32 v142, 1.0, v142
  v_add_f32 v143, 1.0, v143
  v_rcp_f32 v140, v140
  v_rcp_f32 v141, v141
  v_rcp_f32 v142, v142
  v_rcp_f32 v143, v143
  v_pk_mul_f32 v[64:65], v[64:65], v[140:141]
  v_cvt_pk_bf16_f32 v124, v64, v65
  v_lshlrev_b32 v64, 16, v124
  v_and_b32 v65, 0xffff0000, v124
  v_pk_mul_f32 v[64:65], v[64:65], v[80:81]
  v_cvt_pk_bf16_f32 v140, v64, v65
  v_pk_mul_f32 v[66:67], v[66:67], v[142:143]
  v_cvt_pk_bf16_f32 v124, v66, v67
  v_lshlrev_b32 v66, 16, v124
  v_and_b32 v67, 0xffff0000, v124
  v_pk_mul_f32 v[66:67], v[66:67], v[82:83]
  v_cvt_pk_bf16_f32 v141, v66, v67
  s_lshr_b32 s70, s17, 1
  s_lshl_b32 s70, s70, 10
  s_and_b32 s71, s17, 1
  s_lshl_b32 s71, s71, 3
  s_add_u32 s70, s70, s71
  v_add_u32 v126, s70, v233
  ds_write_b64 v126, v[140:141] offset:32768
  s_waitcnt lgkmcnt(0)
  s_barrier
  ds_read_b128 v[112:115], v233 offset:32768
  ds_read_b128 v[116:119], v233 offset:33792
  s_mul_i32 s70, s68, 20480
  s_mul_i32 s71, s17, 5120
  s_add_u32 s70, s70, s71
  s_add_u32 s70, s70, s95
  s_add_u32 s71, s70, 4096
  s_waitcnt lgkmcnt(0)
  v_mfma_f32_16x16x32_bf16 v[24:27], a[160:163], v[112:115], 0
  v_mfma_f32_16x16x32_bf16 v[28:31], a[168:171], v[112:115], 0
  v_mfma_f32_16x16x32_bf16 v[32:35], a[176:179], v[112:115], 0
  v_mfma_f32_16x16x32_bf16 v[36:39], a[184:187], v[112:115], 0
  v_mfma_f32_16x16x32_bf16 v[40:43], a[192:195], v[112:115], 0
  v_mfma_f32_16x16x32_bf16 v[44:47], a[200:203], v[112:115], 0
  v_mfma_f32_16x16x32_bf16 v[48:51], a[208:211], v[112:115], 0
  v_mfma_f32_16x16x32_bf16 v[52:55], a[216:219], v[112:115], 0
  v_mfma_f32_16x16x32_bf16 v[56:59], a[224:227], v[112:115], 0
  v_mfma_f32_16x16x32_bf16 v[60:63], a[232:235], v[112:115], 0
  v_mfma_f32_16x16x32_bf16 v[24:27], a[164:167], v[116:119], v[24:27]
  v_mfma_f32_16x16x32_bf16 v[28:31], a[172:175], v[116:119], v[28:31]
  v_mfma_f32_16x16x32_bf16 v[32:35], a[180:183], v[116:119], v[32:35]
  v_mfma_f32_16x16x32_bf16 v[36:39], a[188:191], v[116:119], v[36:39]
  v_mfma_f32_16x16x32_bf16 v[40:43], a[196:199], v[116:119], v[40:43]
  v_mfma_f32_16x16x32_bf16 v[44:47], a[204:207], v[116:119], v[44:47]
  v_mfma_f32_16x16x32_bf16 v[48:51], a[212:215], v[116:119], v[48:51]
  v_mfma_f32_16x16x32_bf16 v[52:55], a[220:223], v[116:119], v[52:55]
  v_mfma_f32_16x16x32_bf16 v[56:59], a[228:231], v[116:119], v[56:59]
  v_mfma_f32_16x16x32_bf16 v[60:63], a[236:239], v[116:119], v[60:63]
  s_mov_b32 exec_lo, 0x00ff00ff
  s_mov_b32 exec_hi, 0x00ff00ff
  buffer_store_dwordx4 v[24:27], v236, s[8:11], s70 offen offset:0 sc1
  buffer_store_dwordx4 v[28:31], v236, s[8:11], s70 offen offset:512 sc1
  buffer_store_dwordx4 v[32:35], v236, s[8:11], s70 offen offset:1024 sc1
  buffer_store_dwordx4 v[36:39], v236, s[8:11], s70 offen offset:1536 sc1
  buffer_store_dwordx4 v[40:43], v236, s[8:11], s70 offen offset:2048 sc1
  buffer_store_dwordx4 v[44:47], v236, s[8:11], s70 offen offset:2560 sc1
  buffer_store_dwordx4 v[48:51], v236, s[8:11], s70 offen offset:3072 sc1
  buffer_store_dwordx4 v[52:55], v236, s[8:11], s70 offen offset:3584 sc1
  buffer_store_dwordx4 v[56:59], v236, s[8:11], s71 offen offset:0 sc1
  buffer_store_dwordx4 v[60:63], v236, s[8:11], s71 offen offset:512 sc1
  s_mov_b64 exec, -1
  s_cmp_ge_u32 s78, 40
  s_cbranch_scc1 moe_mid
  s_lshl_b32 s72, s78, 9
  s_add_u32 s72, s72, s95
  s_sleep 8
  s_mov_b32 s69, 0
moe_yp:
  s_mov_b32 s70, s72
  buffer_load_dwordx4 v[64:67], v237, s[8:11], s70 offen sc1
  s_add_u32 s70, s70, 40960
  buffer_load_dwordx4 v[68:71], v237, s[8:11], s70 offen sc1
  s_add_u32 s70, s70, 40960
  buffer_load_dwordx4 v[72:75], v237, s[8:11], s70 offen sc1
  s_add_u32 s70, s70, 40960
  buffer_load_dwordx4 v[76:79], v237, s[8:11], s70 offen sc1
  s_add_u32 s70, s70, 40960
  buffer_load_dwordx4 v[80:83], v237, s[8:11], s70 offen sc1
  s_add_u32 s70, s70, 40960
  buffer_load_dwordx4 v[84:87], v237, s[8:11], s70 offen sc1
  s_add_u32 s70, s70, 40960
  buffer_load_dwordx4 v[88:91], v237, s[8:11], s70 offen sc1
  s_add_u32 s70, s70, 40960
  buffer_load_dwordx4 v[92:95], v237, s[8:11], s70 offen sc1
  s_add_u32 s70, s70, 40960
  buffer_load_dwordx4 v[96:99], v237, s[8:11], s70 offen sc1
  s_add_u32 s70, s70, 40960
  buffer_load_dwordx4 v[100:103], v237, s[8:11], s70 offen sc1
  s_add_u32 s70, s70, 40960
  buffer_load_dwordx4 v[104:107], v237, s[8:11], s70 offen sc1
  s_add_u32 s70, s70, 40960
  buffer_load_dwordx4 v[108:111], v237, s[8:11], s70 offen sc1
  s_add_u32 s70, s70, 40960
  s_add_u32 s69, s69, 1
  s_cmp_gt_u32 s69, 65536
  s_cbranch_scc1 role_abort
  s_waitcnt vmcnt(10)
  v_pk_add_f32 v[136:137], v[64:65], v[68:69]
  v_pk_add_f32 v[138:139], v[66:67], v[70:71]
  s_waitcnt vmcnt(9)
  v_pk_add_f32 v[136:137], v[136:137], v[72:73]
  v_pk_add_f32 v[138:139], v[138:139], v[74:75]
  s_waitcnt vmcnt(8)
  v_pk_add_f32 v[136:137], v[136:137], v[76:77]
  v_pk_add_f32 v[138:139], v[138:139], v[78:79]
  s_waitcnt vmcnt(7)
  v_pk_add_f32 v[136:137], v[136:137], v[80:81]
  v_pk_add_f32 v[138:139], v[138:139], v[82:83]
  s_waitcnt vmcnt(6)
  v_pk_add_f32 v[136:137], v[136:137], v[84:85]
  v_pk_add_f32 v[138:139], v[138:139], v[86:87]
  s_waitcnt vmcnt(5)
  v_pk_add_f32 v[136:137], v[136:137], v[88:89]
  v_pk_add_f32 v[138:139], v[138:139], v[90:91]
  s_waitcnt vmcnt(4)
  v_pk_add_f32 v[136:137], v[136:137], v[92:93]
  v_pk_add_f32 v[138:139], v[138:139], v[94:95]
  s_waitcnt vmcnt(3)
  v_pk_add_f32 v[136:137], v[136:137], v[96:97]
  v_pk_add_f32 v[138:139], v[138:139], v[98:99]
  s_waitcnt vmcnt(2)
  v_pk_add_f32 v[136:137], v[136:137], v[100:101]
  v_pk_add_f32 v[138:139], v[138:139], v[102:103]
  s_waitcnt vmcnt(1)
  v_pk_add_f32 v[136:137], v[136:137], v[104:105]
  v_pk_add_f32 v[138:139], v[138:139], v[106:107]
  s_waitcnt vmcnt(0)
  v_pk_add_f32 v[136:137], v[136:137], v[108:109]
  v_pk_add_f32 v[138:139], v[138:139], v[110:111]
  v_add_f32 v124, v136, v137
  v_add_f32 v125, v138, v139
  v_cmp_u_f32 vcc, v124, v125
  s_cbranch_vccz moe_yok
  s_sleep 2
  s_branch moe_yp
moe_yok:
  v_mov_b32 v140, v136
  v_mov_b32 v141, v137
  v_mov_b32 v142, v138
  v_mov_b32 v143, v139
  v_permlane32_swap_b32 v136, v140
  v_permlane32_swap_b32 v137, v141
  v_permlane32_swap_b32 v138, v142
  v_permlane32_swap_b32 v139, v143
  v_lshlrev_b32 v64, 16, v128
  v_and_b32 v65, 0xffff0000, v128
  v_lshlrev_b32 v68, 16, v130
  v_and_b32 v69, 0xffff0000, v130
  v_lshlrev_b32 v66, 16, v129
  v_and_b32 v67, 0xffff0000, v129
  v_lshlrev_b32 v70, 16, v131
  v_and_b32 v71, 0xffff0000, v131
  v_pk_add_f32 v[136:137], v[136:137], v[140:141]
  v_cvt_pk_bf16_f32 v124, v136, v137
  v_lshlrev_b32 v136, 16, v124
  v_and_b32 v137, 0xffff0000, v124
  v_mul_f32 v136, v136, v123
  v_mul_f32 v137, v137, v123
  v_cvt_pk_bf16_f32 v124, v136, v137
  v_lshlrev_b32 v136, 16, v124
  v_and_b32 v137, 0xffff0000, v124
  v_pk_add_f32 v[136:137], v[136:137], v[68:69]
  v_cvt_pk_bf16_f32 v124, v136, v137
  v_lshlrev_b32 v136, 16, v124
  v_and_b32 v137, 0xffff0000, v124
  v_pk_mul_f32 v[136:137], v[136:137], v[132:133]
  v_cvt_pk_bf16_f32 v124, v136, v137
  v_lshlrev_b32 v136, 16, v124
  v_and_b32 v137, 0xffff0000, v124
  v_pk_add_f32 v[136:137], v[136:137], v[64:65]
  v_cvt_pk_bf16_f32 v140, v136, v137
  v_pk_add_f32 v[138:139], v[138:139], v[142:143]
  v_cvt_pk_bf16_f32 v124, v138, v139
  v_lshlrev_b32 v138, 16, v124
  v_and_b32 v139, 0xffff0000, v124
  v_mul_f32 v138, v138, v123
  v_mul_f32 v139, v139, v123
  v_cvt_pk_bf16_f32 v124, v138, v139
  v_lshlrev_b32 v138, 16, v124
  v_and_b32 v139, 0xffff0000, v124
  v_pk_add_f32 v[138:139], v[138:139], v[70:71]
  v_cvt_pk_bf16_f32 v124, v138, v139
  v_lshlrev_b32 v138, 16, v124
  v_and_b32 v139, 0xffff0000, v124
  v_pk_mul_f32 v[138:139], v[138:139], v[134:135]
  v_cvt_pk_bf16_f32 v124, v138, v139
  v_lshlrev_b32 v138, 16, v124
  v_and_b32 v139, 0xffff0000, v124
  v_pk_add_f32 v[138:139], v[138:139], v[66:67]
  v_cvt_pk_bf16_f32 v141, v138, v139
moe_mid:
  s_cmp_lg_u32 s95, 2326528
  s_cbranch_scc1 moe_fin
mc_25_chunk:
  s_cmp_ge_i32 s74, 32
  s_cbranch_scc1 mc_25_done
  s_mov_b32 s69, 0
mc_25_kp:
  buffer_load_dword v235, v234, s[8:11], s75 offen sc1
  s_add_u32 s69, s69, 1
  s_cmp_gt_u32 s69, 65536
  s_cbranch_scc1 role_abort
  s_waitcnt vmcnt(0)
  v_cmp_eq_u32 vcc, -1, v235
  s_cbranch_vccz mc_25_ins
  s_sleep 4
  s_branch mc_25_kp
mc_25_ins:
  v_cmp_lt_u32 vcc, s86, v235
  s_cbranch_vccz mc_25_nx
  s_ff1_i32_b64 s70, vcc
  v_readlane_b32 s76, v235, s70
  v_writelane_b32 v235, 0, s70
  s_min_u32 s77, s79, s76
  s_max_u32 s79, s79, s76
  s_min_u32 s76, s80, s77
  s_max_u32 s80, s80, s77
  s_min_u32 s77, s81, s76
  s_max_u32 s81, s81, s76
  s_min_u32 s76, s82, s77
  s_max_u32 s82, s82, s77
  s_min_u32 s77, s83, s76
  s_max_u32 s83, s83, s76
  s_min_u32 s76, s84, s77
  s_max_u32 s84, s84, s77
  s_min_u32 s77, s85, s76
  s_max_u32 s85, s85, s76
  s_min_u32 s76, s86, s77
  s_max_u32 s86, s86, s77
  s_branch mc_25_ins
mc_25_nx:
  s_add_u32 s75, s75, 2048
  s_add_u32 s74, s74, 1
  s_branch mc_25_chunk
mc_25_done:
  s_add_u32 s95, s95, 491520
  s_cmp_lg_u32 s87, s79
  s_cbranch_scc1 moe_pass
  s_cmp_lg_u32 s88, s80
  s_cbranch_scc1 moe_pass
  s_cmp_lg_u32 s89, s81
  s_cbranch_scc1 moe_pass
  s_cmp_lg_u32 s90, s82
  s_cbranch_scc1 moe_pass
  s_cmp_lg_u32 s91, s83
  s_cbranch_scc1 moe_pass
  s_cmp_lg_u32 s92, s84
  s_cbranch_scc1 moe_pass
  s_cmp_lg_u32 s93, s85
  s_cbranch_scc1 moe_pass
  s_cmp_lg_u32 s94, s86
  s_cbranch_scc1 moe_pass
moe_fin:
  s_cmp_ge_u32 s78, 40
  s_cbranch_scc1 moe_end
  s_mov_b32 exec_hi, 0
  buffer_store_dwordx2 v[140:141], v122, s[24:27], 0 offen sc1
moe_end:
  s_endpgm
role_b:
  s_load_dwordx2 s[20:21], s[0:1], 16
  s_load_dwordx2 s[4:5], s[0:1], 24
  s_load_dwordx2 s[6:7], s[0:1], 32
  s_mov_b32 s22, 7864320
  s_mov_b32 s23, 0x00020000
  s_and_b32 s31, s17, 1
  s_lshl_b32 s24, s18, 1
  s_add_u32 s24, s24, s31
  s_lshl_b32 s32, s18, 2
  s_add_u32 s32, s32, s17
  s_sub_u32 s32, s32, 48
  s_lshr_b32 s27, s17, 1
  s_cmp_lt_u32 s18, 12
  s_cselect_b32 s24, s24, s32
  s_cselect_b32 s27, s27, 2
  s_mul_i32 s25, s24, 43
  s_lshr_b32 s25, s25, 8
  s_mul_i32 s32, s25, 6
  s_sub_u32 s26, s24, s32
  s_mul_i32 s33, s16, 1536
  s_lshr_b32 s32, s24, 1
  s_lshl_b32 s32, s32, 7
  s_add_u32 s33, s33, s32
  s_mul_i32 s32, s31, 983040
  s_add_u32 s33, s33, s32
  s_lshr_b32 s32, s17, 1
  s_mul_i32 s44, s32, 81920
  s_mul_i32 s34, s31, 10240
  s_add_u32 s34, s34, s44
  v_lshrrev_b32 v167, 4, v1
  v_and_b32 v167, 3, v167
  v_lshlrev_b32 v167, 1, v167
  v_and_b32 v4, 7, v1
  v_xor_b32 v4, v4, v167
  v_lshlrev_b32 v4, 4, v4
  v_lshrrev_b32 v167, 3, v1
  v_mul_u32_u24 v167, 12288, v167
  v_add_u32 v4, v4, v167
  s_waitcnt lgkmcnt(0)
  s_cmp_eq_u32 s27, 1
  s_cselect_b64 s[20:21], s[4:5], s[20:21]
  s_cmp_eq_u32 s27, 2
  s_cselect_b64 s[20:21], s[6:7], s[20:21]
  s_add_u32 m0, s34, 0
  s_add_u32 s32, s33, 0
  buffer_load_dwordx4 v4, s[20:23], s32 offen nt lds
  s_add_u32 m0, s34, 1024
  s_add_u32 s32, s33, 98304
  buffer_load_dwordx4 v4, s[20:23], s32 offen nt lds
  s_add_u32 m0, s34, 2048
  s_add_u32 s32, s33, 196608
  buffer_load_dwordx4 v4, s[20:23], s32 offen nt lds
  s_add_u32 m0, s34, 3072
  s_add_u32 s32, s33, 294912
  buffer_load_dwordx4 v4, s[20:23], s32 offen nt lds
  s_add_u32 m0, s34, 4096
  s_add_u32 s32, s33, 393216
  buffer_load_dwordx4 v4, s[20:23], s32 offen nt lds
  s_add_u32 m0, s34, 5120
  s_add_u32 s32, s33, 491520
  buffer_load_dwordx4 v4, s[20:23], s32 offen nt lds
  s_add_u32 m0, s34, 6144
  s_add_u32 s32, s33, 589824
  buffer_load_dwordx4 v4, s[20:23], s32 offen nt lds
  s_add_u32 m0, s34, 7168
  s_add_u32 s32, s33, 688128
  buffer_load_dwordx4 v4, s[20:23], s32 offen nt lds
  s_add_u32 m0, s34, 8192
  s_add_u32 s32, s33, 786432
  buffer_load_dwordx4 v4, s[20:23], s32 offen nt lds
  s_add_u32 m0, s34, 9216
  s_add_u32 s32, s33, 884736
  buffer_load_dwordx4 v4, s[20:23], s32 offen nt lds
  s_add_u32 m0, s34, 20480
  s_add_u32 s32, s33, 1966080
  buffer_load_dwordx4 v4, s[20:23], s32 offen nt lds
  s_add_u32 m0, s34, 21504
  s_add_u32 s32, s33, 2064384
  buffer_load_dwordx4 v4, s[20:23], s32 offen nt lds
  s_add_u32 m0, s34, 22528
  s_add_u32 s32, s33, 2162688
  buffer_load_dwordx4 v4, s[20:23], s32 offen nt lds
  s_add_u32 m0, s34, 23552
  s_add_u32 s32, s33, 2260992
  buffer_load_dwordx4 v4, s[20:23], s32 offen nt lds
  s_add_u32 m0, s34, 24576
  s_add_u32 s32, s33, 2359296
  buffer_load_dwordx4 v4, s[20:23], s32 offen nt lds
  s_add_u32 m0, s34, 25600
  s_add_u32 s32, s33, 2457600
  buffer_load_dwordx4 v4, s[20:23], s32 offen nt lds
  s_add_u32 m0, s34, 26624
  s_add_u32 s32, s33, 2555904
  buffer_load_dwordx4 v4, s[20:23], s32 offen nt lds
  s_add_u32 m0, s34, 27648
  s_add_u32 s32, s33, 2654208
  buffer_load_dwordx4 v4, s[20:23], s32 offen nt lds
  s_add_u32 m0, s34, 28672
  s_add_u32 s32, s33, 2752512
  buffer_load_dwordx4 v4, s[20:23], s32 offen nt lds
  s_add_u32 m0, s34, 29696
  s_add_u32 s32, s33, 2850816
  buffer_load_dwordx4 v4, s[20:23], s32 offen nt lds
  s_add_u32 m0, s34, 40960
  s_add_u32 s32, s33, 3932160
  buffer_load_dwordx4 v4, s[20:23], s32 offen nt lds
  s_add_u32 m0, s34, 41984
  s_add_u32 s32, s33, 4030464
  buffer_load_dwordx4 v4, s[20:23], s32 offen nt lds
  s_add_u32 m0, s34, 43008
  s_add_u32 s32, s33, 4128768
  buffer_load_dwordx4 v4, s[20:23], s32 offen nt lds
  s_add_u32 m0, s34, 44032
  s_add_u32 s32, s33, 4227072
  buffer_load_dwordx4 v4, s[20:23], s32 offen nt lds
  s_add_u32 m0, s34, 45056
  s_add_u32 s32, s33, 4325376
  buffer_load_dwordx4 v4, s[20:23], s32 offen nt lds
  s_add_u32 m0, s34, 46080
  s_add_u32 s32, s33, 4423680
  buffer_load_dwordx4 v4, s[20:23], s32 offen nt lds
  s_add_u32 m0, s34, 47104
  s_add_u32 s32, s33, 4521984
  buffer_load_dwordx4 v4, s[20:23], s32 offen nt lds
  s_add_u32 m0, s34, 48128
  s_add_u32 s32, s33, 4620288
  buffer_load_dwordx4 v4, s[20:23], s32 offen nt lds
  s_add_u32 m0, s34, 49152
  s_add_u32 s32, s33, 4718592
  buffer_load_dwordx4 v4, s[20:23], s32 offen nt lds
  s_add_u32 m0, s34, 50176
  s_add_u32 s32, s33, 4816896
  buffer_load_dwordx4 v4, s[20:23], s32 offen nt lds
  s_lshl_b32 s32, s31, 2
  s_xor_b32 s32, s32, 0
  v_lshrrev_b32 v167, 2, v1
  v_lshrrev_b32 v168, 1, v167
  v_and_b32 v168, 3, v168
  v_lshlrev_b32 v168, 1, v168
  v_bfe_u32 v172, v1, 1, 1
  v_add_u32 v172, s32, v172
  v_xor_b32 v172, v172, v168
  v_lshlrev_b32 v172, 4, v172
  v_lshlrev_b32 v167, 7, v167
  v_add_u32 v172, v172, v167
  v_and_b32 v167, 1, v1
  v_lshlrev_b32 v167, 3, v167
  v_add_u32 v172, v172, v167
  v_add_u32 v172, s44, v172
  s_lshl_b32 s32, s31, 2
  s_xor_b32 s32, s32, 2
  v_lshrrev_b32 v167, 2, v1
  v_lshrrev_b32 v168, 1, v167
  v_and_b32 v168, 3, v168
  v_lshlrev_b32 v168, 1, v168
  v_bfe_u32 v173, v1, 1, 1
  v_add_u32 v173, s32, v173
  v_xor_b32 v173, v173, v168
  v_lshlrev_b32 v173, 4, v173
  v_lshlrev_b32 v167, 7, v167
  v_add_u32 v173, v173, v167
  v_and_b32 v167, 1, v1
  v_lshlrev_b32 v167, 3, v167
  v_add_u32 v173, v173, v167
  v_add_u32 v173, s44, v173
  s_lshl_b32 s32, s31, 2
  s_xor_b32 s32, s32, 4
  v_lshrrev_b32 v167, 2, v1
  v_lshrrev_b32 v168, 1, v167
  v_and_b32 v168, 3, v168
  v_lshlrev_b32 v168, 1, v168
  v_bfe_u32 v174, v1, 1, 1
  v_add_u32 v174, s32, v174
  v_xor_b32 v174, v174, v168
  v_lshlrev_b32 v174, 4, v174
  v_lshlrev_b32 v167, 7, v167
  v_add_u32 v174, v174, v167
  v_and_b32 v167, 1, v1
  v_lshlrev_b32 v167, 3, v167
  v_add_u32 v174, v174, v167
  v_add_u32 v174, s44, v174
  s_lshl_b32 s32, s31, 2
  s_xor_b32 s32, s32, 6
  v_lshrrev_b32 v167, 2, v1
  v_lshrrev_b32 v168, 1, v167
  v_and_b32 v168, 3, v168
  v_lshlrev_b32 v168, 1, v168
  v_bfe_u32 v175, v1, 1, 1
  v_add_u32 v175, s32, v175
  v_xor_b32 v175, v175, v168
  v_lshlrev_b32 v175, 4, v175
  v_lshlrev_b32 v167, 7, v167
  v_add_u32 v175, v175, v167
  v_and_b32 v167, 1, v1
  v_lshlrev_b32 v167, 3, v167
  v_add_u32 v175, v175, v167
  v_add_u32 v175, s44, v175
  v_lshlrev_b32 v144, 4, v1
  v_lshlrev_b32 v145, 3, v1
  v_lshlrev_b32 v146, 2, v1
  s_mul_i32 s32, s17, 2560
  v_add_u32 v147, s32, v144
  s_add_u32 s32, s32, 2048
  v_add_u32 v148, s32, v146
  v_lshrrev_b32 v52, 4, v1
  v_and_b32 v53, 15, v1
  v_bfe_u32 v167, v1, 1, 1
  v_mul_u32_u24 v167, 0xaaaa, v167
  v_add_u32 v151, 0x4444, v167
  v_and_b32 v167, 1, v1
  v_mov_b32 v152, 0x05040100
  v_mov_b32 v168, 0x03020706
  v_cmp_eq_u32 vcc, 1, v167
  s_nop 1
  v_cndmask_b32 v152, v152, v168, vcc
  s_lshl_b32 s32, s17, 10
  s_add_u32 s32, s32, 10240
  v_lshl_add_u32 v149, v53, 5, s32
  s_lshr_b32 s32, s17, 1
  s_add_u32 s32, s32, 2
  v_lshlrev_b32 v167, s32, v52
  v_add_u32 v149, v149, v167
  v_and_b32 v167, 3, v1
  v_lshl_add_u32 v167, v52, 2, v167
  v_lshlrev_b32 v167, 4, v167
  v_bfe_u32 v168, v1, 3, 1
  v_lshl_add_u32 v167, v168, 8, v167
  v_bfe_u32 v168, v1, 2, 1
  v_lshl_add_u32 v150, v168, 3, v167
  v_bfe_u32 v167, v1, 2, 2
  v_lshlrev_b32 v167, 1, v167
  v_and_b32 v168, 1, v1
  v_add_u32 v167, v167, v168
  v_lshl_add_u32 v167, v52, 3, v167
  v_lshlrev_b32 v153, 4, v167
  v_lshlrev_b32 v167, 11, v52
  v_lshl_add_u32 v164, v53, 4, v167
  v_and_b32 v167, 7, v1
  v_lshlrev_b32 v167, 7, v167
  v_bfe_u32 v168, v1, 3, 1
  v_mul_u32_u24 v168, 6144, v168
  v_add_u32 v165, v167, v168
  s_mul_i32 s32, s31, 3072
  s_add_u32 s32, s32, 65536
  v_add_u32 v160, s32, v144
  s_mul_i32 s51, s31, 6144
  s_lshl_b32 s50, s31, 11
  s_sub_u32 s50, 1024, s50
  s_mul_i32 s32, s31, 20480
  v_add_u32 v159, s32, v144
  s_lshl_b32 s32, s31, 11
  s_add_u32 s32, s32, 65536
  v_add_u32 v161, s32, v144
  s_mov_b32 s54, 0xff00ff00
  s_mov_b32 s55, 0xff00ff00
  s_not_b64 s[52:53], s[54:55]
  s_cmp_eq_u32 s17, 0
  s_cselect_b64 s[52:53], s[52:53], s[54:55]
  s_mul_i32 s35, s16, 10240
  s_add_u32 s35, s35, 131072
  s_lshl_b32 s37, s16, 17
  s_lshl_b32 s32, s25, 13
  s_add_u32 s37, s37, s32
  s_add_u32 s37, s37, 3407872
  s_lshl_b32 s41, s16, 22
  s_add_u32 s41, s41, 67108864
  s_lshr_b32 s32, s24, 1
  s_lshl_b32 s39, s32, 10
  s_add_u32 s39, s39, s41
  s_add_u32 s39, s39, 589824
  s_mul_i32 s32, s27, 49152
  s_add_u32 s41, s41, s32
  s_mul_i32 s32, s25, 12288
  s_add_u32 s41, s41, s32
  s_lshl_b32 s32, s26, 10
  s_add_u32 s41, s41, s32
  s_mul_i32 s43, s16, 2621440
  s_add_u32 s43, s43, 247463936
  s_mul_i32 s32, s17, 10240
  s_add_u32 s43, s43, s32
  s_add_u32 s49, s32, 16384
  s_lshl_b32 s46, s16, 8
  v_add_u32 v157, s46, v146
  s_lshl_b32 s32, s25, 6
  s_add_u32 s32, s32, s46
  s_lshr_b32 s45, s26, 1
  s_lshl_b32 s45, s45, 2
  s_add_u32 s45, s45, s32
  s_add_u32 s48, s45, 48
  v_mov_b32 v155, s48
  s_add_u32 s45, s45, 12288
  s_lshl_b32 s48, s26, 2
  s_add_u32 s32, s32, s48
  s_add_u32 s48, s32, 12300
  s_cmp_lt_u32 s18, 12
  s_cselect_b32 s45, s45, s48
  v_mov_b32 v156, s45
  s_mul_i32 s48, s27, 24
  s_add_u32 s32, s32, s48
  s_add_u32 s32, s32, 0
  s_lshl_b32 s48, s24, 2
  s_add_u32 s48, s48, s46
  s_add_u32 s48, s48, 4096
  s_cmp_lt_u32 s18, 12
  s_cselect_b32 s32, s32, s48
  v_mov_b32 v154, s32
  s_lshl_b32 s47, s24, 13
  s_add_u32 s47, s47, s46
  s_add_u32 s47, s47, 16777216
  s_mov_b32 s28, 0
  s_mov_b32 s29, 0
  v_mov_b32 v169, 0
  v_mov_b32 v170, 0
  v_mov_b32 v72, -1
  v_mov_b32 v73, -1
  v_mov_b32 v74, -1
  v_mov_b32 v75, -1
  s_mov_b64 s[74:75], 0xffff
  v_add_u32 v167, 4096, v157
  v_cndmask_b32 v189, v157, v167, s[74:75]
  s_and_b32 s57, s24, 15
  s_add_u32 s57, s57, 24
  s_cmp_lt_u32 s18, 12
  s_cselect_b32 s57, s57, s24
  s_lshr_b32 s56, s57, 2
  s_mul_i32 s56, s56, 16384
  s_and_b32 s32, s57, 3
  s_lshl_b32 s32, s32, 11
  s_add_u32 s56, s56, s32
  s_add_u32 s56, s56, 16769024
  s_lshl_b32 s57, s57, 8
  v_and_b32 v168, 3, v1
  v_mov_b32 v132, 0x3f80
  v_cmp_eq_u32 vcc, 0, v168
  s_nop 1
  v_cndmask_b32 v133, v169, v132, vcc
  v_mov_b32 v132, 0x3f800000
  v_cmp_eq_u32 vcc, 1, v168
  s_nop 1
  v_cndmask_b32 v133, v133, v132, vcc
  v_lshrrev_b32 v167, 2, v53
  v_cmp_eq_u32 vcc, 0, v167
  s_nop 1
  v_cndmask_b32 v180, v169, v133, vcc
  v_cmp_eq_u32 vcc, 1, v167
  s_nop 1
  v_cndmask_b32 v181, v169, v133, vcc
  v_cmp_eq_u32 vcc, 2, v167
  s_nop 1
  v_cndmask_b32 v182, v169, v133, vcc
  v_cmp_eq_u32 vcc, 3, v167
  s_nop 1
  v_cndmask_b32 v183, v169, v133, vcc
  s_waitcnt vmcnt(20)
  s_lshl_b32 s31, s16, 2
  s_add_u32 s31, s31, 32
  v_mov_b32 v167, s31
  buffer_load_dword v166, v167, s[12:15], 0 offen sc1
  s_add_u32 m0, s34, 61440
  s_add_u32 s32, s33, 5898240
  buffer_load_dwordx4 v4, s[20:23], s32 offen nt lds
  s_add_u32 m0, s34, 62464
  s_add_u32 s32, s33, 5996544
  buffer_load_dwordx4 v4, s[20:23], s32 offen nt lds
  s_add_u32 m0, s34, 63488
  s_add_u32 s32, s33, 6094848
  buffer_load_dwordx4 v4, s[20:23], s32 offen nt lds
  s_add_u32 m0, s34, 64512
  s_add_u32 s32, s33, 6193152
  buffer_load_dwordx4 v4, s[20:23], s32 offen nt lds
  s_add_u32 m0, s34, 65536
  s_add_u32 s32, s33, 6291456
  buffer_load_dwordx4 v4, s[20:23], s32 offen nt lds
  s_add_u32 m0, s34, 66560
  s_add_u32 s32, s33, 6389760
  buffer_load_dwordx4 v4, s[20:23], s32 offen nt lds
  s_add_u32 m0, s34, 67584
  s_add_u32 s32, s33, 6488064
  buffer_load_dwordx4 v4, s[20:23], s32 offen nt lds
  s_add_u32 m0, s34, 68608
  s_add_u32 s32, s33, 6586368
  buffer_load_dwordx4 v4, s[20:23], s32 offen nt lds
  s_add_u32 m0, s34, 69632
  s_add_u32 s32, s33, 6684672
  buffer_load_dwordx4 v4, s[20:23], s32 offen nt lds
  s_add_u32 m0, s34, 70656
  s_add_u32 s32, s33, 6782976
  buffer_load_dwordx4 v4, s[20:23], s32 offen nt lds
  s_barrier
  ds_read_b64_tr_b16 v[192:193], v172 offset:0
  ds_read_b64_tr_b16 v[194:195], v172 offset:2048
  ds_read_b64_tr_b16 a[16:17], v173 offset:0
  ds_read_b64_tr_b16 a[18:19], v173 offset:2048
  ds_read_b64_tr_b16 a[96:97], v174 offset:0
  ds_read_b64_tr_b16 a[98:99], v174 offset:2048
  ds_read_b64_tr_b16 a[176:177], v175 offset:0
  ds_read_b64_tr_b16 a[178:179], v175 offset:2048
  s_waitcnt lgkmcnt(6)
  ds_read_b64_tr_b16 v[196:197], v172 offset:4096
  ds_read_b64_tr_b16 v[198:199], v172 offset:6144
  ds_read_b64_tr_b16 a[20:21], v173 offset:4096
  ds_read_b64_tr_b16 a[22:23], v173 offset:6144
  ds_read_b64_tr_b16 a[100:101], v174 offset:4096
  ds_read_b64_tr_b16 a[102:103], v174 offset:6144
  ds_read_b64_tr_b16 a[180:181], v175 offset:4096
  ds_read_b64_tr_b16 a[182:183], v175 offset:6144
  s_waitcnt lgkmcnt(6)
  ds_read_b64_tr_b16 v[200:201], v172 offset:8192
  ds_read_b64_tr_b16 v[202:203], v172 offset:10240
  ds_read_b64_tr_b16 a[24:25], v173 offset:8192
  ds_read_b64_tr_b16 a[26:27], v173 offset:10240
  ds_read_b64_tr_b16 a[104:105], v174 offset:8192
  ds_read_b64_tr_b16 a[106:107], v174 offset:10240
  ds_read_b64_tr_b16 a[184:185], v175 offset:8192
  ds_read_b64_tr_b16 a[186:187], v175 offset:10240
  s_waitcnt lgkmcnt(6)
  ds_read_b64_tr_b16 v[204:205], v172 offset:12288
  ds_read_b64_tr_b16 v[206:207], v172 offset:14336
  ds_read_b64_tr_b16 a[28:29], v173 offset:12288
  ds_read_b64_tr_b16 a[30:31], v173 offset:14336
  ds_read_b64_tr_b16 a[108:109], v174 offset:12288
  ds_read_b64_tr_b16 a[110:111], v174 offset:14336
  ds_read_b64_tr_b16 a[188:189], v175 offset:12288
  ds_read_b64_tr_b16 a[190:191], v175 offset:14336
  s_waitcnt lgkmcnt(6)
  ds_read_b64_tr_b16 v[208:209], v172 offset:16384
  ds_read_b64_tr_b16 v[210:211], v172 offset:18432
  ds_read_b64_tr_b16 a[32:33], v173 offset:16384
  ds_read_b64_tr_b16 a[34:35], v173 offset:18432
  ds_read_b64_tr_b16 a[112:113], v174 offset:16384
  ds_read_b64_tr_b16 a[114:115], v174 offset:18432
  ds_read_b64_tr_b16 a[192:193], v175 offset:16384
  ds_read_b64_tr_b16 a[194:195], v175 offset:18432
  s_waitcnt lgkmcnt(6)
  s_waitcnt vmcnt(21)
  s_barrier
  ds_read_b64_tr_b16 v[212:213], v172 offset:20480
  ds_read_b64_tr_b16 v[214:215], v172 offset:22528
  ds_read_b64_tr_b16 a[36:37], v173 offset:20480
  ds_read_b64_tr_b16 a[38:39], v173 offset:22528
  ds_read_b64_tr_b16 a[116:117], v174 offset:20480
  ds_read_b64_tr_b16 a[118:119], v174 offset:22528
  ds_read_b64_tr_b16 a[196:197], v175 offset:20480
  ds_read_b64_tr_b16 a[198:199], v175 offset:22528
  s_waitcnt lgkmcnt(6)
  ds_read_b64_tr_b16 v[216:217], v172 offset:24576
  ds_read_b64_tr_b16 v[218:219], v172 offset:26624
  ds_read_b64_tr_b16 a[40:41], v173 offset:24576
  ds_read_b64_tr_b16 a[42:43], v173 offset:26624
  ds_read_b64_tr_b16 a[120:121], v174 offset:24576
  ds_read_b64_tr_b16 a[122:123], v174 offset:26624
  ds_read_b64_tr_b16 a[200:201], v175 offset:24576
  ds_read_b64_tr_b16 a[202:203], v175 offset:26624
  s_waitcnt lgkmcnt(6)
  ds_read_b64_tr_b16 v[220:221], v172 offset:28672
  ds_read_b64_tr_b16 v[222:223], v172 offset:30720
  ds_read_b64_tr_b16 a[44:45], v173 offset:28672
  ds_read_b64_tr_b16 a[46:47], v173 offset:30720
  ds_read_b64_tr_b16 a[124:125], v174 offset:28672
  ds_read_b64_tr_b16 a[126:127], v174 offset:30720
  ds_read_b64_tr_b16 a[204:205], v175 offset:28672
  ds_read_b64_tr_b16 a[206:207], v175 offset:30720
  s_waitcnt lgkmcnt(6)
  ds_read_b64_tr_b16 v[224:225], v172 offset:32768
  ds_read_b64_tr_b16 v[226:227], v172 offset:34816
  ds_read_b64_tr_b16 a[48:49], v173 offset:32768
  ds_read_b64_tr_b16 a[50:51], v173 offset:34816
  ds_read_b64_tr_b16 a[128:129], v174 offset:32768
  ds_read_b64_tr_b16 a[130:131], v174 offset:34816
  ds_read_b64_tr_b16 a[208:209], v175 offset:32768
  ds_read_b64_tr_b16 a[210:211], v175 offset:34816
  s_waitcnt lgkmcnt(6)
  ds_read_b64_tr_b16 v[228:229], v172 offset:36864
  ds_read_b64_tr_b16 v[230:231], v172 offset:38912
  ds_read_b64_tr_b16 a[52:53], v173 offset:36864
  ds_read_b64_tr_b16 a[54:55], v173 offset:38912
  ds_read_b64_tr_b16 a[132:133], v174 offset:36864
  ds_read_b64_tr_b16 a[134:135], v174 offset:38912
  ds_read_b64_tr_b16 a[212:213], v175 offset:36864
  ds_read_b64_tr_b16 a[214:215], v175 offset:38912
  s_waitcnt lgkmcnt(6)
  s_waitcnt vmcnt(10)
  v_cmp_gt_u32 vcc, 1, v166
  s_cbranch_vccz b_g0
  s_lshl_b32 s30, s16, 2
  s_add_u32 s30, s30, 32
  v_mov_b32 v167, s30
  s_mov_b32 s30, 0
  s_mov_b64 exec, 1
gw_26:
  buffer_load_dword v168, v167, s[12:15], 0 offen sc1
  s_add_u32 s30, s30, 1
  s_cmp_gt_u32 s30, 65536
  s_cbranch_scc1 role_abort
  s_waitcnt vmcnt(0)
  v_cmp_gt_u32 vcc, 1, v168
  s_cbranch_vccz gk_27
  s_sleep 4
  s_branch gw_26
gk_27:
  s_mov_b64 exec, -1
b_g0:
  s_mov_b32 s33, 8192
  buffer_load_dword v158, v157, s[8:11], s33 offen sc1
  s_barrier
  v_add_u32 v172, 40960, v172
  v_add_u32 v173, 40960, v173
  v_add_u32 v174, 40960, v174
  v_add_u32 v175, 40960, v175
  ds_read_b64_tr_b16 v[232:233], v172 offset:0
  ds_read_b64_tr_b16 v[234:235], v172 offset:2048
  ds_read_b64_tr_b16 a[56:57], v173 offset:0
  ds_read_b64_tr_b16 a[58:59], v173 offset:2048
  ds_read_b64_tr_b16 a[136:137], v174 offset:0
  ds_read_b64_tr_b16 a[138:139], v174 offset:2048
  ds_read_b64_tr_b16 a[216:217], v175 offset:0
  ds_read_b64_tr_b16 a[218:219], v175 offset:2048
  s_waitcnt lgkmcnt(6)
  ds_read_b64_tr_b16 v[236:237], v172 offset:4096
  ds_read_b64_tr_b16 v[238:239], v172 offset:6144
  ds_read_b64_tr_b16 a[60:61], v173 offset:4096
  ds_read_b64_tr_b16 a[62:63], v173 offset:6144
  ds_read_b64_tr_b16 a[140:141], v174 offset:4096
  ds_read_b64_tr_b16 a[142:143], v174 offset:6144
  ds_read_b64_tr_b16 a[220:221], v175 offset:4096
  ds_read_b64_tr_b16 a[222:223], v175 offset:6144
  s_waitcnt lgkmcnt(6)
  ds_read_b64_tr_b16 v[240:241], v172 offset:8192
  ds_read_b64_tr_b16 v[242:243], v172 offset:10240
  ds_read_b64_tr_b16 a[64:65], v173 offset:8192
  ds_read_b64_tr_b16 a[66:67], v173 offset:10240
  ds_read_b64_tr_b16 a[144:145], v174 offset:8192
  ds_read_b64_tr_b16 a[146:147], v174 offset:10240
  ds_read_b64_tr_b16 a[224:225], v175 offset:8192
  ds_read_b64_tr_b16 a[226:227], v175 offset:10240
  s_waitcnt lgkmcnt(6)
  ds_read_b64_tr_b16 v[244:245], v172 offset:12288
  ds_read_b64_tr_b16 v[246:247], v172 offset:14336
  ds_read_b64_tr_b16 a[68:69], v173 offset:12288
  ds_read_b64_tr_b16 a[70:71], v173 offset:14336
  ds_read_b64_tr_b16 a[148:149], v174 offset:12288
  ds_read_b64_tr_b16 a[150:151], v174 offset:14336
  ds_read_b64_tr_b16 a[228:229], v175 offset:12288
  ds_read_b64_tr_b16 a[230:231], v175 offset:14336
  s_waitcnt lgkmcnt(6)
  ds_read_b64_tr_b16 v[248:249], v172 offset:16384
  ds_read_b64_tr_b16 v[250:251], v172 offset:18432
  ds_read_b64_tr_b16 a[72:73], v173 offset:16384
  ds_read_b64_tr_b16 a[74:75], v173 offset:18432
  ds_read_b64_tr_b16 a[152:153], v174 offset:16384
  ds_read_b64_tr_b16 a[154:155], v174 offset:18432
  ds_read_b64_tr_b16 a[232:233], v175 offset:16384
  ds_read_b64_tr_b16 a[234:235], v175 offset:18432
  s_waitcnt lgkmcnt(6)
  s_waitcnt vmcnt(0)
  s_waitcnt lgkmcnt(0)
  s_barrier
  s_mov_b32 s44, s49
  s_mov_b32 s30, 0
  s_branch pc_30
pw_28:
  buffer_load_dword v158, v157, s[8:11], s33 offen sc1
  s_add_u32 s30, s30, 1
  s_cmp_gt_u32 s30, 65536
  s_cbranch_scc1 role_abort
  s_waitcnt vmcnt(0)
pc_30:
  v_cmp_gt_u32 vcc, 2, v158
  s_nop 0
  s_and_b32 vcc_lo, vcc_lo, 0xfff
  s_and_b32 vcc_hi, vcc_hi, 0x0
  s_cmp_eq_u64 vcc, 0
  s_cbranch_scc1 po_29
  s_sleep 4
  s_branch pw_28
po_29:
  s_add_u32 m0, s44, 0
  s_add_u32 s31, s43, 0
  buffer_load_dwordx4 v144, s[8:11], s31 offen offset:0 sc1 lds
  buffer_load_dwordx4 v144, s[8:11], s31 offen offset:1024 sc1 lds
  buffer_load_dwordx4 v144, s[8:11], s31 offen offset:2048 sc1 lds
  buffer_load_dwordx4 v144, s[8:11], s31 offen offset:3072 sc1 lds
  s_add_u32 m0, s44, 4096
  s_add_u32 s31, s43, 4096
  buffer_load_dwordx4 v144, s[8:11], s31 offen offset:0 sc1 lds
  buffer_load_dwordx4 v144, s[8:11], s31 offen offset:1024 sc1 lds
  buffer_load_dwordx4 v144, s[8:11], s31 offen offset:2048 sc1 lds
  buffer_load_dwordx4 v144, s[8:11], s31 offen offset:3072 sc1 lds
  s_add_u32 m0, s44, 8192
  s_add_u32 s31, s43, 8192
  buffer_load_dwordx4 v144, s[8:11], s31 offen offset:0 sc1 lds
  buffer_load_dwordx4 v144, s[8:11], s31 offen offset:1024 sc1 lds
  buffer_load_dword v158, v157, s[8:11], s33 offen sc1
  ds_read_b64_tr_b16 v[252:253], v172 offset:20480
  ds_read_b64_tr_b16 v[254:255], v172 offset:22528
  ds_read_b64_tr_b16 a[76:77], v173 offset:20480
  ds_read_b64_tr_b16 a[78:79], v173 offset:22528
  ds_read_b64_tr_b16 a[156:157], v174 offset:20480
  ds_read_b64_tr_b16 a[158:159], v174 offset:22528
  ds_read_b64_tr_b16 a[236:237], v175 offset:20480
  ds_read_b64_tr_b16 a[238:239], v175 offset:22528
  s_waitcnt lgkmcnt(6)
  ds_read_b64_tr_b16 a[0:1], v172 offset:24576
  ds_read_b64_tr_b16 a[2:3], v172 offset:26624
  ds_read_b64_tr_b16 a[80:81], v173 offset:24576
  ds_read_b64_tr_b16 a[82:83], v173 offset:26624
  ds_read_b64_tr_b16 a[160:161], v174 offset:24576
  ds_read_b64_tr_b16 a[162:163], v174 offset:26624
  ds_read_b64_tr_b16 a[240:241], v175 offset:24576
  ds_read_b64_tr_b16 a[242:243], v175 offset:26624
  s_waitcnt lgkmcnt(6)
  ds_read_b64_tr_b16 a[4:5], v172 offset:28672
  ds_read_b64_tr_b16 a[6:7], v172 offset:30720
  ds_read_b64_tr_b16 a[84:85], v173 offset:28672
  ds_read_b64_tr_b16 a[86:87], v173 offset:30720
  ds_read_b64_tr_b16 a[164:165], v174 offset:28672
  ds_read_b64_tr_b16 a[166:167], v174 offset:30720
  ds_read_b64_tr_b16 a[244:245], v175 offset:28672
  ds_read_b64_tr_b16 a[246:247], v175 offset:30720
  s_waitcnt lgkmcnt(6)
  ds_read_b64_tr_b16 a[8:9], v172 offset:32768
  ds_read_b64_tr_b16 a[10:11], v172 offset:34816
  ds_read_b64_tr_b16 a[88:89], v173 offset:32768
  ds_read_b64_tr_b16 a[90:91], v173 offset:34816
  ds_read_b64_tr_b16 a[168:169], v174 offset:32768
  ds_read_b64_tr_b16 a[170:171], v174 offset:34816
  ds_read_b64_tr_b16 a[248:249], v175 offset:32768
  ds_read_b64_tr_b16 a[250:251], v175 offset:34816
  s_waitcnt lgkmcnt(6)
  ds_read_b64_tr_b16 a[12:13], v172 offset:36864
  ds_read_b64_tr_b16 a[14:15], v172 offset:38912
  ds_read_b64_tr_b16 a[92:93], v173 offset:36864
  ds_read_b64_tr_b16 a[94:95], v173 offset:38912
  ds_read_b64_tr_b16 a[172:173], v174 offset:36864
  ds_read_b64_tr_b16 a[174:175], v174 offset:38912
  ds_read_b64_tr_b16 a[252:253], v175 offset:36864
  ds_read_b64_tr_b16 a[254:255], v175 offset:38912
  s_waitcnt lgkmcnt(6)
  s_waitcnt lgkmcnt(0)
  s_xor_b32 s44, s44, 0x10000
  s_add_u32 s43, s43, 40960
  s_waitcnt vmcnt(0)
  s_barrier
  s_cmp_ge_u32 s18, 12
  s_cbranch_scc1 b_pro3
  s_cmp_lt_u32 s17, 2
  s_cbranch_scc1 b_pro0
  s_cmp_eq_u32 s17, 2
  s_cbranch_scc1 b_pro1
  s_branch b_pro2
b_pro0:
  s_lshr_b32 s31, s26, 1
  s_lshl_b32 s31, s31, 10
  s_cmp_eq_u32 s17, 0
  s_cselect_b32 s46, s31, 3072
  s_add_u32 s46, s46, s37
  s_add_u32 s37, s37, s31
.p2align 7
b_top0:
  s_add_u32 s31, s28, 3
  s_and_b32 s31, s31, 3
  s_mul_i32 s31, s31, 163840
  s_add_u32 s58, s56, s31
  s_add_u32 s59, s58, 16384
  s_add_u32 s60, s58, 32768
  s_cmp_ge_u32 s29, 64
  s_cbranch_scc1 b_step00
  ds_read_b128 v[116:119], v159 offset:16384
  ds_read_b128 v[120:123], v159 offset:17408
  ds_read_b128 v[124:127], v159 offset:18432
  s_and_b32 s31, s29, 3
  s_mul_i32 s31, s31, 147456
  s_add_u32 s42, s41, s31
  s_add_u32 s42, s42, s51
  s_add_u32 s49, s29, 2
  s_lshl_b32 s48, s49, 1
  s_min_u32 s48, s48, 128
  s_and_b32 s31, s29, 3
  s_lshl_b32 s31, s31, 12
  v_add_u32 v162, s31, v160
  v_xor_b32 v176, 1024, v162
  s_add_u32 s29, s29, 1
  s_mov_b32 s33, 4096
  s_max_u32 s31, s29, 4
  s_sub_u32 s31, s31, 4
  v_mov_b32 v190, s31
  v_mov_b32 v167, s48
  v_cndmask_b32 v190, v190, v167, s[74:75]
  s_waitcnt lgkmcnt(2)
  v_mfma_f32_16x16x32_bf16 v[100:103], v[192:195], v[116:119], 0
  ds_read_b128 v[128:131], v159 offset:19456
  v_mfma_f32_16x16x32_bf16 v[104:107], a[16:19], v[116:119], 0
  v_mfma_f32_16x16x32_bf16 v[108:111], a[96:99], v[116:119], 0
  v_mfma_f32_16x16x32_bf16 v[112:115], a[176:179], v[116:119], 0
  s_waitcnt lgkmcnt(2)
  v_mfma_f32_16x16x32_bf16 v[100:103], v[196:199], v[120:123], v[100:103]
  ds_read_b128 v[116:119], v159 offset:20480
  v_mfma_f32_16x16x32_bf16 v[104:107], a[20:23], v[120:123], v[104:107]
  v_mfma_f32_16x16x32_bf16 v[108:111], a[100:103], v[120:123], v[108:111]
  v_mfma_f32_16x16x32_bf16 v[112:115], a[180:183], v[120:123], v[112:115]
  s_waitcnt lgkmcnt(2)
  v_mfma_f32_16x16x32_bf16 v[100:103], v[200:203], v[124:127], v[100:103]
  ds_read_b128 v[120:123], v159 offset:21504
  v_mfma_f32_16x16x32_bf16 v[104:107], a[24:27], v[124:127], v[104:107]
  s_mov_b32 s30, 0
  s_branch pc_33
pw_31:
  buffer_load_dword v158, v189, s[8:11], s33 offen sc1
  s_add_u32 s30, s30, 1
  s_cmp_gt_u32 s30, 65536
  s_cbranch_scc1 role_abort
  s_waitcnt vmcnt(0)
pc_33:
  v_cmp_gt_u32 vcc, v190, v158
  s_nop 0
  s_and_b32 vcc_lo, vcc_lo, 0xf000fff
  s_and_b32 vcc_hi, vcc_hi, 0x0
  s_cmp_eq_u64 vcc, 0
  s_cbranch_scc1 po_32
  s_sleep 4
  s_branch pw_31
po_32:
  v_mfma_f32_16x16x32_bf16 v[108:111], a[104:107], v[124:127], v[108:111]
  v_mfma_f32_16x16x32_bf16 v[112:115], a[184:187], v[124:127], v[112:115]
  s_add_u32 m0, s44, 0
  s_add_u32 s31, s43, 0
  buffer_load_dwordx4 v144, s[8:11], s31 offen offset:0 sc1 lds
  s_waitcnt lgkmcnt(2)
  v_mfma_f32_16x16x32_bf16 v[100:103], v[204:207], v[128:131], v[100:103]
  ds_read_b128 v[124:127], v159 offset:22528
  v_mfma_f32_16x16x32_bf16 v[104:107], a[28:31], v[128:131], v[104:107]
  v_mfma_f32_16x16x32_bf16 v[108:111], a[108:111], v[128:131], v[108:111]
  v_mfma_f32_16x16x32_bf16 v[112:115], a[188:191], v[128:131], v[112:115]
  buffer_load_dwordx4 v144, s[8:11], s31 offen offset:1024 sc1 lds
  s_waitcnt lgkmcnt(2)
  v_mfma_f32_16x16x32_bf16 v[100:103], v[208:211], v[116:119], v[100:103]
  ds_read_b128 v[128:131], v159 offset:23552
  v_mfma_f32_16x16x32_bf16 v[104:107], a[32:35], v[116:119], v[104:107]
  v_mfma_f32_16x16x32_bf16 v[108:111], a[112:115], v[116:119], v[108:111]
  v_mfma_f32_16x16x32_bf16 v[112:115], a[192:195], v[116:119], v[112:115]
  buffer_load_dwordx4 v144, s[8:11], s31 offen offset:2048 sc1 lds
  s_waitcnt lgkmcnt(2)
  v_mfma_f32_16x16x32_bf16 v[100:103], v[212:215], v[120:123], v[100:103]
  ds_read_b128 v[116:119], v159 offset:24576
  v_mfma_f32_16x16x32_bf16 v[104:107], a[36:39], v[120:123], v[104:107]
  v_mfma_f32_16x16x32_bf16 v[108:111], a[116:119], v[120:123], v[108:111]
  v_mfma_f32_16x16x32_bf16 v[112:115], a[196:199], v[120:123], v[112:115]
  buffer_load_dwordx4 v144, s[8:11], s31 offen offset:3072 sc1 lds
  s_waitcnt lgkmcnt(2)
  v_mfma_f32_16x16x32_bf16 v[100:103], v[216:219], v[124:127], v[100:103]
  ds_read_b128 v[120:123], v159 offset:25600
  v_mfma_f32_16x16x32_bf16 v[104:107], a[40:43], v[124:127], v[104:107]
  v_mfma_f32_16x16x32_bf16 v[108:111], a[120:123], v[124:127], v[108:111]
  v_mfma_f32_16x16x32_bf16 v[112:115], a[200:203], v[124:127], v[112:115]
  s_add_u32 m0, s44, 4096
  s_add_u32 s31, s43, 4096
  buffer_load_dwordx4 v144, s[8:11], s31 offen offset:0 sc1 lds
  s_waitcnt lgkmcnt(2)
  v_mfma_f32_16x16x32_bf16 v[100:103], v[220:223], v[128:131], v[100:103]
  ds_read_b128 v[124:127], v159 offset:26624
  v_mfma_f32_16x16x32_bf16 v[104:107], a[44:47], v[128:131], v[104:107]
  v_mfma_f32_16x16x32_bf16 v[108:111], a[124:127], v[128:131], v[108:111]
  v_mfma_f32_16x16x32_bf16 v[112:115], a[204:207], v[128:131], v[112:115]
  buffer_load_dwordx4 v144, s[8:11], s31 offen offset:1024 sc1 lds
  s_waitcnt lgkmcnt(2)
  v_mfma_f32_16x16x32_bf16 v[100:103], v[224:227], v[116:119], v[100:103]
  ds_read_b128 v[128:131], v159 offset:27648
  v_mfma_f32_16x16x32_bf16 v[104:107], a[48:51], v[116:119], v[104:107]
  v_mfma_f32_16x16x32_bf16 v[108:111], a[128:131], v[116:119], v[108:111]
  v_mfma_f32_16x16x32_bf16 v[112:115], a[208:211], v[116:119], v[112:115]
  buffer_load_dwordx4 v144, s[8:11], s31 offen offset:2048 sc1 lds
  s_waitcnt lgkmcnt(2)
  v_mfma_f32_16x16x32_bf16 v[100:103], v[228:231], v[120:123], v[100:103]
  ds_read_b128 v[116:119], v159 offset:28672
  v_mfma_f32_16x16x32_bf16 v[104:107], a[52:55], v[120:123], v[104:107]
  v_mfma_f32_16x16x32_bf16 v[108:111], a[132:135], v[120:123], v[108:111]
  v_mfma_f32_16x16x32_bf16 v[112:115], a[212:215], v[120:123], v[112:115]
  buffer_load_dwordx4 v144, s[8:11], s31 offen offset:3072 sc1 lds
  s_waitcnt lgkmcnt(2)
  v_mfma_f32_16x16x32_bf16 v[100:103], v[232:235], v[124:127], v[100:103]
  ds_read_b128 v[120:123], v159 offset:29696
  v_mfma_f32_16x16x32_bf16 v[104:107], a[56:59], v[124:127], v[104:107]
  v_mfma_f32_16x16x32_bf16 v[108:111], a[136:139], v[124:127], v[108:111]
  v_mfma_f32_16x16x32_bf16 v[112:115], a[216:219], v[124:127], v[112:115]
  s_add_u32 m0, s44, 8192
  s_add_u32 s31, s43, 8192
  buffer_load_dwordx4 v144, s[8:11], s31 offen offset:0 sc1 lds
  s_waitcnt lgkmcnt(2)
  v_mfma_f32_16x16x32_bf16 v[100:103], v[236:239], v[128:131], v[100:103]
  ds_read_b128 v[124:127], v159 offset:30720
  v_mfma_f32_16x16x32_bf16 v[104:107], a[60:63], v[128:131], v[104:107]
  v_mfma_f32_16x16x32_bf16 v[108:111], a[140:143], v[128:131], v[108:111]
  v_mfma_f32_16x16x32_bf16 v[112:115], a[220:223], v[128:131], v[112:115]
  buffer_load_dwordx4 v144, s[8:11], s31 offen offset:1024 sc1 lds
  s_waitcnt lgkmcnt(2)
  v_mfma_f32_16x16x32_bf16 v[100:103], v[240:243], v[116:119], v[100:103]
  ds_read_b128 v[128:131], v159 offset:31744
  v_mfma_f32_16x16x32_bf16 v[104:107], a[64:67], v[116:119], v[104:107]
  v_mfma_f32_16x16x32_bf16 v[108:111], a[144:147], v[116:119], v[108:111]
  v_mfma_f32_16x16x32_bf16 v[112:115], a[224:227], v[116:119], v[112:115]
  buffer_load_dword v158, v189, s[8:11], s33 offen sc1
  s_waitcnt lgkmcnt(2)
  v_mfma_f32_16x16x32_bf16 v[100:103], v[244:247], v[120:123], v[100:103]
  ds_read_b128 v[116:119], v159 offset:32768
  v_mfma_f32_16x16x32_bf16 v[104:107], a[68:71], v[120:123], v[104:107]
  v_mfma_f32_16x16x32_bf16 v[108:111], a[148:151], v[120:123], v[108:111]
  v_mfma_f32_16x16x32_bf16 v[112:115], a[228:231], v[120:123], v[112:115]
  s_waitcnt lgkmcnt(2)
  v_mfma_f32_16x16x32_bf16 v[100:103], v[248:251], v[124:127], v[100:103]
  ds_read_b128 v[120:123], v159 offset:33792
  v_mfma_f32_16x16x32_bf16 v[104:107], a[72:75], v[124:127], v[104:107]
  v_mfma_f32_16x16x32_bf16 v[108:111], a[152:155], v[124:127], v[108:111]
  v_mfma_f32_16x16x32_bf16 v[112:115], a[232:235], v[124:127], v[112:115]
  s_waitcnt lgkmcnt(2)
  v_mfma_f32_16x16x32_bf16 v[100:103], v[252:255], v[128:131], v[100:103]
  ds_read_b128 v[124:127], v159 offset:34816
  v_mfma_f32_16x16x32_bf16 v[104:107], a[76:79], v[128:131], v[104:107]
  v_mfma_f32_16x16x32_bf16 v[108:111], a[156:159], v[128:131], v[108:111]
  v_mfma_f32_16x16x32_bf16 v[112:115], a[236:239], v[128:131], v[112:115]
  s_waitcnt lgkmcnt(2)
  v_mfma_f32_16x16x32_bf16 v[100:103], a[0:3], v[116:119], v[100:103]
  ds_read_b128 v[128:131], v159 offset:35840
  v_mfma_f32_16x16x32_bf16 v[104:107], a[80:83], v[116:119], v[104:107]
  v_mfma_f32_16x16x32_bf16 v[108:111], a[160:163], v[116:119], v[108:111]
  v_mfma_f32_16x16x32_bf16 v[112:115], a[240:243], v[116:119], v[112:115]
  s_waitcnt lgkmcnt(2)
  v_mfma_f32_16x16x32_bf16 v[100:103], a[4:7], v[120:123], v[100:103]
  v_mfma_f32_16x16x32_bf16 v[104:107], a[84:87], v[120:123], v[104:107]
  v_mfma_f32_16x16x32_bf16 v[108:111], a[164:167], v[120:123], v[108:111]
  v_mfma_f32_16x16x32_bf16 v[112:115], a[244:247], v[120:123], v[112:115]
  s_waitcnt lgkmcnt(1)
  v_mfma_f32_16x16x32_bf16 v[100:103], a[8:11], v[124:127], v[100:103]
  v_mfma_f32_16x16x32_bf16 v[104:107], a[88:91], v[124:127], v[104:107]
  v_mfma_f32_16x16x32_bf16 v[108:111], a[168:171], v[124:127], v[108:111]
  v_mfma_f32_16x16x32_bf16 v[112:115], a[248:251], v[124:127], v[112:115]
  s_waitcnt lgkmcnt(0)
  v_mfma_f32_16x16x32_bf16 v[100:103], a[12:15], v[128:131], v[100:103]
  v_mfma_f32_16x16x32_bf16 v[104:107], a[92:95], v[128:131], v[104:107]
  v_mfma_f32_16x16x32_bf16 v[108:111], a[172:175], v[128:131], v[108:111]
  v_mfma_f32_16x16x32_bf16 v[112:115], a[252:255], v[128:131], v[112:115]
  s_xor_b32 s44, s44, 0x10000
  v_xor_b32 v159, 0x10000, v159
  s_cmp_lt_u32 s29, 63
  s_cselect_b32 s31, 40960, 0
  s_add_u32 s43, s43, s31
  s_mul_i32 s31, s16, 2621440
  s_cmp_eq_u32 s29, 11
  s_cselect_b32 s31, s31, 0
  s_sub_u32 s43, s43, s31
  v_mov_b32 v169, s29
  v_cvt_pk_bf16_f32 v132, v100, v101
  v_cvt_pk_bf16_f32 v133, v102, v103
  v_cvt_pk_bf16_f32 v134, v104, v105
  v_cvt_pk_bf16_f32 v135, v106, v107
  buffer_store_dwordx4 v[132:135], v144, s[8:11], s42 offen
  s_add_u32 s42, s42, s50
  v_cvt_pk_bf16_f32 v136, v108, v109
  v_cvt_pk_bf16_f32 v137, v110, v111
  v_cvt_pk_bf16_f32 v138, v112, v113
  v_cvt_pk_bf16_f32 v139, v114, v115
  buffer_store_dwordx4 v[136:139], v144, s[8:11], s42 offen
  s_add_u32 s42, s42, s50
  s_cmp_gt_u32 s29, 1
  s_cbranch_scc1 b_step03
  s_waitcnt vmcnt(0) lgkmcnt(0)
  buffer_store_dword v169, v154, s[8:11], 0 offen
  s_cmp_eq_u32 s29, 2
  s_barrier
  s_cbranch_scc1 b_top0
  s_mov_b32 s33, 4096
  s_mov_b32 s30, 0
pw_34:
  buffer_load_dword v166, v157, s[8:11], s33 offen sc1
  s_add_u32 s30, s30, 1
  s_cmp_gt_u32 s30, 65536
  s_cbranch_scc1 role_abort
  s_waitcnt vmcnt(0)
pc_36:
  v_cmp_gt_u32 vcc, 1, v166
  s_nop 0
  s_and_b32 vcc_lo, vcc_lo, 0x10000000
  s_and_b32 vcc_hi, vcc_hi, 0x0
  s_cmp_eq_u64 vcc, 0
  s_cbranch_scc1 po_35
  s_sleep 2
  s_branch pw_34
po_35:
  v_readlane_b32 s31, v166, 28
  s_nop 0
  s_lshl_b32 s31, s31, 13
  s_add_u32 s56, s56, s31
  s_branch b_step02
b_step00:
  s_sleep 24
b_step03:
  s_waitcnt vmcnt(2) lgkmcnt(0)
  s_barrier
  buffer_load_dwordx4 v[116:119], v144, s[8:11], s58 offen sc1
  buffer_load_dwordx4 v[120:123], v144, s[8:11], s58 offen offset:1024 sc1
  s_and_b32 s31, s28, 3
  s_mul_i32 s36, s31, 81920
  s_add_u32 s36, s36, s35
  s_lshl_b32 s32, s31, 15
  s_add_u32 s38, s37, s32
  s_add_u32 s28, s28, 1
  v_mov_b32 v170, s28
  s_lshl_b32 s32, s31, 12
  v_add_u32 v163, s32, v161
  ds_read_b128 v[44:47], v163
  ds_read_b128 v[48:51], v163 offset:1024
  v_mov_b32 v60, 0
  v_mov_b32 v61, 0
  v_mov_b32 v62, 0
  v_mov_b32 v63, 0
  v_mov_b32 v64, 0
  v_mov_b32 v65, 0
  v_mov_b32 v66, 0
  v_mov_b32 v67, 0
  s_mov_b32 s30, 0
  s_add_u32 s31, s36, s57
  s_waitcnt vmcnt(0)
  v_mfma_f32_16x16x32_bf16 v[108:111], v[180:183], v[116:119], 0
  v_mfma_f32_16x16x32_bf16 v[108:111], v[180:183], v[120:123], v[108:111]
  s_nop 7
  v_cmp_u_f32 vcc, v108, v109
  v_cvt_pk_bf16_f32 v168, v108, v109
  s_cbranch_vccnz b_step0xr
b_step0x:
  buffer_store_dword v168, v146, s[8:11], s31 offen
  buffer_store_dword v169, v154, s[8:11], 0 offen
  s_nop 15
  s_nop 13
  s_branch b_step0P
b_step0S:
  s_sleep 6
b_step02:
  s_and_b32 s31, s28, 3
  s_mul_i32 s36, s31, 81920
  s_add_u32 s36, s36, s35
  s_lshl_b32 s32, s31, 15
  s_add_u32 s38, s37, s32
  s_add_u32 s28, s28, 1
  v_mov_b32 v170, s28
  s_lshl_b32 s32, s31, 12
  v_add_u32 v163, s32, v161
  ds_read_b128 v[44:47], v163
  ds_read_b128 v[48:51], v163 offset:1024
  v_mov_b32 v60, 0
  v_mov_b32 v61, 0
  v_mov_b32 v62, 0
  v_mov_b32 v63, 0
  v_mov_b32 v64, 0
  v_mov_b32 v65, 0
  v_mov_b32 v66, 0
  v_mov_b32 v67, 0
.p2align 7
b_step0P:
  s_mov_b32 s30, 0
  buffer_load_dwordx4 v[76:79], v147, s[8:11], s36 offen sc1
  buffer_load_dwordx4 v[80:83], v147, s[8:11], s36 offen offset:1024 sc1
  buffer_load_dword v84, v148, s[8:11], s36 offen sc1
  buffer_load_dword v85, v148, s[8:11], s36 offen offset:256 sc1
  s_nop 15
  s_nop 15
mq_37:
  buffer_load_dwordx4 v[88:91], v147, s[8:11], s36 offen sc1
  buffer_load_dwordx4 v[92:95], v147, s[8:11], s36 offen offset:1024 sc1
  buffer_load_dword v96, v148, s[8:11], s36 offen sc1
  buffer_load_dword v97, v148, s[8:11], s36 offen offset:256 sc1
  s_add_u32 s30, s30, 1
  s_cmp_gt_u32 s30, 65536
  s_cbranch_scc1 chain_abort
  s_waitcnt vmcnt(4)
  buffer_store_dword v169, v154, s[8:11], 0 offen
  v_max3_u32 v167, v76, v80, v84
  v_max_u32 v167, v167, v85
  v_cmp_eq_u32 vcc, -1, v167
  ds_write_b128 v147, v[76:79]
  ds_write_b128 v147, v[80:83] offset:1024
  ds_write2st64_b32 v148, v84, v85 offset0:0 offset1:1
  s_cbranch_vccz mq_37_ok
  buffer_load_dwordx4 v[76:79], v147, s[8:11], s36 offen sc1
  buffer_load_dwordx4 v[80:83], v147, s[8:11], s36 offen offset:1024 sc1
  buffer_load_dword v84, v148, s[8:11], s36 offen sc1
  buffer_load_dword v85, v148, s[8:11], s36 offen offset:256 sc1
  s_waitcnt vmcnt(5)
  v_max3_u32 v167, v88, v92, v96
  v_max_u32 v167, v167, v97
  v_cmp_eq_u32 vcc, -1, v167
  ds_write_b128 v147, v[88:91]
  ds_write_b128 v147, v[92:95] offset:1024
  ds_write2st64_b32 v148, v96, v97 offset0:0 offset1:1
  s_cbranch_vccz mq_37_ok
  s_branch mq_37
.p2align 7
mq_37_ok:
  s_waitcnt lgkmcnt(0)
  s_barrier
  ds_read_b128 v[4:7], v144 offset:0
  ds_read_b128 v[8:11], v144 offset:1024
  ds_read_b128 v[12:15], v144 offset:2048
  ds_read_b128 v[16:19], v144 offset:3072
  ds_read_b128 v[20:23], v144 offset:4096
  ds_read_b128 v[24:27], v144 offset:5120
  ds_read_b128 v[28:31], v144 offset:6144
  ds_read_b128 v[32:35], v144 offset:7168
  ds_read_b128 v[36:39], v144 offset:8192
  ds_read_b128 v[40:43], v144 offset:9216
  s_waitcnt lgkmcnt(9)
  v_smfmac_f32_16x16x64_bf16 v[60:63], v[4:7], v[192:199], v151
  v_smfmac_f32_16x16x64_bf16 v[64:67], v[4:7], a[16:23], v151
  s_waitcnt lgkmcnt(8)
  v_smfmac_f32_16x16x64_bf16 v[60:63], v[8:11], v[200:207], v151
  v_smfmac_f32_16x16x64_bf16 v[64:67], v[8:11], a[24:31], v151
  s_waitcnt lgkmcnt(7)
  v_smfmac_f32_16x16x64_bf16 v[60:63], v[12:15], v[208:215], v151
  v_smfmac_f32_16x16x64_bf16 v[64:67], v[12:15], a[32:39], v151
  s_waitcnt lgkmcnt(6)
  v_smfmac_f32_16x16x64_bf16 v[60:63], v[16:19], v[216:223], v151
  v_smfmac_f32_16x16x64_bf16 v[64:67], v[16:19], a[40:47], v151
  s_waitcnt lgkmcnt(5)
  v_smfmac_f32_16x16x64_bf16 v[60:63], v[20:23], v[224:231], v151
  v_smfmac_f32_16x16x64_bf16 v[64:67], v[20:23], a[48:55], v151
  s_waitcnt lgkmcnt(4)
  v_smfmac_f32_16x16x64_bf16 v[60:63], v[24:27], v[232:239], v151
  v_smfmac_f32_16x16x64_bf16 v[64:67], v[24:27], a[56:63], v151
  s_waitcnt lgkmcnt(3)
  v_smfmac_f32_16x16x64_bf16 v[60:63], v[28:31], v[240:247], v151
  v_smfmac_f32_16x16x64_bf16 v[64:67], v[28:31], a[64:71], v151
  s_waitcnt lgkmcnt(2)
  v_smfmac_f32_16x16x64_bf16 v[60:63], v[32:35], v[248:255], v151
  s_waitcnt lgkmcnt(1)
  v_smfmac_f32_16x16x64_bf16 v[60:63], v[36:39], a[0:7], v151
  s_waitcnt lgkmcnt(0)
  v_smfmac_f32_16x16x64_bf16 v[60:63], v[40:43], a[8:15], v151
  s_nop 2
  v_smfmac_f32_16x16x64_bf16 v[64:67], v[32:35], a[72:79], v151
  s_nop 2
  v_smfmac_f32_16x16x64_bf16 v[64:67], v[36:39], a[80:87], v151
  v_add_f32 v60, v60, v62
  v_add_f32 v61, v61, v63
  v_cvt_pk_bf16_f32 v140, v60, v61
  ds_write2_b32 v149, v140, v140 offset0:0 offset1:4
  v_smfmac_f32_16x16x64_bf16 v[64:67], v[40:43], a[88:95], v151
  s_nop 7
  v_add_f32 v64, v64, v66
  v_add_f32 v65, v65, v67
  v_cvt_pk_bf16_f32 v141, v64, v65
  ds_write2_b32 v149, v141, v141 offset0:128 offset1:132
  s_mov_b32 s30, 0
  s_nop 5
sx_38:
  ds_read_b64_tr_b16 v[52:53], v145 offset:10240
  ds_read_b64_tr_b16 v[54:55], v145 offset:10752
  ds_read_b64_tr_b16 v[56:57], v145 offset:11264
  ds_read_b64_tr_b16 v[58:59], v145 offset:11776
  s_waitcnt lgkmcnt(2)
  v_mfma_f32_16x16x32_bf16 v[68:71], v[44:47], v[52:55], 0
  s_waitcnt lgkmcnt(0)
  v_mfma_f32_16x16x32_bf16 v[68:71], v[48:51], v[56:59], v[68:71]
  s_nop 7
  v_cmp_u_f32 vcc, v68, v69
  s_mov_b64 exec, s[52:53]
  s_cbranch_vccnz sx_38_r
  buffer_store_dwordx4 v[68:71], v144, s[8:11], s38 offen
  s_mov_b64 exec, -1
  s_add_u32 s31, s28, 2
  s_and_b32 s31, s31, 3
  s_cmp_eq_u32 s28, 64
  s_cbranch_scc1 b_end
  s_lshl_b32 s31, s31, 15
  s_add_u32 s31, s31, s46
  buffer_store_dwordx4 v[72:75], v144, s[8:11], s31 offen
  s_branch b_top0
b_step0xr:
  buffer_load_dwordx4 v[116:119], v144, s[8:11], s58 offen sc1
  buffer_load_dwordx4 v[120:123], v144, s[8:11], s58 offen offset:1024 sc1
  s_add_u32 s30, s30, 1
  s_cmp_gt_u32 s30, 65536
  s_cbranch_scc1 chain_abort
  s_waitcnt vmcnt(0)
  v_mfma_f32_16x16x32_bf16 v[108:111], v[180:183], v[116:119], 0
  v_mfma_f32_16x16x32_bf16 v[108:111], v[180:183], v[120:123], v[108:111]
  s_nop 7
  v_cmp_u_f32 vcc, v108, v109
  v_cvt_pk_bf16_f32 v168, v108, v109
  s_cbranch_vccz b_step0x
  s_branch b_step0xr
sx_38_r:
  s_mov_b64 exec, -1
  s_add_u32 s30, s30, 1
  s_cmp_gt_u32 s30, 65536
  s_cbranch_scc1 chain_abort
  s_branch sx_38
b_pro1:
  s_lshl_b32 s31, s26, 7
  s_add_u32 s37, s37, s31
  s_add_u32 s37, s37, 3072
  s_min_u32 s31, s18, 9
  s_lshl_b32 s31, s31, 10
  s_add_u32 s46, s35, s31
  ds_write_b128 v144, v[72:75] offset:10240
  ds_write_b128 v144, v[72:75] offset:11264
.p2align 7
b_top1:
  s_cmp_ge_u32 s29, 64
  s_cbranch_scc1 b_step10
  ds_read_b128 v[116:119], v159 offset:16384
  ds_read_b128 v[120:123], v159 offset:17408
  ds_read_b128 v[124:127], v159 offset:18432
  s_and_b32 s31, s29, 3
  s_mul_i32 s31, s31, 147456
  s_add_u32 s42, s41, s31
  s_add_u32 s42, s42, s51
  s_add_u32 s49, s29, 2
  s_lshl_b32 s48, s49, 1
  s_min_u32 s48, s48, 128
  s_and_b32 s31, s29, 3
  s_lshl_b32 s31, s31, 12
  v_add_u32 v162, s31, v160
  v_xor_b32 v176, 1024, v162
  s_add_u32 s29, s29, 1
  s_mov_b32 s33, 4096
  s_max_u32 s31, s29, 4
  s_sub_u32 s31, s31, 4
  v_mov_b32 v190, s31
  v_mov_b32 v167, s48
  v_cndmask_b32 v190, v190, v167, s[74:75]
  s_waitcnt lgkmcnt(2)
  v_mfma_f32_16x16x32_bf16 v[100:103], v[192:195], v[116:119], 0
  ds_read_b128 v[128:131], v159 offset:19456
  v_mfma_f32_16x16x32_bf16 v[104:107], a[16:19], v[116:119], 0
  v_mfma_f32_16x16x32_bf16 v[108:111], a[96:99], v[116:119], 0
  v_mfma_f32_16x16x32_bf16 v[112:115], a[176:179], v[116:119], 0
  s_waitcnt lgkmcnt(2)
  v_mfma_f32_16x16x32_bf16 v[100:103], v[196:199], v[120:123], v[100:103]
  ds_read_b128 v[116:119], v159 offset:20480
  v_mfma_f32_16x16x32_bf16 v[104:107], a[20:23], v[120:123], v[104:107]
  v_mfma_f32_16x16x32_bf16 v[108:111], a[100:103], v[120:123], v[108:111]
  v_mfma_f32_16x16x32_bf16 v[112:115], a[180:183], v[120:123], v[112:115]
  s_waitcnt lgkmcnt(2)
  v_mfma_f32_16x16x32_bf16 v[100:103], v[200:203], v[124:127], v[100:103]
  ds_read_b128 v[120:123], v159 offset:21504
  v_mfma_f32_16x16x32_bf16 v[104:107], a[24:27], v[124:127], v[104:107]
  s_mov_b32 s30, 0
  s_branch pc_41
pw_39:
  buffer_load_dword v158, v189, s[8:11], s33 offen sc1
  s_add_u32 s30, s30, 1
  s_cmp_gt_u32 s30, 65536
  s_cbranch_scc1 role_abort
  s_waitcnt vmcnt(0)
pc_41:
  v_cmp_gt_u32 vcc, v190, v158
  s_nop 0
  s_and_b32 vcc_lo, vcc_lo, 0xf000fff
  s_and_b32 vcc_hi, vcc_hi, 0x0
  s_cmp_eq_u64 vcc, 0
  s_cbranch_scc1 po_40
  s_sleep 4
  s_branch pw_39
po_40:
  v_mfma_f32_16x16x32_bf16 v[108:111], a[104:107], v[124:127], v[108:111]
  v_mfma_f32_16x16x32_bf16 v[112:115], a[184:187], v[124:127], v[112:115]
  s_add_u32 m0, s44, 0
  s_add_u32 s31, s43, 0
  buffer_load_dwordx4 v144, s[8:11], s31 offen offset:0 sc1 lds
  s_waitcnt lgkmcnt(2)
  v_mfma_f32_16x16x32_bf16 v[100:103], v[204:207], v[128:131], v[100:103]
  ds_read_b128 v[124:127], v159 offset:22528
  v_mfma_f32_16x16x32_bf16 v[104:107], a[28:31], v[128:131], v[104:107]
  v_mfma_f32_16x16x32_bf16 v[108:111], a[108:111], v[128:131], v[108:111]
  v_mfma_f32_16x16x32_bf16 v[112:115], a[188:191], v[128:131], v[112:115]
  buffer_load_dwordx4 v144, s[8:11], s31 offen offset:1024 sc1 lds
  s_waitcnt lgkmcnt(2)
  v_mfma_f32_16x16x32_bf16 v[100:103], v[208:211], v[116:119], v[100:103]
  ds_read_b128 v[128:131], v159 offset:23552
  v_mfma_f32_16x16x32_bf16 v[104:107], a[32:35], v[116:119], v[104:107]
  v_mfma_f32_16x16x32_bf16 v[108:111], a[112:115], v[116:119], v[108:111]
  v_mfma_f32_16x16x32_bf16 v[112:115], a[192:195], v[116:119], v[112:115]
  buffer_load_dwordx4 v144, s[8:11], s31 offen offset:2048 sc1 lds
  s_waitcnt lgkmcnt(2)
  v_mfma_f32_16x16x32_bf16 v[100:103], v[212:215], v[120:123], v[100:103]
  ds_read_b128 v[116:119], v159 offset:24576
  v_mfma_f32_16x16x32_bf16 v[104:107], a[36:39], v[120:123], v[104:107]
  v_mfma_f32_16x16x32_bf16 v[108:111], a[116:119], v[120:123], v[108:111]
  v_mfma_f32_16x16x32_bf16 v[112:115], a[196:199], v[120:123], v[112:115]
  buffer_load_dwordx4 v144, s[8:11], s31 offen offset:3072 sc1 lds
  s_waitcnt lgkmcnt(2)
  v_mfma_f32_16x16x32_bf16 v[100:103], v[216:219], v[124:127], v[100:103]
  ds_read_b128 v[120:123], v159 offset:25600
  v_mfma_f32_16x16x32_bf16 v[104:107], a[40:43], v[124:127], v[104:107]
  v_mfma_f32_16x16x32_bf16 v[108:111], a[120:123], v[124:127], v[108:111]
  v_mfma_f32_16x16x32_bf16 v[112:115], a[200:203], v[124:127], v[112:115]
  s_add_u32 m0, s44, 4096
  s_add_u32 s31, s43, 4096
  buffer_load_dwordx4 v144, s[8:11], s31 offen offset:0 sc1 lds
  s_waitcnt lgkmcnt(2)
  v_mfma_f32_16x16x32_bf16 v[100:103], v[220:223], v[128:131], v[100:103]
  ds_read_b128 v[124:127], v159 offset:26624
  v_mfma_f32_16x16x32_bf16 v[104:107], a[44:47], v[128:131], v[104:107]
  v_mfma_f32_16x16x32_bf16 v[108:111], a[124:127], v[128:131], v[108:111]
  v_mfma_f32_16x16x32_bf16 v[112:115], a[204:207], v[128:131], v[112:115]
  buffer_load_dwordx4 v144, s[8:11], s31 offen offset:1024 sc1 lds
  s_waitcnt lgkmcnt(2)
  v_mfma_f32_16x16x32_bf16 v[100:103], v[224:227], v[116:119], v[100:103]
  ds_read_b128 v[128:131], v159 offset:27648
  v_mfma_f32_16x16x32_bf16 v[104:107], a[48:51], v[116:119], v[104:107]
  v_mfma_f32_16x16x32_bf16 v[108:111], a[128:131], v[116:119], v[108:111]
  v_mfma_f32_16x16x32_bf16 v[112:115], a[208:211], v[116:119], v[112:115]
  buffer_load_dwordx4 v144, s[8:11], s31 offen offset:2048 sc1 lds
  s_waitcnt lgkmcnt(2)
  v_mfma_f32_16x16x32_bf16 v[100:103], v[228:231], v[120:123], v[100:103]
  ds_read_b128 v[116:119], v159 offset:28672
  v_mfma_f32_16x16x32_bf16 v[104:107], a[52:55], v[120:123], v[104:107]
  v_mfma_f32_16x16x32_bf16 v[108:111], a[132:135], v[120:123], v[108:111]
  v_mfma_f32_16x16x32_bf16 v[112:115], a[212:215], v[120:123], v[112:115]
  buffer_load_dwordx4 v144, s[8:11], s31 offen offset:3072 sc1 lds
  s_waitcnt lgkmcnt(2)
  v_mfma_f32_16x16x32_bf16 v[100:103], v[232:235], v[124:127], v[100:103]
  ds_read_b128 v[120:123], v159 offset:29696
  v_mfma_f32_16x16x32_bf16 v[104:107], a[56:59], v[124:127], v[104:107]
  v_mfma_f32_16x16x32_bf16 v[108:111], a[136:139], v[124:127], v[108:111]
  v_mfma_f32_16x16x32_bf16 v[112:115], a[216:219], v[124:127], v[112:115]
  s_add_u32 m0, s44, 8192
  s_add_u32 s31, s43, 8192
  buffer_load_dwordx4 v144, s[8:11], s31 offen offset:0 sc1 lds
  s_waitcnt lgkmcnt(2)
  v_mfma_f32_16x16x32_bf16 v[100:103], v[236:239], v[128:131], v[100:103]
  ds_read_b128 v[124:127], v159 offset:30720
  v_mfma_f32_16x16x32_bf16 v[104:107], a[60:63], v[128:131], v[104:107]
  v_mfma_f32_16x16x32_bf16 v[108:111], a[140:143], v[128:131], v[108:111]
  v_mfma_f32_16x16x32_bf16 v[112:115], a[220:223], v[128:131], v[112:115]
  buffer_load_dwordx4 v144, s[8:11], s31 offen offset:1024 sc1 lds
  s_waitcnt lgkmcnt(2)
  v_mfma_f32_16x16x32_bf16 v[100:103], v[240:243], v[116:119], v[100:103]
  ds_read_b128 v[128:131], v159 offset:31744
  v_mfma_f32_16x16x32_bf16 v[104:107], a[64:67], v[116:119], v[104:107]
  v_mfma_f32_16x16x32_bf16 v[108:111], a[144:147], v[116:119], v[108:111]
  v_mfma_f32_16x16x32_bf16 v[112:115], a[224:227], v[116:119], v[112:115]
  buffer_load_dword v158, v189, s[8:11], s33 offen sc1
  s_waitcnt lgkmcnt(2)
  v_mfma_f32_16x16x32_bf16 v[100:103], v[244:247], v[120:123], v[100:103]
  ds_read_b128 v[116:119], v159 offset:32768
  v_mfma_f32_16x16x32_bf16 v[104:107], a[68:71], v[120:123], v[104:107]
  v_mfma_f32_16x16x32_bf16 v[108:111], a[148:151], v[120:123], v[108:111]
  v_mfma_f32_16x16x32_bf16 v[112:115], a[228:231], v[120:123], v[112:115]
  s_waitcnt lgkmcnt(2)
  v_mfma_f32_16x16x32_bf16 v[100:103], v[248:251], v[124:127], v[100:103]
  ds_read_b128 v[120:123], v159 offset:33792
  v_mfma_f32_16x16x32_bf16 v[104:107], a[72:75], v[124:127], v[104:107]
  v_mfma_f32_16x16x32_bf16 v[108:111], a[152:155], v[124:127], v[108:111]
  v_mfma_f32_16x16x32_bf16 v[112:115], a[232:235], v[124:127], v[112:115]
  s_waitcnt lgkmcnt(2)
  v_mfma_f32_16x16x32_bf16 v[100:103], v[252:255], v[128:131], v[100:103]
  ds_read_b128 v[124:127], v159 offset:34816
  v_mfma_f32_16x16x32_bf16 v[104:107], a[76:79], v[128:131], v[104:107]
  v_mfma_f32_16x16x32_bf16 v[108:111], a[156:159], v[128:131], v[108:111]
  v_mfma_f32_16x16x32_bf16 v[112:115], a[236:239], v[128:131], v[112:115]
  s_waitcnt lgkmcnt(2)
  v_mfma_f32_16x16x32_bf16 v[100:103], a[0:3], v[116:119], v[100:103]
  ds_read_b128 v[128:131], v159 offset:35840
  v_mfma_f32_16x16x32_bf16 v[104:107], a[80:83], v[116:119], v[104:107]
  v_mfma_f32_16x16x32_bf16 v[108:111], a[160:163], v[116:119], v[108:111]
  v_mfma_f32_16x16x32_bf16 v[112:115], a[240:243], v[116:119], v[112:115]
  s_waitcnt lgkmcnt(2)
  v_mfma_f32_16x16x32_bf16 v[100:103], a[4:7], v[120:123], v[100:103]
  v_mfma_f32_16x16x32_bf16 v[104:107], a[84:87], v[120:123], v[104:107]
  v_mfma_f32_16x16x32_bf16 v[108:111], a[164:167], v[120:123], v[108:111]
  v_mfma_f32_16x16x32_bf16 v[112:115], a[244:247], v[120:123], v[112:115]
  s_waitcnt lgkmcnt(1)
  v_mfma_f32_16x16x32_bf16 v[100:103], a[8:11], v[124:127], v[100:103]
  v_mfma_f32_16x16x32_bf16 v[104:107], a[88:91], v[124:127], v[104:107]
  v_mfma_f32_16x16x32_bf16 v[108:111], a[168:171], v[124:127], v[108:111]
  v_mfma_f32_16x16x32_bf16 v[112:115], a[248:251], v[124:127], v[112:115]
  s_waitcnt lgkmcnt(0)
  v_mfma_f32_16x16x32_bf16 v[100:103], a[12:15], v[128:131], v[100:103]
  v_mfma_f32_16x16x32_bf16 v[104:107], a[92:95], v[128:131], v[104:107]
  v_mfma_f32_16x16x32_bf16 v[108:111], a[172:175], v[128:131], v[108:111]
  v_mfma_f32_16x16x32_bf16 v[112:115], a[252:255], v[128:131], v[112:115]
  s_xor_b32 s44, s44, 0x10000
  v_xor_b32 v159, 0x10000, v159
  s_cmp_lt_u32 s29, 63
  s_cselect_b32 s31, 40960, 0
  s_add_u32 s43, s43, s31
  s_mul_i32 s31, s16, 2621440
  s_cmp_eq_u32 s29, 11
  s_cselect_b32 s31, s31, 0
  s_sub_u32 s43, s43, s31
  v_mov_b32 v169, s29
  v_cvt_pk_bf16_f32 v132, v100, v101
  v_cvt_pk_bf16_f32 v133, v102, v103
  v_cvt_pk_bf16_f32 v134, v104, v105
  v_cvt_pk_bf16_f32 v135, v106, v107
  buffer_store_dwordx4 v[132:135], v144, s[8:11], s42 offen
  s_add_u32 s42, s42, s50
  ds_write_b128 v162, v[132:135]
  v_cvt_pk_bf16_f32 v136, v108, v109
  v_cvt_pk_bf16_f32 v137, v110, v111
  v_cvt_pk_bf16_f32 v138, v112, v113
  v_cvt_pk_bf16_f32 v139, v114, v115
  buffer_store_dwordx4 v[136:139], v144, s[8:11], s42 offen
  s_add_u32 s42, s42, s50
  ds_write_b128 v176, v[136:139]
  s_cmp_gt_u32 s29, 1
  s_cbranch_scc1 b_step13
  s_waitcnt vmcnt(0) lgkmcnt(0)
  buffer_store_dword v169, v154, s[8:11], 0 offen
  s_cmp_eq_u32 s29, 2
  s_barrier
  s_cbranch_scc1 b_top1
  s_mov_b32 s33, 4096
  s_mov_b32 s30, 0
pw_42:
  buffer_load_dword v166, v157, s[8:11], s33 offen sc1
  s_add_u32 s30, s30, 1
  s_cmp_gt_u32 s30, 65536
  s_cbranch_scc1 role_abort
  s_waitcnt vmcnt(0)
pc_44:
  v_cmp_gt_u32 vcc, 1, v166
  s_nop 0
  s_and_b32 vcc_lo, vcc_lo, 0x10000000
  s_and_b32 vcc_hi, vcc_hi, 0x0
  s_cmp_eq_u64 vcc, 0
  s_cbranch_scc1 po_43
  s_sleep 2
  s_branch pw_42
po_43:
  v_readlane_b32 s31, v166, 28
  s_nop 0
  s_lshl_b32 s31, s31, 13
  s_add_u32 s56, s56, s31
  s_branch b_step12
b_step10:
  s_sleep 24
b_step13:
  s_waitcnt vmcnt(2) lgkmcnt(0)
  s_barrier
  ds_write_b128 v144, v[72:75] offset:10240
  ds_write_b128 v144, v[72:75] offset:11264
b_step1S:
  s_sleep 6
b_step12:
  s_and_b32 s31, s28, 3
  s_mul_i32 s36, s31, 81920
  s_add_u32 s36, s36, s35
  s_lshl_b32 s32, s31, 15
  s_add_u32 s38, s37, s32
  s_add_u32 s28, s28, 1
  v_mov_b32 v170, s28
  v_mov_b32 v60, 0
  v_mov_b32 v61, 0
  v_mov_b32 v62, 0
  v_mov_b32 v63, 0
  v_mov_b32 v64, 0
  v_mov_b32 v65, 0
  v_mov_b32 v66, 0
  v_mov_b32 v67, 0
b_step1P:
  s_mov_b32 s30, 0
  buffer_load_dwordx4 v[76:79], v147, s[8:11], s36 offen sc1
  buffer_load_dwordx4 v[80:83], v147, s[8:11], s36 offen offset:1024 sc1
  buffer_load_dword v84, v148, s[8:11], s36 offen sc1
  buffer_load_dword v85, v148, s[8:11], s36 offen offset:256 sc1
  s_nop 15
  s_nop 15
mq_45:
  buffer_load_dwordx4 v[88:91], v147, s[8:11], s36 offen sc1
  buffer_load_dwordx4 v[92:95], v147, s[8:11], s36 offen offset:1024 sc1
  buffer_load_dword v96, v148, s[8:11], s36 offen sc1
  buffer_load_dword v97, v148, s[8:11], s36 offen offset:256 sc1
  s_add_u32 s30, s30, 1
  s_cmp_gt_u32 s30, 65536
  s_cbranch_scc1 chain_abort
  s_waitcnt vmcnt(4)
  buffer_store_dword v169, v154, s[8:11], 0 offen
  v_max3_u32 v167, v76, v80, v84
  v_max_u32 v167, v167, v85
  v_cmp_eq_u32 vcc, -1, v167
  ds_write_b128 v147, v[76:79]
  ds_write_b128 v147, v[80:83] offset:1024
  ds_write2st64_b32 v148, v84, v85 offset0:0 offset1:1
  s_cbranch_vccz mq_45_ok
  buffer_load_dwordx4 v[76:79], v147, s[8:11], s36 offen sc1
  buffer_load_dwordx4 v[80:83], v147, s[8:11], s36 offen offset:1024 sc1
  buffer_load_dword v84, v148, s[8:11], s36 offen sc1
  buffer_load_dword v85, v148, s[8:11], s36 offen offset:256 sc1
  s_waitcnt vmcnt(5)
  v_max3_u32 v167, v88, v92, v96
  v_max_u32 v167, v167, v97
  v_cmp_eq_u32 vcc, -1, v167
  ds_write_b128 v147, v[88:91]
  ds_write_b128 v147, v[92:95] offset:1024
  ds_write2st64_b32 v148, v96, v97 offset0:0 offset1:1
  s_cbranch_vccz mq_45_ok
  s_branch mq_45
.p2align 7
mq_45_ok:
  s_waitcnt lgkmcnt(0)
  s_barrier
  ds_read_b128 v[4:7], v144 offset:0
  ds_read_b128 v[8:11], v144 offset:1024
  ds_read_b128 v[12:15], v144 offset:2048
  ds_read_b128 v[16:19], v144 offset:3072
  ds_read_b128 v[20:23], v144 offset:4096
  ds_read_b128 v[24:27], v144 offset:5120
  ds_read_b128 v[28:31], v144 offset:6144
  ds_read_b128 v[32:35], v144 offset:7168
  ds_read_b128 v[36:39], v144 offset:8192
  ds_read_b128 v[40:43], v144 offset:9216
  s_waitcnt lgkmcnt(9)
  v_smfmac_f32_16x16x64_bf16 v[60:63], v[4:7], v[192:199], v151
  v_smfmac_f32_16x16x64_bf16 v[64:67], v[4:7], a[16:23], v151
  s_waitcnt lgkmcnt(8)
  v_smfmac_f32_16x16x64_bf16 v[60:63], v[8:11], v[200:207], v151
  v_smfmac_f32_16x16x64_bf16 v[64:67], v[8:11], a[24:31], v151
  s_waitcnt lgkmcnt(7)
  v_smfmac_f32_16x16x64_bf16 v[60:63], v[12:15], v[208:215], v151
  v_smfmac_f32_16x16x64_bf16 v[64:67], v[12:15], a[32:39], v151
  s_waitcnt lgkmcnt(6)
  v_smfmac_f32_16x16x64_bf16 v[60:63], v[16:19], v[216:223], v151
  v_smfmac_f32_16x16x64_bf16 v[64:67], v[16:19], a[40:47], v151
  s_waitcnt lgkmcnt(5)
  v_smfmac_f32_16x16x64_bf16 v[60:63], v[20:23], v[224:231], v151
  v_smfmac_f32_16x16x64_bf16 v[64:67], v[20:23], a[48:55], v151
  s_waitcnt lgkmcnt(4)
  v_smfmac_f32_16x16x64_bf16 v[60:63], v[24:27], v[232:239], v151
  v_smfmac_f32_16x16x64_bf16 v[64:67], v[24:27], a[56:63], v151
  s_waitcnt lgkmcnt(3)
  v_smfmac_f32_16x16x64_bf16 v[60:63], v[28:31], v[240:247], v151
  v_smfmac_f32_16x16x64_bf16 v[64:67], v[28:31], a[64:71], v151
  s_waitcnt lgkmcnt(2)
  v_smfmac_f32_16x16x64_bf16 v[60:63], v[32:35], v[248:255], v151
  s_waitcnt lgkmcnt(1)
  v_smfmac_f32_16x16x64_bf16 v[60:63], v[36:39], a[0:7], v151
  s_waitcnt lgkmcnt(0)
  v_smfmac_f32_16x16x64_bf16 v[60:63], v[40:43], a[8:15], v151
  s_nop 2
  v_smfmac_f32_16x16x64_bf16 v[64:67], v[32:35], a[72:79], v151
  s_nop 2
  v_smfmac_f32_16x16x64_bf16 v[64:67], v[36:39], a[80:87], v151
  v_add_f32 v60, v60, v62
  v_add_f32 v61, v61, v63
  v_cvt_pk_bf16_f32 v140, v60, v61
  ds_write2_b32 v149, v140, v140 offset0:0 offset1:1
  v_smfmac_f32_16x16x64_bf16 v[64:67], v[40:43], a[88:95], v151
  s_nop 7
  v_add_f32 v64, v64, v66
  v_add_f32 v65, v65, v67
  v_cvt_pk_bf16_f32 v141, v64, v65
  ds_write2_b32 v149, v141, v141 offset0:128 offset1:129
  s_mov_b32 s30, 0
  s_nop 5
sx_46:
  ds_read_b64_tr_b16 v[52:53], v145 offset:10240
  ds_read_b64_tr_b16 v[54:55], v145 offset:10752
  ds_read_b64_tr_b16 v[44:45], v145 offset:12288
  ds_read_b64_tr_b16 v[46:47], v145 offset:12800
  ds_read_b64_tr_b16 v[56:57], v145 offset:11264
  ds_read_b64_tr_b16 v[58:59], v145 offset:11776
  ds_read_b64_tr_b16 v[48:49], v145 offset:13312
  ds_read_b64_tr_b16 v[50:51], v145 offset:13824
  s_waitcnt lgkmcnt(4)
  v_mfma_f32_16x16x32_bf16 v[68:71], v[44:47], v[52:55], 0
  s_waitcnt lgkmcnt(0)
  v_mfma_f32_16x16x32_bf16 v[68:71], v[48:51], v[56:59], v[68:71]
  s_nop 7
  v_cmp_u_f32 vcc, v68, v69
  v_cndmask_b32 v167, v68, v69, s[54:55]
  s_cbranch_vccnz sx_46_r
  buffer_store_dword v167, v146, s[8:11], s38 offen
  s_add_u32 s31, s28, 2
  s_and_b32 s31, s31, 3
  s_cmp_eq_u32 s28, 64
  s_cbranch_scc1 b_end
  s_mul_i32 s31, s31, 81920
  s_add_u32 s31, s31, s46
  buffer_store_dwordx4 v[72:75], v144, s[8:11], s31 offen
  s_branch b_top1
sx_46_r:
  s_mov_b64 exec, -1
  s_add_u32 s30, s30, 1
  s_cmp_gt_u32 s30, 65536
  s_cbranch_scc1 chain_abort
  s_branch sx_46
b_pro2:
  ds_write_b128 v144, v[72:75] offset:12288
  ds_write_b128 v144, v[72:75] offset:13312
.p2align 7
b_top2:
  s_cmp_ge_u32 s29, 64
  s_cbranch_scc1 b_step20
  ds_read_b128 v[116:119], v159 offset:16384
  ds_read_b128 v[120:123], v159 offset:17408
  ds_read_b128 v[124:127], v159 offset:18432
  s_and_b32 s31, s29, 3
  s_mul_i32 s31, s31, 147456
  s_add_u32 s42, s41, s31
  s_add_u32 s42, s42, s51
  s_add_u32 s49, s29, 2
  s_lshl_b32 s48, s49, 1
  s_min_u32 s48, s48, 128
  s_and_b32 s31, s29, 3
  s_lshl_b32 s31, s31, 12
  v_add_u32 v162, s31, v160
  v_xor_b32 v176, 1024, v162
  s_add_u32 s29, s29, 1
  s_mov_b32 s33, 4096
  s_max_u32 s31, s29, 4
  s_sub_u32 s31, s31, 4
  v_mov_b32 v190, s31
  v_mov_b32 v167, s48
  v_cndmask_b32 v190, v190, v167, s[74:75]
  s_waitcnt lgkmcnt(2)
  v_mfma_f32_16x16x32_bf16 v[100:103], v[192:195], v[116:119], 0
  ds_read_b128 v[128:131], v159 offset:19456
  v_mfma_f32_16x16x32_bf16 v[104:107], a[16:19], v[116:119], 0
  v_mfma_f32_16x16x32_bf16 v[108:111], a[96:99], v[116:119], 0
  v_mfma_f32_16x16x32_bf16 v[112:115], a[176:179], v[116:119], 0
  s_waitcnt lgkmcnt(2)
  v_mfma_f32_16x16x32_bf16 v[100:103], v[196:199], v[120:123], v[100:103]
  ds_read_b128 v[116:119], v159 offset:20480
  v_mfma_f32_16x16x32_bf16 v[104:107], a[20:23], v[120:123], v[104:107]
  v_mfma_f32_16x16x32_bf16 v[108:111], a[100:103], v[120:123], v[108:111]
  v_mfma_f32_16x16x32_bf16 v[112:115], a[180:183], v[120:123], v[112:115]
  s_waitcnt lgkmcnt(2)
  v_mfma_f32_16x16x32_bf16 v[100:103], v[200:203], v[124:127], v[100:103]
  ds_read_b128 v[120:123], v159 offset:21504
  v_mfma_f32_16x16x32_bf16 v[104:107], a[24:27], v[124:127], v[104:107]
  v_mfma_f32_16x16x32_bf16 v[108:111], a[104:107], v[124:127], v[108:111]
  v_mfma_f32_16x16x32_bf16 v[112:115], a[184:187], v[124:127], v[112:115]
  s_waitcnt lgkmcnt(2)
  v_mfma_f32_16x16x32_bf16 v[100:103], v[204:207], v[128:131], v[100:103]
  ds_read_b128 v[124:127], v159 offset:22528
  v_mfma_f32_16x16x32_bf16 v[104:107], a[28:31], v[128:131], v[104:107]
  v_mfma_f32_16x16x32_bf16 v[108:111], a[108:111], v[128:131], v[108:111]
  v_mfma_f32_16x16x32_bf16 v[112:115], a[188:191], v[128:131], v[112:115]
  s_waitcnt lgkmcnt(2)
  v_mfma_f32_16x16x32_bf16 v[100:103], v[208:211], v[116:119], v[100:103]
  ds_read_b128 v[128:131], v159 offset:23552
  v_mfma_f32_16x16x32_bf16 v[104:107], a[32:35], v[116:119], v[104:107]
  v_mfma_f32_16x16x32_bf16 v[108:111], a[112:115], v[116:119], v[108:111]
  v_mfma_f32_16x16x32_bf16 v[112:115], a[192:195], v[116:119], v[112:115]
  s_waitcnt lgkmcnt(2)
  v_mfma_f32_16x16x32_bf16 v[100:103], v[212:215], v[120:123], v[100:103]
  ds_read_b128 v[116:119], v159 offset:24576
  v_mfma_f32_16x16x32_bf16 v[104:107], a[36:39], v[120:123], v[104:107]
  s_waitcnt vmcnt(0)
  buffer_store_dword v170, v155, s[8:11], 0 offen
  v_mfma_f32_16x16x32_bf16 v[108:111], a[116:119], v[120:123], v[108:111]
  v_mfma_f32_16x16x32_bf16 v[112:115], a[196:199], v[120:123], v[112:115]
  s_mov_b32 s30, 0
  s_branch pc_49
pw_47:
  buffer_load_dword v158, v189, s[8:11], s33 offen sc1
  s_add_u32 s30, s30, 1
  s_cmp_gt_u32 s30, 65536
  s_cbranch_scc1 role_abort
  s_waitcnt vmcnt(0)
pc_49:
  v_cmp_gt_u32 vcc, v190, v158
  s_nop 0
  s_and_b32 vcc_lo, vcc_lo, 0xf000fff
  s_and_b32 vcc_hi, vcc_hi, 0x0
  s_cmp_eq_u64 vcc, 0
  s_cbranch_scc1 po_48
  s_sleep 4
  s_branch pw_47
po_48:
  s_waitcnt lgkmcnt(2)
  v_mfma_f32_16x16x32_bf16 v[100:103], v[216:219], v[124:127], v[100:103]
  ds_read_b128 v[120:123], v159 offset:25600
  v_mfma_f32_16x16x32_bf16 v[104:107], a[40:43], v[124:127], v[104:107]
  s_add_u32 m0, s44, 0
  s_add_u32 s31, s43, 0
  buffer_load_dwordx4 v144, s[8:11], s31 offen offset:0 sc1 lds
  v_mfma_f32_16x16x32_bf16 v[108:111], a[120:123], v[124:127], v[108:111]
  v_mfma_f32_16x16x32_bf16 v[112:115], a[200:203], v[124:127], v[112:115]
  s_waitcnt lgkmcnt(2)
  v_mfma_f32_16x16x32_bf16 v[100:103], v[220:223], v[128:131], v[100:103]
  ds_read_b128 v[124:127], v159 offset:26624
  v_mfma_f32_16x16x32_bf16 v[104:107], a[44:47], v[128:131], v[104:107]
  buffer_load_dwordx4 v144, s[8:11], s31 offen offset:1024 sc1 lds
  v_mfma_f32_16x16x32_bf16 v[108:111], a[124:127], v[128:131], v[108:111]
  v_mfma_f32_16x16x32_bf16 v[112:115], a[204:207], v[128:131], v[112:115]
  s_waitcnt lgkmcnt(2)
  v_mfma_f32_16x16x32_bf16 v[100:103], v[224:227], v[116:119], v[100:103]
  ds_read_b128 v[128:131], v159 offset:27648
  v_mfma_f32_16x16x32_bf16 v[104:107], a[48:51], v[116:119], v[104:107]
  buffer_load_dwordx4 v144, s[8:11], s31 offen offset:2048 sc1 lds
  v_mfma_f32_16x16x32_bf16 v[108:111], a[128:131], v[116:119], v[108:111]
  v_mfma_f32_16x16x32_bf16 v[112:115], a[208:211], v[116:119], v[112:115]
  s_waitcnt lgkmcnt(2)
  v_mfma_f32_16x16x32_bf16 v[100:103], v[228:231], v[120:123], v[100:103]
  ds_read_b128 v[116:119], v159 offset:28672
  v_mfma_f32_16x16x32_bf16 v[104:107], a[52:55], v[120:123], v[104:107]
  buffer_load_dwordx4 v144, s[8:11], s31 offen offset:3072 sc1 lds
  v_mfma_f32_16x16x32_bf16 v[108:111], a[132:135], v[120:123], v[108:111]
  v_mfma_f32_16x16x32_bf16 v[112:115], a[212:215], v[120:123], v[112:115]
  s_waitcnt lgkmcnt(2)
  v_mfma_f32_16x16x32_bf16 v[100:103], v[232:235], v[124:127], v[100:103]
  ds_read_b128 v[120:123], v159 offset:29696
  v_mfma_f32_16x16x32_bf16 v[104:107], a[56:59], v[124:127], v[104:107]
  s_add_u32 m0, s44, 4096
  s_add_u32 s31, s43, 4096
  buffer_load_dwordx4 v144, s[8:11], s31 offen offset:0 sc1 lds
  v_mfma_f32_16x16x32_bf16 v[108:111], a[136:139], v[124:127], v[108:111]
  v_mfma_f32_16x16x32_bf16 v[112:115], a[216:219], v[124:127], v[112:115]
  s_waitcnt lgkmcnt(2)
  v_mfma_f32_16x16x32_bf16 v[100:103], v[236:239], v[128:131], v[100:103]
  ds_read_b128 v[124:127], v159 offset:30720
  v_mfma_f32_16x16x32_bf16 v[104:107], a[60:63], v[128:131], v[104:107]
  buffer_load_dwordx4 v144, s[8:11], s31 offen offset:1024 sc1 lds
  v_mfma_f32_16x16x32_bf16 v[108:111], a[140:143], v[128:131], v[108:111]
  v_mfma_f32_16x16x32_bf16 v[112:115], a[220:223], v[128:131], v[112:115]
  s_waitcnt lgkmcnt(2)
  v_mfma_f32_16x16x32_bf16 v[100:103], v[240:243], v[116:119], v[100:103]
  ds_read_b128 v[128:131], v159 offset:31744
  v_mfma_f32_16x16x32_bf16 v[104:107], a[64:67], v[116:119], v[104:107]
  buffer_load_dwordx4 v144, s[8:11], s31 offen offset:2048 sc1 lds
  v_mfma_f32_16x16x32_bf16 v[108:111], a[144:147], v[116:119], v[108:111]
  v_mfma_f32_16x16x32_bf16 v[112:115], a[224:227], v[116:119], v[112:115]
  s_waitcnt lgkmcnt(2)
  v_mfma_f32_16x16x32_bf16 v[100:103], v[244:247], v[120:123], v[100:103]
  ds_read_b128 v[116:119], v159 offset:32768
  v_mfma_f32_16x16x32_bf16 v[104:107], a[68:71], v[120:123], v[104:107]
  buffer_load_dwordx4 v144, s[8:11], s31 offen offset:3072 sc1 lds
  v_mfma_f32_16x16x32_bf16 v[108:111], a[148:151], v[120:123], v[108:111]
  v_mfma_f32_16x16x32_bf16 v[112:115], a[228:231], v[120:123], v[112:115]
  s_waitcnt lgkmcnt(2)
  v_mfma_f32_16x16x32_bf16 v[100:103], v[248:251], v[124:127], v[100:103]
  ds_read_b128 v[120:123], v159 offset:33792
  v_mfma_f32_16x16x32_bf16 v[104:107], a[72:75], v[124:127], v[104:107]
  s_add_u32 m0, s44, 8192
  s_add_u32 s31, s43, 8192
  buffer_load_dwordx4 v144, s[8:11], s31 offen offset:0 sc1 lds
  v_mfma_f32_16x16x32_bf16 v[108:111], a[152:155], v[124:127], v[108:111]
  v_mfma_f32_16x16x32_bf16 v[112:115], a[232:235], v[124:127], v[112:115]
  s_waitcnt lgkmcnt(2)
  v_mfma_f32_16x16x32_bf16 v[100:103], v[252:255], v[128:131], v[100:103]
  ds_read_b128 v[124:127], v159 offset:34816
  v_mfma_f32_16x16x32_bf16 v[104:107], a[76:79], v[128:131], v[104:107]
  buffer_load_dwordx4 v144, s[8:11], s31 offen offset:1024 sc1 lds
  v_mfma_f32_16x16x32_bf16 v[108:111], a[156:159], v[128:131], v[108:111]
  v_mfma_f32_16x16x32_bf16 v[112:115], a[236:239], v[128:131], v[112:115]
  s_waitcnt lgkmcnt(2)
  v_mfma_f32_16x16x32_bf16 v[100:103], a[0:3], v[116:119], v[100:103]
  ds_read_b128 v[128:131], v159 offset:35840
  v_mfma_f32_16x16x32_bf16 v[104:107], a[80:83], v[116:119], v[104:107]
  buffer_load_dword v158, v189, s[8:11], s33 offen sc1
  v_mfma_f32_16x16x32_bf16 v[108:111], a[160:163], v[116:119], v[108:111]
  v_mfma_f32_16x16x32_bf16 v[112:115], a[240:243], v[116:119], v[112:115]
  s_waitcnt lgkmcnt(2)
  v_mfma_f32_16x16x32_bf16 v[100:103], a[4:7], v[120:123], v[100:103]
  v_mfma_f32_16x16x32_bf16 v[104:107], a[84:87], v[120:123], v[104:107]
  v_mfma_f32_16x16x32_bf16 v[108:111], a[164:167], v[120:123], v[108:111]
  v_mfma_f32_16x16x32_bf16 v[112:115], a[244:247], v[120:123], v[112:115]
  s_waitcnt lgkmcnt(1)
  v_mfma_f32_16x16x32_bf16 v[100:103], a[8:11], v[124:127], v[100:103]
  v_mfma_f32_16x16x32_bf16 v[104:107], a[88:91], v[124:127], v[104:107]
  v_mfma_f32_16x16x32_bf16 v[108:111], a[168:171], v[124:127], v[108:111]
  v_mfma_f32_16x16x32_bf16 v[112:115], a[248:251], v[124:127], v[112:115]
  s_waitcnt lgkmcnt(0)
  v_mfma_f32_16x16x32_bf16 v[100:103], a[12:15], v[128:131], v[100:103]
  v_mfma_f32_16x16x32_bf16 v[104:107], a[92:95], v[128:131], v[104:107]
  v_mfma_f32_16x16x32_bf16 v[108:111], a[172:175], v[128:131], v[108:111]
  v_mfma_f32_16x16x32_bf16 v[112:115], a[252:255], v[128:131], v[112:115]
  s_xor_b32 s44, s44, 0x10000
  v_xor_b32 v159, 0x10000, v159
  s_cmp_lt_u32 s29, 63
  s_cselect_b32 s31, 40960, 0
  s_add_u32 s43, s43, s31
  s_mul_i32 s31, s16, 2621440
  s_cmp_eq_u32 s29, 11
  s_cselect_b32 s31, s31, 0
  s_sub_u32 s43, s43, s31
  v_mov_b32 v169, s29
  v_cvt_pk_bf16_f32 v132, v100, v101
  v_cvt_pk_bf16_f32 v133, v102, v103
  v_cvt_pk_bf16_f32 v134, v104, v105
  v_cvt_pk_bf16_f32 v135, v106, v107
  buffer_store_dwordx4 v[132:135], v144, s[8:11], s42 offen
  s_add_u32 s42, s42, s50
  ds_write_b128 v162, v[132:135]
  v_cvt_pk_bf16_f32 v136, v108, v109
  v_cvt_pk_bf16_f32 v137, v110, v111
  v_cvt_pk_bf16_f32 v138, v112, v113
  v_cvt_pk_bf16_f32 v139, v114, v115
  buffer_store_dwordx4 v[136:139], v144, s[8:11], s42 offen
  s_add_u32 s42, s42, s50
  ds_write_b128 v176, v[136:139]
  s_cmp_gt_u32 s29, 1
  s_cbranch_scc1 b_step23
  s_waitcnt vmcnt(0) lgkmcnt(0)
  buffer_store_dword v169, v154, s[8:11], 0 offen
  s_cmp_eq_u32 s29, 2
  s_barrier
  s_cbranch_scc1 b_top2
  s_mov_b32 s33, 4096
  s_mov_b32 s30, 0
pw_50:
  buffer_load_dword v166, v157, s[8:11], s33 offen sc1
  s_add_u32 s30, s30, 1
  s_cmp_gt_u32 s30, 65536
  s_cbranch_scc1 role_abort
  s_waitcnt vmcnt(0)
pc_52:
  v_cmp_gt_u32 vcc, 1, v166
  s_nop 0
  s_and_b32 vcc_lo, vcc_lo, 0x10000000
  s_and_b32 vcc_hi, vcc_hi, 0x0
  s_cmp_eq_u64 vcc, 0
  s_cbranch_scc1 po_51
  s_sleep 2
  s_branch pw_50
po_51:
  v_readlane_b32 s31, v166, 28
  s_nop 0
  s_lshl_b32 s31, s31, 13
  s_add_u32 s56, s56, s31
  s_branch b_step22
b_step20:
  s_waitcnt vmcnt(0)
  buffer_store_dword v170, v155, s[8:11], 0 offen
  s_sleep 24
b_step23:
  s_waitcnt vmcnt(2) lgkmcnt(0)
  s_barrier
  ds_write_b128 v144, v[72:75] offset:12288
  ds_write_b128 v144, v[72:75] offset:13312
b_step2S:
  s_sleep 6
b_step22:
  s_and_b32 s31, s28, 3
  s_mul_i32 s36, s31, 81920
  s_add_u32 s36, s36, s35
  s_lshl_b32 s32, s31, 15
  s_add_u32 s38, s37, s32
  s_add_u32 s28, s28, 1
  v_mov_b32 v170, s28
  s_mul_i32 s40, s31, 24576
  s_add_u32 s40, s40, s39
  v_mov_b32 v60, 0
  v_mov_b32 v61, 0
  v_mov_b32 v62, 0
  v_mov_b32 v63, 0
  v_mov_b32 v64, 0
  v_mov_b32 v65, 0
  v_mov_b32 v66, 0
  v_mov_b32 v67, 0
b_step2P:
  s_mov_b32 s30, 0
  buffer_load_dwordx4 v[76:79], v147, s[8:11], s36 offen sc1
  buffer_load_dwordx4 v[80:83], v147, s[8:11], s36 offen offset:1024 sc1
  buffer_load_dword v84, v148, s[8:11], s36 offen sc1
  buffer_load_dword v85, v148, s[8:11], s36 offen offset:256 sc1
  s_nop 15
  s_nop 15
mq_53:
  buffer_load_dwordx4 v[88:91], v147, s[8:11], s36 offen sc1
  buffer_load_dwordx4 v[92:95], v147, s[8:11], s36 offen offset:1024 sc1
  buffer_load_dword v96, v148, s[8:11], s36 offen sc1
  buffer_load_dword v97, v148, s[8:11], s36 offen offset:256 sc1
  s_add_u32 s30, s30, 1
  s_cmp_gt_u32 s30, 65536
  s_cbranch_scc1 chain_abort
  s_waitcnt vmcnt(4)
  buffer_store_dword v169, v154, s[8:11], 0 offen
  v_max3_u32 v167, v76, v80, v84
  v_max_u32 v167, v167, v85
  v_cmp_eq_u32 vcc, -1, v167
  ds_write_b128 v147, v[76:79]
  ds_write_b128 v147, v[80:83] offset:1024
  ds_write2st64_b32 v148, v84, v85 offset0:0 offset1:1
  s_cbranch_vccz mq_53_ok
  buffer_load_dwordx4 v[76:79], v147, s[8:11], s36 offen sc1
  buffer_load_dwordx4 v[80:83], v147, s[8:11], s36 offen offset:1024 sc1
  buffer_load_dword v84, v148, s[8:11], s36 offen sc1
  buffer_load_dword v85, v148, s[8:11], s36 offen offset:256 sc1
  s_waitcnt vmcnt(5)
  v_max3_u32 v167, v88, v92, v96
  v_max_u32 v167, v167, v97
  v_cmp_eq_u32 vcc, -1, v167
  ds_write_b128 v147, v[88:91]
  ds_write_b128 v147, v[92:95] offset:1024
  ds_write2st64_b32 v148, v96, v97 offset0:0 offset1:1
  s_cbranch_vccz mq_53_ok
  s_branch mq_53
.p2align 7
mq_53_ok:
  s_waitcnt lgkmcnt(0)
  s_barrier
  ds_read_b128 v[4:7], v144 offset:0
  ds_read_b128 v[8:11], v144 offset:1024
  ds_read_b128 v[12:15], v144 offset:2048
  ds_read_b128 v[16:19], v144 offset:3072
  ds_read_b128 v[20:23], v144 offset:4096
  ds_read_b128 v[24:27], v144 offset:5120
  ds_read_b128 v[28:31], v144 offset:6144
  ds_read_b128 v[32:35], v144 offset:7168
  ds_read_b128 v[36:39], v144 offset:8192
  ds_read_b128 v[40:43], v144 offset:9216
  s_waitcnt lgkmcnt(9)
  v_smfmac_f32_16x16x64_bf16 v[60:63], v[4:7], v[192:199], v151
  v_smfmac_f32_16x16x64_bf16 v[64:67], v[4:7], a[16:23], v151
  s_waitcnt lgkmcnt(8)
  v_smfmac_f32_16x16x64_bf16 v[60:63], v[8:11], v[200:207], v151
  v_smfmac_f32_16x16x64_bf16 v[64:67], v[8:11], a[24:31], v151
  s_waitcnt lgkmcnt(7)
  v_smfmac_f32_16x16x64_bf16 v[60:63], v[12:15], v[208:215], v151
  v_smfmac_f32_16x16x64_bf16 v[64:67], v[12:15], a[32:39], v151
  s_waitcnt lgkmcnt(6)
  v_smfmac_f32_16x16x64_bf16 v[60:63], v[16:19], v[216:223], v151
  buffer_store_dword v170, v156, s[8:11], 0 offen
  v_smfmac_f32_16x16x64_bf16 v[64:67], v[16:19], a[40:47], v151
  s_waitcnt lgkmcnt(5)
  v_smfmac_f32_16x16x64_bf16 v[60:63], v[20:23], v[224:231], v151
  v_smfmac_f32_16x16x64_bf16 v[64:67], v[20:23], a[48:55], v151
  s_waitcnt lgkmcnt(4)
  v_smfmac_f32_16x16x64_bf16 v[60:63], v[24:27], v[232:239], v151
  v_smfmac_f32_16x16x64_bf16 v[64:67], v[24:27], a[56:63], v151
  s_waitcnt lgkmcnt(3)
  v_smfmac_f32_16x16x64_bf16 v[60:63], v[28:31], v[240:247], v151
  v_smfmac_f32_16x16x64_bf16 v[64:67], v[28:31], a[64:71], v151
  s_waitcnt lgkmcnt(2)
  v_smfmac_f32_16x16x64_bf16 v[60:63], v[32:35], v[248:255], v151
  s_waitcnt lgkmcnt(1)
  v_smfmac_f32_16x16x64_bf16 v[60:63], v[36:39], a[0:7], v151
  s_waitcnt lgkmcnt(0)
  v_smfmac_f32_16x16x64_bf16 v[60:63], v[40:43], a[8:15], v151
  s_nop 2
  v_smfmac_f32_16x16x64_bf16 v[64:67], v[32:35], a[72:79], v151
  s_nop 2
  v_smfmac_f32_16x16x64_bf16 v[64:67], v[36:39], a[80:87], v151
  v_add_f32 v60, v60, v62
  v_add_f32 v61, v61, v63
  v_cvt_pk_bf16_f32 v140, v60, v61
  ds_write2_b32 v149, v140, v140 offset0:0 offset1:1
  v_smfmac_f32_16x16x64_bf16 v[64:67], v[40:43], a[88:95], v151
  s_nop 7
  v_add_f32 v64, v64, v66
  v_add_f32 v65, v65, v67
  v_cvt_pk_bf16_f32 v141, v64, v65
  ds_write2_b32 v149, v141, v141 offset0:128 offset1:129
  s_mov_b32 s30, 0
  s_nop 15
  s_nop 7
sx_54:
  ds_read_b64_tr_b16 v[44:45], v145 offset:12288
  ds_read_b64_tr_b16 v[46:47], v145 offset:12800
  ds_read_b64_tr_b16 v[48:49], v145 offset:13312
  ds_read_b64_tr_b16 v[50:51], v145 offset:13824
  s_waitcnt lgkmcnt(0)
  v_pk_max_u16 v167, v44, v45
  v_pk_max_u16 v168, v46, v47
  v_pk_max_u16 v167, v167, v48
  v_pk_max_u16 v168, v168, v49
  v_pk_max_u16 v167, v167, v50
  v_pk_max_u16 v168, v168, v51
  v_pk_max_u16 v167, v167, v168
  v_lshlrev_b32 v168, 16, v167
  v_max_u32 v167, v167, v168
  v_cmp_le_u32 vcc, 0xffff0000, v167
  s_cbranch_vccnz sx_54_r
  buffer_store_dwordx4 v[44:47], v153, s[8:11], s40 offen
  buffer_store_dwordx4 v[48:51], v153, s[8:11], s40 offen offset:512
  s_add_u32 s31, s28, 2
  s_and_b32 s31, s31, 3
  s_cmp_lg_u32 s28, 64
  s_cbranch_scc1 b_top2
  s_waitcnt vmcnt(0)
  buffer_store_dword v170, v155, s[8:11], 0 offen
  s_cmp_eq_u32 s28, 64
  s_cbranch_scc1 b_end
  s_branch b_top2
sx_54_r:
  s_add_u32 s30, s30, 1
  s_cmp_gt_u32 s30, 65536
  s_cbranch_scc1 chain_abort
  s_branch sx_54
b_pro3:
  s_lshl_b32 s31, s26, 9
  s_add_u32 s37, s37, s31
  s_add_u32 s37, s37, 4096
  s_cmp_lt_u32 s24, 20
  s_cselect_b32 s31, 0, 32768
  s_sub_u32 s47, s47, s31
  s_cmp_lt_u32 s24, 20
  s_cselect_b32 s46, 0, 0
.p2align 7
b_top3:
  s_add_u32 s31, s28, 3
  s_and_b32 s31, s31, 3
  s_mul_i32 s31, s31, 163840
  s_add_u32 s58, s56, s31
  s_add_u32 s59, s58, 16384
  s_add_u32 s60, s58, 32768
  s_cmp_ge_u32 s29, 64
  s_cbranch_scc1 b_step30
  ds_read_b128 v[116:119], v159 offset:16384
  ds_read_b128 v[120:123], v159 offset:17408
  ds_read_b128 v[124:127], v159 offset:18432
  s_and_b32 s31, s29, 3
  s_mul_i32 s31, s31, 147456
  s_add_u32 s42, s41, s31
  s_add_u32 s42, s42, s51
  s_add_u32 s49, s29, 2
  s_lshl_b32 s48, s49, 1
  s_min_u32 s48, s48, 128
  s_and_b32 s31, s29, 3
  s_lshl_b32 s31, s31, 12
  v_add_u32 v162, s31, v160
  v_xor_b32 v176, 1024, v162
  s_add_u32 s29, s29, 1
  s_mov_b32 s33, 4096
  s_max_u32 s31, s29, 4
  s_sub_u32 s31, s31, 4
  v_mov_b32 v190, s31
  v_mov_b32 v167, s48
  v_cndmask_b32 v190, v190, v167, s[74:75]
  s_waitcnt lgkmcnt(2)
  v_mfma_f32_16x16x32_bf16 v[100:103], v[192:195], v[116:119], 0
  ds_read_b128 v[128:131], v159 offset:19456
  v_mfma_f32_16x16x32_bf16 v[104:107], a[16:19], v[116:119], 0
  v_mfma_f32_16x16x32_bf16 v[108:111], a[96:99], v[116:119], 0
  v_mfma_f32_16x16x32_bf16 v[112:115], a[176:179], v[116:119], 0
  s_waitcnt lgkmcnt(2)
  v_mfma_f32_16x16x32_bf16 v[100:103], v[196:199], v[120:123], v[100:103]
  ds_read_b128 v[116:119], v159 offset:20480
  v_mfma_f32_16x16x32_bf16 v[104:107], a[20:23], v[120:123], v[104:107]
  v_mfma_f32_16x16x32_bf16 v[108:111], a[100:103], v[120:123], v[108:111]
  v_mfma_f32_16x16x32_bf16 v[112:115], a[180:183], v[120:123], v[112:115]
  s_waitcnt lgkmcnt(2)
  v_mfma_f32_16x16x32_bf16 v[100:103], v[200:203], v[124:127], v[100:103]
  ds_read_b128 v[120:123], v159 offset:21504
  v_mfma_f32_16x16x32_bf16 v[104:107], a[24:27], v[124:127], v[104:107]
  s_mov_b32 s30, 0
  s_branch pc_57
pw_55:
  buffer_load_dword v158, v189, s[8:11], s33 offen sc1
  s_add_u32 s30, s30, 1
  s_cmp_gt_u32 s30, 65536
  s_cbranch_scc1 role_abort
  s_waitcnt vmcnt(0)
pc_57:
  v_cmp_gt_u32 vcc, v190, v158
  s_nop 0
  s_and_b32 vcc_lo, vcc_lo, 0xf000fff
  s_and_b32 vcc_hi, vcc_hi, 0x0
  s_cmp_eq_u64 vcc, 0
  s_cbranch_scc1 po_56
  s_sleep 4
  s_branch pw_55
po_56:
  v_mfma_f32_16x16x32_bf16 v[108:111], a[104:107], v[124:127], v[108:111]
  v_mfma_f32_16x16x32_bf16 v[112:115], a[184:187], v[124:127], v[112:115]
  s_add_u32 m0, s44, 0
  s_add_u32 s31, s43, 0
  buffer_load_dwordx4 v144, s[8:11], s31 offen offset:0 sc1 lds
  s_waitcnt lgkmcnt(2)
  v_mfma_f32_16x16x32_bf16 v[100:103], v[204:207], v[128:131], v[100:103]
  ds_read_b128 v[124:127], v159 offset:22528
  v_mfma_f32_16x16x32_bf16 v[104:107], a[28:31], v[128:131], v[104:107]
  v_mfma_f32_16x16x32_bf16 v[108:111], a[108:111], v[128:131], v[108:111]
  v_mfma_f32_16x16x32_bf16 v[112:115], a[188:191], v[128:131], v[112:115]
  buffer_load_dwordx4 v144, s[8:11], s31 offen offset:1024 sc1 lds
  s_waitcnt lgkmcnt(2)
  v_mfma_f32_16x16x32_bf16 v[100:103], v[208:211], v[116:119], v[100:103]
  ds_read_b128 v[128:131], v159 offset:23552
  v_mfma_f32_16x16x32_bf16 v[104:107], a[32:35], v[116:119], v[104:107]
  v_mfma_f32_16x16x32_bf16 v[108:111], a[112:115], v[116:119], v[108:111]
  v_mfma_f32_16x16x32_bf16 v[112:115], a[192:195], v[116:119], v[112:115]
  buffer_load_dwordx4 v144, s[8:11], s31 offen offset:2048 sc1 lds
  s_waitcnt lgkmcnt(2)
  v_mfma_f32_16x16x32_bf16 v[100:103], v[212:215], v[120:123], v[100:103]
  ds_read_b128 v[116:119], v159 offset:24576
  v_mfma_f32_16x16x32_bf16 v[104:107], a[36:39], v[120:123], v[104:107]
  v_mfma_f32_16x16x32_bf16 v[108:111], a[116:119], v[120:123], v[108:111]
  v_mfma_f32_16x16x32_bf16 v[112:115], a[196:199], v[120:123], v[112:115]
  buffer_load_dwordx4 v144, s[8:11], s31 offen offset:3072 sc1 lds
  s_waitcnt lgkmcnt(2)
  v_mfma_f32_16x16x32_bf16 v[100:103], v[216:219], v[124:127], v[100:103]
  ds_read_b128 v[120:123], v159 offset:25600
  v_mfma_f32_16x16x32_bf16 v[104:107], a[40:43], v[124:127], v[104:107]
  v_mfma_f32_16x16x32_bf16 v[108:111], a[120:123], v[124:127], v[108:111]
  v_mfma_f32_16x16x32_bf16 v[112:115], a[200:203], v[124:127], v[112:115]
  s_add_u32 m0, s44, 4096
  s_add_u32 s31, s43, 4096
  buffer_load_dwordx4 v144, s[8:11], s31 offen offset:0 sc1 lds
  s_waitcnt lgkmcnt(2)
  v_mfma_f32_16x16x32_bf16 v[100:103], v[220:223], v[128:131], v[100:103]
  ds_read_b128 v[124:127], v159 offset:26624
  v_mfma_f32_16x16x32_bf16 v[104:107], a[44:47], v[128:131], v[104:107]
  v_mfma_f32_16x16x32_bf16 v[108:111], a[124:127], v[128:131], v[108:111]
  v_mfma_f32_16x16x32_bf16 v[112:115], a[204:207], v[128:131], v[112:115]
  buffer_load_dwordx4 v144, s[8:11], s31 offen offset:1024 sc1 lds
  s_waitcnt lgkmcnt(2)
  v_mfma_f32_16x16x32_bf16 v[100:103], v[224:227], v[116:119], v[100:103]
  ds_read_b128 v[128:131], v159 offset:27648
  v_mfma_f32_16x16x32_bf16 v[104:107], a[48:51], v[116:119], v[104:107]
  v_mfma_f32_16x16x32_bf16 v[108:111], a[128:131], v[116:119], v[108:111]
  v_mfma_f32_16x16x32_bf16 v[112:115], a[208:211], v[116:119], v[112:115]
  buffer_load_dwordx4 v144, s[8:11], s31 offen offset:2048 sc1 lds
  s_waitcnt lgkmcnt(2)
  v_mfma_f32_16x16x32_bf16 v[100:103], v[228:231], v[120:123], v[100:103]
  ds_read_b128 v[116:119], v159 offset:28672
  v_mfma_f32_16x16x32_bf16 v[104:107], a[52:55], v[120:123], v[104:107]
  v_mfma_f32_16x16x32_bf16 v[108:111], a[132:135], v[120:123], v[108:111]
  v_mfma_f32_16x16x32_bf16 v[112:115], a[212:215], v[120:123], v[112:115]
  buffer_load_dwordx4 v144, s[8:11], s31 offen offset:3072 sc1 lds
  s_waitcnt lgkmcnt(2)
  v_mfma_f32_16x16x32_bf16 v[100:103], v[232:235], v[124:127], v[100:103]
  ds_read_b128 v[120:123], v159 offset:29696
  v_mfma_f32_16x16x32_bf16 v[104:107], a[56:59], v[124:127], v[104:107]
  v_mfma_f32_16x16x32_bf16 v[108:111], a[136:139], v[124:127], v[108:111]
  v_mfma_f32_16x16x32_bf16 v[112:115], a[216:219], v[124:127], v[112:115]
  s_add_u32 m0, s44, 8192
  s_add_u32 s31, s43, 8192
  buffer_load_dwordx4 v144, s[8:11], s31 offen offset:0 sc1 lds
  s_waitcnt lgkmcnt(2)
  v_mfma_f32_16x16x32_bf16 v[100:103], v[236:239], v[128:131], v[100:103]
  ds_read_b128 v[124:127], v159 offset:30720
  v_mfma_f32_16x16x32_bf16 v[104:107], a[60:63], v[128:131], v[104:107]
  v_mfma_f32_16x16x32_bf16 v[108:111], a[140:143], v[128:131], v[108:111]
  v_mfma_f32_16x16x32_bf16 v[112:115], a[220:223], v[128:131], v[112:115]
  buffer_load_dwordx4 v144, s[8:11], s31 offen offset:1024 sc1 lds
  s_waitcnt lgkmcnt(2)
  v_mfma_f32_16x16x32_bf16 v[100:103], v[240:243], v[116:119], v[100:103]
  ds_read_b128 v[128:131], v159 offset:31744
  v_mfma_f32_16x16x32_bf16 v[104:107], a[64:67], v[116:119], v[104:107]
  v_mfma_f32_16x16x32_bf16 v[108:111], a[144:147], v[116:119], v[108:111]
  v_mfma_f32_16x16x32_bf16 v[112:115], a[224:227], v[116:119], v[112:115]
  buffer_load_dword v158, v189, s[8:11], s33 offen sc1
  s_waitcnt lgkmcnt(2)
  v_mfma_f32_16x16x32_bf16 v[100:103], v[244:247], v[120:123], v[100:103]
  ds_read_b128 v[116:119], v159 offset:32768
  v_mfma_f32_16x16x32_bf16 v[104:107], a[68:71], v[120:123], v[104:107]
  v_mfma_f32_16x16x32_bf16 v[108:111], a[148:151], v[120:123], v[108:111]
  v_mfma_f32_16x16x32_bf16 v[112:115], a[228:231], v[120:123], v[112:115]
  s_waitcnt lgkmcnt(2)
  v_mfma_f32_16x16x32_bf16 v[100:103], v[248:251], v[124:127], v[100:103]
  ds_read_b128 v[120:123], v159 offset:33792
  v_mfma_f32_16x16x32_bf16 v[104:107], a[72:75], v[124:127], v[104:107]
  v_mfma_f32_16x16x32_bf16 v[108:111], a[152:155], v[124:127], v[108:111]
  v_mfma_f32_16x16x32_bf16 v[112:115], a[232:235], v[124:127], v[112:115]
  s_waitcnt lgkmcnt(2)
  v_mfma_f32_16x16x32_bf16 v[100:103], v[252:255], v[128:131], v[100:103]
  ds_read_b128 v[124:127], v159 offset:34816
  v_mfma_f32_16x16x32_bf16 v[104:107], a[76:79], v[128:131], v[104:107]
  v_mfma_f32_16x16x32_bf16 v[108:111], a[156:159], v[128:131], v[108:111]
  v_mfma_f32_16x16x32_bf16 v[112:115], a[236:239], v[128:131], v[112:115]
  s_waitcnt lgkmcnt(2)
  v_mfma_f32_16x16x32_bf16 v[100:103], a[0:3], v[116:119], v[100:103]
  ds_read_b128 v[128:131], v159 offset:35840
  v_mfma_f32_16x16x32_bf16 v[104:107], a[80:83], v[116:119], v[104:107]
  v_mfma_f32_16x16x32_bf16 v[108:111], a[160:163], v[116:119], v[108:111]
  v_mfma_f32_16x16x32_bf16 v[112:115], a[240:243], v[116:119], v[112:115]
  s_waitcnt lgkmcnt(2)
  v_mfma_f32_16x16x32_bf16 v[100:103], a[4:7], v[120:123], v[100:103]
  v_mfma_f32_16x16x32_bf16 v[104:107], a[84:87], v[120:123], v[104:107]
  v_mfma_f32_16x16x32_bf16 v[108:111], a[164:167], v[120:123], v[108:111]
  v_mfma_f32_16x16x32_bf16 v[112:115], a[244:247], v[120:123], v[112:115]
  s_waitcnt lgkmcnt(1)
  v_mfma_f32_16x16x32_bf16 v[100:103], a[8:11], v[124:127], v[100:103]
  v_mfma_f32_16x16x32_bf16 v[104:107], a[88:91], v[124:127], v[104:107]
  v_mfma_f32_16x16x32_bf16 v[108:111], a[168:171], v[124:127], v[108:111]
  v_mfma_f32_16x16x32_bf16 v[112:115], a[248:251], v[124:127], v[112:115]
  s_waitcnt lgkmcnt(0)
  v_mfma_f32_16x16x32_bf16 v[100:103], a[12:15], v[128:131], v[100:103]
  v_mfma_f32_16x16x32_bf16 v[104:107], a[92:95], v[128:131], v[104:107]
  v_mfma_f32_16x16x32_bf16 v[108:111], a[172:175], v[128:131], v[108:111]
  v_mfma_f32_16x16x32_bf16 v[112:115], a[252:255], v[128:131], v[112:115]
  s_xor_b32 s44, s44, 0x10000
  v_xor_b32 v159, 0x10000, v159
  s_cmp_lt_u32 s29, 63
  s_cselect_b32 s31, 40960, 0
  s_add_u32 s43, s43, s31
  s_mul_i32 s31, s16, 2621440
  s_cmp_eq_u32 s29, 11
  s_cselect_b32 s31, s31, 0
  s_sub_u32 s43, s43, s31
  v_mov_b32 v169, s29
  v_cvt_pk_bf16_f32 v132, v100, v101
  v_cvt_pk_bf16_f32 v133, v102, v103
  v_cvt_pk_bf16_f32 v134, v104, v105
  v_cvt_pk_bf16_f32 v135, v106, v107
  buffer_store_dwordx4 v[132:135], v144, s[8:11], s42 offen
  s_add_u32 s42, s42, s50
  v_cvt_pk_bf16_f32 v136, v108, v109
  v_cvt_pk_bf16_f32 v137, v110, v111
  v_cvt_pk_bf16_f32 v138, v112, v113
  v_cvt_pk_bf16_f32 v139, v114, v115
  buffer_store_dwordx4 v[136:139], v144, s[8:11], s42 offen
  s_add_u32 s42, s42, s50
  s_cmp_gt_u32 s29, 2
  s_cbranch_scc1 b_step33
  s_waitcnt vmcnt(0) lgkmcnt(0)
  buffer_store_dword v169, v154, s[8:11], 0 offen
  s_cmp_eq_u32 s29, 1
  s_barrier
  s_cbranch_scc1 b_top3
  s_mov_b32 s33, 4096
  s_mov_b32 s30, 0
pw_58:
  buffer_load_dword v166, v157, s[8:11], s33 offen sc1
  s_add_u32 s30, s30, 1
  s_cmp_gt_u32 s30, 65536
  s_cbranch_scc1 role_abort
  s_waitcnt vmcnt(0)
pc_60:
  v_cmp_gt_u32 vcc, 1, v166
  s_nop 0
  s_and_b32 vcc_lo, vcc_lo, 0x10000000
  s_and_b32 vcc_hi, vcc_hi, 0x0
  s_cmp_eq_u64 vcc, 0
  s_cbranch_scc1 po_59
  s_sleep 2
  s_branch pw_58
po_59:
  v_readlane_b32 s31, v166, 28
  s_nop 0
  s_lshl_b32 s31, s31, 13
  s_add_u32 s56, s56, s31
  s_branch b_step32
b_step30:
  s_sleep 24
b_step33:
  s_waitcnt vmcnt(2) lgkmcnt(0)
  s_barrier
  s_nop 15
  s_nop 11
  buffer_load_dwordx4 v[116:119], v144, s[8:11], s58 offen sc1
  buffer_load_dwordx4 v[120:123], v144, s[8:11], s58 offen offset:1024 sc1
  s_and_b32 s31, s28, 3
  s_mul_i32 s36, s31, 81920
  s_add_u32 s36, s36, s35
  s_lshl_b32 s32, s31, 15
  s_add_u32 s38, s37, s32
  s_add_u32 s28, s28, 1
  v_mov_b32 v170, s28
  v_mov_b32 v60, 0
  v_mov_b32 v61, 0
  v_mov_b32 v62, 0
  v_mov_b32 v63, 0
  v_mov_b32 v64, 0
  v_mov_b32 v65, 0
  v_mov_b32 v66, 0
  v_mov_b32 v67, 0
  s_mov_b32 s30, 0
  s_add_u32 s31, s36, s57
  s_waitcnt vmcnt(0)
  v_mfma_f32_16x16x32_bf16 v[108:111], v[180:183], v[116:119], 0
  v_mfma_f32_16x16x32_bf16 v[108:111], v[180:183], v[120:123], v[108:111]
  s_nop 7
  v_cmp_u_f32 vcc, v108, v109
  v_cvt_pk_bf16_f32 v168, v108, v109
  s_cbranch_vccnz b_step3xr
b_step3x:
  buffer_store_dword v168, v146, s[8:11], s31 offen
  buffer_store_dword v169, v154, s[8:11], 0 offen
  s_nop 15
  s_nop 13
  s_branch b_step3P
b_step3S:
  s_sleep 6
b_step32:
  s_and_b32 s31, s28, 3
  s_mul_i32 s36, s31, 81920
  s_add_u32 s36, s36, s35
  s_lshl_b32 s32, s31, 15
  s_add_u32 s38, s37, s32
  s_add_u32 s28, s28, 1
  v_mov_b32 v170, s28
  v_mov_b32 v60, 0
  v_mov_b32 v61, 0
  v_mov_b32 v62, 0
  v_mov_b32 v63, 0
  v_mov_b32 v64, 0
  v_mov_b32 v65, 0
  v_mov_b32 v66, 0
  v_mov_b32 v67, 0
.p2align 7
b_step3P:
  s_mov_b32 s30, 0
  buffer_load_dwordx4 v[76:79], v147, s[8:11], s36 offen sc1
  buffer_load_dwordx4 v[80:83], v147, s[8:11], s36 offen offset:1024 sc1
  buffer_load_dword v84, v148, s[8:11], s36 offen sc1
  buffer_load_dword v85, v148, s[8:11], s36 offen offset:256 sc1
  s_nop 15
  s_nop 15
mq_61:
  buffer_load_dwordx4 v[88:91], v147, s[8:11], s36 offen sc1
  buffer_load_dwordx4 v[92:95], v147, s[8:11], s36 offen offset:1024 sc1
  buffer_load_dword v96, v148, s[8:11], s36 offen sc1
  buffer_load_dword v97, v148, s[8:11], s36 offen offset:256 sc1
  s_add_u32 s30, s30, 1
  s_cmp_gt_u32 s30, 65536
  s_cbranch_scc1 chain_abort
  s_waitcnt vmcnt(4)
  buffer_store_dword v169, v154, s[8:11], 0 offen
  v_max3_u32 v167, v76, v80, v84
  v_max_u32 v167, v167, v85
  v_cmp_eq_u32 vcc, -1, v167
  ds_write_b128 v147, v[76:79]
  ds_write_b128 v147, v[80:83] offset:1024
  ds_write2st64_b32 v148, v84, v85 offset0:0 offset1:1
  s_cbranch_vccz mq_61_ok
  buffer_load_dwordx4 v[76:79], v147, s[8:11], s36 offen sc1
  buffer_load_dwordx4 v[80:83], v147, s[8:11], s36 offen offset:1024 sc1
  buffer_load_dword v84, v148, s[8:11], s36 offen sc1
  buffer_load_dword v85, v148, s[8:11], s36 offen offset:256 sc1
  s_waitcnt vmcnt(5)
  v_max3_u32 v167, v88, v92, v96
  v_max_u32 v167, v167, v97
  v_cmp_eq_u32 vcc, -1, v167
  ds_write_b128 v147, v[88:91]
  ds_write_b128 v147, v[92:95] offset:1024
  ds_write2st64_b32 v148, v96, v97 offset0:0 offset1:1
  s_cbranch_vccz mq_61_ok
  s_branch mq_61
.p2align 7
mq_61_ok:
  s_waitcnt lgkmcnt(0)
  s_barrier
  ds_read_b128 v[4:7], v144 offset:0
  ds_read_b128 v[8:11], v144 offset:1024
  ds_read_b128 v[12:15], v144 offset:2048
  ds_read_b128 v[16:19], v144 offset:3072
  ds_read_b128 v[20:23], v144 offset:4096
  ds_read_b128 v[24:27], v144 offset:5120
  ds_read_b128 v[28:31], v144 offset:6144
  ds_read_b128 v[32:35], v144 offset:7168
  ds_read_b128 v[36:39], v144 offset:8192
  ds_read_b128 v[40:43], v144 offset:9216
  s_waitcnt lgkmcnt(9)
  v_smfmac_f32_16x16x64_bf16 v[60:63], v[4:7], v[192:199], v151
  v_smfmac_f32_16x16x64_bf16 v[64:67], v[4:7], a[16:23], v151
  s_waitcnt lgkmcnt(8)
  v_smfmac_f32_16x16x64_bf16 v[60:63], v[8:11], v[200:207], v151
  v_smfmac_f32_16x16x64_bf16 v[64:67], v[8:11], a[24:31], v151
  s_waitcnt lgkmcnt(7)
  v_smfmac_f32_16x16x64_bf16 v[60:63], v[12:15], v[208:215], v151
  v_smfmac_f32_16x16x64_bf16 v[64:67], v[12:15], a[32:39], v151
  s_waitcnt lgkmcnt(6)
  v_smfmac_f32_16x16x64_bf16 v[60:63], v[16:19], v[216:223], v151
  buffer_store_dword v170, v156, s[8:11], 0 offen
  v_smfmac_f32_16x16x64_bf16 v[64:67], v[16:19], a[40:47], v151
  s_waitcnt lgkmcnt(5)
  v_smfmac_f32_16x16x64_bf16 v[60:63], v[20:23], v[224:231], v151
  v_smfmac_f32_16x16x64_bf16 v[64:67], v[20:23], a[48:55], v151
  s_waitcnt lgkmcnt(4)
  v_smfmac_f32_16x16x64_bf16 v[60:63], v[24:27], v[232:239], v151
  v_smfmac_f32_16x16x64_bf16 v[64:67], v[24:27], a[56:63], v151
  s_waitcnt lgkmcnt(3)
  v_smfmac_f32_16x16x64_bf16 v[60:63], v[28:31], v[240:247], v151
  v_smfmac_f32_16x16x64_bf16 v[64:67], v[28:31], a[64:71], v151
  s_waitcnt lgkmcnt(2)
  v_smfmac_f32_16x16x64_bf16 v[60:63], v[32:35], v[248:255], v151
  s_waitcnt lgkmcnt(1)
  v_smfmac_f32_16x16x64_bf16 v[60:63], v[36:39], a[0:7], v151
  s_waitcnt lgkmcnt(0)
  v_smfmac_f32_16x16x64_bf16 v[60:63], v[40:43], a[8:15], v151
  s_nop 2
  v_smfmac_f32_16x16x64_bf16 v[64:67], v[32:35], a[72:79], v151
  s_nop 2
  v_smfmac_f32_16x16x64_bf16 v[64:67], v[36:39], a[80:87], v151
  v_add_f32 v60, v60, v62
  v_add_f32 v61, v61, v63
  v_cvt_pk_bf16_f32 v140, v60, v61
  s_nop 1
  v_mov_b32_dpp v142, v140 quad_perm:[1,0,3,2] row_mask:0xf bank_mask:0xf
  v_perm_b32 v140, v142, v140, v152
  v_smfmac_f32_16x16x64_bf16 v[64:67], v[40:43], a[88:95], v151
  s_nop 7
  v_add_f32 v64, v64, v66
  v_add_f32 v65, v65, v67
  v_cvt_pk_bf16_f32 v141, v64, v65
  s_nop 1
  v_mov_b32_dpp v143, v141 quad_perm:[1,0,3,2] row_mask:0xf bank_mask:0xf
  v_perm_b32 v141, v143, v141, v152
  buffer_store_dwordx2 v[140:141], v150, s[8:11], s38 offen
  s_add_u32 s31, s28, 2
  s_and_b32 s31, s31, 3
  s_cmp_eq_u32 s28, 64
  s_cbranch_scc1 b_end
  s_lshl_b32 s31, s31, 15
  s_add_u32 s31, s31, s37
  buffer_store_dwordx2 v[72:73], v150, s[8:11], s31 offen
  s_add_u32 s31, s28, 1
  s_and_b32 s31, s31, 3
  s_mul_i32 s31, s31, 163840
  s_add_u32 s31, s31, s47
  s_add_u32 s32, s31, s46
  buffer_store_dwordx4 v[72:75], v164, s[8:11], s31 offen sc1
  s_add_u32 s31, s31, 196608
  s_branch b_top3
b_step3xr:
  buffer_load_dwordx4 v[116:119], v144, s[8:11], s58 offen sc1
  buffer_load_dwordx4 v[120:123], v144, s[8:11], s58 offen offset:1024 sc1
  s_add_u32 s30, s30, 1
  s_cmp_gt_u32 s30, 65536
  s_cbranch_scc1 chain_abort
  s_waitcnt vmcnt(0)
  v_mfma_f32_16x16x32_bf16 v[108:111], v[180:183], v[116:119], 0
  v_mfma_f32_16x16x32_bf16 v[108:111], v[180:183], v[120:123], v[108:111]
  s_nop 7
  v_cmp_u_f32 vcc, v108, v109
  v_cvt_pk_bf16_f32 v168, v108, v109
  s_cbranch_vccz b_step3x
  s_branch b_step3xr
b_end:
  s_cmp_lt_u32 s18, 4
  s_waitcnt vmcnt(0) lgkmcnt(0)
  s_cbranch_scc1 r_help
  s_endpgm
chain_abort:
  v_mov_b32 v167, 128
  v_mov_b32 v168, 1
  s_mov_b64 exec, 1
  buffer_atomic_add v168, v167, s[12:15], 0 offen
  s_endpgm
role_w:
  s_load_dwordx2 s[20:21], s[0:1], 40
  s_mov_b32 s22, 7864320
  s_mov_b32 s23, 0x00020000
  s_load_dwordx2 s[88:89], s[0:1], 96
  s_mov_b32 s90, 1280
  s_mov_b32 s91, 0x00020000
  s_load_dwordx2 s[92:93], s[0:1], 104
  s_mov_b32 s94, 4915200
  s_mov_b32 s95, 0x00020000
  v_lshrrev_b32 v203, 4, v1
  v_and_b32 v203, 3, v203
  v_lshlrev_b32 v203, 1, v203
  v_and_b32 v207, 7, v1
  v_xor_b32 v207, v207, v203
  v_lshlrev_b32 v207, 4, v207
  v_lshrrev_b32 v203, 3, v1
  v_mul_u32_u24 v203, 1280, v203
  v_add_u32 v207, v207, v203
  s_sub_u32 s24, s18, 18
  s_lshl_b32 s27, s16, 2
  s_add_u32 s27, s27, s17
  s_mul_i32 s29, s27, 245760
  s_lshl_b32 s27, s24, 7
  s_add_u32 s29, s29, s27
  s_mul_i32 s30, s17, 24576
  s_add_u32 s30, s30, 16384
  s_sub_u32 s27, 7, s24
  s_lshl_b32 s27, s27, 3
  s_add_u32 s27, s27, s16
  s_cmp_ge_u32 s27, 20
  s_waitcnt lgkmcnt(0)
  s_cbranch_scc1 w_nm
  v_lshlrev_b32 v12, 2, v0
  buffer_load_dword v13, v12, s[88:91], 0 offen
  buffer_load_dword v14, v12, s[88:91], 0 offen offset:1024
  v_lshrrev_b32 v20, 3, v0
  v_and_b32 v21, 7, v0
  v_mul_u32_u24 v22, 153600, v20
  v_lshl_add_u32 v22, v21, 4, v22
  s_lshl_b32 s6, s27, 7
  buffer_load_dwordx4 v[28:31], v22, s[92:95], s6 offen nt
  s_add_u32 s6, s6, 7680
  buffer_load_dwordx4 v[32:35], v22, s[92:95], s6 offen nt
  s_add_u32 s6, s6, 7680
  buffer_load_dwordx4 v[36:39], v22, s[92:95], s6 offen nt
  s_add_u32 s6, s6, 7680
  buffer_load_dwordx4 v[40:43], v22, s[92:95], s6 offen nt
  s_add_u32 s6, s6, 7680
  buffer_load_dwordx4 v[44:47], v22, s[92:95], s6 offen nt
  s_add_u32 s6, s6, 7680
  buffer_load_dwordx4 v[48:51], v22, s[92:95], s6 offen nt
  s_add_u32 s6, s6, 7680
  buffer_load_dwordx4 v[52:55], v22, s[92:95], s6 offen nt
  s_add_u32 s6, s6, 7680
  buffer_load_dwordx4 v[56:59], v22, s[92:95], s6 offen nt
  s_add_u32 s6, s6, 7680
  buffer_load_dwordx4 v[60:63], v22, s[92:95], s6 offen nt
  s_add_u32 s6, s6, 7680
  buffer_load_dwordx4 v[64:67], v22, s[92:95], s6 offen nt
  s_add_u32 s6, s6, 7680
  buffer_load_dwordx4 v[68:71], v22, s[92:95], s6 offen nt
  s_add_u32 s6, s6, 7680
  buffer_load_dwordx4 v[72:75], v22, s[92:95], s6 offen nt
  s_add_u32 s6, s6, 7680
  buffer_load_dwordx4 v[76:79], v22, s[92:95], s6 offen nt
  s_add_u32 s6, s6, 7680
  buffer_load_dwordx4 v[80:83], v22, s[92:95], s6 offen nt
  s_add_u32 s6, s6, 7680
  buffer_load_dwordx4 v[84:87], v22, s[92:95], s6 offen nt
  s_add_u32 s6, s6, 7680
  buffer_load_dwordx4 v[88:91], v22, s[92:95], s6 offen nt
  s_add_u32 s6, s6, 7680
  buffer_load_dwordx4 v[92:95], v22, s[92:95], s6 offen nt
  s_add_u32 s6, s6, 7680
  buffer_load_dwordx4 v[96:99], v22, s[92:95], s6 offen nt
  s_add_u32 s6, s6, 7680
  buffer_load_dwordx4 v[100:103], v22, s[92:95], s6 offen nt
  s_add_u32 s6, s6, 7680
  buffer_load_dwordx4 v[104:107], v22, s[92:95], s6 offen nt
  s_add_u32 s6, s6, 7680
  s_waitcnt vmcnt(20)
  v_lshlrev_b32 v24, 16, v13
  v_and_b32 v25, 0xffff0000, v13
  v_mul_f32 v16, 0xbfb8aa3b, v24
  v_mul_f32 v17, 0xbfb8aa3b, v25
  v_exp_f32 v16, v16
  v_exp_f32 v17, v17
  v_add_f32 v16, 1.0, v16
  v_add_f32 v17, 1.0, v17
  v_rcp_f32 v16, v16
  v_rcp_f32 v17, v17
  v_mul_f32 v24, v24, v16
  v_mul_f32 v25, v25, v17
  v_cvt_pk_bf16_f32 v16, v24, v25
  v_lshlrev_b32 v24, 16, v16
  v_and_b32 v25, 0xffff0000, v16
  v_lshlrev_b32 v26, 16, v14
  v_and_b32 v27, 0xffff0000, v14
  v_mul_f32 v16, 0xbfb8aa3b, v26
  v_mul_f32 v17, 0xbfb8aa3b, v27
  v_exp_f32 v16, v16
  v_exp_f32 v17, v17
  v_add_f32 v16, 1.0, v16
  v_add_f32 v17, 1.0, v17
  v_rcp_f32 v16, v16
  v_rcp_f32 v17, v17
  v_mul_f32 v26, v26, v16
  v_mul_f32 v27, v27, v17
  v_cvt_pk_bf16_f32 v16, v26, v27
  v_lshlrev_b32 v26, 16, v16
  v_and_b32 v27, 0xffff0000, v16
  v_lshlrev_b32 v12, 3, v0
  ds_write_b64 v12, v[24:25]
  ds_write_b64 v12, v[26:27] offset:2048
  v_mul_u32_u24 v12, 80, v20
  s_waitcnt lgkmcnt(0)
  s_barrier
  ds_read_b128 v[108:111], v12 offset:0
  ds_read_b128 v[112:115], v12 offset:16
  ds_read_b128 v[116:119], v12 offset:32
  ds_read_b128 v[120:123], v12 offset:48
  ds_read_b128 v[124:127], v12 offset:64
  v_mov_b32 v148, 0
  v_mov_b32 v149, 0
  v_mov_b32 v150, 0
  v_mov_b32 v151, 0
  v_mov_b32 v152, 0
  v_mov_b32 v153, 0
  v_mov_b32 v154, 0
  v_mov_b32 v155, 0
  s_waitcnt lgkmcnt(0)
  v_lshrrev_b32 v128, 16, v108
  v_lshrrev_b32 v129, 16, v109
  v_lshrrev_b32 v130, 16, v110
  v_lshrrev_b32 v131, 16, v111
  v_lshrrev_b32 v132, 16, v112
  v_lshrrev_b32 v133, 16, v113
  v_lshrrev_b32 v134, 16, v114
  v_lshrrev_b32 v135, 16, v115
  v_lshrrev_b32 v136, 16, v116
  v_lshrrev_b32 v137, 16, v117
  v_lshrrev_b32 v138, 16, v118
  v_lshrrev_b32 v139, 16, v119
  v_lshrrev_b32 v140, 16, v120
  v_lshrrev_b32 v141, 16, v121
  v_lshrrev_b32 v142, 16, v122
  v_lshrrev_b32 v143, 16, v123
  v_lshrrev_b32 v144, 16, v124
  v_lshrrev_b32 v145, 16, v125
  v_lshrrev_b32 v146, 16, v126
  v_lshrrev_b32 v147, 16, v127
  s_waitcnt vmcnt(18)
  v_dot2c_f32_bf16 v148, v28, v128
  v_dot2c_f32_bf16 v149, v28, v108
  v_dot2c_f32_bf16 v150, v29, v128
  v_dot2c_f32_bf16 v151, v29, v108
  v_dot2c_f32_bf16 v152, v30, v128
  v_dot2c_f32_bf16 v153, v30, v108
  v_dot2c_f32_bf16 v154, v31, v128
  v_dot2c_f32_bf16 v155, v31, v108
  v_dot2c_f32_bf16 v148, v32, v129
  v_dot2c_f32_bf16 v149, v32, v109
  v_dot2c_f32_bf16 v150, v33, v129
  v_dot2c_f32_bf16 v151, v33, v109
  v_dot2c_f32_bf16 v152, v34, v129
  v_dot2c_f32_bf16 v153, v34, v109
  v_dot2c_f32_bf16 v154, v35, v129
  v_dot2c_f32_bf16 v155, v35, v109
  s_waitcnt vmcnt(16)
  v_dot2c_f32_bf16 v148, v36, v130
  v_dot2c_f32_bf16 v149, v36, v110
  v_dot2c_f32_bf16 v150, v37, v130
  v_dot2c_f32_bf16 v151, v37, v110
  v_dot2c_f32_bf16 v152, v38, v130
  v_dot2c_f32_bf16 v153, v38, v110
  v_dot2c_f32_bf16 v154, v39, v130
  v_dot2c_f32_bf16 v155, v39, v110
  v_dot2c_f32_bf16 v148, v40, v131
  v_dot2c_f32_bf16 v149, v40, v111
  v_dot2c_f32_bf16 v150, v41, v131
  v_dot2c_f32_bf16 v151, v41, v111
  v_dot2c_f32_bf16 v152, v42, v131
  v_dot2c_f32_bf16 v153, v42, v111
  v_dot2c_f32_bf16 v154, v43, v131
  v_dot2c_f32_bf16 v155, v43, v111
  s_waitcnt vmcnt(14)
  v_dot2c_f32_bf16 v148, v44, v132
  v_dot2c_f32_bf16 v149, v44, v112
  v_dot2c_f32_bf16 v150, v45, v132
  v_dot2c_f32_bf16 v151, v45, v112
  v_dot2c_f32_bf16 v152, v46, v132
  v_dot2c_f32_bf16 v153, v46, v112
  v_dot2c_f32_bf16 v154, v47, v132
  v_dot2c_f32_bf16 v155, v47, v112
  v_dot2c_f32_bf16 v148, v48, v133
  v_dot2c_f32_bf16 v149, v48, v113
  v_dot2c_f32_bf16 v150, v49, v133
  v_dot2c_f32_bf16 v151, v49, v113
  v_dot2c_f32_bf16 v152, v50, v133
  v_dot2c_f32_bf16 v153, v50, v113
  v_dot2c_f32_bf16 v154, v51, v133
  v_dot2c_f32_bf16 v155, v51, v113
  s_waitcnt vmcnt(12)
  v_dot2c_f32_bf16 v148, v52, v134
  v_dot2c_f32_bf16 v149, v52, v114
  v_dot2c_f32_bf16 v150, v53, v134
  v_dot2c_f32_bf16 v151, v53, v114
  v_dot2c_f32_bf16 v152, v54, v134
  v_dot2c_f32_bf16 v153, v54, v114
  v_dot2c_f32_bf16 v154, v55, v134
  v_dot2c_f32_bf16 v155, v55, v114
  v_dot2c_f32_bf16 v148, v56, v135
  v_dot2c_f32_bf16 v149, v56, v115
  v_dot2c_f32_bf16 v150, v57, v135
  v_dot2c_f32_bf16 v151, v57, v115
  v_dot2c_f32_bf16 v152, v58, v135
  v_dot2c_f32_bf16 v153, v58, v115
  v_dot2c_f32_bf16 v154, v59, v135
  v_dot2c_f32_bf16 v155, v59, v115
  s_waitcnt vmcnt(10)
  v_dot2c_f32_bf16 v148, v60, v136
  v_dot2c_f32_bf16 v149, v60, v116
  v_dot2c_f32_bf16 v150, v61, v136
  v_dot2c_f32_bf16 v151, v61, v116
  v_dot2c_f32_bf16 v152, v62, v136
  v_dot2c_f32_bf16 v153, v62, v116
  v_dot2c_f32_bf16 v154, v63, v136
  v_dot2c_f32_bf16 v155, v63, v116
  v_dot2c_f32_bf16 v148, v64, v137
  v_dot2c_f32_bf16 v149, v64, v117
  v_dot2c_f32_bf16 v150, v65, v137
  v_dot2c_f32_bf16 v151, v65, v117
  v_dot2c_f32_bf16 v152, v66, v137
  v_dot2c_f32_bf16 v153, v66, v117
  v_dot2c_f32_bf16 v154, v67, v137
  v_dot2c_f32_bf16 v155, v67, v117
  s_waitcnt vmcnt(8)
  v_dot2c_f32_bf16 v148, v68, v138
  v_dot2c_f32_bf16 v149, v68, v118
  v_dot2c_f32_bf16 v150, v69, v138
  v_dot2c_f32_bf16 v151, v69, v118
  v_dot2c_f32_bf16 v152, v70, v138
  v_dot2c_f32_bf16 v153, v70, v118
  v_dot2c_f32_bf16 v154, v71, v138
  v_dot2c_f32_bf16 v155, v71, v118
  v_dot2c_f32_bf16 v148, v72, v139
  v_dot2c_f32_bf16 v149, v72, v119
  v_dot2c_f32_bf16 v150, v73, v139
  v_dot2c_f32_bf16 v151, v73, v119
  v_dot2c_f32_bf16 v152, v74, v139
  v_dot2c_f32_bf16 v153, v74, v119
  v_dot2c_f32_bf16 v154, v75, v139
  v_dot2c_f32_bf16 v155, v75, v119
  s_waitcnt vmcnt(6)
  v_dot2c_f32_bf16 v148, v76, v140
  v_dot2c_f32_bf16 v149, v76, v120
  v_dot2c_f32_bf16 v150, v77, v140
  v_dot2c_f32_bf16 v151, v77, v120
  v_dot2c_f32_bf16 v152, v78, v140
  v_dot2c_f32_bf16 v153, v78, v120
  v_dot2c_f32_bf16 v154, v79, v140
  v_dot2c_f32_bf16 v155, v79, v120
  v_dot2c_f32_bf16 v148, v80, v141
  v_dot2c_f32_bf16 v149, v80, v121
  v_dot2c_f32_bf16 v150, v81, v141
  v_dot2c_f32_bf16 v151, v81, v121
  v_dot2c_f32_bf16 v152, v82, v141
  v_dot2c_f32_bf16 v153, v82, v121
  v_dot2c_f32_bf16 v154, v83, v141
  v_dot2c_f32_bf16 v155, v83, v121
  s_waitcnt vmcnt(4)
  v_dot2c_f32_bf16 v148, v84, v142
  v_dot2c_f32_bf16 v149, v84, v122
  v_dot2c_f32_bf16 v150, v85, v142
  v_dot2c_f32_bf16 v151, v85, v122
  v_dot2c_f32_bf16 v152, v86, v142
  v_dot2c_f32_bf16 v153, v86, v122
  v_dot2c_f32_bf16 v154, v87, v142
  v_dot2c_f32_bf16 v155, v87, v122
  v_dot2c_f32_bf16 v148, v88, v143
  v_dot2c_f32_bf16 v149, v88, v123
  v_dot2c_f32_bf16 v150, v89, v143
  v_dot2c_f32_bf16 v151, v89, v123
  v_dot2c_f32_bf16 v152, v90, v143
  v_dot2c_f32_bf16 v153, v90, v123
  v_dot2c_f32_bf16 v154, v91, v143
  v_dot2c_f32_bf16 v155, v91, v123
  s_waitcnt vmcnt(2)
  v_dot2c_f32_bf16 v148, v92, v144
  v_dot2c_f32_bf16 v149, v92, v124
  v_dot2c_f32_bf16 v150, v93, v144
  v_dot2c_f32_bf16 v151, v93, v124
  v_dot2c_f32_bf16 v152, v94, v144
  v_dot2c_f32_bf16 v153, v94, v124
  v_dot2c_f32_bf16 v154, v95, v144
  v_dot2c_f32_bf16 v155, v95, v124
  v_dot2c_f32_bf16 v148, v96, v145
  v_dot2c_f32_bf16 v149, v96, v125
  v_dot2c_f32_bf16 v150, v97, v145
  v_dot2c_f32_bf16 v151, v97, v125
  v_dot2c_f32_bf16 v152, v98, v145
  v_dot2c_f32_bf16 v153, v98, v125
  v_dot2c_f32_bf16 v154, v99, v145
  v_dot2c_f32_bf16 v155, v99, v125
  s_waitcnt vmcnt(0)
  v_dot2c_f32_bf16 v148, v100, v146
  v_dot2c_f32_bf16 v149, v100, v126
  v_dot2c_f32_bf16 v150, v101, v146
  v_dot2c_f32_bf16 v151, v101, v126
  v_dot2c_f32_bf16 v152, v102, v146
  v_dot2c_f32_bf16 v153, v102, v126
  v_dot2c_f32_bf16 v154, v103, v146
  v_dot2c_f32_bf16 v155, v103, v126
  v_dot2c_f32_bf16 v148, v104, v147
  v_dot2c_f32_bf16 v149, v104, v127
  v_dot2c_f32_bf16 v150, v105, v147
  v_dot2c_f32_bf16 v151, v105, v127
  v_dot2c_f32_bf16 v152, v106, v147
  v_dot2c_f32_bf16 v153, v106, v127
  v_dot2c_f32_bf16 v154, v107, v147
  v_dot2c_f32_bf16 v155, v107, v127
  v_lshlrev_b32 v12, 5, v0
  ds_write_b128 v12, v[148:151] offset:4096
  s_nop 0
  ds_write_b128 v12, v[152:155] offset:4112
  v_lshlrev_b32 v12, 2, v0
  s_waitcnt lgkmcnt(0)
  s_barrier
  s_cmp_lg_u32 s17, 0
  s_cbranch_scc1 mod_enda
  ds_read2st64_b32 v[28:29], v12 offset0:16 offset1:17
  ds_read2st64_b32 v[30:31], v12 offset0:18 offset1:19
  ds_read2st64_b32 v[32:33], v12 offset0:20 offset1:21
  ds_read2st64_b32 v[34:35], v12 offset0:22 offset1:23
  ds_read2st64_b32 v[36:37], v12 offset0:24 offset1:25
  ds_read2st64_b32 v[38:39], v12 offset0:26 offset1:27
  ds_read2st64_b32 v[40:41], v12 offset0:28 offset1:29
  ds_read2st64_b32 v[42:43], v12 offset0:30 offset1:31
  ds_read2st64_b32 v[44:45], v12 offset0:32 offset1:33
  ds_read2st64_b32 v[46:47], v12 offset0:34 offset1:35
  ds_read2st64_b32 v[48:49], v12 offset0:36 offset1:37
  ds_read2st64_b32 v[50:51], v12 offset0:38 offset1:39
  ds_read2st64_b32 v[52:53], v12 offset0:40 offset1:41
  ds_read2st64_b32 v[54:55], v12 offset0:42 offset1:43
  ds_read2st64_b32 v[56:57], v12 offset0:44 offset1:45
  ds_read2st64_b32 v[58:59], v12 offset0:46 offset1:47
  s_waitcnt lgkmcnt(11)
  v_pk_add_f32 v[28:29], v[28:29], v[30:31]
  v_pk_add_f32 v[28:29], v[28:29], v[32:33]
  v_pk_add_f32 v[28:29], v[28:29], v[34:35]
  v_pk_add_f32 v[28:29], v[28:29], v[36:37]
  s_waitcnt lgkmcnt(7)
  v_pk_add_f32 v[28:29], v[28:29], v[38:39]
  v_pk_add_f32 v[28:29], v[28:29], v[40:41]
  v_pk_add_f32 v[28:29], v[28:29], v[42:43]
  v_pk_add_f32 v[28:29], v[28:29], v[44:45]
  s_waitcnt lgkmcnt(3)
  v_pk_add_f32 v[28:29], v[28:29], v[46:47]
  v_pk_add_f32 v[28:29], v[28:29], v[48:49]
  v_pk_add_f32 v[28:29], v[28:29], v[50:51]
  v_pk_add_f32 v[28:29], v[28:29], v[52:53]
  s_waitcnt lgkmcnt(0)
  v_pk_add_f32 v[28:29], v[28:29], v[54:55]
  v_pk_add_f32 v[28:29], v[28:29], v[56:57]
  v_pk_add_f32 v[28:29], v[28:29], v[58:59]
  v_add_f32 v28, v28, v29
  v_cvt_pk_bf16_f32 v28, v28, v28
  v_lshlrev_b32 v28, 16, v28
  s_lshl_b32 s6, s27, 8
  s_add_u32 s6, s6, 65536
  buffer_store_dword v28, v12, s[8:11], s6 offen sc1
  v_mov_b32 v16, 200
  v_mov_b32 v17, 1
  s_waitcnt vmcnt(0)
  s_mov_b64 exec, 1
  buffer_atomic_add v17, v16, s[12:15], 0 offen sc1
  s_mov_b64 exec, -1
mod_enda:
  s_branch w_nc
w_nm:
  s_waitcnt lgkmcnt(0)
  s_lshl_b32 s27, s24, 2
  s_add_u32 s27, s27, s17
  s_cmp_lg_u32 s27, 32
  s_cbranch_scc1 w_nc
  s_lshl_b32 s92, s16, 8
  s_add_u32 s92, s92, 17268736
  s_mov_b32 s93, 0
  s_mov_b32 s94, -1
  s_mov_b32 s95, -1
  v_lshlrev_b32 v12, 2, v1
  v_mov_b32 v13, -1
  s_waitcnt vmcnt(0)
boot_cal:
  s_memtime s[88:89]
  s_waitcnt lgkmcnt(0)
  buffer_store_dword v13, v12, s[8:11], s92 offen sc1
  s_waitcnt vmcnt(0)
  s_memtime s[90:91]
  s_waitcnt lgkmcnt(0)
  s_sub_u32 s88, s90, s88
  s_min_u32 s88, s88, s94
  s_mov_b32 s94, s95
  s_mov_b32 s95, s88
  s_xor_b32 s92, s92, 8192
  s_add_u32 s93, s93, 1
  s_cmp_lt_u32 s93, 10
  s_cbranch_scc1 boot_cal
  v_mov_b32 v12, 192
  s_mov_b32 s93, 0
gw_63:
  buffer_load_dword v13, v12, s[12:15], 0 offen sc1
  s_add_u32 s93, s93, 1
  s_cmp_gt_u32 s93, 65536
  s_cbranch_scc1 role_abort
  s_waitcnt vmcnt(0)
  v_cmp_gt_u32 vcc, 16, v13
  s_cbranch_vccz gk_64
  s_sleep 8
  s_branch gw_63
gk_64:
  s_cmp_lt_u32 s94, s95
  s_cselect_b32 s93, 1, 2
  s_lshl_b32 s92, s16, 8
  s_add_u32 s92, s92, 4208
  v_mov_b32 v12, s93
  v_mov_b32 v13, s92
  s_mov_b64 exec, 1
  buffer_store_dword v12, v13, s[8:11], 0 offen
  s_mov_b64 exec, -1
w_nc:
  s_cmp_ge_u32 s24, 4
  s_cbranch_scc1 w_nt
  s_lshl_b32 s27, s24, 2
  s_add_u32 s27, s27, s17
  s_lshl_b32 s27, s27, 13
  s_mul_i32 s28, s16, 2621440
  s_add_u32 s28, s28, s27
  s_add_u32 s28, s28, 247463936
  v_lshlrev_b32 v203, 7, v1
  buffer_load_dword v204, v203, s[8:11], s28 offen sc1
  s_lshl_b32 s28, s16, 22
  s_add_u32 s27, s27, s28
  s_add_u32 s27, s27, 67108864
  buffer_load_dword v204, v203, s[8:11], s27 offen sc1
  s_add_u32 s27, s27, 131072
  buffer_load_dword v204, v203, s[8:11], s27 offen sc1
  s_add_u32 s27, s27, 131072
  buffer_load_dword v204, v203, s[8:11], s27 offen sc1
w_nt:
  s_add_u32 m0, s30, 0
  s_add_u32 s28, s29, 0
  buffer_load_dwordx4 v207, s[20:23], s28 offen nt lds
  s_add_u32 m0, s30, 1024
  s_add_u32 s28, s29, 10240
  buffer_load_dwordx4 v207, s[20:23], s28 offen nt lds
  s_add_u32 m0, s30, 2048
  s_add_u32 s28, s29, 20480
  buffer_load_dwordx4 v207, s[20:23], s28 offen nt lds
  s_add_u32 m0, s30, 3072
  s_add_u32 s28, s29, 30720
  buffer_load_dwordx4 v207, s[20:23], s28 offen nt lds
  s_add_u32 m0, s30, 4096
  s_add_u32 s28, s29, 40960
  buffer_load_dwordx4 v207, s[20:23], s28 offen nt lds
  s_add_u32 m0, s30, 5120
  s_add_u32 s28, s29, 51200
  buffer_load_dwordx4 v207, s[20:23], s28 offen nt lds
  s_add_u32 m0, s30, 6144
  s_add_u32 s28, s29, 61440
  buffer_load_dwordx4 v207, s[20:23], s28 offen nt lds
  s_add_u32 m0, s30, 7168
  s_add_u32 s28, s29, 71680
  buffer_load_dwordx4 v207, s[20:23], s28 offen nt lds
  s_add_u32 m0, s30, 8192
  s_add_u32 s28, s29, 81920
  buffer_load_dwordx4 v207, s[20:23], s28 offen nt lds
  s_add_u32 m0, s30, 9216
  s_add_u32 s28, s29, 92160
  buffer_load_dwordx4 v207, s[20:23], s28 offen nt lds
  s_add_u32 m0, s30, 10240
  s_add_u32 s28, s29, 102400
  buffer_load_dwordx4 v207, s[20:23], s28 offen nt lds
  s_add_u32 m0, s30, 11264
  s_add_u32 s28, s29, 112640
  buffer_load_dwordx4 v207, s[20:23], s28 offen nt lds
  s_add_u32 m0, s30, 12288
  s_add_u32 s28, s29, 122880
  buffer_load_dwordx4 v207, s[20:23], s28 offen nt lds
  s_add_u32 m0, s30, 13312
  s_add_u32 s28, s29, 133120
  buffer_load_dwordx4 v207, s[20:23], s28 offen nt lds
  s_add_u32 m0, s30, 14336
  s_add_u32 s28, s29, 143360
  buffer_load_dwordx4 v207, s[20:23], s28 offen nt lds
  s_add_u32 m0, s30, 15360
  s_add_u32 s28, s29, 153600
  buffer_load_dwordx4 v207, s[20:23], s28 offen nt lds
  s_add_u32 m0, s30, 16384
  s_add_u32 s28, s29, 163840
  buffer_load_dwordx4 v207, s[20:23], s28 offen nt lds
  s_add_u32 m0, s30, 17408
  s_add_u32 s28, s29, 174080
  buffer_load_dwordx4 v207, s[20:23], s28 offen nt lds
  s_add_u32 m0, s30, 18432
  s_add_u32 s28, s29, 184320
  buffer_load_dwordx4 v207, s[20:23], s28 offen nt lds
  s_add_u32 m0, s30, 19456
  s_add_u32 s28, s29, 194560
  buffer_load_dwordx4 v207, s[20:23], s28 offen nt lds
  s_add_u32 m0, s30, 20480
  s_add_u32 s28, s29, 204800
  buffer_load_dwordx4 v207, s[20:23], s28 offen nt lds
  s_add_u32 m0, s30, 21504
  s_add_u32 s28, s29, 215040
  buffer_load_dwordx4 v207, s[20:23], s28 offen nt lds
  s_add_u32 m0, s30, 22528
  s_add_u32 s28, s29, 225280
  buffer_load_dwordx4 v207, s[20:23], s28 offen nt lds
  s_add_u32 m0, s30, 23552
  s_add_u32 s28, s29, 235520
  buffer_load_dwordx4 v207, s[20:23], s28 offen nt lds
w_md:
  s_waitcnt vmcnt(24)
  v_mov_b32 v152, -1
  v_mov_b32 v153, -1
  v_mov_b32 v154, -1
  v_mov_b32 v155, -1
  s_cmp_ge_u32 s24, 8
  s_cbranch_scc1 w_ns
  s_lshl_b32 s27, s24, 2
  s_add_u32 s27, s27, s17
  s_mul_i32 s28, s16, 30
  s_add_u32 s28, s28, 568
  s_lshl_b32 s29, s16, 1
  s_add_u32 s29, s29, 482
  s_cmp_lt_u32 s27, 30
  s_cselect_b32 s28, s28, s29
  s_add_u32 s27, s27, s28
  s_lshl_b32 s27, s27, 12
  v_lshlrev_b32 v156, 4, v1
  buffer_store_dwordx4 v[152:155], v156, s[8:11], s27 offen offset:0 sc1
  buffer_store_dwordx4 v[152:155], v156, s[8:11], s27 offen offset:1024 sc1
  buffer_store_dwordx4 v[152:155], v156, s[8:11], s27 offen offset:2048 sc1
  buffer_store_dwordx4 v[152:155], v156, s[8:11], s27 offen offset:3072 sc1
w_ns:
  v_lshrrev_b32 v203, 2, v1
  v_lshrrev_b32 v204, 1, v203
  v_and_b32 v204, 3, v204
  v_lshlrev_b32 v204, 1, v204
  v_bfe_u32 v220, v1, 1, 1
  v_add_u32 v220, 0, v220
  v_xor_b32 v220, v220, v204
  v_lshlrev_b32 v220, 4, v220
  v_lshlrev_b32 v203, 7, v203
  v_add_u32 v220, v220, v203
  v_and_b32 v203, 1, v1
  v_lshlrev_b32 v203, 3, v203
  v_add_u32 v220, v220, v203
  v_add_u32 v220, s30, v220
  v_lshrrev_b32 v203, 2, v1
  v_lshrrev_b32 v204, 1, v203
  v_and_b32 v204, 3, v204
  v_lshlrev_b32 v204, 1, v204
  v_bfe_u32 v221, v1, 1, 1
  v_add_u32 v221, 2, v221
  v_xor_b32 v221, v221, v204
  v_lshlrev_b32 v221, 4, v221
  v_lshlrev_b32 v203, 7, v203
  v_add_u32 v221, v221, v203
  v_and_b32 v203, 1, v1
  v_lshlrev_b32 v203, 3, v203
  v_add_u32 v221, v221, v203
  v_add_u32 v221, s30, v221
  v_lshrrev_b32 v203, 2, v1
  v_lshrrev_b32 v204, 1, v203
  v_and_b32 v204, 3, v204
  v_lshlrev_b32 v204, 1, v204
  v_bfe_u32 v222, v1, 1, 1
  v_add_u32 v222, 4, v222
  v_xor_b32 v222, v222, v204
  v_lshlrev_b32 v222, 4, v222
  v_lshlrev_b32 v203, 7, v203
  v_add_u32 v222, v222, v203
  v_and_b32 v203, 1, v1
  v_lshlrev_b32 v203, 3, v203
  v_add_u32 v222, v222, v203
  v_add_u32 v222, s30, v222
  v_lshrrev_b32 v203, 2, v1
  v_lshrrev_b32 v204, 1, v203
  v_and_b32 v204, 3, v204
  v_lshlrev_b32 v204, 1, v204
  v_bfe_u32 v223, v1, 1, 1
  v_add_u32 v223, 6, v223
  v_xor_b32 v223, v223, v204
  v_lshlrev_b32 v223, 4, v223
  v_lshlrev_b32 v203, 7, v203
  v_add_u32 v223, v223, v203
  v_and_b32 v203, 1, v1
  v_lshlrev_b32 v203, 3, v203
  v_add_u32 v223, v223, v203
  v_add_u32 v223, s30, v223
  v_mov_b32 v80, 0x3f803f80
  v_mov_b32 v81, 0x3f803f80
  v_mov_b32 v82, 0x3f803f80
  v_mov_b32 v83, 0x3f803f80
  v_mov_b32 v108, 0
  v_mov_b32 v109, 0
  v_mov_b32 v110, 0
  v_mov_b32 v111, 0
  v_mov_b32 v112, 0
  v_mov_b32 v113, 0
  v_mov_b32 v114, 0
  v_mov_b32 v115, 0
  v_mov_b32 v116, 0
  v_mov_b32 v117, 0
  v_mov_b32 v118, 0
  v_mov_b32 v119, 0
  v_mov_b32 v84, 0
  v_mov_b32 v85, 0
  v_mov_b32 v86, 0
  v_mov_b32 v87, 0
  v_mov_b32 v88, 0
  v_mov_b32 v89, 0
  v_mov_b32 v90, 0
  v_mov_b32 v91, 0
  v_mov_b32 v92, 0
  v_mov_b32 v93, 0
  v_mov_b32 v94, 0
  v_mov_b32 v95, 0
  v_mov_b32 v96, 0
  v_mov_b32 v97, 0
  v_mov_b32 v98, 0
  v_mov_b32 v99, 0
  v_lshlrev_b32 v184, 4, v1
  v_lshlrev_b32 v185, 2, v1
  v_lshrrev_b32 v32, 4, v1
  v_and_b32 v33, 15, v1
  v_mov_b32 v202, 0
  v_bfe_u32 v203, v1, 1, 1
  v_mul_u32_u24 v203, 0xaaaa, v203
  v_add_u32 v190, 0x4444, v203
  s_lshl_b32 s27, s17, 8
  s_lshl_b32 s28, s24, 10
  s_add_u32 s27, s27, s28
  v_add_u32 v188, s27, v185
  s_lshl_b32 s27, s17, 11
  s_add_u32 s27, s27, 81920
  v_add_u32 v186, s27, v184
  s_lshl_b32 s27, s17, 2
  s_add_u32 s27, s27, 90112
  v_lshl_add_u32 v192, v33, 4, s27
  s_lshl_b32 s27, s17, 9
  s_add_u32 s27, s27, 81920
  v_and_b32 v203, 3, v1
  v_lshlrev_b32 v203, 5, v203
  v_bfe_u32 v204, v1, 4, 1
  v_lshl_add_u32 v203, v204, 4, v203
  v_add_u32 v193, 90112, v203
  v_bfe_u32 v204, v1, 5, 1
  v_lshl_add_u32 v203, v204, 3, v203
  v_bfe_u32 v204, v1, 2, 2
  v_lshl_add_u32 v203, v204, 7, v203
  v_add_u32 v187, s27, v203
  s_mov_b32 s58, 0x00ff00ff
  s_mov_b32 s59, 0x00ff00ff
  s_mov_b32 s60, 0x3dd53b95
  s_mov_b32 s61, s60
  s_mul_i32 s31, s16, 10240
  s_add_u32 s31, s31, 131072
  s_lshl_b32 s33, s16, 17
  s_lshl_b32 s28, s17, 13
  s_add_u32 s33, s33, s28
  s_add_u32 s33, s33, 3407872
  s_lshl_b32 s27, s16, 22
  s_add_u32 s27, s27, 67108864
  s_mul_i32 s38, s17, 12288
  s_add_u32 s38, s38, s27
  s_add_u32 s38, s38, 98304
  s_lshr_b32 s28, s17, 1
  s_lshl_b32 s28, s28, 10
  s_add_u32 s27, s27, s28
  s_add_u32 s39, s27, 602112
  s_add_u32 s40, s27, 610304
  s_mul_i32 s36, s24, 16384
  s_lshl_b32 s27, s17, 11
  s_add_u32 s36, s36, s27
  s_add_u32 s36, s36, 16777216
  v_lshlrev_b32 v194, 2, v32
  v_lshl_add_u32 v194, v33, 4, v194
  s_lshr_b32 s37, s16, 2
  s_lshl_b32 s37, s37, 10
  s_and_b32 s27, s16, 3
  s_lshl_b32 s27, s27, 4
  s_mov_b64 s[56:57], 0xffff
  s_lshl_b64 s[56:57], s[56:57], s27
  s_not_b64 s[56:57], s[56:57]
  s_lshl_b32 s27, s16, 8
  s_mul_i32 s28, s17, 24
  v_mov_b32 v203, 72
  v_mov_b32 v204, s28
  v_cmp_gt_u32 vcc, 6, v1
  s_nop 1
  v_cndmask_b32 v203, v203, v204, vcc
  v_min_u32 v204, 40, v185
  v_add3_u32 v189, v203, v204, s27
  v_add_u32 v189, 4096, v189
  s_lshl_b32 s28, s17, 6
  s_add_u32 s27, s27, s28
  s_add_u32 s27, s27, 12288
  v_add_u32 v195, s27, v185
  v_subrev_u32 v203, 64, v185
  ds_bpermute_b32 v204, v203, v189
  v_cmp_gt_u32 vcc, 22, v1
  s_nop 1
  v_cndmask_b32 v218, 0, 2, vcc
  v_cmp_gt_u32 vcc, 16, v1
  s_nop 1
  v_cndmask_b32 v218, v218, 1, vcc
  s_waitcnt lgkmcnt(0)
  v_cndmask_b32 v195, v204, v195, vcc
  v_bfe_u32 v203, v1, 2, 1
  v_and_b32 v204, 3, v1
  v_lshl_add_u32 v203, v203, 3, v204
  v_lshl_add_u32 v203, v32, 4, v203
  v_lshlrev_b32 v203, 4, v203
  v_bfe_u32 v204, v1, 3, 1
  v_mul_u32_u24 v205, 1088, v204
  s_and_b32 s28, s17, 1
  s_lshl_b32 s27, s28, 11
  v_add3_u32 v212, v203, v205, s27
  v_xor_b32 v213, 64, v212
  s_lshl_b32 s27, s17, 12
  v_add_u32 v214, s27, v184
  v_xor_b32 v215, 64, v214
  s_lshl_b32 s27, s28, 3
  s_add_u32 s27, s27, 65536
  v_lshl_add_u32 v203, v204, 2, v203
  v_add_u32 v198, s27, v203
  v_add_u32 v217, 64, v198
  s_lshl_b32 s27, s17, 10
  s_add_u32 s27, s27, 65536
  v_add_u32 v200, s27, v184
  v_mul_u32_u24 v203, 1280, v33
  v_lshl_add_u32 v197, v32, 4, v203
  s_lshl_b32 s41, s16, 1
  s_lshr_b32 s27, s17, 1
  s_add_u32 s41, s41, s27
  s_mul_i32 s41, s41, 20480
  s_lshl_b32 s27, s24, 7
  s_add_u32 s41, s41, s27
  s_lshl_b32 s27, s28, 6
  s_add_u32 s41, s41, s27
  s_add_u32 s41, s41, 226492416
  s_lshl_b32 s27, s16, 11
  s_lshl_b32 s28, s24, 7
  s_add_u32 s27, s27, s28
  s_lshl_b32 s28, s17, 2
  s_add_u32 s27, s27, s28
  v_mov_b32 v196, s27
  s_mov_b32 s42, 2162688
  s_mov_b32 s25, 0
  v_and_b32 v204, 3, v1
  v_mov_b32 v205, 0
  v_mov_b32 v206, 0x3f80
  v_cmp_eq_u32 vcc, 0, v204
  s_nop 1
  v_cndmask_b32 v205, v205, v206, vcc
  v_mov_b32 v206, 0x3f800000
  v_cmp_eq_u32 vcc, 1, v204
  s_nop 1
  v_cndmask_b32 v205, v205, v206, vcc
  v_lshrrev_b32 v203, 2, v33
  v_mov_b32 v206, 0
  v_mov_b32 v122, 0x3f803f80
  v_mov_b32 v123, 0
  v_mov_b32 v158, 0
  v_mov_b32 v159, 0
  v_cmp_eq_u32 vcc, 0, v203
  s_nop 1
  v_cndmask_b32 v76, v206, v205, vcc
  v_cmp_eq_u32 vcc, 1, v203
  s_nop 1
  v_cndmask_b32 v77, v206, v205, vcc
  v_cmp_eq_u32 vcc, 2, v203
  s_nop 1
  v_cndmask_b32 v78, v206, v205, vcc
  v_cmp_eq_u32 vcc, 3, v203
  s_nop 1
  v_cndmask_b32 v79, v206, v205, vcc
  v_mov_b32 v144, 0
  v_mov_b32 v145, 0
  v_mov_b32 v146, 0
  v_mov_b32 v147, 0
  s_waitcnt vmcnt(0)
  ds_read_b64_tr_b16 a[0:1], v220 offset:0
  ds_read_b64_tr_b16 a[2:3], v220 offset:2048
  ds_read_b64_tr_b16 a[24:25], v221 offset:0
  ds_read_b64_tr_b16 a[26:27], v221 offset:2048
  ds_read_b64_tr_b16 a[48:49], v222 offset:0
  ds_read_b64_tr_b16 a[50:51], v222 offset:2048
  ds_read_b64_tr_b16 a[72:73], v223 offset:0
  ds_read_b64_tr_b16 a[74:75], v223 offset:2048
  s_waitcnt lgkmcnt(8)
  ds_read_b64_tr_b16 a[4:5], v220 offset:4096
  ds_read_b64_tr_b16 a[6:7], v220 offset:6144
  ds_read_b64_tr_b16 a[28:29], v221 offset:4096
  ds_read_b64_tr_b16 a[30:31], v221 offset:6144
  ds_read_b64_tr_b16 a[52:53], v222 offset:4096
  ds_read_b64_tr_b16 a[54:55], v222 offset:6144
  ds_read_b64_tr_b16 a[76:77], v223 offset:4096
  ds_read_b64_tr_b16 a[78:79], v223 offset:6144
  s_waitcnt lgkmcnt(8)
  ds_read_b64_tr_b16 a[8:9], v220 offset:8192
  ds_read_b64_tr_b16 a[10:11], v220 offset:10240
  ds_read_b64_tr_b16 a[32:33], v221 offset:8192
  ds_read_b64_tr_b16 a[34:35], v221 offset:10240
  ds_read_b64_tr_b16 a[56:57], v222 offset:8192
  ds_read_b64_tr_b16 a[58:59], v222 offset:10240
  ds_read_b64_tr_b16 a[80:81], v223 offset:8192
  ds_read_b64_tr_b16 a[82:83], v223 offset:10240
  s_waitcnt lgkmcnt(8)
  ds_read_b64_tr_b16 a[12:13], v220 offset:12288
  ds_read_b64_tr_b16 a[14:15], v220 offset:14336
  ds_read_b64_tr_b16 a[36:37], v221 offset:12288
  ds_read_b64_tr_b16 a[38:39], v221 offset:14336
  ds_read_b64_tr_b16 a[60:61], v222 offset:12288
  ds_read_b64_tr_b16 a[62:63], v222 offset:14336
  ds_read_b64_tr_b16 a[84:85], v223 offset:12288
  ds_read_b64_tr_b16 a[86:87], v223 offset:14336
  s_waitcnt lgkmcnt(8)
  ds_read_b64_tr_b16 a[16:17], v220 offset:16384
  ds_read_b64_tr_b16 a[18:19], v220 offset:18432
  ds_read_b64_tr_b16 a[40:41], v221 offset:16384
  ds_read_b64_tr_b16 a[42:43], v221 offset:18432
  ds_read_b64_tr_b16 a[64:65], v222 offset:16384
  ds_read_b64_tr_b16 a[66:67], v222 offset:18432
  ds_read_b64_tr_b16 a[88:89], v223 offset:16384
  ds_read_b64_tr_b16 a[90:91], v223 offset:18432
  s_waitcnt lgkmcnt(8)
  ds_read_b64_tr_b16 a[20:21], v220 offset:20480
  ds_read_b64_tr_b16 a[22:23], v220 offset:22528
  ds_read_b64_tr_b16 a[44:45], v221 offset:20480
  ds_read_b64_tr_b16 a[46:47], v221 offset:22528
  ds_read_b64_tr_b16 a[68:69], v222 offset:20480
  ds_read_b64_tr_b16 a[70:71], v222 offset:22528
  ds_read_b64_tr_b16 a[92:93], v223 offset:20480
  ds_read_b64_tr_b16 a[94:95], v223 offset:22528
  s_waitcnt lgkmcnt(8)
  s_waitcnt lgkmcnt(0)
  s_barrier
  s_lshl_b32 s26, s16, 2
  s_add_u32 s26, s26, 32
  v_mov_b32 v203, s26
  s_mov_b32 s26, 0
  s_mov_b64 exec, 1
gw_65:
  buffer_load_dword v204, v203, s[12:15], 0 offen sc1
  s_add_u32 s26, s26, 1
  s_cmp_gt_u32 s26, 65536
  s_cbranch_scc1 role_abort
  s_waitcnt vmcnt(0)
  v_cmp_gt_u32 vcc, 1, v204
  s_cbranch_vccz gk_66
  s_sleep 4
  s_branch gw_65
gk_66:
  s_mov_b64 exec, -1
  s_mov_b32 s26, 0
pw_67:
  buffer_load_dword v191, v189, s[8:11], 0 offen sc1
  s_add_u32 s26, s26, 1
  s_cmp_gt_u32 s26, 65536
  s_cbranch_scc1 role_abort
  s_waitcnt vmcnt(0)
pc_69:
  v_cmp_gt_u32 vcc, 1, v191
  s_nop 0
  s_and_b32 vcc_lo, vcc_lo, 0x400
  s_and_b32 vcc_hi, vcc_hi, 0x0
  s_cmp_eq_u64 vcc, 0
  s_cbranch_scc1 po_68
  s_sleep 16
  s_branch pw_67
po_68:
  v_readlane_b32 s27, v191, 10
  s_nop 0
  s_sub_u32 s27, s27, 1
  s_lshl_b32 s27, s27, 13
  s_add_u32 s36, s36, s27
w_pro:
  s_add_u32 s43, s25, 1
  s_mov_b32 s26, 0
  s_waitcnt vmcnt(0)
we_70:
  v_cmp_gt_u32 vcc, s43, v191
  s_nop 0
  s_and_b32 vcc_lo, vcc_lo, 0x3f
  s_cbranch_scc1 we_70_r
  s_add_u32 s27, s25, 0
  s_and_b32 s27, s27, 3
  s_mul_i32 s27, s27, 147456
  s_add_u32 s45, s38, s27
  s_add_u32 s46, s45, 4096
  s_add_u32 s47, s45, 6144
  s_add_u32 s48, s45, 10240
  buffer_load_dwordx4 a[96:99], v184, s[8:11], s45 offen offset:0 sc1
  buffer_load_dwordx4 a[100:103], v184, s[8:11], s45 offen offset:1024 sc1
  buffer_load_dwordx4 a[104:107], v184, s[8:11], s45 offen offset:2048 sc1
  buffer_load_dwordx4 a[108:111], v184, s[8:11], s45 offen offset:3072 sc1
  buffer_load_dwordx4 a[112:115], v184, s[8:11], s46 offen offset:0 sc1
  buffer_load_dwordx4 a[116:119], v184, s[8:11], s46 offen offset:1024 sc1
  buffer_load_dwordx4 a[120:123], v184, s[8:11], s47 offen offset:0 sc1
  buffer_load_dwordx4 a[124:127], v184, s[8:11], s47 offen offset:1024 sc1
  buffer_load_dwordx4 a[128:131], v184, s[8:11], s47 offen offset:2048 sc1
  buffer_load_dwordx4 a[132:135], v184, s[8:11], s47 offen offset:3072 sc1
  buffer_load_dwordx4 a[136:139], v184, s[8:11], s48 offen offset:0 sc1
  buffer_load_dwordx4 a[140:143], v184, s[8:11], s48 offen offset:1024 sc1
  s_waitcnt vmcnt(11)
  v_mfma_f32_16x16x32_bf16 v[48:51], a[96:99], a[0:3], 0
  v_mfma_f32_16x16x32_bf16 v[52:55], a[96:99], a[24:27], 0
  v_mfma_f32_16x16x32_bf16 v[56:59], a[96:99], a[48:51], 0
  v_mfma_f32_16x16x32_bf16 v[60:63], a[96:99], a[72:75], 0
  s_waitcnt vmcnt(10)
  v_mfma_f32_16x16x32_bf16 v[48:51], a[100:103], a[4:7], v[48:51]
  v_mfma_f32_16x16x32_bf16 v[52:55], a[100:103], a[28:31], v[52:55]
  v_mfma_f32_16x16x32_bf16 v[56:59], a[100:103], a[52:55], v[56:59]
  v_mfma_f32_16x16x32_bf16 v[60:63], a[100:103], a[76:79], v[60:63]
  s_waitcnt vmcnt(9)
  v_mfma_f32_16x16x32_bf16 v[48:51], a[104:107], a[8:11], v[48:51]
  v_mfma_f32_16x16x32_bf16 v[52:55], a[104:107], a[32:35], v[52:55]
  v_mfma_f32_16x16x32_bf16 v[56:59], a[104:107], a[56:59], v[56:59]
  v_mfma_f32_16x16x32_bf16 v[60:63], a[104:107], a[80:83], v[60:63]
  s_waitcnt vmcnt(8)
  v_mfma_f32_16x16x32_bf16 v[48:51], a[108:111], a[12:15], v[48:51]
  v_mfma_f32_16x16x32_bf16 v[52:55], a[108:111], a[36:39], v[52:55]
  v_mfma_f32_16x16x32_bf16 v[56:59], a[108:111], a[60:63], v[56:59]
  v_mfma_f32_16x16x32_bf16 v[60:63], a[108:111], a[84:87], v[60:63]
  s_waitcnt vmcnt(7)
  v_mfma_f32_16x16x32_bf16 v[48:51], a[112:115], a[16:19], v[48:51]
  v_mfma_f32_16x16x32_bf16 v[52:55], a[112:115], a[40:43], v[52:55]
  v_mfma_f32_16x16x32_bf16 v[56:59], a[112:115], a[64:67], v[56:59]
  v_mfma_f32_16x16x32_bf16 v[60:63], a[112:115], a[88:91], v[60:63]
  s_waitcnt vmcnt(6)
  v_mfma_f32_16x16x32_bf16 v[48:51], a[116:119], a[20:23], v[48:51]
  v_mfma_f32_16x16x32_bf16 v[52:55], a[116:119], a[44:47], v[52:55]
  v_mfma_f32_16x16x32_bf16 v[56:59], a[116:119], a[68:71], v[56:59]
  v_mfma_f32_16x16x32_bf16 v[60:63], a[116:119], a[92:95], v[60:63]
  s_nop 4
  v_cvt_pk_bf16_f32 v32, v48, v49
  v_cvt_pk_bf16_f32 v33, v50, v51
  v_cvt_pk_bf16_f32 v36, v52, v53
  v_cvt_pk_bf16_f32 v37, v54, v55
  v_cvt_pk_bf16_f32 v40, v56, v57
  v_cvt_pk_bf16_f32 v41, v58, v59
  v_cvt_pk_bf16_f32 v44, v60, v61
  v_cvt_pk_bf16_f32 v45, v62, v63
  s_waitcnt vmcnt(0)
.p2align 7
  s_nop 0
  s_nop 0
  s_nop 0
  s_nop 0
  s_nop 0
  s_nop 0
  s_nop 0
  s_nop 0
  s_nop 0
w_loop:
  v_mfma_f32_16x16x32_bf16 v[48:51], a[120:123], a[0:3], 0
  s_add_u32 s27, s25, 2
  s_and_b32 s27, s27, 3
  s_mul_i32 s28, s27, 24576
  v_mfma_f32_16x16x32_bf16 v[52:55], a[120:123], a[24:27], 0
  s_add_u32 s49, s39, s28
  s_add_u32 s50, s49, 4096
  s_add_u32 s51, s40, s28
  v_mfma_f32_16x16x32_bf16 v[56:59], a[120:123], a[48:51], 0
  s_lshl_b32 s28, s27, 14
  v_add_u32 v208, s28, v212
  v_add_u32 v209, s28, v213
  v_mfma_f32_16x16x32_bf16 v[60:63], a[120:123], a[72:75], 0
  s_lshl_b32 s28, s27, 12
  v_add_u32 v199, s28, v198
  v_add_u32 v216, s28, v217
  v_mfma_f32_16x16x32_bf16 v[48:51], a[124:127], a[4:7], v[48:51]
  ds_read_b128 a[144:147], v208 offset:0
  ds_read_b128 a[148:151], v209 offset:0
  ds_read_b128 a[152:155], v208 offset:4096
  buffer_load_dwordx4 a[176:179], v184, s[8:11], s49 offen offset:0 sc1
  v_mfma_f32_16x16x32_bf16 v[52:55], a[124:127], a[28:31], v[52:55]
  ds_read_b128 a[156:159], v209 offset:4096
  ds_read_b128 a[160:163], v208 offset:8192
  v_mfma_f32_16x16x32_bf16 v[56:59], a[124:127], a[52:55], v[56:59]
  ds_read_b128 a[164:167], v209 offset:8192
  ds_read_b128 a[168:171], v208 offset:12288
  ds_read_b128 a[172:175], v209 offset:12288
  v_mfma_f32_16x16x32_bf16 v[60:63], a[124:127], a[76:79], v[60:63]
  ds_read2st64_b32 v[160:161], v199 offset0:0 offset1:4
  ds_read2st64_b32 v[162:163], v199 offset0:8 offset1:12
  ds_read2st64_b32 v[164:165], v216 offset0:0 offset1:4
  v_mfma_f32_16x16x32_bf16 v[48:51], a[128:131], a[8:11], v[48:51]
  ds_read2st64_b32 v[166:167], v216 offset0:8 offset1:12
  s_cmp_ge_u32 s25, 4
  s_cselect_b32 s27, 327680, 0
  buffer_load_dwordx4 a[180:183], v184, s[8:11], s49 offen offset:2048 sc1
  v_mfma_f32_16x16x32_bf16 v[52:55], a[128:131], a[32:35], v[52:55]
  s_add_u32 s41, s41, s27
  v_add_u32 v219, s25, v218
  v_mfma_f32_16x16x32_bf16 v[56:59], a[128:131], a[56:59], v[56:59]
  v_min_u32 v219, 64, v219
  s_and_b32 s27, s25, 3
  s_lshl_b32 s28, s27, 15
  v_mfma_f32_16x16x32_bf16 v[60:63], a[128:131], a[80:83], v[60:63]
  s_add_u32 s34, s33, s28
  s_add_u32 s35, s34, 4096
  s_lshl_b32 s28, s27, 14
  v_mfma_f32_16x16x32_bf16 v[48:51], a[132:135], a[12:15], v[48:51]
  v_add_u32 v210, s28, v214
  v_add_u32 v211, s28, v215
  s_lshl_b32 s28, s27, 12
  buffer_load_dwordx4 a[184:187], v184, s[8:11], s50 offen offset:0 sc1
  v_mfma_f32_16x16x32_bf16 v[52:55], a[132:135], a[36:39], v[52:55]
  v_add_u32 v201, s28, v200
  s_mul_i32 s27, s27, 163840
  v_mfma_f32_16x16x32_bf16 v[56:59], a[132:135], a[60:63], v[56:59]
  s_add_u32 s27, s27, s36
  s_lshl_b32 s28, s16, 8
  s_add_u32 s52, s27, s28
  v_mfma_f32_16x16x32_bf16 v[60:63], a[132:135], a[84:87], v[60:63]
  s_xor_b32 s53, s52, 8192
  s_add_u32 s54, s27, s37
  s_xor_b32 s55, s54, 1024
  v_mfma_f32_16x16x32_bf16 v[48:51], a[136:139], a[16:19], v[48:51]
  s_add_u32 s44, s25, 1
  s_and_b32 s27, s44, 3
  s_mul_i32 s32, s27, 81920
  buffer_load_dwordx4 a[188:191], v184, s[8:11], s50 offen offset:2048 sc1
  v_mfma_f32_16x16x32_bf16 v[52:55], a[136:139], a[40:43], v[52:55]
  s_add_u32 s32, s32, s31
  s_add_u32 s43, s25, 2
  v_mfma_f32_16x16x32_bf16 v[56:59], a[136:139], a[64:67], v[56:59]
  s_min_u32 s43, s43, 64
  s_cmp_eq_u32 s25, 0
  s_cselect_b32 s43, 0, s43
  v_mfma_f32_16x16x32_bf16 v[60:63], a[136:139], a[88:91], v[60:63]
  s_add_u32 s27, s25, 1
  s_and_b32 s27, s27, 3
  s_mul_i32 s27, s27, 147456
  v_mfma_f32_16x16x32_bf16 v[48:51], a[140:143], a[20:23], v[48:51]
  s_add_u32 s45, s38, s27
  s_add_u32 s46, s45, 4096
  s_add_u32 s47, s45, 6144
  buffer_load_dwordx4 a[192:195], v184, s[8:11], s51 offen sc1
  v_mfma_f32_16x16x32_bf16 v[52:55], a[140:143], a[44:47], v[52:55]
  s_add_u32 s48, s45, 10240
  v_mfma_f32_16x16x32_bf16 v[56:59], a[140:143], a[68:71], v[56:59]
  v_mfma_f32_16x16x32_bf16 v[60:63], a[140:143], a[92:95], v[60:63]
  v_cvt_pk_bf16_f32 v34, v48, v49
  v_cvt_pk_bf16_f32 v35, v50, v51
  ds_write_b128 v210, v[32:35] offset:0
  s_nop 1
  v_cvt_pk_bf16_f32 v38, v52, v53
  v_cvt_pk_bf16_f32 v39, v54, v55
  ds_write_b128 v211, v[36:39] offset:1024
  s_mov_b64 exec, 0x3f01ff
  buffer_load_dword v180, v195, s[8:11], 0 offen sc1
  s_mov_b64 exec, -1
  v_cvt_pk_bf16_f32 v42, v56, v57
  v_cvt_pk_bf16_f32 v43, v58, v59
  ds_write_b128 v210, v[40:43] offset:2048
  v_cvt_pk_bf16_f32 v46, v60, v61
  v_cvt_pk_bf16_f32 v47, v62, v63
  ds_write_b128 v211, v[44:47] offset:3072
  s_mov_b32 s26, 0
  s_mov_b64 exec, 0x3f01ff
  buffer_load_dword v181, v195, s[8:11], 0 offen sc1
  s_nop 15
  buffer_load_dword v182, v195, s[8:11], 0 offen sc1
  s_nop 15
w_mk:
  buffer_load_dword v183, v195, s[8:11], 0 offen sc1
  s_add_u32 s26, s26, 1
  s_cmp_gt_u32 s26, 65536
  s_cbranch_scc1 chain_abort
  s_waitcnt vmcnt(3)
  v_cmp_gt_u32 vcc, v219, v180
  s_cbranch_vccz w_mk_ok
  buffer_load_dword v180, v195, s[8:11], 0 offen sc1
  s_waitcnt vmcnt(3)
  v_cmp_gt_u32 vcc, v219, v181
  s_cbranch_vccz w_mk_ok
  buffer_load_dword v181, v195, s[8:11], 0 offen sc1
  s_waitcnt vmcnt(3)
  v_cmp_gt_u32 vcc, v219, v182
  s_cbranch_vccz w_mk_ok
  buffer_load_dword v182, v195, s[8:11], 0 offen sc1
  s_waitcnt vmcnt(3)
  v_cmp_gt_u32 vcc, v219, v183
  s_cbranch_vccz w_mk_ok
  s_branch w_mk
w_mk_ok:
  s_mov_b64 exec, -1
  s_mov_b32 s26, 0
  s_nop 15
  s_nop 11
  buffer_load_dwordx4 v[4:7], v184, s[8:11], s35 offen offset:0 sc1
  buffer_load_dwordx4 v[8:11], v184, s[8:11], s35 offen offset:1024 sc1
  buffer_load_dwordx4 v[12:15], v184, s[8:11], s35 offen offset:2048 sc1
  s_nop 15
  s_nop 15
  s_nop 15
  s_nop 5
  buffer_load_dwordx4 v[20:23], v184, s[8:11], s34 offen offset:0 sc1
  buffer_load_dwordx4 v[24:27], v184, s[8:11], s34 offen offset:1024 sc1
  buffer_load_dwordx4 v[28:31], v184, s[8:11], s34 offen offset:2048 sc1
  buffer_load_dword v16, v185, s[8:11], s34 offen offset:3072 sc1
  buffer_load_dword v17, v185, s[8:11], s34 offen offset:3328 sc1
  buffer_load_dword v18, v185, s[8:11], s34 offen offset:3584 sc1
  s_waitcnt vmcnt(6)
w_gv:
  v_max3_u32 v203, v4, v8, v12
  v_cmp_eq_u32 vcc, -1, v203
  s_cbranch_vccnz w_gv_r
  v_smfmac_f32_16x16x64_bf16 v[84:87], v[4:7], a[0:7], v190
  v_smfmac_f32_16x16x64_bf16 v[88:91], v[4:7], a[24:31], v190
  v_smfmac_f32_16x16x64_bf16 v[92:95], v[4:7], a[48:55], v190
  buffer_load_dwordx4 a[96:99], v184, s[8:11], s45 offen offset:0 sc1
  v_smfmac_f32_16x16x64_bf16 v[96:99], v[4:7], a[72:79], v190
  v_smfmac_f32_16x16x64_bf16 v[84:87], v[8:11], a[8:15], v190
  v_smfmac_f32_16x16x64_bf16 v[88:91], v[8:11], a[32:39], v190
  v_smfmac_f32_16x16x64_bf16 v[92:95], v[8:11], a[56:63], v190
  buffer_load_dwordx4 a[100:103], v184, s[8:11], s45 offen offset:1024 sc1
  v_smfmac_f32_16x16x64_bf16 v[96:99], v[8:11], a[80:87], v190
  v_smfmac_f32_16x16x64_bf16 v[84:87], v[12:15], a[16:23], v190
  v_smfmac_f32_16x16x64_bf16 v[88:91], v[12:15], a[40:47], v190
  v_smfmac_f32_16x16x64_bf16 v[92:95], v[12:15], a[64:71], v190
  buffer_load_dwordx4 a[104:107], v184, s[8:11], s45 offen offset:2048 sc1
  v_smfmac_f32_16x16x64_bf16 v[96:99], v[12:15], a[88:95], v190
  s_cmp_eq_u32 s25, 63
  s_cbranch_scc1 w_last
  s_nop 1
  v_cvt_pk_bf16_f32 v100, v84, v85
  v_cvt_pk_bf16_f32 v101, v86, v87
  v_cvt_pk_bf16_f32 v104, v92, v93
  v_cvt_pk_bf16_f32 v105, v94, v95
  v_cvt_pk_bf16_f32 v102, v88, v89
  v_cvt_pk_bf16_f32 v103, v90, v91
  v_cvt_pk_bf16_f32 v106, v96, v97
  v_cvt_pk_bf16_f32 v107, v98, v99
  buffer_load_dwordx4 a[108:111], v184, s[8:11], s45 offen offset:3072 sc1
  s_waitcnt vmcnt(7)
w_gx:
  v_pk_add_f32 v[64:65], v[20:21], v[24:25]
  v_pk_add_f32 v[66:67], v[22:23], v[26:27]
  v_pk_add_f32 v[64:65], v[64:65], v[28:29]
  v_pk_add_f32 v[66:67], v[66:67], v[30:31]
  v_cmp_u_f32 vcc, v64, v64
  v_pk_mul_f32 v[64:65], v[64:65], s[60:61]
  v_pk_mul_f32 v[66:67], v[66:67], s[60:61]
  v_exp_f32 v64, v64
  s_cbranch_vccnz w_gx_r
  v_exp_f32 v65, v65
  v_exp_f32 v66, v66
  v_exp_f32 v67, v67
  s_waitcnt vmcnt(4)
w_gm:
  v_add_f32 v68, v16, v17
  v_cvt_pk_bf16_f32 v140, v64, v65
  v_cvt_pk_bf16_f32 v141, v66, v67
  v_add_f32 v68, v68, v18
  v_cmp_u_f32 vcc, v68, v68
  v_mov_b32_dpp v108, v140 quad_perm:[0,1,2,3] row_mask:0xf bank_mask:0x3
  v_mov_b32_dpp v109, v141 quad_perm:[0,1,2,3] row_mask:0xf bank_mask:0x3
  v_mul_f32 v68, s60, v68
  v_mov_b32_dpp v110, v140 row_ror:8 row_mask:0xf bank_mask:0x3
  v_mov_b32_dpp v111, v141 row_ror:8 row_mask:0xf bank_mask:0x3
  v_exp_f32 v68, v68
  s_cbranch_vccnz w_gm_r
  v_mfma_f32_16x16x32_bf16 v[72:75], v[80:83], v[108:111], 0
  buffer_load_dwordx4 a[112:115], v184, s[8:11], s46 offen offset:0 sc1
  v_mov_b32_dpp v112, v140 row_ror:8 row_mask:0xf bank_mask:0xc
  v_mov_b32_dpp v113, v141 row_ror:8 row_mask:0xf bank_mask:0xc
  v_mov_b32_dpp v114, v140 quad_perm:[0,1,2,3] row_mask:0xf bank_mask:0xc
  v_mov_b32_dpp v115, v141 quad_perm:[0,1,2,3] row_mask:0xf bank_mask:0xc
  v_mfma_f32_16x16x32_bf16 v[132:135], v[32:35], v[108:111], 0
  v_mov_b32_dpp v69, v68 row_ror:8 row_mask:0xf bank_mask:0xf
  v_cvt_pk_bf16_f32 v142, v68, v69
  v_mfma_f32_16x16x32_bf16 v[136:139], v[40:43], v[108:111], 0
  s_nop 0
  v_mov_b32_dpp v116, v142 quad_perm:[0,1,2,3] row_mask:0xf bank_mask:0x3
  v_mov_b32_dpp v117, v142 quad_perm:[0,1,2,3] row_mask:0xf bank_mask:0x3
  v_mfma_f32_16x16x32_bf16 v[132:135], v[36:39], v[112:115], v[132:135]
  v_mov_b32_dpp v118, v142 row_ror:8 row_mask:0xf bank_mask:0xc
  v_mov_b32_dpp v119, v142 row_ror:8 row_mask:0xf bank_mask:0xc
  v_mfma_f32_16x16x32_bf16 v[136:139], v[44:47], v[112:115], v[136:139]
  v_mfma_f32_16x16x16_bf16 v[72:75], v[122:123], v[116:117], v[72:75]
  buffer_load_dwordx4 a[116:119], v184, s[8:11], s46 offen offset:1024 sc1
  buffer_store_dwordx4 v[176:179], v197, s[8:11], s41 offen sc1
  v_mfma_f32_16x16x16_bf16 v[132:135], v[100:101], v[116:117], v[132:135]
  s_nop 1
  v_mfma_f32_16x16x16_bf16 v[136:139], v[104:105], v[116:117], v[136:139]
  v_mfma_f32_16x16x16_bf16 v[132:135], v[102:103], v[118:119], v[132:135]
  s_nop 0
  v_subrev_u32 v203, 0x21800000, v72
  v_rcp_f32 v120, v72
  v_mfma_f32_16x16x16_bf16 v[136:139], v[106:107], v[118:119], v[136:139]
  v_cmp_lt_u32 vcc, 0x50000000, v203
  ds_write_b32 v192, v120
  s_and_b64 vcc, vcc, s[58:59]
  s_cbranch_vccnz w_gz_r
w_gz:
  s_nop 0
  ds_write_b128 v186, v[132:135] offset:0
  s_nop 2
  ds_write_b128 v186, v[136:139] offset:1024
  s_waitcnt lgkmcnt(0)
  s_barrier
  ds_read_b128 v[100:103], v193
  ds_read_b64 v[124:125], v187 offset:0
  ds_read_b64 v[126:127], v187 offset:2048
  ds_read_b64 v[128:129], v187 offset:4096
  ds_read_b64 v[130:131], v187 offset:6144
  s_waitcnt lgkmcnt(3)
  v_pk_mul_f32 v[120:121], v[124:125], v[100:101] op_sel_hi:[1,0]
  s_waitcnt lgkmcnt(2)
  v_pk_fma_f32 v[120:121], v[126:127], v[100:101], v[120:121] op_sel:[0,1,0]
  s_waitcnt lgkmcnt(1)
  v_pk_fma_f32 v[120:121], v[128:129], v[102:103], v[120:121] op_sel_hi:[1,0,1]
  s_waitcnt lgkmcnt(0)
  v_pk_fma_f32 v[120:121], v[130:131], v[102:103], v[120:121] op_sel:[0,1,0]
  v_cvt_pk_bf16_f32 v120, v120, v121
  buffer_store_dword v120, v185, s[8:11], s53 offen sc1
  buffer_store_dword v120, v185, s[8:11], s52 offen sc1
  v_mfma_f32_16x16x32_bf16 v[168:171], a[144:147], a[176:179], 0
  v_pk_add_f32 v[84:85], v[84:85], v[86:87]
  v_pk_add_f32 v[88:89], v[88:89], v[90:91]
  v_pk_add_f32 v[92:93], v[92:93], v[94:95]
  v_mfma_f32_16x16x32_bf16 v[172:175], a[148:151], a[176:179], 0
  v_pk_add_f32 v[96:97], v[96:97], v[98:99]
  v_cvt_pk_bf16_f32 v72, v84, v85
  v_cvt_pk_bf16_f32 v73, v88, v89
  buffer_load_dwordx4 a[120:123], v184, s[8:11], s47 offen offset:0 sc1
  v_mfma_f32_16x16x32_bf16 v[168:171], a[152:155], a[180:183], v[168:171]
  v_cvt_pk_bf16_f32 v74, v92, v93
  v_cvt_pk_bf16_f32 v75, v96, v97
  v_mfma_f32_16x16x32_bf16 v[172:175], a[156:159], a[180:183], v[172:175]
  ds_write_b128 v201, v[72:75]
  v_mov_b32 v84, 0
  v_mov_b32 v85, 0
  v_mfma_f32_16x16x32_bf16 v[168:171], a[160:163], a[184:187], v[168:171]
  v_mov_b32 v86, 0
  v_mov_b32 v87, 0
  v_mov_b32 v88, 0
  v_mfma_f32_16x16x32_bf16 v[172:175], a[164:167], a[184:187], v[172:175]
  v_mov_b32 v89, 0
  v_mov_b32 v90, 0
  v_mov_b32 v91, 0
  buffer_load_dwordx4 a[124:127], v184, s[8:11], s47 offen offset:1024 sc1
  v_mfma_f32_16x16x32_bf16 v[168:171], a[168:171], a[188:191], v[168:171]
  v_mov_b32 v92, 0
  v_mov_b32 v93, 0
  v_mfma_f32_16x16x32_bf16 v[172:175], a[172:175], a[188:191], v[172:175]
  v_mov_b32 v94, 0
  v_mov_b32 v95, 0
  v_mov_b32 v96, 0
  v_mfma_f32_16x16x32_bf16 v[168:171], v[160:163], a[192:195], v[168:171]
  v_mov_b32 v97, 0
  v_mov_b32 v98, 0
  v_mov_b32 v99, 0
  v_mfma_f32_16x16x32_bf16 v[172:175], v[164:167], a[192:195], v[172:175]
  s_waitcnt vmcnt(5)
  buffer_load_dwordx4 a[128:131], v184, s[8:11], s47 offen offset:2048 sc1
  v_mfma_f32_16x16x32_bf16 v[48:51], a[96:99], a[0:3], 0
  v_mfma_f32_16x16x32_bf16 v[52:55], a[96:99], a[24:27], 0
  v_cvt_pk_bf16_f32 v176, v168, v169
  v_cvt_pk_bf16_f32 v177, v170, v171
  v_mfma_f32_16x16x32_bf16 v[56:59], a[96:99], a[48:51], 0
  s_nop 0
  v_cvt_pk_bf16_f32 v178, v172, v173
  v_cvt_pk_bf16_f32 v179, v174, v175
  v_mfma_f32_16x16x32_bf16 v[60:63], a[96:99], a[72:75], 0
  buffer_load_dwordx4 a[132:135], v184, s[8:11], s47 offen offset:3072 sc1
  v_mfma_f32_16x16x32_bf16 v[48:51], a[100:103], a[4:7], v[48:51]
  v_mfma_f32_16x16x32_bf16 v[52:55], a[100:103], a[28:31], v[52:55]
  v_mfma_f32_16x16x32_bf16 v[56:59], a[100:103], a[52:55], v[56:59]
  v_mfma_f32_16x16x32_bf16 v[60:63], a[100:103], a[76:79], v[60:63]
  buffer_load_dwordx4 a[136:139], v184, s[8:11], s48 offen offset:0 sc1
  v_mfma_f32_16x16x32_bf16 v[48:51], a[104:107], a[8:11], v[48:51]
  v_mfma_f32_16x16x32_bf16 v[52:55], a[104:107], a[32:35], v[52:55]
  v_mfma_f32_16x16x32_bf16 v[56:59], a[104:107], a[56:59], v[56:59]
  v_mfma_f32_16x16x32_bf16 v[60:63], a[104:107], a[80:83], v[60:63]
  buffer_load_dwordx4 a[140:143], v184, s[8:11], s48 offen offset:1024 sc1
  v_mfma_f32_16x16x32_bf16 v[48:51], a[108:111], a[12:15], v[48:51]
  v_mfma_f32_16x16x32_bf16 v[52:55], a[108:111], a[36:39], v[52:55]
  v_mfma_f32_16x16x32_bf16 v[56:59], a[108:111], a[60:63], v[56:59]
  v_mfma_f32_16x16x32_bf16 v[60:63], a[108:111], a[84:87], v[60:63]
  buffer_load_dword v191, v189, s[8:11], 0 offen sc1
  v_mfma_f32_16x16x32_bf16 v[48:51], a[112:115], a[16:19], v[48:51]
  v_mfma_f32_16x16x32_bf16 v[52:55], a[112:115], a[40:43], v[52:55]
  v_mfma_f32_16x16x32_bf16 v[56:59], a[112:115], a[64:67], v[56:59]
  v_mfma_f32_16x16x32_bf16 v[60:63], a[112:115], a[88:91], v[60:63]
  v_mfma_f32_16x16x32_bf16 v[48:51], a[116:119], a[20:23], v[48:51]
  v_mfma_f32_16x16x32_bf16 v[52:55], a[116:119], a[44:47], v[52:55]
  v_mfma_f32_16x16x32_bf16 v[56:59], a[116:119], a[68:71], v[56:59]
  v_mfma_f32_16x16x32_bf16 v[60:63], a[116:119], a[92:95], v[60:63]
  s_nop 2
  s_nop 3
  v_cvt_pk_bf16_f32 v32, v48, v49
  v_cvt_pk_bf16_f32 v33, v50, v51
  s_nop 1
  v_cvt_pk_bf16_f32 v36, v52, v53
  v_cvt_pk_bf16_f32 v37, v54, v55
  s_nop 1
  v_cvt_pk_bf16_f32 v40, v56, v57
  v_cvt_pk_bf16_f32 v41, v58, v59
  s_nop 1
  v_cvt_pk_bf16_f32 v44, v60, v61
  v_cvt_pk_bf16_f32 v45, v62, v63
  s_waitcnt vmcnt(0)
we_71:
  v_cmp_gt_u32 vcc, s25, v191
  s_nop 0
  s_and_b32 vcc_lo, vcc_lo, 0x3c0
  s_cbranch_scc1 we_71_r
  s_add_u32 s25, s25, 1
  s_sub_u32 s27, s25, 9
  s_cmp_lt_u32 s27, 10
  s_cbranch_scc1 w_sent
  s_cmp_lg_u32 s25, 63
  s_cbranch_scc1 w_loop
  s_add_u32 s27, s41, 327680
  s_nop 15
  buffer_store_dwordx4 v[176:179], v197, s[8:11], s27 offen sc1
  s_branch w_loop
w_last:
  s_add_u32 s41, s41, 327680
  buffer_load_dword v191, v189, s[8:11], 0 offen sc1
  v_pk_add_f32 v[84:85], v[84:85], v[86:87]
  v_pk_add_f32 v[88:89], v[88:89], v[90:91]
  v_pk_add_f32 v[92:93], v[92:93], v[94:95]
  s_nop 0
  v_pk_add_f32 v[96:97], v[96:97], v[98:99]
  v_cvt_pk_bf16_f32 v72, v84, v85
  v_cvt_pk_bf16_f32 v73, v88, v89
  v_cvt_pk_bf16_f32 v74, v92, v93
  v_cvt_pk_bf16_f32 v75, v96, v97
  ds_write_b128 v201, v[72:75]
  v_mfma_f32_16x16x32_bf16 v[168:171], a[144:147], a[176:179], 0
  v_mfma_f32_16x16x32_bf16 v[172:175], a[148:151], a[176:179], 0
  v_mfma_f32_16x16x32_bf16 v[168:171], a[152:155], a[180:183], v[168:171]
  v_mfma_f32_16x16x32_bf16 v[172:175], a[156:159], a[180:183], v[172:175]
  v_mfma_f32_16x16x32_bf16 v[168:171], a[160:163], a[184:187], v[168:171]
  v_mfma_f32_16x16x32_bf16 v[172:175], a[164:167], a[184:187], v[172:175]
  v_mfma_f32_16x16x32_bf16 v[168:171], a[168:171], a[188:191], v[168:171]
  v_mfma_f32_16x16x32_bf16 v[172:175], a[172:175], a[188:191], v[172:175]
  v_mfma_f32_16x16x32_bf16 v[168:171], v[160:163], a[192:195], v[168:171]
  v_mfma_f32_16x16x32_bf16 v[172:175], v[164:167], a[192:195], v[172:175]
  s_add_u32 s27, s25, 3
  s_and_b32 s27, s27, 3
  s_mul_i32 s28, s27, 24576
  s_add_u32 s49, s39, s28
  s_add_u32 s50, s49, 4096
  s_add_u32 s51, s40, s28
  s_lshl_b32 s28, s27, 14
  v_add_u32 v208, s28, v212
  v_add_u32 v209, s28, v213
  s_lshl_b32 s28, s27, 12
  v_add_u32 v199, s28, v198
  v_add_u32 v216, s28, v217
  s_mov_b32 s26, 0
  s_waitcnt vmcnt(0) lgkmcnt(0)
  s_barrier
we_72:
  v_cmp_gt_u32 vcc, 63, v191
  s_nop 0
  s_and_b32 vcc_lo, vcc_lo, 0x3c0
  s_cbranch_scc1 we_72_r
  buffer_load_dwordx4 a[176:179], v184, s[8:11], s49 offen offset:0 sc1
  buffer_load_dwordx4 a[180:183], v184, s[8:11], s49 offen offset:2048 sc1
  buffer_load_dwordx4 a[184:187], v184, s[8:11], s50 offen offset:0 sc1
  buffer_load_dwordx4 a[188:191], v184, s[8:11], s50 offen offset:2048 sc1
  buffer_load_dwordx4 a[192:195], v184, s[8:11], s51 offen sc1
  ds_read_b128 a[144:147], v208 offset:0
  ds_read_b128 a[148:151], v209 offset:0
  ds_read_b128 a[152:155], v208 offset:4096
  ds_read_b128 a[156:159], v209 offset:4096
  ds_read_b128 a[160:163], v208 offset:8192
  ds_read_b128 a[164:167], v209 offset:8192
  ds_read_b128 a[168:171], v208 offset:12288
  ds_read_b128 a[172:175], v209 offset:12288
  ds_read2st64_b32 v[160:161], v199 offset0:0 offset1:4
  ds_read2st64_b32 v[162:163], v199 offset0:8 offset1:12
  ds_read2st64_b32 v[164:165], v216 offset0:0 offset1:4
  ds_read2st64_b32 v[166:167], v216 offset0:8 offset1:12
  v_cvt_pk_bf16_f32 v152, v168, v169
  v_cvt_pk_bf16_f32 v153, v170, v171
  v_cvt_pk_bf16_f32 v154, v172, v173
  v_cvt_pk_bf16_f32 v155, v174, v175
  s_mov_b32 s29, s41
  s_waitcnt lgkmcnt(0)
  s_waitcnt vmcnt(4)
  v_mfma_f32_16x16x32_bf16 v[168:171], a[144:147], a[176:179], 0
  v_mfma_f32_16x16x32_bf16 v[172:175], a[148:151], a[176:179], 0
  s_waitcnt vmcnt(3)
  v_mfma_f32_16x16x32_bf16 v[168:171], a[152:155], a[180:183], v[168:171]
  v_mfma_f32_16x16x32_bf16 v[172:175], a[156:159], a[180:183], v[172:175]
  s_waitcnt vmcnt(2)
  v_mfma_f32_16x16x32_bf16 v[168:171], a[160:163], a[184:187], v[168:171]
  v_mfma_f32_16x16x32_bf16 v[172:175], a[164:167], a[184:187], v[172:175]
  s_waitcnt vmcnt(1)
  v_mfma_f32_16x16x32_bf16 v[168:171], a[168:171], a[188:191], v[168:171]
  v_mfma_f32_16x16x32_bf16 v[172:175], a[172:175], a[188:191], v[172:175]
  s_waitcnt vmcnt(0)
  v_mfma_f32_16x16x32_bf16 v[168:171], v[160:163], a[192:195], v[168:171]
  v_mfma_f32_16x16x32_bf16 v[172:175], v[164:167], a[192:195], v[172:175]
  s_nop 6
  v_cvt_pk_bf16_f32 v176, v168, v169
  v_cvt_pk_bf16_f32 v177, v170, v171
  v_cvt_pk_bf16_f32 v178, v172, v173
  v_cvt_pk_bf16_f32 v179, v174, v175
  s_add_u32 s41, s41, 327680
  buffer_store_dwordx4 v[176:179], v197, s[8:11], s41 offen sc1
  buffer_store_dwordx4 v[152:155], v197, s[8:11], s29 offen sc1
  s_add_u32 s27, s25, 4
  s_and_b32 s27, s27, 3
  s_mul_i32 s28, s27, 24576
  s_add_u32 s49, s39, s28
  s_add_u32 s50, s49, 4096
  s_add_u32 s51, s40, s28
  s_lshl_b32 s28, s27, 14
  v_add_u32 v208, s28, v212
  v_add_u32 v209, s28, v213
  s_lshl_b32 s28, s27, 12
  v_add_u32 v199, s28, v198
  v_add_u32 v216, s28, v217
  ds_read_b128 a[144:147], v208 offset:0
  ds_read_b128 a[148:151], v209 offset:0
  ds_read_b128 a[152:155], v208 offset:4096
  ds_read_b128 a[156:159], v209 offset:4096
  ds_read_b128 a[160:163], v208 offset:8192
  ds_read_b128 a[164:167], v209 offset:8192
  ds_read_b128 a[168:171], v208 offset:12288
  ds_read_b128 a[172:175], v209 offset:12288
  ds_read2st64_b32 v[160:161], v199 offset0:0 offset1:4
  ds_read2st64_b32 v[162:163], v199 offset0:8 offset1:12
  ds_read2st64_b32 v[164:165], v216 offset0:0 offset1:4
  ds_read2st64_b32 v[166:167], v216 offset0:8 offset1:12
  s_mov_b32 s26, 0
pw_73:
  buffer_load_dword v191, v189, s[8:11], 0 offen sc1
  s_add_u32 s26, s26, 1
  s_cmp_gt_u32 s26, 65536
  s_cbranch_scc1 role_abort
  s_waitcnt vmcnt(0)
pc_75:
  v_cmp_gt_u32 vcc, 64, v191
  s_nop 0
  s_and_b32 vcc_lo, vcc_lo, 0x3c0
  s_and_b32 vcc_hi, vcc_hi, 0x0
  s_cmp_eq_u64 vcc, 0
  s_cbranch_scc1 po_74
  s_sleep 1
  s_branch pw_73
po_74:
  buffer_load_dwordx4 a[176:179], v184, s[8:11], s49 offen offset:0 sc1
  buffer_load_dwordx4 a[180:183], v184, s[8:11], s49 offen offset:2048 sc1
  buffer_load_dwordx4 a[184:187], v184, s[8:11], s50 offen offset:0 sc1
  buffer_load_dwordx4 a[188:191], v184, s[8:11], s50 offen offset:2048 sc1
  buffer_load_dwordx4 a[192:195], v184, s[8:11], s51 offen sc1
  s_waitcnt lgkmcnt(0)
  s_waitcnt vmcnt(4)
  v_mfma_f32_16x16x32_bf16 v[168:171], a[144:147], a[176:179], 0
  v_mfma_f32_16x16x32_bf16 v[172:175], a[148:151], a[176:179], 0
  s_waitcnt vmcnt(3)
  v_mfma_f32_16x16x32_bf16 v[168:171], a[152:155], a[180:183], v[168:171]
  v_mfma_f32_16x16x32_bf16 v[172:175], a[156:159], a[180:183], v[172:175]
  s_waitcnt vmcnt(2)
  v_mfma_f32_16x16x32_bf16 v[168:171], a[160:163], a[184:187], v[168:171]
  v_mfma_f32_16x16x32_bf16 v[172:175], a[164:167], a[184:187], v[172:175]
  s_waitcnt vmcnt(1)
  v_mfma_f32_16x16x32_bf16 v[168:171], a[168:171], a[188:191], v[168:171]
  v_mfma_f32_16x16x32_bf16 v[172:175], a[172:175], a[188:191], v[172:175]
  s_waitcnt vmcnt(0)
  v_mfma_f32_16x16x32_bf16 v[168:171], v[160:163], a[192:195], v[168:171]
  v_mfma_f32_16x16x32_bf16 v[172:175], v[164:167], a[192:195], v[172:175]
  s_nop 6
  v_cvt_pk_bf16_f32 v176, v168, v169
  v_cvt_pk_bf16_f32 v177, v170, v171
  v_cvt_pk_bf16_f32 v178, v172, v173
  v_cvt_pk_bf16_f32 v179, v174, v175
  s_add_u32 s41, s41, 327680
  buffer_store_dwordx4 v[176:179], v197, s[8:11], s41 offen sc1
  s_endpgm
we_70_r:
  s_sleep 1
  buffer_load_dword v191, v189, s[8:11], 0 offen sc1
  s_add_u32 s26, s26, 1
  s_cmp_gt_u32 s26, 65536
  s_cbranch_scc1 chain_abort
  s_waitcnt vmcnt(0)
  s_branch we_70
w_gx_r:
  v_max3_u32 v205, v20, v21, v22
  v_max_u32 v205, v205, v23
  v_cmp_eq_u32 vcc, -1, v205
  s_cbranch_vccz w_gx_s0
  s_mov_b64 exec, vcc
  buffer_load_dwordx4 v[20:23], v184, s[8:11], s34 offen offset:0 sc1
  s_mov_b64 exec, -1
w_gx_s0:
  v_max3_u32 v205, v24, v25, v26
  v_max_u32 v205, v205, v27
  v_cmp_eq_u32 vcc, -1, v205
  s_cbranch_vccz w_gx_s1
  s_mov_b64 exec, vcc
  buffer_load_dwordx4 v[24:27], v184, s[8:11], s34 offen offset:1024 sc1
  s_mov_b64 exec, -1
w_gx_s1:
  v_max3_u32 v205, v28, v29, v30
  v_max_u32 v205, v205, v31
  v_cmp_eq_u32 vcc, -1, v205
  s_cbranch_vccz w_gx_s2
  s_mov_b64 exec, vcc
  buffer_load_dwordx4 v[28:31], v184, s[8:11], s34 offen offset:2048 sc1
  s_mov_b64 exec, -1
w_gx_s2:
  buffer_load_dword v16, v185, s[8:11], s34 offen offset:3072 sc1
  buffer_load_dword v17, v185, s[8:11], s34 offen offset:3328 sc1
  buffer_load_dword v18, v185, s[8:11], s34 offen offset:3584 sc1
  s_add_u32 s26, s26, 1
  s_cmp_gt_u32 s26, 65536
  s_cbranch_scc1 chain_abort
  s_waitcnt vmcnt(0)
  s_branch w_gx
w_gm_r:
  v_max3_u32 v205, v16, v17, v18
  v_cmp_eq_u32 vcc, -1, v205
  s_cbranch_vccz w_gm_s0
  s_mov_b64 exec, vcc
  buffer_load_dword v16, v185, s[8:11], s34 offen offset:3072 sc1
  buffer_load_dword v17, v185, s[8:11], s34 offen offset:3328 sc1
  buffer_load_dword v18, v185, s[8:11], s34 offen offset:3584 sc1
  s_mov_b64 exec, -1
w_gm_s0:
  s_add_u32 s26, s26, 1
  s_cmp_gt_u32 s26, 65536
  s_cbranch_scc1 chain_abort
  s_waitcnt vmcnt(0)
  s_branch w_gm
w_gv_r:
  v_max3_u32 v205, v4, v5, v6
  v_max_u32 v205, v205, v7
  v_cmp_eq_u32 vcc, -1, v205
  s_cbranch_vccz w_gv_s0
  s_mov_b64 exec, vcc
  buffer_load_dwordx4 v[4:7], v184, s[8:11], s35 offen offset:0 sc1
  s_mov_b64 exec, -1
w_gv_s0:
  v_max3_u32 v205, v8, v9, v10
  v_max_u32 v205, v205, v11
  v_cmp_eq_u32 vcc, -1, v205
  s_cbranch_vccz w_gv_s1
  s_mov_b64 exec, vcc
  buffer_load_dwordx4 v[8:11], v184, s[8:11], s35 offen offset:1024 sc1
  s_mov_b64 exec, -1
w_gv_s1:
  v_max3_u32 v205, v12, v13, v14
  v_max_u32 v205, v205, v15
  v_cmp_eq_u32 vcc, -1, v205
  s_cbranch_vccz w_gv_s2
  s_mov_b64 exec, vcc
  buffer_load_dwordx4 v[12:15], v184, s[8:11], s35 offen offset:2048 sc1
  s_mov_b64 exec, -1
w_gv_s2:
  buffer_load_dwordx4 v[20:23], v184, s[8:11], s34 offen offset:0 sc1
  buffer_load_dwordx4 v[24:27], v184, s[8:11], s34 offen offset:1024 sc1
  buffer_load_dwordx4 v[28:31], v184, s[8:11], s34 offen offset:2048 sc1
  buffer_load_dword v16, v185, s[8:11], s34 offen offset:3072 sc1
  buffer_load_dword v17, v185, s[8:11], s34 offen offset:3328 sc1
  buffer_load_dword v18, v185, s[8:11], s34 offen offset:3584 sc1
  s_add_u32 s26, s26, 1
  s_cmp_gt_u32 s26, 65536
  s_cbranch_scc1 chain_abort
  s_waitcnt vmcnt(0)
  s_branch w_gv
w_gz_r:
  v_pk_add_f32 v[64:65], v[20:21], v[24:25]
  v_pk_add_f32 v[66:67], v[22:23], v[26:27]
  v_pk_add_f32 v[64:65], v[64:65], v[28:29]
  v_pk_add_f32 v[66:67], v[66:67], v[30:31]
  v_add_f32 v68, v16, v17
  v_add_f32 v68, v68, v18
  v_max3_f32 v203, v64, v65, v66
  v_max3_f32 v203, v203, v67, v68
  s_nop 1
  v_max_f32_dpp v203, v203, v203 row_ror:8 row_mask:0xf bank_mask:0xf
  v_mov_b32 v204, v203
  s_nop 1
  v_permlane16_swap_b32 v203, v204
  v_max_f32 v203, v203, v204
  v_mov_b32 v204, v203
  s_nop 1
  v_permlane32_swap_b32 v203, v204
  v_max_f32 v203, v203, v204
  v_sub_f32 v64, v64, v203
  v_mul_f32 v64, s60, v64
  v_exp_f32 v64, v64
  v_sub_f32 v65, v65, v203
  v_mul_f32 v65, s60, v65
  v_exp_f32 v65, v65
  v_sub_f32 v66, v66, v203
  v_mul_f32 v66, s60, v66
  v_exp_f32 v66, v66
  v_sub_f32 v67, v67, v203
  v_mul_f32 v67, s60, v67
  v_exp_f32 v67, v67
  v_sub_f32 v68, v68, v203
  v_mul_f32 v68, s60, v68
  v_exp_f32 v68, v68
  v_cvt_pk_bf16_f32 v140, v64, v65
  v_cvt_pk_bf16_f32 v141, v66, v67
  s_nop 0
  v_mov_b32_dpp v108, v140 quad_perm:[0,1,2,3] row_mask:0xf bank_mask:0x3
  v_mov_b32_dpp v109, v141 quad_perm:[0,1,2,3] row_mask:0xf bank_mask:0x3
  v_mov_b32_dpp v110, v140 row_ror:8 row_mask:0xf bank_mask:0x3
  v_mov_b32_dpp v111, v141 row_ror:8 row_mask:0xf bank_mask:0x3
  v_mov_b32_dpp v112, v140 row_ror:8 row_mask:0xf bank_mask:0xc
  v_mov_b32_dpp v113, v141 row_ror:8 row_mask:0xf bank_mask:0xc
  v_mov_b32_dpp v114, v140 quad_perm:[0,1,2,3] row_mask:0xf bank_mask:0xc
  v_mov_b32_dpp v115, v141 quad_perm:[0,1,2,3] row_mask:0xf bank_mask:0xc
  v_mov_b32_dpp v69, v68 row_ror:8 row_mask:0xf bank_mask:0xf
  v_cvt_pk_bf16_f32 v142, v68, v69
  s_nop 1
  v_mov_b32_dpp v116, v142 quad_perm:[0,1,2,3] row_mask:0xf bank_mask:0x3
  v_mov_b32_dpp v117, v142 quad_perm:[0,1,2,3] row_mask:0xf bank_mask:0x3
  v_mov_b32_dpp v118, v142 row_ror:8 row_mask:0xf bank_mask:0xc
  v_mov_b32_dpp v119, v142 row_ror:8 row_mask:0xf bank_mask:0xc
  v_mfma_f32_16x16x32_bf16 v[72:75], v[80:83], v[108:111], 0
  v_mfma_f32_16x16x32_bf16 v[132:135], v[32:35], v[108:111], 0
  v_mfma_f32_16x16x32_bf16 v[136:139], v[40:43], v[108:111], 0
  v_mfma_f32_16x16x32_bf16 v[132:135], v[36:39], v[112:115], v[132:135]
  v_mfma_f32_16x16x32_bf16 v[136:139], v[44:47], v[112:115], v[136:139]
  s_nop 1
  v_mfma_f32_16x16x16_bf16 v[72:75], v[122:123], v[116:117], v[72:75]
  s_nop 1
  v_mfma_f32_16x16x16_bf16 v[132:135], v[100:101], v[116:117], v[132:135]
  v_mfma_f32_16x16x16_bf16 v[136:139], v[104:105], v[116:117], v[136:139]
  v_mfma_f32_16x16x16_bf16 v[132:135], v[102:103], v[118:119], v[132:135]
  v_mfma_f32_16x16x16_bf16 v[136:139], v[106:107], v[118:119], v[136:139]
  s_nop 1
  v_rcp_f32 v120, v72
  s_nop 0
  ds_write_b32 v192, v120
  s_branch w_gz
we_71_r:
  s_sleep 1
  buffer_load_dword v191, v189, s[8:11], 0 offen sc1
  s_add_u32 s26, s26, 1
  s_cmp_gt_u32 s26, 65536
  s_cbranch_scc1 chain_abort
  s_waitcnt vmcnt(0)
  s_branch we_71
w_sent:
  s_add_u32 s27, s41, 16056320
  buffer_store_dwordx4 v[152:155], v197, s[8:11], s27 offen sc1
  s_branch w_loop
we_72_r:
  s_sleep 1
  buffer_load_dword v191, v189, s[8:11], 0 offen sc1
  s_add_u32 s26, s26, 1
  s_cmp_gt_u32 s26, 65536
  s_cbranch_scc1 chain_abort
  s_waitcnt vmcnt(0)
  s_branch we_72
.section .rodata,"a"
.p2align 6
.amdhsa_kernel main_kernel
  .amdhsa_next_free_vgpr 512
  .amdhsa_next_free_sgpr 102
  .amdhsa_accum_offset 256
  .amdhsa_group_segment_fixed_size 0
  .amdhsa_kernarg_size 136
  .amdhsa_user_sgpr_count 2
  .amdhsa_user_sgpr_kernarg_segment_ptr 1
  .amdhsa_system_sgpr_workgroup_id_x 1
.end_amdhsa_kernel
```

```asm
; @launch grid=(256,1,1) block=(256,1,1) lds=163840
.amdgcn_target "amdgcn-amd-amdhsa--gfx950"
.text
.globl adaLN_cond__memory_aug_recurrent_mem_tr__moe_arch_mod__prompt_kernel
.p2align 8
.type adaLN_cond__memory_aug_recurrent_mem_tr__moe_arch_mod__prompt_kernel,@function
adaLN_cond__memory_aug_recurrent_mem_tr__moe_arch_mod__prompt_kernel:
  s_load_dwordx2 s[8:9], s[0:1], 128
  s_mov_b32 s10, 268435456
  s_mov_b32 s11, 0x00020000
  s_load_dwordx2 s[12:13], s[0:1], 120
  s_mov_b32 s14, 256
  s_mov_b32 s15, 0x00020000
  s_load_dword s4, s[0:1], 0
  s_load_dword s5, s[0:1], 64
  s_getreg_b32 s16, hwreg(HW_REG_XCC_ID)
  s_and_b32 s16, s16, 7
  v_and_b32 v1, 63, v0
  v_lshrrev_b32 v2, 6, v0
  s_nop 0
  v_readfirstlane_b32 s17, v2
  v_mov_b32 v3, 1
  s_lshl_b32 s3, s16, 2
  v_mov_b32 v4, s3
  v_mov_b32 v5, 0
  s_waitcnt lgkmcnt(0)
  v_cmp_eq_u32 vcc, 0, v0
  s_nop 0
  s_and_b64 exec, exec, vcc
  s_cbranch_execz main_tk
  buffer_atomic_add v3, v4, s[12:15], 0 offen sc0
  s_waitcnt vmcnt(0)
  ds_write_b32 v5, v3
  s_waitcnt lgkmcnt(0)
main_tk:
  s_mov_b64 exec, -1
  s_barrier
  ds_read_b32 v3, v5
  s_waitcnt lgkmcnt(0)
  v_readfirstlane_b32 s18, v3
  s_barrier
  s_cmp_ge_u32 s18, 32
  s_cbranch_scc1 role_none
  s_sub_u32 s18, 31, s18
  s_cmp_lt_u32 s18, 18
  s_cbranch_scc1 role_b
  s_cmp_lt_u32 s18, 27
  s_cbranch_scc1 role_w
  s_cmp_gt_u32 s18, 28
  s_cbranch_scc1 role_r
  s_sub_u32 s20, 28, s18
  s_lshl_b32 s20, s20, 2
  s_add_u32 s20, s20, s17
  s_load_dwordx2 s[24:25], s[0:1], 8
  s_mov_b32 s26, 10240
  s_mov_b32 s27, 0x00020000
  v_lshlrev_b32 v2, 4, v1
  v_lshlrev_b32 v3, 7, v1
  v_mov_b32 v4, -1
  v_mov_b32 v5, -1
  v_mov_b32 v6, -1
  v_mov_b32 v7, -1
  v_mov_b32 v8, 0
  v_mov_b32 v9, 0
  v_mov_b32 v10, 0
  v_mov_b32 v11, 0
  v_lshrrev_b32 v12, 4, v1
  v_and_b32 v13, 15, v1
  v_lshlrev_b32 v13, 4, v13
  v_lshl_add_u32 v14, v12, 12, v13
  v_lshl_add_u32 v15, v12, 11, v13
  s_lshl_b32 s28, s16, 8
  s_cmp_lg_u32 s20, 4
  s_cbranch_scc1 boot_nf
  buffer_load_dwordx4 v[40:43], v14, s[8:11], s28 offen sc1
  s_waitcnt vmcnt(0)
  buffer_store_dwordx4 v[8:11], v14, s[8:11], s28 offen
  s_lshl_b32 s30, s16, 2
  s_add_u32 s30, s30, 32
  v_mov_b32 v16, s30
  v_mov_b32 v17, 1
  s_waitcnt vmcnt(0)
  s_mov_b64 exec, 1
  buffer_atomic_add v17, v16, s[12:15], 0 offen
  s_mov_b64 exec, -1
boot_nf:
  s_lshl_b32 s29, s16, 17
  s_lshl_b32 s30, s20, 14
  s_add_u32 s29, s29, s30
  s_add_u32 s29, s29, 3407872
  buffer_load_dword v44, v3, s[8:11], s29 offen sc1
  s_add_u32 s30, s29, 8192
  buffer_load_dword v45, v3, s[8:11], s30 offen sc1
  v_bfe_u32 v13, v1, 5, 1
  v_lshlrev_b32 v12, 6, v13
  v_bfe_u32 v13, v1, 4, 1
  v_lshl_add_u32 v12, v13, 4, v12
  v_bfe_u32 v13, v1, 1, 1
  v_lshl_add_u32 v12, v13, 2, v12
  v_bfe_u32 v13, v1, 2, 2
  v_lshlrev_b32 v13, 1, v13
  v_and_b32 v18, 1, v1
  v_add_u32 v13, v13, v18
  v_mul_u32_u24 v13, 1280, v13
  v_add_u32 v12, v12, v13
  s_waitcnt lgkmcnt(0)
  s_mov_b32 s31, s20
  s_lshl_b32 s30, s31, 7
  buffer_load_dword v20, v12, s[24:27], s30 offen
  buffer_load_dword v21, v12, s[24:27], s30 offen offset:32
  buffer_load_dword v22, v12, s[24:27], s30 offen offset:8
  buffer_load_dword v23, v12, s[24:27], s30 offen offset:40
  s_lshl_b32 s31, s31, 10
  s_mul_i32 s30, s16, 10240
  s_add_u32 s32, s31, s30
  s_add_u32 s32, s32, 131072
  s_add_u32 s33, s32, 81920
  buffer_load_dwordx4 v[46:49], v2, s[8:11], s32 offen sc1
  buffer_load_dwordx4 v[50:53], v2, s[8:11], s33 offen sc1
  s_add_u32 s36, s32, 163840
  s_add_u32 s37, s32, 245760
  buffer_load_dwordx4 v[46:49], v2, s[8:11], s36 offen sc1
  buffer_load_dwordx4 v[50:53], v2, s[8:11], s37 offen sc1
  s_add_u32 s31, s20, 8
  s_min_u32 s31, s31, 9
  s_lshl_b32 s30, s31, 7
  buffer_load_dword v24, v12, s[24:27], s30 offen
  buffer_load_dword v25, v12, s[24:27], s30 offen offset:32
  buffer_load_dword v26, v12, s[24:27], s30 offen offset:8
  buffer_load_dword v27, v12, s[24:27], s30 offen offset:40
  s_lshl_b32 s31, s31, 10
  s_mul_i32 s30, s16, 10240
  s_add_u32 s34, s31, s30
  s_add_u32 s34, s34, 131072
  s_add_u32 s35, s34, 81920
  buffer_load_dwordx4 v[46:49], v2, s[8:11], s34 offen sc1
  buffer_load_dwordx4 v[50:53], v2, s[8:11], s35 offen sc1
  s_add_u32 s38, s34, 163840
  s_add_u32 s39, s34, 245760
  buffer_load_dwordx4 v[46:49], v2, s[8:11], s38 offen sc1
  buffer_load_dwordx4 v[50:53], v2, s[8:11], s39 offen sc1
  s_waitcnt vmcnt(0)
  buffer_store_dwordx4 v[20:23], v2, s[8:11], s32 offen
  buffer_store_dwordx4 v[4:7], v2, s[8:11], s33 offen
  buffer_store_dwordx4 v[4:7], v2, s[8:11], s36 offen
  buffer_store_dwordx4 v[4:7], v2, s[8:11], s37 offen
  buffer_store_dwordx4 v[24:27], v2, s[8:11], s34 offen
  buffer_store_dwordx4 v[4:7], v2, s[8:11], s35 offen
  buffer_store_dwordx4 v[4:7], v2, s[8:11], s38 offen
  buffer_store_dwordx4 v[4:7], v2, s[8:11], s39 offen
  buffer_store_dwordx4 v[4:7], v2, s[8:11], s29 offen offset:0
  buffer_store_dwordx4 v[4:7], v2, s[8:11], s29 offen offset:1024
  buffer_store_dwordx4 v[4:7], v2, s[8:11], s29 offen offset:2048
  buffer_store_dwordx4 v[4:7], v2, s[8:11], s29 offen offset:3072
  s_add_u32 s29, s29, 4096
  buffer_store_dwordx4 v[4:7], v2, s[8:11], s29 offen offset:0
  buffer_store_dwordx4 v[4:7], v2, s[8:11], s29 offen offset:1024
  buffer_store_dwordx4 v[4:7], v2, s[8:11], s29 offen offset:2048
  buffer_store_dwordx4 v[4:7], v2, s[8:11], s29 offen offset:3072
  s_add_u32 s29, s29, 4096
  buffer_store_dwordx4 v[4:7], v2, s[8:11], s29 offen offset:0
  buffer_store_dwordx4 v[4:7], v2, s[8:11], s29 offen offset:1024
  buffer_store_dwordx4 v[4:7], v2, s[8:11], s29 offen offset:2048
  buffer_store_dwordx4 v[4:7], v2, s[8:11], s29 offen offset:3072
  s_add_u32 s29, s29, 4096
  buffer_store_dwordx4 v[4:7], v2, s[8:11], s29 offen offset:0
  buffer_store_dwordx4 v[4:7], v2, s[8:11], s29 offen offset:1024
  buffer_store_dwordx4 v[4:7], v2, s[8:11], s29 offen offset:2048
  buffer_store_dwordx4 v[4:7], v2, s[8:11], s29 offen offset:3072
  s_add_u32 s29, s29, 4096
  s_mul_i32 s30, s20, 81920
  s_add_u32 s30, s30, s28
  s_add_u32 s30, s30, 16777216
  buffer_store_dwordx4 v[4:7], v15, s[8:11], s30 offen sc1
  s_add_u32 s30, s30, 8192
  buffer_store_dwordx4 v[4:7], v15, s[8:11], s30 offen sc1
  s_add_u32 s30, s30, 8192
  buffer_store_dwordx4 v[4:7], v15, s[8:11], s30 offen sc1
  s_add_u32 s30, s30, 8192
  buffer_store_dwordx4 v[4:7], v15, s[8:11], s30 offen sc1
  s_add_u32 s30, s30, 8192
  buffer_store_dwordx4 v[4:7], v15, s[8:11], s30 offen sc1
  s_add_u32 s30, s30, 8192
  buffer_store_dwordx4 v[4:7], v15, s[8:11], s30 offen sc1
  s_add_u32 s30, s30, 8192
  buffer_store_dwordx4 v[4:7], v15, s[8:11], s30 offen sc1
  s_add_u32 s30, s30, 8192
  buffer_store_dwordx4 v[4:7], v15, s[8:11], s30 offen sc1
  s_add_u32 s30, s30, 8192
  buffer_store_dwordx4 v[4:7], v15, s[8:11], s30 offen sc1
  s_add_u32 s30, s30, 8192
  buffer_store_dwordx4 v[4:7], v15, s[8:11], s30 offen sc1
  s_add_u32 s30, s30, 8192
  v_lshrrev_b32 v12, 3, v1
  v_and_b32 v13, 7, v1
  v_lshlrev_b32 v13, 4, v13
  v_lshl_add_u32 v12, v12, 10, v13
  s_lshl_b32 s30, s20, 13
  s_lshl_b32 s31, s16, 7
  s_add_u32 s30, s30, s31
  s_add_u32 s30, s30, 2162688
  buffer_store_dwordx4 v[4:7], v12, s[8:11], s30 offen sc1
  s_waitcnt vmcnt(0)
  s_barrier
  s_cmp_lg_u32 s17, 0
  s_cbranch_scc1 boot_ng
  v_mov_b32 v16, 192
  v_mov_b32 v17, 1
  s_waitcnt vmcnt(0)
  s_mov_b64 exec, 1
  buffer_atomic_add v17, v16, s[12:15], 0 offen sc1
  s_mov_b64 exec, -1
boot_ng:
  s_lshl_b32 s28, s16, 22
  s_lshl_b32 s29, s20, 13
  s_add_u32 s28, s28, s29
  s_add_u32 s28, s28, 67108864
  s_cmp_ge_u32 s20, 4
  s_cbranch_scc1 boot_nt
  s_add_u32 s29, s28, 622592
  buffer_load_dword v20, v3, s[8:11], s29 offen sc1
  s_add_u32 s29, s28, 655360
  buffer_load_dword v21, v3, s[8:11], s29 offen sc1
  s_waitcnt vmcnt(2)
  s_add_u32 s29, s28, 557056
  buffer_load_dword v22, v3, s[8:11], s29 offen sc1
  s_add_u32 s29, s28, 589824
  buffer_load_dword v23, v3, s[8:11], s29 offen sc1
  s_waitcnt vmcnt(2)
  s_add_u32 s29, s28, 294912
  buffer_load_dword v24, v3, s[8:11], s29 offen sc1
  s_add_u32 s29, s28, 327680
  buffer_load_dword v25, v3, s[8:11], s29 offen sc1
  s_waitcnt vmcnt(2)
  s_add_u32 s29, s28, 360448
  buffer_load_dword v26, v3, s[8:11], s29 offen sc1
  s_add_u32 s29, s28, 393216
  buffer_load_dword v27, v3, s[8:11], s29 offen sc1
  s_waitcnt vmcnt(2)
  s_add_u32 s29, s28, 425984
  buffer_load_dword v28, v3, s[8:11], s29 offen sc1
  s_add_u32 s29, s28, 458752
  buffer_load_dword v29, v3, s[8:11], s29 offen sc1
  s_waitcnt vmcnt(2)
  s_add_u32 s29, s28, 491520
  buffer_load_dword v30, v3, s[8:11], s29 offen sc1
  s_add_u32 s29, s28, 524288
  buffer_load_dword v31, v3, s[8:11], s29 offen sc1
  s_waitcnt vmcnt(2)
boot_nt:
  s_cmp_eq_u32 s18, 27
  s_cbranch_scc1 role_w
  s_branch role_sm
role_none:
  s_endpgm
role_abort:
  v_mov_b32 v2, 132
  v_mov_b32 v3, 1
  s_mov_b64 exec, 1
  buffer_atomic_add v3, v2, s[12:15], 0 offen
  s_endpgm
role_sm:
  v_lshlrev_b32 v166, 4, v1
  v_bfe_u32 v171, v1, 2, 2
  v_and_b32 v172, 1, v1
  v_lshl_add_u32 v171, v171, 1, v172
  v_lshrrev_b32 v172, 4, v1
  v_lshl_add_u32 v171, v172, 3, v171
  v_lshlrev_b32 v167, 4, v171
  v_and_b32 v171, 15, v1
  v_lshlrev_b32 v172, 2, v172
  v_sub_u32 v171, v171, v172
  v_mov_b32 v172, 0
  v_mov_b32 v170, 0xf149f2ca
  v_cmp_le_i32 vcc, 0, v171
  s_nop 1
  v_cndmask_b32 v148, v170, v172, vcc
  v_cmp_le_i32 vcc, 1, v171
  s_nop 1
  v_cndmask_b32 v149, v170, v172, vcc
  v_cmp_le_i32 vcc, 2, v171
  s_nop 1
  v_cndmask_b32 v150, v170, v172, vcc
  v_cmp_le_i32 vcc, 3, v171
  s_nop 1
  v_cndmask_b32 v151, v170, v172, vcc
  v_mov_b32 v160, 0x3d93cd3a
  v_mov_b32 v161, 0x3d93cd3a
  v_mov_b32 v154, 0
  v_mov_b32 v155, 0
  s_lshl_b32 s23, s16, 8
  s_lshl_b32 s24, s17, 6
  s_add_u32 s24, s24, s23
  v_and_b32 v171, 15, v1
  v_lshl_add_u32 v168, v171, 2, s24
  s_lshl_b32 s24, s17, 2
  s_add_u32 s23, s23, s24
  s_add_u32 s23, s23, 4192
  v_mov_b32 v169, s23
  s_lshl_b32 s25, s16, 22
  s_add_u32 s25, s25, 67108864
  s_mul_i32 s33, s17, 12288
  s_add_u32 s33, s33, s25
  s_mul_i32 s34, s17, 3072
  s_add_u32 s34, s34, s25
  s_add_u32 s34, s34, 589824
  s_lshl_b32 s35, s17, 11
  s_add_u32 s35, s35, s25
  s_add_u32 s35, s35, 602112
  s_add_u32 s36, s24, s25
  s_add_u32 s36, s36, 610304
  s_mov_b32 s32, 1
  v_lshlrev_b32 v179, 7, v1
  s_lshl_b32 s37, s16, 2
  s_add_u32 s37, s37, s17
  s_mul_i32 s37, s37, 10240
  s_add_u32 s37, s37, 226492416
  v_mov_b32 v170, 0
  s_waitcnt vmcnt(0)
  s_lshl_b32 s22, s16, 2
  s_add_u32 s22, s22, 32
  v_mov_b32 v171, s22
  s_mov_b32 s22, 0
  s_mov_b64 exec, 1
gw_1:
  buffer_load_dword v172, v171, s[12:15], 0 offen sc1
  s_add_u32 s22, s22, 1
  s_cmp_gt_u32 s22, 65536
  s_cbranch_scc1 role_abort
  s_waitcnt vmcnt(0)
  v_cmp_gt_u32 vcc, 1, v172
  s_cbranch_vccz gk_2
  s_sleep 8
  s_branch gw_1
gk_2:
  s_mov_b64 exec, -1
sm_loop:
  s_sub_u32 s21, s32, 1
  s_and_b32 s23, s21, 3
  s_mul_i32 s23, s23, 147456
  s_add_u32 s27, s33, s23
  s_add_u32 s28, s27, 49152
  s_and_b32 s23, s21, 3
  s_mul_i32 s23, s23, 24576
  s_add_u32 s29, s34, s23
  s_add_u32 s30, s35, s23
  s_add_u32 s31, s36, s23
  s_mov_b32 s22, 0
  s_branch pc_5
pw_3:
  buffer_load_dword v170, v168, s[8:11], 0 offen sc1
  s_add_u32 s22, s22, 1
  s_cmp_gt_u32 s22, 65536
  s_cbranch_scc1 role_abort
  s_waitcnt vmcnt(0)
pc_5:
  v_cmp_gt_u32 vcc, s32, v170
  s_nop 0
  s_and_b32 vcc_lo, vcc_lo, 0xfff
  s_and_b32 vcc_hi, vcc_hi, 0x0
  s_cmp_eq_u64 vcc, 0
  s_cbranch_scc1 po_4
  s_sleep 4
  s_branch pw_3
po_4:
  s_add_u32 s23, s28, 4096
  s_add_u32 s24, s28, 8192
  s_add_u32 s25, s27, 4096
  s_add_u32 s26, s27, 8192
  buffer_load_dwordx4 v[4:7], v166, s[8:11], s27 offen offset:0 sc1
  buffer_load_dwordx4 v[28:31], v166, s[8:11], s25 offen offset:2048 sc1
  buffer_load_dwordx4 v[52:55], v166, s[8:11], s28 offen offset:0 sc1
  buffer_load_dwordx4 v[76:79], v166, s[8:11], s23 offen offset:2048 sc1
  buffer_load_dwordx4 v[8:11], v166, s[8:11], s27 offen offset:1024 sc1
  buffer_load_dwordx4 v[32:35], v166, s[8:11], s25 offen offset:3072 sc1
  buffer_load_dwordx4 v[56:59], v166, s[8:11], s28 offen offset:1024 sc1
  buffer_load_dwordx4 v[80:83], v166, s[8:11], s23 offen offset:3072 sc1
  buffer_load_dwordx4 v[12:15], v166, s[8:11], s27 offen offset:2048 sc1
  buffer_load_dwordx4 v[36:39], v166, s[8:11], s26 offen offset:0 sc1
  buffer_load_dwordx4 v[60:63], v166, s[8:11], s28 offen offset:2048 sc1
  buffer_load_dwordx4 v[84:87], v166, s[8:11], s24 offen offset:0 sc1
  buffer_load_dwordx4 v[16:19], v166, s[8:11], s27 offen offset:3072 sc1
  buffer_load_dwordx4 v[40:43], v166, s[8:11], s26 offen offset:1024 sc1
  buffer_load_dwordx4 v[64:67], v166, s[8:11], s28 offen offset:3072 sc1
  buffer_load_dwordx4 v[88:91], v166, s[8:11], s24 offen offset:1024 sc1
  buffer_load_dwordx4 v[20:23], v166, s[8:11], s25 offen offset:0 sc1
  buffer_load_dwordx4 v[44:47], v166, s[8:11], s26 offen offset:2048 sc1
  buffer_load_dwordx4 v[68:71], v166, s[8:11], s23 offen offset:0 sc1
  buffer_load_dwordx4 v[92:95], v166, s[8:11], s24 offen offset:2048 sc1
  buffer_load_dwordx4 v[24:27], v166, s[8:11], s25 offen offset:1024 sc1
  buffer_load_dwordx4 v[48:51], v166, s[8:11], s26 offen offset:3072 sc1
  buffer_load_dwordx4 v[72:75], v166, s[8:11], s23 offen offset:1024 sc1
  buffer_load_dwordx4 v[96:99], v166, s[8:11], s24 offen offset:3072 sc1
  s_waitcnt vmcnt(20)
  v_mfma_f32_16x16x32_bf16 v[124:127], v[52:55], v[4:7], 0
  v_mfma_f32_16x16x32_bf16 v[132:135], v[52:55], v[28:31], 0
  v_mfma_f32_16x16x32_bf16 v[136:139], v[76:79], v[28:31], 0
  s_waitcnt vmcnt(16)
  v_mfma_f32_16x16x32_bf16 v[124:127], v[56:59], v[8:11], v[124:127]
  v_mfma_f32_16x16x32_bf16 v[132:135], v[56:59], v[32:35], v[132:135]
  v_mfma_f32_16x16x32_bf16 v[136:139], v[80:83], v[32:35], v[136:139]
  s_waitcnt vmcnt(12)
  v_mfma_f32_16x16x32_bf16 v[124:127], v[60:63], v[12:15], v[124:127]
  v_mfma_f32_16x16x32_bf16 v[132:135], v[60:63], v[36:39], v[132:135]
  v_mfma_f32_16x16x32_bf16 v[136:139], v[84:87], v[36:39], v[136:139]
  s_waitcnt vmcnt(8)
  v_mfma_f32_16x16x32_bf16 v[124:127], v[64:67], v[16:19], v[124:127]
  v_mfma_f32_16x16x32_bf16 v[132:135], v[64:67], v[40:43], v[132:135]
  v_mfma_f32_16x16x32_bf16 v[136:139], v[88:91], v[40:43], v[136:139]
  s_waitcnt vmcnt(4)
  v_mfma_f32_16x16x32_bf16 v[124:127], v[68:71], v[20:23], v[124:127]
  v_mfma_f32_16x16x32_bf16 v[132:135], v[68:71], v[44:47], v[132:135]
  v_mfma_f32_16x16x32_bf16 v[136:139], v[92:95], v[44:47], v[136:139]
  s_waitcnt vmcnt(0)
  v_mfma_f32_16x16x32_bf16 v[124:127], v[72:75], v[24:27], v[124:127]
  v_mfma_f32_16x16x32_bf16 v[132:135], v[72:75], v[48:51], v[132:135]
  v_mfma_f32_16x16x32_bf16 v[136:139], v[96:99], v[48:51], v[136:139]
  s_nop 5
  v_cvt_pk_bf16_f32 v173, v124, v125
  v_lshlrev_b32 v124, 16, v173
  v_and_b32 v125, 0xffff0000, v173
  v_cvt_pk_bf16_f32 v173, v126, v127
  v_lshlrev_b32 v126, 16, v173
  v_and_b32 v127, 0xffff0000, v173
  v_cvt_pk_bf16_f32 v174, v132, v133
  v_lshlrev_b32 v132, 16, v174
  v_and_b32 v133, 0xffff0000, v174
  v_cvt_pk_bf16_f32 v174, v134, v135
  v_lshlrev_b32 v134, 16, v174
  v_and_b32 v135, 0xffff0000, v174
  v_cvt_pk_bf16_f32 v174, v136, v137
  v_lshlrev_b32 v136, 16, v174
  v_and_b32 v137, 0xffff0000, v174
  v_cvt_pk_bf16_f32 v174, v138, v139
  v_lshlrev_b32 v138, 16, v174
  v_and_b32 v139, 0xffff0000, v174
  v_pk_fma_f32 v[124:125], v[124:125], v[160:161], v[148:149]
  v_cvt_pk_bf16_f32 v173, v124, v125
  v_lshlrev_b32 v124, 16, v173
  v_and_b32 v125, 0xffff0000, v173
  v_pk_fma_f32 v[126:127], v[126:127], v[160:161], v[150:151]
  v_cvt_pk_bf16_f32 v173, v126, v127
  v_lshlrev_b32 v126, 16, v173
  v_and_b32 v127, 0xffff0000, v173
  v_pk_mul_f32 v[132:133], v[132:133], v[160:161]
  v_cvt_pk_bf16_f32 v174, v132, v133
  v_lshlrev_b32 v132, 16, v174
  v_and_b32 v133, 0xffff0000, v174
  v_pk_mul_f32 v[134:135], v[134:135], v[160:161]
  v_cvt_pk_bf16_f32 v174, v134, v135
  v_lshlrev_b32 v134, 16, v174
  v_and_b32 v135, 0xffff0000, v174
  v_pk_fma_f32 v[136:137], v[136:137], v[160:161], v[148:149]
  v_cvt_pk_bf16_f32 v174, v136, v137
  v_lshlrev_b32 v136, 16, v174
  v_and_b32 v137, 0xffff0000, v174
  v_pk_fma_f32 v[138:139], v[138:139], v[160:161], v[150:151]
  v_cvt_pk_bf16_f32 v174, v138, v139
  v_lshlrev_b32 v138, 16, v174
  v_and_b32 v139, 0xffff0000, v174
  v_max3_f32 v175, v124, v125, v126
  v_max3_f32 v176, v132, v133, v134
  v_max_f32 v175, v175, v127
  v_max3_f32 v176, v176, v135, v136
  v_max3_f32 v176, v176, v137, v138
  v_max_f32 v176, v176, v139
sm_b2r:
  s_mov_b32 s22, 0
pw_6:
  buffer_load_dword v170, v168, s[8:11], 0 offen sc1
  s_add_u32 s22, s22, 1
  s_cmp_gt_u32 s22, 65536
  s_cbranch_scc1 role_abort
  s_waitcnt vmcnt(0)
pc_8:
  v_cmp_gt_u32 vcc, s32, v170
  s_nop 0
  s_and_b32 vcc_lo, vcc_lo, 0x7000
  s_and_b32 vcc_hi, vcc_hi, 0x0
  s_cmp_eq_u64 vcc, 0
  s_cbranch_scc1 po_7
  s_sleep 2
  s_branch pw_6
po_7:
  buffer_load_dwordx4 v[100:103], v167, s[8:11], s29 offen offset:0 sc1
  buffer_load_dwordx4 v[104:107], v167, s[8:11], s29 offen offset:512 sc1
  buffer_load_dwordx4 v[108:111], v167, s[8:11], s29 offen offset:1024 sc1
  buffer_load_dwordx4 v[112:115], v167, s[8:11], s29 offen offset:1536 sc1
  buffer_load_dwordx4 v[116:119], v167, s[8:11], s29 offen offset:2048 sc1
  buffer_load_dwordx4 v[120:123], v167, s[8:11], s29 offen offset:2560 sc1
  s_waitcnt vmcnt(5)
  v_mfma_f32_16x16x32_bf16 v[140:143], v[100:103], v[4:7], 0
  v_mfma_f32_16x16x32_bf16 v[144:147], v[100:103], v[28:31], 0
  s_waitcnt vmcnt(4)
  v_mfma_f32_16x16x32_bf16 v[140:143], v[104:107], v[8:11], v[140:143]
  v_mfma_f32_16x16x32_bf16 v[144:147], v[104:107], v[32:35], v[144:147]
  s_waitcnt vmcnt(3)
  v_mfma_f32_16x16x32_bf16 v[140:143], v[108:111], v[12:15], v[140:143]
  v_mfma_f32_16x16x32_bf16 v[144:147], v[108:111], v[36:39], v[144:147]
  s_waitcnt vmcnt(2)
  v_mfma_f32_16x16x32_bf16 v[140:143], v[112:115], v[16:19], v[140:143]
  v_mfma_f32_16x16x32_bf16 v[144:147], v[112:115], v[40:43], v[144:147]
  s_waitcnt vmcnt(1)
  v_mfma_f32_16x16x32_bf16 v[140:143], v[116:119], v[20:23], v[140:143]
  v_mfma_f32_16x16x32_bf16 v[144:147], v[116:119], v[44:47], v[144:147]
  s_waitcnt vmcnt(0)
  v_mfma_f32_16x16x32_bf16 v[140:143], v[120:123], v[24:27], v[140:143]
  v_mfma_f32_16x16x32_bf16 v[144:147], v[120:123], v[48:51], v[144:147]
  s_nop 6
  v_cvt_pk_bf16_f32 v173, v140, v141
  v_cvt_pk_bf16_f32 v174, v144, v145
  v_lshlrev_b32 v140, 16, v173
  v_lshlrev_b32 v144, 16, v174
  v_and_b32 v141, 0xffff0000, v173
  v_and_b32 v145, 0xffff0000, v174
  v_pk_mul_f32 v[140:141], v[140:141], v[160:161]
  v_pk_mul_f32 v[144:145], v[144:145], v[160:161]
  v_cvt_pk_bf16_f32 v173, v140, v141
  v_cvt_pk_bf16_f32 v174, v144, v145
  v_lshlrev_b32 v140, 16, v173
  v_lshlrev_b32 v144, 16, v174
  v_and_b32 v141, 0xffff0000, v173
  v_and_b32 v145, 0xffff0000, v174
  v_max3_f32 v175, v175, v140, v141
  v_max3_f32 v176, v176, v144, v145
  v_mov_b32 v173, v175
  v_mov_b32 v174, v176
  s_nop 0
  v_permlane16_swap_b32 v175, v173
  v_permlane16_swap_b32 v176, v174
  v_max_f32 v175, v175, v173
  v_max_f32 v176, v176, v174
  v_mov_b32 v173, v175
  v_mov_b32 v174, v176
  s_nop 0
  v_permlane32_swap_b32 v175, v173
  v_permlane32_swap_b32 v176, v174
  v_max_f32 v175, v175, v173
  v_max_f32 v176, v176, v174
  v_sub_f32 v124, v124, v175
  v_sub_f32 v125, v125, v175
  v_sub_f32 v126, v126, v175
  v_sub_f32 v127, v127, v175
  v_sub_f32 v132, v132, v176
  v_sub_f32 v133, v133, v176
  v_sub_f32 v134, v134, v176
  v_sub_f32 v135, v135, v176
  v_sub_f32 v136, v136, v176
  v_sub_f32 v137, v137, v176
  v_sub_f32 v138, v138, v176
  v_sub_f32 v139, v139, v176
  v_sub_f32 v140, v140, v175
  v_sub_f32 v141, v141, v175
  v_sub_f32 v144, v144, v176
  v_sub_f32 v145, v145, v176
  v_mul_f32 v124, 0x3fb8aa3b, v124
  v_mul_f32 v125, 0x3fb8aa3b, v125
  v_mul_f32 v126, 0x3fb8aa3b, v126
  v_mul_f32 v127, 0x3fb8aa3b, v127
  v_mul_f32 v132, 0x3fb8aa3b, v132
  v_mul_f32 v133, 0x3fb8aa3b, v133
  v_mul_f32 v134, 0x3fb8aa3b, v134
  v_mul_f32 v135, 0x3fb8aa3b, v135
  v_mul_f32 v136, 0x3fb8aa3b, v136
  v_mul_f32 v137, 0x3fb8aa3b, v137
  v_mul_f32 v138, 0x3fb8aa3b, v138
  v_mul_f32 v139, 0x3fb8aa3b, v139
  v_mul_f32 v140, 0x3fb8aa3b, v140
  v_mul_f32 v141, 0x3fb8aa3b, v141
  v_mul_f32 v144, 0x3fb8aa3b, v144
  v_mul_f32 v145, 0x3fb8aa3b, v145
  v_exp_f32 v124, v124
  v_exp_f32 v125, v125
  v_exp_f32 v126, v126
  v_exp_f32 v127, v127
  v_exp_f32 v132, v132
  v_exp_f32 v133, v133
  v_exp_f32 v134, v134
  v_exp_f32 v135, v135
  v_exp_f32 v136, v136
  v_exp_f32 v137, v137
  v_exp_f32 v138, v138
  v_exp_f32 v139, v139
  v_exp_f32 v140, v140
  v_exp_f32 v141, v141
  v_exp_f32 v144, v144
  v_exp_f32 v145, v145
  v_pk_add_f32 v[162:163], v[124:125], v[126:127]
  v_pk_add_f32 v[164:165], v[132:133], v[134:135]
  v_pk_add_f32 v[146:147], v[136:137], v[138:139]
  v_pk_add_f32 v[162:163], v[162:163], v[140:141]
  v_pk_add_f32 v[164:165], v[164:165], v[144:145]
  v_pk_add_f32 v[164:165], v[164:165], v[146:147]
  v_add_f32 v175, v162, v163
  v_add_f32 v176, v164, v165
  v_mov_b32 v173, v175
  v_mov_b32 v174, v176
  s_nop 0
  v_permlane16_swap_b32 v175, v173
  v_permlane16_swap_b32 v176, v174
  v_add_f32 v175, v175, v173
  v_add_f32 v176, v176, v174
  v_mov_b32 v173, v175
  v_mov_b32 v174, v176
  s_nop 0
  v_permlane32_swap_b32 v175, v173
  v_permlane32_swap_b32 v176, v174
  v_add_f32 v175, v175, v173
  v_add_f32 v176, v176, v174
  v_rcp_f32 v162, v175
  v_rcp_f32 v164, v176
  v_mov_b32 v163, v162
  v_mov_b32 v165, v164
  v_pk_mul_f32 v[124:125], v[124:125], v[162:163]
  v_cvt_pk_bf16_f32 v152, v124, v125
  v_pk_mul_f32 v[126:127], v[126:127], v[162:163]
  v_cvt_pk_bf16_f32 v153, v126, v127
  v_pk_mul_f32 v[140:141], v[140:141], v[162:163]
  buffer_store_dwordx4 v[152:155], v166, s[8:11], s30 offen offset:0
  v_cvt_pk_bf16_f32 v177, v140, v141
  buffer_store_dword v177, v166, s[8:11], s31 offen offset:0
  v_pk_mul_f32 v[132:133], v[132:133], v[164:165]
  v_cvt_pk_bf16_f32 v156, v132, v133
  v_pk_mul_f32 v[134:135], v[134:135], v[164:165]
  v_cvt_pk_bf16_f32 v157, v134, v135
  v_pk_mul_f32 v[136:137], v[136:137], v[164:165]
  v_cvt_pk_bf16_f32 v158, v136, v137
  v_pk_mul_f32 v[138:139], v[138:139], v[164:165]
  v_cvt_pk_bf16_f32 v159, v138, v139
  v_pk_mul_f32 v[144:145], v[144:145], v[164:165]
  buffer_store_dwordx4 v[156:159], v166, s[8:11], s30 offen offset:1024
  v_cvt_pk_bf16_f32 v178, v144, v145
  buffer_store_dword v178, v166, s[8:11], s31 offen offset:1024
  v_mov_b32 v171, s32
  s_add_u32 s32, s32, 1
  s_waitcnt vmcnt(0)
  buffer_store_dword v171, v169, s[8:11], 0 offen
  s_cmp_le_u32 s32, 64
  s_cbranch_scc1 sm_loop
  s_endpgm
sm_boot2:
  s_add_u32 s25, s17, 0
  v_mov_b32 v100, -1
  v_mov_b32 v101, -1
  v_mov_b32 v102, -1
  v_mov_b32 v103, -1
  s_lshl_b32 s24, s16, 3
  s_add_u32 s24, s24, s25
  s_lshl_b32 s23, s24, 10
  s_add_u32 s23, s23, 2097152
  buffer_store_dwordx4 v[100:103], v166, s[8:11], s23 offen sc1
  s_mul_i32 s23, s24, 15360
  s_add_u32 s23, s23, 2326528
  buffer_store_dwordx4 v[100:103], v166, s[8:11], s23 offen sc1
  s_add_u32 s23, s23, 1024
  buffer_store_dwordx4 v[100:103], v166, s[8:11], s23 offen sc1
  s_add_u32 s23, s23, 1024
  buffer_store_dwordx4 v[100:103], v166, s[8:11], s23 offen sc1
  s_add_u32 s23, s23, 1024
  buffer_store_dwordx4 v[100:103], v166, s[8:11], s23 offen sc1
  s_add_u32 s23, s23, 1024
  buffer_store_dwordx4 v[100:103], v166, s[8:11], s23 offen sc1
  s_add_u32 s23, s23, 1024
  buffer_store_dwordx4 v[100:103], v166, s[8:11], s23 offen sc1
  s_add_u32 s23, s23, 1024
  buffer_store_dwordx4 v[100:103], v166, s[8:11], s23 offen sc1
  s_add_u32 s23, s23, 1024
  buffer_store_dwordx4 v[100:103], v166, s[8:11], s23 offen sc1
  s_add_u32 s23, s23, 1024
  buffer_store_dwordx4 v[100:103], v166, s[8:11], s23 offen sc1
  s_add_u32 s23, s23, 1024
  buffer_store_dwordx4 v[100:103], v166, s[8:11], s23 offen sc1
  s_add_u32 s23, s23, 1024
  buffer_store_dwordx4 v[100:103], v166, s[8:11], s23 offen sc1
  s_add_u32 s23, s23, 1024
  buffer_store_dwordx4 v[100:103], v166, s[8:11], s23 offen sc1
  s_add_u32 s23, s23, 1024
  buffer_store_dwordx4 v[100:103], v166, s[8:11], s23 offen sc1
  s_add_u32 s23, s23, 1024
  buffer_store_dwordx4 v[100:103], v166, s[8:11], s23 offen sc1
  s_add_u32 s23, s23, 1024
  buffer_store_dwordx4 v[100:103], v166, s[8:11], s23 offen sc1
  s_add_u32 s23, s23, 1024
  v_mov_b32 v171, 196
  v_mov_b32 v172, 1
  s_waitcnt vmcnt(0)
  s_mov_b64 exec, 1
  buffer_atomic_add v172, v171, s[12:15], 0 offen sc1
  s_mov_b64 exec, -1
  s_add_u32 s25, s17, 4
  v_mov_b32 v100, -1
  v_mov_b32 v101, -1
  v_mov_b32 v102, -1
  v_mov_b32 v103, -1
  s_lshl_b32 s24, s16, 3
  s_add_u32 s24, s24, s25
  s_lshl_b32 s23, s24, 10
  s_add_u32 s23, s23, 2097152
  buffer_store_dwordx4 v[100:103], v166, s[8:11], s23 offen sc1
  s_mul_i32 s23, s24, 15360
  s_add_u32 s23, s23, 2326528
  buffer_store_dwordx4 v[100:103], v166, s[8:11], s23 offen sc1
  s_add_u32 s23, s23, 1024
  buffer_store_dwordx4 v[100:103], v166, s[8:11], s23 offen sc1
  s_add_u32 s23, s23, 1024
  buffer_store_dwordx4 v[100:103], v166, s[8:11], s23 offen sc1
  s_add_u32 s23, s23, 1024
  buffer_store_dwordx4 v[100:103], v166, s[8:11], s23 offen sc1
  s_add_u32 s23, s23, 1024
  buffer_store_dwordx4 v[100:103], v166, s[8:11], s23 offen sc1
  s_add_u32 s23, s23, 1024
  buffer_store_dwordx4 v[100:103], v166, s[8:11], s23 offen sc1
  s_add_u32 s23, s23, 1024
  buffer_store_dwordx4 v[100:103], v166, s[8:11], s23 offen sc1
  s_add_u32 s23, s23, 1024
  buffer_store_dwordx4 v[100:103], v166, s[8:11], s23 offen sc1
  s_add_u32 s23, s23, 1024
  buffer_store_dwordx4 v[100:103], v166, s[8:11], s23 offen sc1
  s_add_u32 s23, s23, 1024
  buffer_store_dwordx4 v[100:103], v166, s[8:11], s23 offen sc1
  s_add_u32 s23, s23, 1024
  buffer_store_dwordx4 v[100:103], v166, s[8:11], s23 offen sc1
  s_add_u32 s23, s23, 1024
  buffer_store_dwordx4 v[100:103], v166, s[8:11], s23 offen sc1
  s_add_u32 s23, s23, 1024
  buffer_store_dwordx4 v[100:103], v166, s[8:11], s23 offen sc1
  s_add_u32 s23, s23, 1024
  buffer_store_dwordx4 v[100:103], v166, s[8:11], s23 offen sc1
  s_add_u32 s23, s23, 1024
  buffer_store_dwordx4 v[100:103], v166, s[8:11], s23 offen sc1
  s_add_u32 s23, s23, 1024
  v_mov_b32 v171, 196
  v_mov_b32 v172, 1
  s_waitcnt vmcnt(0)
  s_mov_b64 exec, 1
  buffer_atomic_add v172, v171, s[12:15], 0 offen sc1
  s_mov_b64 exec, -1
  s_branch sm_b2r
role_r:
  s_load_dwordx2 s[20:21], s[0:1], 0
  s_mov_b32 s22, 2621440
  s_mov_b32 s23, 0x00020000
  s_load_dwordx2 s[24:25], s[0:1], 112
  s_mov_b32 s26, 2621440
  s_mov_b32 s27, 0x00020000
  s_load_dwordx2 s[28:29], s[0:1], 64
  s_mov_b32 s30, 1280
  s_mov_b32 s31, 0x00020000
  s_load_dwordx2 s[44:45], s[0:1], 96
  s_mov_b32 s46, 1280
  s_mov_b32 s47, 0x00020000
  s_load_dwordx2 s[48:49], s[0:1], 104
  s_mov_b32 s50, 4915200
  s_mov_b32 s51, 0x00020000
  s_sub_u32 s54, s18, 29
  s_sub_u32 s52, 2, s54
  s_lshl_b32 s52, s52, 3
  s_add_u32 s52, s52, s16
  s_lshl_b32 s32, s54, 2
  s_add_u32 s32, s32, s17
  s_mul_i32 s38, s16, 2621440
  s_lshl_b32 s35, s32, 13
  s_add_u32 s35, s35, s38
  s_add_u32 s35, s35, 247463936
  v_lshlrev_b32 v2, 7, v1
  s_waitcnt lgkmcnt(0)
  s_mov_b32 s40, s54
  s_mov_b32 s41, s54
  s_mul_i32 s39, s16, 3
  s_add_u32 s39, s39, s54
  s_add_u32 s39, s39, 24
  v_lshlrev_b32 v226, 2, v1
  s_mul_i32 s37, s32, 5120
  v_and_b32 v90, 3, v1
  v_lshrrev_b32 v91, 2, v1
  v_mul_u32_u24 v160, 1280, v90
  v_lshrrev_b32 v92, 4, v1
  v_bfe_u32 v93, v1, 2, 2
  v_lshl_add_u32 v93, v92, 3, v93
  v_lshl_add_u32 v160, v93, 3, v160
  buffer_load_dwordx2 v[100:101], v160, s[20:23], s37 offen offset:0
  buffer_load_dwordx2 v[102:103], v160, s[20:23], s37 offen offset:32
  buffer_load_dwordx2 v[104:105], v160, s[20:23], s37 offen offset:256
  buffer_load_dwordx2 v[106:107], v160, s[20:23], s37 offen offset:288
  buffer_load_dwordx2 v[108:109], v160, s[20:23], s37 offen offset:512
  buffer_load_dwordx2 v[110:111], v160, s[20:23], s37 offen offset:544
  buffer_load_dwordx2 v[112:113], v160, s[20:23], s37 offen offset:768
  buffer_load_dwordx2 v[114:115], v160, s[20:23], s37 offen offset:800
  buffer_load_dwordx2 v[116:117], v160, s[20:23], s37 offen offset:1024
  buffer_load_dwordx2 v[118:119], v160, s[20:23], s37 offen offset:1056
  s_add_u32 s36, s40, 24
  s_cmp_lt_u32 s40, 24
  s_cselect_b32 s36, s39, s36
  s_add_u32 s40, s40, 3
  s_cmp_lt_u32 s40, 24
  s_cselect_b32 s40, s40, s36
  s_min_u32 s40, s40, 127
  s_mul_i32 s37, s40, 20480
  s_mul_i32 s36, s17, 5120
  s_add_u32 s37, s37, s36
  buffer_load_dwordx2 v[120:121], v160, s[20:23], s37 offen offset:0
  buffer_load_dwordx2 v[122:123], v160, s[20:23], s37 offen offset:32
  buffer_load_dwordx2 v[124:125], v160, s[20:23], s37 offen offset:256
  buffer_load_dwordx2 v[126:127], v160, s[20:23], s37 offen offset:288
  buffer_load_dwordx2 v[128:129], v160, s[20:23], s37 offen offset:512
  buffer_load_dwordx2 v[130:131], v160, s[20:23], s37 offen offset:544
  buffer_load_dwordx2 v[132:133], v160, s[20:23], s37 offen offset:768
  buffer_load_dwordx2 v[134:135], v160, s[20:23], s37 offen offset:800
  buffer_load_dwordx2 v[136:137], v160, s[20:23], s37 offen offset:1024
  buffer_load_dwordx2 v[138:139], v160, s[20:23], s37 offen offset:1056
  s_add_u32 s36, s40, 24
  s_cmp_lt_u32 s40, 24
  s_cselect_b32 s36, s39, s36
  s_add_u32 s40, s40, 3
  s_cmp_lt_u32 s40, 24
  s_cselect_b32 s40, s40, s36
  s_min_u32 s40, s40, 127
  s_mul_i32 s37, s40, 20480
  s_mul_i32 s36, s17, 5120
  s_add_u32 s37, s37, s36
  buffer_load_dwordx2 v[46:47], v160, s[20:23], s37 offen offset:0
  buffer_load_dwordx2 v[48:49], v160, s[20:23], s37 offen offset:32
  buffer_load_dwordx2 v[50:51], v160, s[20:23], s37 offen offset:256
  buffer_load_dwordx2 v[52:53], v160, s[20:23], s37 offen offset:288
  buffer_load_dwordx2 v[54:55], v160, s[20:23], s37 offen offset:512
  buffer_load_dwordx2 v[56:57], v160, s[20:23], s37 offen offset:544
  buffer_load_dwordx2 v[58:59], v160, s[20:23], s37 offen offset:768
  buffer_load_dwordx2 v[60:61], v160, s[20:23], s37 offen offset:800
  buffer_load_dwordx2 v[62:63], v160, s[20:23], s37 offen offset:1024
  buffer_load_dwordx2 v[64:65], v160, s[20:23], s37 offen offset:1056
  s_add_u32 s36, s40, 24
  s_cmp_lt_u32 s40, 24
  s_cselect_b32 s36, s39, s36
  s_add_u32 s40, s40, 3
  s_cmp_lt_u32 s40, 24
  s_cselect_b32 s40, s40, s36
  s_min_u32 s40, s40, 127
  s_mul_i32 s37, s40, 20480
  s_mul_i32 s36, s17, 5120
  s_add_u32 s37, s37, s36
  s_add_u32 s35, s35, 98304
  v_lshlrev_b32 v161, 4, v90
  v_lshl_add_u32 v161, v91, 8, v161
  v_lshrrev_b32 v92, 1, v90
  v_mul_u32_u24 v162, 2432, v92
  v_lshl_add_u32 v162, v90, 6, v162
  v_lshl_add_u32 v162, v93, 4, v162
  v_cvt_f32_u32 v163, v92
  s_lshl_b32 s35, s16, 22
  s_lshl_b32 s36, s32, 13
  s_add_u32 s35, s35, s36
  s_add_u32 s35, s35, 67108864
  v_lshlrev_b32 v227, 3, v1
  s_lshl_b32 s35, s16, 8
  s_lshl_b32 s36, s32, 2
  s_add_u32 s35, s35, s36
  s_add_u32 s35, s35, 8192
  v_mov_b32 v228, s35
  v_mov_b32 v230, 0x00003f80
  v_mov_b32 v231, 0x3f800000
  s_mul_i32 s38, s16, 2621440
  s_add_u32 s38, s38, 247463936
  s_mul_i32 s35, s54, 20480
  s_add_u32 s38, s38, s35
  s_lshl_b32 s35, s17, 6
  s_add_u32 s38, s38, s35
  s_waitcnt lgkmcnt(0)
  s_waitcnt vmcnt(20)
  v_lshlrev_b32 v2, 16, v100
  v_and_b32 v3, 0xffff0000, v100
  v_lshlrev_b32 v4, 16, v101
  v_and_b32 v5, 0xffff0000, v101
  v_lshlrev_b32 v6, 16, v102
  v_and_b32 v7, 0xffff0000, v102
  v_lshlrev_b32 v8, 16, v103
  v_and_b32 v9, 0xffff0000, v103
  v_lshlrev_b32 v10, 16, v104
  v_and_b32 v11, 0xffff0000, v104
  v_lshlrev_b32 v12, 16, v105
  v_and_b32 v13, 0xffff0000, v105
  v_lshlrev_b32 v14, 16, v106
  v_and_b32 v15, 0xffff0000, v106
  v_lshlrev_b32 v16, 16, v107
  v_and_b32 v17, 0xffff0000, v107
  v_lshlrev_b32 v18, 16, v108
  v_and_b32 v19, 0xffff0000, v108
  v_lshlrev_b32 v20, 16, v109
  v_and_b32 v21, 0xffff0000, v109
  v_lshlrev_b32 v22, 16, v110
  v_and_b32 v23, 0xffff0000, v110
  v_lshlrev_b32 v24, 16, v111
  v_and_b32 v25, 0xffff0000, v111
  v_lshlrev_b32 v26, 16, v112
  v_and_b32 v27, 0xffff0000, v112
  v_lshlrev_b32 v28, 16, v113
  v_and_b32 v29, 0xffff0000, v113
  v_lshlrev_b32 v30, 16, v114
  v_and_b32 v31, 0xffff0000, v114
  v_lshlrev_b32 v32, 16, v115
  v_and_b32 v33, 0xffff0000, v115
  v_lshlrev_b32 v34, 16, v116
  v_and_b32 v35, 0xffff0000, v116
  v_lshlrev_b32 v36, 16, v117
  v_and_b32 v37, 0xffff0000, v117
  v_lshlrev_b32 v38, 16, v118
  v_and_b32 v39, 0xffff0000, v118
  v_lshlrev_b32 v40, 16, v119
  v_and_b32 v41, 0xffff0000, v119
  v_pk_add_f32 v[86:87], v[2:3], v[4:5]
  v_pk_add_f32 v[88:89], v[6:7], v[8:9]
  v_pk_add_f32 v[86:87], v[86:87], v[10:11]
  v_pk_add_f32 v[88:89], v[88:89], v[12:13]
  v_pk_add_f32 v[86:87], v[86:87], v[14:15]
  v_pk_add_f32 v[88:89], v[88:89], v[16:17]
  v_pk_add_f32 v[86:87], v[86:87], v[18:19]
  v_pk_add_f32 v[88:89], v[88:89], v[20:21]
  v_pk_add_f32 v[86:87], v[86:87], v[22:23]
  v_pk_add_f32 v[88:89], v[88:89], v[24:25]
  v_pk_add_f32 v[86:87], v[86:87], v[26:27]
  v_pk_add_f32 v[88:89], v[88:89], v[28:29]
  v_pk_add_f32 v[86:87], v[86:87], v[30:31]
  v_pk_add_f32 v[88:89], v[88:89], v[32:33]
  v_pk_add_f32 v[86:87], v[86:87], v[34:35]
  v_pk_add_f32 v[88:89], v[88:89], v[36:37]
  v_pk_add_f32 v[86:87], v[86:87], v[38:39]
  v_pk_add_f32 v[88:89], v[88:89], v[40:41]
  v_pk_add_f32 v[86:87], v[86:87], v[88:89]
  v_add_f32 v86, v86, v87
  s_nop 1
  v_add_f32_dpp v86, v86, v86 row_ror:8 row_mask:0xf bank_mask:0xf
  s_nop 1
  v_add_f32_dpp v86, v86, v86 row_ror:4 row_mask:0xf bank_mask:0xf
  v_mov_b32 v90, v86
  s_nop 1
  v_permlane16_swap_b32 v86, v90
  v_add_f32 v86, v86, v90
  v_mov_b32 v90, v86
  s_nop 1
  v_permlane32_swap_b32 v86, v90
  v_add_f32 v86, v86, v90
  v_mul_f32 v88, 0xbacccccd, v86
  v_mul_f32 v89, 0xbacccccd, v86
  v_pk_add_f32 v[164:165], v[2:3], v[88:89]
  v_pk_add_f32 v[166:167], v[4:5], v[88:89]
  v_pk_mul_f32 v[170:171], v[164:165], v[164:165]
  v_pk_add_f32 v[168:169], v[6:7], v[88:89]
  v_pk_mul_f32 v[86:87], v[166:167], v[166:167]
  v_pk_add_f32 v[164:165], v[8:9], v[88:89]
  v_pk_fma_f32 v[170:171], v[168:169], v[168:169], v[170:171]
  v_pk_add_f32 v[166:167], v[10:11], v[88:89]
  v_pk_fma_f32 v[86:87], v[164:165], v[164:165], v[86:87]
  v_pk_add_f32 v[168:169], v[12:13], v[88:89]
  v_pk_fma_f32 v[170:171], v[166:167], v[166:167], v[170:171]
  v_pk_add_f32 v[164:165], v[14:15], v[88:89]
  v_pk_fma_f32 v[86:87], v[168:169], v[168:169], v[86:87]
  v_pk_add_f32 v[166:167], v[16:17], v[88:89]
  v_pk_fma_f32 v[170:171], v[164:165], v[164:165], v[170:171]
  v_pk_add_f32 v[168:169], v[18:19], v[88:89]
  v_pk_fma_f32 v[86:87], v[166:167], v[166:167], v[86:87]
  v_pk_add_f32 v[164:165], v[20:21], v[88:89]
  v_pk_fma_f32 v[170:171], v[168:169], v[168:169], v[170:171]
  v_pk_add_f32 v[166:167], v[22:23], v[88:89]
  v_pk_fma_f32 v[86:87], v[164:165], v[164:165], v[86:87]
  v_pk_add_f32 v[168:169], v[24:25], v[88:89]
  v_pk_fma_f32 v[170:171], v[166:167], v[166:167], v[170:171]
  v_pk_add_f32 v[164:165], v[26:27], v[88:89]
  v_pk_fma_f32 v[86:87], v[168:169], v[168:169], v[86:87]
  v_pk_add_f32 v[166:167], v[28:29], v[88:89]
  v_pk_fma_f32 v[170:171], v[164:165], v[164:165], v[170:171]
  v_pk_add_f32 v[168:169], v[30:31], v[88:89]
  v_pk_fma_f32 v[86:87], v[166:167], v[166:167], v[86:87]
  v_pk_add_f32 v[164:165], v[32:33], v[88:89]
  v_pk_fma_f32 v[170:171], v[168:169], v[168:169], v[170:171]
  v_pk_add_f32 v[166:167], v[34:35], v[88:89]
  v_pk_fma_f32 v[86:87], v[164:165], v[164:165], v[86:87]
  v_pk_add_f32 v[168:169], v[36:37], v[88:89]
  v_pk_fma_f32 v[170:171], v[166:167], v[166:167], v[170:171]
  v_pk_add_f32 v[164:165], v[38:39], v[88:89]
  v_pk_fma_f32 v[86:87], v[168:169], v[168:169], v[86:87]
  v_pk_add_f32 v[166:167], v[40:41], v[88:89]
  v_pk_fma_f32 v[170:171], v[164:165], v[164:165], v[170:171]
  v_pk_fma_f32 v[86:87], v[166:167], v[166:167], v[86:87]
  v_cvt_pk_bf16_f32 v91, v88, v89
  v_lshlrev_b32 v88, 16, v91
  v_and_b32 v89, 0xffff0000, v91
  v_pk_add_f32 v[86:87], v[86:87], v[170:171]
  v_add_f32 v86, v86, v87
  s_nop 1
  v_add_f32_dpp v86, v86, v86 row_ror:8 row_mask:0xf bank_mask:0xf
  s_nop 1
  v_add_f32_dpp v86, v86, v86 row_ror:4 row_mask:0xf bank_mask:0xf
  v_mov_b32 v90, v86
  s_nop 1
  v_permlane16_swap_b32 v86, v90
  v_add_f32 v86, v86, v90
  v_mov_b32 v90, v86
  s_nop 1
  v_permlane32_swap_b32 v86, v90
  v_add_f32 v86, v86, v90
  v_pk_add_f32 v[2:3], v[2:3], v[88:89]
  v_mul_f32 v86, 0x3acccccd, v86
  v_pk_add_f32 v[4:5], v[4:5], v[88:89]
  v_cvt_pk_bf16_f32 v86, v86, v86
  v_pk_add_f32 v[6:7], v[6:7], v[88:89]
  v_lshlrev_b32 v86, 16, v86
  v_pk_add_f32 v[8:9], v[8:9], v[88:89]
  v_add_f32 v86, 0x3727c5ac, v86
  v_pk_add_f32 v[10:11], v[10:11], v[88:89]
  v_cvt_pk_bf16_f32 v86, v86, v86
  v_pk_add_f32 v[12:13], v[12:13], v[88:89]
  v_lshlrev_b32 v86, 16, v86
  v_pk_add_f32 v[14:15], v[14:15], v[88:89]
  v_sqrt_f32 v86, v86
  v_pk_add_f32 v[16:17], v[16:17], v[88:89]
  v_cvt_pk_bf16_f32 v86, v86, v86
  v_pk_add_f32 v[18:19], v[18:19], v[88:89]
  v_lshlrev_b32 v86, 16, v86
  v_pk_add_f32 v[20:21], v[20:21], v[88:89]
  v_rcp_f32 v86, v86
  v_pk_add_f32 v[22:23], v[22:23], v[88:89]
  v_mov_b32 v87, v86
  v_pk_add_f32 v[24:25], v[24:25], v[88:89]
  v_pk_add_f32 v[26:27], v[26:27], v[88:89]
  v_pk_add_f32 v[28:29], v[28:29], v[88:89]
  v_pk_add_f32 v[30:31], v[30:31], v[88:89]
  v_pk_add_f32 v[32:33], v[32:33], v[88:89]
  v_pk_add_f32 v[34:35], v[34:35], v[88:89]
  v_pk_add_f32 v[36:37], v[36:37], v[88:89]
  v_pk_add_f32 v[38:39], v[38:39], v[88:89]
  v_pk_add_f32 v[40:41], v[40:41], v[88:89]
  v_cvt_pk_bf16_f32 v164, v2, v3
  v_lshlrev_b32 v2, 16, v164
  v_and_b32 v3, 0xffff0000, v164
  v_cvt_pk_bf16_f32 v165, v4, v5
  v_lshlrev_b32 v4, 16, v165
  v_and_b32 v5, 0xffff0000, v165
  v_cvt_pk_bf16_f32 v166, v6, v7
  v_lshlrev_b32 v6, 16, v166
  v_and_b32 v7, 0xffff0000, v166
  v_cvt_pk_bf16_f32 v167, v8, v9
  v_lshlrev_b32 v8, 16, v167
  v_and_b32 v9, 0xffff0000, v167
  v_cvt_pk_bf16_f32 v164, v10, v11
  v_lshlrev_b32 v10, 16, v164
  v_and_b32 v11, 0xffff0000, v164
  v_cvt_pk_bf16_f32 v165, v12, v13
  v_lshlrev_b32 v12, 16, v165
  v_and_b32 v13, 0xffff0000, v165
  v_cvt_pk_bf16_f32 v166, v14, v15
  v_lshlrev_b32 v14, 16, v166
  v_and_b32 v15, 0xffff0000, v166
  v_cvt_pk_bf16_f32 v167, v16, v17
  v_lshlrev_b32 v16, 16, v167
  v_and_b32 v17, 0xffff0000, v167
  v_cvt_pk_bf16_f32 v164, v18, v19
  v_lshlrev_b32 v18, 16, v164
  v_and_b32 v19, 0xffff0000, v164
  v_cvt_pk_bf16_f32 v165, v20, v21
  v_lshlrev_b32 v20, 16, v165
  v_and_b32 v21, 0xffff0000, v165
  v_cvt_pk_bf16_f32 v166, v22, v23
  v_lshlrev_b32 v22, 16, v166
  v_and_b32 v23, 0xffff0000, v166
  v_cvt_pk_bf16_f32 v167, v24, v25
  v_lshlrev_b32 v24, 16, v167
  v_and_b32 v25, 0xffff0000, v167
  v_cvt_pk_bf16_f32 v164, v26, v27
  v_lshlrev_b32 v26, 16, v164
  v_and_b32 v27, 0xffff0000, v164
  v_cvt_pk_bf16_f32 v165, v28, v29
  v_lshlrev_b32 v28, 16, v165
  v_and_b32 v29, 0xffff0000, v165
  v_cvt_pk_bf16_f32 v166, v30, v31
  v_lshlrev_b32 v30, 16, v166
  v_and_b32 v31, 0xffff0000, v166
  v_cvt_pk_bf16_f32 v167, v32, v33
  v_lshlrev_b32 v32, 16, v167
  v_and_b32 v33, 0xffff0000, v167
  v_cvt_pk_bf16_f32 v164, v34, v35
  v_lshlrev_b32 v34, 16, v164
  v_and_b32 v35, 0xffff0000, v164
  v_cvt_pk_bf16_f32 v165, v36, v37
  v_lshlrev_b32 v36, 16, v165
  v_and_b32 v37, 0xffff0000, v165
  v_cvt_pk_bf16_f32 v166, v38, v39
  v_lshlrev_b32 v38, 16, v166
  v_and_b32 v39, 0xffff0000, v166
  v_cvt_pk_bf16_f32 v167, v40, v41
  v_lshlrev_b32 v40, 16, v167
  v_and_b32 v41, 0xffff0000, v167
  v_pk_mul_f32 v[2:3], v[2:3], v[86:87]
  v_pk_mul_f32 v[4:5], v[4:5], v[86:87]
  v_pk_mul_f32 v[6:7], v[6:7], v[86:87]
  v_pk_mul_f32 v[8:9], v[8:9], v[86:87]
  v_pk_mul_f32 v[10:11], v[10:11], v[86:87]
  v_pk_mul_f32 v[12:13], v[12:13], v[86:87]
  v_pk_mul_f32 v[14:15], v[14:15], v[86:87]
  v_pk_mul_f32 v[16:17], v[16:17], v[86:87]
  v_pk_mul_f32 v[18:19], v[18:19], v[86:87]
  v_pk_mul_f32 v[20:21], v[20:21], v[86:87]
  v_pk_mul_f32 v[22:23], v[22:23], v[86:87]
  v_pk_mul_f32 v[24:25], v[24:25], v[86:87]
  v_pk_mul_f32 v[26:27], v[26:27], v[86:87]
  v_pk_mul_f32 v[28:29], v[28:29], v[86:87]
  v_pk_mul_f32 v[30:31], v[30:31], v[86:87]
  v_pk_mul_f32 v[32:33], v[32:33], v[86:87]
  v_pk_mul_f32 v[34:35], v[34:35], v[86:87]
  v_pk_mul_f32 v[36:37], v[36:37], v[86:87]
  v_pk_mul_f32 v[38:39], v[38:39], v[86:87]
  v_pk_mul_f32 v[40:41], v[40:41], v[86:87]
  v_cvt_pk_bf16_f32 v100, v2, v3
  v_cvt_pk_bf16_f32 v101, v4, v5
  v_cvt_pk_bf16_f32 v102, v6, v7
  v_cvt_pk_bf16_f32 v103, v8, v9
  v_cvt_pk_bf16_f32 v104, v10, v11
  v_cvt_pk_bf16_f32 v105, v12, v13
  v_cvt_pk_bf16_f32 v106, v14, v15
  v_cvt_pk_bf16_f32 v107, v16, v17
  v_cvt_pk_bf16_f32 v108, v18, v19
  v_cvt_pk_bf16_f32 v109, v20, v21
  v_cvt_pk_bf16_f32 v110, v22, v23
  v_cvt_pk_bf16_f32 v111, v24, v25
  v_cvt_pk_bf16_f32 v112, v26, v27
  v_cvt_pk_bf16_f32 v113, v28, v29
  v_cvt_pk_bf16_f32 v114, v30, v31
  v_cvt_pk_bf16_f32 v115, v32, v33
  v_cvt_pk_bf16_f32 v116, v34, v35
  v_cvt_pk_bf16_f32 v117, v36, v37
  v_cvt_pk_bf16_f32 v118, v38, v39
  v_cvt_pk_bf16_f32 v119, v40, v41
  s_waitcnt vmcnt(10)
  v_lshlrev_b32 v2, 16, v120
  v_and_b32 v3, 0xffff0000, v120
  v_lshlrev_b32 v4, 16, v121
  v_and_b32 v5, 0xffff0000, v121
  v_lshlrev_b32 v6, 16, v122
  v_and_b32 v7, 0xffff0000, v122
  v_lshlrev_b32 v8, 16, v123
  v_and_b32 v9, 0xffff0000, v123
  v_lshlrev_b32 v10, 16, v124
  v_and_b32 v11, 0xffff0000, v124
  v_lshlrev_b32 v12, 16, v125
  v_and_b32 v13, 0xffff0000, v125
  v_lshlrev_b32 v14, 16, v126
  v_and_b32 v15, 0xffff0000, v126
  v_lshlrev_b32 v16, 16, v127
  v_and_b32 v17, 0xffff0000, v127
  v_lshlrev_b32 v18, 16, v128
  v_and_b32 v19, 0xffff0000, v128
  v_lshlrev_b32 v20, 16, v129
  v_and_b32 v21, 0xffff0000, v129
  v_lshlrev_b32 v22, 16, v130
  v_and_b32 v23, 0xffff0000, v130
  v_lshlrev_b32 v24, 16, v131
  v_and_b32 v25, 0xffff0000, v131
  v_lshlrev_b32 v26, 16, v132
  v_and_b32 v27, 0xffff0000, v132
  v_lshlrev_b32 v28, 16, v133
  v_and_b32 v29, 0xffff0000, v133
  v_lshlrev_b32 v30, 16, v134
  v_and_b32 v31, 0xffff0000, v134
  v_lshlrev_b32 v32, 16, v135
  v_and_b32 v33, 0xffff0000, v135
  v_lshlrev_b32 v34, 16, v136
  v_and_b32 v35, 0xffff0000, v136
  v_lshlrev_b32 v36, 16, v137
  v_and_b32 v37, 0xffff0000, v137
  v_lshlrev_b32 v38, 16, v138
  v_and_b32 v39, 0xffff0000, v138
  v_lshlrev_b32 v40, 16, v139
  v_and_b32 v41, 0xffff0000, v139
  v_pk_add_f32 v[86:87], v[2:3], v[4:5]
  v_pk_add_f32 v[88:89], v[6:7], v[8:9]
  v_pk_add_f32 v[86:87], v[86:87], v[10:11]
  v_pk_add_f32 v[88:89], v[88:89], v[12:13]
  v_pk_add_f32 v[86:87], v[86:87], v[14:15]
  v_pk_add_f32 v[88:89], v[88:89], v[16:17]
  v_pk_add_f32 v[86:87], v[86:87], v[18:19]
  v_pk_add_f32 v[88:89], v[88:89], v[20:21]
  v_pk_add_f32 v[86:87], v[86:87], v[22:23]
  v_pk_add_f32 v[88:89], v[88:89], v[24:25]
  v_pk_add_f32 v[86:87], v[86:87], v[26:27]
  v_pk_add_f32 v[88:89], v[88:89], v[28:29]
  v_pk_add_f32 v[86:87], v[86:87], v[30:31]
  v_pk_add_f32 v[88:89], v[88:89], v[32:33]
  v_pk_add_f32 v[86:87], v[86:87], v[34:35]
  v_pk_add_f32 v[88:89], v[88:89], v[36:37]
  v_pk_add_f32 v[86:87], v[86:87], v[38:39]
  v_pk_add_f32 v[88:89], v[88:89], v[40:41]
  v_pk_add_f32 v[86:87], v[86:87], v[88:89]
  v_add_f32 v86, v86, v87
  s_nop 1
  v_add_f32_dpp v86, v86, v86 row_ror:8 row_mask:0xf bank_mask:0xf
  s_nop 1
  v_add_f32_dpp v86, v86, v86 row_ror:4 row_mask:0xf bank_mask:0xf
  v_mov_b32 v90, v86
  s_nop 1
  v_permlane16_swap_b32 v86, v90
  v_add_f32 v86, v86, v90
  v_mov_b32 v90, v86
  s_nop 1
  v_permlane32_swap_b32 v86, v90
  v_add_f32 v86, v86, v90
  v_mul_f32 v88, 0xbacccccd, v86
  v_mul_f32 v89, 0xbacccccd, v86
  v_pk_add_f32 v[164:165], v[2:3], v[88:89]
  v_pk_add_f32 v[166:167], v[4:5], v[88:89]
  v_pk_mul_f32 v[170:171], v[164:165], v[164:165]
  v_pk_add_f32 v[168:169], v[6:7], v[88:89]
  v_pk_mul_f32 v[86:87], v[166:167], v[166:167]
  v_pk_add_f32 v[164:165], v[8:9], v[88:89]
  v_pk_fma_f32 v[170:171], v[168:169], v[168:169], v[170:171]
  v_pk_add_f32 v[166:167], v[10:11], v[88:89]
  v_pk_fma_f32 v[86:87], v[164:165], v[164:165], v[86:87]
  v_pk_add_f32 v[168:169], v[12:13], v[88:89]
  v_pk_fma_f32 v[170:171], v[166:167], v[166:167], v[170:171]
  v_pk_add_f32 v[164:165], v[14:15], v[88:89]
  v_pk_fma_f32 v[86:87], v[168:169], v[168:169], v[86:87]
  v_pk_add_f32 v[166:167], v[16:17], v[88:89]
  v_pk_fma_f32 v[170:171], v[164:165], v[164:165], v[170:171]
  v_pk_add_f32 v[168:169], v[18:19], v[88:89]
  v_pk_fma_f32 v[86:87], v[166:167], v[166:167], v[86:87]
  v_pk_add_f32 v[164:165], v[20:21], v[88:89]
  v_pk_fma_f32 v[170:171], v[168:169], v[168:169], v[170:171]
  v_pk_add_f32 v[166:167], v[22:23], v[88:89]
  v_pk_fma_f32 v[86:87], v[164:165], v[164:165], v[86:87]
  v_pk_add_f32 v[168:169], v[24:25], v[88:89]
  v_pk_fma_f32 v[170:171], v[166:167], v[166:167], v[170:171]
  v_pk_add_f32 v[164:165], v[26:27], v[88:89]
  v_pk_fma_f32 v[86:87], v[168:169], v[168:169], v[86:87]
  v_pk_add_f32 v[166:167], v[28:29], v[88:89]
  v_pk_fma_f32 v[170:171], v[164:165], v[164:165], v[170:171]
  v_pk_add_f32 v[168:169], v[30:31], v[88:89]
  v_pk_fma_f32 v[86:87], v[166:167], v[166:167], v[86:87]
  v_pk_add_f32 v[164:165], v[32:33], v[88:89]
  v_pk_fma_f32 v[170:171], v[168:169], v[168:169], v[170:171]
  v_pk_add_f32 v[166:167], v[34:35], v[88:89]
  v_pk_fma_f32 v[86:87], v[164:165], v[164:165], v[86:87]
  v_pk_add_f32 v[168:169], v[36:37], v[88:89]
  v_pk_fma_f32 v[170:171], v[166:167], v[166:167], v[170:171]
  v_pk_add_f32 v[164:165], v[38:39], v[88:89]
  v_pk_fma_f32 v[86:87], v[168:169], v[168:169], v[86:87]
  v_pk_add_f32 v[166:167], v[40:41], v[88:89]
  v_pk_fma_f32 v[170:171], v[164:165], v[164:165], v[170:171]
  v_pk_fma_f32 v[86:87], v[166:167], v[166:167], v[86:87]
  v_cvt_pk_bf16_f32 v91, v88, v89
  v_lshlrev_b32 v88, 16, v91
  v_and_b32 v89, 0xffff0000, v91
  v_pk_add_f32 v[86:87], v[86:87], v[170:171]
  v_add_f32 v86, v86, v87
  s_nop 1
  v_add_f32_dpp v86, v86, v86 row_ror:8 row_mask:0xf bank_mask:0xf
  s_nop 1
  v_add_f32_dpp v86, v86, v86 row_ror:4 row_mask:0xf bank_mask:0xf
  v_mov_b32 v90, v86
  s_nop 1
  v_permlane16_swap_b32 v86, v90
  v_add_f32 v86, v86, v90
  v_mov_b32 v90, v86
  s_nop 1
  v_permlane32_swap_b32 v86, v90
  v_add_f32 v86, v86, v90
  v_pk_add_f32 v[2:3], v[2:3], v[88:89]
  v_mul_f32 v86, 0x3acccccd, v86
  v_pk_add_f32 v[4:5], v[4:5], v[88:89]
  v_cvt_pk_bf16_f32 v86, v86, v86
  v_pk_add_f32 v[6:7], v[6:7], v[88:89]
  v_lshlrev_b32 v86, 16, v86
  v_pk_add_f32 v[8:9], v[8:9], v[88:89]
  v_add_f32 v86, 0x3727c5ac, v86
  v_pk_add_f32 v[10:11], v[10:11], v[88:89]
  v_cvt_pk_bf16_f32 v86, v86, v86
  v_pk_add_f32 v[12:13], v[12:13], v[88:89]
  v_lshlrev_b32 v86, 16, v86
  v_pk_add_f32 v[14:15], v[14:15], v[88:89]
  v_sqrt_f32 v86, v86
  v_pk_add_f32 v[16:17], v[16:17], v[88:89]
  v_cvt_pk_bf16_f32 v86, v86, v86
  v_pk_add_f32 v[18:19], v[18:19], v[88:89]
  v_lshlrev_b32 v86, 16, v86
  v_pk_add_f32 v[20:21], v[20:21], v[88:89]
  v_rcp_f32 v86, v86
  v_pk_add_f32 v[22:23], v[22:23], v[88:89]
  v_mov_b32 v87, v86
  v_pk_add_f32 v[24:25], v[24:25], v[88:89]
  v_pk_add_f32 v[26:27], v[26:27], v[88:89]
  v_pk_add_f32 v[28:29], v[28:29], v[88:89]
  v_pk_add_f32 v[30:31], v[30:31], v[88:89]
  v_pk_add_f32 v[32:33], v[32:33], v[88:89]
  v_pk_add_f32 v[34:35], v[34:35], v[88:89]
  v_pk_add_f32 v[36:37], v[36:37], v[88:89]
  v_pk_add_f32 v[38:39], v[38:39], v[88:89]
  v_pk_add_f32 v[40:41], v[40:41], v[88:89]
  v_cvt_pk_bf16_f32 v164, v2, v3
  v_lshlrev_b32 v2, 16, v164
  v_and_b32 v3, 0xffff0000, v164
  v_cvt_pk_bf16_f32 v165, v4, v5
  v_lshlrev_b32 v4, 16, v165
  v_and_b32 v5, 0xffff0000, v165
  v_cvt_pk_bf16_f32 v166, v6, v7
  v_lshlrev_b32 v6, 16, v166
  v_and_b32 v7, 0xffff0000, v166
  v_cvt_pk_bf16_f32 v167, v8, v9
  v_lshlrev_b32 v8, 16, v167
  v_and_b32 v9, 0xffff0000, v167
  v_cvt_pk_bf16_f32 v164, v10, v11
  v_lshlrev_b32 v10, 16, v164
  v_and_b32 v11, 0xffff0000, v164
  v_cvt_pk_bf16_f32 v165, v12, v13
  v_lshlrev_b32 v12, 16, v165
  v_and_b32 v13, 0xffff0000, v165
  v_cvt_pk_bf16_f32 v166, v14, v15
  v_lshlrev_b32 v14, 16, v166
  v_and_b32 v15, 0xffff0000, v166
  v_cvt_pk_bf16_f32 v167, v16, v17
  v_lshlrev_b32 v16, 16, v167
  v_and_b32 v17, 0xffff0000, v167
  v_cvt_pk_bf16_f32 v164, v18, v19
  v_lshlrev_b32 v18, 16, v164
  v_and_b32 v19, 0xffff0000, v164
  v_cvt_pk_bf16_f32 v165, v20, v21
  v_lshlrev_b32 v20, 16, v165
  v_and_b32 v21, 0xffff0000, v165
  v_cvt_pk_bf16_f32 v166, v22, v23
  v_lshlrev_b32 v22, 16, v166
  v_and_b32 v23, 0xffff0000, v166
  v_cvt_pk_bf16_f32 v167, v24, v25
  v_lshlrev_b32 v24, 16, v167
  v_and_b32 v25, 0xffff0000, v167
  v_cvt_pk_bf16_f32 v164, v26, v27
  v_lshlrev_b32 v26, 16, v164
  v_and_b32 v27, 0xffff0000, v164
  v_cvt_pk_bf16_f32 v165, v28, v29
  v_lshlrev_b32 v28, 16, v165
  v_and_b32 v29, 0xffff0000, v165
  v_cvt_pk_bf16_f32 v166, v30, v31
  v_lshlrev_b32 v30, 16, v166
  v_and_b32 v31, 0xffff0000, v166
  v_cvt_pk_bf16_f32 v167, v32, v33
  v_lshlrev_b32 v32, 16, v167
  v_and_b32 v33, 0xffff0000, v167
  v_cvt_pk_bf16_f32 v164, v34, v35
  v_lshlrev_b32 v34, 16, v164
  v_and_b32 v35, 0xffff0000, v164
  v_cvt_pk_bf16_f32 v165, v36, v37
  v_lshlrev_b32 v36, 16, v165
  v_and_b32 v37, 0xffff0000, v165
  v_cvt_pk_bf16_f32 v166, v38, v39
  v_lshlrev_b32 v38, 16, v166
  v_and_b32 v39, 0xffff0000, v166
  v_cvt_pk_bf16_f32 v167, v40, v41
  v_lshlrev_b32 v40, 16, v167
  v_and_b32 v41, 0xffff0000, v167
  v_pk_mul_f32 v[2:3], v[2:3], v[86:87]
  v_pk_mul_f32 v[4:5], v[4:5], v[86:87]
  v_pk_mul_f32 v[6:7], v[6:7], v[86:87]
  v_pk_mul_f32 v[8:9], v[8:9], v[86:87]
  v_pk_mul_f32 v[10:11], v[10:11], v[86:87]
  v_pk_mul_f32 v[12:13], v[12:13], v[86:87]
  v_pk_mul_f32 v[14:15], v[14:15], v[86:87]
  v_pk_mul_f32 v[16:17], v[16:17], v[86:87]
  v_pk_mul_f32 v[18:19], v[18:19], v[86:87]
  v_pk_mul_f32 v[20:21], v[20:21], v[86:87]
  v_pk_mul_f32 v[22:23], v[22:23], v[86:87]
  v_pk_mul_f32 v[24:25], v[24:25], v[86:87]
  v_pk_mul_f32 v[26:27], v[26:27], v[86:87]
  v_pk_mul_f32 v[28:29], v[28:29], v[86:87]
  v_pk_mul_f32 v[30:31], v[30:31], v[86:87]
  v_pk_mul_f32 v[32:33], v[32:33], v[86:87]
  v_pk_mul_f32 v[34:35], v[34:35], v[86:87]
  v_pk_mul_f32 v[36:37], v[36:37], v[86:87]
  v_pk_mul_f32 v[38:39], v[38:39], v[86:87]
  v_pk_mul_f32 v[40:41], v[40:41], v[86:87]
  v_cvt_pk_bf16_f32 v120, v2, v3
  v_cvt_pk_bf16_f32 v121, v4, v5
  v_cvt_pk_bf16_f32 v122, v6, v7
  v_cvt_pk_bf16_f32 v123, v8, v9
  v_cvt_pk_bf16_f32 v124, v10, v11
  v_cvt_pk_bf16_f32 v125, v12, v13
  v_cvt_pk_bf16_f32 v126, v14, v15
  v_cvt_pk_bf16_f32 v127, v16, v17
  v_cvt_pk_bf16_f32 v128, v18, v19
  v_cvt_pk_bf16_f32 v129, v20, v21
  v_cvt_pk_bf16_f32 v130, v22, v23
  v_cvt_pk_bf16_f32 v131, v24, v25
  v_cvt_pk_bf16_f32 v132, v26, v27
  v_cvt_pk_bf16_f32 v133, v28, v29
  v_cvt_pk_bf16_f32 v134, v30, v31
  v_cvt_pk_bf16_f32 v135, v32, v33
  v_cvt_pk_bf16_f32 v136, v34, v35
  v_cvt_pk_bf16_f32 v137, v36, v37
  v_cvt_pk_bf16_f32 v138, v38, v39
  v_cvt_pk_bf16_f32 v139, v40, v41
  s_cmp_lg_u32 s17, 0
  s_cbranch_scc1 r_g1
  s_lshl_b32 s35, s16, 2
  s_add_u32 s35, s35, 32
  v_mov_b32 v90, 200
  v_mov_b32 v92, 20
  v_writelane_b32 v90, s35, 0
  v_writelane_b32 v92, 1, 0
  s_mov_b32 s34, 0
  s_mov_b64 exec, 3
  s_cmp_eq_u32 s18, 31
  s_cselect_b64 exec, 3, 1
r_gp:
  buffer_load_dword v91, v90, s[12:15], 0 offen sc1
  s_add_u32 s34, s34, 1
  s_cmp_gt_u32 s34, 65536
  s_cbranch_scc1 role_abort
  s_waitcnt vmcnt(0)
  v_cmp_gt_u32 vcc, v92, v91
  s_cbranch_vccz r_gq
  s_sleep 8
  s_branch r_gp
r_gq:
  s_mov_b64 exec, -1
  s_lshl_b32 s35, s16, 8
  s_add_u32 s35, s35, 8320
  v_mov_b32 v90, s35
  v_mov_b32 v92, 1
  s_cmp_lg_u32 s18, 31
  s_cbranch_scc1 r_g2
  buffer_store_dword v92, v90, s[8:11], 0 offen
  s_branch r_g1
r_g2:
  s_mov_b32 s34, 0
pw_9:
  buffer_load_dword v91, v90, s[8:11], 0 offen sc1
  s_add_u32 s34, s34, 1
  s_cmp_gt_u32 s34, 65536
  s_cbranch_scc1 role_abort
  s_waitcnt vmcnt(0)
pc_11:
  v_cmp_gt_u32 vcc, 1, v91
  s_nop 0
  s_and_b32 vcc_lo, vcc_lo, 0x1
  s_and_b32 vcc_hi, vcc_hi, 0x0
  s_cmp_eq_u64 vcc, 0
  s_cbranch_scc1 po_10
  s_sleep 1
  s_branch pw_9
po_10:
r_g1:
  s_barrier
  s_cmp_lg_u32 s32, 9
  s_cbranch_scc1 r_g0
r_g0:
  s_mov_b32 s35, 65536
  s_mov_b32 s33, s54
  buffer_load_dwordx4 v[176:179], v162, s[8:11], s35 offen offset:0 sc1
  buffer_load_dwordx4 v[180:183], v162, s[8:11], s35 offen offset:512 sc1
  buffer_load_dwordx4 v[184:187], v162, s[8:11], s35 offen offset:1024 sc1
  buffer_load_dwordx4 v[188:191], v162, s[8:11], s35 offen offset:1536 sc1
  buffer_load_dwordx4 v[192:195], v162, s[8:11], s35 offen offset:2048 sc1
  s_waitcnt vmcnt(4)
  v_add_f32 v176, v163, v176
  v_add_f32 v177, v163, v177
  v_add_f32 v178, v163, v178
  v_add_f32 v179, v163, v179
  v_cvt_pk_bf16_f32 v90, v176, v177
  v_lshlrev_b32 v176, 16, v90
  v_and_b32 v177, 0xffff0000, v90
  v_cvt_pk_bf16_f32 v91, v178, v179
  v_lshlrev_b32 v178, 16, v91
  v_and_b32 v179, 0xffff0000, v91
  s_waitcnt vmcnt(3)
  v_add_f32 v180, v163, v180
  v_add_f32 v181, v163, v181
  v_add_f32 v182, v163, v182
  v_add_f32 v183, v163, v183
  v_cvt_pk_bf16_f32 v90, v180, v181
  v_lshlrev_b32 v180, 16, v90
  v_and_b32 v181, 0xffff0000, v90
  v_cvt_pk_bf16_f32 v91, v182, v183
  v_lshlrev_b32 v182, 16, v91
  v_and_b32 v183, 0xffff0000, v91
  s_waitcnt vmcnt(2)
  v_add_f32 v184, v163, v184
  v_add_f32 v185, v163, v185
  v_add_f32 v186, v163, v186
  v_add_f32 v187, v163, v187
  v_cvt_pk_bf16_f32 v90, v184, v185
  v_lshlrev_b32 v184, 16, v90
  v_and_b32 v185, 0xffff0000, v90
  v_cvt_pk_bf16_f32 v91, v186, v187
  v_lshlrev_b32 v186, 16, v91
  v_and_b32 v187, 0xffff0000, v91
  s_waitcnt vmcnt(1)
  v_add_f32 v188, v163, v188
  v_add_f32 v189, v163, v189
  v_add_f32 v190, v163, v190
  v_add_f32 v191, v163, v191
  v_cvt_pk_bf16_f32 v90, v188, v189
  v_lshlrev_b32 v188, 16, v90
  v_and_b32 v189, 0xffff0000, v90
  v_cvt_pk_bf16_f32 v91, v190, v191
  v_lshlrev_b32 v190, 16, v91
  v_and_b32 v191, 0xffff0000, v91
  s_waitcnt vmcnt(0)
  v_add_f32 v192, v163, v192
  v_add_f32 v193, v163, v193
  v_add_f32 v194, v163, v194
  v_add_f32 v195, v163, v195
  v_cvt_pk_bf16_f32 v90, v192, v193
  v_lshlrev_b32 v192, 16, v90
  v_and_b32 v193, 0xffff0000, v90
  v_cvt_pk_bf16_f32 v91, v194, v195
  v_lshlrev_b32 v194, 16, v91
  v_and_b32 v195, 0xffff0000, v91
  v_lshlrev_b32 v2, 16, v100
  v_and_b32 v3, 0xffff0000, v100
  v_lshlrev_b32 v4, 16, v101
  v_and_b32 v5, 0xffff0000, v101
  v_lshlrev_b32 v6, 16, v102
  v_and_b32 v7, 0xffff0000, v102
  v_lshlrev_b32 v8, 16, v103
  v_and_b32 v9, 0xffff0000, v103
  v_mul_f32_dpp v2, v176, v2 quad_perm:[2,2,2,2] row_mask:0xf bank_mask:0xf
  v_mul_f32_dpp v3, v177, v3 quad_perm:[2,2,2,2] row_mask:0xf bank_mask:0xf
  v_mul_f32_dpp v4, v178, v4 quad_perm:[2,2,2,2] row_mask:0xf bank_mask:0xf
  v_mul_f32_dpp v5, v179, v5 quad_perm:[2,2,2,2] row_mask:0xf bank_mask:0xf
  v_mul_f32_dpp v6, v176, v6 quad_perm:[3,3,3,3] row_mask:0xf bank_mask:0xf
  v_mul_f32_dpp v7, v177, v7 quad_perm:[3,3,3,3] row_mask:0xf bank_mask:0xf
  v_mul_f32_dpp v8, v178, v8 quad_perm:[3,3,3,3] row_mask:0xf bank_mask:0xf
  v_mul_f32_dpp v9, v179, v9 quad_perm:[3,3,3,3] row_mask:0xf bank_mask:0xf
  v_cvt_pk_bf16_f32 v164, v2, v3
  v_lshlrev_b32 v2, 16, v164
  v_and_b32 v3, 0xffff0000, v164
  v_cvt_pk_bf16_f32 v165, v4, v5
  v_lshlrev_b32 v4, 16, v165
  v_and_b32 v5, 0xffff0000, v165
  v_cvt_pk_bf16_f32 v166, v6, v7
  v_lshlrev_b32 v6, 16, v166
  v_and_b32 v7, 0xffff0000, v166
  v_cvt_pk_bf16_f32 v167, v8, v9
  v_lshlrev_b32 v8, 16, v167
  v_and_b32 v9, 0xffff0000, v167
  v_add_f32_dpp v2, v176, v2 quad_perm:[0,0,0,0] row_mask:0xf bank_mask:0xf
  v_add_f32_dpp v3, v177, v3 quad_perm:[0,0,0,0] row_mask:0xf bank_mask:0xf
  v_add_f32_dpp v4, v178, v4 quad_perm:[0,0,0,0] row_mask:0xf bank_mask:0xf
  v_add_f32_dpp v5, v179, v5 quad_perm:[0,0,0,0] row_mask:0xf bank_mask:0xf
  v_add_f32_dpp v6, v176, v6 quad_perm:[1,1,1,1] row_mask:0xf bank_mask:0xf
  v_add_f32_dpp v7, v177, v7 quad_perm:[1,1,1,1] row_mask:0xf bank_mask:0xf
  v_add_f32_dpp v8, v178, v8 quad_perm:[1,1,1,1] row_mask:0xf bank_mask:0xf
  v_add_f32_dpp v9, v179, v9 quad_perm:[1,1,1,1] row_mask:0xf bank_mask:0xf
  v_cvt_pk_bf16_f32 v196, v2, v3
  v_cvt_pk_bf16_f32 v197, v4, v5
  v_cvt_pk_bf16_f32 v198, v6, v7
  v_cvt_pk_bf16_f32 v199, v8, v9
  s_add_u32 s35, s38, 0
  buffer_store_dwordx4 v[196:199], v161, s[8:11], s35 offen
  v_lshlrev_b32 v10, 16, v104
  v_and_b32 v11, 0xffff0000, v104
  v_lshlrev_b32 v12, 16, v105
  v_and_b32 v13, 0xffff0000, v105
  v_lshlrev_b32 v14, 16, v106
  v_and_b32 v15, 0xffff0000, v106
  v_lshlrev_b32 v16, 16, v107
  v_and_b32 v17, 0xffff0000, v107
  v_mul_f32_dpp v10, v180, v10 quad_perm:[2,2,2,2] row_mask:0xf bank_mask:0xf
  v_mul_f32_dpp v11, v181, v11 quad_perm:[2,2,2,2] row_mask:0xf bank_mask:0xf
  v_mul_f32_dpp v12, v182, v12 quad_perm:[2,2,2,2] row_mask:0xf bank_mask:0xf
  v_mul_f32_dpp v13, v183, v13 quad_perm:[2,2,2,2] row_mask:0xf bank_mask:0xf
  v_mul_f32_dpp v14, v180, v14 quad_perm:[3,3,3,3] row_mask:0xf bank_mask:0xf
  v_mul_f32_dpp v15, v181, v15 quad_perm:[3,3,3,3] row_mask:0xf bank_mask:0xf
  v_mul_f32_dpp v16, v182, v16 quad_perm:[3,3,3,3] row_mask:0xf bank_mask:0xf
  v_mul_f32_dpp v17, v183, v17 quad_perm:[3,3,3,3] row_mask:0xf bank_mask:0xf
  v_cvt_pk_bf16_f32 v164, v10, v11
  v_lshlrev_b32 v10, 16, v164
  v_and_b32 v11, 0xffff0000, v164
  v_cvt_pk_bf16_f32 v165, v12, v13
  v_lshlrev_b32 v12, 16, v165
  v_and_b32 v13, 0xffff0000, v165
  v_cvt_pk_bf16_f32 v166, v14, v15
  v_lshlrev_b32 v14, 16, v166
  v_and_b32 v15, 0xffff0000, v166
  v_cvt_pk_bf16_f32 v167, v16, v17
  v_lshlrev_b32 v16, 16, v167
  v_and_b32 v17, 0xffff0000, v167
  v_add_f32_dpp v10, v180, v10 quad_perm:[0,0,0,0] row_mask:0xf bank_mask:0xf
  v_add_f32_dpp v11, v181, v11 quad_perm:[0,0,0,0] row_mask:0xf bank_mask:0xf
  v_add_f32_dpp v12, v182, v12 quad_perm:[0,0,0,0] row_mask:0xf bank_mask:0xf
  v_add_f32_dpp v13, v183, v13 quad_perm:[0,0,0,0] row_mask:0xf bank_mask:0xf
  v_add_f32_dpp v14, v180, v14 quad_perm:[1,1,1,1] row_mask:0xf bank_mask:0xf
  v_add_f32_dpp v15, v181, v15 quad_perm:[1,1,1,1] row_mask:0xf bank_mask:0xf
  v_add_f32_dpp v16, v182, v16 quad_perm:[1,1,1,1] row_mask:0xf bank_mask:0xf
  v_add_f32_dpp v17, v183, v17 quad_perm:[1,1,1,1] row_mask:0xf bank_mask:0xf
  v_cvt_pk_bf16_f32 v200, v10, v11
  v_cvt_pk_bf16_f32 v201, v12, v13
  v_cvt_pk_bf16_f32 v202, v14, v15
  v_cvt_pk_bf16_f32 v203, v16, v17
  s_add_u32 s35, s38, 4096
  buffer_store_dwordx4 v[200:203], v161, s[8:11], s35 offen
  v_lshlrev_b32 v18, 16, v108
  v_and_b32 v19, 0xffff0000, v108
  v_lshlrev_b32 v20, 16, v109
  v_and_b32 v21, 0xffff0000, v109
  v_lshlrev_b32 v22, 16, v110
  v_and_b32 v23, 0xffff0000, v110
  v_lshlrev_b32 v24, 16, v111
  v_and_b32 v25, 0xffff0000, v111
  v_mul_f32_dpp v18, v184, v18 quad_perm:[2,2,2,2] row_mask:0xf bank_mask:0xf
  v_mul_f32_dpp v19, v185, v19 quad_perm:[2,2,2,2] row_mask:0xf bank_mask:0xf
  v_mul_f32_dpp v20, v186, v20 quad_perm:[2,2,2,2] row_mask:0xf bank_mask:0xf
  v_mul_f32_dpp v21, v187, v21 quad_perm:[2,2,2,2] row_mask:0xf bank_mask:0xf
  v_mul_f32_dpp v22, v184, v22 quad_perm:[3,3,3,3] row_mask:0xf bank_mask:0xf
  v_mul_f32_dpp v23, v185, v23 quad_perm:[3,3,3,3] row_mask:0xf bank_mask:0xf
  v_mul_f32_dpp v24, v186, v24 quad_perm:[3,3,3,3] row_mask:0xf bank_mask:0xf
  v_mul_f32_dpp v25, v187, v25 quad_perm:[3,3,3,3] row_mask:0xf bank_mask:0xf
  v_cvt_pk_bf16_f32 v164, v18, v19
  v_lshlrev_b32 v18, 16, v164
  v_and_b32 v19, 0xffff0000, v164
  v_cvt_pk_bf16_f32 v165, v20, v21
  v_lshlrev_b32 v20, 16, v165
  v_and_b32 v21, 0xffff0000, v165
  v_cvt_pk_bf16_f32 v166, v22, v23
  v_lshlrev_b32 v22, 16, v166
  v_and_b32 v23, 0xffff0000, v166
  v_cvt_pk_bf16_f32 v167, v24, v25
  v_lshlrev_b32 v24, 16, v167
  v_and_b32 v25, 0xffff0000, v167
  v_add_f32_dpp v18, v184, v18 quad_perm:[0,0,0,0] row_mask:0xf bank_mask:0xf
  v_add_f32_dpp v19, v185, v19 quad_perm:[0,0,0,0] row_mask:0xf bank_mask:0xf
  v_add_f32_dpp v20, v186, v20 quad_perm:[0,0,0,0] row_mask:0xf bank_mask:0xf
  v_add_f32_dpp v21, v187, v21 quad_perm:[0,0,0,0] row_mask:0xf bank_mask:0xf
  v_add_f32_dpp v22, v184, v22 quad_perm:[1,1,1,1] row_mask:0xf bank_mask:0xf
  v_add_f32_dpp v23, v185, v23 quad_perm:[1,1,1,1] row_mask:0xf bank_mask:0xf
  v_add_f32_dpp v24, v186, v24 quad_perm:[1,1,1,1] row_mask:0xf bank_mask:0xf
  v_add_f32_dpp v25, v187, v25 quad_perm:[1,1,1,1] row_mask:0xf bank_mask:0xf
  v_cvt_pk_bf16_f32 v204, v18, v19
  v_cvt_pk_bf16_f32 v205, v20, v21
  v_cvt_pk_bf16_f32 v206, v22, v23
  v_cvt_pk_bf16_f32 v207, v24, v25
  s_add_u32 s35, s38, 8192
  buffer_store_dwordx4 v[204:207], v161, s[8:11], s35 offen
  v_lshlrev_b32 v26, 16, v112
  v_and_b32 v27, 0xffff0000, v112
  v_lshlrev_b32 v28, 16, v113
  v_and_b32 v29, 0xffff0000, v113
  v_lshlrev_b32 v30, 16, v114
  v_and_b32 v31, 0xffff0000, v114
  v_lshlrev_b32 v32, 16, v115
  v_and_b32 v33, 0xffff0000, v115
  v_mul_f32_dpp v26, v188, v26 quad_perm:[2,2,2,2] row_mask:0xf bank_mask:0xf
  v_mul_f32_dpp v27, v189, v27 quad_perm:[2,2,2,2] row_mask:0xf bank_mask:0xf
  v_mul_f32_dpp v28, v190, v28 quad_perm:[2,2,2,2] row_mask:0xf bank_mask:0xf
  v_mul_f32_dpp v29, v191, v29 quad_perm:[2,2,2,2] row_mask:0xf bank_mask:0xf
  v_mul_f32_dpp v30, v188, v30 quad_perm:[3,3,3,3] row_mask:0xf bank_mask:0xf
  v_mul_f32_dpp v31, v189, v31 quad_perm:[3,3,3,3] row_mask:0xf bank_mask:0xf
  v_mul_f32_dpp v32, v190, v32 quad_perm:[3,3,3,3] row_mask:0xf bank_mask:0xf
  v_mul_f32_dpp v33, v191, v33 quad_perm:[3,3,3,3] row_mask:0xf bank_mask:0xf
  v_cvt_pk_bf16_f32 v164, v26, v27
  v_lshlrev_b32 v26, 16, v164
  v_and_b32 v27, 0xffff0000, v164
  v_cvt_pk_bf16_f32 v165, v28, v29
  v_lshlrev_b32 v28, 16, v165
  v_and_b32 v29, 0xffff0000, v165
  v_cvt_pk_bf16_f32 v166, v30, v31
  v_lshlrev_b32 v30, 16, v166
  v_and_b32 v31, 0xffff0000, v166
  v_cvt_pk_bf16_f32 v167, v32, v33
  v_lshlrev_b32 v32, 16, v167
  v_and_b32 v33, 0xffff0000, v167
  v_add_f32_dpp v26, v188, v26 quad_perm:[0,0,0,0] row_mask:0xf bank_mask:0xf
  v_add_f32_dpp v27, v189, v27 quad_perm:[0,0,0,0] row_mask:0xf bank_mask:0xf
  v_add_f32_dpp v28, v190, v28 quad_perm:[0,0,0,0] row_mask:0xf bank_mask:0xf
  v_add_f32_dpp v29, v191, v29 quad_perm:[0,0,0,0] row_mask:0xf bank_mask:0xf
  v_add_f32_dpp v30, v188, v30 quad_perm:[1,1,1,1] row_mask:0xf bank_mask:0xf
  v_add_f32_dpp v31, v189, v31 quad_perm:[1,1,1,1] row_mask:0xf bank_mask:0xf
  v_add_f32_dpp v32, v190, v32 quad_perm:[1,1,1,1] row_mask:0xf bank_mask:0xf
  v_add_f32_dpp v33, v191, v33 quad_perm:[1,1,1,1] row_mask:0xf bank_mask:0xf
  v_cvt_pk_bf16_f32 v208, v26, v27
  v_cvt_pk_bf16_f32 v209, v28, v29
  v_cvt_pk_bf16_f32 v210, v30, v31
  v_cvt_pk_bf16_f32 v211, v32, v33
  s_add_u32 s35, s38, 12288
  buffer_store_dwordx4 v[208:211], v161, s[8:11], s35 offen
  v_lshlrev_b32 v34, 16, v116
  v_and_b32 v35, 0xffff0000, v116
  v_lshlrev_b32 v36, 16, v117
  v_and_b32 v37, 0xffff0000, v117
  v_lshlrev_b32 v38, 16, v118
  v_and_b32 v39, 0xffff0000, v118
  v_lshlrev_b32 v40, 16, v119
  v_and_b32 v41, 0xffff0000, v119
  v_mul_f32_dpp v34, v192, v34 quad_perm:[2,2,2,2] row_mask:0xf bank_mask:0xf
  v_mul_f32_dpp v35, v193, v35 quad_perm:[2,2,2,2] row_mask:0xf bank_mask:0xf
  v_mul_f32_dpp v36, v194, v36 quad_perm:[2,2,2,2] row_mask:0xf bank_mask:0xf
  v_mul_f32_dpp v37, v195, v37 quad_perm:[2,2,2,2] row_mask:0xf bank_mask:0xf
  v_mul_f32_dpp v38, v192, v38 quad_perm:[3,3,3,3] row_mask:0xf bank_mask:0xf
  v_mul_f32_dpp v39, v193, v39 quad_perm:[3,3,3,3] row_mask:0xf bank_mask:0xf
  v_mul_f32_dpp v40, v194, v40 quad_perm:[3,3,3,3] row_mask:0xf bank_mask:0xf
  v_mul_f32_dpp v41, v195, v41 quad_perm:[3,3,3,3] row_mask:0xf bank_mask:0xf
  v_cvt_pk_bf16_f32 v164, v34, v35
  v_lshlrev_b32 v34, 16, v164
  v_and_b32 v35, 0xffff0000, v164
  v_cvt_pk_bf16_f32 v165, v36, v37
  v_lshlrev_b32 v36, 16, v165
  v_and_b32 v37, 0xffff0000, v165
  v_cvt_pk_bf16_f32 v166, v38, v39
  v_lshlrev_b32 v38, 16, v166
  v_and_b32 v39, 0xffff0000, v166
  v_cvt_pk_bf16_f32 v167, v40, v41
  v_lshlrev_b32 v40, 16, v167
  v_and_b32 v41, 0xffff0000, v167
  v_add_f32_dpp v34, v192, v34 quad_perm:[0,0,0,0] row_mask:0xf bank_mask:0xf
  v_add_f32_dpp v35, v193, v35 quad_perm:[0,0,0,0] row_mask:0xf bank_mask:0xf
  v_add_f32_dpp v36, v194, v36 quad_perm:[0,0,0,0] row_mask:0xf bank_mask:0xf
  v_add_f32_dpp v37, v195, v37 quad_perm:[0,0,0,0] row_mask:0xf bank_mask:0xf
  v_add_f32_dpp v38, v192, v38 quad_perm:[1,1,1,1] row_mask:0xf bank_mask:0xf
  v_add_f32_dpp v39, v193, v39 quad_perm:[1,1,1,1] row_mask:0xf bank_mask:0xf
  v_add_f32_dpp v40, v194, v40 quad_perm:[1,1,1,1] row_mask:0xf bank_mask:0xf
  v_add_f32_dpp v41, v195, v41 quad_perm:[1,1,1,1] row_mask:0xf bank_mask:0xf
  v_cvt_pk_bf16_f32 v212, v34, v35
  v_cvt_pk_bf16_f32 v213, v36, v37
  v_cvt_pk_bf16_f32 v214, v38, v39
  v_cvt_pk_bf16_f32 v215, v40, v41
  s_add_u32 s35, s38, 16384
  buffer_store_dwordx4 v[212:215], v161, s[8:11], s35 offen
  s_add_u32 s36, s41, 24
  s_cmp_lt_u32 s41, 24
  s_cselect_b32 s36, s39, s36
  s_add_u32 s41, s41, 3
  s_cmp_lt_u32 s41, 24
  s_cselect_b32 s41, s41, s36
  s_min_u32 s41, s41, 127
  s_mul_i32 s38, s16, 2621440
  s_cmp_lt_u32 s41, 24
  s_cselect_b32 s38, s38, 0
  s_mul_i32 s36, s41, 20480
  s_add_u32 s38, s38, s36
  s_lshl_b32 s36, s17, 6
  s_add_u32 s38, s38, s36
  s_add_u32 s38, s38, 247463936
  s_add_u32 s33, s33, 3
  v_lshlrev_b32 v2, 16, v120
  v_and_b32 v3, 0xffff0000, v120
  v_lshlrev_b32 v4, 16, v121
  v_and_b32 v5, 0xffff0000, v121
  v_lshlrev_b32 v6, 16, v122
  v_and_b32 v7, 0xffff0000, v122
  v_lshlrev_b32 v8, 16, v123
  v_and_b32 v9, 0xffff0000, v123
  v_mul_f32_dpp v2, v176, v2 quad_perm:[2,2,2,2] row_mask:0xf bank_mask:0xf
  v_mul_f32_dpp v3, v177, v3 quad_perm:[2,2,2,2] row_mask:0xf bank_mask:0xf
  v_mul_f32_dpp v4, v178, v4 quad_perm:[2,2,2,2] row_mask:0xf bank_mask:0xf
  v_mul_f32_dpp v5, v179, v5 quad_perm:[2,2,2,2] row_mask:0xf bank_mask:0xf
  v_mul_f32_dpp v6, v176, v6 quad_perm:[3,3,3,3] row_mask:0xf bank_mask:0xf
  v_mul_f32_dpp v7, v177, v7 quad_perm:[3,3,3,3] row_mask:0xf bank_mask:0xf
  v_mul_f32_dpp v8, v178, v8 quad_perm:[3,3,3,3] row_mask:0xf bank_mask:0xf
  v_mul_f32_dpp v9, v179, v9 quad_perm:[3,3,3,3] row_mask:0xf bank_mask:0xf
  v_cvt_pk_bf16_f32 v164, v2, v3
  v_lshlrev_b32 v2, 16, v164
  v_and_b32 v3, 0xffff0000, v164
  v_cvt_pk_bf16_f32 v165, v4, v5
  v_lshlrev_b32 v4, 16, v165
  v_and_b32 v5, 0xffff0000, v165
  v_cvt_pk_bf16_f32 v166, v6, v7
  v_lshlrev_b32 v6, 16, v166
  v_and_b32 v7, 0xffff0000, v166
  v_cvt_pk_bf16_f32 v167, v8, v9
  v_lshlrev_b32 v8, 16, v167
  v_and_b32 v9, 0xffff0000, v167
  v_add_f32_dpp v2, v176, v2 quad_perm:[0,0,0,0] row_mask:0xf bank_mask:0xf
  v_add_f32_dpp v3, v177, v3 quad_perm:[0,0,0,0] row_mask:0xf bank_mask:0xf
  v_add_f32_dpp v4, v178, v4 quad_perm:[0,0,0,0] row_mask:0xf bank_mask:0xf
  v_add_f32_dpp v5, v179, v5 quad_perm:[0,0,0,0] row_mask:0xf bank_mask:0xf
  v_add_f32_dpp v6, v176, v6 quad_perm:[1,1,1,1] row_mask:0xf bank_mask:0xf
  v_add_f32_dpp v7, v177, v7 quad_perm:[1,1,1,1] row_mask:0xf bank_mask:0xf
  v_add_f32_dpp v8, v178, v8 quad_perm:[1,1,1,1] row_mask:0xf bank_mask:0xf
  v_add_f32_dpp v9, v179, v9 quad_perm:[1,1,1,1] row_mask:0xf bank_mask:0xf
  v_cvt_pk_bf16_f32 v196, v2, v3
  v_cvt_pk_bf16_f32 v197, v4, v5
  v_cvt_pk_bf16_f32 v198, v6, v7
  v_cvt_pk_bf16_f32 v199, v8, v9
  s_sub_u32 s36, s33, 0
  s_min_u32 s36, s36, 24
  v_mov_b32 v92, s36
  s_waitcnt vmcnt(0)
  buffer_store_dword v92, v228, s[8:11], 0 offen
  s_add_u32 s35, s38, 0
  buffer_store_dwordx4 v[196:199], v161, s[8:11], s35 offen
  v_lshlrev_b32 v10, 16, v124
  v_and_b32 v11, 0xffff0000, v124
  v_lshlrev_b32 v12, 16, v125
  v_and_b32 v13, 0xffff0000, v125
  v_lshlrev_b32 v14, 16, v126
  v_and_b32 v15, 0xffff0000, v126
  v_lshlrev_b32 v16, 16, v127
  v_and_b32 v17, 0xffff0000, v127
  v_mul_f32_dpp v10, v180, v10 quad_perm:[2,2,2,2] row_mask:0xf bank_mask:0xf
  v_mul_f32_dpp v11, v181, v11 quad_perm:[2,2,2,2] row_mask:0xf bank_mask:0xf
  v_mul_f32_dpp v12, v182, v12 quad_perm:[2,2,2,2] row_mask:0xf bank_mask:0xf
  v_mul_f32_dpp v13, v183, v13 quad_perm:[2,2,2,2] row_mask:0xf bank_mask:0xf
  v_mul_f32_dpp v14, v180, v14 quad_perm:[3,3,3,3] row_mask:0xf bank_mask:0xf
  v_mul_f32_dpp v15, v181, v15 quad_perm:[3,3,3,3] row_mask:0xf bank_mask:0xf
  v_mul_f32_dpp v16, v182, v16 quad_perm:[3,3,3,3] row_mask:0xf bank_mask:0xf
  v_mul_f32_dpp v17, v183, v17 quad_perm:[3,3,3,3] row_mask:0xf bank_mask:0xf
  v_cvt_pk_bf16_f32 v164, v10, v11
  v_lshlrev_b32 v10, 16, v164
  v_and_b32 v11, 0xffff0000, v164
  v_cvt_pk_bf16_f32 v165, v12, v13
  v_lshlrev_b32 v12, 16, v165
  v_and_b32 v13, 0xffff0000, v165
  v_cvt_pk_bf16_f32 v166, v14, v15
  v_lshlrev_b32 v14, 16, v166
  v_and_b32 v15, 0xffff0000, v166
  v_cvt_pk_bf16_f32 v167, v16, v17
  v_lshlrev_b32 v16, 16, v167
  v_and_b32 v17, 0xffff0000, v167
  v_add_f32_dpp v10, v180, v10 quad_perm:[0,0,0,0] row_mask:0xf bank_mask:0xf
  v_add_f32_dpp v11, v181, v11 quad_perm:[0,0,0,0] row_mask:0xf bank_mask:0xf
  v_add_f32_dpp v12, v182, v12 quad_perm:[0,0,0,0] row_mask:0xf bank_mask:0xf
  v_add_f32_dpp v13, v183, v13 quad_perm:[0,0,0,0] row_mask:0xf bank_mask:0xf
  v_add_f32_dpp v14, v180, v14 quad_perm:[1,1,1,1] row_mask:0xf bank_mask:0xf
  v_add_f32_dpp v15, v181, v15 quad_perm:[1,1,1,1] row_mask:0xf bank_mask:0xf
  v_add_f32_dpp v16, v182, v16 quad_perm:[1,1,1,1] row_mask:0xf bank_mask:0xf
  v_add_f32_dpp v17, v183, v17 quad_perm:[1,1,1,1] row_mask:0xf bank_mask:0xf
  v_cvt_pk_bf16_f32 v200, v10, v11
  v_cvt_pk_bf16_f32 v201, v12, v13
  v_cvt_pk_bf16_f32 v202, v14, v15
  v_cvt_pk_bf16_f32 v203, v16, v17
  s_add_u32 s35, s38, 4096
  buffer_store_dwordx4 v[200:203], v161, s[8:11], s35 offen
  v_lshlrev_b32 v18, 16, v128
  v_and_b32 v19, 0xffff0000, v128
  v_lshlrev_b32 v20, 16, v129
  v_and_b32 v21, 0xffff0000, v129
  v_lshlrev_b32 v22, 16, v130
  v_and_b32 v23, 0xffff0000, v130
  v_lshlrev_b32 v24, 16, v131
  v_and_b32 v25, 0xffff0000, v131
  v_mul_f32_dpp v18, v184, v18 quad_perm:[2,2,2,2] row_mask:0xf bank_mask:0xf
  v_mul_f32_dpp v19, v185, v19 quad_perm:[2,2,2,2] row_mask:0xf bank_mask:0xf
  v_mul_f32_dpp v20, v186, v20 quad_perm:[2,2,2,2] row_mask:0xf bank_mask:0xf
  v_mul_f32_dpp v21, v187, v21 quad_perm:[2,2,2,2] row_mask:0xf bank_mask:0xf
  v_mul_f32_dpp v22, v184, v22 quad_perm:[3,3,3,3] row_mask:0xf bank_mask:0xf
  v_mul_f32_dpp v23, v185, v23 quad_perm:[3,3,3,3] row_mask:0xf bank_mask:0xf
  v_mul_f32_dpp v24, v186, v24 quad_perm:[3,3,3,3] row_mask:0xf bank_mask:0xf
  v_mul_f32_dpp v25, v187, v25 quad_perm:[3,3,3,3] row_mask:0xf bank_mask:0xf
  v_cvt_pk_bf16_f32 v164, v18, v19
  v_lshlrev_b32 v18, 16, v164
  v_and_b32 v19, 0xffff0000, v164
  v_cvt_pk_bf16_f32 v165, v20, v21
  v_lshlrev_b32 v20, 16, v165
  v_and_b32 v21, 0xffff0000, v165
  v_cvt_pk_bf16_f32 v166, v22, v23
  v_lshlrev_b32 v22, 16, v166
  v_and_b32 v23, 0xffff0000, v166
  v_cvt_pk_bf16_f32 v167, v24, v25
  v_lshlrev_b32 v24, 16, v167
  v_and_b32 v25, 0xffff0000, v167
  v_add_f32_dpp v18, v184, v18 quad_perm:[0,0,0,0] row_mask:0xf bank_mask:0xf
  v_add_f32_dpp v19, v185, v19 quad_perm:[0,0,0,0] row_mask:0xf bank_mask:0xf
  v_add_f32_dpp v20, v186, v20 quad_perm:[0,0,0,0] row_mask:0xf bank_mask:0xf
  v_add_f32_dpp v21, v187, v21 quad_perm:[0,0,0,0] row_mask:0xf bank_mask:0xf
  v_add_f32_dpp v22, v184, v22 quad_perm:[1,1,1,1] row_mask:0xf bank_mask:0xf
  v_add_f32_dpp v23, v185, v23 quad_perm:[1,1,1,1] row_mask:0xf bank_mask:0xf
  v_add_f32_dpp v24, v186, v24 quad_perm:[1,1,1,1] row_mask:0xf bank_mask:0xf
  v_add_f32_dpp v25, v187, v25 quad_perm:[1,1,1,1] row_mask:0xf bank_mask:0xf
  v_cvt_pk_bf16_f32 v204, v18, v19
  v_cvt_pk_bf16_f32 v205, v20, v21
  v_cvt_pk_bf16_f32 v206, v22, v23
  v_cvt_pk_bf16_f32 v207, v24, v25
  s_add_u32 s35, s38, 8192
  buffer_store_dwordx4 v[204:207], v161, s[8:11], s35 offen
  v_lshlrev_b32 v26, 16, v132
  v_and_b32 v27, 0xffff0000, v132
  v_lshlrev_b32 v28, 16, v133
  v_and_b32 v29, 0xffff0000, v133
  v_lshlrev_b32 v30, 16, v134
  v_and_b32 v31, 0xffff0000, v134
  v_lshlrev_b32 v32, 16, v135
  v_and_b32 v33, 0xffff0000, v135
  v_mul_f32_dpp v26, v188, v26 quad_perm:[2,2,2,2] row_mask:0xf bank_mask:0xf
  v_mul_f32_dpp v27, v189, v27 quad_perm:[2,2,2,2] row_mask:0xf bank_mask:0xf
  v_mul_f32_dpp v28, v190, v28 quad_perm:[2,2,2,2] row_mask:0xf bank_mask:0xf
  v_mul_f32_dpp v29, v191, v29 quad_perm:[2,2,2,2] row_mask:0xf bank_mask:0xf
  v_mul_f32_dpp v30, v188, v30 quad_perm:[3,3,3,3] row_mask:0xf bank_mask:0xf
  v_mul_f32_dpp v31, v189, v31 quad_perm:[3,3,3,3] row_mask:0xf bank_mask:0xf
  v_mul_f32_dpp v32, v190, v32 quad_perm:[3,3,3,3] row_mask:0xf bank_mask:0xf
  v_mul_f32_dpp v33, v191, v33 quad_perm:[3,3,3,3] row_mask:0xf bank_mask:0xf
  v_cvt_pk_bf16_f32 v164, v26, v27
  v_lshlrev_b32 v26, 16, v164
  v_and_b32 v27, 0xffff0000, v164
  v_cvt_pk_bf16_f32 v165, v28, v29
  v_lshlrev_b32 v28, 16, v165
  v_and_b32 v29, 0xffff0000, v165
  v_cvt_pk_bf16_f32 v166, v30, v31
  v_lshlrev_b32 v30, 16, v166
  v_and_b32 v31, 0xffff0000, v166
  v_cvt_pk_bf16_f32 v167, v32, v33
  v_lshlrev_b32 v32, 16, v167
  v_and_b32 v33, 0xffff0000, v167
  v_add_f32_dpp v26, v188, v26 quad_perm:[0,0,0,0] row_mask:0xf bank_mask:0xf
  v_add_f32_dpp v27, v189, v27 quad_perm:[0,0,0,0] row_mask:0xf bank_mask:0xf
  v_add_f32_dpp v28, v190, v28 quad_perm:[0,0,0,0] row_mask:0xf bank_mask:0xf
  v_add_f32_dpp v29, v191, v29 quad_perm:[0,0,0,0] row_mask:0xf bank_mask:0xf
  v_add_f32_dpp v30, v188, v30 quad_perm:[1,1,1,1] row_mask:0xf bank_mask:0xf
  v_add_f32_dpp v31, v189, v31 quad_perm:[1,1,1,1] row_mask:0xf bank_mask:0xf
  v_add_f32_dpp v32, v190, v32 quad_perm:[1,1,1,1] row_mask:0xf bank_mask:0xf
  v_add_f32_dpp v33, v191, v33 quad_perm:[1,1,1,1] row_mask:0xf bank_mask:0xf
  v_cvt_pk_bf16_f32 v208, v26, v27
  v_cvt_pk_bf16_f32 v209, v28, v29
  v_cvt_pk_bf16_f32 v210, v30, v31
  v_cvt_pk_bf16_f32 v211, v32, v33
  s_add_u32 s35, s38, 12288
  buffer_store_dwordx4 v[208:211], v161, s[8:11], s35 offen
  v_lshlrev_b32 v34, 16, v136
  v_and_b32 v35, 0xffff0000, v136
  v_lshlrev_b32 v36, 16, v137
  v_and_b32 v37, 0xffff0000, v137
  v_lshlrev_b32 v38, 16, v138
  v_and_b32 v39, 0xffff0000, v138
  v_lshlrev_b32 v40, 16, v139
  v_and_b32 v41, 0xffff0000, v139
  v_mul_f32_dpp v34, v192, v34 quad_perm:[2,2,2,2] row_mask:0xf bank_mask:0xf
  v_mul_f32_dpp v35, v193, v35 quad_perm:[2,2,2,2] row_mask:0xf bank_mask:0xf
  v_mul_f32_dpp v36, v194, v36 quad_perm:[2,2,2,2] row_mask:0xf bank_mask:0xf
  v_mul_f32_dpp v37, v195, v37 quad_perm:[2,2,2,2] row_mask:0xf bank_mask:0xf
  v_mul_f32_dpp v38, v192, v38 quad_perm:[3,3,3,3] row_mask:0xf bank_mask:0xf
  v_mul_f32_dpp v39, v193, v39 quad_perm:[3,3,3,3] row_mask:0xf bank_mask:0xf
  v_mul_f32_dpp v40, v194, v40 quad_perm:[3,3,3,3] row_mask:0xf bank_mask:0xf
  v_mul_f32_dpp v41, v195, v41 quad_perm:[3,3,3,3] row_mask:0xf bank_mask:0xf
  v_cvt_pk_bf16_f32 v164, v34, v35
  v_lshlrev_b32 v34, 16, v164
  v_and_b32 v35, 0xffff0000, v164
  v_cvt_pk_bf16_f32 v165, v36, v37
  v_lshlrev_b32 v36, 16, v165
  v_and_b32 v37, 0xffff0000, v165
  v_cvt_pk_bf16_f32 v166, v38, v39
  v_lshlrev_b32 v38, 16, v166
  v_and_b32 v39, 0xffff0000, v166
  v_cvt_pk_bf16_f32 v167, v40, v41
  v_lshlrev_b32 v40, 16, v167
  v_and_b32 v41, 0xffff0000, v167
  v_add_f32_dpp v34, v192, v34 quad_perm:[0,0,0,0] row_mask:0xf bank_mask:0xf
  v_add_f32_dpp v35, v193, v35 quad_perm:[0,0,0,0] row_mask:0xf bank_mask:0xf
  v_add_f32_dpp v36, v194, v36 quad_perm:[0,0,0,0] row_mask:0xf bank_mask:0xf
  v_add_f32_dpp v37, v195, v37 quad_perm:[0,0,0,0] row_mask:0xf bank_mask:0xf
  v_add_f32_dpp v38, v192, v38 quad_perm:[1,1,1,1] row_mask:0xf bank_mask:0xf
  v_add_f32_dpp v39, v193, v39 quad_perm:[1,1,1,1] row_mask:0xf bank_mask:0xf
  v_add_f32_dpp v40, v194, v40 quad_perm:[1,1,1,1] row_mask:0xf bank_mask:0xf
  v_add_f32_dpp v41, v195, v41 quad_perm:[1,1,1,1] row_mask:0xf bank_mask:0xf
  v_cvt_pk_bf16_f32 v212, v34, v35
  v_cvt_pk_bf16_f32 v213, v36, v37
  v_cvt_pk_bf16_f32 v214, v38, v39
  v_cvt_pk_bf16_f32 v215, v40, v41
  s_add_u32 s35, s38, 16384
  buffer_store_dwordx4 v[212:215], v161, s[8:11], s35 offen
  s_add_u32 s36, s41, 24
  s_cmp_lt_u32 s41, 24
  s_cselect_b32 s36, s39, s36
  s_add_u32 s41, s41, 3
  s_cmp_lt_u32 s41, 24
  s_cselect_b32 s41, s41, s36
  s_min_u32 s41, s41, 127
  s_mul_i32 s38, s16, 2621440
  s_cmp_lt_u32 s41, 24
  s_cselect_b32 s38, s38, 0
  s_mul_i32 s36, s41, 20480
  s_add_u32 s38, s38, s36
  s_lshl_b32 s36, s17, 6
  s_add_u32 s38, s38, s36
  s_add_u32 s38, s38, 247463936
  s_add_u32 s33, s33, 3
  s_sub_u32 s36, s33, 0
  s_min_u32 s36, s36, 24
  v_mov_b32 v92, s36
  s_waitcnt vmcnt(0)
  buffer_store_dword v92, v228, s[8:11], 0 offen
  buffer_load_dwordx2 v[66:67], v160, s[20:23], s37 offen offset:0
  buffer_load_dwordx2 v[68:69], v160, s[20:23], s37 offen offset:32
  buffer_load_dwordx2 v[70:71], v160, s[20:23], s37 offen offset:256
  buffer_load_dwordx2 v[72:73], v160, s[20:23], s37 offen offset:288
  buffer_load_dwordx2 v[74:75], v160, s[20:23], s37 offen offset:512
  buffer_load_dwordx2 v[76:77], v160, s[20:23], s37 offen offset:544
  buffer_load_dwordx2 v[78:79], v160, s[20:23], s37 offen offset:768
  buffer_load_dwordx2 v[80:81], v160, s[20:23], s37 offen offset:800
  buffer_load_dwordx2 v[82:83], v160, s[20:23], s37 offen offset:1024
  buffer_load_dwordx2 v[84:85], v160, s[20:23], s37 offen offset:1056
  s_add_u32 s36, s40, 24
  s_cmp_lt_u32 s40, 24
  s_cselect_b32 s36, s39, s36
  s_add_u32 s40, s40, 3
  s_cmp_lt_u32 s40, 24
  s_cselect_b32 s40, s40, s36
  s_min_u32 s40, s40, 127
  s_mul_i32 s37, s40, 20480
  s_mul_i32 s36, s17, 5120
  s_add_u32 s37, s37, s36
  v_lshlrev_b32 v2, 16, v46
  v_and_b32 v3, 0xffff0000, v46
  v_lshlrev_b32 v4, 16, v47
  v_and_b32 v5, 0xffff0000, v47
  v_lshlrev_b32 v6, 16, v48
  v_and_b32 v7, 0xffff0000, v48
  v_lshlrev_b32 v8, 16, v49
  v_and_b32 v9, 0xffff0000, v49
  v_lshlrev_b32 v10, 16, v50
  v_and_b32 v11, 0xffff0000, v50
  v_lshlrev_b32 v12, 16, v51
  v_and_b32 v13, 0xffff0000, v51
  v_lshlrev_b32 v14, 16, v52
  v_and_b32 v15, 0xffff0000, v52
  v_lshlrev_b32 v16, 16, v53
  v_and_b32 v17, 0xffff0000, v53
  v_lshlrev_b32 v18, 16, v54
  v_and_b32 v19, 0xffff0000, v54
  v_lshlrev_b32 v20, 16, v55
  v_and_b32 v21, 0xffff0000, v55
  v_lshlrev_b32 v22, 16, v56
  v_and_b32 v23, 0xffff0000, v56
  v_lshlrev_b32 v24, 16, v57
  v_and_b32 v25, 0xffff0000, v57
  v_lshlrev_b32 v26, 16, v58
  v_and_b32 v27, 0xffff0000, v58
  v_lshlrev_b32 v28, 16, v59
  v_and_b32 v29, 0xffff0000, v59
  v_lshlrev_b32 v30, 16, v60
  v_and_b32 v31, 0xffff0000, v60
  v_lshlrev_b32 v32, 16, v61
  v_and_b32 v33, 0xffff0000, v61
  v_lshlrev_b32 v34, 16, v62
  v_and_b32 v35, 0xffff0000, v62
  v_lshlrev_b32 v36, 16, v63
  v_and_b32 v37, 0xffff0000, v63
  v_lshlrev_b32 v38, 16, v64
  v_and_b32 v39, 0xffff0000, v64
  v_lshlrev_b32 v40, 16, v65
  v_and_b32 v41, 0xffff0000, v65
  v_pk_add_f32 v[86:87], v[2:3], v[4:5]
  v_pk_add_f32 v[88:89], v[6:7], v[8:9]
  v_pk_add_f32 v[86:87], v[86:87], v[10:11]
  v_pk_add_f32 v[88:89], v[88:89], v[12:13]
  v_pk_add_f32 v[86:87], v[86:87], v[14:15]
  v_pk_add_f32 v[88:89], v[88:89], v[16:17]
  v_pk_add_f32 v[86:87], v[86:87], v[18:19]
  v_pk_add_f32 v[88:89], v[88:89], v[20:21]
  v_pk_add_f32 v[86:87], v[86:87], v[22:23]
  v_pk_add_f32 v[88:89], v[88:89], v[24:25]
  v_pk_add_f32 v[86:87], v[86:87], v[26:27]
  v_pk_add_f32 v[88:89], v[88:89], v[28:29]
  v_pk_add_f32 v[86:87], v[86:87], v[30:31]
  v_pk_add_f32 v[88:89], v[88:89], v[32:33]
  v_pk_add_f32 v[86:87], v[86:87], v[34:35]
  v_pk_add_f32 v[88:89], v[88:89], v[36:37]
  v_pk_add_f32 v[86:87], v[86:87], v[38:39]
  v_pk_add_f32 v[88:89], v[88:89], v[40:41]
  v_pk_add_f32 v[86:87], v[86:87], v[88:89]
  v_add_f32 v86, v86, v87
  s_nop 1
  v_add_f32_dpp v86, v86, v86 row_ror:8 row_mask:0xf bank_mask:0xf
  s_nop 1
  v_add_f32_dpp v86, v86, v86 row_ror:4 row_mask:0xf bank_mask:0xf
  v_mov_b32 v90, v86
  s_nop 1
  v_permlane16_swap_b32 v86, v90
  v_add_f32 v86, v86, v90
  v_mov_b32 v90, v86
  s_nop 1
  v_permlane32_swap_b32 v86, v90
  v_add_f32 v86, v86, v90
  v_mul_f32 v88, 0xbacccccd, v86
  v_mul_f32 v89, 0xbacccccd, v86
  v_pk_add_f32 v[164:165], v[2:3], v[88:89]
  v_pk_add_f32 v[166:167], v[4:5], v[88:89]
  v_pk_mul_f32 v[170:171], v[164:165], v[164:165]
  v_pk_add_f32 v[168:169], v[6:7], v[88:89]
  v_pk_mul_f32 v[86:87], v[166:167], v[166:167]
  v_pk_add_f32 v[164:165], v[8:9], v[88:89]
  v_pk_fma_f32 v[170:171], v[168:169], v[168:169], v[170:171]
  v_pk_add_f32 v[166:167], v[10:11], v[88:89]
  v_pk_fma_f32 v[86:87], v[164:165], v[164:165], v[86:87]
  v_pk_add_f32 v[168:169], v[12:13], v[88:89]
  v_pk_fma_f32 v[170:171], v[166:167], v[166:167], v[170:171]
  v_pk_add_f32 v[164:165], v[14:15], v[88:89]
  v_pk_fma_f32 v[86:87], v[168:169], v[168:169], v[86:87]
  v_pk_add_f32 v[166:167], v[16:17], v[88:89]
  v_pk_fma_f32 v[170:171], v[164:165], v[164:165], v[170:171]
  v_pk_add_f32 v[168:169], v[18:19], v[88:89]
  v_pk_fma_f32 v[86:87], v[166:167], v[166:167], v[86:87]
  v_pk_add_f32 v[164:165], v[20:21], v[88:89]
  v_pk_fma_f32 v[170:171], v[168:169], v[168:169], v[170:171]
  v_pk_add_f32 v[166:167], v[22:23], v[88:89]
  v_pk_fma_f32 v[86:87], v[164:165], v[164:165], v[86:87]
  v_pk_add_f32 v[168:169], v[24:25], v[88:89]
  v_pk_fma_f32 v[170:171], v[166:167], v[166:167], v[170:171]
  v_pk_add_f32 v[164:165], v[26:27], v[88:89]
  v_pk_fma_f32 v[86:87], v[168:169], v[168:169], v[86:87]
  v_pk_add_f32 v[166:167], v[28:29], v[88:89]
  v_pk_fma_f32 v[170:171], v[164:165], v[164:165], v[170:171]
  v_pk_add_f32 v[168:169], v[30:31], v[88:89]
  v_pk_fma_f32 v[86:87], v[166:167], v[166:167], v[86:87]
  v_pk_add_f32 v[164:165], v[32:33], v[88:89]
  v_pk_fma_f32 v[170:171], v[168:169], v[168:169], v[170:171]
  v_pk_add_f32 v[166:167], v[34:35], v[88:89]
  v_pk_fma_f32 v[86:87], v[164:165], v[164:165], v[86:87]
  v_pk_add_f32 v[168:169], v[36:37], v[88:89]
  v_pk_fma_f32 v[170:171], v[166:167], v[166:167], v[170:171]
  v_pk_add_f32 v[164:165], v[38:39], v[88:89]
  v_pk_fma_f32 v[86:87], v[168:169], v[168:169], v[86:87]
  v_pk_add_f32 v[166:167], v[40:41], v[88:89]
  v_pk_fma_f32 v[170:171], v[164:165], v[164:165], v[170:171]
  v_pk_fma_f32 v[86:87], v[166:167], v[166:167], v[86:87]
  v_cvt_pk_bf16_f32 v91, v88, v89
  v_lshlrev_b32 v88, 16, v91
  v_and_b32 v89, 0xffff0000, v91
  v_pk_add_f32 v[86:87], v[86:87], v[170:171]
  v_add_f32 v86, v86, v87
  s_nop 1
  v_add_f32_dpp v86, v86, v86 row_ror:8 row_mask:0xf bank_mask:0xf
  s_nop 1
  v_add_f32_dpp v86, v86, v86 row_ror:4 row_mask:0xf bank_mask:0xf
  v_mov_b32 v90, v86
  s_nop 1
  v_permlane16_swap_b32 v86, v90
  v_add_f32 v86, v86, v90
  v_mov_b32 v90, v86
  s_nop 1
  v_permlane32_swap_b32 v86, v90
  v_add_f32 v86, v86, v90
  v_pk_add_f32 v[2:3], v[2:3], v[88:89]
  v_mul_f32 v86, 0x3acccccd, v86
  v_pk_add_f32 v[4:5], v[4:5], v[88:89]
  v_cvt_pk_bf16_f32 v86, v86, v86
  v_pk_add_f32 v[6:7], v[6:7], v[88:89]
  v_lshlrev_b32 v86, 16, v86
  v_pk_add_f32 v[8:9], v[8:9], v[88:89]
  v_add_f32 v86, 0x3727c5ac, v86
  v_pk_add_f32 v[10:11], v[10:11], v[88:89]
  v_cvt_pk_bf16_f32 v86, v86, v86
  v_pk_add_f32 v[12:13], v[12:13], v[88:89]
  v_lshlrev_b32 v86, 16, v86
  v_pk_add_f32 v[14:15], v[14:15], v[88:89]
  v_sqrt_f32 v86, v86
  v_pk_add_f32 v[16:17], v[16:17], v[88:89]
  v_cvt_pk_bf16_f32 v86, v86, v86
  v_pk_add_f32 v[18:19], v[18:19], v[88:89]
  v_lshlrev_b32 v86, 16, v86
  v_pk_add_f32 v[20:21], v[20:21], v[88:89]
  v_rcp_f32 v86, v86
  v_pk_add_f32 v[22:23], v[22:23], v[88:89]
  v_mov_b32 v87, v86
  v_pk_add_f32 v[24:25], v[24:25], v[88:89]
  v_pk_add_f32 v[26:27], v[26:27], v[88:89]
  v_pk_add_f32 v[28:29], v[28:29], v[88:89]
  v_pk_add_f32 v[30:31], v[30:31], v[88:89]
  v_pk_add_f32 v[32:33], v[32:33], v[88:89]
  v_pk_add_f32 v[34:35], v[34:35], v[88:89]
  v_pk_add_f32 v[36:37], v[36:37], v[88:89]
  v_pk_add_f32 v[38:39], v[38:39], v[88:89]
  v_pk_add_f32 v[40:41], v[40:41], v[88:89]
  v_cvt_pk_bf16_f32 v164, v2, v3
  v_lshlrev_b32 v2, 16, v164
  v_and_b32 v3, 0xffff0000, v164
  v_cvt_pk_bf16_f32 v165, v4, v5
  v_lshlrev_b32 v4, 16, v165
  v_and_b32 v5, 0xffff0000, v165
  v_cvt_pk_bf16_f32 v166, v6, v7
  v_lshlrev_b32 v6, 16, v166
  v_and_b32 v7, 0xffff0000, v166
  v_cvt_pk_bf16_f32 v167, v8, v9
  v_lshlrev_b32 v8, 16, v167
  v_and_b32 v9, 0xffff0000, v167
  v_cvt_pk_bf16_f32 v164, v10, v11
  v_lshlrev_b32 v10, 16, v164
  v_and_b32 v11, 0xffff0000, v164
  v_cvt_pk_bf16_f32 v165, v12, v13
  v_lshlrev_b32 v12, 16, v165
  v_and_b32 v13, 0xffff0000, v165
  v_cvt_pk_bf16_f32 v166, v14, v15
  v_lshlrev_b32 v14, 16, v166
  v_and_b32 v15, 0xffff0000, v166
  v_cvt_pk_bf16_f32 v167, v16, v17
  v_lshlrev_b32 v16, 16, v167
  v_and_b32 v17, 0xffff0000, v167
  v_cvt_pk_bf16_f32 v164, v18, v19
  v_lshlrev_b32 v18, 16, v164
  v_and_b32 v19, 0xffff0000, v164
  v_cvt_pk_bf16_f32 v165, v20, v21
  v_lshlrev_b32 v20, 16, v165
  v_and_b32 v21, 0xffff0000, v165
  v_cvt_pk_bf16_f32 v166, v22, v23
  v_lshlrev_b32 v22, 16, v166
  v_and_b32 v23, 0xffff0000, v166
  v_cvt_pk_bf16_f32 v167, v24, v25
  v_lshlrev_b32 v24, 16, v167
  v_and_b32 v25, 0xffff0000, v167
  v_cvt_pk_bf16_f32 v164, v26, v27
  v_lshlrev_b32 v26, 16, v164
  v_and_b32 v27, 0xffff0000, v164
  v_cvt_pk_bf16_f32 v165, v28, v29
  v_lshlrev_b32 v28, 16, v165
  v_and_b32 v29, 0xffff0000, v165
  v_cvt_pk_bf16_f32 v166, v30, v31
  v_lshlrev_b32 v30, 16, v166
  v_and_b32 v31, 0xffff0000, v166
  v_cvt_pk_bf16_f32 v167, v32, v33
  v_lshlrev_b32 v32, 16, v167
  v_and_b32 v33, 0xffff0000, v167
  v_cvt_pk_bf16_f32 v164, v34, v35
  v_lshlrev_b32 v34, 16, v164
  v_and_b32 v35, 0xffff0000, v164
  v_cvt_pk_bf16_f32 v165, v36, v37
  v_lshlrev_b32 v36, 16, v165
  v_and_b32 v37, 0xffff0000, v165
  v_cvt_pk_bf16_f32 v166, v38, v39
  v_lshlrev_b32 v38, 16, v166
  v_and_b32 v39, 0xffff0000, v166
  v_cvt_pk_bf16_f32 v167, v40, v41
  v_lshlrev_b32 v40, 16, v167
  v_and_b32 v41, 0xffff0000, v167
  v_pk_mul_f32 v[2:3], v[2:3], v[86:87]
  v_pk_mul_f32 v[4:5], v[4:5], v[86:87]
  v_pk_mul_f32 v[6:7], v[6:7], v[86:87]
  v_pk_mul_f32 v[8:9], v[8:9], v[86:87]
  v_pk_mul_f32 v[10:11], v[10:11], v[86:87]
  v_pk_mul_f32 v[12:13], v[12:13], v[86:87]
  v_pk_mul_f32 v[14:15], v[14:15], v[86:87]
  v_pk_mul_f32 v[16:17], v[16:17], v[86:87]
  v_pk_mul_f32 v[18:19], v[18:19], v[86:87]
  v_pk_mul_f32 v[20:21], v[20:21], v[86:87]
  v_pk_mul_f32 v[22:23], v[22:23], v[86:87]
  v_pk_mul_f32 v[24:25], v[24:25], v[86:87]
  v_pk_mul_f32 v[26:27], v[26:27], v[86:87]
  v_pk_mul_f32 v[28:29], v[28:29], v[86:87]
  v_pk_mul_f32 v[30:31], v[30:31], v[86:87]
  v_pk_mul_f32 v[32:33], v[32:33], v[86:87]
  v_pk_mul_f32 v[34:35], v[34:35], v[86:87]
  v_pk_mul_f32 v[36:37], v[36:37], v[86:87]
  v_pk_mul_f32 v[38:39], v[38:39], v[86:87]
  v_pk_mul_f32 v[40:41], v[40:41], v[86:87]
  v_cvt_pk_bf16_f32 v164, v2, v3
  v_lshlrev_b32 v2, 16, v164
  v_and_b32 v3, 0xffff0000, v164
  v_cvt_pk_bf16_f32 v165, v4, v5
  v_lshlrev_b32 v4, 16, v165
  v_and_b32 v5, 0xffff0000, v165
  v_cvt_pk_bf16_f32 v166, v6, v7
  v_lshlrev_b32 v6, 16, v166
  v_and_b32 v7, 0xffff0000, v166
  v_cvt_pk_bf16_f32 v167, v8, v9
  v_lshlrev_b32 v8, 16, v167
  v_and_b32 v9, 0xffff0000, v167
  v_cvt_pk_bf16_f32 v164, v10, v11
  v_lshlrev_b32 v10, 16, v164
  v_and_b32 v11, 0xffff0000, v164
  v_cvt_pk_bf16_f32 v165, v12, v13
  v_lshlrev_b32 v12, 16, v165
  v_and_b32 v13, 0xffff0000, v165
  v_cvt_pk_bf16_f32 v166, v14, v15
  v_lshlrev_b32 v14, 16, v166
  v_and_b32 v15, 0xffff0000, v166
  v_cvt_pk_bf16_f32 v167, v16, v17
  v_lshlrev_b32 v16, 16, v167
  v_and_b32 v17, 0xffff0000, v167
  v_cvt_pk_bf16_f32 v164, v18, v19
  v_lshlrev_b32 v18, 16, v164
  v_and_b32 v19, 0xffff0000, v164
  v_cvt_pk_bf16_f32 v165, v20, v21
  v_lshlrev_b32 v20, 16, v165
  v_and_b32 v21, 0xffff0000, v165
  v_cvt_pk_bf16_f32 v166, v22, v23
  v_lshlrev_b32 v22, 16, v166
  v_and_b32 v23, 0xffff0000, v166
  v_cvt_pk_bf16_f32 v167, v24, v25
  v_lshlrev_b32 v24, 16, v167
  v_and_b32 v25, 0xffff0000, v167
  v_cvt_pk_bf16_f32 v164, v26, v27
  v_lshlrev_b32 v26, 16, v164
  v_and_b32 v27, 0xffff0000, v164
  v_cvt_pk_bf16_f32 v165, v28, v29
  v_lshlrev_b32 v28, 16, v165
  v_and_b32 v29, 0xffff0000, v165
  v_cvt_pk_bf16_f32 v166, v30, v31
  v_lshlrev_b32 v30, 16, v166
  v_and_b32 v31, 0xffff0000, v166
  v_cvt_pk_bf16_f32 v167, v32, v33
  v_lshlrev_b32 v32, 16, v167
  v_and_b32 v33, 0xffff0000, v167
  v_cvt_pk_bf16_f32 v164, v34, v35
  v_lshlrev_b32 v34, 16, v164
  v_and_b32 v35, 0xffff0000, v164
  v_cvt_pk_bf16_f32 v165, v36, v37
  v_lshlrev_b32 v36, 16, v165
  v_and_b32 v37, 0xffff0000, v165
  v_cvt_pk_bf16_f32 v166, v38, v39
  v_lshlrev_b32 v38, 16, v166
  v_and_b32 v39, 0xffff0000, v166
  v_cvt_pk_bf16_f32 v167, v40, v41
  v_lshlrev_b32 v40, 16, v167
  v_and_b32 v41, 0xffff0000, v167
  v_mul_f32_dpp v2, v176, v2 quad_perm:[2,2,2,2] row_mask:0xf bank_mask:0xf
  v_mul_f32_dpp v3, v177, v3 quad_perm:[2,2,2,2] row_mask:0xf bank_mask:0xf
  v_mul_f32_dpp v4, v178, v4 quad_perm:[2,2,2,2] row_mask:0xf bank_mask:0xf
  v_mul_f32_dpp v5, v179, v5 quad_perm:[2,2,2,2] row_mask:0xf bank_mask:0xf
  v_mul_f32_dpp v6, v176, v6 quad_perm:[3,3,3,3] row_mask:0xf bank_mask:0xf
  v_mul_f32_dpp v7, v177, v7 quad_perm:[3,3,3,3] row_mask:0xf bank_mask:0xf
  v_mul_f32_dpp v8, v178, v8 quad_perm:[3,3,3,3] row_mask:0xf bank_mask:0xf
  v_mul_f32_dpp v9, v179, v9 quad_perm:[3,3,3,3] row_mask:0xf bank_mask:0xf
  v_cvt_pk_bf16_f32 v164, v2, v3
  v_lshlrev_b32 v2, 16, v164
  v_and_b32 v3, 0xffff0000, v164
  v_cvt_pk_bf16_f32 v165, v4, v5
  v_lshlrev_b32 v4, 16, v165
  v_and_b32 v5, 0xffff0000, v165
  v_cvt_pk_bf16_f32 v166, v6, v7
  v_lshlrev_b32 v6, 16, v166
  v_and_b32 v7, 0xffff0000, v166
  v_cvt_pk_bf16_f32 v167, v8, v9
  v_lshlrev_b32 v8, 16, v167
  v_and_b32 v9, 0xffff0000, v167
  v_add_f32_dpp v2, v176, v2 quad_perm:[0,0,0,0] row_mask:0xf bank_mask:0xf
  v_add_f32_dpp v3, v177, v3 quad_perm:[0,0,0,0] row_mask:0xf bank_mask:0xf
  v_add_f32_dpp v4, v178, v4 quad_perm:[0,0,0,0] row_mask:0xf bank_mask:0xf
  v_add_f32_dpp v5, v179, v5 quad_perm:[0,0,0,0] row_mask:0xf bank_mask:0xf
  v_add_f32_dpp v6, v176, v6 quad_perm:[1,1,1,1] row_mask:0xf bank_mask:0xf
  v_add_f32_dpp v7, v177, v7 quad_perm:[1,1,1,1] row_mask:0xf bank_mask:0xf
  v_add_f32_dpp v8, v178, v8 quad_perm:[1,1,1,1] row_mask:0xf bank_mask:0xf
  v_add_f32_dpp v9, v179, v9 quad_perm:[1,1,1,1] row_mask:0xf bank_mask:0xf
  v_cvt_pk_bf16_f32 v196, v2, v3
  v_cvt_pk_bf16_f32 v197, v4, v5
  v_cvt_pk_bf16_f32 v198, v6, v7
  v_cvt_pk_bf16_f32 v199, v8, v9
  s_add_u32 s35, s38, 0
  buffer_store_dwordx4 v[196:199], v161, s[8:11], s35 offen sc1
  v_mul_f32_dpp v10, v180, v10 quad_perm:[2,2,2,2] row_mask:0xf bank_mask:0xf
  v_mul_f32_dpp v11, v181, v11 quad_perm:[2,2,2,2] row_mask:0xf bank_mask:0xf
  v_mul_f32_dpp v12, v182, v12 quad_perm:[2,2,2,2] row_mask:0xf bank_mask:0xf
  v_mul_f32_dpp v13, v183, v13 quad_perm:[2,2,2,2] row_mask:0xf bank_mask:0xf
  v_mul_f32_dpp v14, v180, v14 quad_perm:[3,3,3,3] row_mask:0xf bank_mask:0xf
  v_mul_f32_dpp v15, v181, v15 quad_perm:[3,3,3,3] row_mask:0xf bank_mask:0xf
  v_mul_f32_dpp v16, v182, v16 quad_perm:[3,3,3,3] row_mask:0xf bank_mask:0xf
  v_mul_f32_dpp v17, v183, v17 quad_perm:[3,3,3,3] row_mask:0xf bank_mask:0xf
  v_cvt_pk_bf16_f32 v164, v10, v11
  v_lshlrev_b32 v10, 16, v164
  v_and_b32 v11, 0xffff0000, v164
  v_cvt_pk_bf16_f32 v165, v12, v13
  v_lshlrev_b32 v12, 16, v165
  v_and_b32 v13, 0xffff0000, v165
  v_cvt_pk_bf16_f32 v166, v14, v15
  v_lshlrev_b32 v14, 16, v166
  v_and_b32 v15, 0xffff0000, v166
  v_cvt_pk_bf16_f32 v167, v16, v17
  v_lshlrev_b32 v16, 16, v167
  v_and_b32 v17, 0xffff0000, v167
  v_add_f32_dpp v10, v180, v10 quad_perm:[0,0,0,0] row_mask:0xf bank_mask:0xf
  v_add_f32_dpp v11, v181, v11 quad_perm:[0,0,0,0] row_mask:0xf bank_mask:0xf
  v_add_f32_dpp v12, v182, v12 quad_perm:[0,0,0,0] row_mask:0xf bank_mask:0xf
  v_add_f32_dpp v13, v183, v13 quad_perm:[0,0,0,0] row_mask:0xf bank_mask:0xf
  v_add_f32_dpp v14, v180, v14 quad_perm:[1,1,1,1] row_mask:0xf bank_mask:0xf
  v_add_f32_dpp v15, v181, v15 quad_perm:[1,1,1,1] row_mask:0xf bank_mask:0xf
  v_add_f32_dpp v16, v182, v16 quad_perm:[1,1,1,1] row_mask:0xf bank_mask:0xf
  v_add_f32_dpp v17, v183, v17 quad_perm:[1,1,1,1] row_mask:0xf bank_mask:0xf
  v_cvt_pk_bf16_f32 v200, v10, v11
  v_cvt_pk_bf16_f32 v201, v12, v13
  v_cvt_pk_bf16_f32 v202, v14, v15
  v_cvt_pk_bf16_f32 v203, v16, v17
  s_add_u32 s35, s38, 4096
  buffer_store_dwordx4 v[200:203], v161, s[8:11], s35 offen sc1
  v_mul_f32_dpp v18, v184, v18 quad_perm:[2,2,2,2] row_mask:0xf bank_mask:0xf
  v_mul_f32_dpp v19, v185, v19 quad_perm:[2,2,2,2] row_mask:0xf bank_mask:0xf
  v_mul_f32_dpp v20, v186, v20 quad_perm:[2,2,2,2] row_mask:0xf bank_mask:0xf
  v_mul_f32_dpp v21, v187, v21 quad_perm:[2,2,2,2] row_mask:0xf bank_mask:0xf
  v_mul_f32_dpp v22, v184, v22 quad_perm:[3,3,3,3] row_mask:0xf bank_mask:0xf
  v_mul_f32_dpp v23, v185, v23 quad_perm:[3,3,3,3] row_mask:0xf bank_mask:0xf
  v_mul_f32_dpp v24, v186, v24 quad_perm:[3,3,3,3] row_mask:0xf bank_mask:0xf
  v_mul_f32_dpp v25, v187, v25 quad_perm:[3,3,3,3] row_mask:0xf bank_mask:0xf
  v_cvt_pk_bf16_f32 v164, v18, v19
  v_lshlrev_b32 v18, 16, v164
  v_and_b32 v19, 0xffff0000, v164
  v_cvt_pk_bf16_f32 v165, v20, v21
  v_lshlrev_b32 v20, 16, v165
  v_and_b32 v21, 0xffff0000, v165
  v_cvt_pk_bf16_f32 v166, v22, v23
  v_lshlrev_b32 v22, 16, v166
  v_and_b32 v23, 0xffff0000, v166
  v_cvt_pk_bf16_f32 v167, v24, v25
  v_lshlrev_b32 v24, 16, v167
  v_and_b32 v25, 0xffff0000, v167
  v_add_f32_dpp v18, v184, v18 quad_perm:[0,0,0,0] row_mask:0xf bank_mask:0xf
  v_add_f32_dpp v19, v185, v19 quad_perm:[0,0,0,0] row_mask:0xf bank_mask:0xf
  v_add_f32_dpp v20, v186, v20 quad_perm:[0,0,0,0] row_mask:0xf bank_mask:0xf
  v_add_f32_dpp v21, v187, v21 quad_perm:[0,0,0,0] row_mask:0xf bank_mask:0xf
  v_add_f32_dpp v22, v184, v22 quad_perm:[1,1,1,1] row_mask:0xf bank_mask:0xf
  v_add_f32_dpp v23, v185, v23 quad_perm:[1,1,1,1] row_mask:0xf bank_mask:0xf
  v_add_f32_dpp v24, v186, v24 quad_perm:[1,1,1,1] row_mask:0xf bank_mask:0xf
  v_add_f32_dpp v25, v187, v25 quad_perm:[1,1,1,1] row_mask:0xf bank_mask:0xf
  v_cvt_pk_bf16_f32 v204, v18, v19
  v_cvt_pk_bf16_f32 v205, v20, v21
  v_cvt_pk_bf16_f32 v206, v22, v23
  v_cvt_pk_bf16_f32 v207, v24, v25
  s_add_u32 s35, s38, 8192
  buffer_store_dwordx4 v[204:207], v161, s[8:11], s35 offen sc1
  v_mul_f32_dpp v26, v188, v26 quad_perm:[2,2,2,2] row_mask:0xf bank_mask:0xf
  v_mul_f32_dpp v27, v189, v27 quad_perm:[2,2,2,2] row_mask:0xf bank_mask:0xf
  v_mul_f32_dpp v28, v190, v28 quad_perm:[2,2,2,2] row_mask:0xf bank_mask:0xf
  v_mul_f32_dpp v29, v191, v29 quad_perm:[2,2,2,2] row_mask:0xf bank_mask:0xf
  v_mul_f32_dpp v30, v188, v30 quad_perm:[3,3,3,3] row_mask:0xf bank_mask:0xf
  v_mul_f32_dpp v31, v189, v31 quad_perm:[3,3,3,3] row_mask:0xf bank_mask:0xf
  v_mul_f32_dpp v32, v190, v32 quad_perm:[3,3,3,3] row_mask:0xf bank_mask:0xf
  v_mul_f32_dpp v33, v191, v33 quad_perm:[3,3,3,3] row_mask:0xf bank_mask:0xf
  v_cvt_pk_bf16_f32 v164, v26, v27
  v_lshlrev_b32 v26, 16, v164
  v_and_b32 v27, 0xffff0000, v164
  v_cvt_pk_bf16_f32 v165, v28, v29
  v_lshlrev_b32 v28, 16, v165
  v_and_b32 v29, 0xffff0000, v165
  v_cvt_pk_bf16_f32 v166, v30, v31
  v_lshlrev_b32 v30, 16, v166
  v_and_b32 v31, 0xffff0000, v166
  v_cvt_pk_bf16_f32 v167, v32, v33
  v_lshlrev_b32 v32, 16, v167
  v_and_b32 v33, 0xffff0000, v167
  v_add_f32_dpp v26, v188, v26 quad_perm:[0,0,0,0] row_mask:0xf bank_mask:0xf
  v_add_f32_dpp v27, v189, v27 quad_perm:[0,0,0,0] row_mask:0xf bank_mask:0xf
  v_add_f32_dpp v28, v190, v28 quad_perm:[0,0,0,0] row_mask:0xf bank_mask:0xf
  v_add_f32_dpp v29, v191, v29 quad_perm:[0,0,0,0] row_mask:0xf bank_mask:0xf
  v_add_f32_dpp v30, v188, v30 quad_perm:[1,1,1,1] row_mask:0xf bank_mask:0xf
  v_add_f32_dpp v31, v189, v31 quad_perm:[1,1,1,1] row_mask:0xf bank_mask:0xf
  v_add_f32_dpp v32, v190, v32 quad_perm:[1,1,1,1] row_mask:0xf bank_mask:0xf
  v_add_f32_dpp v33, v191, v33 quad_perm:[1,1,1,1] row_mask:0xf bank_mask:0xf
  v_cvt_pk_bf16_f32 v208, v26, v27
  v_cvt_pk_bf16_f32 v209, v28, v29
  v_cvt_pk_bf16_f32 v210, v30, v31
  v_cvt_pk_bf16_f32 v211, v32, v33
  s_add_u32 s35, s38, 12288
  buffer_store_dwordx4 v[208:211], v161, s[8:11], s35 offen sc1
  v_mul_f32_dpp v34, v192, v34 quad_perm:[2,2,2,2] row_mask:0xf bank_mask:0xf
  v_mul_f32_dpp v35, v193, v35 quad_perm:[2,2,2,2] row_mask:0xf bank_mask:0xf
  v_mul_f32_dpp v36, v194, v36 quad_perm:[2,2,2,2] row_mask:0xf bank_mask:0xf
  v_mul_f32_dpp v37, v195, v37 quad_perm:[2,2,2,2] row_mask:0xf bank_mask:0xf
  v_mul_f32_dpp v38, v192, v38 quad_perm:[3,3,3,3] row_mask:0xf bank_mask:0xf
  v_mul_f32_dpp v39, v193, v39 quad_perm:[3,3,3,3] row_mask:0xf bank_mask:0xf
  v_mul_f32_dpp v40, v194, v40 quad_perm:[3,3,3,3] row_mask:0xf bank_mask:0xf
  v_mul_f32_dpp v41, v195, v41 quad_perm:[3,3,3,3] row_mask:0xf bank_mask:0xf
  v_cvt_pk_bf16_f32 v164, v34, v35
  v_lshlrev_b32 v34, 16, v164
  v_and_b32 v35, 0xffff0000, v164
  v_cvt_pk_bf16_f32 v165, v36, v37
  v_lshlrev_b32 v36, 16, v165
  v_and_b32 v37, 0xffff0000, v165
  v_cvt_pk_bf16_f32 v166, v38, v39
  v_lshlrev_b32 v38, 16, v166
  v_and_b32 v39, 0xffff0000, v166
  v_cvt_pk_bf16_f32 v167, v40, v41
  v_lshlrev_b32 v40, 16, v167
  v_and_b32 v41, 0xffff0000, v167
  v_add_f32_dpp v34, v192, v34 quad_perm:[0,0,0,0] row_mask:0xf bank_mask:0xf
  v_add_f32_dpp v35, v193, v35 quad_perm:[0,0,0,0] row_mask:0xf bank_mask:0xf
  v_add_f32_dpp v36, v194, v36 quad_perm:[0,0,0,0] row_mask:0xf bank_mask:0xf
  v_add_f32_dpp v37, v195, v37 quad_perm:[0,0,0,0] row_mask:0xf bank_mask:0xf
  v_add_f32_dpp v38, v192, v38 quad_perm:[1,1,1,1] row_mask:0xf bank_mask:0xf
  v_add_f32_dpp v39, v193, v39 quad_perm:[1,1,1,1] row_mask:0xf bank_mask:0xf
  v_add_f32_dpp v40, v194, v40 quad_perm:[1,1,1,1] row_mask:0xf bank_mask:0xf
  v_add_f32_dpp v41, v195, v41 quad_perm:[1,1,1,1] row_mask:0xf bank_mask:0xf
  v_cvt_pk_bf16_f32 v212, v34, v35
  v_cvt_pk_bf16_f32 v213, v36, v37
  v_cvt_pk_bf16_f32 v214, v38, v39
  v_cvt_pk_bf16_f32 v215, v40, v41
  s_add_u32 s35, s38, 16384
  buffer_store_dwordx4 v[212:215], v161, s[8:11], s35 offen sc1
  s_add_u32 s36, s41, 24
  s_cmp_lt_u32 s41, 24
  s_cselect_b32 s36, s39, s36
  s_add_u32 s41, s41, 3
  s_cmp_lt_u32 s41, 24
  s_cselect_b32 s41, s41, s36
  s_min_u32 s41, s41, 127
  s_mul_i32 s38, s16, 2621440
  s_cmp_lt_u32 s41, 24
  s_cselect_b32 s38, s38, 0
  s_mul_i32 s36, s41, 20480
  s_add_u32 s38, s38, s36
  s_lshl_b32 s36, s17, 6
  s_add_u32 s38, s38, s36
  s_add_u32 s38, s38, 247463936
  s_add_u32 s33, s33, 3
  s_sub_u32 s36, s33, 0
  s_min_u32 s36, s36, 24
  v_mov_b32 v92, s36
  s_waitcnt vmcnt(0)
  buffer_store_dword v92, v228, s[8:11], 0 offen
  buffer_load_dwordx2 v[140:141], v160, s[20:23], s37 offen offset:0
  buffer_load_dwordx2 v[142:143], v160, s[20:23], s37 offen offset:32
  buffer_load_dwordx2 v[144:145], v160, s[20:23], s37 offen offset:256
  buffer_load_dwordx2 v[146:147], v160, s[20:23], s37 offen offset:288
  buffer_load_dwordx2 v[148:149], v160, s[20:23], s37 offen offset:512
  buffer_load_dwordx2 v[150:151], v160, s[20:23], s37 offen offset:544
  buffer_load_dwordx2 v[152:153], v160, s[20:23], s37 offen offset:768
  buffer_load_dwordx2 v[154:155], v160, s[20:23], s37 offen offset:800
  buffer_load_dwordx2 v[156:157], v160, s[20:23], s37 offen offset:1024
  buffer_load_dwordx2 v[158:159], v160, s[20:23], s37 offen offset:1056
  s_add_u32 s36, s40, 24
  s_cmp_lt_u32 s40, 24
  s_cselect_b32 s36, s39, s36
  s_add_u32 s40, s40, 3
  s_cmp_lt_u32 s40, 24
  s_cselect_b32 s40, s40, s36
  s_min_u32 s40, s40, 127
  s_mul_i32 s37, s40, 20480
  s_mul_i32 s36, s17, 5120
  s_add_u32 s37, s37, s36
  buffer_load_dwordx2 v[46:47], v160, s[20:23], s37 offen offset:0
  buffer_load_dwordx2 v[48:49], v160, s[20:23], s37 offen offset:32
  buffer_load_dwordx2 v[50:51], v160, s[20:23], s37 offen offset:256
  buffer_load_dwordx2 v[52:53], v160, s[20:23], s37 offen offset:288
  buffer_load_dwordx2 v[54:55], v160, s[20:23], s37 offen offset:512
  buffer_load_dwordx2 v[56:57], v160, s[20:23], s37 offen offset:544
  buffer_load_dwordx2 v[58:59], v160, s[20:23], s37 offen offset:768
  buffer_load_dwordx2 v[60:61], v160, s[20:23], s37 offen offset:800
  buffer_load_dwordx2 v[62:63], v160, s[20:23], s37 offen offset:1024
  buffer_load_dwordx2 v[64:65], v160, s[20:23], s37 offen offset:1056
  s_add_u32 s36, s40, 24
  s_cmp_lt_u32 s40, 24
  s_cselect_b32 s36, s39, s36
  s_add_u32 s40, s40, 3
  s_cmp_lt_u32 s40, 24
  s_cselect_b32 s40, s40, s36
  s_min_u32 s40, s40, 127
  s_mul_i32 s37, s40, 20480
  s_mul_i32 s36, s17, 5120
  s_add_u32 s37, s37, s36
r_ln1:
  v_lshlrev_b32 v2, 16, v66
  v_and_b32 v3, 0xffff0000, v66
  v_lshlrev_b32 v4, 16, v67
  v_and_b32 v5, 0xffff0000, v67
  v_lshlrev_b32 v6, 16, v68
  v_and_b32 v7, 0xffff0000, v68
  v_lshlrev_b32 v8, 16, v69
  v_and_b32 v9, 0xffff0000, v69
  v_lshlrev_b32 v10, 16, v70
  v_and_b32 v11, 0xffff0000, v70
  v_lshlrev_b32 v12, 16, v71
  v_and_b32 v13, 0xffff0000, v71
  v_lshlrev_b32 v14, 16, v72
  v_and_b32 v15, 0xffff0000, v72
  v_lshlrev_b32 v16, 16, v73
  v_and_b32 v17, 0xffff0000, v73
  v_lshlrev_b32 v18, 16, v74
  v_and_b32 v19, 0xffff0000, v74
  v_lshlrev_b32 v20, 16, v75
  v_and_b32 v21, 0xffff0000, v75
  v_lshlrev_b32 v22, 16, v76
  v_and_b32 v23, 0xffff0000, v76
  v_lshlrev_b32 v24, 16, v77
  v_and_b32 v25, 0xffff0000, v77
  v_lshlrev_b32 v26, 16, v78
  v_and_b32 v27, 0xffff0000, v78
  v_lshlrev_b32 v28, 16, v79
  v_and_b32 v29, 0xffff0000, v79
  v_lshlrev_b32 v30, 16, v80
  v_and_b32 v31, 0xffff0000, v80
  v_lshlrev_b32 v32, 16, v81
  v_and_b32 v33, 0xffff0000, v81
  v_lshlrev_b32 v34, 16, v82
  v_and_b32 v35, 0xffff0000, v82
  v_lshlrev_b32 v36, 16, v83
  v_and_b32 v37, 0xffff0000, v83
  v_lshlrev_b32 v38, 16, v84
  v_and_b32 v39, 0xffff0000, v84
  v_lshlrev_b32 v40, 16, v85
  v_and_b32 v41, 0xffff0000, v85
  v_pk_add_f32 v[86:87], v[2:3], v[4:5]
  v_pk_add_f32 v[88:89], v[6:7], v[8:9]
  v_pk_add_f32 v[86:87], v[86:87], v[10:11]
  v_pk_add_f32 v[88:89], v[88:89], v[12:13]
  v_pk_add_f32 v[86:87], v[86:87], v[14:15]
  v_pk_add_f32 v[88:89], v[88:89], v[16:17]
  v_pk_add_f32 v[86:87], v[86:87], v[18:19]
  v_pk_add_f32 v[88:89], v[88:89], v[20:21]
  v_pk_add_f32 v[86:87], v[86:87], v[22:23]
  v_pk_add_f32 v[88:89], v[88:89], v[24:25]
  v_pk_add_f32 v[86:87], v[86:87], v[26:27]
  v_pk_add_f32 v[88:89], v[88:89], v[28:29]
  v_pk_add_f32 v[86:87], v[86:87], v[30:31]
  v_pk_add_f32 v[88:89], v[88:89], v[32:33]
  v_pk_add_f32 v[86:87], v[86:87], v[34:35]
  v_pk_add_f32 v[88:89], v[88:89], v[36:37]
  v_pk_add_f32 v[86:87], v[86:87], v[38:39]
  v_pk_add_f32 v[88:89], v[88:89], v[40:41]
  v_pk_add_f32 v[86:87], v[86:87], v[88:89]
  v_add_f32 v86, v86, v87
  s_nop 1
  v_add_f32_dpp v86, v86, v86 row_ror:8 row_mask:0xf bank_mask:0xf
  s_nop 1
  v_add_f32_dpp v86, v86, v86 row_ror:4 row_mask:0xf bank_mask:0xf
  v_mov_b32 v90, v86
  s_nop 1
  v_permlane16_swap_b32 v86, v90
  v_add_f32 v86, v86, v90
  v_mov_b32 v90, v86
  s_nop 1
  v_permlane32_swap_b32 v86, v90
  v_add_f32 v86, v86, v90
  v_mul_f32 v88, 0xbacccccd, v86
  v_mul_f32 v89, 0xbacccccd, v86
  v_pk_add_f32 v[164:165], v[2:3], v[88:89]
  v_pk_add_f32 v[166:167], v[4:5], v[88:89]
  v_pk_mul_f32 v[170:171], v[164:165], v[164:165]
  v_pk_add_f32 v[168:169], v[6:7], v[88:89]
  v_pk_mul_f32 v[86:87], v[166:167], v[166:167]
  v_pk_add_f32 v[164:165], v[8:9], v[88:89]
  v_pk_fma_f32 v[170:171], v[168:169], v[168:169], v[170:171]
  v_pk_add_f32 v[166:167], v[10:11], v[88:89]
  v_pk_fma_f32 v[86:87], v[164:165], v[164:165], v[86:87]
  v_pk_add_f32 v[168:169], v[12:13], v[88:89]
  v_pk_fma_f32 v[170:171], v[166:167], v[166:167], v[170:171]
  v_pk_add_f32 v[164:165], v[14:15], v[88:89]
  v_pk_fma_f32 v[86:87], v[168:169], v[168:169], v[86:87]
  v_pk_add_f32 v[166:167], v[16:17], v[88:89]
  v_pk_fma_f32 v[170:171], v[164:165], v[164:165], v[170:171]
  v_pk_add_f32 v[168:169], v[18:19], v[88:89]
  v_pk_fma_f32 v[86:87], v[166:167], v[166:167], v[86:87]
  v_pk_add_f32 v[164:165], v[20:21], v[88:89]
  v_pk_fma_f32 v[170:171], v[168:169], v[168:169], v[170:171]
  v_pk_add_f32 v[166:167], v[22:23], v[88:89]
  v_pk_fma_f32 v[86:87], v[164:165], v[164:165], v[86:87]
  v_pk_add_f32 v[168:169], v[24:25], v[88:89]
  v_pk_fma_f32 v[170:171], v[166:167], v[166:167], v[170:171]
  v_pk_add_f32 v[164:165], v[26:27], v[88:89]
  v_pk_fma_f32 v[86:87], v[168:169], v[168:169], v[86:87]
  v_pk_add_f32 v[166:167], v[28:29], v[88:89]
  v_pk_fma_f32 v[170:171], v[164:165], v[164:165], v[170:171]
  v_pk_add_f32 v[168:169], v[30:31], v[88:89]
  v_pk_fma_f32 v[86:87], v[166:167], v[166:167], v[86:87]
  v_pk_add_f32 v[164:165], v[32:33], v[88:89]
  v_pk_fma_f32 v[170:171], v[168:169], v[168:169], v[170:171]
  v_pk_add_f32 v[166:167], v[34:35], v[88:89]
  v_pk_fma_f32 v[86:87], v[164:165], v[164:165], v[86:87]
  v_pk_add_f32 v[168:169], v[36:37], v[88:89]
  v_pk_fma_f32 v[170:171], v[166:167], v[166:167], v[170:171]
  v_pk_add_f32 v[164:165], v[38:39], v[88:89]
  v_pk_fma_f32 v[86:87], v[168:169], v[168:169], v[86:87]
  v_pk_add_f32 v[166:167], v[40:41], v[88:89]
  v_pk_fma_f32 v[170:171], v[164:165], v[164:165], v[170:171]
  v_pk_fma_f32 v[86:87], v[166:167], v[166:167], v[86:87]
  v_cvt_pk_bf16_f32 v91, v88, v89
  v_lshlrev_b32 v88, 16, v91
  v_and_b32 v89, 0xffff0000, v91
  v_pk_add_f32 v[86:87], v[86:87], v[170:171]
  v_add_f32 v86, v86, v87
  s_nop 1
  v_add_f32_dpp v86, v86, v86 row_ror:8 row_mask:0xf bank_mask:0xf
  s_nop 1
  v_add_f32_dpp v86, v86, v86 row_ror:4 row_mask:0xf bank_mask:0xf
  v_mov_b32 v90, v86
  s_nop 1
  v_permlane16_swap_b32 v86, v90
  v_add_f32 v86, v86, v90
  v_mov_b32 v90, v86
  s_nop 1
  v_permlane32_swap_b32 v86, v90
  v_add_f32 v86, v86, v90
  v_pk_add_f32 v[2:3], v[2:3], v[88:89]
  v_mul_f32 v86, 0x3acccccd, v86
  v_pk_add_f32 v[4:5], v[4:5], v[88:89]
  v_cvt_pk_bf16_f32 v86, v86, v86
  v_pk_add_f32 v[6:7], v[6:7], v[88:89]
  v_lshlrev_b32 v86, 16, v86
  v_pk_add_f32 v[8:9], v[8:9], v[88:89]
  v_add_f32 v86, 0x3727c5ac, v86
  v_pk_add_f32 v[10:11], v[10:11], v[88:89]
  v_cvt_pk_bf16_f32 v86, v86, v86
  v_pk_add_f32 v[12:13], v[12:13], v[88:89]
  v_lshlrev_b32 v86, 16, v86
  v_pk_add_f32 v[14:15], v[14:15], v[88:89]
  v_sqrt_f32 v86, v86
  v_pk_add_f32 v[16:17], v[16:17], v[88:89]
  v_cvt_pk_bf16_f32 v86, v86, v86
  v_pk_add_f32 v[18:19], v[18:19], v[88:89]
  v_lshlrev_b32 v86, 16, v86
  v_pk_add_f32 v[20:21], v[20:21], v[88:89]
  v_rcp_f32 v86, v86
  v_pk_add_f32 v[22:23], v[22:23], v[88:89]
  v_mov_b32 v87, v86
  v_pk_add_f32 v[24:25], v[24:25], v[88:89]
  v_pk_add_f32 v[26:27], v[26:27], v[88:89]
  v_pk_add_f32 v[28:29], v[28:29], v[88:89]
  v_pk_add_f32 v[30:31], v[30:31], v[88:89]
  v_pk_add_f32 v[32:33], v[32:33], v[88:89]
  v_pk_add_f32 v[34:35], v[34:35], v[88:89]
  v_pk_add_f32 v[36:37], v[36:37], v[88:89]
  v_pk_add_f32 v[38:39], v[38:39], v[88:89]
  v_pk_add_f32 v[40:41], v[40:41], v[88:89]
  v_cvt_pk_bf16_f32 v164, v2, v3
  v_lshlrev_b32 v2, 16, v164
  v_and_b32 v3, 0xffff0000, v164
  v_cvt_pk_bf16_f32 v165, v4, v5
  v_lshlrev_b32 v4, 16, v165
  v_and_b32 v5, 0xffff0000, v165
  v_cvt_pk_bf16_f32 v166, v6, v7
  v_lshlrev_b32 v6, 16, v166
  v_and_b32 v7, 0xffff0000, v166
  v_cvt_pk_bf16_f32 v167, v8, v9
  v_lshlrev_b32 v8, 16, v167
  v_and_b32 v9, 0xffff0000, v167
  v_cvt_pk_bf16_f32 v164, v10, v11
  v_lshlrev_b32 v10, 16, v164
  v_and_b32 v11, 0xffff0000, v164
  v_cvt_pk_bf16_f32 v165, v12, v13
  v_lshlrev_b32 v12, 16, v165
  v_and_b32 v13, 0xffff0000, v165
  v_cvt_pk_bf16_f32 v166, v14, v15
  v_lshlrev_b32 v14, 16, v166
  v_and_b32 v15, 0xffff0000, v166
  v_cvt_pk_bf16_f32 v167, v16, v17
  v_lshlrev_b32 v16, 16, v167
  v_and_b32 v17, 0xffff0000, v167
  v_cvt_pk_bf16_f32 v164, v18, v19
  v_lshlrev_b32 v18, 16, v164
  v_and_b32 v19, 0xffff0000, v164
  v_cvt_pk_bf16_f32 v165, v20, v21
  v_lshlrev_b32 v20, 16, v165
  v_and_b32 v21, 0xffff0000, v165
  v_cvt_pk_bf16_f32 v166, v22, v23
  v_lshlrev_b32 v22, 16, v166
  v_and_b32 v23, 0xffff0000, v166
  v_cvt_pk_bf16_f32 v167, v24, v25
  v_lshlrev_b32 v24, 16, v167
  v_and_b32 v25, 0xffff0000, v167
  v_cvt_pk_bf16_f32 v164, v26, v27
  v_lshlrev_b32 v26, 16, v164
  v_and_b32 v27, 0xffff0000, v164
  v_cvt_pk_bf16_f32 v165, v28, v29
  v_lshlrev_b32 v28, 16, v165
  v_and_b32 v29, 0xffff0000, v165
  v_cvt_pk_bf16_f32 v166, v30, v31
  v_lshlrev_b32 v30, 16, v166
  v_and_b32 v31, 0xffff0000, v166
  v_cvt_pk_bf16_f32 v167, v32, v33
  v_lshlrev_b32 v32, 16, v167
  v_and_b32 v33, 0xffff0000, v167
  v_cvt_pk_bf16_f32 v164, v34, v35
  v_lshlrev_b32 v34, 16, v164
  v_and_b32 v35, 0xffff0000, v164
  v_cvt_pk_bf16_f32 v165, v36, v37
  v_lshlrev_b32 v36, 16, v165
  v_and_b32 v37, 0xffff0000, v165
  v_cvt_pk_bf16_f32 v166, v38, v39
  v_lshlrev_b32 v38, 16, v166
  v_and_b32 v39, 0xffff0000, v166
  v_cvt_pk_bf16_f32 v167, v40, v41
  v_lshlrev_b32 v40, 16, v167
  v_and_b32 v41, 0xffff0000, v167
  s_sub_u32 s36, s33, 0
  s_min_u32 s36, s36, 24
  v_mov_b32 v92, s36
  s_waitcnt vmcnt(10)
  buffer_store_dword v92, v228, s[8:11], 0 offen
  v_pk_mul_f32 v[2:3], v[2:3], v[86:87]
  v_pk_mul_f32 v[4:5], v[4:5], v[86:87]
  v_pk_mul_f32 v[6:7], v[6:7], v[86:87]
  v_pk_mul_f32 v[8:9], v[8:9], v[86:87]
  v_pk_mul_f32 v[10:11], v[10:11], v[86:87]
  v_pk_mul_f32 v[12:13], v[12:13], v[86:87]
  v_pk_mul_f32 v[14:15], v[14:15], v[86:87]
  v_pk_mul_f32 v[16:17], v[16:17], v[86:87]
  v_pk_mul_f32 v[18:19], v[18:19], v[86:87]
  v_pk_mul_f32 v[20:21], v[20:21], v[86:87]
  v_pk_mul_f32 v[22:23], v[22:23], v[86:87]
  v_pk_mul_f32 v[24:25], v[24:25], v[86:87]
  v_pk_mul_f32 v[26:27], v[26:27], v[86:87]
  v_pk_mul_f32 v[28:29], v[28:29], v[86:87]
  v_pk_mul_f32 v[30:31], v[30:31], v[86:87]
  v_pk_mul_f32 v[32:33], v[32:33], v[86:87]
  v_pk_mul_f32 v[34:35], v[34:35], v[86:87]
  v_pk_mul_f32 v[36:37], v[36:37], v[86:87]
  v_pk_mul_f32 v[38:39], v[38:39], v[86:87]
  v_pk_mul_f32 v[40:41], v[40:41], v[86:87]
  v_cvt_pk_bf16_f32 v164, v2, v3
  v_lshlrev_b32 v2, 16, v164
  v_and_b32 v3, 0xffff0000, v164
  v_cvt_pk_bf16_f32 v165, v4, v5
  v_lshlrev_b32 v4, 16, v165
  v_and_b32 v5, 0xffff0000, v165
  v_cvt_pk_bf16_f32 v166, v6, v7
  v_lshlrev_b32 v6, 16, v166
  v_and_b32 v7, 0xffff0000, v166
  v_cvt_pk_bf16_f32 v167, v8, v9
  v_lshlrev_b32 v8, 16, v167
  v_and_b32 v9, 0xffff0000, v167
  v_cvt_pk_bf16_f32 v164, v10, v11
  v_lshlrev_b32 v10, 16, v164
  v_and_b32 v11, 0xffff0000, v164
  v_cvt_pk_bf16_f32 v165, v12, v13
  v_lshlrev_b32 v12, 16, v165
  v_and_b32 v13, 0xffff0000, v165
  v_cvt_pk_bf16_f32 v166, v14, v15
  v_lshlrev_b32 v14, 16, v166
  v_and_b32 v15, 0xffff0000, v166
  v_cvt_pk_bf16_f32 v167, v16, v17
  v_lshlrev_b32 v16, 16, v167
  v_and_b32 v17, 0xffff0000, v167
  v_cvt_pk_bf16_f32 v164, v18, v19
  v_lshlrev_b32 v18, 16, v164
  v_and_b32 v19, 0xffff0000, v164
  v_cvt_pk_bf16_f32 v165, v20, v21
  v_lshlrev_b32 v20, 16, v165
  v_and_b32 v21, 0xffff0000, v165
  v_cvt_pk_bf16_f32 v166, v22, v23
  v_lshlrev_b32 v22, 16, v166
  v_and_b32 v23, 0xffff0000, v166
  v_cvt_pk_bf16_f32 v167, v24, v25
  v_lshlrev_b32 v24, 16, v167
  v_and_b32 v25, 0xffff0000, v167
  v_cvt_pk_bf16_f32 v164, v26, v27
  v_lshlrev_b32 v26, 16, v164
  v_and_b32 v27, 0xffff0000, v164
  v_cvt_pk_bf16_f32 v165, v28, v29
  v_lshlrev_b32 v28, 16, v165
  v_and_b32 v29, 0xffff0000, v165
  v_cvt_pk_bf16_f32 v166, v30, v31
  v_lshlrev_b32 v30, 16, v166
  v_and_b32 v31, 0xffff0000, v166
  v_cvt_pk_bf16_f32 v167, v32, v33
  v_lshlrev_b32 v32, 16, v167
  v_and_b32 v33, 0xffff0000, v167
  v_cvt_pk_bf16_f32 v164, v34, v35
  v_lshlrev_b32 v34, 16, v164
  v_and_b32 v35, 0xffff0000, v164
  v_cvt_pk_bf16_f32 v165, v36, v37
  v_lshlrev_b32 v36, 16, v165
  v_and_b32 v37, 0xffff0000, v165
  v_cvt_pk_bf16_f32 v166, v38, v39
  v_lshlrev_b32 v38, 16, v166
  v_and_b32 v39, 0xffff0000, v166
  v_cvt_pk_bf16_f32 v167, v40, v41
  v_lshlrev_b32 v40, 16, v167
  v_and_b32 v41, 0xffff0000, v167
  v_mul_f32_dpp v2, v176, v2 quad_perm:[2,2,2,2] row_mask:0xf bank_mask:0xf
  v_mul_f32_dpp v3, v177, v3 quad_perm:[2,2,2,2] row_mask:0xf bank_mask:0xf
  v_mul_f32_dpp v4, v178, v4 quad_perm:[2,2,2,2] row_mask:0xf bank_mask:0xf
  v_mul_f32_dpp v5, v179, v5 quad_perm:[2,2,2,2] row_mask:0xf bank_mask:0xf
  v_mul_f32_dpp v6, v176, v6 quad_perm:[3,3,3,3] row_mask:0xf bank_mask:0xf
  v_mul_f32_dpp v7, v177, v7 quad_perm:[3,3,3,3] row_mask:0xf bank_mask:0xf
  v_mul_f32_dpp v8, v178, v8 quad_perm:[3,3,3,3] row_mask:0xf bank_mask:0xf
  v_mul_f32_dpp v9, v179, v9 quad_perm:[3,3,3,3] row_mask:0xf bank_mask:0xf
  v_cvt_pk_bf16_f32 v164, v2, v3
  v_lshlrev_b32 v2, 16, v164
  v_and_b32 v3, 0xffff0000, v164
  v_cvt_pk_bf16_f32 v165, v4, v5
  v_lshlrev_b32 v4, 16, v165
  v_and_b32 v5, 0xffff0000, v165
  v_cvt_pk_bf16_f32 v166, v6, v7
  v_lshlrev_b32 v6, 16, v166
  v_and_b32 v7, 0xffff0000, v166
  v_cvt_pk_bf16_f32 v167, v8, v9
  v_lshlrev_b32 v8, 16, v167
  v_and_b32 v9, 0xffff0000, v167
  v_add_f32_dpp v2, v176, v2 quad_perm:[0,0,0,0] row_mask:0xf bank_mask:0xf
  v_add_f32_dpp v3, v177, v3 quad_perm:[0,0,0,0] row_mask:0xf bank_mask:0xf
  v_add_f32_dpp v4, v178, v4 quad_perm:[0,0,0,0] row_mask:0xf bank_mask:0xf
  v_add_f32_dpp v5, v179, v5 quad_perm:[0,0,0,0] row_mask:0xf bank_mask:0xf
  v_add_f32_dpp v6, v176, v6 quad_perm:[1,1,1,1] row_mask:0xf bank_mask:0xf
  v_add_f32_dpp v7, v177, v7 quad_perm:[1,1,1,1] row_mask:0xf bank_mask:0xf
  v_add_f32_dpp v8, v178, v8 quad_perm:[1,1,1,1] row_mask:0xf bank_mask:0xf
  v_add_f32_dpp v9, v179, v9 quad_perm:[1,1,1,1] row_mask:0xf bank_mask:0xf
  v_cvt_pk_bf16_f32 v196, v2, v3
  v_cvt_pk_bf16_f32 v197, v4, v5
  v_cvt_pk_bf16_f32 v198, v6, v7
  v_cvt_pk_bf16_f32 v199, v8, v9
  s_add_u32 s35, s38, 0
  buffer_store_dwordx4 v[196:199], v161, s[8:11], s35 offen sc1
  v_mul_f32_dpp v10, v180, v10 quad_perm:[2,2,2,2] row_mask:0xf bank_mask:0xf
  v_mul_f32_dpp v11, v181, v11 quad_perm:[2,2,2,2] row_mask:0xf bank_mask:0xf
  v_mul_f32_dpp v12, v182, v12 quad_perm:[2,2,2,2] row_mask:0xf bank_mask:0xf
  v_mul_f32_dpp v13, v183, v13 quad_perm:[2,2,2,2] row_mask:0xf bank_mask:0xf
  v_mul_f32_dpp v14, v180, v14 quad_perm:[3,3,3,3] row_mask:0xf bank_mask:0xf
  v_mul_f32_dpp v15, v181, v15 quad_perm:[3,3,3,3] row_mask:0xf bank_mask:0xf
  v_mul_f32_dpp v16, v182, v16 quad_perm:[3,3,3,3] row_mask:0xf bank_mask:0xf
  v_mul_f32_dpp v17, v183, v17 quad_perm:[3,3,3,3] row_mask:0xf bank_mask:0xf
  v_cvt_pk_bf16_f32 v164, v10, v11
  v_lshlrev_b32 v10, 16, v164
  v_and_b32 v11, 0xffff0000, v164
  v_cvt_pk_bf16_f32 v165, v12, v13
  v_lshlrev_b32 v12, 16, v165
  v_and_b32 v13, 0xffff0000, v165
  v_cvt_pk_bf16_f32 v166, v14, v15
  v_lshlrev_b32 v14, 16, v166
  v_and_b32 v15, 0xffff0000, v166
  v_cvt_pk_bf16_f32 v167, v16, v17
  v_lshlrev_b32 v16, 16, v167
  v_and_b32 v17, 0xffff0000, v167
  v_add_f32_dpp v10, v180, v10 quad_perm:[0,0,0,0] row_mask:0xf bank_mask:0xf
  v_add_f32_dpp v11, v181, v11 quad_perm:[0,0,0,0] row_mask:0xf bank_mask:0xf
  v_add_f32_dpp v12, v182, v12 quad_perm:[0,0,0,0] row_mask:0xf bank_mask:0xf
  v_add_f32_dpp v13, v183, v13 quad_perm:[0,0,0,0] row_mask:0xf bank_mask:0xf
  v_add_f32_dpp v14, v180, v14 quad_perm:[1,1,1,1] row_mask:0xf bank_mask:0xf
  v_add_f32_dpp v15, v181, v15 quad_perm:[1,1,1,1] row_mask:0xf bank_mask:0xf
  v_add_f32_dpp v16, v182, v16 quad_perm:[1,1,1,1] row_mask:0xf bank_mask:0xf
  v_add_f32_dpp v17, v183, v17 quad_perm:[1,1,1,1] row_mask:0xf bank_mask:0xf
  v_cvt_pk_bf16_f32 v200, v10, v11
  v_cvt_pk_bf16_f32 v201, v12, v13
  v_cvt_pk_bf16_f32 v202, v14, v15
  v_cvt_pk_bf16_f32 v203, v16, v17
  s_add_u32 s35, s38, 4096
  buffer_store_dwordx4 v[200:203], v161, s[8:11], s35 offen sc1
  v_mul_f32_dpp v18, v184, v18 quad_perm:[2,2,2,2] row_mask:0xf bank_mask:0xf
  v_mul_f32_dpp v19, v185, v19 quad_perm:[2,2,2,2] row_mask:0xf bank_mask:0xf
  v_mul_f32_dpp v20, v186, v20 quad_perm:[2,2,2,2] row_mask:0xf bank_mask:0xf
  v_mul_f32_dpp v21, v187, v21 quad_perm:[2,2,2,2] row_mask:0xf bank_mask:0xf
  v_mul_f32_dpp v22, v184, v22 quad_perm:[3,3,3,3] row_mask:0xf bank_mask:0xf
  v_mul_f32_dpp v23, v185, v23 quad_perm:[3,3,3,3] row_mask:0xf bank_mask:0xf
  v_mul_f32_dpp v24, v186, v24 quad_perm:[3,3,3,3] row_mask:0xf bank_mask:0xf
  v_mul_f32_dpp v25, v187, v25 quad_perm:[3,3,3,3] row_mask:0xf bank_mask:0xf
  v_cvt_pk_bf16_f32 v164, v18, v19
  v_lshlrev_b32 v18, 16, v164
  v_and_b32 v19, 0xffff0000, v164
  v_cvt_pk_bf16_f32 v165, v20, v21
  v_lshlrev_b32 v20, 16, v165
  v_and_b32 v21, 0xffff0000, v165
  v_cvt_pk_bf16_f32 v166, v22, v23
  v_lshlrev_b32 v22, 16, v166
  v_and_b32 v23, 0xffff0000, v166
  v_cvt_pk_bf16_f32 v167, v24, v25
  v_lshlrev_b32 v24, 16, v167
  v_and_b32 v25, 0xffff0000, v167
  v_add_f32_dpp v18, v184, v18 quad_perm:[0,0,0,0] row_mask:0xf bank_mask:0xf
  v_add_f32_dpp v19, v185, v19 quad_perm:[0,0,0,0] row_mask:0xf bank_mask:0xf
  v_add_f32_dpp v20, v186, v20 quad_perm:[0,0,0,0] row_mask:0xf bank_mask:0xf
  v_add_f32_dpp v21, v187, v21 quad_perm:[0,0,0,0] row_mask:0xf bank_mask:0xf
  v_add_f32_dpp v22, v184, v22 quad_perm:[1,1,1,1] row_mask:0xf bank_mask:0xf
  v_add_f32_dpp v23, v185, v23 quad_perm:[1,1,1,1] row_mask:0xf bank_mask:0xf
  v_add_f32_dpp v24, v186, v24 quad_perm:[1,1,1,1] row_mask:0xf bank_mask:0xf
  v_add_f32_dpp v25, v187, v25 quad_perm:[1,1,1,1] row_mask:0xf bank_mask:0xf
  v_cvt_pk_bf16_f32 v204, v18, v19
  v_cvt_pk_bf16_f32 v205, v20, v21
  v_cvt_pk_bf16_f32 v206, v22, v23
  v_cvt_pk_bf16_f32 v207, v24, v25
  s_add_u32 s35, s38, 8192
  buffer_store_dwordx4 v[204:207], v161, s[8:11], s35 offen sc1
  v_mul_f32_dpp v26, v188, v26 quad_perm:[2,2,2,2] row_mask:0xf bank_mask:0xf
  v_mul_f32_dpp v27, v189, v27 quad_perm:[2,2,2,2] row_mask:0xf bank_mask:0xf
  v_mul_f32_dpp v28, v190, v28 quad_perm:[2,2,2,2] row_mask:0xf bank_mask:0xf
  v_mul_f32_dpp v29, v191, v29 quad_perm:[2,2,2,2] row_mask:0xf bank_mask:0xf
  v_mul_f32_dpp v30, v188, v30 quad_perm:[3,3,3,3] row_mask:0xf bank_mask:0xf
  v_mul_f32_dpp v31, v189, v31 quad_perm:[3,3,3,3] row_mask:0xf bank_mask:0xf
  v_mul_f32_dpp v32, v190, v32 quad_perm:[3,3,3,3] row_mask:0xf bank_mask:0xf
  v_mul_f32_dpp v33, v191, v33 quad_perm:[3,3,3,3] row_mask:0xf bank_mask:0xf
  v_cvt_pk_bf16_f32 v164, v26, v27
  v_lshlrev_b32 v26, 16, v164
  v_and_b32 v27, 0xffff0000, v164
  v_cvt_pk_bf16_f32 v165, v28, v29
  v_lshlrev_b32 v28, 16, v165
  v_and_b32 v29, 0xffff0000, v165
  v_cvt_pk_bf16_f32 v166, v30, v31
  v_lshlrev_b32 v30, 16, v166
  v_and_b32 v31, 0xffff0000, v166
  v_cvt_pk_bf16_f32 v167, v32, v33
  v_lshlrev_b32 v32, 16, v167
  v_and_b32 v33, 0xffff0000, v167
  v_add_f32_dpp v26, v188, v26 quad_perm:[0,0,0,0] row_mask:0xf bank_mask:0xf
  v_add_f32_dpp v27, v189, v27 quad_perm:[0,0,0,0] row_mask:0xf bank_mask:0xf
  v_add_f32_dpp v28, v190, v28 quad_perm:[0,0,0,0] row_mask:0xf bank_mask:0xf
  v_add_f32_dpp v29, v191, v29 quad_perm:[0,0,0,0] row_mask:0xf bank_mask:0xf
  v_add_f32_dpp v30, v188, v30 quad_perm:[1,1,1,1] row_mask:0xf bank_mask:0xf
  v_add_f32_dpp v31, v189, v31 quad_perm:[1,1,1,1] row_mask:0xf bank_mask:0xf
  v_add_f32_dpp v32, v190, v32 quad_perm:[1,1,1,1] row_mask:0xf bank_mask:0xf
  v_add_f32_dpp v33, v191, v33 quad_perm:[1,1,1,1] row_mask:0xf bank_mask:0xf
  v_cvt_pk_bf16_f32 v208, v26, v27
  v_cvt_pk_bf16_f32 v209, v28, v29
  v_cvt_pk_bf16_f32 v210, v30, v31
  v_cvt_pk_bf16_f32 v211, v32, v33
  s_add_u32 s35, s38, 12288
  buffer_store_dwordx4 v[208:211], v161, s[8:11], s35 offen sc1
  v_mul_f32_dpp v34, v192, v34 quad_perm:[2,2,2,2] row_mask:0xf bank_mask:0xf
  v_mul_f32_dpp v35, v193, v35 quad_perm:[2,2,2,2] row_mask:0xf bank_mask:0xf
  v_mul_f32_dpp v36, v194, v36 quad_perm:[2,2,2,2] row_mask:0xf bank_mask:0xf
  v_mul_f32_dpp v37, v195, v37 quad_perm:[2,2,2,2] row_mask:0xf bank_mask:0xf
  v_mul_f32_dpp v38, v192, v38 quad_perm:[3,3,3,3] row_mask:0xf bank_mask:0xf
  v_mul_f32_dpp v39, v193, v39 quad_perm:[3,3,3,3] row_mask:0xf bank_mask:0xf
  v_mul_f32_dpp v40, v194, v40 quad_perm:[3,3,3,3] row_mask:0xf bank_mask:0xf
  v_mul_f32_dpp v41, v195, v41 quad_perm:[3,3,3,3] row_mask:0xf bank_mask:0xf
  v_cvt_pk_bf16_f32 v164, v34, v35
  v_lshlrev_b32 v34, 16, v164
  v_and_b32 v35, 0xffff0000, v164
  v_cvt_pk_bf16_f32 v165, v36, v37
  v_lshlrev_b32 v36, 16, v165
  v_and_b32 v37, 0xffff0000, v165
  v_cvt_pk_bf16_f32 v166, v38, v39
  v_lshlrev_b32 v38, 16, v166
  v_and_b32 v39, 0xffff0000, v166
  v_cvt_pk_bf16_f32 v167, v40, v41
  v_lshlrev_b32 v40, 16, v167
  v_and_b32 v41, 0xffff0000, v167
  v_add_f32_dpp v34, v192, v34 quad_perm:[0,0,0,0] row_mask:0xf bank_mask:0xf
  v_add_f32_dpp v35, v193, v35 quad_perm:[0,0,0,0] row_mask:0xf bank_mask:0xf
  v_add_f32_dpp v36, v194, v36 quad_perm:[0,0,0,0] row_mask:0xf bank_mask:0xf
  v_add_f32_dpp v37, v195, v37 quad_perm:[0,0,0,0] row_mask:0xf bank_mask:0xf
  v_add_f32_dpp v38, v192, v38 quad_perm:[1,1,1,1] row_mask:0xf bank_mask:0xf
  v_add_f32_dpp v39, v193, v39 quad_perm:[1,1,1,1] row_mask:0xf bank_mask:0xf
  v_add_f32_dpp v40, v194, v40 quad_perm:[1,1,1,1] row_mask:0xf bank_mask:0xf
  v_add_f32_dpp v41, v195, v41 quad_perm:[1,1,1,1] row_mask:0xf bank_mask:0xf
  v_cvt_pk_bf16_f32 v212, v34, v35
  v_cvt_pk_bf16_f32 v213, v36, v37
  v_cvt_pk_bf16_f32 v214, v38, v39
  v_cvt_pk_bf16_f32 v215, v40, v41
  s_add_u32 s35, s38, 16384
  buffer_store_dwordx4 v[212:215], v161, s[8:11], s35 offen sc1
  s_add_u32 s36, s41, 24
  s_cmp_lt_u32 s41, 24
  s_cselect_b32 s36, s39, s36
  s_add_u32 s41, s41, 3
  s_cmp_lt_u32 s41, 24
  s_cselect_b32 s41, s41, s36
  s_min_u32 s41, s41, 127
  s_mul_i32 s38, s16, 2621440
  s_cmp_lt_u32 s41, 24
  s_cselect_b32 s38, s38, 0
  s_mul_i32 s36, s41, 20480
  s_add_u32 s38, s38, s36
  s_lshl_b32 s36, s17, 6
  s_add_u32 s38, s38, s36
  s_add_u32 s38, s38, 247463936
  s_add_u32 s33, s33, 3
  buffer_load_dwordx2 v[66:67], v160, s[20:23], s37 offen offset:0
  buffer_load_dwordx2 v[68:69], v160, s[20:23], s37 offen offset:32
  buffer_load_dwordx2 v[70:71], v160, s[20:23], s37 offen offset:256
  buffer_load_dwordx2 v[72:73], v160, s[20:23], s37 offen offset:288
  buffer_load_dwordx2 v[74:75], v160, s[20:23], s37 offen offset:512
  buffer_load_dwordx2 v[76:77], v160, s[20:23], s37 offen offset:544
  buffer_load_dwordx2 v[78:79], v160, s[20:23], s37 offen offset:768
  buffer_load_dwordx2 v[80:81], v160, s[20:23], s37 offen offset:800
  buffer_load_dwordx2 v[82:83], v160, s[20:23], s37 offen offset:1024
  buffer_load_dwordx2 v[84:85], v160, s[20:23], s37 offen offset:1056
  s_add_u32 s36, s40, 24
  s_cmp_lt_u32 s40, 24
  s_cselect_b32 s36, s39, s36
  s_add_u32 s40, s40, 3
  s_cmp_lt_u32 s40, 24
  s_cselect_b32 s40, s40, s36
  s_min_u32 s40, s40, 127
  s_mul_i32 s37, s40, 20480
  s_mul_i32 s36, s17, 5120
  s_add_u32 s37, s37, s36
  s_cmp_lt_u32 s33, 39
  s_cbranch_scc0 r_ln1e
  v_lshlrev_b32 v2, 16, v140
  v_and_b32 v3, 0xffff0000, v140
  v_lshlrev_b32 v4, 16, v141
  v_and_b32 v5, 0xffff0000, v141
  v_lshlrev_b32 v6, 16, v142
  v_and_b32 v7, 0xffff0000, v142
  v_lshlrev_b32 v8, 16, v143
  v_and_b32 v9, 0xffff0000, v143
  v_lshlrev_b32 v10, 16, v144
  v_and_b32 v11, 0xffff0000, v144
  v_lshlrev_b32 v12, 16, v145
  v_and_b32 v13, 0xffff0000, v145
  v_lshlrev_b32 v14, 16, v146
  v_and_b32 v15, 0xffff0000, v146
  v_lshlrev_b32 v16, 16, v147
  v_and_b32 v17, 0xffff0000, v147
  v_lshlrev_b32 v18, 16, v148
  v_and_b32 v19, 0xffff0000, v148
  v_lshlrev_b32 v20, 16, v149
  v_and_b32 v21, 0xffff0000, v149
  v_lshlrev_b32 v22, 16, v150
  v_and_b32 v23, 0xffff0000, v150
  v_lshlrev_b32 v24, 16, v151
  v_and_b32 v25, 0xffff0000, v151
  v_lshlrev_b32 v26, 16, v152
  v_and_b32 v27, 0xffff0000, v152
  v_lshlrev_b32 v28, 16, v153
  v_and_b32 v29, 0xffff0000, v153
  v_lshlrev_b32 v30, 16, v154
  v_and_b32 v31, 0xffff0000, v154
  v_lshlrev_b32 v32, 16, v155
  v_and_b32 v33, 0xffff0000, v155
  v_lshlrev_b32 v34, 16, v156
  v_and_b32 v35, 0xffff0000, v156
  v_lshlrev_b32 v36, 16, v157
  v_and_b32 v37, 0xffff0000, v157
  v_lshlrev_b32 v38, 16, v158
  v_and_b32 v39, 0xffff0000, v158
  v_lshlrev_b32 v40, 16, v159
  v_and_b32 v41, 0xffff0000, v159
  v_pk_add_f32 v[86:87], v[2:3], v[4:5]
  v_pk_add_f32 v[88:89], v[6:7], v[8:9]
  v_pk_add_f32 v[86:87], v[86:87], v[10:11]
  v_pk_add_f32 v[88:89], v[88:89], v[12:13]
  v_pk_add_f32 v[86:87], v[86:87], v[14:15]
  v_pk_add_f32 v[88:89], v[88:89], v[16:17]
  v_pk_add_f32 v[86:87], v[86:87], v[18:19]
  v_pk_add_f32 v[88:89], v[88:89], v[20:21]
  v_pk_add_f32 v[86:87], v[86:87], v[22:23]
  v_pk_add_f32 v[88:89], v[88:89], v[24:25]
  v_pk_add_f32 v[86:87], v[86:87], v[26:27]
  v_pk_add_f32 v[88:89], v[88:89], v[28:29]
  v_pk_add_f32 v[86:87], v[86:87], v[30:31]
  v_pk_add_f32 v[88:89], v[88:89], v[32:33]
  v_pk_add_f32 v[86:87], v[86:87], v[34:35]
  v_pk_add_f32 v[88:89], v[88:89], v[36:37]
  v_pk_add_f32 v[86:87], v[86:87], v[38:39]
  v_pk_add_f32 v[88:89], v[88:89], v[40:41]
  v_pk_add_f32 v[86:87], v[86:87], v[88:89]
  v_add_f32 v86, v86, v87
  s_nop 1
  v_add_f32_dpp v86, v86, v86 row_ror:8 row_mask:0xf bank_mask:0xf
  s_nop 1
  v_add_f32_dpp v86, v86, v86 row_ror:4 row_mask:0xf bank_mask:0xf
  v_mov_b32 v90, v86
  s_nop 1
  v_permlane16_swap_b32 v86, v90
  v_add_f32 v86, v86, v90
  v_mov_b32 v90, v86
  s_nop 1
  v_permlane32_swap_b32 v86, v90
  v_add_f32 v86, v86, v90
  v_mul_f32 v88, 0xbacccccd, v86
  v_mul_f32 v89, 0xbacccccd, v86
  v_pk_add_f32 v[164:165], v[2:3], v[88:89]
  v_pk_add_f32 v[166:167], v[4:5], v[88:89]
  v_pk_mul_f32 v[170:171], v[164:165], v[164:165]
  v_pk_add_f32 v[168:169], v[6:7], v[88:89]
  v_pk_mul_f32 v[86:87], v[166:167], v[166:167]
  v_pk_add_f32 v[164:165], v[8:9], v[88:89]
  v_pk_fma_f32 v[170:171], v[168:169], v[168:169], v[170:171]
  v_pk_add_f32 v[166:167], v[10:11], v[88:89]
  v_pk_fma_f32 v[86:87], v[164:165], v[164:165], v[86:87]
  v_pk_add_f32 v[168:169], v[12:13], v[88:89]
  v_pk_fma_f32 v[170:171], v[166:167], v[166:167], v[170:171]
  v_pk_add_f32 v[164:165], v[14:15], v[88:89]
  v_pk_fma_f32 v[86:87], v[168:169], v[168:169], v[86:87]
  v_pk_add_f32 v[166:167], v[16:17], v[88:89]
  v_pk_fma_f32 v[170:171], v[164:165], v[164:165], v[170:171]
  v_pk_add_f32 v[168:169], v[18:19], v[88:89]
  v_pk_fma_f32 v[86:87], v[166:167], v[166:167], v[86:87]
  v_pk_add_f32 v[164:165], v[20:21], v[88:89]
  v_pk_fma_f32 v[170:171], v[168:169], v[168:169], v[170:171]
  v_pk_add_f32 v[166:167], v[22:23], v[88:89]
  v_pk_fma_f32 v[86:87], v[164:165], v[164:165], v[86:87]
  v_pk_add_f32 v[168:169], v[24:25], v[88:89]
  v_pk_fma_f32 v[170:171], v[166:167], v[166:167], v[170:171]
  v_pk_add_f32 v[164:165], v[26:27], v[88:89]
  v_pk_fma_f32 v[86:87], v[168:169], v[168:169], v[86:87]
  v_pk_add_f32 v[166:167], v[28:29], v[88:89]
  v_pk_fma_f32 v[170:171], v[164:165], v[164:165], v[170:171]
  v_pk_add_f32 v[168:169], v[30:31], v[88:89]
  v_pk_fma_f32 v[86:87], v[166:167], v[166:167], v[86:87]
  v_pk_add_f32 v[164:165], v[32:33], v[88:89]
  v_pk_fma_f32 v[170:171], v[168:169], v[168:169], v[170:171]
  v_pk_add_f32 v[166:167], v[34:35], v[88:89]
  v_pk_fma_f32 v[86:87], v[164:165], v[164:165], v[86:87]
  v_pk_add_f32 v[168:169], v[36:37], v[88:89]
  v_pk_fma_f32 v[170:171], v[166:167], v[166:167], v[170:171]
  v_pk_add_f32 v[164:165], v[38:39], v[88:89]
  v_pk_fma_f32 v[86:87], v[168:169], v[168:169], v[86:87]
  v_pk_add_f32 v[166:167], v[40:41], v[88:89]
  v_pk_fma_f32 v[170:171], v[164:165], v[164:165], v[170:171]
  v_pk_fma_f32 v[86:87], v[166:167], v[166:167], v[86:87]
  v_cvt_pk_bf16_f32 v91, v88, v89
  v_lshlrev_b32 v88, 16, v91
  v_and_b32 v89, 0xffff0000, v91
  v_pk_add_f32 v[86:87], v[86:87], v[170:171]
  v_add_f32 v86, v86, v87
  s_nop 1
  v_add_f32_dpp v86, v86, v86 row_ror:8 row_mask:0xf bank_mask:0xf
  s_nop 1
  v_add_f32_dpp v86, v86, v86 row_ror:4 row_mask:0xf bank_mask:0xf
  v_mov_b32 v90, v86
  s_nop 1
  v_permlane16_swap_b32 v86, v90
  v_add_f32 v86, v86, v90
  v_mov_b32 v90, v86
  s_nop 1
  v_permlane32_swap_b32 v86, v90
  v_add_f32 v86, v86, v90
  v_pk_add_f32 v[2:3], v[2:3], v[88:89]
  v_mul_f32 v86, 0x3acccccd, v86
  v_pk_add_f32 v[4:5], v[4:5], v[88:89]
  v_cvt_pk_bf16_f32 v86, v86, v86
  v_pk_add_f32 v[6:7], v[6:7], v[88:89]
  v_lshlrev_b32 v86, 16, v86
  v_pk_add_f32 v[8:9], v[8:9], v[88:89]
  v_add_f32 v86, 0x3727c5ac, v86
  v_pk_add_f32 v[10:11], v[10:11], v[88:89]
  v_cvt_pk_bf16_f32 v86, v86, v86
  v_pk_add_f32 v[12:13], v[12:13], v[88:89]
  v_lshlrev_b32 v86, 16, v86
  v_pk_add_f32 v[14:15], v[14:15], v[88:89]
  v_sqrt_f32 v86, v86
  v_pk_add_f32 v[16:17], v[16:17], v[88:89]
  v_cvt_pk_bf16_f32 v86, v86, v86
  v_pk_add_f32 v[18:19], v[18:19], v[88:89]
  v_lshlrev_b32 v86, 16, v86
  v_pk_add_f32 v[20:21], v[20:21], v[88:89]
  v_rcp_f32 v86, v86
  v_pk_add_f32 v[22:23], v[22:23], v[88:89]
  v_mov_b32 v87, v86
  v_pk_add_f32 v[24:25], v[24:25], v[88:89]
  v_pk_add_f32 v[26:27], v[26:27], v[88:89]
  v_pk_add_f32 v[28:29], v[28:29], v[88:89]
  v_pk_add_f32 v[30:31], v[30:31], v[88:89]
  v_pk_add_f32 v[32:33], v[32:33], v[88:89]
  v_pk_add_f32 v[34:35], v[34:35], v[88:89]
  v_pk_add_f32 v[36:37], v[36:37], v[88:89]
  v_pk_add_f32 v[38:39], v[38:39], v[88:89]
  v_pk_add_f32 v[40:41], v[40:41], v[88:89]
  v_cvt_pk_bf16_f32 v164, v2, v3
  v_lshlrev_b32 v2, 16, v164
  v_and_b32 v3, 0xffff0000, v164
  v_cvt_pk_bf16_f32 v165, v4, v5
  v_lshlrev_b32 v4, 16, v165
  v_and_b32 v5, 0xffff0000, v165
  v_cvt_pk_bf16_f32 v166, v6, v7
  v_lshlrev_b32 v6, 16, v166
  v_and_b32 v7, 0xffff0000, v166
  v_cvt_pk_bf16_f32 v167, v8, v9
  v_lshlrev_b32 v8, 16, v167
  v_and_b32 v9, 0xffff0000, v167
  v_cvt_pk_bf16_f32 v164, v10, v11
  v_lshlrev_b32 v10, 16, v164
  v_and_b32 v11, 0xffff0000, v164
  v_cvt_pk_bf16_f32 v165, v12, v13
  v_lshlrev_b32 v12, 16, v165
  v_and_b32 v13, 0xffff0000, v165
  v_cvt_pk_bf16_f32 v166, v14, v15
  v_lshlrev_b32 v14, 16, v166
  v_and_b32 v15, 0xffff0000, v166
  v_cvt_pk_bf16_f32 v167, v16, v17
  v_lshlrev_b32 v16, 16, v167
  v_and_b32 v17, 0xffff0000, v167
  v_cvt_pk_bf16_f32 v164, v18, v19
  v_lshlrev_b32 v18, 16, v164
  v_and_b32 v19, 0xffff0000, v164
  v_cvt_pk_bf16_f32 v165, v20, v21
  v_lshlrev_b32 v20, 16, v165
  v_and_b32 v21, 0xffff0000, v165
  v_cvt_pk_bf16_f32 v166, v22, v23
  v_lshlrev_b32 v22, 16, v166
  v_and_b32 v23, 0xffff0000, v166
  v_cvt_pk_bf16_f32 v167, v24, v25
  v_lshlrev_b32 v24, 16, v167
  v_and_b32 v25, 0xffff0000, v167
  v_cvt_pk_bf16_f32 v164, v26, v27
  v_lshlrev_b32 v26, 16, v164
  v_and_b32 v27, 0xffff0000, v164
  v_cvt_pk_bf16_f32 v165, v28, v29
  v_lshlrev_b32 v28, 16, v165
  v_and_b32 v29, 0xffff0000, v165
  v_cvt_pk_bf16_f32 v166, v30, v31
  v_lshlrev_b32 v30, 16, v166
  v_and_b32 v31, 0xffff0000, v166
  v_cvt_pk_bf16_f32 v167, v32, v33
  v_lshlrev_b32 v32, 16, v167
  v_and_b32 v33, 0xffff0000, v167
  v_cvt_pk_bf16_f32 v164, v34, v35
  v_lshlrev_b32 v34, 16, v164
  v_and_b32 v35, 0xffff0000, v164
  v_cvt_pk_bf16_f32 v165, v36, v37
  v_lshlrev_b32 v36, 16, v165
  v_and_b32 v37, 0xffff0000, v165
  v_cvt_pk_bf16_f32 v166, v38, v39
  v_lshlrev_b32 v38, 16, v166
  v_and_b32 v39, 0xffff0000, v166
  v_cvt_pk_bf16_f32 v167, v40, v41
  v_lshlrev_b32 v40, 16, v167
  v_and_b32 v41, 0xffff0000, v167
  s_sub_u32 s36, s33, 0
  s_min_u32 s36, s36, 24
  v_mov_b32 v92, s36
  s_waitcnt vmcnt(10)
  buffer_store_dword v92, v228, s[8:11], 0 offen
  v_pk_mul_f32 v[2:3], v[2:3], v[86:87]
  v_pk_mul_f32 v[4:5], v[4:5], v[86:87]
  v_pk_mul_f32 v[6:7], v[6:7], v[86:87]
  v_pk_mul_f32 v[8:9], v[8:9], v[86:87]
  v_pk_mul_f32 v[10:11], v[10:11], v[86:87]
  v_pk_mul_f32 v[12:13], v[12:13], v[86:87]
  v_pk_mul_f32 v[14:15], v[14:15], v[86:87]
  v_pk_mul_f32 v[16:17], v[16:17], v[86:87]
  v_pk_mul_f32 v[18:19], v[18:19], v[86:87]
  v_pk_mul_f32 v[20:21], v[20:21], v[86:87]
  v_pk_mul_f32 v[22:23], v[22:23], v[86:87]
  v_pk_mul_f32 v[24:25], v[24:25], v[86:87]
  v_pk_mul_f32 v[26:27], v[26:27], v[86:87]
  v_pk_mul_f32 v[28:29], v[28:29], v[86:87]
  v_pk_mul_f32 v[30:31], v[30:31], v[86:87]
  v_pk_mul_f32 v[32:33], v[32:33], v[86:87]
  v_pk_mul_f32 v[34:35], v[34:35], v[86:87]
  v_pk_mul_f32 v[36:37], v[36:37], v[86:87]
  v_pk_mul_f32 v[38:39], v[38:39], v[86:87]
  v_pk_mul_f32 v[40:41], v[40:41], v[86:87]
  v_cvt_pk_bf16_f32 v164, v2, v3
  v_lshlrev_b32 v2, 16, v164
  v_and_b32 v3, 0xffff0000, v164
  v_cvt_pk_bf16_f32 v165, v4, v5
  v_lshlrev_b32 v4, 16, v165
  v_and_b32 v5, 0xffff0000, v165
  v_cvt_pk_bf16_f32 v166, v6, v7
  v_lshlrev_b32 v6, 16, v166
  v_and_b32 v7, 0xffff0000, v166
  v_cvt_pk_bf16_f32 v167, v8, v9
  v_lshlrev_b32 v8, 16, v167
  v_and_b32 v9, 0xffff0000, v167
  v_cvt_pk_bf16_f32 v164, v10, v11
  v_lshlrev_b32 v10, 16, v164
  v_and_b32 v11, 0xffff0000, v164
  v_cvt_pk_bf16_f32 v165, v12, v13
  v_lshlrev_b32 v12, 16, v165
  v_and_b32 v13, 0xffff0000, v165
  v_cvt_pk_bf16_f32 v166, v14, v15
  v_lshlrev_b32 v14, 16, v166
  v_and_b32 v15, 0xffff0000, v166
  v_cvt_pk_bf16_f32 v167, v16, v17
  v_lshlrev_b32 v16, 16, v167
  v_and_b32 v17, 0xffff0000, v167
  v_cvt_pk_bf16_f32 v164, v18, v19
  v_lshlrev_b32 v18, 16, v164
  v_and_b32 v19, 0xffff0000, v164
  v_cvt_pk_bf16_f32 v165, v20, v21
  v_lshlrev_b32 v20, 16, v165
  v_and_b32 v21, 0xffff0000, v165
  v_cvt_pk_bf16_f32 v166, v22, v23
  v_lshlrev_b32 v22, 16, v166
  v_and_b32 v23, 0xffff0000, v166
  v_cvt_pk_bf16_f32 v167, v24, v25
  v_lshlrev_b32 v24, 16, v167
  v_and_b32 v25, 0xffff0000, v167
  v_cvt_pk_bf16_f32 v164, v26, v27
  v_lshlrev_b32 v26, 16, v164
  v_and_b32 v27, 0xffff0000, v164
  v_cvt_pk_bf16_f32 v165, v28, v29
  v_lshlrev_b32 v28, 16, v165
  v_and_b32 v29, 0xffff0000, v165
  v_cvt_pk_bf16_f32 v166, v30, v31
  v_lshlrev_b32 v30, 16, v166
  v_and_b32 v31, 0xffff0000, v166
  v_cvt_pk_bf16_f32 v167, v32, v33
  v_lshlrev_b32 v32, 16, v167
  v_and_b32 v33, 0xffff0000, v167
  v_cvt_pk_bf16_f32 v164, v34, v35
  v_lshlrev_b32 v34, 16, v164
  v_and_b32 v35, 0xffff0000, v164
  v_cvt_pk_bf16_f32 v165, v36, v37
  v_lshlrev_b32 v36, 16, v165
  v_and_b32 v37, 0xffff0000, v165
  v_cvt_pk_bf16_f32 v166, v38, v39
  v_lshlrev_b32 v38, 16, v166
  v_and_b32 v39, 0xffff0000, v166
  v_cvt_pk_bf16_f32 v167, v40, v41
  v_lshlrev_b32 v40, 16, v167
  v_and_b32 v41, 0xffff0000, v167
  v_mul_f32_dpp v2, v176, v2 quad_perm:[2,2,2,2] row_mask:0xf bank_mask:0xf
  v_mul_f32_dpp v3, v177, v3 quad_perm:[2,2,2,2] row_mask:0xf bank_mask:0xf
  v_mul_f32_dpp v4, v178, v4 quad_perm:[2,2,2,2] row_mask:0xf bank_mask:0xf
  v_mul_f32_dpp v5, v179, v5 quad_perm:[2,2,2,2] row_mask:0xf bank_mask:0xf
  v_mul_f32_dpp v6, v176, v6 quad_perm:[3,3,3,3] row_mask:0xf bank_mask:0xf
  v_mul_f32_dpp v7, v177, v7 quad_perm:[3,3,3,3] row_mask:0xf bank_mask:0xf
  v_mul_f32_dpp v8, v178, v8 quad_perm:[3,3,3,3] row_mask:0xf bank_mask:0xf
  v_mul_f32_dpp v9, v179, v9 quad_perm:[3,3,3,3] row_mask:0xf bank_mask:0xf
  v_cvt_pk_bf16_f32 v164, v2, v3
  v_lshlrev_b32 v2, 16, v164
  v_and_b32 v3, 0xffff0000, v164
  v_cvt_pk_bf16_f32 v165, v4, v5
  v_lshlrev_b32 v4, 16, v165
  v_and_b32 v5, 0xffff0000, v165
  v_cvt_pk_bf16_f32 v166, v6, v7
  v_lshlrev_b32 v6, 16, v166
  v_and_b32 v7, 0xffff0000, v166
  v_cvt_pk_bf16_f32 v167, v8, v9
  v_lshlrev_b32 v8, 16, v167
  v_and_b32 v9, 0xffff0000, v167
  v_add_f32_dpp v2, v176, v2 quad_perm:[0,0,0,0] row_mask:0xf bank_mask:0xf
  v_add_f32_dpp v3, v177, v3 quad_perm:[0,0,0,0] row_mask:0xf bank_mask:0xf
  v_add_f32_dpp v4, v178, v4 quad_perm:[0,0,0,0] row_mask:0xf bank_mask:0xf
  v_add_f32_dpp v5, v179, v5 quad_perm:[0,0,0,0] row_mask:0xf bank_mask:0xf
  v_add_f32_dpp v6, v176, v6 quad_perm:[1,1,1,1] row_mask:0xf bank_mask:0xf
  v_add_f32_dpp v7, v177, v7 quad_perm:[1,1,1,1] row_mask:0xf bank_mask:0xf
  v_add_f32_dpp v8, v178, v8 quad_perm:[1,1,1,1] row_mask:0xf bank_mask:0xf
  v_add_f32_dpp v9, v179, v9 quad_perm:[1,1,1,1] row_mask:0xf bank_mask:0xf
  v_cvt_pk_bf16_f32 v196, v2, v3
  v_cvt_pk_bf16_f32 v197, v4, v5
  v_cvt_pk_bf16_f32 v198, v6, v7
  v_cvt_pk_bf16_f32 v199, v8, v9
  s_add_u32 s35, s38, 0
  buffer_store_dwordx4 v[196:199], v161, s[8:11], s35 offen sc1
  v_mul_f32_dpp v10, v180, v10 quad_perm:[2,2,2,2] row_mask:0xf bank_mask:0xf
  v_mul_f32_dpp v11, v181, v11 quad_perm:[2,2,2,2] row_mask:0xf bank_mask:0xf
  v_mul_f32_dpp v12, v182, v12 quad_perm:[2,2,2,2] row_mask:0xf bank_mask:0xf
  v_mul_f32_dpp v13, v183, v13 quad_perm:[2,2,2,2] row_mask:0xf bank_mask:0xf
  v_mul_f32_dpp v14, v180, v14 quad_perm:[3,3,3,3] row_mask:0xf bank_mask:0xf
  v_mul_f32_dpp v15, v181, v15 quad_perm:[3,3,3,3] row_mask:0xf bank_mask:0xf
  v_mul_f32_dpp v16, v182, v16 quad_perm:[3,3,3,3] row_mask:0xf bank_mask:0xf
  v_mul_f32_dpp v17, v183, v17 quad_perm:[3,3,3,3] row_mask:0xf bank_mask:0xf
  v_cvt_pk_bf16_f32 v164, v10, v11
  v_lshlrev_b32 v10, 16, v164
  v_and_b32 v11, 0xffff0000, v164
  v_cvt_pk_bf16_f32 v165, v12, v13
  v_lshlrev_b32 v12, 16, v165
  v_and_b32 v13, 0xffff0000, v165
  v_cvt_pk_bf16_f32 v166, v14, v15
  v_lshlrev_b32 v14, 16, v166
  v_and_b32 v15, 0xffff0000, v166
  v_cvt_pk_bf16_f32 v167, v16, v17
  v_lshlrev_b32 v16, 16, v167
  v_and_b32 v17, 0xffff0000, v167
  v_add_f32_dpp v10, v180, v10 quad_perm:[0,0,0,0] row_mask:0xf bank_mask:0xf
  v_add_f32_dpp v11, v181, v11 quad_perm:[0,0,0,0] row_mask:0xf bank_mask:0xf
  v_add_f32_dpp v12, v182, v12 quad_perm:[0,0,0,0] row_mask:0xf bank_mask:0xf
  v_add_f32_dpp v13, v183, v13 quad_perm:[0,0,0,0] row_mask:0xf bank_mask:0xf
  v_add_f32_dpp v14, v180, v14 quad_perm:[1,1,1,1] row_mask:0xf bank_mask:0xf
  v_add_f32_dpp v15, v181, v15 quad_perm:[1,1,1,1] row_mask:0xf bank_mask:0xf
  v_add_f32_dpp v16, v182, v16 quad_perm:[1,1,1,1] row_mask:0xf bank_mask:0xf
  v_add_f32_dpp v17, v183, v17 quad_perm:[1,1,1,1] row_mask:0xf bank_mask:0xf
  v_cvt_pk_bf16_f32 v200, v10, v11
  v_cvt_pk_bf16_f32 v201, v12, v13
  v_cvt_pk_bf16_f32 v202, v14, v15
  v_cvt_pk_bf16_f32 v203, v16, v17
  s_add_u32 s35, s38, 4096
  buffer_store_dwordx4 v[200:203], v161, s[8:11], s35 offen sc1
  v_mul_f32_dpp v18, v184, v18 quad_perm:[2,2,2,2] row_mask:0xf bank_mask:0xf
  v_mul_f32_dpp v19, v185, v19 quad_perm:[2,2,2,2] row_mask:0xf bank_mask:0xf
  v_mul_f32_dpp v20, v186, v20 quad_perm:[2,2,2,2] row_mask:0xf bank_mask:0xf
  v_mul_f32_dpp v21, v187, v21 quad_perm:[2,2,2,2] row_mask:0xf bank_mask:0xf
  v_mul_f32_dpp v22, v184, v22 quad_perm:[3,3,3,3] row_mask:0xf bank_mask:0xf
  v_mul_f32_dpp v23, v185, v23 quad_perm:[3,3,3,3] row_mask:0xf bank_mask:0xf
  v_mul_f32_dpp v24, v186, v24 quad_perm:[3,3,3,3] row_mask:0xf bank_mask:0xf
  v_mul_f32_dpp v25, v187, v25 quad_perm:[3,3,3,3] row_mask:0xf bank_mask:0xf
  v_cvt_pk_bf16_f32 v164, v18, v19
  v_lshlrev_b32 v18, 16, v164
  v_and_b32 v19, 0xffff0000, v164
  v_cvt_pk_bf16_f32 v165, v20, v21
  v_lshlrev_b32 v20, 16, v165
  v_and_b32 v21, 0xffff0000, v165
  v_cvt_pk_bf16_f32 v166, v22, v23
  v_lshlrev_b32 v22, 16, v166
  v_and_b32 v23, 0xffff0000, v166
  v_cvt_pk_bf16_f32 v167, v24, v25
  v_lshlrev_b32 v24, 16, v167
  v_and_b32 v25, 0xffff0000, v167
  v_add_f32_dpp v18, v184, v18 quad_perm:[0,0,0,0] row_mask:0xf bank_mask:0xf
  v_add_f32_dpp v19, v185, v19 quad_perm:[0,0,0,0] row_mask:0xf bank_mask:0xf
  v_add_f32_dpp v20, v186, v20 quad_perm:[0,0,0,0] row_mask:0xf bank_mask:0xf
  v_add_f32_dpp v21, v187, v21 quad_perm:[0,0,0,0] row_mask:0xf bank_mask:0xf
  v_add_f32_dpp v22, v184, v22 quad_perm:[1,1,1,1] row_mask:0xf bank_mask:0xf
  v_add_f32_dpp v23, v185, v23 quad_perm:[1,1,1,1] row_mask:0xf bank_mask:0xf
  v_add_f32_dpp v24, v186, v24 quad_perm:[1,1,1,1] row_mask:0xf bank_mask:0xf
  v_add_f32_dpp v25, v187, v25 quad_perm:[1,1,1,1] row_mask:0xf bank_mask:0xf
  v_cvt_pk_bf16_f32 v204, v18, v19
  v_cvt_pk_bf16_f32 v205, v20, v21
  v_cvt_pk_bf16_f32 v206, v22, v23
  v_cvt_pk_bf16_f32 v207, v24, v25
  s_add_u32 s35, s38, 8192
  buffer_store_dwordx4 v[204:207], v161, s[8:11], s35 offen sc1
  v_mul_f32_dpp v26, v188, v26 quad_perm:[2,2,2,2] row_mask:0xf bank_mask:0xf
  v_mul_f32_dpp v27, v189, v27 quad_perm:[2,2,2,2] row_mask:0xf bank_mask:0xf
  v_mul_f32_dpp v28, v190, v28 quad_perm:[2,2,2,2] row_mask:0xf bank_mask:0xf
  v_mul_f32_dpp v29, v191, v29 quad_perm:[2,2,2,2] row_mask:0xf bank_mask:0xf
  v_mul_f32_dpp v30, v188, v30 quad_perm:[3,3,3,3] row_mask:0xf bank_mask:0xf
  v_mul_f32_dpp v31, v189, v31 quad_perm:[3,3,3,3] row_mask:0xf bank_mask:0xf
  v_mul_f32_dpp v32, v190, v32 quad_perm:[3,3,3,3] row_mask:0xf bank_mask:0xf
  v_mul_f32_dpp v33, v191, v33 quad_perm:[3,3,3,3] row_mask:0xf bank_mask:0xf
  v_cvt_pk_bf16_f32 v164, v26, v27
  v_lshlrev_b32 v26, 16, v164
  v_and_b32 v27, 0xffff0000, v164
  v_cvt_pk_bf16_f32 v165, v28, v29
  v_lshlrev_b32 v28, 16, v165
  v_and_b32 v29, 0xffff0000, v165
  v_cvt_pk_bf16_f32 v166, v30, v31
  v_lshlrev_b32 v30, 16, v166
  v_and_b32 v31, 0xffff0000, v166
  v_cvt_pk_bf16_f32 v167, v32, v33
  v_lshlrev_b32 v32, 16, v167
  v_and_b32 v33, 0xffff0000, v167
  v_add_f32_dpp v26, v188, v26 quad_perm:[0,0,0,0] row_mask:0xf bank_mask:0xf
  v_add_f32_dpp v27, v189, v27 quad_perm:[0,0,0,0] row_mask:0xf bank_mask:0xf
  v_add_f32_dpp v28, v190, v28 quad_perm:[0,0,0,0] row_mask:0xf bank_mask:0xf
  v_add_f32_dpp v29, v191, v29 quad_perm:[0,0,0,0] row_mask:0xf bank_mask:0xf
  v_add_f32_dpp v30, v188, v30 quad_perm:[1,1,1,1] row_mask:0xf bank_mask:0xf
  v_add_f32_dpp v31, v189, v31 quad_perm:[1,1,1,1] row_mask:0xf bank_mask:0xf
  v_add_f32_dpp v32, v190, v32 quad_perm:[1,1,1,1] row_mask:0xf bank_mask:0xf
  v_add_f32_dpp v33, v191, v33 quad_perm:[1,1,1,1] row_mask:0xf bank_mask:0xf
  v_cvt_pk_bf16_f32 v208, v26, v27
  v_cvt_pk_bf16_f32 v209, v28, v29
  v_cvt_pk_bf16_f32 v210, v30, v31
  v_cvt_pk_bf16_f32 v211, v32, v33
  s_add_u32 s35, s38, 12288
  buffer_store_dwordx4 v[208:211], v161, s[8:11], s35 offen sc1
  v_mul_f32_dpp v34, v192, v34 quad_perm:[2,2,2,2] row_mask:0xf bank_mask:0xf
  v_mul_f32_dpp v35, v193, v35 quad_perm:[2,2,2,2] row_mask:0xf bank_mask:0xf
  v_mul_f32_dpp v36, v194, v36 quad_perm:[2,2,2,2] row_mask:0xf bank_mask:0xf
  v_mul_f32_dpp v37, v195, v37 quad_perm:[2,2,2,2] row_mask:0xf bank_mask:0xf
  v_mul_f32_dpp v38, v192, v38 quad_perm:[3,3,3,3] row_mask:0xf bank_mask:0xf
  v_mul_f32_dpp v39, v193, v39 quad_perm:[3,3,3,3] row_mask:0xf bank_mask:0xf
  v_mul_f32_dpp v40, v194, v40 quad_perm:[3,3,3,3] row_mask:0xf bank_mask:0xf
  v_mul_f32_dpp v41, v195, v41 quad_perm:[3,3,3,3] row_mask:0xf bank_mask:0xf
  v_cvt_pk_bf16_f32 v164, v34, v35
  v_lshlrev_b32 v34, 16, v164
  v_and_b32 v35, 0xffff0000, v164
  v_cvt_pk_bf16_f32 v165, v36, v37
  v_lshlrev_b32 v36, 16, v165
  v_and_b32 v37, 0xffff0000, v165
  v_cvt_pk_bf16_f32 v166, v38, v39
  v_lshlrev_b32 v38, 16, v166
  v_and_b32 v39, 0xffff0000, v166
  v_cvt_pk_bf16_f32 v167, v40, v41
  v_lshlrev_b32 v40, 16, v167
  v_and_b32 v41, 0xffff0000, v167
  v_add_f32_dpp v34, v192, v34 quad_perm:[0,0,0,0] row_mask:0xf bank_mask:0xf
  v_add_f32_dpp v35, v193, v35 quad_perm:[0,0,0,0] row_mask:0xf bank_mask:0xf
  v_add_f32_dpp v36, v194, v36 quad_perm:[0,0,0,0] row_mask:0xf bank_mask:0xf
  v_add_f32_dpp v37, v195, v37 quad_perm:[0,0,0,0] row_mask:0xf bank_mask:0xf
  v_add_f32_dpp v38, v192, v38 quad_perm:[1,1,1,1] row_mask:0xf bank_mask:0xf
  v_add_f32_dpp v39, v193, v39 quad_perm:[1,1,1,1] row_mask:0xf bank_mask:0xf
  v_add_f32_dpp v40, v194, v40 quad_perm:[1,1,1,1] row_mask:0xf bank_mask:0xf
  v_add_f32_dpp v41, v195, v41 quad_perm:[1,1,1,1] row_mask:0xf bank_mask:0xf
  v_cvt_pk_bf16_f32 v212, v34, v35
  v_cvt_pk_bf16_f32 v213, v36, v37
  v_cvt_pk_bf16_f32 v214, v38, v39
  v_cvt_pk_bf16_f32 v215, v40, v41
  s_add_u32 s35, s38, 16384
  buffer_store_dwordx4 v[212:215], v161, s[8:11], s35 offen sc1
  s_add_u32 s36, s41, 24
  s_cmp_lt_u32 s41, 24
  s_cselect_b32 s36, s39, s36
  s_add_u32 s41, s41, 3
  s_cmp_lt_u32 s41, 24
  s_cselect_b32 s41, s41, s36
  s_min_u32 s41, s41, 127
  s_mul_i32 s38, s16, 2621440
  s_cmp_lt_u32 s41, 24
  s_cselect_b32 s38, s38, 0
  s_mul_i32 s36, s41, 20480
  s_add_u32 s38, s38, s36
  s_lshl_b32 s36, s17, 6
  s_add_u32 s38, s38, s36
  s_add_u32 s38, s38, 247463936
  s_add_u32 s33, s33, 3
  buffer_load_dwordx2 v[140:141], v160, s[20:23], s37 offen offset:0
  buffer_load_dwordx2 v[142:143], v160, s[20:23], s37 offen offset:32
  buffer_load_dwordx2 v[144:145], v160, s[20:23], s37 offen offset:256
  buffer_load_dwordx2 v[146:147], v160, s[20:23], s37 offen offset:288
  buffer_load_dwordx2 v[148:149], v160, s[20:23], s37 offen offset:512
  buffer_load_dwordx2 v[150:151], v160, s[20:23], s37 offen offset:544
  buffer_load_dwordx2 v[152:153], v160, s[20:23], s37 offen offset:768
  buffer_load_dwordx2 v[154:155], v160, s[20:23], s37 offen offset:800
  buffer_load_dwordx2 v[156:157], v160, s[20:23], s37 offen offset:1024
  buffer_load_dwordx2 v[158:159], v160, s[20:23], s37 offen offset:1056
  s_add_u32 s36, s40, 24
  s_cmp_lt_u32 s40, 24
  s_cselect_b32 s36, s39, s36
  s_add_u32 s40, s40, 3
  s_cmp_lt_u32 s40, 24
  s_cselect_b32 s40, s40, s36
  s_min_u32 s40, s40, 127
  s_mul_i32 s37, s40, 20480
  s_mul_i32 s36, s17, 5120
  s_add_u32 s37, s37, s36
  s_cmp_lt_u32 s33, 39
  s_cbranch_scc0 r_ln1e
  v_lshlrev_b32 v2, 16, v46
  v_and_b32 v3, 0xffff0000, v46
  v_lshlrev_b32 v4, 16, v47
  v_and_b32 v5, 0xffff0000, v47
  v_lshlrev_b32 v6, 16, v48
  v_and_b32 v7, 0xffff0000, v48
  v_lshlrev_b32 v8, 16, v49
  v_and_b32 v9, 0xffff0000, v49
  v_lshlrev_b32 v10, 16, v50
  v_and_b32 v11, 0xffff0000, v50
  v_lshlrev_b32 v12, 16, v51
  v_and_b32 v13, 0xffff0000, v51
  v_lshlrev_b32 v14, 16, v52
  v_and_b32 v15, 0xffff0000, v52
  v_lshlrev_b32 v16, 16, v53
  v_and_b32 v17, 0xffff0000, v53
  v_lshlrev_b32 v18, 16, v54
  v_and_b32 v19, 0xffff0000, v54
  v_lshlrev_b32 v20, 16, v55
  v_and_b32 v21, 0xffff0000, v55
  v_lshlrev_b32 v22, 16, v56
  v_and_b32 v23, 0xffff0000, v56
  v_lshlrev_b32 v24, 16, v57
  v_and_b32 v25, 0xffff0000, v57
  v_lshlrev_b32 v26, 16, v58
  v_and_b32 v27, 0xffff0000, v58
  v_lshlrev_b32 v28, 16, v59
  v_and_b32 v29, 0xffff0000, v59
  v_lshlrev_b32 v30, 16, v60
  v_and_b32 v31, 0xffff0000, v60
  v_lshlrev_b32 v32, 16, v61
  v_and_b32 v33, 0xffff0000, v61
  v_lshlrev_b32 v34, 16, v62
  v_and_b32 v35, 0xffff0000, v62
  v_lshlrev_b32 v36, 16, v63
  v_and_b32 v37, 0xffff0000, v63
  v_lshlrev_b32 v38, 16, v64
  v_and_b32 v39, 0xffff0000, v64
  v_lshlrev_b32 v40, 16, v65
  v_and_b32 v41, 0xffff0000, v65
  v_pk_add_f32 v[86:87], v[2:3], v[4:5]
  v_pk_add_f32 v[88:89], v[6:7], v[8:9]
  v_pk_add_f32 v[86:87], v[86:87], v[10:11]
  v_pk_add_f32 v[88:89], v[88:89], v[12:13]
  v_pk_add_f32 v[86:87], v[86:87], v[14:15]
  v_pk_add_f32 v[88:89], v[88:89], v[16:17]
  v_pk_add_f32 v[86:87], v[86:87], v[18:19]
  v_pk_add_f32 v[88:89], v[88:89], v[20:21]
  v_pk_add_f32 v[86:87], v[86:87], v[22:23]
  v_pk_add_f32 v[88:89], v[88:89], v[24:25]
  v_pk_add_f32 v[86:87], v[86:87], v[26:27]
  v_pk_add_f32 v[88:89], v[88:89], v[28:29]
  v_pk_add_f32 v[86:87], v[86:87], v[30:31]
  v_pk_add_f32 v[88:89], v[88:89], v[32:33]
  v_pk_add_f32 v[86:87], v[86:87], v[34:35]
  v_pk_add_f32 v[88:89], v[88:89], v[36:37]
  v_pk_add_f32 v[86:87], v[86:87], v[38:39]
  v_pk_add_f32 v[88:89], v[88:89], v[40:41]
  v_pk_add_f32 v[86:87], v[86:87], v[88:89]
  v_add_f32 v86, v86, v87
  s_nop 1
  v_add_f32_dpp v86, v86, v86 row_ror:8 row_mask:0xf bank_mask:0xf
  s_nop 1
  v_add_f32_dpp v86, v86, v86 row_ror:4 row_mask:0xf bank_mask:0xf
  v_mov_b32 v90, v86
  s_nop 1
  v_permlane16_swap_b32 v86, v90
  v_add_f32 v86, v86, v90
  v_mov_b32 v90, v86
  s_nop 1
  v_permlane32_swap_b32 v86, v90
  v_add_f32 v86, v86, v90
  v_mul_f32 v88, 0xbacccccd, v86
  v_mul_f32 v89, 0xbacccccd, v86
  v_pk_add_f32 v[164:165], v[2:3], v[88:89]
  v_pk_add_f32 v[166:167], v[4:5], v[88:89]
  v_pk_mul_f32 v[170:171], v[164:165], v[164:165]
  v_pk_add_f32 v[168:169], v[6:7], v[88:89]
  v_pk_mul_f32 v[86:87], v[166:167], v[166:167]
  v_pk_add_f32 v[164:165], v[8:9], v[88:89]
  v_pk_fma_f32 v[170:171], v[168:169], v[168:169], v[170:171]
  v_pk_add_f32 v[166:167], v[10:11], v[88:89]
  v_pk_fma_f32 v[86:87], v[164:165], v[164:165], v[86:87]
  v_pk_add_f32 v[168:169], v[12:13], v[88:89]
  v_pk_fma_f32 v[170:171], v[166:167], v[166:167], v[170:171]
  v_pk_add_f32 v[164:165], v[14:15], v[88:89]
  v_pk_fma_f32 v[86:87], v[168:169], v[168:169], v[86:87]
  v_pk_add_f32 v[166:167], v[16:17], v[88:89]
  v_pk_fma_f32 v[170:171], v[164:165], v[164:165], v[170:171]
  v_pk_add_f32 v[168:169], v[18:19], v[88:89]
  v_pk_fma_f32 v[86:87], v[166:167], v[166:167], v[86:87]
  v_pk_add_f32 v[164:165], v[20:21], v[88:89]
  v_pk_fma_f32 v[170:171], v[168:169], v[168:169], v[170:171]
  v_pk_add_f32 v[166:167], v[22:23], v[88:89]
  v_pk_fma_f32 v[86:87], v[164:165], v[164:165], v[86:87]
  v_pk_add_f32 v[168:169], v[24:25], v[88:89]
  v_pk_fma_f32 v[170:171], v[166:167], v[166:167], v[170:171]
  v_pk_add_f32 v[164:165], v[26:27], v[88:89]
  v_pk_fma_f32 v[86:87], v[168:169], v[168:169], v[86:87]
  v_pk_add_f32 v[166:167], v[28:29], v[88:89]
  v_pk_fma_f32 v[170:171], v[164:165], v[164:165], v[170:171]
  v_pk_add_f32 v[168:169], v[30:31], v[88:89]
  v_pk_fma_f32 v[86:87], v[166:167], v[166:167], v[86:87]
  v_pk_add_f32 v[164:165], v[32:33], v[88:89]
  v_pk_fma_f32 v[170:171], v[168:169], v[168:169], v[170:171]
  v_pk_add_f32 v[166:167], v[34:35], v[88:89]
  v_pk_fma_f32 v[86:87], v[164:165], v[164:165], v[86:87]
  v_pk_add_f32 v[168:169], v[36:37], v[88:89]
  v_pk_fma_f32 v[170:171], v[166:167], v[166:167], v[170:171]
  v_pk_add_f32 v[164:165], v[38:39], v[88:89]
  v_pk_fma_f32 v[86:87], v[168:169], v[168:169], v[86:87]
  v_pk_add_f32 v[166:167], v[40:41], v[88:89]
  v_pk_fma_f32 v[170:171], v[164:165], v[164:165], v[170:171]
  v_pk_fma_f32 v[86:87], v[166:167], v[166:167], v[86:87]
  v_cvt_pk_bf16_f32 v91, v88, v89
  v_lshlrev_b32 v88, 16, v91
  v_and_b32 v89, 0xffff0000, v91
  v_pk_add_f32 v[86:87], v[86:87], v[170:171]
  v_add_f32 v86, v86, v87
  s_nop 1
  v_add_f32_dpp v86, v86, v86 row_ror:8 row_mask:0xf bank_mask:0xf
  s_nop 1
  v_add_f32_dpp v86, v86, v86 row_ror:4 row_mask:0xf bank_mask:0xf
  v_mov_b32 v90, v86
  s_nop 1
  v_permlane16_swap_b32 v86, v90
  v_add_f32 v86, v86, v90
  v_mov_b32 v90, v86
  s_nop 1
  v_permlane32_swap_b32 v86, v90
  v_add_f32 v86, v86, v90
  v_pk_add_f32 v[2:3], v[2:3], v[88:89]
  v_mul_f32 v86, 0x3acccccd, v86
  v_pk_add_f32 v[4:5], v[4:5], v[88:89]
  v_cvt_pk_bf16_f32 v86, v86, v86
  v_pk_add_f32 v[6:7], v[6:7], v[88:89]
  v_lshlrev_b32 v86, 16, v86
  v_pk_add_f32 v[8:9], v[8:9], v[88:89]
  v_add_f32 v86, 0x3727c5ac, v86
  v_pk_add_f32 v[10:11], v[10:11], v[88:89]
  v_cvt_pk_bf16_f32 v86, v86, v86
  v_pk_add_f32 v[12:13], v[12:13], v[88:89]
  v_lshlrev_b32 v86, 16, v86
  v_pk_add_f32 v[14:15], v[14:15], v[88:89]
  v_sqrt_f32 v86, v86
  v_pk_add_f32 v[16:17], v[16:17], v[88:89]
  v_cvt_pk_bf16_f32 v86, v86, v86
  v_pk_add_f32 v[18:19], v[18:19], v[88:89]
  v_lshlrev_b32 v86, 16, v86
  v_pk_add_f32 v[20:21], v[20:21], v[88:89]
  v_rcp_f32 v86, v86
  v_pk_add_f32 v[22:23], v[22:23], v[88:89]
  v_mov_b32 v87, v86
  v_pk_add_f32 v[24:25], v[24:25], v[88:89]
  v_pk_add_f32 v[26:27], v[26:27], v[88:89]
  v_pk_add_f32 v[28:29], v[28:29], v[88:89]
  v_pk_add_f32 v[30:31], v[30:31], v[88:89]
  v_pk_add_f32 v[32:33], v[32:33], v[88:89]
  v_pk_add_f32 v[34:35], v[34:35], v[88:89]
  v_pk_add_f32 v[36:37], v[36:37], v[88:89]
  v_pk_add_f32 v[38:39], v[38:39], v[88:89]
  v_pk_add_f32 v[40:41], v[40:41], v[88:89]
  v_cvt_pk_bf16_f32 v164, v2, v3
  v_lshlrev_b32 v2, 16, v164
  v_and_b32 v3, 0xffff0000, v164
  v_cvt_pk_bf16_f32 v165, v4, v5
  v_lshlrev_b32 v4, 16, v165
  v_and_b32 v5, 0xffff0000, v165
  v_cvt_pk_bf16_f32 v166, v6, v7
  v_lshlrev_b32 v6, 16, v166
  v_and_b32 v7, 0xffff0000, v166
  v_cvt_pk_bf16_f32 v167, v8, v9
  v_lshlrev_b32 v8, 16, v167
  v_and_b32 v9, 0xffff0000, v167
  v_cvt_pk_bf16_f32 v164, v10, v11
  v_lshlrev_b32 v10, 16, v164
  v_and_b32 v11, 0xffff0000, v164
  v_cvt_pk_bf16_f32 v165, v12, v13
  v_lshlrev_b32 v12, 16, v165
  v_and_b32 v13, 0xffff0000, v165
  v_cvt_pk_bf16_f32 v166, v14, v15
  v_lshlrev_b32 v14, 16, v166
  v_and_b32 v15, 0xffff0000, v166
  v_cvt_pk_bf16_f32 v167, v16, v17
  v_lshlrev_b32 v16, 16, v167
  v_and_b32 v17, 0xffff0000, v167
  v_cvt_pk_bf16_f32 v164, v18, v19
  v_lshlrev_b32 v18, 16, v164
  v_and_b32 v19, 0xffff0000, v164
  v_cvt_pk_bf16_f32 v165, v20, v21
  v_lshlrev_b32 v20, 16, v165
  v_and_b32 v21, 0xffff0000, v165
  v_cvt_pk_bf16_f32 v166, v22, v23
  v_lshlrev_b32 v22, 16, v166
  v_and_b32 v23, 0xffff0000, v166
  v_cvt_pk_bf16_f32 v167, v24, v25
  v_lshlrev_b32 v24, 16, v167
  v_and_b32 v25, 0xffff0000, v167
  v_cvt_pk_bf16_f32 v164, v26, v27
  v_lshlrev_b32 v26, 16, v164
  v_and_b32 v27, 0xffff0000, v164
  v_cvt_pk_bf16_f32 v165, v28, v29
  v_lshlrev_b32 v28, 16, v165
  v_and_b32 v29, 0xffff0000, v165
  v_cvt_pk_bf16_f32 v166, v30, v31
  v_lshlrev_b32 v30, 16, v166
  v_and_b32 v31, 0xffff0000, v166
  v_cvt_pk_bf16_f32 v167, v32, v33
  v_lshlrev_b32 v32, 16, v167
  v_and_b32 v33, 0xffff0000, v167
  v_cvt_pk_bf16_f32 v164, v34, v35
  v_lshlrev_b32 v34, 16, v164
  v_and_b32 v35, 0xffff0000, v164
  v_cvt_pk_bf16_f32 v165, v36, v37
  v_lshlrev_b32 v36, 16, v165
  v_and_b32 v37, 0xffff0000, v165
  v_cvt_pk_bf16_f32 v166, v38, v39
  v_lshlrev_b32 v38, 16, v166
  v_and_b32 v39, 0xffff0000, v166
  v_cvt_pk_bf16_f32 v167, v40, v41
  v_lshlrev_b32 v40, 16, v167
  v_and_b32 v41, 0xffff0000, v167
  s_sub_u32 s36, s33, 0
  s_min_u32 s36, s36, 24
  v_mov_b32 v92, s36
  s_waitcnt vmcnt(10)
  buffer_store_dword v92, v228, s[8:11], 0 offen
  v_pk_mul_f32 v[2:3], v[2:3], v[86:87]
  v_pk_mul_f32 v[4:5], v[4:5], v[86:87]
  v_pk_mul_f32 v[6:7], v[6:7], v[86:87]
  v_pk_mul_f32 v[8:9], v[8:9], v[86:87]
  v_pk_mul_f32 v[10:11], v[10:11], v[86:87]
  v_pk_mul_f32 v[12:13], v[12:13], v[86:87]
  v_pk_mul_f32 v[14:15], v[14:15], v[86:87]
  v_pk_mul_f32 v[16:17], v[16:17], v[86:87]
  v_pk_mul_f32 v[18:19], v[18:19], v[86:87]
  v_pk_mul_f32 v[20:21], v[20:21], v[86:87]
  v_pk_mul_f32 v[22:23], v[22:23], v[86:87]
  v_pk_mul_f32 v[24:25], v[24:25], v[86:87]
  v_pk_mul_f32 v[26:27], v[26:27], v[86:87]
  v_pk_mul_f32 v[28:29], v[28:29], v[86:87]
  v_pk_mul_f32 v[30:31], v[30:31], v[86:87]
  v_pk_mul_f32 v[32:33], v[32:33], v[86:87]
  v_pk_mul_f32 v[34:35], v[34:35], v[86:87]
  v_pk_mul_f32 v[36:37], v[36:37], v[86:87]
  v_pk_mul_f32 v[38:39], v[38:39], v[86:87]
  v_pk_mul_f32 v[40:41], v[40:41], v[86:87]
  v_cvt_pk_bf16_f32 v164, v2, v3
  v_lshlrev_b32 v2, 16, v164
  v_and_b32 v3, 0xffff0000, v164
  v_cvt_pk_bf16_f32 v165, v4, v5
  v_lshlrev_b32 v4, 16, v165
  v_and_b32 v5, 0xffff0000, v165
  v_cvt_pk_bf16_f32 v166, v6, v7
  v_lshlrev_b32 v6, 16, v166
  v_and_b32 v7, 0xffff0000, v166
  v_cvt_pk_bf16_f32 v167, v8, v9
  v_lshlrev_b32 v8, 16, v167
  v_and_b32 v9, 0xffff0000, v167
  v_cvt_pk_bf16_f32 v164, v10, v11
  v_lshlrev_b32 v10, 16, v164
  v_and_b32 v11, 0xffff0000, v164
  v_cvt_pk_bf16_f32 v165, v12, v13
  v_lshlrev_b32 v12, 16, v165
  v_and_b32 v13, 0xffff0000, v165
  v_cvt_pk_bf16_f32 v166, v14, v15
  v_lshlrev_b32 v14, 16, v166
  v_and_b32 v15, 0xffff0000, v166
  v_cvt_pk_bf16_f32 v167, v16, v17
  v_lshlrev_b32 v16, 16, v167
  v_and_b32 v17, 0xffff0000, v167
  v_cvt_pk_bf16_f32 v164, v18, v19
  v_lshlrev_b32 v18, 16, v164
  v_and_b32 v19, 0xffff0000, v164
  v_cvt_pk_bf16_f32 v165, v20, v21
  v_lshlrev_b32 v20, 16, v165
  v_and_b32 v21, 0xffff0000, v165
  v_cvt_pk_bf16_f32 v166, v22, v23
  v_lshlrev_b32 v22, 16, v166
  v_and_b32 v23, 0xffff0000, v166
  v_cvt_pk_bf16_f32 v167, v24, v25
  v_lshlrev_b32 v24, 16, v167
  v_and_b32 v25, 0xffff0000, v167
  v_cvt_pk_bf16_f32 v164, v26, v27
  v_lshlrev_b32 v26, 16, v164
  v_and_b32 v27, 0xffff0000, v164
  v_cvt_pk_bf16_f32 v165, v28, v29
  v_lshlrev_b32 v28, 16, v165
  v_and_b32 v29, 0xffff0000, v165
  v_cvt_pk_bf16_f32 v166, v30, v31
  v_lshlrev_b32 v30, 16, v166
  v_and_b32 v31, 0xffff0000, v166
  v_cvt_pk_bf16_f32 v167, v32, v33
  v_lshlrev_b32 v32, 16, v167
  v_and_b32 v33, 0xffff0000, v167
  v_cvt_pk_bf16_f32 v164, v34, v35
  v_lshlrev_b32 v34, 16, v164
  v_and_b32 v35, 0xffff0000, v164
  v_cvt_pk_bf16_f32 v165, v36, v37
  v_lshlrev_b32 v36, 16, v165
  v_and_b32 v37, 0xffff0000, v165
  v_cvt_pk_bf16_f32 v166, v38, v39
  v_lshlrev_b32 v38, 16, v166
  v_and_b32 v39, 0xffff0000, v166
  v_cvt_pk_bf16_f32 v167, v40, v41
  v_lshlrev_b32 v40, 16, v167
  v_and_b32 v41, 0xffff0000, v167
  v_mul_f32_dpp v2, v176, v2 quad_perm:[2,2,2,2] row_mask:0xf bank_mask:0xf
  v_mul_f32_dpp v3, v177, v3 quad_perm:[2,2,2,2] row_mask:0xf bank_mask:0xf
  v_mul_f32_dpp v4, v178, v4 quad_perm:[2,2,2,2] row_mask:0xf bank_mask:0xf
  v_mul_f32_dpp v5, v179, v5 quad_perm:[2,2,2,2] row_mask:0xf bank_mask:0xf
  v_mul_f32_dpp v6, v176, v6 quad_perm:[3,3,3,3] row_mask:0xf bank_mask:0xf
  v_mul_f32_dpp v7, v177, v7 quad_perm:[3,3,3,3] row_mask:0xf bank_mask:0xf
  v_mul_f32_dpp v8, v178, v8 quad_perm:[3,3,3,3] row_mask:0xf bank_mask:0xf
  v_mul_f32_dpp v9, v179, v9 quad_perm:[3,3,3,3] row_mask:0xf bank_mask:0xf
  v_cvt_pk_bf16_f32 v164, v2, v3
  v_lshlrev_b32 v2, 16, v164
  v_and_b32 v3, 0xffff0000, v164
  v_cvt_pk_bf16_f32 v165, v4, v5
  v_lshlrev_b32 v4, 16, v165
  v_and_b32 v5, 0xffff0000, v165
  v_cvt_pk_bf16_f32 v166, v6, v7
  v_lshlrev_b32 v6, 16, v166
  v_and_b32 v7, 0xffff0000, v166
  v_cvt_pk_bf16_f32 v167, v8, v9
  v_lshlrev_b32 v8, 16, v167
  v_and_b32 v9, 0xffff0000, v167
  v_add_f32_dpp v2, v176, v2 quad_perm:[0,0,0,0] row_mask:0xf bank_mask:0xf
  v_add_f32_dpp v3, v177, v3 quad_perm:[0,0,0,0] row_mask:0xf bank_mask:0xf
  v_add_f32_dpp v4, v178, v4 quad_perm:[0,0,0,0] row_mask:0xf bank_mask:0xf
  v_add_f32_dpp v5, v179, v5 quad_perm:[0,0,0,0] row_mask:0xf bank_mask:0xf
  v_add_f32_dpp v6, v176, v6 quad_perm:[1,1,1,1] row_mask:0xf bank_mask:0xf
  v_add_f32_dpp v7, v177, v7 quad_perm:[1,1,1,1] row_mask:0xf bank_mask:0xf
  v_add_f32_dpp v8, v178, v8 quad_perm:[1,1,1,1] row_mask:0xf bank_mask:0xf
  v_add_f32_dpp v9, v179, v9 quad_perm:[1,1,1,1] row_mask:0xf bank_mask:0xf
  v_cvt_pk_bf16_f32 v196, v2, v3
  v_cvt_pk_bf16_f32 v197, v4, v5
  v_cvt_pk_bf16_f32 v198, v6, v7
  v_cvt_pk_bf16_f32 v199, v8, v9
  s_add_u32 s35, s38, 0
  buffer_store_dwordx4 v[196:199], v161, s[8:11], s35 offen sc1
  v_mul_f32_dpp v10, v180, v10 quad_perm:[2,2,2,2] row_mask:0xf bank_mask:0xf
  v_mul_f32_dpp v11, v181, v11 quad_perm:[2,2,2,2] row_mask:0xf bank_mask:0xf
  v_mul_f32_dpp v12, v182, v12 quad_perm:[2,2,2,2] row_mask:0xf bank_mask:0xf
  v_mul_f32_dpp v13, v183, v13 quad_perm:[2,2,2,2] row_mask:0xf bank_mask:0xf
  v_mul_f32_dpp v14, v180, v14 quad_perm:[3,3,3,3] row_mask:0xf bank_mask:0xf
  v_mul_f32_dpp v15, v181, v15 quad_perm:[3,3,3,3] row_mask:0xf bank_mask:0xf
  v_mul_f32_dpp v16, v182, v16 quad_perm:[3,3,3,3] row_mask:0xf bank_mask:0xf
  v_mul_f32_dpp v17, v183, v17 quad_perm:[3,3,3,3] row_mask:0xf bank_mask:0xf
  v_cvt_pk_bf16_f32 v164, v10, v11
  v_lshlrev_b32 v10, 16, v164
  v_and_b32 v11, 0xffff0000, v164
  v_cvt_pk_bf16_f32 v165, v12, v13
  v_lshlrev_b32 v12, 16, v165
  v_and_b32 v13, 0xffff0000, v165
  v_cvt_pk_bf16_f32 v166, v14, v15
  v_lshlrev_b32 v14, 16, v166
  v_and_b32 v15, 0xffff0000, v166
  v_cvt_pk_bf16_f32 v167, v16, v17
  v_lshlrev_b32 v16, 16, v167
  v_and_b32 v17, 0xffff0000, v167
  v_add_f32_dpp v10, v180, v10 quad_perm:[0,0,0,0] row_mask:0xf bank_mask:0xf
  v_add_f32_dpp v11, v181, v11 quad_perm:[0,0,0,0] row_mask:0xf bank_mask:0xf
  v_add_f32_dpp v12, v182, v12 quad_perm:[0,0,0,0] row_mask:0xf bank_mask:0xf
  v_add_f32_dpp v13, v183, v13 quad_perm:[0,0,0,0] row_mask:0xf bank_mask:0xf
  v_add_f32_dpp v14, v180, v14 quad_perm:[1,1,1,1] row_mask:0xf bank_mask:0xf
  v_add_f32_dpp v15, v181, v15 quad_perm:[1,1,1,1] row_mask:0xf bank_mask:0xf
  v_add_f32_dpp v16, v182, v16 quad_perm:[1,1,1,1] row_mask:0xf bank_mask:0xf
  v_add_f32_dpp v17, v183, v17 quad_perm:[1,1,1,1] row_mask:0xf bank_mask:0xf
  v_cvt_pk_bf16_f32 v200, v10, v11
  v_cvt_pk_bf16_f32 v201, v12, v13
  v_cvt_pk_bf16_f32 v202, v14, v15
  v_cvt_pk_bf16_f32 v203, v16, v17
  s_add_u32 s35, s38, 4096
  buffer_store_dwordx4 v[200:203], v161, s[8:11], s35 offen sc1
  v_mul_f32_dpp v18, v184, v18 quad_perm:[2,2,2,2] row_mask:0xf bank_mask:0xf
  v_mul_f32_dpp v19, v185, v19 quad_perm:[2,2,2,2] row_mask:0xf bank_mask:0xf
  v_mul_f32_dpp v20, v186, v20 quad_perm:[2,2,2,2] row_mask:0xf bank_mask:0xf
  v_mul_f32_dpp v21, v187, v21 quad_perm:[2,2,2,2] row_mask:0xf bank_mask:0xf
  v_mul_f32_dpp v22, v184, v22 quad_perm:[3,3,3,3] row_mask:0xf bank_mask:0xf
  v_mul_f32_dpp v23, v185, v23 quad_perm:[3,3,3,3] row_mask:0xf bank_mask:0xf
  v_mul_f32_dpp v24, v186, v24 quad_perm:[3,3,3,3] row_mask:0xf bank_mask:0xf
  v_mul_f32_dpp v25, v187, v25 quad_perm:[3,3,3,3] row_mask:0xf bank_mask:0xf
  v_cvt_pk_bf16_f32 v164, v18, v19
  v_lshlrev_b32 v18, 16, v164
  v_and_b32 v19, 0xffff0000, v164
  v_cvt_pk_bf16_f32 v165, v20, v21
  v_lshlrev_b32 v20, 16, v165
  v_and_b32 v21, 0xffff0000, v165
  v_cvt_pk_bf16_f32 v166, v22, v23
  v_lshlrev_b32 v22, 16, v166
  v_and_b32 v23, 0xffff0000, v166
  v_cvt_pk_bf16_f32 v167, v24, v25
  v_lshlrev_b32 v24, 16, v167
  v_and_b32 v25, 0xffff0000, v167
  v_add_f32_dpp v18, v184, v18 quad_perm:[0,0,0,0] row_mask:0xf bank_mask:0xf
  v_add_f32_dpp v19, v185, v19 quad_perm:[0,0,0,0] row_mask:0xf bank_mask:0xf
  v_add_f32_dpp v20, v186, v20 quad_perm:[0,0,0,0] row_mask:0xf bank_mask:0xf
  v_add_f32_dpp v21, v187, v21 quad_perm:[0,0,0,0] row_mask:0xf bank_mask:0xf
  v_add_f32_dpp v22, v184, v22 quad_perm:[1,1,1,1] row_mask:0xf bank_mask:0xf
  v_add_f32_dpp v23, v185, v23 quad_perm:[1,1,1,1] row_mask:0xf bank_mask:0xf
  v_add_f32_dpp v24, v186, v24 quad_perm:[1,1,1,1] row_mask:0xf bank_mask:0xf
  v_add_f32_dpp v25, v187, v25 quad_perm:[1,1,1,1] row_mask:0xf bank_mask:0xf
  v_cvt_pk_bf16_f32 v204, v18, v19
  v_cvt_pk_bf16_f32 v205, v20, v21
  v_cvt_pk_bf16_f32 v206, v22, v23
  v_cvt_pk_bf16_f32 v207, v24, v25
  s_add_u32 s35, s38, 8192
  buffer_store_dwordx4 v[204:207], v161, s[8:11], s35 offen sc1
  v_mul_f32_dpp v26, v188, v26 quad_perm:[2,2,2,2] row_mask:0xf bank_mask:0xf
  v_mul_f32_dpp v27, v189, v27 quad_perm:[2,2,2,2] row_mask:0xf bank_mask:0xf
  v_mul_f32_dpp v28, v190, v28 quad_perm:[2,2,2,2] row_mask:0xf bank_mask:0xf
  v_mul_f32_dpp v29, v191, v29 quad_perm:[2,2,2,2] row_mask:0xf bank_mask:0xf
  v_mul_f32_dpp v30, v188, v30 quad_perm:[3,3,3,3] row_mask:0xf bank_mask:0xf
  v_mul_f32_dpp v31, v189, v31 quad_perm:[3,3,3,3] row_mask:0xf bank_mask:0xf
  v_mul_f32_dpp v32, v190, v32 quad_perm:[3,3,3,3] row_mask:0xf bank_mask:0xf
  v_mul_f32_dpp v33, v191, v33 quad_perm:[3,3,3,3] row_mask:0xf bank_mask:0xf
  v_cvt_pk_bf16_f32 v164, v26, v27
  v_lshlrev_b32 v26, 16, v164
  v_and_b32 v27, 0xffff0000, v164
  v_cvt_pk_bf16_f32 v165, v28, v29
  v_lshlrev_b32 v28, 16, v165
  v_and_b32 v29, 0xffff0000, v165
  v_cvt_pk_bf16_f32 v166, v30, v31
  v_lshlrev_b32 v30, 16, v166
  v_and_b32 v31, 0xffff0000, v166
  v_cvt_pk_bf16_f32 v167, v32, v33
  v_lshlrev_b32 v32, 16, v167
  v_and_b32 v33, 0xffff0000, v167
  v_add_f32_dpp v26, v188, v26 quad_perm:[0,0,0,0] row_mask:0xf bank_mask:0xf
  v_add_f32_dpp v27, v189, v27 quad_perm:[0,0,0,0] row_mask:0xf bank_mask:0xf
  v_add_f32_dpp v28, v190, v28 quad_perm:[0,0,0,0] row_mask:0xf bank_mask:0xf
  v_add_f32_dpp v29, v191, v29 quad_perm:[0,0,0,0] row_mask:0xf bank_mask:0xf
  v_add_f32_dpp v30, v188, v30 quad_perm:[1,1,1,1] row_mask:0xf bank_mask:0xf
  v_add_f32_dpp v31, v189, v31 quad_perm:[1,1,1,1] row_mask:0xf bank_mask:0xf
  v_add_f32_dpp v32, v190, v32 quad_perm:[1,1,1,1] row_mask:0xf bank_mask:0xf
  v_add_f32_dpp v33, v191, v33 quad_perm:[1,1,1,1] row_mask:0xf bank_mask:0xf
  v_cvt_pk_bf16_f32 v208, v26, v27
  v_cvt_pk_bf16_f32 v209, v28, v29
  v_cvt_pk_bf16_f32 v210, v30, v31
  v_cvt_pk_bf16_f32 v211, v32, v33
  s_add_u32 s35, s38, 12288
  buffer_store_dwordx4 v[208:211], v161, s[8:11], s35 offen sc1
  v_mul_f32_dpp v34, v192, v34 quad_perm:[2,2,2,2] row_mask:0xf bank_mask:0xf
  v_mul_f32_dpp v35, v193, v35 quad_perm:[2,2,2,2] row_mask:0xf bank_mask:0xf
  v_mul_f32_dpp v36, v194, v36 quad_perm:[2,2,2,2] row_mask:0xf bank_mask:0xf
  v_mul_f32_dpp v37, v195, v37 quad_perm:[2,2,2,2] row_mask:0xf bank_mask:0xf
  v_mul_f32_dpp v38, v192, v38 quad_perm:[3,3,3,3] row_mask:0xf bank_mask:0xf
  v_mul_f32_dpp v39, v193, v39 quad_perm:[3,3,3,3] row_mask:0xf bank_mask:0xf
  v_mul_f32_dpp v40, v194, v40 quad_perm:[3,3,3,3] row_mask:0xf bank_mask:0xf
  v_mul_f32_dpp v41, v195, v41 quad_perm:[3,3,3,3] row_mask:0xf bank_mask:0xf
  v_cvt_pk_bf16_f32 v164, v34, v35
  v_lshlrev_b32 v34, 16, v164
  v_and_b32 v35, 0xffff0000, v164
  v_cvt_pk_bf16_f32 v165, v36, v37
  v_lshlrev_b32 v36, 16, v165
  v_and_b32 v37, 0xffff0000, v165
  v_cvt_pk_bf16_f32 v166, v38, v39
  v_lshlrev_b32 v38, 16, v166
  v_and_b32 v39, 0xffff0000, v166
  v_cvt_pk_bf16_f32 v167, v40, v41
  v_lshlrev_b32 v40, 16, v167
  v_and_b32 v41, 0xffff0000, v167
  v_add_f32_dpp v34, v192, v34 quad_perm:[0,0,0,0] row_mask:0xf bank_mask:0xf
  v_add_f32_dpp v35, v193, v35 quad_perm:[0,0,0,0] row_mask:0xf bank_mask:0xf
  v_add_f32_dpp v36, v194, v36 quad_perm:[0,0,0,0] row_mask:0xf bank_mask:0xf
  v_add_f32_dpp v37, v195, v37 quad_perm:[0,0,0,0] row_mask:0xf bank_mask:0xf
  v_add_f32_dpp v38, v192, v38 quad_perm:[1,1,1,1] row_mask:0xf bank_mask:0xf
  v_add_f32_dpp v39, v193, v39 quad_perm:[1,1,1,1] row_mask:0xf bank_mask:0xf
  v_add_f32_dpp v40, v194, v40 quad_perm:[1,1,1,1] row_mask:0xf bank_mask:0xf
  v_add_f32_dpp v41, v195, v41 quad_perm:[1,1,1,1] row_mask:0xf bank_mask:0xf
  v_cvt_pk_bf16_f32 v212, v34, v35
  v_cvt_pk_bf16_f32 v213, v36, v37
  v_cvt_pk_bf16_f32 v214, v38, v39
  v_cvt_pk_bf16_f32 v215, v40, v41
  s_add_u32 s35, s38, 16384
  buffer_store_dwordx4 v[212:215], v161, s[8:11], s35 offen sc1
  s_add_u32 s36, s41, 24
  s_cmp_lt_u32 s41, 24
  s_cselect_b32 s36, s39, s36
  s_add_u32 s41, s41, 3
  s_cmp_lt_u32 s41, 24
  s_cselect_b32 s41, s41, s36
  s_min_u32 s41, s41, 127
  s_mul_i32 s38, s16, 2621440
  s_cmp_lt_u32 s41, 24
  s_cselect_b32 s38, s38, 0
  s_mul_i32 s36, s41, 20480
  s_add_u32 s38, s38, s36
  s_lshl_b32 s36, s17, 6
  s_add_u32 s38, s38, s36
  s_add_u32 s38, s38, 247463936
  s_add_u32 s33, s33, 3
  buffer_load_dwordx2 v[46:47], v160, s[20:23], s37 offen offset:0
  buffer_load_dwordx2 v[48:49], v160, s[20:23], s37 offen offset:32
  buffer_load_dwordx2 v[50:51], v160, s[20:23], s37 offen offset:256
  buffer_load_dwordx2 v[52:53], v160, s[20:23], s37 offen offset:288
  buffer_load_dwordx2 v[54:55], v160, s[20:23], s37 offen offset:512
  buffer_load_dwordx2 v[56:57], v160, s[20:23], s37 offen offset:544
  buffer_load_dwordx2 v[58:59], v160, s[20:23], s37 offen offset:768
  buffer_load_dwordx2 v[60:61], v160, s[20:23], s37 offen offset:800
  buffer_load_dwordx2 v[62:63], v160, s[20:23], s37 offen offset:1024
  buffer_load_dwordx2 v[64:65], v160, s[20:23], s37 offen offset:1056
  s_add_u32 s36, s40, 24
  s_cmp_lt_u32 s40, 24
  s_cselect_b32 s36, s39, s36
  s_add_u32 s40, s40, 3
  s_cmp_lt_u32 s40, 24
  s_cselect_b32 s40, s40, s36
  s_min_u32 s40, s40, 127
  s_mul_i32 s37, s40, 20480
  s_mul_i32 s36, s17, 5120
  s_add_u32 s37, s37, s36
  s_cmp_lt_u32 s33, 39
  s_cbranch_scc1 r_ln1
r_ln1e:
  s_waitcnt vmcnt(0)
  s_barrier
  s_cmp_lg_u32 s17, 0
  s_cbranch_scc1 r_h1
  v_mov_b32 v90, 204
  v_mov_b32 v91, 1
  s_waitcnt vmcnt(0)
  s_mov_b64 exec, 1
  buffer_atomic_add v91, v90, s[12:15], 0 offen sc1
  s_mov_b64 exec, -1
  s_cmp_lg_u32 s54, 0
  s_cbranch_scc1 r_h1
  v_mov_b32 v90, 204
  s_mov_b32 s34, 0
gw_12:
  buffer_load_dword v91, v90, s[12:15], 0 offen sc1
  s_add_u32 s34, s34, 1
  s_cmp_gt_u32 s34, 65536
  s_cbranch_scc1 role_abort
  s_waitcnt vmcnt(0)
  v_cmp_gt_u32 vcc, 24, v91
  s_cbranch_vccz gk_13
  s_sleep 8
  s_branch gw_12
gk_13:
  v_add_u32 v90, v228, v226
  v_mov_b32 v91, 128
  s_mov_b64 exec, 0xfff
  buffer_store_dword v91, v90, s[8:11], 0 offen
  s_mov_b64 exec, -1
r_h1:
  s_add_u32 s52, s52, 20
r_mod2:
  v_lshlrev_b32 v12, 2, v0
  buffer_load_dword v13, v12, s[44:47], 0 offen
  buffer_load_dword v14, v12, s[44:47], 0 offen offset:1024
  v_lshrrev_b32 v20, 3, v0
  v_and_b32 v21, 7, v0
  v_mul_u32_u24 v22, 153600, v20
  v_lshl_add_u32 v22, v21, 4, v22
  s_lshl_b32 s6, s52, 7
  buffer_load_dwordx4 v[28:31], v22, s[48:51], s6 offen nt
  s_add_u32 s6, s6, 7680
  buffer_load_dwordx4 v[32:35], v22, s[48:51], s6 offen nt
  s_add_u32 s6, s6, 7680
  buffer_load_dwordx4 v[36:39], v22, s[48:51], s6 offen nt
  s_add_u32 s6, s6, 7680
  buffer_load_dwordx4 v[40:43], v22, s[48:51], s6 offen nt
  s_add_u32 s6, s6, 7680
  buffer_load_dwordx4 v[44:47], v22, s[48:51], s6 offen nt
  s_add_u32 s6, s6, 7680
  buffer_load_dwordx4 v[48:51], v22, s[48:51], s6 offen nt
  s_add_u32 s6, s6, 7680
  buffer_load_dwordx4 v[52:55], v22, s[48:51], s6 offen nt
  s_add_u32 s6, s6, 7680
  buffer_load_dwordx4 v[56:59], v22, s[48:51], s6 offen nt
  s_add_u32 s6, s6, 7680
  buffer_load_dwordx4 v[60:63], v22, s[48:51], s6 offen nt
  s_add_u32 s6, s6, 7680
  buffer_load_dwordx4 v[64:67], v22, s[48:51], s6 offen nt
  s_add_u32 s6, s6, 7680
  buffer_load_dwordx4 v[68:71], v22, s[48:51], s6 offen nt
  s_add_u32 s6, s6, 7680
  buffer_load_dwordx4 v[72:75], v22, s[48:51], s6 offen nt
  s_add_u32 s6, s6, 7680
  buffer_load_dwordx4 v[76:79], v22, s[48:51], s6 offen nt
  s_add_u32 s6, s6, 7680
  buffer_load_dwordx4 v[80:83], v22, s[48:51], s6 offen nt
  s_add_u32 s6, s6, 7680
  buffer_load_dwordx4 v[84:87], v22, s[48:51], s6 offen nt
  s_add_u32 s6, s6, 7680
  buffer_load_dwordx4 v[88:91], v22, s[48:51], s6 offen nt
  s_add_u32 s6, s6, 7680
  buffer_load_dwordx4 v[92:95], v22, s[48:51], s6 offen nt
  s_add_u32 s6, s6, 7680
  buffer_load_dwordx4 v[96:99], v22, s[48:51], s6 offen nt
  s_add_u32 s6, s6, 7680
  buffer_load_dwordx4 v[100:103], v22, s[48:51], s6 offen nt
  s_add_u32 s6, s6, 7680
  buffer_load_dwordx4 v[104:107], v22, s[48:51], s6 offen nt
  s_add_u32 s6, s6, 7680
  s_waitcnt vmcnt(20)
  v_lshlrev_b32 v24, 16, v13
  v_and_b32 v25, 0xffff0000, v13
  v_mul_f32 v16, 0xbfb8aa3b, v24
  v_mul_f32 v17, 0xbfb8aa3b, v25
  v_exp_f32 v16, v16
  v_exp_f32 v17, v17
  v_add_f32 v16, 1.0, v16
  v_add_f32 v17, 1.0, v17
  v_rcp_f32 v16, v16
  v_rcp_f32 v17, v17
  v_mul_f32 v24, v24, v16
  v_mul_f32 v25, v25, v17
  v_cvt_pk_bf16_f32 v16, v24, v25
  v_lshlrev_b32 v24, 16, v16
  v_and_b32 v25, 0xffff0000, v16
  v_lshlrev_b32 v26, 16, v14
  v_and_b32 v27, 0xffff0000, v14
  v_mul_f32 v16, 0xbfb8aa3b, v26
  v_mul_f32 v17, 0xbfb8aa3b, v27
  v_exp_f32 v16, v16
  v_exp_f32 v17, v17
  v_add_f32 v16, 1.0, v16
  v_add_f32 v17, 1.0, v17
  v_rcp_f32 v16, v16
  v_rcp_f32 v17, v17
  v_mul_f32 v26, v26, v16
  v_mul_f32 v27, v27, v17
  v_cvt_pk_bf16_f32 v16, v26, v27
  v_lshlrev_b32 v26, 16, v16
  v_and_b32 v27, 0xffff0000, v16
  v_lshlrev_b32 v12, 3, v0
  ds_write_b64 v12, v[24:25]
  ds_write_b64 v12, v[26:27] offset:2048
  v_mul_u32_u24 v12, 80, v20
  s_waitcnt lgkmcnt(0)
  s_barrier
  ds_read_b128 v[108:111], v12 offset:0
  ds_read_b128 v[112:115], v12 offset:16
  ds_read_b128 v[116:119], v12 offset:32
  ds_read_b128 v[120:123], v12 offset:48
  ds_read_b128 v[124:127], v12 offset:64
  v_mov_b32 v148, 0
  v_mov_b32 v149, 0
  v_mov_b32 v150, 0
  v_mov_b32 v151, 0
  v_mov_b32 v152, 0
  v_mov_b32 v153, 0
  v_mov_b32 v154, 0
  v_mov_b32 v155, 0
  s_waitcnt lgkmcnt(0)
  v_lshrrev_b32 v128, 16, v108
  v_lshrrev_b32 v129, 16, v109
  v_lshrrev_b32 v130, 16, v110
  v_lshrrev_b32 v131, 16, v111
  v_lshrrev_b32 v132, 16, v112
  v_lshrrev_b32 v133, 16, v113
  v_lshrrev_b32 v134, 16, v114
  v_lshrrev_b32 v135, 16, v115
  v_lshrrev_b32 v136, 16, v116
  v_lshrrev_b32 v137, 16, v117
  v_lshrrev_b32 v138, 16, v118
  v_lshrrev_b32 v139, 16, v119
  v_lshrrev_b32 v140, 16, v120
  v_lshrrev_b32 v141, 16, v121
  v_lshrrev_b32 v142, 16, v122
  v_lshrrev_b32 v143, 16, v123
  v_lshrrev_b32 v144, 16, v124
  v_lshrrev_b32 v145, 16, v125
  v_lshrrev_b32 v146, 16, v126
  v_lshrrev_b32 v147, 16, v127
  s_waitcnt vmcnt(18)
  v_dot2c_f32_bf16 v148, v28, v128
  v_dot2c_f32_bf16 v149, v28, v108
  v_dot2c_f32_bf16 v150, v29, v128
  v_dot2c_f32_bf16 v151, v29, v108
  v_dot2c_f32_bf16 v152, v30, v128
  v_dot2c_f32_bf16 v153, v30, v108
  v_dot2c_f32_bf16 v154, v31, v128
  v_dot2c_f32_bf16 v155, v31, v108
  v_dot2c_f32_bf16 v148, v32, v129
  v_dot2c_f32_bf16 v149, v32, v109
  v_dot2c_f32_bf16 v150, v33, v129
  v_dot2c_f32_bf16 v151, v33, v109
  v_dot2c_f32_bf16 v152, v34, v129
  v_dot2c_f32_bf16 v153, v34, v109
  v_dot2c_f32_bf16 v154, v35, v129
  v_dot2c_f32_bf16 v155, v35, v109
  s_waitcnt vmcnt(16)
  v_dot2c_f32_bf16 v148, v36, v130
  v_dot2c_f32_bf16 v149, v36, v110
  v_dot2c_f32_bf16 v150, v37, v130
  v_dot2c_f32_bf16 v151, v37, v110
  v_dot2c_f32_bf16 v152, v38, v130
  v_dot2c_f32_bf16 v153, v38, v110
  v_dot2c_f32_bf16 v154, v39, v130
  v_dot2c_f32_bf16 v155, v39, v110
  v_dot2c_f32_bf16 v148, v40, v131
  v_dot2c_f32_bf16 v149, v40, v111
  v_dot2c_f32_bf16 v150, v41, v131
  v_dot2c_f32_bf16 v151, v41, v111
  v_dot2c_f32_bf16 v152, v42, v131
  v_dot2c_f32_bf16 v153, v42, v111
  v_dot2c_f32_bf16 v154, v43, v131
  v_dot2c_f32_bf16 v155, v43, v111
  s_waitcnt vmcnt(14)
  v_dot2c_f32_bf16 v148, v44, v132
  v_dot2c_f32_bf16 v149, v44, v112
  v_dot2c_f32_bf16 v150, v45, v132
  v_dot2c_f32_bf16 v151, v45, v112
  v_dot2c_f32_bf16 v152, v46, v132
  v_dot2c_f32_bf16 v153, v46, v112
  v_dot2c_f32_bf16 v154, v47, v132
  v_dot2c_f32_bf16 v155, v47, v112
  v_dot2c_f32_bf16 v148, v48, v133
  v_dot2c_f32_bf16 v149, v48, v113
  v_dot2c_f32_bf16 v150, v49, v133
  v_dot2c_f32_bf16 v151, v49, v113
  v_dot2c_f32_bf16 v152, v50, v133
  v_dot2c_f32_bf16 v153, v50, v113
  v_dot2c_f32_bf16 v154, v51, v133
  v_dot2c_f32_bf16 v155, v51, v113
  s_waitcnt vmcnt(12)
  v_dot2c_f32_bf16 v148, v52, v134
  v_dot2c_f32_bf16 v149, v52, v114
  v_dot2c_f32_bf16 v150, v53, v134
  v_dot2c_f32_bf16 v151, v53, v114
  v_dot2c_f32_bf16 v152, v54, v134
  v_dot2c_f32_bf16 v153, v54, v114
  v_dot2c_f32_bf16 v154, v55, v134
  v_dot2c_f32_bf16 v155, v55, v114
  v_dot2c_f32_bf16 v148, v56, v135
  v_dot2c_f32_bf16 v149, v56, v115
  v_dot2c_f32_bf16 v150, v57, v135
  v_dot2c_f32_bf16 v151, v57, v115
  v_dot2c_f32_bf16 v152, v58, v135
  v_dot2c_f32_bf16 v153, v58, v115
  v_dot2c_f32_bf16 v154, v59, v135
  v_dot2c_f32_bf16 v155, v59, v115
  s_waitcnt vmcnt(10)
  v_dot2c_f32_bf16 v148, v60, v136
  v_dot2c_f32_bf16 v149, v60, v116
  v_dot2c_f32_bf16 v150, v61, v136
  v_dot2c_f32_bf16 v151, v61, v116
  v_dot2c_f32_bf16 v152, v62, v136
  v_dot2c_f32_bf16 v153, v62, v116
  v_dot2c_f32_bf16 v154, v63, v136
  v_dot2c_f32_bf16 v155, v63, v116
  v_dot2c_f32_bf16 v148, v64, v137
  v_dot2c_f32_bf16 v149, v64, v117
  v_dot2c_f32_bf16 v150, v65, v137
  v_dot2c_f32_bf16 v151, v65, v117
  v_dot2c_f32_bf16 v152, v66, v137
  v_dot2c_f32_bf16 v153, v66, v117
  v_dot2c_f32_bf16 v154, v67, v137
  v_dot2c_f32_bf16 v155, v67, v117
  s_waitcnt vmcnt(8)
  v_dot2c_f32_bf16 v148, v68, v138
  v_dot2c_f32_bf16 v149, v68, v118
  v_dot2c_f32_bf16 v150, v69, v138
  v_dot2c_f32_bf16 v151, v69, v118
  v_dot2c_f32_bf16 v152, v70, v138
  v_dot2c_f32_bf16 v153, v70, v118
  v_dot2c_f32_bf16 v154, v71, v138
  v_dot2c_f32_bf16 v155, v71, v118
  v_dot2c_f32_bf16 v148, v72, v139
  v_dot2c_f32_bf16 v149, v72, v119
  v_dot2c_f32_bf16 v150, v73, v139
  v_dot2c_f32_bf16 v151, v73, v119
  v_dot2c_f32_bf16 v152, v74, v139
  v_dot2c_f32_bf16 v153, v74, v119
  v_dot2c_f32_bf16 v154, v75, v139
  v_dot2c_f32_bf16 v155, v75, v119
  s_waitcnt vmcnt(6)
  v_dot2c_f32_bf16 v148, v76, v140
  v_dot2c_f32_bf16 v149, v76, v120
  v_dot2c_f32_bf16 v150, v77, v140
  v_dot2c_f32_bf16 v151, v77, v120
  v_dot2c_f32_bf16 v152, v78, v140
  v_dot2c_f32_bf16 v153, v78, v120
  v_dot2c_f32_bf16 v154, v79, v140
  v_dot2c_f32_bf16 v155, v79, v120
  v_dot2c_f32_bf16 v148, v80, v141
  v_dot2c_f32_bf16 v149, v80, v121
  v_dot2c_f32_bf16 v150, v81, v141
  v_dot2c_f32_bf16 v151, v81, v121
  v_dot2c_f32_bf16 v152, v82, v141
  v_dot2c_f32_bf16 v153, v82, v121
  v_dot2c_f32_bf16 v154, v83, v141
  v_dot2c_f32_bf16 v155, v83, v121
  s_waitcnt vmcnt(4)
  v_dot2c_f32_bf16 v148, v84, v142
  v_dot2c_f32_bf16 v149, v84, v122
  v_dot2c_f32_bf16 v150, v85, v142
  v_dot2c_f32_bf16 v151, v85, v122
  v_dot2c_f32_bf16 v152, v86, v142
  v_dot2c_f32_bf16 v153, v86, v122
  v_dot2c_f32_bf16 v154, v87, v142
  v_dot2c_f32_bf16 v155, v87, v122
  v_dot2c_f32_bf16 v148, v88, v143
  v_dot2c_f32_bf16 v149, v88, v123
  v_dot2c_f32_bf16 v150, v89, v143
  v_dot2c_f32_bf16 v151, v89, v123
  v_dot2c_f32_bf16 v152, v90, v143
  v_dot2c_f32_bf16 v153, v90, v123
  v_dot2c_f32_bf16 v154, v91, v143
  v_dot2c_f32_bf16 v155, v91, v123
  s_waitcnt vmcnt(2)
  v_dot2c_f32_bf16 v148, v92, v144
  v_dot2c_f32_bf16 v149, v92, v124
  v_dot2c_f32_bf16 v150, v93, v144
  v_dot2c_f32_bf16 v151, v93, v124
  v_dot2c_f32_bf16 v152, v94, v144
  v_dot2c_f32_bf16 v153, v94, v124
  v_dot2c_f32_bf16 v154, v95, v144
  v_dot2c_f32_bf16 v155, v95, v124
  v_dot2c_f32_bf16 v148, v96, v145
  v_dot2c_f32_bf16 v149, v96, v125
  v_dot2c_f32_bf16 v150, v97, v145
  v_dot2c_f32_bf16 v151, v97, v125
  v_dot2c_f32_bf16 v152, v98, v145
  v_dot2c_f32_bf16 v153, v98, v125
  v_dot2c_f32_bf16 v154, v99, v145
  v_dot2c_f32_bf16 v155, v99, v125
  s_waitcnt vmcnt(0)
  v_dot2c_f32_bf16 v148, v100, v146
  v_dot2c_f32_bf16 v149, v100, v126
  v_dot2c_f32_bf16 v150, v101, v146
  v_dot2c_f32_bf16 v151, v101, v126
  v_dot2c_f32_bf16 v152, v102, v146
  v_dot2c_f32_bf16 v153, v102, v126
  v_dot2c_f32_bf16 v154, v103, v146
  v_dot2c_f32_bf16 v155, v103, v126
  v_dot2c_f32_bf16 v148, v104, v147
  v_dot2c_f32_bf16 v149, v104, v127
  v_dot2c_f32_bf16 v150, v105, v147
  v_dot2c_f32_bf16 v151, v105, v127
  v_dot2c_f32_bf16 v152, v106, v147
  v_dot2c_f32_bf16 v153, v106, v127
  v_dot2c_f32_bf16 v154, v107, v147
  v_dot2c_f32_bf16 v155, v107, v127
  v_lshlrev_b32 v12, 5, v0
  ds_write_b128 v12, v[148:151] offset:4096
  s_nop 0
  ds_write_b128 v12, v[152:155] offset:4112
  v_lshlrev_b32 v12, 2, v0
  s_waitcnt lgkmcnt(0)
  s_barrier
  s_cmp_lg_u32 s17, 0
  s_cbranch_scc1 mod_endb
  ds_read2st64_b32 v[28:29], v12 offset0:16 offset1:17
  ds_read2st64_b32 v[30:31], v12 offset0:18 offset1:19
  ds_read2st64_b32 v[32:33], v12 offset0:20 offset1:21
  ds_read2st64_b32 v[34:35], v12 offset0:22 offset1:23
  ds_read2st64_b32 v[36:37], v12 offset0:24 offset1:25
  ds_read2st64_b32 v[38:39], v12 offset0:26 offset1:27
  ds_read2st64_b32 v[40:41], v12 offset0:28 offset1:29
  ds_read2st64_b32 v[42:43], v12 offset0:30 offset1:31
  ds_read2st64_b32 v[44:45], v12 offset0:32 offset1:33
  ds_read2st64_b32 v[46:47], v12 offset0:34 offset1:35
  ds_read2st64_b32 v[48:49], v12 offset0:36 offset1:37
  ds_read2st64_b32 v[50:51], v12 offset0:38 offset1:39
  ds_read2st64_b32 v[52:53], v12 offset0:40 offset1:41
  ds_read2st64_b32 v[54:55], v12 offset0:42 offset1:43
  ds_read2st64_b32 v[56:57], v12 offset0:44 offset1:45
  ds_read2st64_b32 v[58:59], v12 offset0:46 offset1:47
  s_waitcnt lgkmcnt(11)
  v_pk_add_f32 v[28:29], v[28:29], v[30:31]
  v_pk_add_f32 v[28:29], v[28:29], v[32:33]
  v_pk_add_f32 v[28:29], v[28:29], v[34:35]
  v_pk_add_f32 v[28:29], v[28:29], v[36:37]
  s_waitcnt lgkmcnt(7)
  v_pk_add_f32 v[28:29], v[28:29], v[38:39]
  v_pk_add_f32 v[28:29], v[28:29], v[40:41]
  v_pk_add_f32 v[28:29], v[28:29], v[42:43]
  v_pk_add_f32 v[28:29], v[28:29], v[44:45]
  s_waitcnt lgkmcnt(3)
  v_pk_add_f32 v[28:29], v[28:29], v[46:47]
  v_pk_add_f32 v[28:29], v[28:29], v[48:49]
  v_pk_add_f32 v[28:29], v[28:29], v[50:51]
  v_pk_add_f32 v[28:29], v[28:29], v[52:53]
  s_waitcnt lgkmcnt(0)
  v_pk_add_f32 v[28:29], v[28:29], v[54:55]
  v_pk_add_f32 v[28:29], v[28:29], v[56:57]
  v_pk_add_f32 v[28:29], v[28:29], v[58:59]
  v_add_f32 v28, v28, v29
  v_cvt_pk_bf16_f32 v28, v28, v28
  v_lshlrev_b32 v28, 16, v28
  s_lshl_b32 s6, s52, 8
  s_add_u32 s6, s6, 65536
  buffer_store_dword v28, v12, s[8:11], s6 offen sc1
  v_mov_b32 v16, 196
  v_mov_b32 v17, 1
  s_waitcnt vmcnt(0)
  s_mov_b64 exec, 1
  buffer_atomic_add v17, v16, s[12:15], 0 offen sc1
  s_mov_b64 exec, -1
mod_endb:
  s_barrier
  s_add_u32 s52, s52, 24
  s_cmp_lt_u32 s52, 60
  s_cbranch_scc1 r_mod2
  v_mov_b32 v233, 0
  v_mov_b32 v234, 0
  v_mov_b32 v235, 0
  v_mov_b32 v236, 0
  v_mov_b32 v237, 0
  s_load_dwordx2 s[56:57], s[0:1], 72
  s_mov_b32 s58, 1966080
  s_mov_b32 s59, 0x00020000
  s_load_dwordx2 s[60:61], s[0:1], 80
  s_mov_b32 s62, 1966080
  s_mov_b32 s63, 0x00020000
  s_load_dwordx2 s[64:65], s[0:1], 88
  s_mov_b32 s66, 1966080
  s_mov_b32 s67, 0x00020000
  s_mul_i32 s68, s16, 3
  s_add_u32 s68, s68, s18
  s_sub_u32 s68, s68, 29
  s_mul_i32 s73, s17, 40960
  v_lshrrev_b32 v124, 4, v1
  v_and_b32 v124, 3, v124
  v_lshlrev_b32 v124, 1, v124
  v_and_b32 v4, 7, v1
  v_xor_b32 v4, v4, v124
  v_lshlrev_b32 v4, 4, v4
  v_lshrrev_b32 v124, 3, v1
  v_mul_u32_u24 v124, 0, v124
  v_add_u32 v4, v4, v124
  v_lshrrev_b32 v124, 4, v1
  v_and_b32 v124, 3, v124
  v_lshlrev_b32 v124, 1, v124
  v_and_b32 v5, 7, v1
  v_xor_b32 v5, v5, v124
  v_lshlrev_b32 v5, 4, v5
  v_lshrrev_b32 v124, 3, v1
  v_mul_u32_u24 v124, 1280, v124
  v_add_u32 v5, v5, v124
  v_bfe_u32 v124, v1, 3, 2
  v_bfe_u32 v125, v1, 5, 1
  v_lshl_add_u32 v124, v125, 3, v124
  v_mul_u32_u24 v124, 3072, v124
  v_add_u32 v4, v4, v124
  v_lshrrev_b32 v124, 2, v1
  v_lshrrev_b32 v125, 1, v124
  v_and_b32 v125, 3, v125
  v_lshlrev_b32 v125, 1, v125
  v_bfe_u32 v144, v1, 1, 1
  v_add_u32 v144, 0, v144
  v_xor_b32 v144, v144, v125
  v_lshlrev_b32 v144, 4, v144
  v_lshlrev_b32 v124, 7, v124
  v_add_u32 v144, v144, v124
  v_and_b32 v124, 1, v1
  v_lshlrev_b32 v124, 3, v124
  v_add_u32 v144, v144, v124
  v_add_u32 v144, s73, v144
  v_lshrrev_b32 v124, 2, v1
  v_lshrrev_b32 v125, 1, v124
  v_and_b32 v125, 3, v125
  v_lshlrev_b32 v125, 1, v125
  v_bfe_u32 v145, v1, 1, 1
  v_add_u32 v145, 2, v145
  v_xor_b32 v145, v145, v125
  v_lshlrev_b32 v145, 4, v145
  v_lshlrev_b32 v124, 7, v124
  v_add_u32 v145, v145, v124
  v_and_b32 v124, 1, v1
  v_lshlrev_b32 v124, 3, v124
  v_add_u32 v145, v145, v124
  v_add_u32 v145, s73, v145
  v_lshrrev_b32 v124, 2, v1
  v_lshrrev_b32 v125, 1, v124
  v_and_b32 v125, 3, v125
  v_lshlrev_b32 v125, 1, v125
  v_bfe_u32 v146, v1, 1, 1
  v_add_u32 v146, 4, v146
  v_xor_b32 v146, v146, v125
  v_lshlrev_b32 v146, 4, v146
  v_lshlrev_b32 v124, 7, v124
  v_add_u32 v146, v146, v124
  v_and_b32 v124, 1, v1
  v_lshlrev_b32 v124, 3, v124
  v_add_u32 v146, v146, v124
  v_add_u32 v146, s73, v146
  v_lshrrev_b32 v124, 2, v1
  v_lshrrev_b32 v125, 1, v124
  v_and_b32 v125, 3, v125
  v_lshlrev_b32 v125, 1, v125
  v_bfe_u32 v147, v1, 1, 1
  v_add_u32 v147, 6, v147
  v_xor_b32 v147, v147, v125
  v_lshlrev_b32 v147, 4, v147
  v_lshlrev_b32 v124, 7, v124
  v_add_u32 v147, v147, v124
  v_and_b32 v124, 1, v1
  v_lshlrev_b32 v124, 3, v124
  v_add_u32 v147, v147, v124
  v_add_u32 v147, s73, v147
  s_mul_i32 s72, s17, 491520
  s_lshl_b32 s70, s68, 7
  s_add_u32 s72, s72, s70
  s_waitcnt lgkmcnt(0)
  s_barrier
  s_add_u32 m0, s73, 0
  s_add_u32 s70, s72, 0
  buffer_load_dwordx4 v4, s[56:59], s70 offen nt lds
  s_add_u32 m0, s73, 1024
  s_add_u32 s70, s72, 49152
  buffer_load_dwordx4 v4, s[56:59], s70 offen nt lds
  s_add_u32 m0, s73, 2048
  s_add_u32 s70, s72, 12288
  buffer_load_dwordx4 v4, s[56:59], s70 offen nt lds
  s_add_u32 m0, s73, 3072
  s_add_u32 s70, s72, 61440
  buffer_load_dwordx4 v4, s[56:59], s70 offen nt lds
  s_add_u32 m0, s73, 4096
  s_add_u32 s70, s72, 98304
  buffer_load_dwordx4 v4, s[56:59], s70 offen nt lds
  s_add_u32 m0, s73, 5120
  s_add_u32 s70, s72, 147456
  buffer_load_dwordx4 v4, s[56:59], s70 offen nt lds
  s_add_u32 m0, s73, 6144
  s_add_u32 s70, s72, 110592
  buffer_load_dwordx4 v4, s[56:59], s70 offen nt lds
  s_add_u32 m0, s73, 7168
  s_add_u32 s70, s72, 159744
  buffer_load_dwordx4 v4, s[56:59], s70 offen nt lds
  s_add_u32 m0, s73, 8192
  s_add_u32 s70, s72, 196608
  buffer_load_dwordx4 v4, s[56:59], s70 offen nt lds
  s_add_u32 m0, s73, 9216
  s_add_u32 s70, s72, 245760
  buffer_load_dwordx4 v4, s[56:59], s70 offen nt lds
  s_add_u32 m0, s73, 10240
  s_add_u32 s70, s72, 208896
  buffer_load_dwordx4 v4, s[56:59], s70 offen nt lds
  s_add_u32 m0, s73, 11264
  s_add_u32 s70, s72, 258048
  buffer_load_dwordx4 v4, s[56:59], s70 offen nt lds
  s_add_u32 m0, s73, 12288
  s_add_u32 s70, s72, 294912
  buffer_load_dwordx4 v4, s[56:59], s70 offen nt lds
  s_add_u32 m0, s73, 13312
  s_add_u32 s70, s72, 344064
  buffer_load_dwordx4 v4, s[56:59], s70 offen nt lds
  s_add_u32 m0, s73, 14336
  s_add_u32 s70, s72, 307200
  buffer_load_dwordx4 v4, s[56:59], s70 offen nt lds
  s_add_u32 m0, s73, 15360
  s_add_u32 s70, s72, 356352
  buffer_load_dwordx4 v4, s[56:59], s70 offen nt lds
  s_add_u32 m0, s73, 16384
  s_add_u32 s70, s72, 393216
  buffer_load_dwordx4 v4, s[56:59], s70 offen nt lds
  s_add_u32 m0, s73, 17408
  s_add_u32 s70, s72, 442368
  buffer_load_dwordx4 v4, s[56:59], s70 offen nt lds
  s_add_u32 m0, s73, 18432
  s_add_u32 s70, s72, 405504
  buffer_load_dwordx4 v4, s[56:59], s70 offen nt lds
  s_add_u32 m0, s73, 19456
  s_add_u32 s70, s72, 454656
  buffer_load_dwordx4 v4, s[56:59], s70 offen nt lds
  s_add_u32 m0, s73, 20480
  s_add_u32 s70, s72, 0
  buffer_load_dwordx4 v4, s[60:63], s70 offen nt lds
  s_add_u32 m0, s73, 21504
  s_add_u32 s70, s72, 49152
  buffer_load_dwordx4 v4, s[60:63], s70 offen nt lds
  s_add_u32 m0, s73, 22528
  s_add_u32 s70, s72, 12288
  buffer_load_dwordx4 v4, s[60:63], s70 offen nt lds
  s_add_u32 m0, s73, 23552
  s_add_u32 s70, s72, 61440
  buffer_load_dwordx4 v4, s[60:63], s70 offen nt lds
  s_add_u32 m0, s73, 24576
  s_add_u32 s70, s72, 98304
  buffer_load_dwordx4 v4, s[60:63], s70 offen nt lds
  s_add_u32 m0, s73, 25600
  s_add_u32 s70, s72, 147456
  buffer_load_dwordx4 v4, s[60:63], s70 offen nt lds
  s_add_u32 m0, s73, 26624
  s_add_u32 s70, s72, 110592
  buffer_load_dwordx4 v4, s[60:63], s70 offen nt lds
  s_add_u32 m0, s73, 27648
  s_add_u32 s70, s72, 159744
  buffer_load_dwordx4 v4, s[60:63], s70 offen nt lds
  s_add_u32 m0, s73, 28672
  s_add_u32 s70, s72, 196608
  buffer_load_dwordx4 v4, s[60:63], s70 offen nt lds
  s_add_u32 m0, s73, 29696
  s_add_u32 s70, s72, 245760
  buffer_load_dwordx4 v4, s[60:63], s70 offen nt lds
  s_add_u32 m0, s73, 30720
  s_add_u32 s70, s72, 208896
  buffer_load_dwordx4 v4, s[60:63], s70 offen nt lds
  s_add_u32 m0, s73, 31744
  s_add_u32 s70, s72, 258048
  buffer_load_dwordx4 v4, s[60:63], s70 offen nt lds
  s_add_u32 m0, s73, 32768
  s_add_u32 s70, s72, 294912
  buffer_load_dwordx4 v4, s[60:63], s70 offen nt lds
  s_add_u32 m0, s73, 33792
  s_add_u32 s70, s72, 344064
  buffer_load_dwordx4 v4, s[60:63], s70 offen nt lds
  s_add_u32 m0, s73, 34816
  s_add_u32 s70, s72, 307200
  buffer_load_dwordx4 v4, s[60:63], s70 offen nt lds
  s_add_u32 m0, s73, 35840
  s_add_u32 s70, s72, 356352
  buffer_load_dwordx4 v4, s[60:63], s70 offen nt lds
  s_add_u32 m0, s73, 36864
  s_add_u32 s70, s72, 393216
  buffer_load_dwordx4 v4, s[60:63], s70 offen nt lds
  s_add_u32 m0, s73, 37888
  s_add_u32 s70, s72, 442368
  buffer_load_dwordx4 v4, s[60:63], s70 offen nt lds
  s_add_u32 m0, s73, 38912
  s_add_u32 s70, s72, 405504
  buffer_load_dwordx4 v4, s[60:63], s70 offen nt lds
  s_add_u32 m0, s73, 39936
  s_add_u32 s70, s72, 454656
  buffer_load_dwordx4 v4, s[60:63], s70 offen nt lds
  s_waitcnt vmcnt(36)
  ds_read_b64_tr_b16 a[0:1], v144 offset:0
  ds_read_b64_tr_b16 a[2:3], v144 offset:2048
  ds_read_b64_tr_b16 a[20:21], v145 offset:0
  ds_read_b64_tr_b16 a[22:23], v145 offset:2048
  ds_read_b64_tr_b16 a[40:41], v146 offset:0
  ds_read_b64_tr_b16 a[42:43], v146 offset:2048
  ds_read_b64_tr_b16 a[60:61], v147 offset:0
  ds_read_b64_tr_b16 a[62:63], v147 offset:2048
  s_waitcnt vmcnt(32)
  ds_read_b64_tr_b16 a[4:5], v144 offset:4096
  ds_read_b64_tr_b16 a[6:7], v144 offset:6144
  ds_read_b64_tr_b16 a[24:25], v145 offset:4096
  ds_read_b64_tr_b16 a[26:27], v145 offset:6144
  ds_read_b64_tr_b16 a[44:45], v146 offset:4096
  ds_read_b64_tr_b16 a[46:47], v146 offset:6144
  ds_read_b64_tr_b16 a[64:65], v147 offset:4096
  ds_read_b64_tr_b16 a[66:67], v147 offset:6144
  s_waitcnt lgkmcnt(0)
  s_waitcnt vmcnt(28)
  ds_read_b64_tr_b16 a[8:9], v144 offset:8192
  ds_read_b64_tr_b16 a[10:11], v144 offset:10240
  ds_read_b64_tr_b16 a[28:29], v145 offset:8192
  ds_read_b64_tr_b16 a[30:31], v145 offset:10240
  ds_read_b64_tr_b16 a[48:49], v146 offset:8192
  ds_read_b64_tr_b16 a[50:51], v146 offset:10240
  ds_read_b64_tr_b16 a[68:69], v147 offset:8192
  ds_read_b64_tr_b16 a[70:71], v147 offset:10240
  s_waitcnt vmcnt(24)
  ds_read_b64_tr_b16 a[12:13], v144 offset:12288
  ds_read_b64_tr_b16 a[14:15], v144 offset:14336
  ds_read_b64_tr_b16 a[32:33], v145 offset:12288
  ds_read_b64_tr_b16 a[34:35], v145 offset:14336
  ds_read_b64_tr_b16 a[52:53], v146 offset:12288
  ds_read_b64_tr_b16 a[54:55], v146 offset:14336
  ds_read_b64_tr_b16 a[72:73], v147 offset:12288
  ds_read_b64_tr_b16 a[74:75], v147 offset:14336
  s_waitcnt lgkmcnt(0)
  s_waitcnt vmcnt(20)
  ds_read_b64_tr_b16 a[16:17], v144 offset:16384
  ds_read_b64_tr_b16 a[18:19], v144 offset:18432
  ds_read_b64_tr_b16 a[36:37], v145 offset:16384
  ds_read_b64_tr_b16 a[38:39], v145 offset:18432
  ds_read_b64_tr_b16 a[56:57], v146 offset:16384
  ds_read_b64_tr_b16 a[58:59], v146 offset:18432
  ds_read_b64_tr_b16 a[76:77], v147 offset:16384
  ds_read_b64_tr_b16 a[78:79], v147 offset:18432
  s_waitcnt vmcnt(16)
  ds_read_b64_tr_b16 a[80:81], v144 offset:20480
  ds_read_b64_tr_b16 a[82:83], v144 offset:22528
  ds_read_b64_tr_b16 a[100:101], v145 offset:20480
  ds_read_b64_tr_b16 a[102:103], v145 offset:22528
  ds_read_b64_tr_b16 a[120:121], v146 offset:20480
  ds_read_b64_tr_b16 a[122:123], v146 offset:22528
  ds_read_b64_tr_b16 a[140:141], v147 offset:20480
  ds_read_b64_tr_b16 a[142:143], v147 offset:22528
  s_waitcnt lgkmcnt(0)
  s_waitcnt vmcnt(12)
  ds_read_b64_tr_b16 a[84:85], v144 offset:24576
  ds_read_b64_tr_b16 a[86:87], v144 offset:26624
  ds_read_b64_tr_b16 a[104:105], v145 offset:24576
  ds_read_b64_tr_b16 a[106:107], v145 offset:26624
  ds_read_b64_tr_b16 a[124:125], v146 offset:24576
  ds_read_b64_tr_b16 a[126:127], v146 offset:26624
  ds_read_b64_tr_b16 a[144:145], v147 offset:24576
  ds_read_b64_tr_b16 a[146:147], v147 offset:26624
  s_waitcnt vmcnt(8)
  ds_read_b64_tr_b16 a[88:89], v144 offset:28672
  ds_read_b64_tr_b16 a[90:91], v144 offset:30720
  ds_read_b64_tr_b16 a[108:109], v145 offset:28672
  ds_read_b64_tr_b16 a[110:111], v145 offset:30720
  ds_read_b64_tr_b16 a[128:129], v146 offset:28672
  ds_read_b64_tr_b16 a[130:131], v146 offset:30720
  ds_read_b64_tr_b16 a[148:149], v147 offset:28672
  ds_read_b64_tr_b16 a[150:151], v147 offset:30720
  s_waitcnt lgkmcnt(0)
  s_waitcnt vmcnt(4)
  ds_read_b64_tr_b16 a[92:93], v144 offset:32768
  ds_read_b64_tr_b16 a[94:95], v144 offset:34816
  ds_read_b64_tr_b16 a[112:113], v145 offset:32768
  ds_read_b64_tr_b16 a[114:115], v145 offset:34816
  ds_read_b64_tr_b16 a[132:133], v146 offset:32768
  ds_read_b64_tr_b16 a[134:135], v146 offset:34816
  ds_read_b64_tr_b16 a[152:153], v147 offset:32768
  ds_read_b64_tr_b16 a[154:155], v147 offset:34816
  s_waitcnt vmcnt(0)
  ds_read_b64_tr_b16 a[96:97], v144 offset:36864
  ds_read_b64_tr_b16 a[98:99], v144 offset:38912
  ds_read_b64_tr_b16 a[116:117], v145 offset:36864
  ds_read_b64_tr_b16 a[118:119], v145 offset:38912
  ds_read_b64_tr_b16 a[136:137], v146 offset:36864
  ds_read_b64_tr_b16 a[138:139], v146 offset:38912
  ds_read_b64_tr_b16 a[156:157], v147 offset:36864
  ds_read_b64_tr_b16 a[158:159], v147 offset:38912
  s_waitcnt lgkmcnt(0)
  s_mul_i32 s72, s68, 81920
  s_mul_i32 s70, s17, 320
  s_add_u32 s72, s72, s70
  s_add_u32 m0, s73, 0
  s_add_u32 s70, s72, 0
  buffer_load_dwordx4 v5, s[64:67], s70 offen nt lds
  s_add_u32 m0, s73, 1024
  s_add_u32 s70, s72, 10240
  buffer_load_dwordx4 v5, s[64:67], s70 offen nt lds
  s_add_u32 m0, s73, 2048
  s_add_u32 s70, s72, 20480
  buffer_load_dwordx4 v5, s[64:67], s70 offen nt lds
  s_add_u32 m0, s73, 3072
  s_add_u32 s70, s72, 30720
  buffer_load_dwordx4 v5, s[64:67], s70 offen nt lds
  s_add_u32 m0, s73, 4096
  s_add_u32 s70, s72, 40960
  buffer_load_dwordx4 v5, s[64:67], s70 offen nt lds
  s_add_u32 m0, s73, 5120
  s_add_u32 s70, s72, 51200
  buffer_load_dwordx4 v5, s[64:67], s70 offen nt lds
  s_add_u32 m0, s73, 6144
  s_add_u32 s70, s72, 61440
  buffer_load_dwordx4 v5, s[64:67], s70 offen nt lds
  s_add_u32 m0, s73, 7168
  s_add_u32 s70, s72, 71680
  buffer_load_dwordx4 v5, s[64:67], s70 offen nt lds
  s_add_u32 m0, s73, 8192
  s_add_u32 s70, s72, 128
  buffer_load_dwordx4 v5, s[64:67], s70 offen nt lds
  s_add_u32 m0, s73, 9216
  s_add_u32 s70, s72, 10368
  buffer_load_dwordx4 v5, s[64:67], s70 offen nt lds
  s_add_u32 m0, s73, 10240
  s_add_u32 s70, s72, 20608
  buffer_load_dwordx4 v5, s[64:67], s70 offen nt lds
  s_add_u32 m0, s73, 11264
  s_add_u32 s70, s72, 30848
  buffer_load_dwordx4 v5, s[64:67], s70 offen nt lds
  s_add_u32 m0, s73, 12288
  s_add_u32 s70, s72, 41088
  buffer_load_dwordx4 v5, s[64:67], s70 offen nt lds
  s_add_u32 m0, s73, 13312
  s_add_u32 s70, s72, 51328
  buffer_load_dwordx4 v5, s[64:67], s70 offen nt lds
  s_add_u32 m0, s73, 14336
  s_add_u32 s70, s72, 61568
  buffer_load_dwordx4 v5, s[64:67], s70 offen nt lds
  s_add_u32 m0, s73, 15360
  s_add_u32 s70, s72, 71808
  buffer_load_dwordx4 v5, s[64:67], s70 offen nt lds
  s_add_u32 m0, s73, 16384
  s_add_u32 s70, s72, 256
  buffer_load_dwordx4 v5, s[64:67], s70 offen nt lds
  s_add_u32 m0, s73, 17408
  s_add_u32 s70, s72, 10496
  buffer_load_dwordx4 v5, s[64:67], s70 offen nt lds
  s_add_u32 m0, s73, 18432
  s_add_u32 s70, s72, 20736
  buffer_load_dwordx4 v5, s[64:67], s70 offen nt lds
  s_add_u32 m0, s73, 19456
  s_add_u32 s70, s72, 30976
  buffer_load_dwordx4 v5, s[64:67], s70 offen nt lds
  s_add_u32 m0, s73, 20480
  s_add_u32 s70, s72, 41216
  buffer_load_dwordx4 v5, s[64:67], s70 offen nt lds
  s_add_u32 m0, s73, 21504
  s_add_u32 s70, s72, 51456
  buffer_load_dwordx4 v5, s[64:67], s70 offen nt lds
  s_add_u32 m0, s73, 22528
  s_add_u32 s70, s72, 61696
  buffer_load_dwordx4 v5, s[64:67], s70 offen nt lds
  s_add_u32 m0, s73, 23552
  s_add_u32 s70, s72, 71936
  buffer_load_dwordx4 v5, s[64:67], s70 offen nt lds
  s_waitcnt vmcnt(0)
  ds_read_b64_tr_b16 a[160:161], v144 offset:0
  ds_read_b64_tr_b16 a[162:163], v144 offset:2048
  ds_read_b64_tr_b16 a[164:165], v144 offset:4096
  ds_read_b64_tr_b16 a[166:167], v144 offset:6144
  ds_read_b64_tr_b16 a[168:169], v145 offset:0
  ds_read_b64_tr_b16 a[170:171], v145 offset:2048
  ds_read_b64_tr_b16 a[172:173], v145 offset:4096
  ds_read_b64_tr_b16 a[174:175], v145 offset:6144
  ds_read_b64_tr_b16 a[176:177], v146 offset:0
  ds_read_b64_tr_b16 a[178:179], v146 offset:2048
  ds_read_b64_tr_b16 a[180:181], v146 offset:4096
  ds_read_b64_tr_b16 a[182:183], v146 offset:6144
  s_waitcnt lgkmcnt(0)
  ds_read_b64_tr_b16 a[184:185], v147 offset:0
  ds_read_b64_tr_b16 a[186:187], v147 offset:2048
  ds_read_b64_tr_b16 a[188:189], v147 offset:4096
  ds_read_b64_tr_b16 a[190:191], v147 offset:6144
  ds_read_b64_tr_b16 a[192:193], v144 offset:8192
  ds_read_b64_tr_b16 a[194:195], v144 offset:10240
  ds_read_b64_tr_b16 a[196:197], v144 offset:12288
  ds_read_b64_tr_b16 a[198:199], v144 offset:14336
  ds_read_b64_tr_b16 a[200:201], v145 offset:8192
  ds_read_b64_tr_b16 a[202:203], v145 offset:10240
  ds_read_b64_tr_b16 a[204:205], v145 offset:12288
  ds_read_b64_tr_b16 a[206:207], v145 offset:14336
  s_waitcnt lgkmcnt(0)
  ds_read_b64_tr_b16 a[208:209], v146 offset:8192
  ds_read_b64_tr_b16 a[210:211], v146 offset:10240
  ds_read_b64_tr_b16 a[212:213], v146 offset:12288
  ds_read_b64_tr_b16 a[214:215], v146 offset:14336
  ds_read_b64_tr_b16 a[216:217], v147 offset:8192
  ds_read_b64_tr_b16 a[218:219], v147 offset:10240
  ds_read_b64_tr_b16 a[220:221], v147 offset:12288
  ds_read_b64_tr_b16 a[222:223], v147 offset:14336
  ds_read_b64_tr_b16 a[224:225], v144 offset:16384
  ds_read_b64_tr_b16 a[226:227], v144 offset:18432
  ds_read_b64_tr_b16 a[228:229], v144 offset:20480
  ds_read_b64_tr_b16 a[230:231], v144 offset:22528
  s_waitcnt lgkmcnt(0)
  ds_read_b64_tr_b16 a[232:233], v145 offset:16384
  ds_read_b64_tr_b16 a[234:235], v145 offset:18432
  ds_read_b64_tr_b16 a[236:237], v145 offset:20480
  ds_read_b64_tr_b16 a[238:239], v145 offset:22528
  v_lshlrev_b32 v233, 4, v1
  v_lshrrev_b32 v124, 2, v1
  v_and_b32 v125, 3, v1
  v_lshlrev_b32 v125, 2, v125
  v_lshl_add_u32 v234, v124, 7, v125
  v_lshrrev_b32 v124, 4, v1
  v_and_b32 v125, 7, v1
  v_lshlrev_b32 v125, 4, v125
  v_lshl_add_u32 v236, v124, 7, v125
  v_lshrrev_b32 v124, 5, v1
  v_mul_u32_u24 v124, 20480, v124
  v_and_b32 v125, 31, v1
  v_lshl_add_u32 v237, v125, 4, v124
  s_mul_i32 s78, s17, 24
  s_add_u32 s78, s78, s68
  s_mov_b32 s74, 0
  s_mov_b32 s75, 2097152
  s_waitcnt lgkmcnt(0)
  s_barrier
  s_mov_b32 s79, 0
  s_mov_b32 s80, 0
  s_mov_b32 s81, 0
  s_mov_b32 s82, 0
  s_mov_b32 s83, 0
  s_mov_b32 s84, 0
  s_mov_b32 s85, 0
  s_mov_b32 s86, 0
  s_branch r_par
r_help:
  s_load_dwordx2 s[20:21], s[0:1], 0
  s_mov_b32 s22, 2621440
  s_mov_b32 s23, 0x00020000
  s_load_dwordx2 s[24:25], s[0:1], 112
  s_mov_b32 s26, 2621440
  s_mov_b32 s27, 0x00020000
  s_load_dwordx2 s[28:29], s[0:1], 64
  s_mov_b32 s30, 1280
  s_mov_b32 s31, 0x00020000
  s_add_u32 s54, s18, 60
  v_lshlrev_b32 v226, 2, v1
  v_lshlrev_b32 v227, 3, v1
  v_mov_b32 v230, 0x00003f80
  v_mov_b32 v231, 0x3f800000
  s_waitcnt lgkmcnt(0)
r_par:
  v_mov_b32 v90, 196
  s_mov_b32 s34, 0
gw_14:
  buffer_load_dword v91, v90, s[12:15], 0 offen sc1
  s_add_u32 s34, s34, 1
  s_cmp_gt_u32 s34, 65536
  s_cbranch_scc1 role_abort
  s_waitcnt vmcnt(0)
  v_cmp_gt_u32 vcc, 40, v91
  s_cbranch_vccz gk_15
  s_sleep 8
  s_branch gw_14
gk_15:
  s_mov_b32 s35, 70656
  buffer_load_dwordx2 v[196:197], v227, s[8:11], s35 offen offset:0 sc1
  buffer_load_dwordx2 v[198:199], v227, s[8:11], s35 offen offset:512 sc1
  buffer_load_dwordx2 v[200:201], v227, s[8:11], s35 offen offset:1024 sc1
  buffer_load_dwordx2 v[202:203], v227, s[8:11], s35 offen offset:1536 sc1
  buffer_load_dwordx2 v[204:205], v227, s[8:11], s35 offen offset:2048 sc1
  s_mov_b32 s35, 73216
  buffer_load_dwordx2 v[186:187], v227, s[8:11], s35 offen offset:0 sc1
  buffer_load_dwordx2 v[188:189], v227, s[8:11], s35 offen offset:512 sc1
  buffer_load_dwordx2 v[190:191], v227, s[8:11], s35 offen offset:1024 sc1
  buffer_load_dwordx2 v[192:193], v227, s[8:11], s35 offen offset:1536 sc1
  buffer_load_dwordx2 v[194:195], v227, s[8:11], s35 offen offset:2048 sc1
  s_mov_b32 s35, 75776
  buffer_load_dwordx2 v[176:177], v227, s[8:11], s35 offen offset:0 sc1
  buffer_load_dwordx2 v[178:179], v227, s[8:11], s35 offen offset:512 sc1
  buffer_load_dwordx2 v[180:181], v227, s[8:11], s35 offen offset:1024 sc1
  buffer_load_dwordx2 v[182:183], v227, s[8:11], s35 offen offset:1536 sc1
  buffer_load_dwordx2 v[184:185], v227, s[8:11], s35 offen offset:2048 sc1
  s_mov_b32 s35, 78336
  buffer_load_dwordx2 v[206:207], v227, s[8:11], s35 offen offset:0 sc1
  buffer_load_dwordx2 v[208:209], v227, s[8:11], s35 offen offset:512 sc1
  buffer_load_dwordx2 v[210:211], v227, s[8:11], s35 offen offset:1024 sc1
  buffer_load_dwordx2 v[212:213], v227, s[8:11], s35 offen offset:1536 sc1
  buffer_load_dwordx2 v[214:215], v227, s[8:11], s35 offen offset:2048 sc1
  buffer_load_dword v22, v226, s[28:31], 0 offen offset:0
  buffer_load_dword v23, v226, s[28:31], 0 offen offset:256
  buffer_load_dword v24, v226, s[28:31], 0 offen offset:512
  buffer_load_dword v25, v226, s[28:31], 0 offen offset:768
  buffer_load_dword v26, v226, s[28:31], 0 offen offset:1024
  v_lshlrev_b32 v229, 7, v1
  s_lshl_b32 s35, s16, 8
  s_add_u32 s36, s35, 48
  s_add_u32 s35, s35, 4192
  v_and_b32 v90, 3, v1
  v_lshl_add_u32 v232, v90, 2, s35
  v_mov_b32 v228, s36
  s_waitcnt vmcnt(0)
  v_add_f32 v176, 1.0, v176
  v_add_f32 v177, 1.0, v177
  v_cvt_pk_bf16_f32 v90, v176, v177
  v_lshlrev_b32 v176, 16, v90
  v_and_b32 v177, 0xffff0000, v90
  v_add_f32 v178, 1.0, v178
  v_add_f32 v179, 1.0, v179
  v_cvt_pk_bf16_f32 v90, v178, v179
  v_lshlrev_b32 v178, 16, v90
  v_and_b32 v179, 0xffff0000, v90
  v_add_f32 v180, 1.0, v180
  v_add_f32 v181, 1.0, v181
  v_cvt_pk_bf16_f32 v90, v180, v181
  v_lshlrev_b32 v180, 16, v90
  v_and_b32 v181, 0xffff0000, v90
  v_add_f32 v182, 1.0, v182
  v_add_f32 v183, 1.0, v183
  v_cvt_pk_bf16_f32 v90, v182, v183
  v_lshlrev_b32 v182, 16, v90
  v_and_b32 v183, 0xffff0000, v90
  v_add_f32 v184, 1.0, v184
  v_add_f32 v185, 1.0, v185
  v_cvt_pk_bf16_f32 v90, v184, v185
  v_lshlrev_b32 v184, 16, v90
  v_and_b32 v185, 0xffff0000, v90
  v_lshlrev_b32 v216, 16, v22
  v_and_b32 v217, 0xffff0000, v22
  v_lshlrev_b32 v218, 16, v23
  v_and_b32 v219, 0xffff0000, v23
  v_lshlrev_b32 v220, 16, v24
  v_and_b32 v221, 0xffff0000, v24
  v_lshlrev_b32 v222, 16, v25
  v_and_b32 v223, 0xffff0000, v25
  v_lshlrev_b32 v224, 16, v26
  v_and_b32 v225, 0xffff0000, v26
  s_mov_b32 s39, s54
  s_lshl_b32 s32, s16, 2
  s_add_u32 s32, s32, s17
r_loop:
  s_lshl_b32 s40, s39, 5
  s_add_u32 s40, s40, s32
  s_mul_i32 s37, s40, 1280
  s_mul_i32 s38, s39, 327680
  s_mul_i32 s35, s32, 1280
  s_add_u32 s38, s38, s35
  s_add_u32 s38, s38, 226492416
  s_add_u32 s41, s39, 6
  s_min_u32 s41, s41, 64
  s_max_u32 s36, s39, 60
  s_lshl_b32 s36, s36, 14
  s_add_u32 s36, s36, 1179648
  s_add_u32 s53, s36, 8192
  buffer_load_dword v22, v226, s[20:23], s37 offen offset:0
  buffer_load_dword v23, v226, s[20:23], s37 offen offset:256
  buffer_load_dword v24, v226, s[20:23], s37 offen offset:512
  buffer_load_dword v25, v226, s[20:23], s37 offen offset:768
  buffer_load_dword v26, v226, s[20:23], s37 offen offset:1024
  s_cmp_ge_u32 s39, 54
  s_cbranch_scc1 r_km
  s_mov_b32 s34, 0
pw_16:
  buffer_load_dword v93, v232, s[8:11], 0 offen sc1
  s_add_u32 s34, s34, 1
  s_cmp_gt_u32 s34, 65536
  s_cbranch_scc1 role_abort
  s_waitcnt vmcnt(0)
pc_18:
  v_cmp_gt_u32 vcc, s41, v93
  s_nop 0
  s_and_b32 vcc_lo, vcc_lo, 0xf
  s_and_b32 vcc_hi, vcc_hi, 0x0
  s_cmp_eq_u64 vcc, 0
  s_cbranch_scc1 po_17
  s_sleep 8
  s_branch pw_16
po_17:
  s_branch r_go
r_km:
  s_mov_b32 s53, 0
  s_cmp_eq_u32 s39, 58
  s_cselect_b32 s53, 0, s53
  s_cmp_eq_u32 s39, 59
  s_cselect_b32 s53, 16, s53
  s_cmp_eq_u32 s39, 60
  s_cselect_b32 s53, 36, s53
  s_cmp_eq_u32 s39, 61
  s_cselect_b32 s53, 16, s53
  s_cmp_eq_u32 s39, 62
  s_cselect_b32 s53, 16, s53
  s_cmp_eq_u32 s39, 63
  s_cselect_b32 s53, 2, s53
  s_add_u32 s41, s39, 5
  s_min_u32 s41, s41, 63
  s_cmp_gt_u32 s39, 60
  s_cselect_b32 s41, 64, s41
  s_cmp_eq_u32 s39, 63
  s_cselect_b64 vcc, -1, 0
  v_cndmask_b32 v92, v228, v232, vcc
  s_mov_b32 s34, 0
pw_19:
  buffer_load_dword v93, v92, s[8:11], 0 offen sc1
  s_add_u32 s34, s34, 1
  s_cmp_gt_u32 s34, 65536
  s_cbranch_scc1 role_abort
  s_waitcnt vmcnt(0)
pc_21:
  v_cmp_gt_u32 vcc, s41, v93
  s_nop 0
  s_and_b32 vcc_lo, vcc_lo, 0xf
  s_and_b32 vcc_hi, vcc_hi, 0x0
  s_cmp_eq_u64 vcc, 0
  s_cbranch_scc1 po_20
  s_sleep 4
  s_branch pw_19
po_20:
  s_cmp_lt_u32 s34, 2
  s_cbranch_scc1 r_go
r_z:
  s_sub_u32 s53, s53, 1
  s_cbranch_scc1 r_go
  s_sleep 1
  s_branch r_z
r_go:
  s_mov_b32 s34, 0
r_ld:
  buffer_load_dword v46, v226, s[8:11], s38 offen offset:0 sc1
  buffer_load_dword v47, v226, s[8:11], s38 offen offset:256 sc1
  buffer_load_dword v48, v226, s[8:11], s38 offen offset:512 sc1
  buffer_load_dword v49, v226, s[8:11], s38 offen offset:768 sc1
  buffer_load_dword v50, v226, s[8:11], s38 offen offset:1024 sc1
  s_add_u32 s38, s38, 40960
  buffer_load_dword v51, v226, s[8:11], s38 offen offset:0 sc1
  buffer_load_dword v52, v226, s[8:11], s38 offen offset:256 sc1
  buffer_load_dword v53, v226, s[8:11], s38 offen offset:512 sc1
  buffer_load_dword v54, v226, s[8:11], s38 offen offset:768 sc1
  buffer_load_dword v55, v226, s[8:11], s38 offen offset:1024 sc1
  s_add_u32 s38, s38, 40960
  buffer_load_dword v56, v226, s[8:11], s38 offen offset:0 sc1
  buffer_load_dword v57, v226, s[8:11], s38 offen offset:256 sc1
  buffer_load_dword v58, v226, s[8:11], s38 offen offset:512 sc1
  buffer_load_dword v59, v226, s[8:11], s38 offen offset:768 sc1
  buffer_load_dword v60, v226, s[8:11], s38 offen offset:1024 sc1
  s_add_u32 s38, s38, 40960
  buffer_load_dword v61, v226, s[8:11], s38 offen offset:0 sc1
  buffer_load_dword v62, v226, s[8:11], s38 offen offset:256 sc1
  buffer_load_dword v63, v226, s[8:11], s38 offen offset:512 sc1
  buffer_load_dword v64, v226, s[8:11], s38 offen offset:768 sc1
  buffer_load_dword v65, v226, s[8:11], s38 offen offset:1024 sc1
  s_add_u32 s38, s38, 40960
  buffer_load_dword v66, v226, s[8:11], s38 offen offset:0 sc1
  buffer_load_dword v67, v226, s[8:11], s38 offen offset:256 sc1
  buffer_load_dword v68, v226, s[8:11], s38 offen offset:512 sc1
  buffer_load_dword v69, v226, s[8:11], s38 offen offset:768 sc1
  buffer_load_dword v70, v226, s[8:11], s38 offen offset:1024 sc1
  s_add_u32 s38, s38, 40960
  buffer_load_dword v71, v226, s[8:11], s38 offen offset:0 sc1
  buffer_load_dword v72, v226, s[8:11], s38 offen offset:256 sc1
  buffer_load_dword v73, v226, s[8:11], s38 offen offset:512 sc1
  buffer_load_dword v74, v226, s[8:11], s38 offen offset:768 sc1
  buffer_load_dword v75, v226, s[8:11], s38 offen offset:1024 sc1
  s_add_u32 s38, s38, 40960
  buffer_load_dword v76, v226, s[8:11], s38 offen offset:0 sc1
  buffer_load_dword v77, v226, s[8:11], s38 offen offset:256 sc1
  buffer_load_dword v78, v226, s[8:11], s38 offen offset:512 sc1
  buffer_load_dword v79, v226, s[8:11], s38 offen offset:768 sc1
  buffer_load_dword v80, v226, s[8:11], s38 offen offset:1024 sc1
  s_add_u32 s38, s38, 40960
  buffer_load_dword v81, v226, s[8:11], s38 offen offset:0 sc1
  buffer_load_dword v82, v226, s[8:11], s38 offen offset:256 sc1
  buffer_load_dword v83, v226, s[8:11], s38 offen offset:512 sc1
  buffer_load_dword v84, v226, s[8:11], s38 offen offset:768 sc1
  buffer_load_dword v85, v226, s[8:11], s38 offen offset:1024 sc1
  s_add_u32 s38, s38, 40960
  v_lshlrev_b32 v2, 16, v22
  v_and_b32 v3, 0xffff0000, v22
  v_lshlrev_b32 v4, 16, v23
  v_and_b32 v5, 0xffff0000, v23
  v_lshlrev_b32 v6, 16, v24
  v_and_b32 v7, 0xffff0000, v24
  v_lshlrev_b32 v8, 16, v25
  v_and_b32 v9, 0xffff0000, v25
  v_lshlrev_b32 v10, 16, v26
  v_and_b32 v11, 0xffff0000, v26
  s_waitcnt vmcnt(35)
  v_lshlrev_b32 v12, 16, v46
  v_and_b32 v13, 0xffff0000, v46
  v_lshlrev_b32 v14, 16, v47
  v_and_b32 v15, 0xffff0000, v47
  v_lshlrev_b32 v16, 16, v48
  v_and_b32 v17, 0xffff0000, v48
  v_lshlrev_b32 v18, 16, v49
  v_and_b32 v19, 0xffff0000, v49
  v_lshlrev_b32 v20, 16, v50
  v_and_b32 v21, 0xffff0000, v50
  v_max3_u32 v92, v46, v47, v48
  v_max3_u32 v92, v49, v50, v92
  s_waitcnt vmcnt(30)
  v_dot2c_f32_bf16 v12, v51, v230
  v_dot2c_f32_bf16 v13, v51, v231
  v_dot2c_f32_bf16 v14, v52, v230
  v_dot2c_f32_bf16 v15, v52, v231
  v_dot2c_f32_bf16 v16, v53, v230
  v_dot2c_f32_bf16 v17, v53, v231
  v_dot2c_f32_bf16 v18, v54, v230
  v_dot2c_f32_bf16 v19, v54, v231
  v_dot2c_f32_bf16 v20, v55, v230
  v_dot2c_f32_bf16 v21, v55, v231
  v_max3_u32 v92, v51, v52, v92
  v_max3_u32 v92, v54, v55, v92
  v_max_u32 v92, v53, v92
  s_waitcnt vmcnt(25)
  v_dot2c_f32_bf16 v12, v56, v230
  v_dot2c_f32_bf16 v13, v56, v231
  v_dot2c_f32_bf16 v14, v57, v230
  v_dot2c_f32_bf16 v15, v57, v231
  v_dot2c_f32_bf16 v16, v58, v230
  v_dot2c_f32_bf16 v17, v58, v231
  v_dot2c_f32_bf16 v18, v59, v230
  v_dot2c_f32_bf16 v19, v59, v231
  v_dot2c_f32_bf16 v20, v60, v230
  v_dot2c_f32_bf16 v21, v60, v231
  v_max3_u32 v92, v56, v57, v92
  v_max3_u32 v92, v59, v60, v92
  v_max_u32 v92, v58, v92
  s_waitcnt vmcnt(20)
  v_dot2c_f32_bf16 v12, v61, v230
  v_dot2c_f32_bf16 v13, v61, v231
  v_dot2c_f32_bf16 v14, v62, v230
  v_dot2c_f32_bf16 v15, v62, v231
  v_dot2c_f32_bf16 v16, v63, v230
  v_dot2c_f32_bf16 v17, v63, v231
  v_dot2c_f32_bf16 v18, v64, v230
  v_dot2c_f32_bf16 v19, v64, v231
  v_dot2c_f32_bf16 v20, v65, v230
  v_dot2c_f32_bf16 v21, v65, v231
  v_max3_u32 v92, v61, v62, v92
  v_max3_u32 v92, v64, v65, v92
  v_max_u32 v92, v63, v92
  s_waitcnt vmcnt(15)
  v_dot2c_f32_bf16 v12, v66, v230
  v_dot2c_f32_bf16 v13, v66, v231
  v_dot2c_f32_bf16 v14, v67, v230
  v_dot2c_f32_bf16 v15, v67, v231
  v_dot2c_f32_bf16 v16, v68, v230
  v_dot2c_f32_bf16 v17, v68, v231
  v_dot2c_f32_bf16 v18, v69, v230
  v_dot2c_f32_bf16 v19, v69, v231
  v_dot2c_f32_bf16 v20, v70, v230
  v_dot2c_f32_bf16 v21, v70, v231
  v_max3_u32 v92, v66, v67, v92
  v_max3_u32 v92, v69, v70, v92
  v_max_u32 v92, v68, v92
  s_waitcnt vmcnt(10)
  v_dot2c_f32_bf16 v12, v71, v230
  v_dot2c_f32_bf16 v13, v71, v231
  v_dot2c_f32_bf16 v14, v72, v230
  v_dot2c_f32_bf16 v15, v72, v231
  v_dot2c_f32_bf16 v16, v73, v230
  v_dot2c_f32_bf16 v17, v73, v231
  v_dot2c_f32_bf16 v18, v74, v230
  v_dot2c_f32_bf16 v19, v74, v231
  v_dot2c_f32_bf16 v20, v75, v230
  v_dot2c_f32_bf16 v21, v75, v231
  v_max3_u32 v92, v71, v72, v92
  v_max3_u32 v92, v74, v75, v92
  v_max_u32 v92, v73, v92
  s_waitcnt vmcnt(5)
  v_dot2c_f32_bf16 v12, v76, v230
  v_dot2c_f32_bf16 v13, v76, v231
  v_dot2c_f32_bf16 v14, v77, v230
  v_dot2c_f32_bf16 v15, v77, v231
  v_dot2c_f32_bf16 v16, v78, v230
  v_dot2c_f32_bf16 v17, v78, v231
  v_dot2c_f32_bf16 v18, v79, v230
  v_dot2c_f32_bf16 v19, v79, v231
  v_dot2c_f32_bf16 v20, v80, v230
  v_dot2c_f32_bf16 v21, v80, v231
  v_max3_u32 v92, v76, v77, v92
  v_max3_u32 v92, v79, v80, v92
  v_max_u32 v92, v78, v92
  s_waitcnt vmcnt(0)
  v_dot2c_f32_bf16 v12, v81, v230
  v_dot2c_f32_bf16 v13, v81, v231
  v_dot2c_f32_bf16 v14, v82, v230
  v_dot2c_f32_bf16 v15, v82, v231
  v_dot2c_f32_bf16 v16, v83, v230
  v_dot2c_f32_bf16 v17, v83, v231
  v_dot2c_f32_bf16 v18, v84, v230
  v_dot2c_f32_bf16 v19, v84, v231
  v_dot2c_f32_bf16 v20, v85, v230
  v_dot2c_f32_bf16 v21, v85, v231
  v_max3_u32 v92, v81, v82, v92
  v_max3_u32 v92, v84, v85, v92
  v_max_u32 v92, v83, v92
  v_cmp_eq_u32 vcc, -1, v92
  s_cbranch_vccz r_ok
  s_sub_u32 s38, s38, 327680
  s_add_u32 s34, s34, 1
  s_cmp_gt_u32 s34, 65536
  s_cbranch_scc1 role_abort
  s_sleep 2
  s_branch r_ld
r_ok:
  v_cvt_pk_bf16_f32 v90, v12, v13
  v_lshlrev_b32 v12, 16, v90
  v_and_b32 v13, 0xffff0000, v90
  v_cvt_pk_bf16_f32 v90, v14, v15
  v_lshlrev_b32 v14, 16, v90
  v_and_b32 v15, 0xffff0000, v90
  v_cvt_pk_bf16_f32 v90, v16, v17
  v_lshlrev_b32 v16, 16, v90
  v_and_b32 v17, 0xffff0000, v90
  v_cvt_pk_bf16_f32 v90, v18, v19
  v_lshlrev_b32 v18, 16, v90
  v_and_b32 v19, 0xffff0000, v90
  v_cvt_pk_bf16_f32 v90, v20, v21
  v_lshlrev_b32 v20, 16, v90
  v_and_b32 v21, 0xffff0000, v90
  v_pk_mul_f32 v[12:13], v[12:13], v[196:197]
  v_cvt_pk_bf16_f32 v90, v12, v13
  v_lshlrev_b32 v12, 16, v90
  v_and_b32 v13, 0xffff0000, v90
  v_pk_mul_f32 v[14:15], v[14:15], v[198:199]
  v_cvt_pk_bf16_f32 v90, v14, v15
  v_lshlrev_b32 v14, 16, v90
  v_and_b32 v15, 0xffff0000, v90
  v_pk_mul_f32 v[16:17], v[16:17], v[200:201]
  v_cvt_pk_bf16_f32 v90, v16, v17
  v_lshlrev_b32 v16, 16, v90
  v_and_b32 v17, 0xffff0000, v90
  v_pk_mul_f32 v[18:19], v[18:19], v[202:203]
  v_cvt_pk_bf16_f32 v90, v18, v19
  v_lshlrev_b32 v18, 16, v90
  v_and_b32 v19, 0xffff0000, v90
  v_pk_mul_f32 v[20:21], v[20:21], v[204:205]
  v_cvt_pk_bf16_f32 v90, v20, v21
  v_lshlrev_b32 v20, 16, v90
  v_and_b32 v21, 0xffff0000, v90
  v_pk_add_f32 v[2:3], v[2:3], v[12:13]
  v_cvt_pk_bf16_f32 v34, v2, v3
  v_lshlrev_b32 v2, 16, v34
  v_and_b32 v3, 0xffff0000, v34
  v_pk_add_f32 v[4:5], v[4:5], v[14:15]
  v_cvt_pk_bf16_f32 v35, v4, v5
  v_lshlrev_b32 v4, 16, v35
  v_and_b32 v5, 0xffff0000, v35
  v_pk_add_f32 v[6:7], v[6:7], v[16:17]
  v_cvt_pk_bf16_f32 v36, v6, v7
  v_lshlrev_b32 v6, 16, v36
  v_and_b32 v7, 0xffff0000, v36
  v_pk_add_f32 v[8:9], v[8:9], v[18:19]
  v_cvt_pk_bf16_f32 v37, v8, v9
  v_lshlrev_b32 v8, 16, v37
  v_and_b32 v9, 0xffff0000, v37
  v_pk_add_f32 v[10:11], v[10:11], v[20:21]
  v_cvt_pk_bf16_f32 v38, v10, v11
  v_lshlrev_b32 v10, 16, v38
  v_and_b32 v11, 0xffff0000, v38
  s_add_u32 s35, s37, 5242880
  buffer_store_dword v34, v226, s[8:11], s35 offen offset:0 sc1
  buffer_store_dword v35, v226, s[8:11], s35 offen offset:256 sc1
  buffer_store_dword v36, v226, s[8:11], s35 offen offset:512 sc1
  buffer_store_dword v37, v226, s[8:11], s35 offen offset:768 sc1
  buffer_store_dword v38, v226, s[8:11], s35 offen offset:1024 sc1
  v_pk_add_f32 v[86:87], v[2:3], v[4:5]
  v_pk_add_f32 v[88:89], v[6:7], v[8:9]
  v_pk_add_f32 v[86:87], v[86:87], v[10:11]
  v_pk_add_f32 v[86:87], v[86:87], v[88:89]
  v_add_f32 v86, v86, v87
  s_nop 1
  v_add_f32_dpp v86, v86, v86 row_ror:8 row_mask:0xf bank_mask:0xf
  s_nop 1
  v_add_f32_dpp v86, v86, v86 row_ror:4 row_mask:0xf bank_mask:0xf
  s_nop 1
  v_add_f32_dpp v86, v86, v86 row_ror:2 row_mask:0xf bank_mask:0xf
  s_nop 1
  v_add_f32_dpp v86, v86, v86 row_ror:1 row_mask:0xf bank_mask:0xf
  v_mov_b32 v90, v86
  s_nop 1
  v_permlane16_swap_b32 v86, v90
  v_add_f32 v86, v86, v90
  v_mov_b32 v90, v86
  s_nop 1
  v_permlane32_swap_b32 v86, v90
  v_add_f32 v86, v86, v90
  v_mul_f32 v88, 0xbacccccd, v86
  v_mul_f32 v89, 0xbacccccd, v86
  v_pk_add_f32 v[12:13], v[2:3], v[88:89]
  v_pk_add_f32 v[14:15], v[4:5], v[88:89]
  v_pk_add_f32 v[16:17], v[6:7], v[88:89]
  v_pk_add_f32 v[18:19], v[8:9], v[88:89]
  v_pk_add_f32 v[20:21], v[10:11], v[88:89]
  v_pk_mul_f32 v[86:87], v[12:13], v[12:13]
  v_pk_fma_f32 v[86:87], v[14:15], v[14:15], v[86:87]
  v_pk_fma_f32 v[86:87], v[16:17], v[16:17], v[86:87]
  v_pk_fma_f32 v[86:87], v[18:19], v[18:19], v[86:87]
  v_pk_fma_f32 v[86:87], v[20:21], v[20:21], v[86:87]
  v_add_f32 v86, v86, v87
  v_cvt_pk_bf16_f32 v91, v88, v89
  v_lshlrev_b32 v88, 16, v91
  v_and_b32 v89, 0xffff0000, v91
  v_add_f32_dpp v86, v86, v86 row_ror:8 row_mask:0xf bank_mask:0xf
  s_nop 1
  v_add_f32_dpp v86, v86, v86 row_ror:4 row_mask:0xf bank_mask:0xf
  s_nop 1
  v_add_f32_dpp v86, v86, v86 row_ror:2 row_mask:0xf bank_mask:0xf
  s_nop 1
  v_add_f32_dpp v86, v86, v86 row_ror:1 row_mask:0xf bank_mask:0xf
  v_mov_b32 v90, v86
  s_nop 1
  v_permlane16_swap_b32 v86, v90
  v_add_f32 v86, v86, v90
  v_mov_b32 v90, v86
  s_nop 1
  v_permlane32_swap_b32 v86, v90
  v_add_f32 v86, v86, v90
  v_pk_add_f32 v[12:13], v[2:3], v[88:89]
  v_pk_add_f32 v[14:15], v[4:5], v[88:89]
  v_pk_add_f32 v[16:17], v[6:7], v[88:89]
  v_pk_add_f32 v[18:19], v[8:9], v[88:89]
  v_pk_add_f32 v[20:21], v[10:11], v[88:89]
  v_mul_f32 v86, 0x3acccccd, v86
  v_cvt_pk_bf16_f32 v86, v86, v86
  v_lshlrev_b32 v86, 16, v86
  v_add_f32 v86, 0x3727c5ac, v86
  v_cvt_pk_bf16_f32 v86, v86, v86
  v_lshlrev_b32 v86, 16, v86
  v_sqrt_f32 v86, v86
  v_cvt_pk_bf16_f32 v90, v12, v13
  v_lshlrev_b32 v12, 16, v90
  v_and_b32 v13, 0xffff0000, v90
  v_cvt_pk_bf16_f32 v86, v86, v86
  v_lshlrev_b32 v86, 16, v86
  v_rcp_f32 v86, v86
  v_cvt_pk_bf16_f32 v90, v14, v15
  v_lshlrev_b32 v14, 16, v90
  v_and_b32 v15, 0xffff0000, v90
  v_cvt_pk_bf16_f32 v90, v16, v17
  v_lshlrev_b32 v16, 16, v90
  v_and_b32 v17, 0xffff0000, v90
  v_cvt_pk_bf16_f32 v90, v18, v19
  v_lshlrev_b32 v18, 16, v90
  v_and_b32 v19, 0xffff0000, v90
  v_cvt_pk_bf16_f32 v90, v20, v21
  v_lshlrev_b32 v20, 16, v90
  v_and_b32 v21, 0xffff0000, v90
  v_mov_b32 v87, v86
  v_pk_mul_f32 v[12:13], v[12:13], v[86:87]
  v_cvt_pk_bf16_f32 v90, v12, v13
  v_lshlrev_b32 v12, 16, v90
  v_and_b32 v13, 0xffff0000, v90
  v_pk_mul_f32 v[14:15], v[14:15], v[86:87]
  v_cvt_pk_bf16_f32 v90, v14, v15
  v_lshlrev_b32 v14, 16, v90
  v_and_b32 v15, 0xffff0000, v90
  v_pk_mul_f32 v[16:17], v[16:17], v[86:87]
  v_cvt_pk_bf16_f32 v90, v16, v17
  v_lshlrev_b32 v16, 16, v90
  v_and_b32 v17, 0xffff0000, v90
  v_pk_mul_f32 v[18:19], v[18:19], v[86:87]
  v_cvt_pk_bf16_f32 v90, v18, v19
  v_lshlrev_b32 v18, 16, v90
  v_and_b32 v19, 0xffff0000, v90
  v_pk_mul_f32 v[20:21], v[20:21], v[86:87]
  v_cvt_pk_bf16_f32 v90, v20, v21
  v_lshlrev_b32 v20, 16, v90
  v_and_b32 v21, 0xffff0000, v90
  v_pk_mul_f32 v[12:13], v[12:13], v[176:177]
  v_cvt_pk_bf16_f32 v90, v12, v13
  v_lshlrev_b32 v12, 16, v90
  v_and_b32 v13, 0xffff0000, v90
  v_pk_mul_f32 v[14:15], v[14:15], v[178:179]
  v_cvt_pk_bf16_f32 v90, v14, v15
  v_lshlrev_b32 v14, 16, v90
  v_and_b32 v15, 0xffff0000, v90
  v_pk_mul_f32 v[16:17], v[16:17], v[180:181]
  v_cvt_pk_bf16_f32 v90, v16, v17
  v_lshlrev_b32 v16, 16, v90
  v_and_b32 v17, 0xffff0000, v90
  v_pk_mul_f32 v[18:19], v[18:19], v[182:183]
  v_cvt_pk_bf16_f32 v90, v18, v19
  v_lshlrev_b32 v18, 16, v90
  v_and_b32 v19, 0xffff0000, v90
  v_pk_mul_f32 v[20:21], v[20:21], v[184:185]
  v_cvt_pk_bf16_f32 v90, v20, v21
  v_lshlrev_b32 v20, 16, v90
  v_and_b32 v21, 0xffff0000, v90
  v_pk_add_f32 v[12:13], v[12:13], v[186:187]
  v_cvt_pk_bf16_f32 v28, v12, v13
  v_pk_add_f32 v[14:15], v[14:15], v[188:189]
  v_cvt_pk_bf16_f32 v29, v14, v15
  v_pk_add_f32 v[16:17], v[16:17], v[190:191]
  v_cvt_pk_bf16_f32 v30, v16, v17
  v_pk_add_f32 v[18:19], v[18:19], v[192:193]
  v_cvt_pk_bf16_f32 v31, v18, v19
  v_pk_add_f32 v[20:21], v[20:21], v[194:195]
  v_cvt_pk_bf16_f32 v32, v20, v21
  s_add_u32 s35, s37, 8388608
  buffer_store_dword v28, v226, s[8:11], s35 offen offset:0 sc1
  buffer_store_dword v29, v226, s[8:11], s35 offen offset:256 sc1
  buffer_store_dword v30, v226, s[8:11], s35 offen offset:512 sc1
  buffer_store_dword v31, v226, s[8:11], s35 offen offset:768 sc1
  buffer_store_dword v32, v226, s[8:11], s35 offen offset:1024 sc1
  v_lshlrev_b32 v12, 16, v28
  v_and_b32 v13, 0xffff0000, v28
  v_lshlrev_b32 v14, 16, v29
  v_and_b32 v15, 0xffff0000, v29
  v_lshlrev_b32 v16, 16, v30
  v_and_b32 v17, 0xffff0000, v30
  v_lshlrev_b32 v18, 16, v31
  v_and_b32 v19, 0xffff0000, v31
  v_lshlrev_b32 v20, 16, v32
  v_and_b32 v21, 0xffff0000, v32
  v_pk_mul_f32 v[86:87], v[12:13], v[216:217]
  v_pk_fma_f32 v[86:87], v[14:15], v[218:219], v[86:87]
  v_pk_fma_f32 v[86:87], v[16:17], v[220:221], v[86:87]
  v_pk_fma_f32 v[86:87], v[18:19], v[222:223], v[86:87]
  v_pk_fma_f32 v[86:87], v[20:21], v[224:225], v[86:87]
  v_add_f32 v86, v86, v87
  v_pk_mul_f32 v[12:13], v[12:13], v[206:207]
  v_cvt_pk_bf16_f32 v90, v12, v13
  v_lshlrev_b32 v12, 16, v90
  v_and_b32 v13, 0xffff0000, v90
  v_pk_mul_f32 v[14:15], v[14:15], v[208:209]
  v_cvt_pk_bf16_f32 v90, v14, v15
  v_lshlrev_b32 v14, 16, v90
  v_and_b32 v15, 0xffff0000, v90
  v_pk_mul_f32 v[16:17], v[16:17], v[210:211]
  v_cvt_pk_bf16_f32 v90, v16, v17
  v_lshlrev_b32 v16, 16, v90
  v_and_b32 v17, 0xffff0000, v90
  v_pk_mul_f32 v[18:19], v[18:19], v[212:213]
  v_cvt_pk_bf16_f32 v90, v18, v19
  v_lshlrev_b32 v18, 16, v90
  v_and_b32 v19, 0xffff0000, v90
  v_pk_mul_f32 v[20:21], v[20:21], v[214:215]
  v_cvt_pk_bf16_f32 v90, v20, v21
  v_lshlrev_b32 v20, 16, v90
  v_and_b32 v21, 0xffff0000, v90
  v_pk_add_f32 v[12:13], v[12:13], v[2:3]
  v_cvt_pk_bf16_f32 v40, v12, v13
  v_pk_add_f32 v[14:15], v[14:15], v[4:5]
  v_cvt_pk_bf16_f32 v41, v14, v15
  v_pk_add_f32 v[16:17], v[16:17], v[6:7]
  v_cvt_pk_bf16_f32 v42, v16, v17
  v_pk_add_f32 v[18:19], v[18:19], v[8:9]
  v_cvt_pk_bf16_f32 v43, v18, v19
  v_pk_add_f32 v[20:21], v[20:21], v[10:11]
  v_cvt_pk_bf16_f32 v44, v20, v21
  buffer_store_dword v40, v226, s[24:27], s37 offen offset:0 sc1
  buffer_store_dword v41, v226, s[24:27], s37 offen offset:256 sc1
  buffer_store_dword v42, v226, s[24:27], s37 offen offset:512 sc1
  buffer_store_dword v43, v226, s[24:27], s37 offen offset:768 sc1
  buffer_store_dword v44, v226, s[24:27], s37 offen offset:1024 sc1
  v_add_f32_dpp v86, v86, v86 row_ror:8 row_mask:0xf bank_mask:0xf
  s_nop 1
  v_add_f32_dpp v86, v86, v86 row_ror:4 row_mask:0xf bank_mask:0xf
  s_nop 1
  v_add_f32_dpp v86, v86, v86 row_ror:2 row_mask:0xf bank_mask:0xf
  s_nop 1
  v_add_f32_dpp v86, v86, v86 row_ror:1 row_mask:0xf bank_mask:0xf
  v_mov_b32 v90, v86
  s_nop 1
  v_permlane16_swap_b32 v86, v90
  v_add_f32 v86, v86, v90
  v_mov_b32 v90, v86
  s_nop 1
  v_permlane32_swap_b32 v86, v90
  v_add_f32 v86, v86, v90
  v_cvt_pk_bf16_f32 v86, v86, v86
  v_lshlrev_b32 v86, 16, v86
  v_ashrrev_i32 v90, 31, v86
  v_or_b32 v90, 0x80000000, v90
  v_xor_b32 v86, v86, v90
  v_and_b32 v86, 0xffff0000, v86
  s_sub_u32 s35, 2047, s40
  v_or_b32 v86, s35, v86
  s_lshr_b32 s35, s40, 2
  s_lshl_b32 s35, s35, 7
  s_lshl_b32 s36, s17, 2
  s_add_u32 s35, s35, s36
  s_add_u32 s35, s35, 2097152
  v_mov_b32 v91, s35
  s_waitcnt vmcnt(0)
  s_mov_b64 exec, 1
  buffer_store_dword v86, v91, s[8:11], 0 offen sc1
  s_mov_b64 exec, -1
  s_sub_u32 s53, s39, 3
  s_ashr_i32 s53, s53, 1
  s_cmp_ge_u32 s54, 60
  s_cbranch_scc1 moe_end
mc_22_chunk:
  s_cmp_ge_i32 s74, s53
  s_cbranch_scc1 mc_22_done
  s_mov_b32 s69, 0
mc_22_kp:
  buffer_load_dword v235, v234, s[8:11], s75 offen sc1
  s_add_u32 s69, s69, 1
  s_cmp_gt_u32 s69, 65536
  s_cbranch_scc1 role_abort
  s_waitcnt vmcnt(0)
  v_cmp_eq_u32 vcc, -1, v235
  s_cbranch_vccz mc_22_ins
  s_sleep 4
  s_branch mc_22_kp
mc_22_ins:
  v_cmp_lt_u32 vcc, s86, v235
  s_cbranch_vccz mc_22_nx
  s_ff1_i32_b64 s70, vcc
  v_readlane_b32 s76, v235, s70
  v_writelane_b32 v235, 0, s70
  s_min_u32 s77, s79, s76
  s_max_u32 s79, s79, s76
  s_min_u32 s76, s80, s77
  s_max_u32 s80, s80, s77
  s_min_u32 s77, s81, s76
  s_max_u32 s81, s81, s76
  s_min_u32 s76, s82, s77
  s_max_u32 s82, s82, s77
  s_min_u32 s77, s83, s76
  s_max_u32 s83, s83, s76
  s_min_u32 s76, s84, s77
  s_max_u32 s84, s84, s77
  s_min_u32 s77, s85, s76
  s_max_u32 s85, s85, s76
  s_min_u32 s76, s86, s77
  s_max_u32 s86, s86, s77
  s_branch mc_22_ins
mc_22_nx:
  s_add_u32 s75, s75, 2048
  s_add_u32 s74, s74, 1
  s_branch mc_22_chunk
mc_22_done:
  s_add_u32 s39, s39, 3
  s_cmp_lt_u32 s39, 60
  s_cbranch_scc1 r_loop
mc_23_chunk:
  s_cmp_ge_i32 s74, 29
  s_cbranch_scc1 mc_23_done
  s_mov_b32 s69, 0
mc_23_kp:
  buffer_load_dword v235, v234, s[8:11], s75 offen sc1
  s_add_u32 s69, s69, 1
  s_cmp_gt_u32 s69, 65536
  s_cbranch_scc1 role_abort
  s_waitcnt vmcnt(0)
  v_cmp_eq_u32 vcc, -1, v235
  s_cbranch_vccz mc_23_ins
  s_sleep 4
  s_branch mc_23_kp
mc_23_ins:
  v_cmp_lt_u32 vcc, s86, v235
  s_cbranch_vccz mc_23_nx
  s_ff1_i32_b64 s70, vcc
  v_readlane_b32 s76, v235, s70
  v_writelane_b32 v235, 0, s70
  s_min_u32 s77, s79, s76
  s_max_u32 s79, s79, s76
  s_min_u32 s76, s80, s77
  s_max_u32 s80, s80, s77
  s_min_u32 s77, s81, s76
  s_max_u32 s81, s81, s76
  s_min_u32 s76, s82, s77
  s_max_u32 s82, s82, s77
  s_min_u32 s77, s83, s76
  s_max_u32 s83, s83, s76
  s_min_u32 s76, s84, s77
  s_max_u32 s84, s84, s77
  s_min_u32 s77, s85, s76
  s_max_u32 s85, s85, s76
  s_min_u32 s76, s86, s77
  s_max_u32 s86, s86, s77
  s_branch mc_23_ins
mc_23_nx:
  s_add_u32 s75, s75, 2048
  s_add_u32 s74, s74, 1
  s_branch mc_23_chunk
mc_23_done:
  s_cmp_lg_u32 s54, 0
  s_cbranch_scc1 r_cz0
  s_sleep 40
r_cz0:
  s_cmp_lg_u32 s54, 1
  s_cbranch_scc1 r_cz1
  s_sleep 16
r_cz1:
  s_cmp_lg_u32 s54, 2
  s_cbranch_scc1 r_cz2
  s_sleep 0
r_cz2:
mc_24_chunk:
  s_cmp_ge_i32 s74, 30
  s_cbranch_scc1 mc_24_done
  s_mov_b32 s69, 0
mc_24_kp:
  buffer_load_dword v235, v234, s[8:11], s75 offen sc1
  s_add_u32 s69, s69, 1
  s_cmp_gt_u32 s69, 65536
  s_cbranch_scc1 role_abort
  s_waitcnt vmcnt(0)
  v_cmp_eq_u32 vcc, -1, v235
  s_cbranch_vccz mc_24_ins
  s_sleep 4
  s_branch mc_24_kp
mc_24_ins:
  v_cmp_lt_u32 vcc, s86, v235
  s_cbranch_vccz mc_24_nx
  s_ff1_i32_b64 s70, vcc
  v_readlane_b32 s76, v235, s70
  v_writelane_b32 v235, 0, s70
  s_min_u32 s77, s79, s76
  s_max_u32 s79, s79, s76
  s_min_u32 s76, s80, s77
  s_max_u32 s80, s80, s77
  s_min_u32 s77, s81, s76
  s_max_u32 s81, s81, s76
  s_min_u32 s76, s82, s77
  s_max_u32 s82, s82, s77
  s_min_u32 s77, s83, s76
  s_max_u32 s83, s83, s76
  s_min_u32 s76, s84, s77
  s_max_u32 s84, s84, s77
  s_min_u32 s77, s85, s76
  s_max_u32 s85, s85, s76
  s_min_u32 s76, s86, s77
  s_max_u32 s86, s86, s77
  s_branch mc_24_ins
mc_24_nx:
  s_add_u32 s75, s75, 2048
  s_add_u32 s74, s74, 1
  s_branch mc_24_chunk
mc_24_done:
  s_mov_b32 s87, s79
  s_mov_b32 s88, s80
  s_mov_b32 s89, s81
  s_mov_b32 s90, s82
  s_mov_b32 s91, s83
  s_mov_b32 s92, s84
  s_mov_b32 s93, s85
  s_mov_b32 s94, s86
  s_mov_b32 s95, 2326528
moe_pass:
  s_mov_b32 exec_lo, 0x1010101
  s_mov_b32 exec_hi, 0x1010101
  v_mov_b32 v120, s79
  s_mov_b32 exec_lo, 0x2020202
  s_mov_b32 exec_hi, 0x2020202
  v_mov_b32 v120, s80
  s_mov_b32 exec_lo, 0x4040404
  s_mov_b32 exec_hi, 0x4040404
  v_mov_b32 v120, s81
  s_mov_b32 exec_lo, 0x8080808
  s_mov_b32 exec_hi, 0x8080808
  v_mov_b32 v120, s82
  s_mov_b32 exec_lo, 0x10101010
  s_mov_b32 exec_hi, 0x10101010
  v_mov_b32 v120, s83
  s_mov_b32 exec_lo, 0x20202020
  s_mov_b32 exec_hi, 0x20202020
  v_mov_b32 v120, s84
  s_mov_b32 exec_lo, 0x40404040
  s_mov_b32 exec_hi, 0x40404040
  v_mov_b32 v120, s85
  s_mov_b32 exec_lo, 0x80808080
  s_mov_b32 exec_hi, 0x80808080
  v_mov_b32 v120, s86
  s_mov_b64 exec, -1
  v_and_b32 v124, 0x7ff, v120
  v_sub_u32 v124, 2047, v124
  v_mul_u32_u24 v122, 1280, v124
  v_lshrrev_b32 v125, 4, v1
  v_lshl_add_u32 v121, v125, 4, v122
  s_mul_i32 s70, s17, 320
  s_add_u32 s70, s70, 8388608
  buffer_load_dwordx4 v[4:7], v121, s[8:11], s70 offen offset:0 sc1
  buffer_load_dwordx4 v[8:11], v121, s[8:11], s70 offen offset:64 sc1
  buffer_load_dwordx4 v[12:15], v121, s[8:11], s70 offen offset:128 sc1
  buffer_load_dwordx4 v[16:19], v121, s[8:11], s70 offen offset:192 sc1
  buffer_load_dwordx4 v[20:23], v121, s[8:11], s70 offen offset:256 sc1
  v_bfe_u32 v125, v1, 3, 2
  s_min_u32 s72, s78, 39
  s_lshl_b32 s71, s72, 5
  v_lshl_add_u32 v126, v125, 3, s71
  v_add_u32 v122, v122, v126
  v_lshlrev_b32 v126, 1, v126
  s_mov_b32 s70, 5242880
  s_mov_b32 s71, 8388608
  s_mov_b32 s76, 78336
  buffer_load_dwordx2 v[128:129], v122, s[8:11], s70 offen sc1
  buffer_load_dwordx2 v[130:131], v122, s[8:11], s71 offen sc1
  buffer_load_dwordx4 v[132:135], v126, s[8:11], s76 offen sc1
  v_and_b32 v124, 0xffff0000, v120
  v_ashrrev_i32 v125, 31, v124
  v_not_b32 v125, v125
  v_or_b32 v125, 0x80000000, v125
  v_and_b32 v125, 0xffff0000, v125
  v_xor_b32 v124, v124, v125
  v_mul_f32 v124, 0xbfb8aa3b, v124
  v_exp_f32 v124, v124
  s_nop 0
  v_add_f32 v124, 1.0, v124
  v_rcp_f32 v124, v124
  s_nop 0
  v_cvt_pk_bf16_f32 v124, v124, v124
  v_lshlrev_b32 v123, 16, v124
  s_lshl_b32 s70, s17, 13
  v_add_u32 v126, s70, v233
  s_lshl_b32 s70, s17, 10
  v_add_u32 v127, s70, v233
  s_waitcnt vmcnt(7)
  v_mfma_f32_16x16x32_bf16 v[24:27], a[0:3], v[4:7], 0
  v_mfma_f32_16x16x32_bf16 v[28:31], a[20:23], v[4:7], 0
  v_mfma_f32_16x16x32_bf16 v[32:35], a[40:43], v[4:7], 0
  v_mfma_f32_16x16x32_bf16 v[36:39], a[60:63], v[4:7], 0
  v_mfma_f32_16x16x32_bf16 v[40:43], a[80:83], v[4:7], 0
  v_mfma_f32_16x16x32_bf16 v[44:47], a[100:103], v[4:7], 0
  v_mfma_f32_16x16x32_bf16 v[48:51], a[120:123], v[4:7], 0
  v_mfma_f32_16x16x32_bf16 v[52:55], a[140:143], v[4:7], 0
  s_waitcnt vmcnt(6)
  v_mfma_f32_16x16x32_bf16 v[24:27], a[4:7], v[8:11], v[24:27]
  v_mfma_f32_16x16x32_bf16 v[28:31], a[24:27], v[8:11], v[28:31]
  v_mfma_f32_16x16x32_bf16 v[32:35], a[44:47], v[8:11], v[32:35]
  v_mfma_f32_16x16x32_bf16 v[36:39], a[64:67], v[8:11], v[36:39]
  v_mfma_f32_16x16x32_bf16 v[40:43], a[84:87], v[8:11], v[40:43]
  v_mfma_f32_16x16x32_bf16 v[44:47], a[104:107], v[8:11], v[44:47]
  v_mfma_f32_16x16x32_bf16 v[48:51], a[124:127], v[8:11], v[48:51]
  v_mfma_f32_16x16x32_bf16 v[52:55], a[144:147], v[8:11], v[52:55]
  s_waitcnt vmcnt(5)
  v_mfma_f32_16x16x32_bf16 v[24:27], a[8:11], v[12:15], v[24:27]
  v_mfma_f32_16x16x32_bf16 v[28:31], a[28:31], v[12:15], v[28:31]
  v_mfma_f32_16x16x32_bf16 v[32:35], a[48:51], v[12:15], v[32:35]
  v_mfma_f32_16x16x32_bf16 v[36:39], a[68:71], v[12:15], v[36:39]
  v_mfma_f32_16x16x32_bf16 v[40:43], a[88:91], v[12:15], v[40:43]
  v_mfma_f32_16x16x32_bf16 v[44:47], a[108:111], v[12:15], v[44:47]
  v_mfma_f32_16x16x32_bf16 v[48:51], a[128:131], v[12:15], v[48:51]
  v_mfma_f32_16x16x32_bf16 v[52:55], a[148:151], v[12:15], v[52:55]
  s_waitcnt vmcnt(4)
  v_mfma_f32_16x16x32_bf16 v[24:27], a[12:15], v[16:19], v[24:27]
  v_mfma_f32_16x16x32_bf16 v[28:31], a[32:35], v[16:19], v[28:31]
  v_mfma_f32_16x16x32_bf16 v[32:35], a[52:55], v[16:19], v[32:35]
  v_mfma_f32_16x16x32_bf16 v[36:39], a[72:75], v[16:19], v[36:39]
  v_mfma_f32_16x16x32_bf16 v[40:43], a[92:95], v[16:19], v[40:43]
  v_mfma_f32_16x16x32_bf16 v[44:47], a[112:115], v[16:19], v[44:47]
  v_mfma_f32_16x16x32_bf16 v[48:51], a[132:135], v[16:19], v[48:51]
  v_mfma_f32_16x16x32_bf16 v[52:55], a[152:155], v[16:19], v[52:55]
  s_waitcnt vmcnt(3)
  v_mfma_f32_16x16x32_bf16 v[24:27], a[16:19], v[20:23], v[24:27]
  v_mfma_f32_16x16x32_bf16 v[28:31], a[36:39], v[20:23], v[28:31]
  v_mfma_f32_16x16x32_bf16 v[32:35], a[56:59], v[20:23], v[32:35]
  v_mfma_f32_16x16x32_bf16 v[36:39], a[76:79], v[20:23], v[36:39]
  v_mfma_f32_16x16x32_bf16 v[40:43], a[96:99], v[20:23], v[40:43]
  v_mfma_f32_16x16x32_bf16 v[44:47], a[116:119], v[20:23], v[44:47]
  v_mfma_f32_16x16x32_bf16 v[48:51], a[136:139], v[20:23], v[48:51]
  v_mfma_f32_16x16x32_bf16 v[52:55], a[156:159], v[20:23], v[52:55]
  s_nop 0
  ds_write_b128 v126, v[24:27] offset:0
  ds_write_b128 v126, v[28:31] offset:1024
  ds_write_b128 v126, v[32:35] offset:2048
  ds_write_b128 v126, v[36:39] offset:3072
  ds_write_b128 v126, v[40:43] offset:4096
  ds_write_b128 v126, v[44:47] offset:5120
  ds_write_b128 v126, v[48:51] offset:6144
  ds_write_b128 v126, v[52:55] offset:7168
  s_waitcnt lgkmcnt(0)
  s_barrier
  ds_read_b128 v[64:67], v127 offset:0
  ds_read_b128 v[80:83], v127 offset:4096
  ds_read_b128 v[68:71], v127 offset:8192
  ds_read_b128 v[84:87], v127 offset:12288
  ds_read_b128 v[72:75], v127 offset:16384
  ds_read_b128 v[88:91], v127 offset:20480
  ds_read_b128 v[76:79], v127 offset:24576
  ds_read_b128 v[92:95], v127 offset:28672
  s_waitcnt lgkmcnt(0)
  v_pk_add_f32 v[64:65], v[64:65], v[68:69]
  v_pk_add_f32 v[72:73], v[72:73], v[76:77]
  v_pk_add_f32 v[66:67], v[66:67], v[70:71]
  v_pk_add_f32 v[74:75], v[74:75], v[78:79]
  v_pk_add_f32 v[64:65], v[64:65], v[72:73]
  v_cvt_pk_bf16_f32 v124, v64, v65
  v_lshlrev_b32 v64, 16, v124
  v_and_b32 v65, 0xffff0000, v124
  v_pk_add_f32 v[66:67], v[66:67], v[74:75]
  v_cvt_pk_bf16_f32 v124, v66, v67
  v_lshlrev_b32 v66, 16, v124
  v_and_b32 v67, 0xffff0000, v124
  v_pk_add_f32 v[80:81], v[80:81], v[84:85]
  v_pk_add_f32 v[88:89], v[88:89], v[92:93]
  v_pk_add_f32 v[82:83], v[82:83], v[86:87]
  v_pk_add_f32 v[90:91], v[90:91], v[94:95]
  v_pk_add_f32 v[80:81], v[80:81], v[88:89]
  v_cvt_pk_bf16_f32 v124, v80, v81
  v_lshlrev_b32 v80, 16, v124
  v_and_b32 v81, 0xffff0000, v124
  v_pk_add_f32 v[82:83], v[82:83], v[90:91]
  v_cvt_pk_bf16_f32 v124, v82, v83
  v_lshlrev_b32 v82, 16, v124
  v_and_b32 v83, 0xffff0000, v124
  v_mul_f32 v140, 0xbfb8aa3b, v64
  v_mul_f32 v141, 0xbfb8aa3b, v65
  v_mul_f32 v142, 0xbfb8aa3b, v66
  v_mul_f32 v143, 0xbfb8aa3b, v67
  v_exp_f32 v140, v140
  v_exp_f32 v141, v141
  v_exp_f32 v142, v142
  v_exp_f32 v143, v143
  v_add_f32 v140, 1.0, v140
  v_add_f32 v141, 1.0, v141
  v_add_f32 v142, 1.0, v142
  v_add_f32 v143, 1.0, v143
  v_rcp_f32 v140, v140
  v_rcp_f32 v141, v141
  v_rcp_f32 v142, v142
  v_rcp_f32 v143, v143
  v_pk_mul_f32 v[64:65], v[64:65], v[140:141]
  v_cvt_pk_bf16_f32 v124, v64, v65
  v_lshlrev_b32 v64, 16, v124
  v_and_b32 v65, 0xffff0000, v124
  v_pk_mul_f32 v[64:65], v[64:65], v[80:81]
  v_cvt_pk_bf16_f32 v140, v64, v65
  v_pk_mul_f32 v[66:67], v[66:67], v[142:143]
  v_cvt_pk_bf16_f32 v124, v66, v67
  v_lshlrev_b32 v66, 16, v124
  v_and_b32 v67, 0xffff0000, v124
  v_pk_mul_f32 v[66:67], v[66:67], v[82:83]
  v_cvt_pk_bf16_f32 v141, v66, v67
  s_lshr_b32 s70, s17, 1
  s_lshl_b32 s70, s70, 10
  s_and_b32 s71, s17, 1
  s_lshl_b32 s71, s71, 3
  s_add_u32 s70, s70, s71
  v_add_u32 v126, s70, v233
  ds_write_b64 v126, v[140:141] offset:32768
  s_waitcnt lgkmcnt(0)
  s_barrier
  ds_read_b128 v[112:115], v233 offset:32768
  ds_read_b128 v[116:119], v233 offset:33792
  s_mul_i32 s70, s68, 20480
  s_mul_i32 s71, s17, 5120
  s_add_u32 s70, s70, s71
  s_add_u32 s70, s70, s95
  s_add_u32 s71, s70, 4096
  s_waitcnt lgkmcnt(0)
  v_mfma_f32_16x16x32_bf16 v[24:27], a[160:163], v[112:115], 0
  v_mfma_f32_16x16x32_bf16 v[28:31], a[168:171], v[112:115], 0
  v_mfma_f32_16x16x32_bf16 v[32:35], a[176:179], v[112:115], 0
  v_mfma_f32_16x16x32_bf16 v[36:39], a[184:187], v[112:115], 0
  v_mfma_f32_16x16x32_bf16 v[40:43], a[192:195], v[112:115], 0
  v_mfma_f32_16x16x32_bf16 v[44:47], a[200:203], v[112:115], 0
  v_mfma_f32_16x16x32_bf16 v[48:51], a[208:211], v[112:115], 0
  v_mfma_f32_16x16x32_bf16 v[52:55], a[216:219], v[112:115], 0
  v_mfma_f32_16x16x32_bf16 v[56:59], a[224:227], v[112:115], 0
  v_mfma_f32_16x16x32_bf16 v[60:63], a[232:235], v[112:115], 0
  v_mfma_f32_16x16x32_bf16 v[24:27], a[164:167], v[116:119], v[24:27]
  v_mfma_f32_16x16x32_bf16 v[28:31], a[172:175], v[116:119], v[28:31]
  v_mfma_f32_16x16x32_bf16 v[32:35], a[180:183], v[116:119], v[32:35]
  v_mfma_f32_16x16x32_bf16 v[36:39], a[188:191], v[116:119], v[36:39]
  v_mfma_f32_16x16x32_bf16 v[40:43], a[196:199], v[116:119], v[40:43]
  v_mfma_f32_16x16x32_bf16 v[44:47], a[204:207], v[116:119], v[44:47]
  v_mfma_f32_16x16x32_bf16 v[48:51], a[212:215], v[116:119], v[48:51]
  v_mfma_f32_16x16x32_bf16 v[52:55], a[220:223], v[116:119], v[52:55]
  v_mfma_f32_16x16x32_bf16 v[56:59], a[228:231], v[116:119], v[56:59]
  v_mfma_f32_16x16x32_bf16 v[60:63], a[236:239], v[116:119], v[60:63]
  s_mov_b32 exec_lo, 0x00ff00ff
  s_mov_b32 exec_hi, 0x00ff00ff
  buffer_store_dwordx4 v[24:27], v236, s[8:11], s70 offen offset:0 sc1
  buffer_store_dwordx4 v[28:31], v236, s[8:11], s70 offen offset:512 sc1
  buffer_store_dwordx4 v[32:35], v236, s[8:11], s70 offen offset:1024 sc1
  buffer_store_dwordx4 v[36:39], v236, s[8:11], s70 offen offset:1536 sc1
  buffer_store_dwordx4 v[40:43], v236, s[8:11], s70 offen offset:2048 sc1
  buffer_store_dwordx4 v[44:47], v236, s[8:11], s70 offen offset:2560 sc1
  buffer_store_dwordx4 v[48:51], v236, s[8:11], s70 offen offset:3072 sc1
  buffer_store_dwordx4 v[52:55], v236, s[8:11], s70 offen offset:3584 sc1
  buffer_store_dwordx4 v[56:59], v236, s[8:11], s71 offen offset:0 sc1
  buffer_store_dwordx4 v[60:63], v236, s[8:11], s71 offen offset:512 sc1
  s_mov_b64 exec, -1
  s_cmp_ge_u32 s78, 40
  s_cbranch_scc1 moe_mid
  s_lshl_b32 s72, s78, 9
  s_add_u32 s72, s72, s95
  s_sleep 8
  s_mov_b32 s69, 0
moe_yp:
  s_mov_b32 s70, s72
  buffer_load_dwordx4 v[64:67], v237, s[8:11], s70 offen sc1
  s_add_u32 s70, s70, 40960
  buffer_load_dwordx4 v[68:71], v237, s[8:11], s70 offen sc1
  s_add_u32 s70, s70, 40960
  buffer_load_dwordx4 v[72:75], v237, s[8:11], s70 offen sc1
  s_add_u32 s70, s70, 40960
  buffer_load_dwordx4 v[76:79], v237, s[8:11], s70 offen sc1
  s_add_u32 s70, s70, 40960
  buffer_load_dwordx4 v[80:83], v237, s[8:11], s70 offen sc1
  s_add_u32 s70, s70, 40960
  buffer_load_dwordx4 v[84:87], v237, s[8:11], s70 offen sc1
  s_add_u32 s70, s70, 40960
  buffer_load_dwordx4 v[88:91], v237, s[8:11], s70 offen sc1
  s_add_u32 s70, s70, 40960
  buffer_load_dwordx4 v[92:95], v237, s[8:11], s70 offen sc1
  s_add_u32 s70, s70, 40960
  buffer_load_dwordx4 v[96:99], v237, s[8:11], s70 offen sc1
  s_add_u32 s70, s70, 40960
  buffer_load_dwordx4 v[100:103], v237, s[8:11], s70 offen sc1
  s_add_u32 s70, s70, 40960
  buffer_load_dwordx4 v[104:107], v237, s[8:11], s70 offen sc1
  s_add_u32 s70, s70, 40960
  buffer_load_dwordx4 v[108:111], v237, s[8:11], s70 offen sc1
  s_add_u32 s70, s70, 40960
  s_add_u32 s69, s69, 1
  s_cmp_gt_u32 s69, 65536
  s_cbranch_scc1 role_abort
  s_waitcnt vmcnt(10)
  v_pk_add_f32 v[136:137], v[64:65], v[68:69]
  v_pk_add_f32 v[138:139], v[66:67], v[70:71]
  s_waitcnt vmcnt(9)
  v_pk_add_f32 v[136:137], v[136:137], v[72:73]
  v_pk_add_f32 v[138:139], v[138:139], v[74:75]
  s_waitcnt vmcnt(8)
  v_pk_add_f32 v[136:137], v[136:137], v[76:77]
  v_pk_add_f32 v[138:139], v[138:139], v[78:79]
  s_waitcnt vmcnt(7)
  v_pk_add_f32 v[136:137], v[136:137], v[80:81]
  v_pk_add_f32 v[138:139], v[138:139], v[82:83]
  s_waitcnt vmcnt(6)
  v_pk_add_f32 v[136:137], v[136:137], v[84:85]
  v_pk_add_f32 v[138:139], v[138:139], v[86:87]
  s_waitcnt vmcnt(5)
  v_pk_add_f32 v[136:137], v[136:137], v[88:89]
  v_pk_add_f32 v[138:139], v[138:139], v[90:91]
  s_waitcnt vmcnt(4)
  v_pk_add_f32 v[136:137], v[136:137], v[92:93]
  v_pk_add_f32 v[138:139], v[138:139], v[94:95]
  s_waitcnt vmcnt(3)
  v_pk_add_f32 v[136:137], v[136:137], v[96:97]
  v_pk_add_f32 v[138:139], v[138:139], v[98:99]
  s_waitcnt vmcnt(2)
  v_pk_add_f32 v[136:137], v[136:137], v[100:101]
  v_pk_add_f32 v[138:139], v[138:139], v[102:103]
  s_waitcnt vmcnt(1)
  v_pk_add_f32 v[136:137], v[136:137], v[104:105]
  v_pk_add_f32 v[138:139], v[138:139], v[106:107]
  s_waitcnt vmcnt(0)
  v_pk_add_f32 v[136:137], v[136:137], v[108:109]
  v_pk_add_f32 v[138:139], v[138:139], v[110:111]
  v_add_f32 v124, v136, v137
  v_add_f32 v125, v138, v139
  v_cmp_u_f32 vcc, v124, v125
  s_cbranch_vccz moe_yok
  s_sleep 2
  s_branch moe_yp
moe_yok:
  v_mov_b32 v140, v136
  v_mov_b32 v141, v137
  v_mov_b32 v142, v138
  v_mov_b32 v143, v139
  v_permlane32_swap_b32 v136, v140
  v_permlane32_swap_b32 v137, v141
  v_permlane32_swap_b32 v138, v142
  v_permlane32_swap_b32 v139, v143
  v_lshlrev_b32 v64, 16, v128
  v_and_b32 v65, 0xffff0000, v128
  v_lshlrev_b32 v68, 16, v130
  v_and_b32 v69, 0xffff0000, v130
  v_lshlrev_b32 v66, 16, v129
  v_and_b32 v67, 0xffff0000, v129
  v_lshlrev_b32 v70, 16, v131
  v_and_b32 v71, 0xffff0000, v131
  v_pk_add_f32 v[136:137], v[136:137], v[140:141]
  v_cvt_pk_bf16_f32 v124, v136, v137
  v_lshlrev_b32 v136, 16, v124
  v_and_b32 v137, 0xffff0000, v124
  v_mul_f32 v136, v136, v123
  v_mul_f32 v137, v137, v123
  v_cvt_pk_bf16_f32 v124, v136, v137
  v_lshlrev_b32 v136, 16, v124
  v_and_b32 v137, 0xffff0000, v124
  v_pk_add_f32 v[136:137], v[136:137], v[68:69]
  v_cvt_pk_bf16_f32 v124, v136, v137
  v_lshlrev_b32 v136, 16, v124
  v_and_b32 v137, 0xffff0000, v124
  v_pk_mul_f32 v[136:137], v[136:137], v[132:133]
  v_cvt_pk_bf16_f32 v124, v136, v137
  v_lshlrev_b32 v136, 16, v124
  v_and_b32 v137, 0xffff0000, v124
  v_pk_add_f32 v[136:137], v[136:137], v[64:65]
  v_cvt_pk_bf16_f32 v140, v136, v137
  v_pk_add_f32 v[138:139], v[138:139], v[142:143]
  v_cvt_pk_bf16_f32 v124, v138, v139
  v_lshlrev_b32 v138, 16, v124
  v_and_b32 v139, 0xffff0000, v124
  v_mul_f32 v138, v138, v123
  v_mul_f32 v139, v139, v123
  v_cvt_pk_bf16_f32 v124, v138, v139
  v_lshlrev_b32 v138, 16, v124
  v_and_b32 v139, 0xffff0000, v124
  v_pk_add_f32 v[138:139], v[138:139], v[70:71]
  v_cvt_pk_bf16_f32 v124, v138, v139
  v_lshlrev_b32 v138, 16, v124
  v_and_b32 v139, 0xffff0000, v124
  v_pk_mul_f32 v[138:139], v[138:139], v[134:135]
  v_cvt_pk_bf16_f32 v124, v138, v139
  v_lshlrev_b32 v138, 16, v124
  v_and_b32 v139, 0xffff0000, v124
  v_pk_add_f32 v[138:139], v[138:139], v[66:67]
  v_cvt_pk_bf16_f32 v141, v138, v139
moe_mid:
  s_cmp_lg_u32 s95, 2326528
  s_cbranch_scc1 moe_fin
mc_25_chunk:
  s_cmp_ge_i32 s74, 32
  s_cbranch_scc1 mc_25_done
  s_mov_b32 s69, 0
mc_25_kp:
  buffer_load_dword v235, v234, s[8:11], s75 offen sc1
  s_add_u32 s69, s69, 1
  s_cmp_gt_u32 s69, 65536
  s_cbranch_scc1 role_abort
  s_waitcnt vmcnt(0)
  v_cmp_eq_u32 vcc, -1, v235
  s_cbranch_vccz mc_25_ins
  s_sleep 4
  s_branch mc_25_kp
mc_25_ins:
  v_cmp_lt_u32 vcc, s86, v235
  s_cbranch_vccz mc_25_nx
  s_ff1_i32_b64 s70, vcc
  v_readlane_b32 s76, v235, s70
  v_writelane_b32 v235, 0, s70
  s_min_u32 s77, s79, s76
  s_max_u32 s79, s79, s76
  s_min_u32 s76, s80, s77
  s_max_u32 s80, s80, s77
  s_min_u32 s77, s81, s76
  s_max_u32 s81, s81, s76
  s_min_u32 s76, s82, s77
  s_max_u32 s82, s82, s77
  s_min_u32 s77, s83, s76
  s_max_u32 s83, s83, s76
  s_min_u32 s76, s84, s77
  s_max_u32 s84, s84, s77
  s_min_u32 s77, s85, s76
  s_max_u32 s85, s85, s76
  s_min_u32 s76, s86, s77
  s_max_u32 s86, s86, s77
  s_branch mc_25_ins
mc_25_nx:
  s_add_u32 s75, s75, 2048
  s_add_u32 s74, s74, 1
  s_branch mc_25_chunk
mc_25_done:
  s_add_u32 s95, s95, 491520
  s_cmp_lg_u32 s87, s79
  s_cbranch_scc1 moe_pass
  s_cmp_lg_u32 s88, s80
  s_cbranch_scc1 moe_pass
  s_cmp_lg_u32 s89, s81
  s_cbranch_scc1 moe_pass
  s_cmp_lg_u32 s90, s82
  s_cbranch_scc1 moe_pass
  s_cmp_lg_u32 s91, s83
  s_cbranch_scc1 moe_pass
  s_cmp_lg_u32 s92, s84
  s_cbranch_scc1 moe_pass
  s_cmp_lg_u32 s93, s85
  s_cbranch_scc1 moe_pass
  s_cmp_lg_u32 s94, s86
  s_cbranch_scc1 moe_pass
moe_fin:
  s_cmp_ge_u32 s78, 40
  s_cbranch_scc1 moe_end
  s_mov_b32 exec_hi, 0
  buffer_store_dwordx2 v[140:141], v122, s[24:27], 0 offen sc1
moe_end:
  s_endpgm
role_b:
  s_load_dwordx2 s[20:21], s[0:1], 16
  s_load_dwordx2 s[4:5], s[0:1], 24
  s_load_dwordx2 s[6:7], s[0:1], 32
  s_mov_b32 s22, 7864320
  s_mov_b32 s23, 0x00020000
  s_and_b32 s31, s17, 1
  s_lshl_b32 s24, s18, 1
  s_add_u32 s24, s24, s31
  s_lshl_b32 s32, s18, 2
  s_add_u32 s32, s32, s17
  s_sub_u32 s32, s32, 48
  s_lshr_b32 s27, s17, 1
  s_cmp_lt_u32 s18, 12
  s_cselect_b32 s24, s24, s32
  s_cselect_b32 s27, s27, 2
  s_mul_i32 s25, s24, 43
  s_lshr_b32 s25, s25, 8
  s_mul_i32 s32, s25, 6
  s_sub_u32 s26, s24, s32
  s_mul_i32 s33, s16, 1536
  s_lshr_b32 s32, s24, 1
  s_lshl_b32 s32, s32, 7
  s_add_u32 s33, s33, s32
  s_mul_i32 s32, s31, 983040
  s_add_u32 s33, s33, s32
  s_lshr_b32 s32, s17, 1
  s_mul_i32 s44, s32, 81920
  s_mul_i32 s34, s31, 10240
  s_add_u32 s34, s34, s44
  v_lshrrev_b32 v167, 4, v1
  v_and_b32 v167, 3, v167
  v_lshlrev_b32 v167, 1, v167
  v_and_b32 v4, 7, v1
  v_xor_b32 v4, v4, v167
  v_lshlrev_b32 v4, 4, v4
  v_lshrrev_b32 v167, 3, v1
  v_mul_u32_u24 v167, 12288, v167
  v_add_u32 v4, v4, v167
  s_waitcnt lgkmcnt(0)
  s_cmp_eq_u32 s27, 1
  s_cselect_b64 s[20:21], s[4:5], s[20:21]
  s_cmp_eq_u32 s27, 2
  s_cselect_b64 s[20:21], s[6:7], s[20:21]
  s_add_u32 m0, s34, 0
  s_add_u32 s32, s33, 0
  buffer_load_dwordx4 v4, s[20:23], s32 offen nt lds
  s_add_u32 m0, s34, 1024
  s_add_u32 s32, s33, 98304
  buffer_load_dwordx4 v4, s[20:23], s32 offen nt lds
  s_add_u32 m0, s34, 2048
  s_add_u32 s32, s33, 196608
  buffer_load_dwordx4 v4, s[20:23], s32 offen nt lds
  s_add_u32 m0, s34, 3072
  s_add_u32 s32, s33, 294912
  buffer_load_dwordx4 v4, s[20:23], s32 offen nt lds
  s_add_u32 m0, s34, 4096
  s_add_u32 s32, s33, 393216
  buffer_load_dwordx4 v4, s[20:23], s32 offen nt lds
  s_add_u32 m0, s34, 5120
  s_add_u32 s32, s33, 491520
  buffer_load_dwordx4 v4, s[20:23], s32 offen nt lds
  s_add_u32 m0, s34, 6144
  s_add_u32 s32, s33, 589824
  buffer_load_dwordx4 v4, s[20:23], s32 offen nt lds
  s_add_u32 m0, s34, 7168
  s_add_u32 s32, s33, 688128
  buffer_load_dwordx4 v4, s[20:23], s32 offen nt lds
  s_add_u32 m0, s34, 8192
  s_add_u32 s32, s33, 786432
  buffer_load_dwordx4 v4, s[20:23], s32 offen nt lds
  s_add_u32 m0, s34, 9216
  s_add_u32 s32, s33, 884736
  buffer_load_dwordx4 v4, s[20:23], s32 offen nt lds
  s_add_u32 m0, s34, 20480
  s_add_u32 s32, s33, 1966080
  buffer_load_dwordx4 v4, s[20:23], s32 offen nt lds
  s_add_u32 m0, s34, 21504
  s_add_u32 s32, s33, 2064384
  buffer_load_dwordx4 v4, s[20:23], s32 offen nt lds
  s_add_u32 m0, s34, 22528
  s_add_u32 s32, s33, 2162688
  buffer_load_dwordx4 v4, s[20:23], s32 offen nt lds
  s_add_u32 m0, s34, 23552
  s_add_u32 s32, s33, 2260992
  buffer_load_dwordx4 v4, s[20:23], s32 offen nt lds
  s_add_u32 m0, s34, 24576
  s_add_u32 s32, s33, 2359296
  buffer_load_dwordx4 v4, s[20:23], s32 offen nt lds
  s_add_u32 m0, s34, 25600
  s_add_u32 s32, s33, 2457600
  buffer_load_dwordx4 v4, s[20:23], s32 offen nt lds
  s_add_u32 m0, s34, 26624
  s_add_u32 s32, s33, 2555904
  buffer_load_dwordx4 v4, s[20:23], s32 offen nt lds
  s_add_u32 m0, s34, 27648
  s_add_u32 s32, s33, 2654208
  buffer_load_dwordx4 v4, s[20:23], s32 offen nt lds
  s_add_u32 m0, s34, 28672
  s_add_u32 s32, s33, 2752512
  buffer_load_dwordx4 v4, s[20:23], s32 offen nt lds
  s_add_u32 m0, s34, 29696
  s_add_u32 s32, s33, 2850816
  buffer_load_dwordx4 v4, s[20:23], s32 offen nt lds
  s_add_u32 m0, s34, 40960
  s_add_u32 s32, s33, 3932160
  buffer_load_dwordx4 v4, s[20:23], s32 offen nt lds
  s_add_u32 m0, s34, 41984
  s_add_u32 s32, s33, 4030464
  buffer_load_dwordx4 v4, s[20:23], s32 offen nt lds
  s_add_u32 m0, s34, 43008
  s_add_u32 s32, s33, 4128768
  buffer_load_dwordx4 v4, s[20:23], s32 offen nt lds
  s_add_u32 m0, s34, 44032
  s_add_u32 s32, s33, 4227072
  buffer_load_dwordx4 v4, s[20:23], s32 offen nt lds
  s_add_u32 m0, s34, 45056
  s_add_u32 s32, s33, 4325376
  buffer_load_dwordx4 v4, s[20:23], s32 offen nt lds
  s_add_u32 m0, s34, 46080
  s_add_u32 s32, s33, 4423680
  buffer_load_dwordx4 v4, s[20:23], s32 offen nt lds
  s_add_u32 m0, s34, 47104
  s_add_u32 s32, s33, 4521984
  buffer_load_dwordx4 v4, s[20:23], s32 offen nt lds
  s_add_u32 m0, s34, 48128
  s_add_u32 s32, s33, 4620288
  buffer_load_dwordx4 v4, s[20:23], s32 offen nt lds
  s_add_u32 m0, s34, 49152
  s_add_u32 s32, s33, 4718592
  buffer_load_dwordx4 v4, s[20:23], s32 offen nt lds
  s_add_u32 m0, s34, 50176
  s_add_u32 s32, s33, 4816896
  buffer_load_dwordx4 v4, s[20:23], s32 offen nt lds
  s_lshl_b32 s32, s31, 2
  s_xor_b32 s32, s32, 0
  v_lshrrev_b32 v167, 2, v1
  v_lshrrev_b32 v168, 1, v167
  v_and_b32 v168, 3, v168
  v_lshlrev_b32 v168, 1, v168
  v_bfe_u32 v172, v1, 1, 1
  v_add_u32 v172, s32, v172
  v_xor_b32 v172, v172, v168
  v_lshlrev_b32 v172, 4, v172
  v_lshlrev_b32 v167, 7, v167
  v_add_u32 v172, v172, v167
  v_and_b32 v167, 1, v1
  v_lshlrev_b32 v167, 3, v167
  v_add_u32 v172, v172, v167
  v_add_u32 v172, s44, v172
  s_lshl_b32 s32, s31, 2
  s_xor_b32 s32, s32, 2
  v_lshrrev_b32 v167, 2, v1
  v_lshrrev_b32 v168, 1, v167
  v_and_b32 v168, 3, v168
  v_lshlrev_b32 v168, 1, v168
  v_bfe_u32 v173, v1, 1, 1
  v_add_u32 v173, s32, v173
  v_xor_b32 v173, v173, v168
  v_lshlrev_b32 v173, 4, v173
  v_lshlrev_b32 v167, 7, v167
  v_add_u32 v173, v173, v167
  v_and_b32 v167, 1, v1
  v_lshlrev_b32 v167, 3, v167
  v_add_u32 v173, v173, v167
  v_add_u32 v173, s44, v173
  s_lshl_b32 s32, s31, 2
  s_xor_b32 s32, s32, 4
  v_lshrrev_b32 v167, 2, v1
  v_lshrrev_b32 v168, 1, v167
  v_and_b32 v168, 3, v168
  v_lshlrev_b32 v168, 1, v168
  v_bfe_u32 v174, v1, 1, 1
  v_add_u32 v174, s32, v174
  v_xor_b32 v174, v174, v168
  v_lshlrev_b32 v174, 4, v174
  v_lshlrev_b32 v167, 7, v167
  v_add_u32 v174, v174, v167
  v_and_b32 v167, 1, v1
  v_lshlrev_b32 v167, 3, v167
  v_add_u32 v174, v174, v167
  v_add_u32 v174, s44, v174
  s_lshl_b32 s32, s31, 2
  s_xor_b32 s32, s32, 6
  v_lshrrev_b32 v167, 2, v1
  v_lshrrev_b32 v168, 1, v167
  v_and_b32 v168, 3, v168
  v_lshlrev_b32 v168, 1, v168
  v_bfe_u32 v175, v1, 1, 1
  v_add_u32 v175, s32, v175
  v_xor_b32 v175, v175, v168
  v_lshlrev_b32 v175, 4, v175
  v_lshlrev_b32 v167, 7, v167
  v_add_u32 v175, v175, v167
  v_and_b32 v167, 1, v1
  v_lshlrev_b32 v167, 3, v167
  v_add_u32 v175, v175, v167
  v_add_u32 v175, s44, v175
  v_lshlrev_b32 v144, 4, v1
  v_lshlrev_b32 v145, 3, v1
  v_lshlrev_b32 v146, 2, v1
  s_mul_i32 s32, s17, 2560
  v_add_u32 v147, s32, v144
  s_add_u32 s32, s32, 2048
  v_add_u32 v148, s32, v146
  v_lshrrev_b32 v52, 4, v1
  v_and_b32 v53, 15, v1
  v_bfe_u32 v167, v1, 1, 1
  v_mul_u32_u24 v167, 0xaaaa, v167
  v_add_u32 v151, 0x4444, v167
  v_and_b32 v167, 1, v1
  v_mov_b32 v152, 0x05040100
  v_mov_b32 v168, 0x03020706
  v_cmp_eq_u32 vcc, 1, v167
  s_nop 1
  v_cndmask_b32 v152, v152, v168, vcc
  s_lshl_b32 s32, s17, 10
  s_add_u32 s32, s32, 10240
  v_lshl_add_u32 v149, v53, 5, s32
  s_lshr_b32 s32, s17, 1
  s_add_u32 s32, s32, 2
  v_lshlrev_b32 v167, s32, v52
  v_add_u32 v149, v149, v167
  v_and_b32 v167, 3, v1
  v_lshl_add_u32 v167, v52, 2, v167
  v_lshlrev_b32 v167, 4, v167
  v_bfe_u32 v168, v1, 3, 1
  v_lshl_add_u32 v167, v168, 8, v167
  v_bfe_u32 v168, v1, 2, 1
  v_lshl_add_u32 v150, v168, 3, v167
  v_bfe_u32 v167, v1, 2, 2
  v_lshlrev_b32 v167, 1, v167
  v_and_b32 v168, 1, v1
  v_add_u32 v167, v167, v168
  v_lshl_add_u32 v167, v52, 3, v167
  v_lshlrev_b32 v153, 4, v167
  v_lshlrev_b32 v167, 11, v52
  v_lshl_add_u32 v164, v53, 4, v167
  v_and_b32 v167, 7, v1
  v_lshlrev_b32 v167, 7, v167
  v_bfe_u32 v168, v1, 3, 1
  v_mul_u32_u24 v168, 6144, v168
  v_add_u32 v165, v167, v168
  s_mul_i32 s32, s31, 3072
  s_add_u32 s32, s32, 65536
  v_add_u32 v160, s32, v144
  s_mul_i32 s51, s31, 6144
  s_lshl_b32 s50, s31, 11
  s_sub_u32 s50, 1024, s50
  s_mul_i32 s32, s31, 20480
  v_add_u32 v159, s32, v144
  s_lshl_b32 s32, s31, 11
  s_add_u32 s32, s32, 65536
  v_add_u32 v161, s32, v144
  s_mov_b32 s54, 0xff00ff00
  s_mov_b32 s55, 0xff00ff00
  s_not_b64 s[52:53], s[54:55]
  s_cmp_eq_u32 s17, 0
  s_cselect_b64 s[52:53], s[52:53], s[54:55]
  s_mul_i32 s35, s16, 10240
  s_add_u32 s35, s35, 131072
  s_lshl_b32 s37, s16, 17
  s_lshl_b32 s32, s25, 13
  s_add_u32 s37, s37, s32
  s_add_u32 s37, s37, 3407872
  s_lshl_b32 s41, s16, 22
  s_add_u32 s41, s41, 67108864
  s_lshr_b32 s32, s24, 1
  s_lshl_b32 s39, s32, 10
  s_add_u32 s39, s39, s41
  s_add_u32 s39, s39, 589824
  s_mul_i32 s32, s27, 49152
  s_add_u32 s41, s41, s32
  s_mul_i32 s32, s25, 12288
  s_add_u32 s41, s41, s32
  s_lshl_b32 s32, s26, 10
  s_add_u32 s41, s41, s32
  s_mul_i32 s43, s16, 2621440
  s_add_u32 s43, s43, 247463936
  s_mul_i32 s32, s17, 10240
  s_add_u32 s43, s43, s32
  s_add_u32 s49, s32, 16384
  s_lshl_b32 s46, s16, 8
  v_add_u32 v157, s46, v146
  s_lshl_b32 s32, s25, 6
  s_add_u32 s32, s32, s46
  s_lshr_b32 s45, s26, 1
  s_lshl_b32 s45, s45, 2
  s_add_u32 s45, s45, s32
  s_add_u32 s48, s45, 48
  v_mov_b32 v155, s48
  s_add_u32 s45, s45, 12288
  s_lshl_b32 s48, s26, 2
  s_add_u32 s32, s32, s48
  s_add_u32 s48, s32, 12300
  s_cmp_lt_u32 s18, 12
  s_cselect_b32 s45, s45, s48
  v_mov_b32 v156, s45
  s_mul_i32 s48, s27, 24
  s_add_u32 s32, s32, s48
  s_add_u32 s32, s32, 0
  s_lshl_b32 s48, s24, 2
  s_add_u32 s48, s48, s46
  s_add_u32 s48, s48, 4096
  s_cmp_lt_u32 s18, 12
  s_cselect_b32 s32, s32, s48
  v_mov_b32 v154, s32
  s_lshl_b32 s47, s24, 13
  s_add_u32 s47, s47, s46
  s_add_u32 s47, s47, 16777216
  s_mov_b32 s28, 0
  s_mov_b32 s29, 0
  v_mov_b32 v169, 0
  v_mov_b32 v170, 0
  v_mov_b32 v72, -1
  v_mov_b32 v73, -1
  v_mov_b32 v74, -1
  v_mov_b32 v75, -1
  s_mov_b64 s[74:75], 0xffff
  v_add_u32 v167, 4096, v157
  v_cndmask_b32 v189, v157, v167, s[74:75]
  s_and_b32 s57, s24, 15
  s_add_u32 s57, s57, 24
  s_cmp_lt_u32 s18, 12
  s_cselect_b32 s57, s57, s24
  s_lshr_b32 s56, s57, 2
  s_mul_i32 s56, s56, 16384
  s_and_b32 s32, s57, 3
  s_lshl_b32 s32, s32, 11
  s_add_u32 s56, s56, s32
  s_add_u32 s56, s56, 16769024
  s_lshl_b32 s57, s57, 8
  v_and_b32 v168, 3, v1
  v_mov_b32 v132, 0x3f80
  v_cmp_eq_u32 vcc, 0, v168
  s_nop 1
  v_cndmask_b32 v133, v169, v132, vcc
  v_mov_b32 v132, 0x3f800000
  v_cmp_eq_u32 vcc, 1, v168
  s_nop 1
  v_cndmask_b32 v133, v133, v132, vcc
  v_lshrrev_b32 v167, 2, v53
  v_cmp_eq_u32 vcc, 0, v167
  s_nop 1
  v_cndmask_b32 v180, v169, v133, vcc
  v_cmp_eq_u32 vcc, 1, v167
  s_nop 1
  v_cndmask_b32 v181, v169, v133, vcc
  v_cmp_eq_u32 vcc, 2, v167
  s_nop 1
  v_cndmask_b32 v182, v169, v133, vcc
  v_cmp_eq_u32 vcc, 3, v167
  s_nop 1
  v_cndmask_b32 v183, v169, v133, vcc
  s_waitcnt vmcnt(20)
  s_lshl_b32 s31, s16, 2
  s_add_u32 s31, s31, 32
  v_mov_b32 v167, s31
  buffer_load_dword v166, v167, s[12:15], 0 offen sc1
  s_add_u32 m0, s34, 61440
  s_add_u32 s32, s33, 5898240
  buffer_load_dwordx4 v4, s[20:23], s32 offen nt lds
  s_add_u32 m0, s34, 62464
  s_add_u32 s32, s33, 5996544
  buffer_load_dwordx4 v4, s[20:23], s32 offen nt lds
  s_add_u32 m0, s34, 63488
  s_add_u32 s32, s33, 6094848
  buffer_load_dwordx4 v4, s[20:23], s32 offen nt lds
  s_add_u32 m0, s34, 64512
  s_add_u32 s32, s33, 6193152
  buffer_load_dwordx4 v4, s[20:23], s32 offen nt lds
  s_add_u32 m0, s34, 65536
  s_add_u32 s32, s33, 6291456
  buffer_load_dwordx4 v4, s[20:23], s32 offen nt lds
  s_add_u32 m0, s34, 66560
  s_add_u32 s32, s33, 6389760
  buffer_load_dwordx4 v4, s[20:23], s32 offen nt lds
  s_add_u32 m0, s34, 67584
  s_add_u32 s32, s33, 6488064
  buffer_load_dwordx4 v4, s[20:23], s32 offen nt lds
  s_add_u32 m0, s34, 68608
  s_add_u32 s32, s33, 6586368
  buffer_load_dwordx4 v4, s[20:23], s32 offen nt lds
  s_add_u32 m0, s34, 69632
  s_add_u32 s32, s33, 6684672
  buffer_load_dwordx4 v4, s[20:23], s32 offen nt lds
  s_add_u32 m0, s34, 70656
  s_add_u32 s32, s33, 6782976
  buffer_load_dwordx4 v4, s[20:23], s32 offen nt lds
  s_barrier
  ds_read_b64_tr_b16 v[192:193], v172 offset:0
  ds_read_b64_tr_b16 v[194:195], v172 offset:2048
  ds_read_b64_tr_b16 a[16:17], v173 offset:0
  ds_read_b64_tr_b16 a[18:19], v173 offset:2048
  ds_read_b64_tr_b16 a[96:97], v174 offset:0
  ds_read_b64_tr_b16 a[98:99], v174 offset:2048
  ds_read_b64_tr_b16 a[176:177], v175 offset:0
  ds_read_b64_tr_b16 a[178:179], v175 offset:2048
  s_waitcnt lgkmcnt(6)
  ds_read_b64_tr_b16 v[196:197], v172 offset:4096
  ds_read_b64_tr_b16 v[198:199], v172 offset:6144
  ds_read_b64_tr_b16 a[20:21], v173 offset:4096
  ds_read_b64_tr_b16 a[22:23], v173 offset:6144
  ds_read_b64_tr_b16 a[100:101], v174 offset:4096
  ds_read_b64_tr_b16 a[102:103], v174 offset:6144
  ds_read_b64_tr_b16 a[180:181], v175 offset:4096
  ds_read_b64_tr_b16 a[182:183], v175 offset:6144
  s_waitcnt lgkmcnt(6)
  ds_read_b64_tr_b16 v[200:201], v172 offset:8192
  ds_read_b64_tr_b16 v[202:203], v172 offset:10240
  ds_read_b64_tr_b16 a[24:25], v173 offset:8192
  ds_read_b64_tr_b16 a[26:27], v173 offset:10240
  ds_read_b64_tr_b16 a[104:105], v174 offset:8192
  ds_read_b64_tr_b16 a[106:107], v174 offset:10240
  ds_read_b64_tr_b16 a[184:185], v175 offset:8192
  ds_read_b64_tr_b16 a[186:187], v175 offset:10240
  s_waitcnt lgkmcnt(6)
  ds_read_b64_tr_b16 v[204:205], v172 offset:12288
  ds_read_b64_tr_b16 v[206:207], v172 offset:14336
  ds_read_b64_tr_b16 a[28:29], v173 offset:12288
  ds_read_b64_tr_b16 a[30:31], v173 offset:14336
  ds_read_b64_tr_b16 a[108:109], v174 offset:12288
  ds_read_b64_tr_b16 a[110:111], v174 offset:14336
  ds_read_b64_tr_b16 a[188:189], v175 offset:12288
  ds_read_b64_tr_b16 a[190:191], v175 offset:14336
  s_waitcnt lgkmcnt(6)
  ds_read_b64_tr_b16 v[208:209], v172 offset:16384
  ds_read_b64_tr_b16 v[210:211], v172 offset:18432
  ds_read_b64_tr_b16 a[32:33], v173 offset:16384
  ds_read_b64_tr_b16 a[34:35], v173 offset:18432
  ds_read_b64_tr_b16 a[112:113], v174 offset:16384
  ds_read_b64_tr_b16 a[114:115], v174 offset:18432
  ds_read_b64_tr_b16 a[192:193], v175 offset:16384
  ds_read_b64_tr_b16 a[194:195], v175 offset:18432
  s_waitcnt lgkmcnt(6)
  s_waitcnt vmcnt(21)
  s_barrier
  ds_read_b64_tr_b16 v[212:213], v172 offset:20480
  ds_read_b64_tr_b16 v[214:215], v172 offset:22528
  ds_read_b64_tr_b16 a[36:37], v173 offset:20480
  ds_read_b64_tr_b16 a[38:39], v173 offset:22528
  ds_read_b64_tr_b16 a[116:117], v174 offset:20480
  ds_read_b64_tr_b16 a[118:119], v174 offset:22528
  ds_read_b64_tr_b16 a[196:197], v175 offset:20480
  ds_read_b64_tr_b16 a[198:199], v175 offset:22528
  s_waitcnt lgkmcnt(6)
  ds_read_b64_tr_b16 v[216:217], v172 offset:24576
  ds_read_b64_tr_b16 v[218:219], v172 offset:26624
  ds_read_b64_tr_b16 a[40:41], v173 offset:24576
  ds_read_b64_tr_b16 a[42:43], v173 offset:26624
  ds_read_b64_tr_b16 a[120:121], v174 offset:24576
  ds_read_b64_tr_b16 a[122:123], v174 offset:26624
  ds_read_b64_tr_b16 a[200:201], v175 offset:24576
  ds_read_b64_tr_b16 a[202:203], v175 offset:26624
  s_waitcnt lgkmcnt(6)
  ds_read_b64_tr_b16 v[220:221], v172 offset:28672
  ds_read_b64_tr_b16 v[222:223], v172 offset:30720
  ds_read_b64_tr_b16 a[44:45], v173 offset:28672
  ds_read_b64_tr_b16 a[46:47], v173 offset:30720
  ds_read_b64_tr_b16 a[124:125], v174 offset:28672
  ds_read_b64_tr_b16 a[126:127], v174 offset:30720
  ds_read_b64_tr_b16 a[204:205], v175 offset:28672
  ds_read_b64_tr_b16 a[206:207], v175 offset:30720
  s_waitcnt lgkmcnt(6)
  ds_read_b64_tr_b16 v[224:225], v172 offset:32768
  ds_read_b64_tr_b16 v[226:227], v172 offset:34816
  ds_read_b64_tr_b16 a[48:49], v173 offset:32768
  ds_read_b64_tr_b16 a[50:51], v173 offset:34816
  ds_read_b64_tr_b16 a[128:129], v174 offset:32768
  ds_read_b64_tr_b16 a[130:131], v174 offset:34816
  ds_read_b64_tr_b16 a[208:209], v175 offset:32768
  ds_read_b64_tr_b16 a[210:211], v175 offset:34816
  s_waitcnt lgkmcnt(6)
  ds_read_b64_tr_b16 v[228:229], v172 offset:36864
  ds_read_b64_tr_b16 v[230:231], v172 offset:38912
  ds_read_b64_tr_b16 a[52:53], v173 offset:36864
  ds_read_b64_tr_b16 a[54:55], v173 offset:38912
  ds_read_b64_tr_b16 a[132:133], v174 offset:36864
  ds_read_b64_tr_b16 a[134:135], v174 offset:38912
  ds_read_b64_tr_b16 a[212:213], v175 offset:36864
  ds_read_b64_tr_b16 a[214:215], v175 offset:38912
  s_waitcnt lgkmcnt(6)
  s_waitcnt vmcnt(10)
  v_cmp_gt_u32 vcc, 1, v166
  s_cbranch_vccz b_g0
  s_lshl_b32 s30, s16, 2
  s_add_u32 s30, s30, 32
  v_mov_b32 v167, s30
  s_mov_b32 s30, 0
  s_mov_b64 exec, 1
gw_26:
  buffer_load_dword v168, v167, s[12:15], 0 offen sc1
  s_add_u32 s30, s30, 1
  s_cmp_gt_u32 s30, 65536
  s_cbranch_scc1 role_abort
  s_waitcnt vmcnt(0)
  v_cmp_gt_u32 vcc, 1, v168
  s_cbranch_vccz gk_27
  s_sleep 4
  s_branch gw_26
gk_27:
  s_mov_b64 exec, -1
b_g0:
  s_mov_b32 s33, 8192
  buffer_load_dword v158, v157, s[8:11], s33 offen sc1
  s_barrier
  v_add_u32 v172, 40960, v172
  v_add_u32 v173, 40960, v173
  v_add_u32 v174, 40960, v174
  v_add_u32 v175, 40960, v175
  ds_read_b64_tr_b16 v[232:233], v172 offset:0
  ds_read_b64_tr_b16 v[234:235], v172 offset:2048
  ds_read_b64_tr_b16 a[56:57], v173 offset:0
  ds_read_b64_tr_b16 a[58:59], v173 offset:2048
  ds_read_b64_tr_b16 a[136:137], v174 offset:0
  ds_read_b64_tr_b16 a[138:139], v174 offset:2048
  ds_read_b64_tr_b16 a[216:217], v175 offset:0
  ds_read_b64_tr_b16 a[218:219], v175 offset:2048
  s_waitcnt lgkmcnt(6)
  ds_read_b64_tr_b16 v[236:237], v172 offset:4096
  ds_read_b64_tr_b16 v[238:239], v172 offset:6144
  ds_read_b64_tr_b16 a[60:61], v173 offset:4096
  ds_read_b64_tr_b16 a[62:63], v173 offset:6144
  ds_read_b64_tr_b16 a[140:141], v174 offset:4096
  ds_read_b64_tr_b16 a[142:143], v174 offset:6144
  ds_read_b64_tr_b16 a[220:221], v175 offset:4096
  ds_read_b64_tr_b16 a[222:223], v175 offset:6144
  s_waitcnt lgkmcnt(6)
  ds_read_b64_tr_b16 v[240:241], v172 offset:8192
  ds_read_b64_tr_b16 v[242:243], v172 offset:10240
  ds_read_b64_tr_b16 a[64:65], v173 offset:8192
  ds_read_b64_tr_b16 a[66:67], v173 offset:10240
  ds_read_b64_tr_b16 a[144:145], v174 offset:8192
  ds_read_b64_tr_b16 a[146:147], v174 offset:10240
  ds_read_b64_tr_b16 a[224:225], v175 offset:8192
  ds_read_b64_tr_b16 a[226:227], v175 offset:10240
  s_waitcnt lgkmcnt(6)
  ds_read_b64_tr_b16 v[244:245], v172 offset:12288
  ds_read_b64_tr_b16 v[246:247], v172 offset:14336
  ds_read_b64_tr_b16 a[68:69], v173 offset:12288
  ds_read_b64_tr_b16 a[70:71], v173 offset:14336
  ds_read_b64_tr_b16 a[148:149], v174 offset:12288
  ds_read_b64_tr_b16 a[150:151], v174 offset:14336
  ds_read_b64_tr_b16 a[228:229], v175 offset:12288
  ds_read_b64_tr_b16 a[230:231], v175 offset:14336
  s_waitcnt lgkmcnt(6)
  ds_read_b64_tr_b16 v[248:249], v172 offset:16384
  ds_read_b64_tr_b16 v[250:251], v172 offset:18432
  ds_read_b64_tr_b16 a[72:73], v173 offset:16384
  ds_read_b64_tr_b16 a[74:75], v173 offset:18432
  ds_read_b64_tr_b16 a[152:153], v174 offset:16384
  ds_read_b64_tr_b16 a[154:155], v174 offset:18432
  ds_read_b64_tr_b16 a[232:233], v175 offset:16384
  ds_read_b64_tr_b16 a[234:235], v175 offset:18432
  s_waitcnt lgkmcnt(6)
  s_waitcnt vmcnt(0)
  s_waitcnt lgkmcnt(0)
  s_barrier
  s_mov_b32 s44, s49
  s_mov_b32 s30, 0
  s_branch pc_30
pw_28:
  buffer_load_dword v158, v157, s[8:11], s33 offen sc1
  s_add_u32 s30, s30, 1
  s_cmp_gt_u32 s30, 65536
  s_cbranch_scc1 role_abort
  s_waitcnt vmcnt(0)
pc_30:
  v_cmp_gt_u32 vcc, 2, v158
  s_nop 0
  s_and_b32 vcc_lo, vcc_lo, 0xfff
  s_and_b32 vcc_hi, vcc_hi, 0x0
  s_cmp_eq_u64 vcc, 0
  s_cbranch_scc1 po_29
  s_sleep 4
  s_branch pw_28
po_29:
  s_add_u32 m0, s44, 0
  s_add_u32 s31, s43, 0
  buffer_load_dwordx4 v144, s[8:11], s31 offen offset:0 sc1 lds
  buffer_load_dwordx4 v144, s[8:11], s31 offen offset:1024 sc1 lds
  buffer_load_dwordx4 v144, s[8:11], s31 offen offset:2048 sc1 lds
  buffer_load_dwordx4 v144, s[8:11], s31 offen offset:3072 sc1 lds
  s_add_u32 m0, s44, 4096
  s_add_u32 s31, s43, 4096
  buffer_load_dwordx4 v144, s[8:11], s31 offen offset:0 sc1 lds
  buffer_load_dwordx4 v144, s[8:11], s31 offen offset:1024 sc1 lds
  buffer_load_dwordx4 v144, s[8:11], s31 offen offset:2048 sc1 lds
  buffer_load_dwordx4 v144, s[8:11], s31 offen offset:3072 sc1 lds
  s_add_u32 m0, s44, 8192
  s_add_u32 s31, s43, 8192
  buffer_load_dwordx4 v144, s[8:11], s31 offen offset:0 sc1 lds
  buffer_load_dwordx4 v144, s[8:11], s31 offen offset:1024 sc1 lds
  buffer_load_dword v158, v157, s[8:11], s33 offen sc1
  ds_read_b64_tr_b16 v[252:253], v172 offset:20480
  ds_read_b64_tr_b16 v[254:255], v172 offset:22528
  ds_read_b64_tr_b16 a[76:77], v173 offset:20480
  ds_read_b64_tr_b16 a[78:79], v173 offset:22528
  ds_read_b64_tr_b16 a[156:157], v174 offset:20480
  ds_read_b64_tr_b16 a[158:159], v174 offset:22528
  ds_read_b64_tr_b16 a[236:237], v175 offset:20480
  ds_read_b64_tr_b16 a[238:239], v175 offset:22528
  s_waitcnt lgkmcnt(6)
  ds_read_b64_tr_b16 a[0:1], v172 offset:24576
  ds_read_b64_tr_b16 a[2:3], v172 offset:26624
  ds_read_b64_tr_b16 a[80:81], v173 offset:24576
  ds_read_b64_tr_b16 a[82:83], v173 offset:26624
  ds_read_b64_tr_b16 a[160:161], v174 offset:24576
  ds_read_b64_tr_b16 a[162:163], v174 offset:26624
  ds_read_b64_tr_b16 a[240:241], v175 offset:24576
  ds_read_b64_tr_b16 a[242:243], v175 offset:26624
  s_waitcnt lgkmcnt(6)
  ds_read_b64_tr_b16 a[4:5], v172 offset:28672
  ds_read_b64_tr_b16 a[6:7], v172 offset:30720
  ds_read_b64_tr_b16 a[84:85], v173 offset:28672
  ds_read_b64_tr_b16 a[86:87], v173 offset:30720
  ds_read_b64_tr_b16 a[164:165], v174 offset:28672
  ds_read_b64_tr_b16 a[166:167], v174 offset:30720
  ds_read_b64_tr_b16 a[244:245], v175 offset:28672
  ds_read_b64_tr_b16 a[246:247], v175 offset:30720
  s_waitcnt lgkmcnt(6)
  ds_read_b64_tr_b16 a[8:9], v172 offset:32768
  ds_read_b64_tr_b16 a[10:11], v172 offset:34816
  ds_read_b64_tr_b16 a[88:89], v173 offset:32768
  ds_read_b64_tr_b16 a[90:91], v173 offset:34816
  ds_read_b64_tr_b16 a[168:169], v174 offset:32768
  ds_read_b64_tr_b16 a[170:171], v174 offset:34816
  ds_read_b64_tr_b16 a[248:249], v175 offset:32768
  ds_read_b64_tr_b16 a[250:251], v175 offset:34816
  s_waitcnt lgkmcnt(6)
  ds_read_b64_tr_b16 a[12:13], v172 offset:36864
  ds_read_b64_tr_b16 a[14:15], v172 offset:38912
  ds_read_b64_tr_b16 a[92:93], v173 offset:36864
  ds_read_b64_tr_b16 a[94:95], v173 offset:38912
  ds_read_b64_tr_b16 a[172:173], v174 offset:36864
  ds_read_b64_tr_b16 a[174:175], v174 offset:38912
  ds_read_b64_tr_b16 a[252:253], v175 offset:36864
  ds_read_b64_tr_b16 a[254:255], v175 offset:38912
  s_waitcnt lgkmcnt(6)
  s_waitcnt lgkmcnt(0)
  s_xor_b32 s44, s44, 0x10000
  s_add_u32 s43, s43, 40960
  s_waitcnt vmcnt(0)
  s_barrier
  s_cmp_ge_u32 s18, 12
  s_cbranch_scc1 b_pro3
  s_cmp_lt_u32 s17, 2
  s_cbranch_scc1 b_pro0
  s_cmp_eq_u32 s17, 2
  s_cbranch_scc1 b_pro1
  s_branch b_pro2
b_pro0:
  s_lshr_b32 s31, s26, 1
  s_lshl_b32 s31, s31, 10
  s_cmp_eq_u32 s17, 0
  s_cselect_b32 s46, s31, 3072
  s_add_u32 s46, s46, s37
  s_add_u32 s37, s37, s31
.p2align 7
b_top0:
  s_add_u32 s31, s28, 3
  s_and_b32 s31, s31, 3
  s_mul_i32 s31, s31, 163840
  s_add_u32 s58, s56, s31
  s_add_u32 s59, s58, 16384
  s_add_u32 s60, s58, 32768
  s_cmp_ge_u32 s29, 64
  s_cbranch_scc1 b_step00
  ds_read_b128 v[116:119], v159 offset:16384
  ds_read_b128 v[120:123], v159 offset:17408
  ds_read_b128 v[124:127], v159 offset:18432
  s_and_b32 s31, s29, 3
  s_mul_i32 s31, s31, 147456
  s_add_u32 s42, s41, s31
  s_add_u32 s42, s42, s51
  s_add_u32 s49, s29, 2
  s_lshl_b32 s48, s49, 1
  s_min_u32 s48, s48, 128
  s_and_b32 s31, s29, 3
  s_lshl_b32 s31, s31, 12
  v_add_u32 v162, s31, v160
  v_xor_b32 v176, 1024, v162
  s_add_u32 s29, s29, 1
  s_mov_b32 s33, 4096
  s_max_u32 s31, s29, 4
  s_sub_u32 s31, s31, 4
  v_mov_b32 v190, s31
  v_mov_b32 v167, s48
  v_cndmask_b32 v190, v190, v167, s[74:75]
  s_waitcnt lgkmcnt(2)
  v_mfma_f32_16x16x32_bf16 v[100:103], v[192:195], v[116:119], 0
  ds_read_b128 v[128:131], v159 offset:19456
  v_mfma_f32_16x16x32_bf16 v[104:107], a[16:19], v[116:119], 0
  v_mfma_f32_16x16x32_bf16 v[108:111], a[96:99], v[116:119], 0
  v_mfma_f32_16x16x32_bf16 v[112:115], a[176:179], v[116:119], 0
  s_waitcnt lgkmcnt(2)
  v_mfma_f32_16x16x32_bf16 v[100:103], v[196:199], v[120:123], v[100:103]
  ds_read_b128 v[116:119], v159 offset:20480
  v_mfma_f32_16x16x32_bf16 v[104:107], a[20:23], v[120:123], v[104:107]
  v_mfma_f32_16x16x32_bf16 v[108:111], a[100:103], v[120:123], v[108:111]
  v_mfma_f32_16x16x32_bf16 v[112:115], a[180:183], v[120:123], v[112:115]
  s_waitcnt lgkmcnt(2)
  v_mfma_f32_16x16x32_bf16 v[100:103], v[200:203], v[124:127], v[100:103]
  ds_read_b128 v[120:123], v159 offset:21504
  v_mfma_f32_16x16x32_bf16 v[104:107], a[24:27], v[124:127], v[104:107]
  s_mov_b32 s30, 0
  s_branch pc_33
pw_31:
  buffer_load_dword v158, v189, s[8:11], s33 offen sc1
  s_add_u32 s30, s30, 1
  s_cmp_gt_u32 s30, 65536
  s_cbranch_scc1 role_abort
  s_waitcnt vmcnt(0)
pc_33:
  v_cmp_gt_u32 vcc, v190, v158
  s_nop 0
  s_and_b32 vcc_lo, vcc_lo, 0xf000fff
  s_and_b32 vcc_hi, vcc_hi, 0x0
  s_cmp_eq_u64 vcc, 0
  s_cbranch_scc1 po_32
  s_sleep 4
  s_branch pw_31
po_32:
  v_mfma_f32_16x16x32_bf16 v[108:111], a[104:107], v[124:127], v[108:111]
  v_mfma_f32_16x16x32_bf16 v[112:115], a[184:187], v[124:127], v[112:115]
  s_add_u32 m0, s44, 0
  s_add_u32 s31, s43, 0
  buffer_load_dwordx4 v144, s[8:11], s31 offen offset:0 sc1 lds
  s_waitcnt lgkmcnt(2)
  v_mfma_f32_16x16x32_bf16 v[100:103], v[204:207], v[128:131], v[100:103]
  ds_read_b128 v[124:127], v159 offset:22528
  v_mfma_f32_16x16x32_bf16 v[104:107], a[28:31], v[128:131], v[104:107]
  v_mfma_f32_16x16x32_bf16 v[108:111], a[108:111], v[128:131], v[108:111]
  v_mfma_f32_16x16x32_bf16 v[112:115], a[188:191], v[128:131], v[112:115]
  buffer_load_dwordx4 v144, s[8:11], s31 offen offset:1024 sc1 lds
  s_waitcnt lgkmcnt(2)
  v_mfma_f32_16x16x32_bf16 v[100:103], v[208:211], v[116:119], v[100:103]
  ds_read_b128 v[128:131], v159 offset:23552
  v_mfma_f32_16x16x32_bf16 v[104:107], a[32:35], v[116:119], v[104:107]
  v_mfma_f32_16x16x32_bf16 v[108:111], a[112:115], v[116:119], v[108:111]
  v_mfma_f32_16x16x32_bf16 v[112:115], a[192:195], v[116:119], v[112:115]
  buffer_load_dwordx4 v144, s[8:11], s31 offen offset:2048 sc1 lds
  s_waitcnt lgkmcnt(2)
  v_mfma_f32_16x16x32_bf16 v[100:103], v[212:215], v[120:123], v[100:103]
  ds_read_b128 v[116:119], v159 offset:24576
  v_mfma_f32_16x16x32_bf16 v[104:107], a[36:39], v[120:123], v[104:107]
  v_mfma_f32_16x16x32_bf16 v[108:111], a[116:119], v[120:123], v[108:111]
  v_mfma_f32_16x16x32_bf16 v[112:115], a[196:199], v[120:123], v[112:115]
  buffer_load_dwordx4 v144, s[8:11], s31 offen offset:3072 sc1 lds
  s_waitcnt lgkmcnt(2)
  v_mfma_f32_16x16x32_bf16 v[100:103], v[216:219], v[124:127], v[100:103]
  ds_read_b128 v[120:123], v159 offset:25600
  v_mfma_f32_16x16x32_bf16 v[104:107], a[40:43], v[124:127], v[104:107]
  v_mfma_f32_16x16x32_bf16 v[108:111], a[120:123], v[124:127], v[108:111]
  v_mfma_f32_16x16x32_bf16 v[112:115], a[200:203], v[124:127], v[112:115]
  s_add_u32 m0, s44, 4096
  s_add_u32 s31, s43, 4096
  buffer_load_dwordx4 v144, s[8:11], s31 offen offset:0 sc1 lds
  s_waitcnt lgkmcnt(2)
  v_mfma_f32_16x16x32_bf16 v[100:103], v[220:223], v[128:131], v[100:103]
  ds_read_b128 v[124:127], v159 offset:26624
  v_mfma_f32_16x16x32_bf16 v[104:107], a[44:47], v[128:131], v[104:107]
  v_mfma_f32_16x16x32_bf16 v[108:111], a[124:127], v[128:131], v[108:111]
  v_mfma_f32_16x16x32_bf16 v[112:115], a[204:207], v[128:131], v[112:115]
  buffer_load_dwordx4 v144, s[8:11], s31 offen offset:1024 sc1 lds
  s_waitcnt lgkmcnt(2)
  v_mfma_f32_16x16x32_bf16 v[100:103], v[224:227], v[116:119], v[100:103]
  ds_read_b128 v[128:131], v159 offset:27648
  v_mfma_f32_16x16x32_bf16 v[104:107], a[48:51], v[116:119], v[104:107]
  v_mfma_f32_16x16x32_bf16 v[108:111], a[128:131], v[116:119], v[108:111]
  v_mfma_f32_16x16x32_bf16 v[112:115], a[208:211], v[116:119], v[112:115]
  buffer_load_dwordx4 v144, s[8:11], s31 offen offset:2048 sc1 lds
  s_waitcnt lgkmcnt(2)
  v_mfma_f32_16x16x32_bf16 v[100:103], v[228:231], v[120:123], v[100:103]
  ds_read_b128 v[116:119], v159 offset:28672
  v_mfma_f32_16x16x32_bf16 v[104:107], a[52:55], v[120:123], v[104:107]
  v_mfma_f32_16x16x32_bf16 v[108:111], a[132:135], v[120:123], v[108:111]
  v_mfma_f32_16x16x32_bf16 v[112:115], a[212:215], v[120:123], v[112:115]
  buffer_load_dwordx4 v144, s[8:11], s31 offen offset:3072 sc1 lds
  s_waitcnt lgkmcnt(2)
  v_mfma_f32_16x16x32_bf16 v[100:103], v[232:235], v[124:127], v[100:103]
  ds_read_b128 v[120:123], v159 offset:29696
  v_mfma_f32_16x16x32_bf16 v[104:107], a[56:59], v[124:127], v[104:107]
  v_mfma_f32_16x16x32_bf16 v[108:111], a[136:139], v[124:127], v[108:111]
  v_mfma_f32_16x16x32_bf16 v[112:115], a[216:219], v[124:127], v[112:115]
  s_add_u32 m0, s44, 8192
  s_add_u32 s31, s43, 8192
  buffer_load_dwordx4 v144, s[8:11], s31 offen offset:0 sc1 lds
  s_waitcnt lgkmcnt(2)
  v_mfma_f32_16x16x32_bf16 v[100:103], v[236:239], v[128:131], v[100:103]
  ds_read_b128 v[124:127], v159 offset:30720
  v_mfma_f32_16x16x32_bf16 v[104:107], a[60:63], v[128:131], v[104:107]
  v_mfma_f32_16x16x32_bf16 v[108:111], a[140:143], v[128:131], v[108:111]
  v_mfma_f32_16x16x32_bf16 v[112:115], a[220:223], v[128:131], v[112:115]
  buffer_load_dwordx4 v144, s[8:11], s31 offen offset:1024 sc1 lds
  s_waitcnt lgkmcnt(2)
  v_mfma_f32_16x16x32_bf16 v[100:103], v[240:243], v[116:119], v[100:103]
  ds_read_b128 v[128:131], v159 offset:31744
  v_mfma_f32_16x16x32_bf16 v[104:107], a[64:67], v[116:119], v[104:107]
  v_mfma_f32_16x16x32_bf16 v[108:111], a[144:147], v[116:119], v[108:111]
  v_mfma_f32_16x16x32_bf16 v[112:115], a[224:227], v[116:119], v[112:115]
  buffer_load_dword v158, v189, s[8:11], s33 offen sc1
  s_waitcnt lgkmcnt(2)
  v_mfma_f32_16x16x32_bf16 v[100:103], v[244:247], v[120:123], v[100:103]
  ds_read_b128 v[116:119], v159 offset:32768
  v_mfma_f32_16x16x32_bf16 v[104:107], a[68:71], v[120:123], v[104:107]
  v_mfma_f32_16x16x32_bf16 v[108:111], a[148:151], v[120:123], v[108:111]
  v_mfma_f32_16x16x32_bf16 v[112:115], a[228:231], v[120:123], v[112:115]
  s_waitcnt lgkmcnt(2)
  v_mfma_f32_16x16x32_bf16 v[100:103], v[248:251], v[124:127], v[100:103]
  ds_read_b128 v[120:123], v159 offset:33792
  v_mfma_f32_16x16x32_bf16 v[104:107], a[72:75], v[124:127], v[104:107]
  v_mfma_f32_16x16x32_bf16 v[108:111], a[152:155], v[124:127], v[108:111]
  v_mfma_f32_16x16x32_bf16 v[112:115], a[232:235], v[124:127], v[112:115]
  s_waitcnt lgkmcnt(2)
  v_mfma_f32_16x16x32_bf16 v[100:103], v[252:255], v[128:131], v[100:103]
  ds_read_b128 v[124:127], v159 offset:34816
  v_mfma_f32_16x16x32_bf16 v[104:107], a[76:79], v[128:131], v[104:107]
  v_mfma_f32_16x16x32_bf16 v[108:111], a[156:159], v[128:131], v[108:111]
  v_mfma_f32_16x16x32_bf16 v[112:115], a[236:239], v[128:131], v[112:115]
  s_waitcnt lgkmcnt(2)
  v_mfma_f32_16x16x32_bf16 v[100:103], a[0:3], v[116:119], v[100:103]
  ds_read_b128 v[128:131], v159 offset:35840
  v_mfma_f32_16x16x32_bf16 v[104:107], a[80:83], v[116:119], v[104:107]
  v_mfma_f32_16x16x32_bf16 v[108:111], a[160:163], v[116:119], v[108:111]
  v_mfma_f32_16x16x32_bf16 v[112:115], a[240:243], v[116:119], v[112:115]
  s_waitcnt lgkmcnt(2)
  v_mfma_f32_16x16x32_bf16 v[100:103], a[4:7], v[120:123], v[100:103]
  v_mfma_f32_16x16x32_bf16 v[104:107], a[84:87], v[120:123], v[104:107]
  v_mfma_f32_16x16x32_bf16 v[108:111], a[164:167], v[120:123], v[108:111]
  v_mfma_f32_16x16x32_bf16 v[112:115], a[244:247], v[120:123], v[112:115]
  s_waitcnt lgkmcnt(1)
  v_mfma_f32_16x16x32_bf16 v[100:103], a[8:11], v[124:127], v[100:103]
  v_mfma_f32_16x16x32_bf16 v[104:107], a[88:91], v[124:127], v[104:107]
  v_mfma_f32_16x16x32_bf16 v[108:111], a[168:171], v[124:127], v[108:111]
  v_mfma_f32_16x16x32_bf16 v[112:115], a[248:251], v[124:127], v[112:115]
  s_waitcnt lgkmcnt(0)
  v_mfma_f32_16x16x32_bf16 v[100:103], a[12:15], v[128:131], v[100:103]
  v_mfma_f32_16x16x32_bf16 v[104:107], a[92:95], v[128:131], v[104:107]
  v_mfma_f32_16x16x32_bf16 v[108:111], a[172:175], v[128:131], v[108:111]
  v_mfma_f32_16x16x32_bf16 v[112:115], a[252:255], v[128:131], v[112:115]
  s_xor_b32 s44, s44, 0x10000
  v_xor_b32 v159, 0x10000, v159
  s_cmp_lt_u32 s29, 63
  s_cselect_b32 s31, 40960, 0
  s_add_u32 s43, s43, s31
  s_mul_i32 s31, s16, 2621440
  s_cmp_eq_u32 s29, 11
  s_cselect_b32 s31, s31, 0
  s_sub_u32 s43, s43, s31
  v_mov_b32 v169, s29
  v_cvt_pk_bf16_f32 v132, v100, v101
  v_cvt_pk_bf16_f32 v133, v102, v103
  v_cvt_pk_bf16_f32 v134, v104, v105
  v_cvt_pk_bf16_f32 v135, v106, v107
  buffer_store_dwordx4 v[132:135], v144, s[8:11], s42 offen
  s_add_u32 s42, s42, s50
  v_cvt_pk_bf16_f32 v136, v108, v109
  v_cvt_pk_bf16_f32 v137, v110, v111
  v_cvt_pk_bf16_f32 v138, v112, v113
  v_cvt_pk_bf16_f32 v139, v114, v115
  buffer_store_dwordx4 v[136:139], v144, s[8:11], s42 offen
  s_add_u32 s42, s42, s50
  s_cmp_gt_u32 s29, 1
  s_cbranch_scc1 b_step03
  s_waitcnt vmcnt(0) lgkmcnt(0)
  buffer_store_dword v169, v154, s[8:11], 0 offen
  s_cmp_eq_u32 s29, 2
  s_barrier
  s_cbranch_scc1 b_top0
  s_mov_b32 s33, 4096
  s_mov_b32 s30, 0
pw_34:
  buffer_load_dword v166, v157, s[8:11], s33 offen sc1
  s_add_u32 s30, s30, 1
  s_cmp_gt_u32 s30, 65536
  s_cbranch_scc1 role_abort
  s_waitcnt vmcnt(0)
pc_36:
  v_cmp_gt_u32 vcc, 1, v166
  s_nop 0
  s_and_b32 vcc_lo, vcc_lo, 0x10000000
  s_and_b32 vcc_hi, vcc_hi, 0x0
  s_cmp_eq_u64 vcc, 0
  s_cbranch_scc1 po_35
  s_sleep 2
  s_branch pw_34
po_35:
  v_readlane_b32 s31, v166, 28
  s_nop 0
  s_lshl_b32 s31, s31, 13
  s_add_u32 s56, s56, s31
  s_branch b_step02
b_step00:
  s_sleep 24
b_step03:
  s_waitcnt vmcnt(2) lgkmcnt(0)
  s_barrier
  buffer_load_dwordx4 v[116:119], v144, s[8:11], s58 offen sc1
  buffer_load_dwordx4 v[120:123], v144, s[8:11], s58 offen offset:1024 sc1
  s_and_b32 s31, s28, 3
  s_mul_i32 s36, s31, 81920
  s_add_u32 s36, s36, s35
  s_lshl_b32 s32, s31, 15
  s_add_u32 s38, s37, s32
  s_add_u32 s28, s28, 1
  v_mov_b32 v170, s28
  s_lshl_b32 s32, s31, 12
  v_add_u32 v163, s32, v161
  ds_read_b128 v[44:47], v163
  ds_read_b128 v[48:51], v163 offset:1024
  v_mov_b32 v60, 0
  v_mov_b32 v61, 0
  v_mov_b32 v62, 0
  v_mov_b32 v63, 0
  v_mov_b32 v64, 0
  v_mov_b32 v65, 0
  v_mov_b32 v66, 0
  v_mov_b32 v67, 0
  s_mov_b32 s30, 0
  s_add_u32 s31, s36, s57
  s_nop 15
  s_nop 15
  s_nop 15
  s_nop 15
  s_nop 1
  buffer_load_dwordx4 v[124:127], v144, s[8:11], s58 offen sc1
  buffer_load_dwordx4 v[128:131], v144, s[8:11], s58 offen offset:1024 sc1
  s_waitcnt vmcnt(2)
  v_mfma_f32_16x16x32_bf16 v[108:111], v[180:183], v[116:119], 0
  v_mfma_f32_16x16x32_bf16 v[108:111], v[180:183], v[120:123], v[108:111]
  s_nop 7
  v_cmp_u_f32 vcc, v108, v109
  v_cvt_pk_bf16_f32 v168, v108, v109
  s_cbranch_vccnz b_step0xr
b_step0x:
  buffer_store_dword v168, v146, s[8:11], s31 offen
  buffer_store_dword v169, v154, s[8:11], 0 offen
  s_nop 15
  s_nop 13
  s_branch b_step0P
b_step0S:
  s_sleep 6
b_step02:
  s_and_b32 s31, s28, 3
  s_mul_i32 s36, s31, 81920
  s_add_u32 s36, s36, s35
  s_lshl_b32 s32, s31, 15
  s_add_u32 s38, s37, s32
  s_add_u32 s28, s28, 1
  v_mov_b32 v170, s28
  s_lshl_b32 s32, s31, 12
  v_add_u32 v163, s32, v161
  ds_read_b128 v[44:47], v163
  ds_read_b128 v[48:51], v163 offset:1024
  v_mov_b32 v60, 0
  v_mov_b32 v61, 0
  v_mov_b32 v62, 0
  v_mov_b32 v63, 0
  v_mov_b32 v64, 0
  v_mov_b32 v65, 0
  v_mov_b32 v66, 0
  v_mov_b32 v67, 0
.p2align 7
b_step0P:
  s_mov_b32 s30, 0
  buffer_load_dwordx4 v[76:79], v147, s[8:11], s36 offen sc1
  buffer_load_dwordx4 v[80:83], v147, s[8:11], s36 offen offset:1024 sc1
  buffer_load_dword v84, v148, s[8:11], s36 offen sc1
  buffer_load_dword v85, v148, s[8:11], s36 offen offset:256 sc1
  s_nop 15
  s_nop 15
mq_37:
  buffer_load_dwordx4 v[88:91], v147, s[8:11], s36 offen sc1
  buffer_load_dwordx4 v[92:95], v147, s[8:11], s36 offen offset:1024 sc1
  buffer_load_dword v96, v148, s[8:11], s36 offen sc1
  buffer_load_dword v97, v148, s[8:11], s36 offen offset:256 sc1
  s_add_u32 s30, s30, 1
  s_cmp_gt_u32 s30, 65536
  s_cbranch_scc1 chain_abort
  s_waitcnt vmcnt(4)
  buffer_store_dword v169, v154, s[8:11], 0 offen
  v_max3_u32 v167, v76, v80, v84
  v_max_u32 v167, v167, v85
  v_cmp_eq_u32 vcc, -1, v167
  ds_write_b128 v147, v[76:79]
  ds_write_b128 v147, v[80:83] offset:1024
  ds_write2st64_b32 v148, v84, v85 offset0:0 offset1:1
  s_cbranch_vccz mq_37_ok
  buffer_load_dwordx4 v[76:79], v147, s[8:11], s36 offen sc1
  buffer_load_dwordx4 v[80:83], v147, s[8:11], s36 offen offset:1024 sc1
  buffer_load_dword v84, v148, s[8:11], s36 offen sc1
  buffer_load_dword v85, v148, s[8:11], s36 offen offset:256 sc1
  s_waitcnt vmcnt(5)
  v_max3_u32 v167, v88, v92, v96
  v_max_u32 v167, v167, v97
  v_cmp_eq_u32 vcc, -1, v167
  ds_write_b128 v147, v[88:91]
  ds_write_b128 v147, v[92:95] offset:1024
  ds_write2st64_b32 v148, v96, v97 offset0:0 offset1:1
  s_cbranch_vccz mq_37_ok
  s_branch mq_37
.p2align 7
mq_37_ok:
  s_waitcnt lgkmcnt(0)
  s_barrier
  ds_read_b128 v[4:7], v144 offset:0
  ds_read_b128 v[8:11], v144 offset:1024
  ds_read_b128 v[12:15], v144 offset:2048
  ds_read_b128 v[16:19], v144 offset:3072
  ds_read_b128 v[20:23], v144 offset:4096
  ds_read_b128 v[24:27], v144 offset:5120
  ds_read_b128 v[28:31], v144 offset:6144
  ds_read_b128 v[32:35], v144 offset:7168
  ds_read_b128 v[36:39], v144 offset:8192
  ds_read_b128 v[40:43], v144 offset:9216
  s_waitcnt lgkmcnt(9)
  v_smfmac_f32_16x16x64_bf16 v[60:63], v[4:7], v[192:199], v151
  v_smfmac_f32_16x16x64_bf16 v[64:67], v[4:7], a[16:23], v151
  s_waitcnt lgkmcnt(8)
  v_smfmac_f32_16x16x64_bf16 v[60:63], v[8:11], v[200:207], v151
  v_smfmac_f32_16x16x64_bf16 v[64:67], v[8:11], a[24:31], v151
  s_waitcnt lgkmcnt(7)
  v_smfmac_f32_16x16x64_bf16 v[60:63], v[12:15], v[208:215], v151
  v_smfmac_f32_16x16x64_bf16 v[64:67], v[12:15], a[32:39], v151
  s_waitcnt lgkmcnt(6)
  v_smfmac_f32_16x16x64_bf16 v[60:63], v[16:19], v[216:223], v151
  v_smfmac_f32_16x16x64_bf16 v[64:67], v[16:19], a[40:47], v151
  s_waitcnt lgkmcnt(5)
  v_smfmac_f32_16x16x64_bf16 v[60:63], v[20:23], v[224:231], v151
  v_smfmac_f32_16x16x64_bf16 v[64:67], v[20:23], a[48:55], v151
  s_waitcnt lgkmcnt(4)
  v_smfmac_f32_16x16x64_bf16 v[60:63], v[24:27], v[232:239], v151
  v_smfmac_f32_16x16x64_bf16 v[64:67], v[24:27], a[56:63], v151
  s_waitcnt lgkmcnt(3)
  v_smfmac_f32_16x16x64_bf16 v[60:63], v[28:31], v[240:247], v151
  v_smfmac_f32_16x16x64_bf16 v[64:67], v[28:31], a[64:71], v151
  s_waitcnt lgkmcnt(2)
  v_smfmac_f32_16x16x64_bf16 v[60:63], v[32:35], v[248:255], v151
  s_waitcnt lgkmcnt(1)
  v_smfmac_f32_16x16x64_bf16 v[60:63], v[36:39], a[0:7], v151
  s_waitcnt lgkmcnt(0)
  v_smfmac_f32_16x16x64_bf16 v[60:63], v[40:43], a[8:15], v151
  s_nop 2
  v_smfmac_f32_16x16x64_bf16 v[64:67], v[32:35], a[72:79], v151
  s_nop 2
  v_smfmac_f32_16x16x64_bf16 v[64:67], v[36:39], a[80:87], v151
  v_add_f32 v60, v60, v62
  v_add_f32 v61, v61, v63
  v_cvt_pk_bf16_f32 v140, v60, v61
  ds_write2_b32 v149, v140, v140 offset0:0 offset1:4
  v_smfmac_f32_16x16x64_bf16 v[64:67], v[40:43], a[88:95], v151
  s_nop 7
  v_add_f32 v64, v64, v66
  v_add_f32 v65, v65, v67
  v_cvt_pk_bf16_f32 v141, v64, v65
  ds_write2_b32 v149, v141, v141 offset0:128 offset1:132
  s_mov_b32 s30, 0
  s_nop 5
sx_38:
  ds_read_b64_tr_b16 v[52:53], v145 offset:10240
  ds_read_b64_tr_b16 v[54:55], v145 offset:10752
  ds_read_b64_tr_b16 v[56:57], v145 offset:11264
  ds_read_b64_tr_b16 v[58:59], v145 offset:11776
  s_waitcnt lgkmcnt(2)
  v_mfma_f32_16x16x32_bf16 v[68:71], v[44:47], v[52:55], 0
  s_waitcnt lgkmcnt(0)
  v_mfma_f32_16x16x32_bf16 v[68:71], v[48:51], v[56:59], v[68:71]
  s_nop 7
  v_cmp_u_f32 vcc, v68, v69
  s_mov_b64 exec, s[52:53]
  s_cbranch_vccnz sx_38_r
  buffer_store_dwordx4 v[68:71], v144, s[8:11], s38 offen
  s_mov_b64 exec, -1
  s_add_u32 s31, s28, 2
  s_and_b32 s31, s31, 3
  s_cmp_eq_u32 s28, 64
  s_cbranch_scc1 b_end
  s_lshl_b32 s31, s31, 15
  s_add_u32 s31, s31, s46
  buffer_store_dwordx4 v[72:75], v144, s[8:11], s31 offen
  s_branch b_top0
b_step0xr:
  buffer_load_dwordx4 v[116:119], v144, s[8:11], s58 offen sc1
  buffer_load_dwordx4 v[120:123], v144, s[8:11], s58 offen offset:1024 sc1
  s_add_u32 s30, s30, 1
  s_cmp_gt_u32 s30, 65536
  s_cbranch_scc1 chain_abort
  s_waitcnt vmcnt(2)
  v_mfma_f32_16x16x32_bf16 v[108:111], v[180:183], v[124:127], 0
  v_mfma_f32_16x16x32_bf16 v[108:111], v[180:183], v[128:131], v[108:111]
  s_nop 7
  v_cmp_u_f32 vcc, v108, v109
  v_cvt_pk_bf16_f32 v168, v108, v109
  s_cbranch_vccz b_step0x
  buffer_load_dwordx4 v[124:127], v144, s[8:11], s58 offen sc1
  buffer_load_dwordx4 v[128:131], v144, s[8:11], s58 offen offset:1024 sc1
  s_add_u32 s30, s30, 1
  s_cmp_gt_u32 s30, 65536
  s_cbranch_scc1 chain_abort
  s_waitcnt vmcnt(2)
  v_mfma_f32_16x16x32_bf16 v[108:111], v[180:183], v[116:119], 0
  v_mfma_f32_16x16x32_bf16 v[108:111], v[180:183], v[120:123], v[108:111]
  s_nop 7
  v_cmp_u_f32 vcc, v108, v109
  v_cvt_pk_bf16_f32 v168, v108, v109
  s_cbranch_vccz b_step0x
  s_branch b_step0xr
sx_38_r:
  s_mov_b64 exec, -1
  s_add_u32 s30, s30, 1
  s_cmp_gt_u32 s30, 65536
  s_cbranch_scc1 chain_abort
  s_branch sx_38
b_pro1:
  s_lshl_b32 s31, s26, 7
  s_add_u32 s37, s37, s31
  s_add_u32 s37, s37, 3072
  s_min_u32 s31, s18, 9
  s_lshl_b32 s31, s31, 10
  s_add_u32 s46, s35, s31
  ds_write_b128 v144, v[72:75] offset:10240
  ds_write_b128 v144, v[72:75] offset:11264
.p2align 7
b_top1:
  s_cmp_ge_u32 s29, 64
  s_cbranch_scc1 b_step10
  ds_read_b128 v[116:119], v159 offset:16384
  ds_read_b128 v[120:123], v159 offset:17408
  ds_read_b128 v[124:127], v159 offset:18432
  s_and_b32 s31, s29, 3
  s_mul_i32 s31, s31, 147456
  s_add_u32 s42, s41, s31
  s_add_u32 s42, s42, s51
  s_add_u32 s49, s29, 2
  s_lshl_b32 s48, s49, 1
  s_min_u32 s48, s48, 128
  s_and_b32 s31, s29, 3
  s_lshl_b32 s31, s31, 12
  v_add_u32 v162, s31, v160
  v_xor_b32 v176, 1024, v162
  s_add_u32 s29, s29, 1
  s_mov_b32 s33, 4096
  s_max_u32 s31, s29, 4
  s_sub_u32 s31, s31, 4
  v_mov_b32 v190, s31
  v_mov_b32 v167, s48
  v_cndmask_b32 v190, v190, v167, s[74:75]
  s_waitcnt lgkmcnt(2)
  v_mfma_f32_16x16x32_bf16 v[100:103], v[192:195], v[116:119], 0
  ds_read_b128 v[128:131], v159 offset:19456
  v_mfma_f32_16x16x32_bf16 v[104:107], a[16:19], v[116:119], 0
  v_mfma_f32_16x16x32_bf16 v[108:111], a[96:99], v[116:119], 0
  v_mfma_f32_16x16x32_bf16 v[112:115], a[176:179], v[116:119], 0
  s_waitcnt lgkmcnt(2)
  v_mfma_f32_16x16x32_bf16 v[100:103], v[196:199], v[120:123], v[100:103]
  ds_read_b128 v[116:119], v159 offset:20480
  v_mfma_f32_16x16x32_bf16 v[104:107], a[20:23], v[120:123], v[104:107]
  v_mfma_f32_16x16x32_bf16 v[108:111], a[100:103], v[120:123], v[108:111]
  v_mfma_f32_16x16x32_bf16 v[112:115], a[180:183], v[120:123], v[112:115]
  s_waitcnt lgkmcnt(2)
  v_mfma_f32_16x16x32_bf16 v[100:103], v[200:203], v[124:127], v[100:103]
  ds_read_b128 v[120:123], v159 offset:21504
  v_mfma_f32_16x16x32_bf16 v[104:107], a[24:27], v[124:127], v[104:107]
  s_mov_b32 s30, 0
  s_branch pc_41
pw_39:
  buffer_load_dword v158, v189, s[8:11], s33 offen sc1
  s_add_u32 s30, s30, 1
  s_cmp_gt_u32 s30, 65536
  s_cbranch_scc1 role_abort
  s_waitcnt vmcnt(0)
pc_41:
  v_cmp_gt_u32 vcc, v190, v158
  s_nop 0
  s_and_b32 vcc_lo, vcc_lo, 0xf000fff
  s_and_b32 vcc_hi, vcc_hi, 0x0
  s_cmp_eq_u64 vcc, 0
  s_cbranch_scc1 po_40
  s_sleep 4
  s_branch pw_39
po_40:
  v_mfma_f32_16x16x32_bf16 v[108:111], a[104:107], v[124:127], v[108:111]
  v_mfma_f32_16x16x32_bf16 v[112:115], a[184:187], v[124:127], v[112:115]
  s_add_u32 m0, s44, 0
  s_add_u32 s31, s43, 0
  buffer_load_dwordx4 v144, s[8:11], s31 offen offset:0 sc1 lds
  s_waitcnt lgkmcnt(2)
  v_mfma_f32_16x16x32_bf16 v[100:103], v[204:207], v[128:131], v[100:103]
  ds_read_b128 v[124:127], v159 offset:22528
  v_mfma_f32_16x16x32_bf16 v[104:107], a[28:31], v[128:131], v[104:107]
  v_mfma_f32_16x16x32_bf16 v[108:111], a[108:111], v[128:131], v[108:111]
  v_mfma_f32_16x16x32_bf16 v[112:115], a[188:191], v[128:131], v[112:115]
  buffer_load_dwordx4 v144, s[8:11], s31 offen offset:1024 sc1 lds
  s_waitcnt lgkmcnt(2)
  v_mfma_f32_16x16x32_bf16 v[100:103], v[208:211], v[116:119], v[100:103]
  ds_read_b128 v[128:131], v159 offset:23552
  v_mfma_f32_16x16x32_bf16 v[104:107], a[32:35], v[116:119], v[104:107]
  v_mfma_f32_16x16x32_bf16 v[108:111], a[112:115], v[116:119], v[108:111]
  v_mfma_f32_16x16x32_bf16 v[112:115], a[192:195], v[116:119], v[112:115]
  buffer_load_dwordx4 v144, s[8:11], s31 offen offset:2048 sc1 lds
  s_waitcnt lgkmcnt(2)
  v_mfma_f32_16x16x32_bf16 v[100:103], v[212:215], v[120:123], v[100:103]
  ds_read_b128 v[116:119], v159 offset:24576
  v_mfma_f32_16x16x32_bf16 v[104:107], a[36:39], v[120:123], v[104:107]
  v_mfma_f32_16x16x32_bf16 v[108:111], a[116:119], v[120:123], v[108:111]
  v_mfma_f32_16x16x32_bf16 v[112:115], a[196:199], v[120:123], v[112:115]
  buffer_load_dwordx4 v144, s[8:11], s31 offen offset:3072 sc1 lds
  s_waitcnt lgkmcnt(2)
  v_mfma_f32_16x16x32_bf16 v[100:103], v[216:219], v[124:127], v[100:103]
  ds_read_b128 v[120:123], v159 offset:25600
  v_mfma_f32_16x16x32_bf16 v[104:107], a[40:43], v[124:127], v[104:107]
  v_mfma_f32_16x16x32_bf16 v[108:111], a[120:123], v[124:127], v[108:111]
  v_mfma_f32_16x16x32_bf16 v[112:115], a[200:203], v[124:127], v[112:115]
  s_add_u32 m0, s44, 4096
  s_add_u32 s31, s43, 4096
  buffer_load_dwordx4 v144, s[8:11], s31 offen offset:0 sc1 lds
  s_waitcnt lgkmcnt(2)
  v_mfma_f32_16x16x32_bf16 v[100:103], v[220:223], v[128:131], v[100:103]
  ds_read_b128 v[124:127], v159 offset:26624
  v_mfma_f32_16x16x32_bf16 v[104:107], a[44:47], v[128:131], v[104:107]
  v_mfma_f32_16x16x32_bf16 v[108:111], a[124:127], v[128:131], v[108:111]
  v_mfma_f32_16x16x32_bf16 v[112:115], a[204:207], v[128:131], v[112:115]
  buffer_load_dwordx4 v144, s[8:11], s31 offen offset:1024 sc1 lds
  s_waitcnt lgkmcnt(2)
  v_mfma_f32_16x16x32_bf16 v[100:103], v[224:227], v[116:119], v[100:103]
  ds_read_b128 v[128:131], v159 offset:27648
  v_mfma_f32_16x16x32_bf16 v[104:107], a[48:51], v[116:119], v[104:107]
  v_mfma_f32_16x16x32_bf16 v[108:111], a[128:131], v[116:119], v[108:111]
  v_mfma_f32_16x16x32_bf16 v[112:115], a[208:211], v[116:119], v[112:115]
  buffer_load_dwordx4 v144, s[8:11], s31 offen offset:2048 sc1 lds
  s_waitcnt lgkmcnt(2)
  v_mfma_f32_16x16x32_bf16 v[100:103], v[228:231], v[120:123], v[100:103]
  ds_read_b128 v[116:119], v159 offset:28672
  v_mfma_f32_16x16x32_bf16 v[104:107], a[52:55], v[120:123], v[104:107]
  v_mfma_f32_16x16x32_bf16 v[108:111], a[132:135], v[120:123], v[108:111]
  v_mfma_f32_16x16x32_bf16 v[112:115], a[212:215], v[120:123], v[112:115]
  buffer_load_dwordx4 v144, s[8:11], s31 offen offset:3072 sc1 lds
  s_waitcnt lgkmcnt(2)
  v_mfma_f32_16x16x32_bf16 v[100:103], v[232:235], v[124:127], v[100:103]
  ds_read_b128 v[120:123], v159 offset:29696
  v_mfma_f32_16x16x32_bf16 v[104:107], a[56:59], v[124:127], v[104:107]
  v_mfma_f32_16x16x32_bf16 v[108:111], a[136:139], v[124:127], v[108:111]
  v_mfma_f32_16x16x32_bf16 v[112:115], a[216:219], v[124:127], v[112:115]
  s_add_u32 m0, s44, 8192
  s_add_u32 s31, s43, 8192
  buffer_load_dwordx4 v144, s[8:11], s31 offen offset:0 sc1 lds
  s_waitcnt lgkmcnt(2)
  v_mfma_f32_16x16x32_bf16 v[100:103], v[236:239], v[128:131], v[100:103]
  ds_read_b128 v[124:127], v159 offset:30720
  v_mfma_f32_16x16x32_bf16 v[104:107], a[60:63], v[128:131], v[104:107]
  v_mfma_f32_16x16x32_bf16 v[108:111], a[140:143], v[128:131], v[108:111]
  v_mfma_f32_16x16x32_bf16 v[112:115], a[220:223], v[128:131], v[112:115]
  buffer_load_dwordx4 v144, s[8:11], s31 offen offset:1024 sc1 lds
  s_waitcnt lgkmcnt(2)
  v_mfma_f32_16x16x32_bf16 v[100:103], v[240:243], v[116:119], v[100:103]
  ds_read_b128 v[128:131], v159 offset:31744
  v_mfma_f32_16x16x32_bf16 v[104:107], a[64:67], v[116:119], v[104:107]
  v_mfma_f32_16x16x32_bf16 v[108:111], a[144:147], v[116:119], v[108:111]
  v_mfma_f32_16x16x32_bf16 v[112:115], a[224:227], v[116:119], v[112:115]
  buffer_load_dword v158, v189, s[8:11], s33 offen sc1
  s_waitcnt lgkmcnt(2)
  v_mfma_f32_16x16x32_bf16 v[100:103], v[244:247], v[120:123], v[100:103]
  ds_read_b128 v[116:119], v159 offset:32768
  v_mfma_f32_16x16x32_bf16 v[104:107], a[68:71], v[120:123], v[104:107]
  v_mfma_f32_16x16x32_bf16 v[108:111], a[148:151], v[120:123], v[108:111]
  v_mfma_f32_16x16x32_bf16 v[112:115], a[228:231], v[120:123], v[112:115]
  s_waitcnt lgkmcnt(2)
  v_mfma_f32_16x16x32_bf16 v[100:103], v[248:251], v[124:127], v[100:103]
  ds_read_b128 v[120:123], v159 offset:33792
  v_mfma_f32_16x16x32_bf16 v[104:107], a[72:75], v[124:127], v[104:107]
  v_mfma_f32_16x16x32_bf16 v[108:111], a[152:155], v[124:127], v[108:111]
  v_mfma_f32_16x16x32_bf16 v[112:115], a[232:235], v[124:127], v[112:115]
  s_waitcnt lgkmcnt(2)
  v_mfma_f32_16x16x32_bf16 v[100:103], v[252:255], v[128:131], v[100:103]
  ds_read_b128 v[124:127], v159 offset:34816
  v_mfma_f32_16x16x32_bf16 v[104:107], a[76:79], v[128:131], v[104:107]
  v_mfma_f32_16x16x32_bf16 v[108:111], a[156:159], v[128:131], v[108:111]
  v_mfma_f32_16x16x32_bf16 v[112:115], a[236:239], v[128:131], v[112:115]
  s_waitcnt lgkmcnt(2)
  v_mfma_f32_16x16x32_bf16 v[100:103], a[0:3], v[116:119], v[100:103]
  ds_read_b128 v[128:131], v159 offset:35840
  v_mfma_f32_16x16x32_bf16 v[104:107], a[80:83], v[116:119], v[104:107]
  v_mfma_f32_16x16x32_bf16 v[108:111], a[160:163], v[116:119], v[108:111]
  v_mfma_f32_16x16x32_bf16 v[112:115], a[240:243], v[116:119], v[112:115]
  s_waitcnt lgkmcnt(2)
  v_mfma_f32_16x16x32_bf16 v[100:103], a[4:7], v[120:123], v[100:103]
  v_mfma_f32_16x16x32_bf16 v[104:107], a[84:87], v[120:123], v[104:107]
  v_mfma_f32_16x16x32_bf16 v[108:111], a[164:167], v[120:123], v[108:111]
  v_mfma_f32_16x16x32_bf16 v[112:115], a[244:247], v[120:123], v[112:115]
  s_waitcnt lgkmcnt(1)
  v_mfma_f32_16x16x32_bf16 v[100:103], a[8:11], v[124:127], v[100:103]
  v_mfma_f32_16x16x32_bf16 v[104:107], a[88:91], v[124:127], v[104:107]
  v_mfma_f32_16x16x32_bf16 v[108:111], a[168:171], v[124:127], v[108:111]
  v_mfma_f32_16x16x32_bf16 v[112:115], a[248:251], v[124:127], v[112:115]
  s_waitcnt lgkmcnt(0)
  v_mfma_f32_16x16x32_bf16 v[100:103], a[12:15], v[128:131], v[100:103]
  v_mfma_f32_16x16x32_bf16 v[104:107], a[92:95], v[128:131], v[104:107]
  v_mfma_f32_16x16x32_bf16 v[108:111], a[172:175], v[128:131], v[108:111]
  v_mfma_f32_16x16x32_bf16 v[112:115], a[252:255], v[128:131], v[112:115]
  s_xor_b32 s44, s44, 0x10000
  v_xor_b32 v159, 0x10000, v159
  s_cmp_lt_u32 s29, 63
  s_cselect_b32 s31, 40960, 0
  s_add_u32 s43, s43, s31
  s_mul_i32 s31, s16, 2621440
  s_cmp_eq_u32 s29, 11
  s_cselect_b32 s31, s31, 0
  s_sub_u32 s43, s43, s31
  v_mov_b32 v169, s29
  v_cvt_pk_bf16_f32 v132, v100, v101
  v_cvt_pk_bf16_f32 v133, v102, v103
  v_cvt_pk_bf16_f32 v134, v104, v105
  v_cvt_pk_bf16_f32 v135, v106, v107
  buffer_store_dwordx4 v[132:135], v144, s[8:11], s42 offen
  s_add_u32 s42, s42, s50
  ds_write_b128 v162, v[132:135]
  v_cvt_pk_bf16_f32 v136, v108, v109
  v_cvt_pk_bf16_f32 v137, v110, v111
  v_cvt_pk_bf16_f32 v138, v112, v113
  v_cvt_pk_bf16_f32 v139, v114, v115
  buffer_store_dwordx4 v[136:139], v144, s[8:11], s42 offen
  s_add_u32 s42, s42, s50
  ds_write_b128 v176, v[136:139]
  s_cmp_gt_u32 s29, 1
  s_cbranch_scc1 b_step13
  s_waitcnt vmcnt(0) lgkmcnt(0)
  buffer_store_dword v169, v154, s[8:11], 0 offen
  s_cmp_eq_u32 s29, 2
  s_barrier
  s_cbranch_scc1 b_top1
  s_mov_b32 s33, 4096
  s_mov_b32 s30, 0
pw_42:
  buffer_load_dword v166, v157, s[8:11], s33 offen sc1
  s_add_u32 s30, s30, 1
  s_cmp_gt_u32 s30, 65536
  s_cbranch_scc1 role_abort
  s_waitcnt vmcnt(0)
pc_44:
  v_cmp_gt_u32 vcc, 1, v166
  s_nop 0
  s_and_b32 vcc_lo, vcc_lo, 0x10000000
  s_and_b32 vcc_hi, vcc_hi, 0x0
  s_cmp_eq_u64 vcc, 0
  s_cbranch_scc1 po_43
  s_sleep 2
  s_branch pw_42
po_43:
  v_readlane_b32 s31, v166, 28
  s_nop 0
  s_lshl_b32 s31, s31, 13
  s_add_u32 s56, s56, s31
  s_branch b_step12
b_step10:
  s_sleep 24
b_step13:
  s_waitcnt vmcnt(2) lgkmcnt(0)
  s_barrier
  ds_write_b128 v144, v[72:75] offset:10240
  ds_write_b128 v144, v[72:75] offset:11264
b_step1S:
  s_sleep 6
b_step12:
  s_and_b32 s31, s28, 3
  s_mul_i32 s36, s31, 81920
  s_add_u32 s36, s36, s35
  s_lshl_b32 s32, s31, 15
  s_add_u32 s38, s37, s32
  s_add_u32 s28, s28, 1
  v_mov_b32 v170, s28
  v_mov_b32 v60, 0
  v_mov_b32 v61, 0
  v_mov_b32 v62, 0
  v_mov_b32 v63, 0
  v_mov_b32 v64, 0
  v_mov_b32 v65, 0
  v_mov_b32 v66, 0
  v_mov_b32 v67, 0
b_step1P:
  s_mov_b32 s30, 0
  buffer_load_dwordx4 v[76:79], v147, s[8:11], s36 offen sc1
  buffer_load_dwordx4 v[80:83], v147, s[8:11], s36 offen offset:1024 sc1
  buffer_load_dword v84, v148, s[8:11], s36 offen sc1
  buffer_load_dword v85, v148, s[8:11], s36 offen offset:256 sc1
  s_nop 15
  s_nop 15
mq_45:
  buffer_load_dwordx4 v[88:91], v147, s[8:11], s36 offen sc1
  buffer_load_dwordx4 v[92:95], v147, s[8:11], s36 offen offset:1024 sc1
  buffer_load_dword v96, v148, s[8:11], s36 offen sc1
  buffer_load_dword v97, v148, s[8:11], s36 offen offset:256 sc1
  s_add_u32 s30, s30, 1
  s_cmp_gt_u32 s30, 65536
  s_cbranch_scc1 chain_abort
  s_waitcnt vmcnt(4)
  buffer_store_dword v169, v154, s[8:11], 0 offen
  v_max3_u32 v167, v76, v80, v84
  v_max_u32 v167, v167, v85
  v_cmp_eq_u32 vcc, -1, v167
  ds_write_b128 v147, v[76:79]
  ds_write_b128 v147, v[80:83] offset:1024
  ds_write2st64_b32 v148, v84, v85 offset0:0 offset1:1
  s_cbranch_vccz mq_45_ok
  buffer_load_dwordx4 v[76:79], v147, s[8:11], s36 offen sc1
  buffer_load_dwordx4 v[80:83], v147, s[8:11], s36 offen offset:1024 sc1
  buffer_load_dword v84, v148, s[8:11], s36 offen sc1
  buffer_load_dword v85, v148, s[8:11], s36 offen offset:256 sc1
  s_waitcnt vmcnt(5)
  v_max3_u32 v167, v88, v92, v96
  v_max_u32 v167, v167, v97
  v_cmp_eq_u32 vcc, -1, v167
  ds_write_b128 v147, v[88:91]
  ds_write_b128 v147, v[92:95] offset:1024
  ds_write2st64_b32 v148, v96, v97 offset0:0 offset1:1
  s_cbranch_vccz mq_45_ok
  s_branch mq_45
.p2align 7
mq_45_ok:
  s_waitcnt lgkmcnt(0)
  s_barrier
  ds_read_b128 v[4:7], v144 offset:0
  ds_read_b128 v[8:11], v144 offset:1024
  ds_read_b128 v[12:15], v144 offset:2048
  ds_read_b128 v[16:19], v144 offset:3072
  ds_read_b128 v[20:23], v144 offset:4096
  ds_read_b128 v[24:27], v144 offset:5120
  ds_read_b128 v[28:31], v144 offset:6144
  ds_read_b128 v[32:35], v144 offset:7168
  ds_read_b128 v[36:39], v144 offset:8192
  ds_read_b128 v[40:43], v144 offset:9216
  s_waitcnt lgkmcnt(9)
  v_smfmac_f32_16x16x64_bf16 v[60:63], v[4:7], v[192:199], v151
  v_smfmac_f32_16x16x64_bf16 v[64:67], v[4:7], a[16:23], v151
  s_waitcnt lgkmcnt(8)
  v_smfmac_f32_16x16x64_bf16 v[60:63], v[8:11], v[200:207], v151
  v_smfmac_f32_16x16x64_bf16 v[64:67], v[8:11], a[24:31], v151
  s_waitcnt lgkmcnt(7)
  v_smfmac_f32_16x16x64_bf16 v[60:63], v[12:15], v[208:215], v151
  v_smfmac_f32_16x16x64_bf16 v[64:67], v[12:15], a[32:39], v151
  s_waitcnt lgkmcnt(6)
  v_smfmac_f32_16x16x64_bf16 v[60:63], v[16:19], v[216:223], v151
  v_smfmac_f32_16x16x64_bf16 v[64:67], v[16:19], a[40:47], v151
  s_waitcnt lgkmcnt(5)
  v_smfmac_f32_16x16x64_bf16 v[60:63], v[20:23], v[224:231], v151
  v_smfmac_f32_16x16x64_bf16 v[64:67], v[20:23], a[48:55], v151
  s_waitcnt lgkmcnt(4)
  v_smfmac_f32_16x16x64_bf16 v[60:63], v[24:27], v[232:239], v151
  v_smfmac_f32_16x16x64_bf16 v[64:67], v[24:27], a[56:63], v151
  s_waitcnt lgkmcnt(3)
  v_smfmac_f32_16x16x64_bf16 v[60:63], v[28:31], v[240:247], v151
  v_smfmac_f32_16x16x64_bf16 v[64:67], v[28:31], a[64:71], v151
  s_waitcnt lgkmcnt(2)
  v_smfmac_f32_16x16x64_bf16 v[60:63], v[32:35], v[248:255], v151
  s_waitcnt lgkmcnt(1)
  v_smfmac_f32_16x16x64_bf16 v[60:63], v[36:39], a[0:7], v151
  s_waitcnt lgkmcnt(0)
  v_smfmac_f32_16x16x64_bf16 v[60:63], v[40:43], a[8:15], v151
  s_nop 2
  v_smfmac_f32_16x16x64_bf16 v[64:67], v[32:35], a[72:79], v151
  s_nop 2
  v_smfmac_f32_16x16x64_bf16 v[64:67], v[36:39], a[80:87], v151
  v_add_f32 v60, v60, v62
  v_add_f32 v61, v61, v63
  v_cvt_pk_bf16_f32 v140, v60, v61
  ds_write2_b32 v149, v140, v140 offset0:0 offset1:1
  v_smfmac_f32_16x16x64_bf16 v[64:67], v[40:43], a[88:95], v151
  s_nop 7
  v_add_f32 v64, v64, v66
  v_add_f32 v65, v65, v67
  v_cvt_pk_bf16_f32 v141, v64, v65
  ds_write2_b32 v149, v141, v141 offset0:128 offset1:129
  s_mov_b32 s30, 0
  s_nop 5
sx_46:
  ds_read_b64_tr_b16 v[52:53], v145 offset:10240
  ds_read_b64_tr_b16 v[54:55], v145 offset:10752
  ds_read_b64_tr_b16 v[44:45], v145 offset:12288
  ds_read_b64_tr_b16 v[46:47], v145 offset:12800
  ds_read_b64_tr_b16 v[56:57], v145 offset:11264
  ds_read_b64_tr_b16 v[58:59], v145 offset:11776
  ds_read_b64_tr_b16 v[48:49], v145 offset:13312
  ds_read_b64_tr_b16 v[50:51], v145 offset:13824
  s_waitcnt lgkmcnt(4)
  v_mfma_f32_16x16x32_bf16 v[68:71], v[44:47], v[52:55], 0
  s_waitcnt lgkmcnt(0)
  v_mfma_f32_16x16x32_bf16 v[68:71], v[48:51], v[56:59], v[68:71]
  s_nop 7
  v_cmp_u_f32 vcc, v68, v69
  v_cndmask_b32 v167, v68, v69, s[54:55]
  s_cbranch_vccnz sx_46_r
  buffer_store_dword v167, v146, s[8:11], s38 offen
  s_add_u32 s31, s28, 2
  s_and_b32 s31, s31, 3
  s_cmp_eq_u32 s28, 64
  s_cbranch_scc1 b_end
  s_mul_i32 s31, s31, 81920
  s_add_u32 s31, s31, s46
  buffer_store_dwordx4 v[72:75], v144, s[8:11], s31 offen
  s_branch b_top1
sx_46_r:
  s_mov_b64 exec, -1
  s_add_u32 s30, s30, 1
  s_cmp_gt_u32 s30, 65536
  s_cbranch_scc1 chain_abort
  s_branch sx_46
b_pro2:
  ds_write_b128 v144, v[72:75] offset:12288
  ds_write_b128 v144, v[72:75] offset:13312
.p2align 7
b_top2:
  s_cmp_ge_u32 s29, 64
  s_cbranch_scc1 b_step20
  ds_read_b128 v[116:119], v159 offset:16384
  ds_read_b128 v[120:123], v159 offset:17408
  ds_read_b128 v[124:127], v159 offset:18432
  s_and_b32 s31, s29, 3
  s_mul_i32 s31, s31, 147456
  s_add_u32 s42, s41, s31
  s_add_u32 s42, s42, s51
  s_add_u32 s49, s29, 2
  s_lshl_b32 s48, s49, 1
  s_min_u32 s48, s48, 128
  s_and_b32 s31, s29, 3
  s_lshl_b32 s31, s31, 12
  v_add_u32 v162, s31, v160
  v_xor_b32 v176, 1024, v162
  s_add_u32 s29, s29, 1
  s_mov_b32 s33, 4096
  s_max_u32 s31, s29, 4
  s_sub_u32 s31, s31, 4
  v_mov_b32 v190, s31
  v_mov_b32 v167, s48
  v_cndmask_b32 v190, v190, v167, s[74:75]
  s_waitcnt lgkmcnt(2)
  v_mfma_f32_16x16x32_bf16 v[100:103], v[192:195], v[116:119], 0
  ds_read_b128 v[128:131], v159 offset:19456
  v_mfma_f32_16x16x32_bf16 v[104:107], a[16:19], v[116:119], 0
  v_mfma_f32_16x16x32_bf16 v[108:111], a[96:99], v[116:119], 0
  v_mfma_f32_16x16x32_bf16 v[112:115], a[176:179], v[116:119], 0
  s_waitcnt lgkmcnt(2)
  v_mfma_f32_16x16x32_bf16 v[100:103], v[196:199], v[120:123], v[100:103]
  ds_read_b128 v[116:119], v159 offset:20480
  v_mfma_f32_16x16x32_bf16 v[104:107], a[20:23], v[120:123], v[104:107]
  v_mfma_f32_16x16x32_bf16 v[108:111], a[100:103], v[120:123], v[108:111]
  v_mfma_f32_16x16x32_bf16 v[112:115], a[180:183], v[120:123], v[112:115]
  s_waitcnt lgkmcnt(2)
  v_mfma_f32_16x16x32_bf16 v[100:103], v[200:203], v[124:127], v[100:103]
  ds_read_b128 v[120:123], v159 offset:21504
  v_mfma_f32_16x16x32_bf16 v[104:107], a[24:27], v[124:127], v[104:107]
  v_mfma_f32_16x16x32_bf16 v[108:111], a[104:107], v[124:127], v[108:111]
  v_mfma_f32_16x16x32_bf16 v[112:115], a[184:187], v[124:127], v[112:115]
  s_waitcnt lgkmcnt(2)
  v_mfma_f32_16x16x32_bf16 v[100:103], v[204:207], v[128:131], v[100:103]
  ds_read_b128 v[124:127], v159 offset:22528
  v_mfma_f32_16x16x32_bf16 v[104:107], a[28:31], v[128:131], v[104:107]
  v_mfma_f32_16x16x32_bf16 v[108:111], a[108:111], v[128:131], v[108:111]
  v_mfma_f32_16x16x32_bf16 v[112:115], a[188:191], v[128:131], v[112:115]
  s_waitcnt lgkmcnt(2)
  v_mfma_f32_16x16x32_bf16 v[100:103], v[208:211], v[116:119], v[100:103]
  ds_read_b128 v[128:131], v159 offset:23552
  v_mfma_f32_16x16x32_bf16 v[104:107], a[32:35], v[116:119], v[104:107]
  v_mfma_f32_16x16x32_bf16 v[108:111], a[112:115], v[116:119], v[108:111]
  v_mfma_f32_16x16x32_bf16 v[112:115], a[192:195], v[116:119], v[112:115]
  s_waitcnt lgkmcnt(2)
  v_mfma_f32_16x16x32_bf16 v[100:103], v[212:215], v[120:123], v[100:103]
  ds_read_b128 v[116:119], v159 offset:24576
  v_mfma_f32_16x16x32_bf16 v[104:107], a[36:39], v[120:123], v[104:107]
  s_waitcnt vmcnt(0)
  buffer_store_dword v170, v155, s[8:11], 0 offen
  v_mfma_f32_16x16x32_bf16 v[108:111], a[116:119], v[120:123], v[108:111]
  v_mfma_f32_16x16x32_bf16 v[112:115], a[196:199], v[120:123], v[112:115]
  s_mov_b32 s30, 0
  s_branch pc_49
pw_47:
  buffer_load_dword v158, v189, s[8:11], s33 offen sc1
  s_add_u32 s30, s30, 1
  s_cmp_gt_u32 s30, 65536
  s_cbranch_scc1 role_abort
  s_waitcnt vmcnt(0)
pc_49:
  v_cmp_gt_u32 vcc, v190, v158
  s_nop 0
  s_and_b32 vcc_lo, vcc_lo, 0xf000fff
  s_and_b32 vcc_hi, vcc_hi, 0x0
  s_cmp_eq_u64 vcc, 0
  s_cbranch_scc1 po_48
  s_sleep 4
  s_branch pw_47
po_48:
  s_waitcnt lgkmcnt(2)
  v_mfma_f32_16x16x32_bf16 v[100:103], v[216:219], v[124:127], v[100:103]
  ds_read_b128 v[120:123], v159 offset:25600
  v_mfma_f32_16x16x32_bf16 v[104:107], a[40:43], v[124:127], v[104:107]
  s_add_u32 m0, s44, 0
  s_add_u32 s31, s43, 0
  buffer_load_dwordx4 v144, s[8:11], s31 offen offset:0 sc1 lds
  v_mfma_f32_16x16x32_bf16 v[108:111], a[120:123], v[124:127], v[108:111]
  v_mfma_f32_16x16x32_bf16 v[112:115], a[200:203], v[124:127], v[112:115]
  s_waitcnt lgkmcnt(2)
  v_mfma_f32_16x16x32_bf16 v[100:103], v[220:223], v[128:131], v[100:103]
  ds_read_b128 v[124:127], v159 offset:26624
  v_mfma_f32_16x16x32_bf16 v[104:107], a[44:47], v[128:131], v[104:107]
  buffer_load_dwordx4 v144, s[8:11], s31 offen offset:1024 sc1 lds
  v_mfma_f32_16x16x32_bf16 v[108:111], a[124:127], v[128:131], v[108:111]
  v_mfma_f32_16x16x32_bf16 v[112:115], a[204:207], v[128:131], v[112:115]
  s_waitcnt lgkmcnt(2)
  v_mfma_f32_16x16x32_bf16 v[100:103], v[224:227], v[116:119], v[100:103]
  ds_read_b128 v[128:131], v159 offset:27648
  v_mfma_f32_16x16x32_bf16 v[104:107], a[48:51], v[116:119], v[104:107]
  buffer_load_dwordx4 v144, s[8:11], s31 offen offset:2048 sc1 lds
  v_mfma_f32_16x16x32_bf16 v[108:111], a[128:131], v[116:119], v[108:111]
  v_mfma_f32_16x16x32_bf16 v[112:115], a[208:211], v[116:119], v[112:115]
  s_waitcnt lgkmcnt(2)
  v_mfma_f32_16x16x32_bf16 v[100:103], v[228:231], v[120:123], v[100:103]
  ds_read_b128 v[116:119], v159 offset:28672
  v_mfma_f32_16x16x32_bf16 v[104:107], a[52:55], v[120:123], v[104:107]
  buffer_load_dwordx4 v144, s[8:11], s31 offen offset:3072 sc1 lds
  v_mfma_f32_16x16x32_bf16 v[108:111], a[132:135], v[120:123], v[108:111]
  v_mfma_f32_16x16x32_bf16 v[112:115], a[212:215], v[120:123], v[112:115]
  s_waitcnt lgkmcnt(2)
  v_mfma_f32_16x16x32_bf16 v[100:103], v[232:235], v[124:127], v[100:103]
  ds_read_b128 v[120:123], v159 offset:29696
  v_mfma_f32_16x16x32_bf16 v[104:107], a[56:59], v[124:127], v[104:107]
  s_add_u32 m0, s44, 4096
  s_add_u32 s31, s43, 4096
  buffer_load_dwordx4 v144, s[8:11], s31 offen offset:0 sc1 lds
  v_mfma_f32_16x16x32_bf16 v[108:111], a[136:139], v[124:127], v[108:111]
  v_mfma_f32_16x16x32_bf16 v[112:115], a[216:219], v[124:127], v[112:115]
  s_waitcnt lgkmcnt(2)
  v_mfma_f32_16x16x32_bf16 v[100:103], v[236:239], v[128:131], v[100:103]
  ds_read_b128 v[124:127], v159 offset:30720
  v_mfma_f32_16x16x32_bf16 v[104:107], a[60:63], v[128:131], v[104:107]
  buffer_load_dwordx4 v144, s[8:11], s31 offen offset:1024 sc1 lds
  v_mfma_f32_16x16x32_bf16 v[108:111], a[140:143], v[128:131], v[108:111]
  v_mfma_f32_16x16x32_bf16 v[112:115], a[220:223], v[128:131], v[112:115]
  s_waitcnt lgkmcnt(2)
  v_mfma_f32_16x16x32_bf16 v[100:103], v[240:243], v[116:119], v[100:103]
  ds_read_b128 v[128:131], v159 offset:31744
  v_mfma_f32_16x16x32_bf16 v[104:107], a[64:67], v[116:119], v[104:107]
  buffer_load_dwordx4 v144, s[8:11], s31 offen offset:2048 sc1 lds
  v_mfma_f32_16x16x32_bf16 v[108:111], a[144:147], v[116:119], v[108:111]
  v_mfma_f32_16x16x32_bf16 v[112:115], a[224:227], v[116:119], v[112:115]
  s_waitcnt lgkmcnt(2)
  v_mfma_f32_16x16x32_bf16 v[100:103], v[244:247], v[120:123], v[100:103]
  ds_read_b128 v[116:119], v159 offset:32768
  v_mfma_f32_16x16x32_bf16 v[104:107], a[68:71], v[120:123], v[104:107]
  buffer_load_dwordx4 v144, s[8:11], s31 offen offset:3072 sc1 lds
  v_mfma_f32_16x16x32_bf16 v[108:111], a[148:151], v[120:123], v[108:111]
  v_mfma_f32_16x16x32_bf16 v[112:115], a[228:231], v[120:123], v[112:115]
  s_waitcnt lgkmcnt(2)
  v_mfma_f32_16x16x32_bf16 v[100:103], v[248:251], v[124:127], v[100:103]
  ds_read_b128 v[120:123], v159 offset:33792
  v_mfma_f32_16x16x32_bf16 v[104:107], a[72:75], v[124:127], v[104:107]
  s_add_u32 m0, s44, 8192
  s_add_u32 s31, s43, 8192
  buffer_load_dwordx4 v144, s[8:11], s31 offen offset:0 sc1 lds
  v_mfma_f32_16x16x32_bf16 v[108:111], a[152:155], v[124:127], v[108:111]
  v_mfma_f32_16x16x32_bf16 v[112:115], a[232:235], v[124:127], v[112:115]
  s_waitcnt lgkmcnt(2)
  v_mfma_f32_16x16x32_bf16 v[100:103], v[252:255], v[128:131], v[100:103]
  ds_read_b128 v[124:127], v159 offset:34816
  v_mfma_f32_16x16x32_bf16 v[104:107], a[76:79], v[128:131], v[104:107]
  buffer_load_dwordx4 v144, s[8:11], s31 offen offset:1024 sc1 lds
  v_mfma_f32_16x16x32_bf16 v[108:111], a[156:159], v[128:131], v[108:111]
  v_mfma_f32_16x16x32_bf16 v[112:115], a[236:239], v[128:131], v[112:115]
  s_waitcnt lgkmcnt(2)
  v_mfma_f32_16x16x32_bf16 v[100:103], a[0:3], v[116:119], v[100:103]
  ds_read_b128 v[128:131], v159 offset:35840
  v_mfma_f32_16x16x32_bf16 v[104:107], a[80:83], v[116:119], v[104:107]
  buffer_load_dword v158, v189, s[8:11], s33 offen sc1
  v_mfma_f32_16x16x32_bf16 v[108:111], a[160:163], v[116:119], v[108:111]
  v_mfma_f32_16x16x32_bf16 v[112:115], a[240:243], v[116:119], v[112:115]
  s_waitcnt lgkmcnt(2)
  v_mfma_f32_16x16x32_bf16 v[100:103], a[4:7], v[120:123], v[100:103]
  v_mfma_f32_16x16x32_bf16 v[104:107], a[84:87], v[120:123], v[104:107]
  v_mfma_f32_16x16x32_bf16 v[108:111], a[164:167], v[120:123], v[108:111]
  v_mfma_f32_16x16x32_bf16 v[112:115], a[244:247], v[120:123], v[112:115]
  s_waitcnt lgkmcnt(1)
  v_mfma_f32_16x16x32_bf16 v[100:103], a[8:11], v[124:127], v[100:103]
  v_mfma_f32_16x16x32_bf16 v[104:107], a[88:91], v[124:127], v[104:107]
  v_mfma_f32_16x16x32_bf16 v[108:111], a[168:171], v[124:127], v[108:111]
  v_mfma_f32_16x16x32_bf16 v[112:115], a[248:251], v[124:127], v[112:115]
  s_waitcnt lgkmcnt(0)
  v_mfma_f32_16x16x32_bf16 v[100:103], a[12:15], v[128:131], v[100:103]
  v_mfma_f32_16x16x32_bf16 v[104:107], a[92:95], v[128:131], v[104:107]
  v_mfma_f32_16x16x32_bf16 v[108:111], a[172:175], v[128:131], v[108:111]
  v_mfma_f32_16x16x32_bf16 v[112:115], a[252:255], v[128:131], v[112:115]
  s_xor_b32 s44, s44, 0x10000
  v_xor_b32 v159, 0x10000, v159
  s_cmp_lt_u32 s29, 63
  s_cselect_b32 s31, 40960, 0
  s_add_u32 s43, s43, s31
  s_mul_i32 s31, s16, 2621440
  s_cmp_eq_u32 s29, 11
  s_cselect_b32 s31, s31, 0
  s_sub_u32 s43, s43, s31
  v_mov_b32 v169, s29
  v_cvt_pk_bf16_f32 v132, v100, v101
  v_cvt_pk_bf16_f32 v133, v102, v103
  v_cvt_pk_bf16_f32 v134, v104, v105
  v_cvt_pk_bf16_f32 v135, v106, v107
  buffer_store_dwordx4 v[132:135], v144, s[8:11], s42 offen
  s_add_u32 s42, s42, s50
  ds_write_b128 v162, v[132:135]
  v_cvt_pk_bf16_f32 v136, v108, v109
  v_cvt_pk_bf16_f32 v137, v110, v111
  v_cvt_pk_bf16_f32 v138, v112, v113
  v_cvt_pk_bf16_f32 v139, v114, v115
  buffer_store_dwordx4 v[136:139], v144, s[8:11], s42 offen
  s_add_u32 s42, s42, s50
  ds_write_b128 v176, v[136:139]
  s_cmp_gt_u32 s29, 1
  s_cbranch_scc1 b_step23
  s_waitcnt vmcnt(0) lgkmcnt(0)
  buffer_store_dword v169, v154, s[8:11], 0 offen
  s_cmp_eq_u32 s29, 2
  s_barrier
  s_cbranch_scc1 b_top2
  s_mov_b32 s33, 4096
  s_mov_b32 s30, 0
pw_50:
  buffer_load_dword v166, v157, s[8:11], s33 offen sc1
  s_add_u32 s30, s30, 1
  s_cmp_gt_u32 s30, 65536
  s_cbranch_scc1 role_abort
  s_waitcnt vmcnt(0)
pc_52:
  v_cmp_gt_u32 vcc, 1, v166
  s_nop 0
  s_and_b32 vcc_lo, vcc_lo, 0x10000000
  s_and_b32 vcc_hi, vcc_hi, 0x0
  s_cmp_eq_u64 vcc, 0
  s_cbranch_scc1 po_51
  s_sleep 2
  s_branch pw_50
po_51:
  v_readlane_b32 s31, v166, 28
  s_nop 0
  s_lshl_b32 s31, s31, 13
  s_add_u32 s56, s56, s31
  s_branch b_step22
b_step20:
  s_waitcnt vmcnt(0)
  buffer_store_dword v170, v155, s[8:11], 0 offen
  s_sleep 24
b_step23:
  s_waitcnt vmcnt(2) lgkmcnt(0)
  s_barrier
  ds_write_b128 v144, v[72:75] offset:12288
  ds_write_b128 v144, v[72:75] offset:13312
b_step2S:
  s_sleep 6
b_step22:
  s_and_b32 s31, s28, 3
  s_mul_i32 s36, s31, 81920
  s_add_u32 s36, s36, s35
  s_lshl_b32 s32, s31, 15
  s_add_u32 s38, s37, s32
  s_add_u32 s28, s28, 1
  v_mov_b32 v170, s28
  s_mul_i32 s40, s31, 24576
  s_add_u32 s40, s40, s39
  v_mov_b32 v60, 0
  v_mov_b32 v61, 0
  v_mov_b32 v62, 0
  v_mov_b32 v63, 0
  v_mov_b32 v64, 0
  v_mov_b32 v65, 0
  v_mov_b32 v66, 0
  v_mov_b32 v67, 0
b_step2P:
  s_mov_b32 s30, 0
  buffer_load_dwordx4 v[76:79], v147, s[8:11], s36 offen sc1
  buffer_load_dwordx4 v[80:83], v147, s[8:11], s36 offen offset:1024 sc1
  buffer_load_dword v84, v148, s[8:11], s36 offen sc1
  buffer_load_dword v85, v148, s[8:11], s36 offen offset:256 sc1
  s_nop 15
  s_nop 15
mq_53:
  buffer_load_dwordx4 v[88:91], v147, s[8:11], s36 offen sc1
  buffer_load_dwordx4 v[92:95], v147, s[8:11], s36 offen offset:1024 sc1
  buffer_load_dword v96, v148, s[8:11], s36 offen sc1
  buffer_load_dword v97, v148, s[8:11], s36 offen offset:256 sc1
  s_add_u32 s30, s30, 1
  s_cmp_gt_u32 s30, 65536
  s_cbranch_scc1 chain_abort
  s_waitcnt vmcnt(4)
  buffer_store_dword v169, v154, s[8:11], 0 offen
  v_max3_u32 v167, v76, v80, v84
  v_max_u32 v167, v167, v85
  v_cmp_eq_u32 vcc, -1, v167
  ds_write_b128 v147, v[76:79]
  ds_write_b128 v147, v[80:83] offset:1024
  ds_write2st64_b32 v148, v84, v85 offset0:0 offset1:1
  s_cbranch_vccz mq_53_ok
  buffer_load_dwordx4 v[76:79], v147, s[8:11], s36 offen sc1
  buffer_load_dwordx4 v[80:83], v147, s[8:11], s36 offen offset:1024 sc1
  buffer_load_dword v84, v148, s[8:11], s36 offen sc1
  buffer_load_dword v85, v148, s[8:11], s36 offen offset:256 sc1
  s_waitcnt vmcnt(5)
  v_max3_u32 v167, v88, v92, v96
  v_max_u32 v167, v167, v97
  v_cmp_eq_u32 vcc, -1, v167
  ds_write_b128 v147, v[88:91]
  ds_write_b128 v147, v[92:95] offset:1024
  ds_write2st64_b32 v148, v96, v97 offset0:0 offset1:1
  s_cbranch_vccz mq_53_ok
  s_branch mq_53
.p2align 7
mq_53_ok:
  s_waitcnt lgkmcnt(0)
  s_barrier
  ds_read_b128 v[4:7], v144 offset:0
  ds_read_b128 v[8:11], v144 offset:1024
  ds_read_b128 v[12:15], v144 offset:2048
  ds_read_b128 v[16:19], v144 offset:3072
  ds_read_b128 v[20:23], v144 offset:4096
  ds_read_b128 v[24:27], v144 offset:5120
  ds_read_b128 v[28:31], v144 offset:6144
  ds_read_b128 v[32:35], v144 offset:7168
  ds_read_b128 v[36:39], v144 offset:8192
  ds_read_b128 v[40:43], v144 offset:9216
  s_waitcnt lgkmcnt(9)
  v_smfmac_f32_16x16x64_bf16 v[60:63], v[4:7], v[192:199], v151
  v_smfmac_f32_16x16x64_bf16 v[64:67], v[4:7], a[16:23], v151
  s_waitcnt lgkmcnt(8)
  v_smfmac_f32_16x16x64_bf16 v[60:63], v[8:11], v[200:207], v151
  v_smfmac_f32_16x16x64_bf16 v[64:67], v[8:11], a[24:31], v151
  s_waitcnt lgkmcnt(7)
  v_smfmac_f32_16x16x64_bf16 v[60:63], v[12:15], v[208:215], v151
  v_smfmac_f32_16x16x64_bf16 v[64:67], v[12:15], a[32:39], v151
  s_waitcnt lgkmcnt(6)
  v_smfmac_f32_16x16x64_bf16 v[60:63], v[16:19], v[216:223], v151
  buffer_store_dword v170, v156, s[8:11], 0 offen
  v_smfmac_f32_16x16x64_bf16 v[64:67], v[16:19], a[40:47], v151
  s_waitcnt lgkmcnt(5)
  v_smfmac_f32_16x16x64_bf16 v[60:63], v[20:23], v[224:231], v151
  v_smfmac_f32_16x16x64_bf16 v[64:67], v[20:23], a[48:55], v151
  s_waitcnt lgkmcnt(4)
  v_smfmac_f32_16x16x64_bf16 v[60:63], v[24:27], v[232:239], v151
  v_smfmac_f32_16x16x64_bf16 v[64:67], v[24:27], a[56:63], v151
  s_waitcnt lgkmcnt(3)
  v_smfmac_f32_16x16x64_bf16 v[60:63], v[28:31], v[240:247], v151
  v_smfmac_f32_16x16x64_bf16 v[64:67], v[28:31], a[64:71], v151
  s_waitcnt lgkmcnt(2)
  v_smfmac_f32_16x16x64_bf16 v[60:63], v[32:35], v[248:255], v151
  s_waitcnt lgkmcnt(1)
  v_smfmac_f32_16x16x64_bf16 v[60:63], v[36:39], a[0:7], v151
  s_waitcnt lgkmcnt(0)
  v_smfmac_f32_16x16x64_bf16 v[60:63], v[40:43], a[8:15], v151
  s_nop 2
  v_smfmac_f32_16x16x64_bf16 v[64:67], v[32:35], a[72:79], v151
  s_nop 2
  v_smfmac_f32_16x16x64_bf16 v[64:67], v[36:39], a[80:87], v151
  v_add_f32 v60, v60, v62
  v_add_f32 v61, v61, v63
  v_cvt_pk_bf16_f32 v140, v60, v61
  ds_write2_b32 v149, v140, v140 offset0:0 offset1:1
  v_smfmac_f32_16x16x64_bf16 v[64:67], v[40:43], a[88:95], v151
  s_nop 7
  v_add_f32 v64, v64, v66
  v_add_f32 v65, v65, v67
  v_cvt_pk_bf16_f32 v141, v64, v65
  ds_write2_b32 v149, v141, v141 offset0:128 offset1:129
  s_mov_b32 s30, 0
  s_nop 15
  s_nop 7
sx_54:
  ds_read_b64_tr_b16 v[44:45], v145 offset:12288
  ds_read_b64_tr_b16 v[46:47], v145 offset:12800
  ds_read_b64_tr_b16 v[48:49], v145 offset:13312
  ds_read_b64_tr_b16 v[50:51], v145 offset:13824
  s_waitcnt lgkmcnt(0)
  v_pk_max_u16 v167, v44, v45
  v_pk_max_u16 v168, v46, v47
  v_pk_max_u16 v167, v167, v48
  v_pk_max_u16 v168, v168, v49
  v_pk_max_u16 v167, v167, v50
  v_pk_max_u16 v168, v168, v51
  v_pk_max_u16 v167, v167, v168
  v_lshlrev_b32 v168, 16, v167
  v_max_u32 v167, v167, v168
  v_cmp_le_u32 vcc, 0xffff0000, v167
  s_cbranch_vccnz sx_54_r
  buffer_store_dwordx4 v[44:47], v153, s[8:11], s40 offen
  buffer_store_dwordx4 v[48:51], v153, s[8:11], s40 offen offset:512
  s_add_u32 s31, s28, 2
  s_and_b32 s31, s31, 3
  s_cmp_lg_u32 s28, 64
  s_cbranch_scc1 b_top2
  s_waitcnt vmcnt(0)
  buffer_store_dword v170, v155, s[8:11], 0 offen
  s_cmp_eq_u32 s28, 64
  s_cbranch_scc1 b_end
  s_branch b_top2
sx_54_r:
  s_add_u32 s30, s30, 1
  s_cmp_gt_u32 s30, 65536
  s_cbranch_scc1 chain_abort
  s_branch sx_54
b_pro3:
  s_lshl_b32 s31, s26, 9
  s_add_u32 s37, s37, s31
  s_add_u32 s37, s37, 4096
  s_cmp_lt_u32 s24, 20
  s_cselect_b32 s31, 0, 32768
  s_sub_u32 s47, s47, s31
  s_cmp_lt_u32 s24, 20
  s_cselect_b32 s46, 0, 0
.p2align 7
b_top3:
  s_add_u32 s31, s28, 3
  s_and_b32 s31, s31, 3
  s_mul_i32 s31, s31, 163840
  s_add_u32 s58, s56, s31
  s_add_u32 s59, s58, 16384
  s_add_u32 s60, s58, 32768
  s_cmp_ge_u32 s29, 64
  s_cbranch_scc1 b_step30
  ds_read_b128 v[116:119], v159 offset:16384
  ds_read_b128 v[120:123], v159 offset:17408
  ds_read_b128 v[124:127], v159 offset:18432
  s_and_b32 s31, s29, 3
  s_mul_i32 s31, s31, 147456
  s_add_u32 s42, s41, s31
  s_add_u32 s42, s42, s51
  s_add_u32 s49, s29, 2
  s_lshl_b32 s48, s49, 1
  s_min_u32 s48, s48, 128
  s_and_b32 s31, s29, 3
  s_lshl_b32 s31, s31, 12
  v_add_u32 v162, s31, v160
  v_xor_b32 v176, 1024, v162
  s_add_u32 s29, s29, 1
  s_mov_b32 s33, 4096
  s_max_u32 s31, s29, 4
  s_sub_u32 s31, s31, 4
  v_mov_b32 v190, s31
  v_mov_b32 v167, s48
  v_cndmask_b32 v190, v190, v167, s[74:75]
  s_waitcnt lgkmcnt(2)
  v_mfma_f32_16x16x32_bf16 v[100:103], v[192:195], v[116:119], 0
  ds_read_b128 v[128:131], v159 offset:19456
  v_mfma_f32_16x16x32_bf16 v[104:107], a[16:19], v[116:119], 0
  v_mfma_f32_16x16x32_bf16 v[108:111], a[96:99], v[116:119], 0
  v_mfma_f32_16x16x32_bf16 v[112:115], a[176:179], v[116:119], 0
  s_waitcnt lgkmcnt(2)
  v_mfma_f32_16x16x32_bf16 v[100:103], v[196:199], v[120:123], v[100:103]
  ds_read_b128 v[116:119], v159 offset:20480
  v_mfma_f32_16x16x32_bf16 v[104:107], a[20:23], v[120:123], v[104:107]
  v_mfma_f32_16x16x32_bf16 v[108:111], a[100:103], v[120:123], v[108:111]
  v_mfma_f32_16x16x32_bf16 v[112:115], a[180:183], v[120:123], v[112:115]
  s_waitcnt lgkmcnt(2)
  v_mfma_f32_16x16x32_bf16 v[100:103], v[200:203], v[124:127], v[100:103]
  ds_read_b128 v[120:123], v159 offset:21504
  v_mfma_f32_16x16x32_bf16 v[104:107], a[24:27], v[124:127], v[104:107]
  s_mov_b32 s30, 0
  s_branch pc_57
pw_55:
  buffer_load_dword v158, v189, s[8:11], s33 offen sc1
  s_add_u32 s30, s30, 1
  s_cmp_gt_u32 s30, 65536
  s_cbranch_scc1 role_abort
  s_waitcnt vmcnt(0)
pc_57:
  v_cmp_gt_u32 vcc, v190, v158
  s_nop 0
  s_and_b32 vcc_lo, vcc_lo, 0xf000fff
  s_and_b32 vcc_hi, vcc_hi, 0x0
  s_cmp_eq_u64 vcc, 0
  s_cbranch_scc1 po_56
  s_sleep 4
  s_branch pw_55
po_56:
  v_mfma_f32_16x16x32_bf16 v[108:111], a[104:107], v[124:127], v[108:111]
  v_mfma_f32_16x16x32_bf16 v[112:115], a[184:187], v[124:127], v[112:115]
  s_add_u32 m0, s44, 0
  s_add_u32 s31, s43, 0
  buffer_load_dwordx4 v144, s[8:11], s31 offen offset:0 sc1 lds
  s_waitcnt lgkmcnt(2)
  v_mfma_f32_16x16x32_bf16 v[100:103], v[204:207], v[128:131], v[100:103]
  ds_read_b128 v[124:127], v159 offset:22528
  v_mfma_f32_16x16x32_bf16 v[104:107], a[28:31], v[128:131], v[104:107]
  v_mfma_f32_16x16x32_bf16 v[108:111], a[108:111], v[128:131], v[108:111]
  v_mfma_f32_16x16x32_bf16 v[112:115], a[188:191], v[128:131], v[112:115]
  buffer_load_dwordx4 v144, s[8:11], s31 offen offset:1024 sc1 lds
  s_waitcnt lgkmcnt(2)
  v_mfma_f32_16x16x32_bf16 v[100:103], v[208:211], v[116:119], v[100:103]
  ds_read_b128 v[128:131], v159 offset:23552
  v_mfma_f32_16x16x32_bf16 v[104:107], a[32:35], v[116:119], v[104:107]
  v_mfma_f32_16x16x32_bf16 v[108:111], a[112:115], v[116:119], v[108:111]
  v_mfma_f32_16x16x32_bf16 v[112:115], a[192:195], v[116:119], v[112:115]
  buffer_load_dwordx4 v144, s[8:11], s31 offen offset:2048 sc1 lds
  s_waitcnt lgkmcnt(2)
  v_mfma_f32_16x16x32_bf16 v[100:103], v[212:215], v[120:123], v[100:103]
  ds_read_b128 v[116:119], v159 offset:24576
  v_mfma_f32_16x16x32_bf16 v[104:107], a[36:39], v[120:123], v[104:107]
  v_mfma_f32_16x16x32_bf16 v[108:111], a[116:119], v[120:123], v[108:111]
  v_mfma_f32_16x16x32_bf16 v[112:115], a[196:199], v[120:123], v[112:115]
  buffer_load_dwordx4 v144, s[8:11], s31 offen offset:3072 sc1 lds
  s_waitcnt lgkmcnt(2)
  v_mfma_f32_16x16x32_bf16 v[100:103], v[216:219], v[124:127], v[100:103]
  ds_read_b128 v[120:123], v159 offset:25600
  v_mfma_f32_16x16x32_bf16 v[104:107], a[40:43], v[124:127], v[104:107]
  v_mfma_f32_16x16x32_bf16 v[108:111], a[120:123], v[124:127], v[108:111]
  v_mfma_f32_16x16x32_bf16 v[112:115], a[200:203], v[124:127], v[112:115]
  s_add_u32 m0, s44, 4096
  s_add_u32 s31, s43, 4096
  buffer_load_dwordx4 v144, s[8:11], s31 offen offset:0 sc1 lds
  s_waitcnt lgkmcnt(2)
  v_mfma_f32_16x16x32_bf16 v[100:103], v[220:223], v[128:131], v[100:103]
  ds_read_b128 v[124:127], v159 offset:26624
  v_mfma_f32_16x16x32_bf16 v[104:107], a[44:47], v[128:131], v[104:107]
  v_mfma_f32_16x16x32_bf16 v[108:111], a[124:127], v[128:131], v[108:111]
  v_mfma_f32_16x16x32_bf16 v[112:115], a[204:207], v[128:131], v[112:115]
  buffer_load_dwordx4 v144, s[8:11], s31 offen offset:1024 sc1 lds
  s_waitcnt lgkmcnt(2)
  v_mfma_f32_16x16x32_bf16 v[100:103], v[224:227], v[116:119], v[100:103]
  ds_read_b128 v[128:131], v159 offset:27648
  v_mfma_f32_16x16x32_bf16 v[104:107], a[48:51], v[116:119], v[104:107]
  v_mfma_f32_16x16x32_bf16 v[108:111], a[128:131], v[116:119], v[108:111]
  v_mfma_f32_16x16x32_bf16 v[112:115], a[208:211], v[116:119], v[112:115]
  buffer_load_dwordx4 v144, s[8:11], s31 offen offset:2048 sc1 lds
  s_waitcnt lgkmcnt(2)
  v_mfma_f32_16x16x32_bf16 v[100:103], v[228:231], v[120:123], v[100:103]
  ds_read_b128 v[116:119], v159 offset:28672
  v_mfma_f32_16x16x32_bf16 v[104:107], a[52:55], v[120:123], v[104:107]
  v_mfma_f32_16x16x32_bf16 v[108:111], a[132:135], v[120:123], v[108:111]
  v_mfma_f32_16x16x32_bf16 v[112:115], a[212:215], v[120:123], v[112:115]
  buffer_load_dwordx4 v144, s[8:11], s31 offen offset:3072 sc1 lds
  s_waitcnt lgkmcnt(2)
  v_mfma_f32_16x16x32_bf16 v[100:103], v[232:235], v[124:127], v[100:103]
  ds_read_b128 v[120:123], v159 offset:29696
  v_mfma_f32_16x16x32_bf16 v[104:107], a[56:59], v[124:127], v[104:107]
  v_mfma_f32_16x16x32_bf16 v[108:111], a[136:139], v[124:127], v[108:111]
  v_mfma_f32_16x16x32_bf16 v[112:115], a[216:219], v[124:127], v[112:115]
  s_add_u32 m0, s44, 8192
  s_add_u32 s31, s43, 8192
  buffer_load_dwordx4 v144, s[8:11], s31 offen offset:0 sc1 lds
  s_waitcnt lgkmcnt(2)
  v_mfma_f32_16x16x32_bf16 v[100:103], v[236:239], v[128:131], v[100:103]
  ds_read_b128 v[124:127], v159 offset:30720
  v_mfma_f32_16x16x32_bf16 v[104:107], a[60:63], v[128:131], v[104:107]
  v_mfma_f32_16x16x32_bf16 v[108:111], a[140:143], v[128:131], v[108:111]
  v_mfma_f32_16x16x32_bf16 v[112:115], a[220:223], v[128:131], v[112:115]
  buffer_load_dwordx4 v144, s[8:11], s31 offen offset:1024 sc1 lds
  s_waitcnt lgkmcnt(2)
  v_mfma_f32_16x16x32_bf16 v[100:103], v[240:243], v[116:119], v[100:103]
  ds_read_b128 v[128:131], v159 offset:31744
  v_mfma_f32_16x16x32_bf16 v[104:107], a[64:67], v[116:119], v[104:107]
  v_mfma_f32_16x16x32_bf16 v[108:111], a[144:147], v[116:119], v[108:111]
  v_mfma_f32_16x16x32_bf16 v[112:115], a[224:227], v[116:119], v[112:115]
  buffer_load_dword v158, v189, s[8:11], s33 offen sc1
  s_waitcnt lgkmcnt(2)
  v_mfma_f32_16x16x32_bf16 v[100:103], v[244:247], v[120:123], v[100:103]
  ds_read_b128 v[116:119], v159 offset:32768
  v_mfma_f32_16x16x32_bf16 v[104:107], a[68:71], v[120:123], v[104:107]
  v_mfma_f32_16x16x32_bf16 v[108:111], a[148:151], v[120:123], v[108:111]
  v_mfma_f32_16x16x32_bf16 v[112:115], a[228:231], v[120:123], v[112:115]
  s_waitcnt lgkmcnt(2)
  v_mfma_f32_16x16x32_bf16 v[100:103], v[248:251], v[124:127], v[100:103]
  ds_read_b128 v[120:123], v159 offset:33792
  v_mfma_f32_16x16x32_bf16 v[104:107], a[72:75], v[124:127], v[104:107]
  v_mfma_f32_16x16x32_bf16 v[108:111], a[152:155], v[124:127], v[108:111]
  v_mfma_f32_16x16x32_bf16 v[112:115], a[232:235], v[124:127], v[112:115]
  s_waitcnt lgkmcnt(2)
  v_mfma_f32_16x16x32_bf16 v[100:103], v[252:255], v[128:131], v[100:103]
  ds_read_b128 v[124:127], v159 offset:34816
  v_mfma_f32_16x16x32_bf16 v[104:107], a[76:79], v[128:131], v[104:107]
  v_mfma_f32_16x16x32_bf16 v[108:111], a[156:159], v[128:131], v[108:111]
  v_mfma_f32_16x16x32_bf16 v[112:115], a[236:239], v[128:131], v[112:115]
  s_waitcnt lgkmcnt(2)
  v_mfma_f32_16x16x32_bf16 v[100:103], a[0:3], v[116:119], v[100:103]
  ds_read_b128 v[128:131], v159 offset:35840
  v_mfma_f32_16x16x32_bf16 v[104:107], a[80:83], v[116:119], v[104:107]
  v_mfma_f32_16x16x32_bf16 v[108:111], a[160:163], v[116:119], v[108:111]
  v_mfma_f32_16x16x32_bf16 v[112:115], a[240:243], v[116:119], v[112:115]
  s_waitcnt lgkmcnt(2)
  v_mfma_f32_16x16x32_bf16 v[100:103], a[4:7], v[120:123], v[100:103]
  v_mfma_f32_16x16x32_bf16 v[104:107], a[84:87], v[120:123], v[104:107]
  v_mfma_f32_16x16x32_bf16 v[108:111], a[164:167], v[120:123], v[108:111]
  v_mfma_f32_16x16x32_bf16 v[112:115], a[244:247], v[120:123], v[112:115]
  s_waitcnt lgkmcnt(1)
  v_mfma_f32_16x16x32_bf16 v[100:103], a[8:11], v[124:127], v[100:103]
  v_mfma_f32_16x16x32_bf16 v[104:107], a[88:91], v[124:127], v[104:107]
  v_mfma_f32_16x16x32_bf16 v[108:111], a[168:171], v[124:127], v[108:111]
  v_mfma_f32_16x16x32_bf16 v[112:115], a[248:251], v[124:127], v[112:115]
  s_waitcnt lgkmcnt(0)
  v_mfma_f32_16x16x32_bf16 v[100:103], a[12:15], v[128:131], v[100:103]
  v_mfma_f32_16x16x32_bf16 v[104:107], a[92:95], v[128:131], v[104:107]
  v_mfma_f32_16x16x32_bf16 v[108:111], a[172:175], v[128:131], v[108:111]
  v_mfma_f32_16x16x32_bf16 v[112:115], a[252:255], v[128:131], v[112:115]
  s_xor_b32 s44, s44, 0x10000
  v_xor_b32 v159, 0x10000, v159
  s_cmp_lt_u32 s29, 63
  s_cselect_b32 s31, 40960, 0
  s_add_u32 s43, s43, s31
  s_mul_i32 s31, s16, 2621440
  s_cmp_eq_u32 s29, 11
  s_cselect_b32 s31, s31, 0
  s_sub_u32 s43, s43, s31
  v_mov_b32 v169, s29
  v_cvt_pk_bf16_f32 v132, v100, v101
  v_cvt_pk_bf16_f32 v133, v102, v103
  v_cvt_pk_bf16_f32 v134, v104, v105
  v_cvt_pk_bf16_f32 v135, v106, v107
  buffer_store_dwordx4 v[132:135], v144, s[8:11], s42 offen
  s_add_u32 s42, s42, s50
  v_cvt_pk_bf16_f32 v136, v108, v109
  v_cvt_pk_bf16_f32 v137, v110, v111
  v_cvt_pk_bf16_f32 v138, v112, v113
  v_cvt_pk_bf16_f32 v139, v114, v115
  buffer_store_dwordx4 v[136:139], v144, s[8:11], s42 offen
  s_add_u32 s42, s42, s50
  s_cmp_gt_u32 s29, 2
  s_cbranch_scc1 b_step33
  s_waitcnt vmcnt(0) lgkmcnt(0)
  buffer_store_dword v169, v154, s[8:11], 0 offen
  s_cmp_eq_u32 s29, 1
  s_barrier
  s_cbranch_scc1 b_top3
  s_mov_b32 s33, 4096
  s_mov_b32 s30, 0
pw_58:
  buffer_load_dword v166, v157, s[8:11], s33 offen sc1
  s_add_u32 s30, s30, 1
  s_cmp_gt_u32 s30, 65536
  s_cbranch_scc1 role_abort
  s_waitcnt vmcnt(0)
pc_60:
  v_cmp_gt_u32 vcc, 1, v166
  s_nop 0
  s_and_b32 vcc_lo, vcc_lo, 0x10000000
  s_and_b32 vcc_hi, vcc_hi, 0x0
  s_cmp_eq_u64 vcc, 0
  s_cbranch_scc1 po_59
  s_sleep 2
  s_branch pw_58
po_59:
  v_readlane_b32 s31, v166, 28
  s_nop 0
  s_lshl_b32 s31, s31, 13
  s_add_u32 s56, s56, s31
  s_branch b_step32
b_step30:
  s_sleep 24
b_step33:
  s_waitcnt vmcnt(2) lgkmcnt(0)
  s_barrier
  s_nop 15
  buffer_load_dwordx4 v[116:119], v144, s[8:11], s58 offen sc1
  buffer_load_dwordx4 v[120:123], v144, s[8:11], s58 offen offset:1024 sc1
  s_and_b32 s31, s28, 3
  s_mul_i32 s36, s31, 81920
  s_add_u32 s36, s36, s35
  s_lshl_b32 s32, s31, 15
  s_add_u32 s38, s37, s32
  s_add_u32 s28, s28, 1
  v_mov_b32 v170, s28
  v_mov_b32 v60, 0
  v_mov_b32 v61, 0
  v_mov_b32 v62, 0
  v_mov_b32 v63, 0
  v_mov_b32 v64, 0
  v_mov_b32 v65, 0
  v_mov_b32 v66, 0
  v_mov_b32 v67, 0
  s_mov_b32 s30, 0
  s_add_u32 s31, s36, s57
  s_nop 15
  s_nop 15
  s_nop 15
  s_nop 15
  s_nop 1
  buffer_load_dwordx4 v[124:127], v144, s[8:11], s58 offen sc1
  buffer_load_dwordx4 v[128:131], v144, s[8:11], s58 offen offset:1024 sc1
  s_waitcnt vmcnt(2)
  v_mfma_f32_16x16x32_bf16 v[108:111], v[180:183], v[116:119], 0
  v_mfma_f32_16x16x32_bf16 v[108:111], v[180:183], v[120:123], v[108:111]
  s_nop 7
  v_cmp_u_f32 vcc, v108, v109
  v_cvt_pk_bf16_f32 v168, v108, v109
  s_cbranch_vccnz b_step3xr
b_step3x:
  buffer_store_dword v168, v146, s[8:11], s31 offen
  buffer_store_dword v169, v154, s[8:11], 0 offen
  s_nop 15
  s_nop 13
  s_branch b_step3P
b_step3S:
  s_sleep 6
b_step32:
  s_and_b32 s31, s28, 3
  s_mul_i32 s36, s31, 81920
  s_add_u32 s36, s36, s35
  s_lshl_b32 s32, s31, 15
  s_add_u32 s38, s37, s32
  s_add_u32 s28, s28, 1
  v_mov_b32 v170, s28
  v_mov_b32 v60, 0
  v_mov_b32 v61, 0
  v_mov_b32 v62, 0
  v_mov_b32 v63, 0
  v_mov_b32 v64, 0
  v_mov_b32 v65, 0
  v_mov_b32 v66, 0
  v_mov_b32 v67, 0
.p2align 7
b_step3P:
  s_mov_b32 s30, 0
  buffer_load_dwordx4 v[76:79], v147, s[8:11], s36 offen sc1
  buffer_load_dwordx4 v[80:83], v147, s[8:11], s36 offen offset:1024 sc1
  buffer_load_dword v84, v148, s[8:11], s36 offen sc1
  buffer_load_dword v85, v148, s[8:11], s36 offen offset:256 sc1
  s_nop 15
  s_nop 15
mq_61:
  buffer_load_dwordx4 v[88:91], v147, s[8:11], s36 offen sc1
  buffer_load_dwordx4 v[92:95], v147, s[8:11], s36 offen offset:1024 sc1
  buffer_load_dword v96, v148, s[8:11], s36 offen sc1
  buffer_load_dword v97, v148, s[8:11], s36 offen offset:256 sc1
  s_add_u32 s30, s30, 1
  s_cmp_gt_u32 s30, 65536
  s_cbranch_scc1 chain_abort
  s_waitcnt vmcnt(4)
  buffer_store_dword v169, v154, s[8:11], 0 offen
  v_max3_u32 v167, v76, v80, v84
  v_max_u32 v167, v167, v85
  v_cmp_eq_u32 vcc, -1, v167
  ds_write_b128 v147, v[76:79]
  ds_write_b128 v147, v[80:83] offset:1024
  ds_write2st64_b32 v148, v84, v85 offset0:0 offset1:1
  s_cbranch_vccz mq_61_ok
  buffer_load_dwordx4 v[76:79], v147, s[8:11], s36 offen sc1
  buffer_load_dwordx4 v[80:83], v147, s[8:11], s36 offen offset:1024 sc1
  buffer_load_dword v84, v148, s[8:11], s36 offen sc1
  buffer_load_dword v85, v148, s[8:11], s36 offen offset:256 sc1
  s_waitcnt vmcnt(5)
  v_max3_u32 v167, v88, v92, v96
  v_max_u32 v167, v167, v97
  v_cmp_eq_u32 vcc, -1, v167
  ds_write_b128 v147, v[88:91]
  ds_write_b128 v147, v[92:95] offset:1024
  ds_write2st64_b32 v148, v96, v97 offset0:0 offset1:1
  s_cbranch_vccz mq_61_ok
  s_branch mq_61
.p2align 7
mq_61_ok:
  s_waitcnt lgkmcnt(0)
  s_barrier
  ds_read_b128 v[4:7], v144 offset:0
  ds_read_b128 v[8:11], v144 offset:1024
  ds_read_b128 v[12:15], v144 offset:2048
  ds_read_b128 v[16:19], v144 offset:3072
  ds_read_b128 v[20:23], v144 offset:4096
  ds_read_b128 v[24:27], v144 offset:5120
  ds_read_b128 v[28:31], v144 offset:6144
  ds_read_b128 v[32:35], v144 offset:7168
  ds_read_b128 v[36:39], v144 offset:8192
  ds_read_b128 v[40:43], v144 offset:9216
  s_waitcnt lgkmcnt(9)
  v_smfmac_f32_16x16x64_bf16 v[60:63], v[4:7], v[192:199], v151
  v_smfmac_f32_16x16x64_bf16 v[64:67], v[4:7], a[16:23], v151
  s_waitcnt lgkmcnt(8)
  v_smfmac_f32_16x16x64_bf16 v[60:63], v[8:11], v[200:207], v151
  v_smfmac_f32_16x16x64_bf16 v[64:67], v[8:11], a[24:31], v151
  s_waitcnt lgkmcnt(7)
  v_smfmac_f32_16x16x64_bf16 v[60:63], v[12:15], v[208:215], v151
  v_smfmac_f32_16x16x64_bf16 v[64:67], v[12:15], a[32:39], v151
  s_waitcnt lgkmcnt(6)
  v_smfmac_f32_16x16x64_bf16 v[60:63], v[16:19], v[216:223], v151
  buffer_store_dword v170, v156, s[8:11], 0 offen
  v_smfmac_f32_16x16x64_bf16 v[64:67], v[16:19], a[40:47], v151
  s_waitcnt lgkmcnt(5)
  v_smfmac_f32_16x16x64_bf16 v[60:63], v[20:23], v[224:231], v151
  v_smfmac_f32_16x16x64_bf16 v[64:67], v[20:23], a[48:55], v151
  s_waitcnt lgkmcnt(4)
  v_smfmac_f32_16x16x64_bf16 v[60:63], v[24:27], v[232:239], v151
  v_smfmac_f32_16x16x64_bf16 v[64:67], v[24:27], a[56:63], v151
  s_waitcnt lgkmcnt(3)
  v_smfmac_f32_16x16x64_bf16 v[60:63], v[28:31], v[240:247], v151
  v_smfmac_f32_16x16x64_bf16 v[64:67], v[28:31], a[64:71], v151
  s_waitcnt lgkmcnt(2)
  v_smfmac_f32_16x16x64_bf16 v[60:63], v[32:35], v[248:255], v151
  s_waitcnt lgkmcnt(1)
  v_smfmac_f32_16x16x64_bf16 v[60:63], v[36:39], a[0:7], v151
  s_waitcnt lgkmcnt(0)
  v_smfmac_f32_16x16x64_bf16 v[60:63], v[40:43], a[8:15], v151
  s_nop 2
  v_smfmac_f32_16x16x64_bf16 v[64:67], v[32:35], a[72:79], v151
  s_nop 2
  v_smfmac_f32_16x16x64_bf16 v[64:67], v[36:39], a[80:87], v151
  v_add_f32 v60, v60, v62
  v_add_f32 v61, v61, v63
  v_cvt_pk_bf16_f32 v140, v60, v61
  s_nop 1
  v_mov_b32_dpp v142, v140 quad_perm:[1,0,3,2] row_mask:0xf bank_mask:0xf
  v_perm_b32 v140, v142, v140, v152
  v_smfmac_f32_16x16x64_bf16 v[64:67], v[40:43], a[88:95], v151
  s_nop 7
  v_add_f32 v64, v64, v66
  v_add_f32 v65, v65, v67
  v_cvt_pk_bf16_f32 v141, v64, v65
  s_nop 1
  v_mov_b32_dpp v143, v141 quad_perm:[1,0,3,2] row_mask:0xf bank_mask:0xf
  v_perm_b32 v141, v143, v141, v152
  buffer_store_dwordx2 v[140:141], v150, s[8:11], s38 offen
  s_add_u32 s31, s28, 2
  s_and_b32 s31, s31, 3
  s_cmp_eq_u32 s28, 64
  s_cbranch_scc1 b_end
  s_lshl_b32 s31, s31, 15
  s_add_u32 s31, s31, s37
  buffer_store_dwordx2 v[72:73], v150, s[8:11], s31 offen
  s_add_u32 s31, s28, 1
  s_and_b32 s31, s31, 3
  s_mul_i32 s31, s31, 163840
  s_add_u32 s31, s31, s47
  s_add_u32 s32, s31, s46
  buffer_store_dwordx4 v[72:75], v164, s[8:11], s31 offen sc1
  s_add_u32 s31, s31, 196608
  s_branch b_top3
b_step3xr:
  buffer_load_dwordx4 v[116:119], v144, s[8:11], s58 offen sc1
  buffer_load_dwordx4 v[120:123], v144, s[8:11], s58 offen offset:1024 sc1
  s_add_u32 s30, s30, 1
  s_cmp_gt_u32 s30, 65536
  s_cbranch_scc1 chain_abort
  s_waitcnt vmcnt(2)
  v_mfma_f32_16x16x32_bf16 v[108:111], v[180:183], v[124:127], 0
  v_mfma_f32_16x16x32_bf16 v[108:111], v[180:183], v[128:131], v[108:111]
  s_nop 7
  v_cmp_u_f32 vcc, v108, v109
  v_cvt_pk_bf16_f32 v168, v108, v109
  s_cbranch_vccz b_step3x
  buffer_load_dwordx4 v[124:127], v144, s[8:11], s58 offen sc1
  buffer_load_dwordx4 v[128:131], v144, s[8:11], s58 offen offset:1024 sc1
  s_add_u32 s30, s30, 1
  s_cmp_gt_u32 s30, 65536
  s_cbranch_scc1 chain_abort
  s_waitcnt vmcnt(2)
  v_mfma_f32_16x16x32_bf16 v[108:111], v[180:183], v[116:119], 0
  v_mfma_f32_16x16x32_bf16 v[108:111], v[180:183], v[120:123], v[108:111]
  s_nop 7
  v_cmp_u_f32 vcc, v108, v109
  v_cvt_pk_bf16_f32 v168, v108, v109
  s_cbranch_vccz b_step3x
  s_branch b_step3xr
b_end:
  s_cmp_lt_u32 s18, 4
  s_waitcnt vmcnt(0) lgkmcnt(0)
  s_cbranch_scc1 r_help
  s_endpgm
chain_abort:
  v_mov_b32 v167, 128
  v_mov_b32 v168, 1
  s_mov_b64 exec, 1
  buffer_atomic_add v168, v167, s[12:15], 0 offen
  s_endpgm
role_w:
  s_load_dwordx2 s[20:21], s[0:1], 40
  s_mov_b32 s22, 7864320
  s_mov_b32 s23, 0x00020000
  s_load_dwordx2 s[88:89], s[0:1], 96
  s_mov_b32 s90, 1280
  s_mov_b32 s91, 0x00020000
  s_load_dwordx2 s[92:93], s[0:1], 104
  s_mov_b32 s94, 4915200
  s_mov_b32 s95, 0x00020000
  v_lshrrev_b32 v203, 4, v1
  v_and_b32 v203, 3, v203
  v_lshlrev_b32 v203, 1, v203
  v_and_b32 v207, 7, v1
  v_xor_b32 v207, v207, v203
  v_lshlrev_b32 v207, 4, v207
  v_lshrrev_b32 v203, 3, v1
  v_mul_u32_u24 v203, 1280, v203
  v_add_u32 v207, v207, v203
  s_sub_u32 s24, s18, 18
  s_lshl_b32 s27, s16, 2
  s_add_u32 s27, s27, s17
  s_mul_i32 s29, s27, 245760
  s_lshl_b32 s27, s24, 7
  s_add_u32 s29, s29, s27
  s_mul_i32 s30, s17, 24576
  s_add_u32 s30, s30, 16384
  s_sub_u32 s27, 7, s24
  s_lshl_b32 s27, s27, 3
  s_add_u32 s27, s27, s16
  s_cmp_ge_u32 s27, 20
  s_waitcnt lgkmcnt(0)
  s_cbranch_scc1 w_nm
  v_lshlrev_b32 v12, 2, v0
  buffer_load_dword v13, v12, s[88:91], 0 offen
  buffer_load_dword v14, v12, s[88:91], 0 offen offset:1024
  v_lshrrev_b32 v20, 3, v0
  v_and_b32 v21, 7, v0
  v_mul_u32_u24 v22, 153600, v20
  v_lshl_add_u32 v22, v21, 4, v22
  s_lshl_b32 s6, s27, 7
  buffer_load_dwordx4 v[28:31], v22, s[92:95], s6 offen nt
  s_add_u32 s6, s6, 7680
  buffer_load_dwordx4 v[32:35], v22, s[92:95], s6 offen nt
  s_add_u32 s6, s6, 7680
  buffer_load_dwordx4 v[36:39], v22, s[92:95], s6 offen nt
  s_add_u32 s6, s6, 7680
  buffer_load_dwordx4 v[40:43], v22, s[92:95], s6 offen nt
  s_add_u32 s6, s6, 7680
  buffer_load_dwordx4 v[44:47], v22, s[92:95], s6 offen nt
  s_add_u32 s6, s6, 7680
  buffer_load_dwordx4 v[48:51], v22, s[92:95], s6 offen nt
  s_add_u32 s6, s6, 7680
  buffer_load_dwordx4 v[52:55], v22, s[92:95], s6 offen nt
  s_add_u32 s6, s6, 7680
  buffer_load_dwordx4 v[56:59], v22, s[92:95], s6 offen nt
  s_add_u32 s6, s6, 7680
  buffer_load_dwordx4 v[60:63], v22, s[92:95], s6 offen nt
  s_add_u32 s6, s6, 7680
  buffer_load_dwordx4 v[64:67], v22, s[92:95], s6 offen nt
  s_add_u32 s6, s6, 7680
  buffer_load_dwordx4 v[68:71], v22, s[92:95], s6 offen nt
  s_add_u32 s6, s6, 7680
  buffer_load_dwordx4 v[72:75], v22, s[92:95], s6 offen nt
  s_add_u32 s6, s6, 7680
  buffer_load_dwordx4 v[76:79], v22, s[92:95], s6 offen nt
  s_add_u32 s6, s6, 7680
  buffer_load_dwordx4 v[80:83], v22, s[92:95], s6 offen nt
  s_add_u32 s6, s6, 7680
  buffer_load_dwordx4 v[84:87], v22, s[92:95], s6 offen nt
  s_add_u32 s6, s6, 7680
  buffer_load_dwordx4 v[88:91], v22, s[92:95], s6 offen nt
  s_add_u32 s6, s6, 7680
  buffer_load_dwordx4 v[92:95], v22, s[92:95], s6 offen nt
  s_add_u32 s6, s6, 7680
  buffer_load_dwordx4 v[96:99], v22, s[92:95], s6 offen nt
  s_add_u32 s6, s6, 7680
  buffer_load_dwordx4 v[100:103], v22, s[92:95], s6 offen nt
  s_add_u32 s6, s6, 7680
  buffer_load_dwordx4 v[104:107], v22, s[92:95], s6 offen nt
  s_add_u32 s6, s6, 7680
  s_waitcnt vmcnt(20)
  v_lshlrev_b32 v24, 16, v13
  v_and_b32 v25, 0xffff0000, v13
  v_mul_f32 v16, 0xbfb8aa3b, v24
  v_mul_f32 v17, 0xbfb8aa3b, v25
  v_exp_f32 v16, v16
  v_exp_f32 v17, v17
  v_add_f32 v16, 1.0, v16
  v_add_f32 v17, 1.0, v17
  v_rcp_f32 v16, v16
  v_rcp_f32 v17, v17
  v_mul_f32 v24, v24, v16
  v_mul_f32 v25, v25, v17
  v_cvt_pk_bf16_f32 v16, v24, v25
  v_lshlrev_b32 v24, 16, v16
  v_and_b32 v25, 0xffff0000, v16
  v_lshlrev_b32 v26, 16, v14
  v_and_b32 v27, 0xffff0000, v14
  v_mul_f32 v16, 0xbfb8aa3b, v26
  v_mul_f32 v17, 0xbfb8aa3b, v27
  v_exp_f32 v16, v16
  v_exp_f32 v17, v17
  v_add_f32 v16, 1.0, v16
  v_add_f32 v17, 1.0, v17
  v_rcp_f32 v16, v16
  v_rcp_f32 v17, v17
  v_mul_f32 v26, v26, v16
  v_mul_f32 v27, v27, v17
  v_cvt_pk_bf16_f32 v16, v26, v27
  v_lshlrev_b32 v26, 16, v16
  v_and_b32 v27, 0xffff0000, v16
  v_lshlrev_b32 v12, 3, v0
  ds_write_b64 v12, v[24:25]
  ds_write_b64 v12, v[26:27] offset:2048
  v_mul_u32_u24 v12, 80, v20
  s_waitcnt lgkmcnt(0)
  s_barrier
  ds_read_b128 v[108:111], v12 offset:0
  ds_read_b128 v[112:115], v12 offset:16
  ds_read_b128 v[116:119], v12 offset:32
  ds_read_b128 v[120:123], v12 offset:48
  ds_read_b128 v[124:127], v12 offset:64
  v_mov_b32 v148, 0
  v_mov_b32 v149, 0
  v_mov_b32 v150, 0
  v_mov_b32 v151, 0
  v_mov_b32 v152, 0
  v_mov_b32 v153, 0
  v_mov_b32 v154, 0
  v_mov_b32 v155, 0
  s_waitcnt lgkmcnt(0)
  v_lshrrev_b32 v128, 16, v108
  v_lshrrev_b32 v129, 16, v109
  v_lshrrev_b32 v130, 16, v110
  v_lshrrev_b32 v131, 16, v111
  v_lshrrev_b32 v132, 16, v112
  v_lshrrev_b32 v133, 16, v113
  v_lshrrev_b32 v134, 16, v114
  v_lshrrev_b32 v135, 16, v115
  v_lshrrev_b32 v136, 16, v116
  v_lshrrev_b32 v137, 16, v117
  v_lshrrev_b32 v138, 16, v118
  v_lshrrev_b32 v139, 16, v119
  v_lshrrev_b32 v140, 16, v120
  v_lshrrev_b32 v141, 16, v121
  v_lshrrev_b32 v142, 16, v122
  v_lshrrev_b32 v143, 16, v123
  v_lshrrev_b32 v144, 16, v124
  v_lshrrev_b32 v145, 16, v125
  v_lshrrev_b32 v146, 16, v126
  v_lshrrev_b32 v147, 16, v127
  s_waitcnt vmcnt(18)
  v_dot2c_f32_bf16 v148, v28, v128
  v_dot2c_f32_bf16 v149, v28, v108
  v_dot2c_f32_bf16 v150, v29, v128
  v_dot2c_f32_bf16 v151, v29, v108
  v_dot2c_f32_bf16 v152, v30, v128
  v_dot2c_f32_bf16 v153, v30, v108
  v_dot2c_f32_bf16 v154, v31, v128
  v_dot2c_f32_bf16 v155, v31, v108
  v_dot2c_f32_bf16 v148, v32, v129
  v_dot2c_f32_bf16 v149, v32, v109
  v_dot2c_f32_bf16 v150, v33, v129
  v_dot2c_f32_bf16 v151, v33, v109
  v_dot2c_f32_bf16 v152, v34, v129
  v_dot2c_f32_bf16 v153, v34, v109
  v_dot2c_f32_bf16 v154, v35, v129
  v_dot2c_f32_bf16 v155, v35, v109
  s_waitcnt vmcnt(16)
  v_dot2c_f32_bf16 v148, v36, v130
  v_dot2c_f32_bf16 v149, v36, v110
  v_dot2c_f32_bf16 v150, v37, v130
  v_dot2c_f32_bf16 v151, v37, v110
  v_dot2c_f32_bf16 v152, v38, v130
  v_dot2c_f32_bf16 v153, v38, v110
  v_dot2c_f32_bf16 v154, v39, v130
  v_dot2c_f32_bf16 v155, v39, v110
  v_dot2c_f32_bf16 v148, v40, v131
  v_dot2c_f32_bf16 v149, v40, v111
  v_dot2c_f32_bf16 v150, v41, v131
  v_dot2c_f32_bf16 v151, v41, v111
  v_dot2c_f32_bf16 v152, v42, v131
  v_dot2c_f32_bf16 v153, v42, v111
  v_dot2c_f32_bf16 v154, v43, v131
  v_dot2c_f32_bf16 v155, v43, v111
  s_waitcnt vmcnt(14)
  v_dot2c_f32_bf16 v148, v44, v132
  v_dot2c_f32_bf16 v149, v44, v112
  v_dot2c_f32_bf16 v150, v45, v132
  v_dot2c_f32_bf16 v151, v45, v112
  v_dot2c_f32_bf16 v152, v46, v132
  v_dot2c_f32_bf16 v153, v46, v112
  v_dot2c_f32_bf16 v154, v47, v132
  v_dot2c_f32_bf16 v155, v47, v112
  v_dot2c_f32_bf16 v148, v48, v133
  v_dot2c_f32_bf16 v149, v48, v113
  v_dot2c_f32_bf16 v150, v49, v133
  v_dot2c_f32_bf16 v151, v49, v113
  v_dot2c_f32_bf16 v152, v50, v133
  v_dot2c_f32_bf16 v153, v50, v113
  v_dot2c_f32_bf16 v154, v51, v133
  v_dot2c_f32_bf16 v155, v51, v113
  s_waitcnt vmcnt(12)
  v_dot2c_f32_bf16 v148, v52, v134
  v_dot2c_f32_bf16 v149, v52, v114
  v_dot2c_f32_bf16 v150, v53, v134
  v_dot2c_f32_bf16 v151, v53, v114
  v_dot2c_f32_bf16 v152, v54, v134
  v_dot2c_f32_bf16 v153, v54, v114
  v_dot2c_f32_bf16 v154, v55, v134
  v_dot2c_f32_bf16 v155, v55, v114
  v_dot2c_f32_bf16 v148, v56, v135
  v_dot2c_f32_bf16 v149, v56, v115
  v_dot2c_f32_bf16 v150, v57, v135
  v_dot2c_f32_bf16 v151, v57, v115
  v_dot2c_f32_bf16 v152, v58, v135
  v_dot2c_f32_bf16 v153, v58, v115
  v_dot2c_f32_bf16 v154, v59, v135
  v_dot2c_f32_bf16 v155, v59, v115
  s_waitcnt vmcnt(10)
  v_dot2c_f32_bf16 v148, v60, v136
  v_dot2c_f32_bf16 v149, v60, v116
  v_dot2c_f32_bf16 v150, v61, v136
  v_dot2c_f32_bf16 v151, v61, v116
  v_dot2c_f32_bf16 v152, v62, v136
  v_dot2c_f32_bf16 v153, v62, v116
  v_dot2c_f32_bf16 v154, v63, v136
  v_dot2c_f32_bf16 v155, v63, v116
  v_dot2c_f32_bf16 v148, v64, v137
  v_dot2c_f32_bf16 v149, v64, v117
  v_dot2c_f32_bf16 v150, v65, v137
  v_dot2c_f32_bf16 v151, v65, v117
  v_dot2c_f32_bf16 v152, v66, v137
  v_dot2c_f32_bf16 v153, v66, v117
  v_dot2c_f32_bf16 v154, v67, v137
  v_dot2c_f32_bf16 v155, v67, v117
  s_waitcnt vmcnt(8)
  v_dot2c_f32_bf16 v148, v68, v138
  v_dot2c_f32_bf16 v149, v68, v118
  v_dot2c_f32_bf16 v150, v69, v138
  v_dot2c_f32_bf16 v151, v69, v118
  v_dot2c_f32_bf16 v152, v70, v138
  v_dot2c_f32_bf16 v153, v70, v118
  v_dot2c_f32_bf16 v154, v71, v138
  v_dot2c_f32_bf16 v155, v71, v118
  v_dot2c_f32_bf16 v148, v72, v139
  v_dot2c_f32_bf16 v149, v72, v119
  v_dot2c_f32_bf16 v150, v73, v139
  v_dot2c_f32_bf16 v151, v73, v119
  v_dot2c_f32_bf16 v152, v74, v139
  v_dot2c_f32_bf16 v153, v74, v119
  v_dot2c_f32_bf16 v154, v75, v139
  v_dot2c_f32_bf16 v155, v75, v119
  s_waitcnt vmcnt(6)
  v_dot2c_f32_bf16 v148, v76, v140
  v_dot2c_f32_bf16 v149, v76, v120
  v_dot2c_f32_bf16 v150, v77, v140
  v_dot2c_f32_bf16 v151, v77, v120
  v_dot2c_f32_bf16 v152, v78, v140
  v_dot2c_f32_bf16 v153, v78, v120
  v_dot2c_f32_bf16 v154, v79, v140
  v_dot2c_f32_bf16 v155, v79, v120
  v_dot2c_f32_bf16 v148, v80, v141
  v_dot2c_f32_bf16 v149, v80, v121
  v_dot2c_f32_bf16 v150, v81, v141
  v_dot2c_f32_bf16 v151, v81, v121
  v_dot2c_f32_bf16 v152, v82, v141
  v_dot2c_f32_bf16 v153, v82, v121
  v_dot2c_f32_bf16 v154, v83, v141
  v_dot2c_f32_bf16 v155, v83, v121
  s_waitcnt vmcnt(4)
  v_dot2c_f32_bf16 v148, v84, v142
  v_dot2c_f32_bf16 v149, v84, v122
  v_dot2c_f32_bf16 v150, v85, v142
  v_dot2c_f32_bf16 v151, v85, v122
  v_dot2c_f32_bf16 v152, v86, v142
  v_dot2c_f32_bf16 v153, v86, v122
  v_dot2c_f32_bf16 v154, v87, v142
  v_dot2c_f32_bf16 v155, v87, v122
  v_dot2c_f32_bf16 v148, v88, v143
  v_dot2c_f32_bf16 v149, v88, v123
  v_dot2c_f32_bf16 v150, v89, v143
  v_dot2c_f32_bf16 v151, v89, v123
  v_dot2c_f32_bf16 v152, v90, v143
  v_dot2c_f32_bf16 v153, v90, v123
  v_dot2c_f32_bf16 v154, v91, v143
  v_dot2c_f32_bf16 v155, v91, v123
  s_waitcnt vmcnt(2)
  v_dot2c_f32_bf16 v148, v92, v144
  v_dot2c_f32_bf16 v149, v92, v124
  v_dot2c_f32_bf16 v150, v93, v144
  v_dot2c_f32_bf16 v151, v93, v124
  v_dot2c_f32_bf16 v152, v94, v144
  v_dot2c_f32_bf16 v153, v94, v124
  v_dot2c_f32_bf16 v154, v95, v144
  v_dot2c_f32_bf16 v155, v95, v124
  v_dot2c_f32_bf16 v148, v96, v145
  v_dot2c_f32_bf16 v149, v96, v125
  v_dot2c_f32_bf16 v150, v97, v145
  v_dot2c_f32_bf16 v151, v97, v125
  v_dot2c_f32_bf16 v152, v98, v145
  v_dot2c_f32_bf16 v153, v98, v125
  v_dot2c_f32_bf16 v154, v99, v145
  v_dot2c_f32_bf16 v155, v99, v125
  s_waitcnt vmcnt(0)
  v_dot2c_f32_bf16 v148, v100, v146
  v_dot2c_f32_bf16 v149, v100, v126
  v_dot2c_f32_bf16 v150, v101, v146
  v_dot2c_f32_bf16 v151, v101, v126
  v_dot2c_f32_bf16 v152, v102, v146
  v_dot2c_f32_bf16 v153, v102, v126
  v_dot2c_f32_bf16 v154, v103, v146
  v_dot2c_f32_bf16 v155, v103, v126
  v_dot2c_f32_bf16 v148, v104, v147
  v_dot2c_f32_bf16 v149, v104, v127
  v_dot2c_f32_bf16 v150, v105, v147
  v_dot2c_f32_bf16 v151, v105, v127
  v_dot2c_f32_bf16 v152, v106, v147
  v_dot2c_f32_bf16 v153, v106, v127
  v_dot2c_f32_bf16 v154, v107, v147
  v_dot2c_f32_bf16 v155, v107, v127
  v_lshlrev_b32 v12, 5, v0
  ds_write_b128 v12, v[148:151] offset:4096
  s_nop 0
  ds_write_b128 v12, v[152:155] offset:4112
  v_lshlrev_b32 v12, 2, v0
  s_waitcnt lgkmcnt(0)
  s_barrier
  s_cmp_lg_u32 s17, 0
  s_cbranch_scc1 mod_enda
  ds_read2st64_b32 v[28:29], v12 offset0:16 offset1:17
  ds_read2st64_b32 v[30:31], v12 offset0:18 offset1:19
  ds_read2st64_b32 v[32:33], v12 offset0:20 offset1:21
  ds_read2st64_b32 v[34:35], v12 offset0:22 offset1:23
  ds_read2st64_b32 v[36:37], v12 offset0:24 offset1:25
  ds_read2st64_b32 v[38:39], v12 offset0:26 offset1:27
  ds_read2st64_b32 v[40:41], v12 offset0:28 offset1:29
  ds_read2st64_b32 v[42:43], v12 offset0:30 offset1:31
  ds_read2st64_b32 v[44:45], v12 offset0:32 offset1:33
  ds_read2st64_b32 v[46:47], v12 offset0:34 offset1:35
  ds_read2st64_b32 v[48:49], v12 offset0:36 offset1:37
  ds_read2st64_b32 v[50:51], v12 offset0:38 offset1:39
  ds_read2st64_b32 v[52:53], v12 offset0:40 offset1:41
  ds_read2st64_b32 v[54:55], v12 offset0:42 offset1:43
  ds_read2st64_b32 v[56:57], v12 offset0:44 offset1:45
  ds_read2st64_b32 v[58:59], v12 offset0:46 offset1:47
  s_waitcnt lgkmcnt(11)
  v_pk_add_f32 v[28:29], v[28:29], v[30:31]
  v_pk_add_f32 v[28:29], v[28:29], v[32:33]
  v_pk_add_f32 v[28:29], v[28:29], v[34:35]
  v_pk_add_f32 v[28:29], v[28:29], v[36:37]
  s_waitcnt lgkmcnt(7)
  v_pk_add_f32 v[28:29], v[28:29], v[38:39]
  v_pk_add_f32 v[28:29], v[28:29], v[40:41]
  v_pk_add_f32 v[28:29], v[28:29], v[42:43]
  v_pk_add_f32 v[28:29], v[28:29], v[44:45]
  s_waitcnt lgkmcnt(3)
  v_pk_add_f32 v[28:29], v[28:29], v[46:47]
  v_pk_add_f32 v[28:29], v[28:29], v[48:49]
  v_pk_add_f32 v[28:29], v[28:29], v[50:51]
  v_pk_add_f32 v[28:29], v[28:29], v[52:53]
  s_waitcnt lgkmcnt(0)
  v_pk_add_f32 v[28:29], v[28:29], v[54:55]
  v_pk_add_f32 v[28:29], v[28:29], v[56:57]
  v_pk_add_f32 v[28:29], v[28:29], v[58:59]
  v_add_f32 v28, v28, v29
  v_cvt_pk_bf16_f32 v28, v28, v28
  v_lshlrev_b32 v28, 16, v28
  s_lshl_b32 s6, s27, 8
  s_add_u32 s6, s6, 65536
  buffer_store_dword v28, v12, s[8:11], s6 offen sc1
  v_mov_b32 v16, 200
  v_mov_b32 v17, 1
  s_waitcnt vmcnt(0)
  s_mov_b64 exec, 1
  buffer_atomic_add v17, v16, s[12:15], 0 offen sc1
  s_mov_b64 exec, -1
mod_enda:
  s_branch w_nc
w_nm:
  s_waitcnt lgkmcnt(0)
  s_lshl_b32 s27, s24, 2
  s_add_u32 s27, s27, s17
  s_cmp_lg_u32 s27, 32
  s_cbranch_scc1 w_nc
  s_lshl_b32 s92, s16, 8
  s_add_u32 s92, s92, 17268736
  s_mov_b32 s93, 0
  s_mov_b32 s94, -1
  s_mov_b32 s95, -1
  v_lshlrev_b32 v12, 2, v1
  v_mov_b32 v13, -1
  s_waitcnt vmcnt(0)
boot_cal:
  s_memtime s[88:89]
  s_waitcnt lgkmcnt(0)
  buffer_store_dword v13, v12, s[8:11], s92 offen sc1
  s_waitcnt vmcnt(0)
  s_memtime s[90:91]
  s_waitcnt lgkmcnt(0)
  s_sub_u32 s88, s90, s88
  s_min_u32 s88, s88, s94
  s_mov_b32 s94, s95
  s_mov_b32 s95, s88
  s_xor_b32 s92, s92, 8192
  s_add_u32 s93, s93, 1
  s_cmp_lt_u32 s93, 10
  s_cbranch_scc1 boot_cal
  v_mov_b32 v12, 192
  s_mov_b32 s93, 0
gw_63:
  buffer_load_dword v13, v12, s[12:15], 0 offen sc1
  s_add_u32 s93, s93, 1
  s_cmp_gt_u32 s93, 65536
  s_cbranch_scc1 role_abort
  s_waitcnt vmcnt(0)
  v_cmp_gt_u32 vcc, 16, v13
  s_cbranch_vccz gk_64
  s_sleep 8
  s_branch gw_63
gk_64:
  s_cmp_lt_u32 s94, s95
  s_cselect_b32 s93, 1, 2
  s_lshl_b32 s92, s16, 8
  s_add_u32 s92, s92, 4208
  v_mov_b32 v12, s93
  v_mov_b32 v13, s92
  s_mov_b64 exec, 1
  buffer_store_dword v12, v13, s[8:11], 0 offen
  s_mov_b64 exec, -1
w_nc:
  s_cmp_ge_u32 s24, 4
  s_cbranch_scc1 w_nt
  s_lshl_b32 s27, s24, 2
  s_add_u32 s27, s27, s17
  s_lshl_b32 s27, s27, 13
  s_mul_i32 s28, s16, 2621440
  s_add_u32 s28, s28, s27
  s_add_u32 s28, s28, 247463936
  v_lshlrev_b32 v203, 7, v1
  buffer_load_dword v204, v203, s[8:11], s28 offen sc1
  s_lshl_b32 s28, s16, 22
  s_add_u32 s27, s27, s28
  s_add_u32 s27, s27, 67108864
  buffer_load_dword v204, v203, s[8:11], s27 offen sc1
  s_add_u32 s27, s27, 131072
  buffer_load_dword v204, v203, s[8:11], s27 offen sc1
  s_add_u32 s27, s27, 131072
  buffer_load_dword v204, v203, s[8:11], s27 offen sc1
w_nt:
  s_add_u32 m0, s30, 0
  s_add_u32 s28, s29, 0
  buffer_load_dwordx4 v207, s[20:23], s28 offen nt lds
  s_add_u32 m0, s30, 1024
  s_add_u32 s28, s29, 10240
  buffer_load_dwordx4 v207, s[20:23], s28 offen nt lds
  s_add_u32 m0, s30, 2048
  s_add_u32 s28, s29, 20480
  buffer_load_dwordx4 v207, s[20:23], s28 offen nt lds
  s_add_u32 m0, s30, 3072
  s_add_u32 s28, s29, 30720
  buffer_load_dwordx4 v207, s[20:23], s28 offen nt lds
  s_add_u32 m0, s30, 4096
  s_add_u32 s28, s29, 40960
  buffer_load_dwordx4 v207, s[20:23], s28 offen nt lds
  s_add_u32 m0, s30, 5120
  s_add_u32 s28, s29, 51200
  buffer_load_dwordx4 v207, s[20:23], s28 offen nt lds
  s_add_u32 m0, s30, 6144
  s_add_u32 s28, s29, 61440
  buffer_load_dwordx4 v207, s[20:23], s28 offen nt lds
  s_add_u32 m0, s30, 7168
  s_add_u32 s28, s29, 71680
  buffer_load_dwordx4 v207, s[20:23], s28 offen nt lds
  s_add_u32 m0, s30, 8192
  s_add_u32 s28, s29, 81920
  buffer_load_dwordx4 v207, s[20:23], s28 offen nt lds
  s_add_u32 m0, s30, 9216
  s_add_u32 s28, s29, 92160
  buffer_load_dwordx4 v207, s[20:23], s28 offen nt lds
  s_add_u32 m0, s30, 10240
  s_add_u32 s28, s29, 102400
  buffer_load_dwordx4 v207, s[20:23], s28 offen nt lds
  s_add_u32 m0, s30, 11264
  s_add_u32 s28, s29, 112640
  buffer_load_dwordx4 v207, s[20:23], s28 offen nt lds
  s_add_u32 m0, s30, 12288
  s_add_u32 s28, s29, 122880
  buffer_load_dwordx4 v207, s[20:23], s28 offen nt lds
  s_add_u32 m0, s30, 13312
  s_add_u32 s28, s29, 133120
  buffer_load_dwordx4 v207, s[20:23], s28 offen nt lds
  s_add_u32 m0, s30, 14336
  s_add_u32 s28, s29, 143360
  buffer_load_dwordx4 v207, s[20:23], s28 offen nt lds
  s_add_u32 m0, s30, 15360
  s_add_u32 s28, s29, 153600
  buffer_load_dwordx4 v207, s[20:23], s28 offen nt lds
  s_add_u32 m0, s30, 16384
  s_add_u32 s28, s29, 163840
  buffer_load_dwordx4 v207, s[20:23], s28 offen nt lds
  s_add_u32 m0, s30, 17408
  s_add_u32 s28, s29, 174080
  buffer_load_dwordx4 v207, s[20:23], s28 offen nt lds
  s_add_u32 m0, s30, 18432
  s_add_u32 s28, s29, 184320
  buffer_load_dwordx4 v207, s[20:23], s28 offen nt lds
  s_add_u32 m0, s30, 19456
  s_add_u32 s28, s29, 194560
  buffer_load_dwordx4 v207, s[20:23], s28 offen nt lds
  s_add_u32 m0, s30, 20480
  s_add_u32 s28, s29, 204800
  buffer_load_dwordx4 v207, s[20:23], s28 offen nt lds
  s_add_u32 m0, s30, 21504
  s_add_u32 s28, s29, 215040
  buffer_load_dwordx4 v207, s[20:23], s28 offen nt lds
  s_add_u32 m0, s30, 22528
  s_add_u32 s28, s29, 225280
  buffer_load_dwordx4 v207, s[20:23], s28 offen nt lds
  s_add_u32 m0, s30, 23552
  s_add_u32 s28, s29, 235520
  buffer_load_dwordx4 v207, s[20:23], s28 offen nt lds
w_md:
  s_waitcnt vmcnt(24)
  v_mov_b32 v152, -1
  v_mov_b32 v153, -1
  v_mov_b32 v154, -1
  v_mov_b32 v155, -1
  s_cmp_ge_u32 s24, 8
  s_cbranch_scc1 w_ns
  s_lshl_b32 s27, s24, 2
  s_add_u32 s27, s27, s17
  s_mul_i32 s28, s16, 30
  s_add_u32 s28, s28, 568
  s_lshl_b32 s29, s16, 1
  s_add_u32 s29, s29, 482
  s_cmp_lt_u32 s27, 30
  s_cselect_b32 s28, s28, s29
  s_add_u32 s27, s27, s28
  s_lshl_b32 s27, s27, 12
  v_lshlrev_b32 v156, 4, v1
  buffer_store_dwordx4 v[152:155], v156, s[8:11], s27 offen offset:0 sc1
  buffer_store_dwordx4 v[152:155], v156, s[8:11], s27 offen offset:1024 sc1
  buffer_store_dwordx4 v[152:155], v156, s[8:11], s27 offen offset:2048 sc1
  buffer_store_dwordx4 v[152:155], v156, s[8:11], s27 offen offset:3072 sc1
w_ns:
  v_lshrrev_b32 v203, 2, v1
  v_lshrrev_b32 v204, 1, v203
  v_and_b32 v204, 3, v204
  v_lshlrev_b32 v204, 1, v204
  v_bfe_u32 v220, v1, 1, 1
  v_add_u32 v220, 0, v220
  v_xor_b32 v220, v220, v204
  v_lshlrev_b32 v220, 4, v220
  v_lshlrev_b32 v203, 7, v203
  v_add_u32 v220, v220, v203
  v_and_b32 v203, 1, v1
  v_lshlrev_b32 v203, 3, v203
  v_add_u32 v220, v220, v203
  v_add_u32 v220, s30, v220
  v_lshrrev_b32 v203, 2, v1
  v_lshrrev_b32 v204, 1, v203
  v_and_b32 v204, 3, v204
  v_lshlrev_b32 v204, 1, v204
  v_bfe_u32 v221, v1, 1, 1
  v_add_u32 v221, 2, v221
  v_xor_b32 v221, v221, v204
  v_lshlrev_b32 v221, 4, v221
  v_lshlrev_b32 v203, 7, v203
  v_add_u32 v221, v221, v203
  v_and_b32 v203, 1, v1
  v_lshlrev_b32 v203, 3, v203
  v_add_u32 v221, v221, v203
  v_add_u32 v221, s30, v221
  v_lshrrev_b32 v203, 2, v1
  v_lshrrev_b32 v204, 1, v203
  v_and_b32 v204, 3, v204
  v_lshlrev_b32 v204, 1, v204
  v_bfe_u32 v222, v1, 1, 1
  v_add_u32 v222, 4, v222
  v_xor_b32 v222, v222, v204
  v_lshlrev_b32 v222, 4, v222
  v_lshlrev_b32 v203, 7, v203
  v_add_u32 v222, v222, v203
  v_and_b32 v203, 1, v1
  v_lshlrev_b32 v203, 3, v203
  v_add_u32 v222, v222, v203
  v_add_u32 v222, s30, v222
  v_lshrrev_b32 v203, 2, v1
  v_lshrrev_b32 v204, 1, v203
  v_and_b32 v204, 3, v204
  v_lshlrev_b32 v204, 1, v204
  v_bfe_u32 v223, v1, 1, 1
  v_add_u32 v223, 6, v223
  v_xor_b32 v223, v223, v204
  v_lshlrev_b32 v223, 4, v223
  v_lshlrev_b32 v203, 7, v203
  v_add_u32 v223, v223, v203
  v_and_b32 v203, 1, v1
  v_lshlrev_b32 v203, 3, v203
  v_add_u32 v223, v223, v203
  v_add_u32 v223, s30, v223
  v_mov_b32 v80, 0x3f803f80
  v_mov_b32 v81, 0x3f803f80
  v_mov_b32 v82, 0x3f803f80
  v_mov_b32 v83, 0x3f803f80
  v_mov_b32 v108, 0
  v_mov_b32 v109, 0
  v_mov_b32 v110, 0
  v_mov_b32 v111, 0
  v_mov_b32 v112, 0
  v_mov_b32 v113, 0
  v_mov_b32 v114, 0
  v_mov_b32 v115, 0
  v_mov_b32 v116, 0
  v_mov_b32 v117, 0
  v_mov_b32 v118, 0
  v_mov_b32 v119, 0
  v_mov_b32 v84, 0
  v_mov_b32 v85, 0
  v_mov_b32 v86, 0
  v_mov_b32 v87, 0
  v_mov_b32 v88, 0
  v_mov_b32 v89, 0
  v_mov_b32 v90, 0
  v_mov_b32 v91, 0
  v_mov_b32 v92, 0
  v_mov_b32 v93, 0
  v_mov_b32 v94, 0
  v_mov_b32 v95, 0
  v_mov_b32 v96, 0
  v_mov_b32 v97, 0
  v_mov_b32 v98, 0
  v_mov_b32 v99, 0
  v_lshlrev_b32 v184, 4, v1
  v_lshlrev_b32 v185, 2, v1
  v_lshrrev_b32 v32, 4, v1
  v_and_b32 v33, 15, v1
  v_mov_b32 v202, 0
  v_bfe_u32 v203, v1, 1, 1
  v_mul_u32_u24 v203, 0xaaaa, v203
  v_add_u32 v190, 0x4444, v203
  s_lshl_b32 s27, s17, 8
  s_lshl_b32 s28, s24, 10
  s_add_u32 s27, s27, s28
  v_add_u32 v188, s27, v185
  s_lshl_b32 s27, s17, 11
  s_add_u32 s27, s27, 81920
  v_add_u32 v186, s27, v184
  s_lshl_b32 s27, s17, 2
  s_add_u32 s27, s27, 90112
  v_lshl_add_u32 v192, v33, 4, s27
  s_lshl_b32 s27, s17, 9
  s_add_u32 s27, s27, 81920
  v_and_b32 v203, 3, v1
  v_lshlrev_b32 v203, 5, v203
  v_bfe_u32 v204, v1, 4, 1
  v_lshl_add_u32 v203, v204, 4, v203
  v_add_u32 v193, 90112, v203
  v_bfe_u32 v204, v1, 5, 1
  v_lshl_add_u32 v203, v204, 3, v203
  v_bfe_u32 v204, v1, 2, 2
  v_lshl_add_u32 v203, v204, 7, v203
  v_add_u32 v187, s27, v203
  s_mov_b32 s58, 0x00ff00ff
  s_mov_b32 s59, 0x00ff00ff
  s_mov_b32 s60, 0x3dd53b95
  s_mov_b32 s61, s60
  s_mul_i32 s31, s16, 10240
  s_add_u32 s31, s31, 131072
  s_lshl_b32 s33, s16, 17
  s_lshl_b32 s28, s17, 13
  s_add_u32 s33, s33, s28
  s_add_u32 s33, s33, 3407872
  s_lshl_b32 s27, s16, 22
  s_add_u32 s27, s27, 67108864
  s_mul_i32 s38, s17, 12288
  s_add_u32 s38, s38, s27
  s_add_u32 s38, s38, 98304
  s_lshr_b32 s28, s17, 1
  s_lshl_b32 s28, s28, 10
  s_add_u32 s27, s27, s28
  s_add_u32 s39, s27, 602112
  s_add_u32 s40, s27, 610304
  s_mul_i32 s36, s24, 16384
  s_lshl_b32 s27, s17, 11
  s_add_u32 s36, s36, s27
  s_add_u32 s36, s36, 16777216
  v_lshlrev_b32 v194, 2, v32
  v_lshl_add_u32 v194, v33, 4, v194
  s_lshr_b32 s37, s16, 2
  s_lshl_b32 s37, s37, 10
  s_and_b32 s27, s16, 3
  s_lshl_b32 s27, s27, 4
  s_mov_b64 s[56:57], 0xffff
  s_lshl_b64 s[56:57], s[56:57], s27
  s_not_b64 s[56:57], s[56:57]
  s_lshl_b32 s27, s16, 8
  s_mul_i32 s28, s17, 24
  v_mov_b32 v203, 72
  v_mov_b32 v204, s28
  v_cmp_gt_u32 vcc, 6, v1
  s_nop 1
  v_cndmask_b32 v203, v203, v204, vcc
  v_min_u32 v204, 40, v185
  v_add3_u32 v189, v203, v204, s27
  v_add_u32 v189, 4096, v189
  s_lshl_b32 s28, s17, 6
  s_add_u32 s27, s27, s28
  s_add_u32 s27, s27, 12288
  v_add_u32 v195, s27, v185
  v_subrev_u32 v203, 64, v185
  ds_bpermute_b32 v204, v203, v189
  v_cmp_gt_u32 vcc, 22, v1
  s_nop 1
  v_cndmask_b32 v218, 0, 2, vcc
  v_cmp_gt_u32 vcc, 16, v1
  s_nop 1
  v_cndmask_b32 v218, v218, 1, vcc
  s_waitcnt lgkmcnt(0)
  v_cndmask_b32 v195, v204, v195, vcc
  v_bfe_u32 v203, v1, 2, 1
  v_and_b32 v204, 3, v1
  v_lshl_add_u32 v203, v203, 3, v204
  v_lshl_add_u32 v203, v32, 4, v203
  v_lshlrev_b32 v203, 4, v203
  v_bfe_u32 v204, v1, 3, 1
  v_mul_u32_u24 v205, 1088, v204
  s_and_b32 s28, s17, 1
  s_lshl_b32 s27, s28, 11
  v_add3_u32 v212, v203, v205, s27
  v_xor_b32 v213, 64, v212
  s_lshl_b32 s27, s17, 12
  v_add_u32 v214, s27, v184
  v_xor_b32 v215, 64, v214
  s_lshl_b32 s27, s28, 3
  s_add_u32 s27, s27, 65536
  v_lshl_add_u32 v203, v204, 2, v203
  v_add_u32 v198, s27, v203
  v_add_u32 v217, 64, v198
  s_lshl_b32 s27, s17, 10
  s_add_u32 s27, s27, 65536
  v_add_u32 v200, s27, v184
  v_mul_u32_u24 v203, 1280, v33
  v_lshl_add_u32 v197, v32, 4, v203
  s_lshl_b32 s41, s16, 1
  s_lshr_b32 s27, s17, 1
  s_add_u32 s41, s41, s27
  s_mul_i32 s41, s41, 20480
  s_lshl_b32 s27, s24, 7
  s_add_u32 s41, s41, s27
  s_lshl_b32 s27, s28, 6
  s_add_u32 s41, s41, s27
  s_add_u32 s41, s41, 226492416
  s_lshl_b32 s27, s16, 11
  s_lshl_b32 s28, s24, 7
  s_add_u32 s27, s27, s28
  s_lshl_b32 s28, s17, 2
  s_add_u32 s27, s27, s28
  v_mov_b32 v196, s27
  s_mov_b32 s42, 2162688
  s_mov_b32 s25, 0
  v_and_b32 v204, 3, v1
  v_mov_b32 v205, 0
  v_mov_b32 v206, 0x3f80
  v_cmp_eq_u32 vcc, 0, v204
  s_nop 1
  v_cndmask_b32 v205, v205, v206, vcc
  v_mov_b32 v206, 0x3f800000
  v_cmp_eq_u32 vcc, 1, v204
  s_nop 1
  v_cndmask_b32 v205, v205, v206, vcc
  v_lshrrev_b32 v203, 2, v33
  v_mov_b32 v206, 0
  v_mov_b32 v122, 0x3f803f80
  v_mov_b32 v123, 0
  v_mov_b32 v158, 0
  v_mov_b32 v159, 0
  v_cmp_eq_u32 vcc, 0, v203
  s_nop 1
  v_cndmask_b32 v76, v206, v205, vcc
  v_cmp_eq_u32 vcc, 1, v203
  s_nop 1
  v_cndmask_b32 v77, v206, v205, vcc
  v_cmp_eq_u32 vcc, 2, v203
  s_nop 1
  v_cndmask_b32 v78, v206, v205, vcc
  v_cmp_eq_u32 vcc, 3, v203
  s_nop 1
  v_cndmask_b32 v79, v206, v205, vcc
  v_mov_b32 v144, 0
  v_mov_b32 v145, 0
  v_mov_b32 v146, 0
  v_mov_b32 v147, 0
  s_waitcnt vmcnt(0)
  ds_read_b64_tr_b16 a[0:1], v220 offset:0
  ds_read_b64_tr_b16 a[2:3], v220 offset:2048
  ds_read_b64_tr_b16 a[24:25], v221 offset:0
  ds_read_b64_tr_b16 a[26:27], v221 offset:2048
  ds_read_b64_tr_b16 a[48:49], v222 offset:0
  ds_read_b64_tr_b16 a[50:51], v222 offset:2048
  ds_read_b64_tr_b16 a[72:73], v223 offset:0
  ds_read_b64_tr_b16 a[74:75], v223 offset:2048
  s_waitcnt lgkmcnt(8)
  ds_read_b64_tr_b16 a[4:5], v220 offset:4096
  ds_read_b64_tr_b16 a[6:7], v220 offset:6144
  ds_read_b64_tr_b16 a[28:29], v221 offset:4096
  ds_read_b64_tr_b16 a[30:31], v221 offset:6144
  ds_read_b64_tr_b16 a[52:53], v222 offset:4096
  ds_read_b64_tr_b16 a[54:55], v222 offset:6144
  ds_read_b64_tr_b16 a[76:77], v223 offset:4096
  ds_read_b64_tr_b16 a[78:79], v223 offset:6144
  s_waitcnt lgkmcnt(8)
  ds_read_b64_tr_b16 a[8:9], v220 offset:8192
  ds_read_b64_tr_b16 a[10:11], v220 offset:10240
  ds_read_b64_tr_b16 a[32:33], v221 offset:8192
  ds_read_b64_tr_b16 a[34:35], v221 offset:10240
  ds_read_b64_tr_b16 a[56:57], v222 offset:8192
  ds_read_b64_tr_b16 a[58:59], v222 offset:10240
  ds_read_b64_tr_b16 a[80:81], v223 offset:8192
  ds_read_b64_tr_b16 a[82:83], v223 offset:10240
  s_waitcnt lgkmcnt(8)
  ds_read_b64_tr_b16 a[12:13], v220 offset:12288
  ds_read_b64_tr_b16 a[14:15], v220 offset:14336
  ds_read_b64_tr_b16 a[36:37], v221 offset:12288
  ds_read_b64_tr_b16 a[38:39], v221 offset:14336
  ds_read_b64_tr_b16 a[60:61], v222 offset:12288
  ds_read_b64_tr_b16 a[62:63], v222 offset:14336
  ds_read_b64_tr_b16 a[84:85], v223 offset:12288
  ds_read_b64_tr_b16 a[86:87], v223 offset:14336
  s_waitcnt lgkmcnt(8)
  ds_read_b64_tr_b16 a[16:17], v220 offset:16384
  ds_read_b64_tr_b16 a[18:19], v220 offset:18432
  ds_read_b64_tr_b16 a[40:41], v221 offset:16384
  ds_read_b64_tr_b16 a[42:43], v221 offset:18432
  ds_read_b64_tr_b16 a[64:65], v222 offset:16384
  ds_read_b64_tr_b16 a[66:67], v222 offset:18432
  ds_read_b64_tr_b16 a[88:89], v223 offset:16384
  ds_read_b64_tr_b16 a[90:91], v223 offset:18432
  s_waitcnt lgkmcnt(8)
  ds_read_b64_tr_b16 a[20:21], v220 offset:20480
  ds_read_b64_tr_b16 a[22:23], v220 offset:22528
  ds_read_b64_tr_b16 a[44:45], v221 offset:20480
  ds_read_b64_tr_b16 a[46:47], v221 offset:22528
  ds_read_b64_tr_b16 a[68:69], v222 offset:20480
  ds_read_b64_tr_b16 a[70:71], v222 offset:22528
  ds_read_b64_tr_b16 a[92:93], v223 offset:20480
  ds_read_b64_tr_b16 a[94:95], v223 offset:22528
  s_waitcnt lgkmcnt(8)
  s_waitcnt lgkmcnt(0)
  s_barrier
  s_lshl_b32 s26, s16, 2
  s_add_u32 s26, s26, 32
  v_mov_b32 v203, s26
  s_mov_b32 s26, 0
  s_mov_b64 exec, 1
gw_65:
  buffer_load_dword v204, v203, s[12:15], 0 offen sc1
  s_add_u32 s26, s26, 1
  s_cmp_gt_u32 s26, 65536
  s_cbranch_scc1 role_abort
  s_waitcnt vmcnt(0)
  v_cmp_gt_u32 vcc, 1, v204
  s_cbranch_vccz gk_66
  s_sleep 4
  s_branch gw_65
gk_66:
  s_mov_b64 exec, -1
  s_mov_b32 s26, 0
pw_67:
  buffer_load_dword v191, v189, s[8:11], 0 offen sc1
  s_add_u32 s26, s26, 1
  s_cmp_gt_u32 s26, 65536
  s_cbranch_scc1 role_abort
  s_waitcnt vmcnt(0)
pc_69:
  v_cmp_gt_u32 vcc, 1, v191
  s_nop 0
  s_and_b32 vcc_lo, vcc_lo, 0x400
  s_and_b32 vcc_hi, vcc_hi, 0x0
  s_cmp_eq_u64 vcc, 0
  s_cbranch_scc1 po_68
  s_sleep 16
  s_branch pw_67
po_68:
  v_readlane_b32 s27, v191, 10
  s_nop 0
  s_sub_u32 s27, s27, 1
  s_lshl_b32 s27, s27, 13
  s_add_u32 s36, s36, s27
w_pro:
  s_add_u32 s43, s25, 1
  s_mov_b32 s26, 0
  s_waitcnt vmcnt(0)
we_70:
  v_cmp_gt_u32 vcc, s43, v191
  s_nop 0
  s_and_b32 vcc_lo, vcc_lo, 0x3f
  s_cbranch_scc1 we_70_r
  s_add_u32 s27, s25, 0
  s_and_b32 s27, s27, 3
  s_mul_i32 s27, s27, 147456
  s_add_u32 s45, s38, s27
  s_add_u32 s46, s45, 4096
  s_add_u32 s47, s45, 6144
  s_add_u32 s48, s45, 10240
  buffer_load_dwordx4 a[96:99], v184, s[8:11], s45 offen offset:0 sc1
  buffer_load_dwordx4 a[100:103], v184, s[8:11], s45 offen offset:1024 sc1
  buffer_load_dwordx4 a[104:107], v184, s[8:11], s45 offen offset:2048 sc1
  buffer_load_dwordx4 a[108:111], v184, s[8:11], s45 offen offset:3072 sc1
  buffer_load_dwordx4 a[112:115], v184, s[8:11], s46 offen offset:0 sc1
  buffer_load_dwordx4 a[116:119], v184, s[8:11], s46 offen offset:1024 sc1
  buffer_load_dwordx4 a[120:123], v184, s[8:11], s47 offen offset:0 sc1
  buffer_load_dwordx4 a[124:127], v184, s[8:11], s47 offen offset:1024 sc1
  buffer_load_dwordx4 a[128:131], v184, s[8:11], s47 offen offset:2048 sc1
  buffer_load_dwordx4 a[132:135], v184, s[8:11], s47 offen offset:3072 sc1
  buffer_load_dwordx4 a[136:139], v184, s[8:11], s48 offen offset:0 sc1
  buffer_load_dwordx4 a[140:143], v184, s[8:11], s48 offen offset:1024 sc1
  s_waitcnt vmcnt(11)
  v_mfma_f32_16x16x32_bf16 v[48:51], a[96:99], a[0:3], 0
  v_mfma_f32_16x16x32_bf16 v[52:55], a[96:99], a[24:27], 0
  v_mfma_f32_16x16x32_bf16 v[56:59], a[96:99], a[48:51], 0
  v_mfma_f32_16x16x32_bf16 v[60:63], a[96:99], a[72:75], 0
  s_waitcnt vmcnt(10)
  v_mfma_f32_16x16x32_bf16 v[48:51], a[100:103], a[4:7], v[48:51]
  v_mfma_f32_16x16x32_bf16 v[52:55], a[100:103], a[28:31], v[52:55]
  v_mfma_f32_16x16x32_bf16 v[56:59], a[100:103], a[52:55], v[56:59]
  v_mfma_f32_16x16x32_bf16 v[60:63], a[100:103], a[76:79], v[60:63]
  s_waitcnt vmcnt(9)
  v_mfma_f32_16x16x32_bf16 v[48:51], a[104:107], a[8:11], v[48:51]
  v_mfma_f32_16x16x32_bf16 v[52:55], a[104:107], a[32:35], v[52:55]
  v_mfma_f32_16x16x32_bf16 v[56:59], a[104:107], a[56:59], v[56:59]
  v_mfma_f32_16x16x32_bf16 v[60:63], a[104:107], a[80:83], v[60:63]
  s_waitcnt vmcnt(8)
  v_mfma_f32_16x16x32_bf16 v[48:51], a[108:111], a[12:15], v[48:51]
  v_mfma_f32_16x16x32_bf16 v[52:55], a[108:111], a[36:39], v[52:55]
  v_mfma_f32_16x16x32_bf16 v[56:59], a[108:111], a[60:63], v[56:59]
  v_mfma_f32_16x16x32_bf16 v[60:63], a[108:111], a[84:87], v[60:63]
  s_waitcnt vmcnt(7)
  v_mfma_f32_16x16x32_bf16 v[48:51], a[112:115], a[16:19], v[48:51]
  v_mfma_f32_16x16x32_bf16 v[52:55], a[112:115], a[40:43], v[52:55]
  v_mfma_f32_16x16x32_bf16 v[56:59], a[112:115], a[64:67], v[56:59]
  v_mfma_f32_16x16x32_bf16 v[60:63], a[112:115], a[88:91], v[60:63]
  s_waitcnt vmcnt(6)
  v_mfma_f32_16x16x32_bf16 v[48:51], a[116:119], a[20:23], v[48:51]
  v_mfma_f32_16x16x32_bf16 v[52:55], a[116:119], a[44:47], v[52:55]
  v_mfma_f32_16x16x32_bf16 v[56:59], a[116:119], a[68:71], v[56:59]
  v_mfma_f32_16x16x32_bf16 v[60:63], a[116:119], a[92:95], v[60:63]
  s_nop 4
  v_cvt_pk_bf16_f32 v32, v48, v49
  v_cvt_pk_bf16_f32 v33, v50, v51
  v_cvt_pk_bf16_f32 v36, v52, v53
  v_cvt_pk_bf16_f32 v37, v54, v55
  v_cvt_pk_bf16_f32 v40, v56, v57
  v_cvt_pk_bf16_f32 v41, v58, v59
  v_cvt_pk_bf16_f32 v44, v60, v61
  v_cvt_pk_bf16_f32 v45, v62, v63
  s_waitcnt vmcnt(0)
.p2align 7
  s_nop 0
  s_nop 0
  s_nop 0
  s_nop 0
  s_nop 0
  s_nop 0
  s_nop 0
  s_nop 0
  s_nop 0
w_loop:
  v_mfma_f32_16x16x32_bf16 v[48:51], a[120:123], a[0:3], 0
  s_add_u32 s27, s25, 2
  s_and_b32 s27, s27, 3
  s_mul_i32 s28, s27, 24576
  v_mfma_f32_16x16x32_bf16 v[52:55], a[120:123], a[24:27], 0
  s_add_u32 s49, s39, s28
  s_add_u32 s50, s49, 4096
  s_add_u32 s51, s40, s28
  v_mfma_f32_16x16x32_bf16 v[56:59], a[120:123], a[48:51], 0
  s_lshl_b32 s28, s27, 14
  v_add_u32 v208, s28, v212
  v_add_u32 v209, s28, v213
  v_mfma_f32_16x16x32_bf16 v[60:63], a[120:123], a[72:75], 0
  s_lshl_b32 s28, s27, 12
  v_add_u32 v199, s28, v198
  v_add_u32 v216, s28, v217
  v_mfma_f32_16x16x32_bf16 v[48:51], a[124:127], a[4:7], v[48:51]
  ds_read_b128 a[144:147], v208 offset:0
  ds_read_b128 a[148:151], v209 offset:0
  ds_read_b128 a[152:155], v208 offset:4096
  buffer_load_dwordx4 a[176:179], v184, s[8:11], s49 offen offset:0 sc1
  v_mfma_f32_16x16x32_bf16 v[52:55], a[124:127], a[28:31], v[52:55]
  ds_read_b128 a[156:159], v209 offset:4096
  ds_read_b128 a[160:163], v208 offset:8192
  v_mfma_f32_16x16x32_bf16 v[56:59], a[124:127], a[52:55], v[56:59]
  ds_read_b128 a[164:167], v209 offset:8192
  ds_read_b128 a[168:171], v208 offset:12288
  ds_read_b128 a[172:175], v209 offset:12288
  v_mfma_f32_16x16x32_bf16 v[60:63], a[124:127], a[76:79], v[60:63]
  ds_read2st64_b32 v[160:161], v199 offset0:0 offset1:4
  ds_read2st64_b32 v[162:163], v199 offset0:8 offset1:12
  ds_read2st64_b32 v[164:165], v216 offset0:0 offset1:4
  v_mfma_f32_16x16x32_bf16 v[48:51], a[128:131], a[8:11], v[48:51]
  ds_read2st64_b32 v[166:167], v216 offset0:8 offset1:12
  s_cmp_ge_u32 s25, 4
  s_cselect_b32 s27, 327680, 0
  buffer_load_dwordx4 a[180:183], v184, s[8:11], s49 offen offset:2048 sc1
  v_mfma_f32_16x16x32_bf16 v[52:55], a[128:131], a[32:35], v[52:55]
  s_add_u32 s41, s41, s27
  v_add_u32 v219, s25, v218
  v_mfma_f32_16x16x32_bf16 v[56:59], a[128:131], a[56:59], v[56:59]
  v_min_u32 v219, 64, v219
  s_and_b32 s27, s25, 3
  s_lshl_b32 s28, s27, 15
  v_mfma_f32_16x16x32_bf16 v[60:63], a[128:131], a[80:83], v[60:63]
  s_add_u32 s34, s33, s28
  s_add_u32 s35, s34, 4096
  s_lshl_b32 s28, s27, 14
  v_mfma_f32_16x16x32_bf16 v[48:51], a[132:135], a[12:15], v[48:51]
  v_add_u32 v210, s28, v214
  v_add_u32 v211, s28, v215
  s_lshl_b32 s28, s27, 12
  buffer_load_dwordx4 a[184:187], v184, s[8:11], s50 offen offset:0 sc1
  v_mfma_f32_16x16x32_bf16 v[52:55], a[132:135], a[36:39], v[52:55]
  v_add_u32 v201, s28, v200
  s_mul_i32 s27, s27, 163840
  v_mfma_f32_16x16x32_bf16 v[56:59], a[132:135], a[60:63], v[56:59]
  s_add_u32 s27, s27, s36
  s_lshl_b32 s28, s16, 8
  s_add_u32 s52, s27, s28
  v_mfma_f32_16x16x32_bf16 v[60:63], a[132:135], a[84:87], v[60:63]
  s_xor_b32 s53, s52, 8192
  s_add_u32 s54, s27, s37
  s_xor_b32 s55, s54, 1024
  v_mfma_f32_16x16x32_bf16 v[48:51], a[136:139], a[16:19], v[48:51]
  s_add_u32 s44, s25, 1
  s_and_b32 s27, s44, 3
  s_mul_i32 s32, s27, 81920
  buffer_load_dwordx4 a[188:191], v184, s[8:11], s50 offen offset:2048 sc1
  v_mfma_f32_16x16x32_bf16 v[52:55], a[136:139], a[40:43], v[52:55]
  s_add_u32 s32, s32, s31
  s_add_u32 s43, s25, 2
  v_mfma_f32_16x16x32_bf16 v[56:59], a[136:139], a[64:67], v[56:59]
  s_min_u32 s43, s43, 64
  s_cmp_eq_u32 s25, 0
  s_cselect_b32 s43, 0, s43
  v_mfma_f32_16x16x32_bf16 v[60:63], a[136:139], a[88:91], v[60:63]
  s_add_u32 s27, s25, 1
  s_and_b32 s27, s27, 3
  s_mul_i32 s27, s27, 147456
  v_mfma_f32_16x16x32_bf16 v[48:51], a[140:143], a[20:23], v[48:51]
  s_add_u32 s45, s38, s27
  s_add_u32 s46, s45, 4096
  s_add_u32 s47, s45, 6144
  buffer_load_dwordx4 a[192:195], v184, s[8:11], s51 offen sc1
  v_mfma_f32_16x16x32_bf16 v[52:55], a[140:143], a[44:47], v[52:55]
  s_add_u32 s48, s45, 10240
  v_mfma_f32_16x16x32_bf16 v[56:59], a[140:143], a[68:71], v[56:59]
  v_mfma_f32_16x16x32_bf16 v[60:63], a[140:143], a[92:95], v[60:63]
  v_cvt_pk_bf16_f32 v34, v48, v49
  v_cvt_pk_bf16_f32 v35, v50, v51
  ds_write_b128 v210, v[32:35] offset:0
  s_nop 1
  v_cvt_pk_bf16_f32 v38, v52, v53
  v_cvt_pk_bf16_f32 v39, v54, v55
  ds_write_b128 v211, v[36:39] offset:1024
  s_mov_b64 exec, 0x3f01ff
  buffer_load_dword v180, v195, s[8:11], 0 offen sc1
  s_mov_b64 exec, -1
  v_cvt_pk_bf16_f32 v42, v56, v57
  v_cvt_pk_bf16_f32 v43, v58, v59
  ds_write_b128 v210, v[40:43] offset:2048
  v_cvt_pk_bf16_f32 v46, v60, v61
  v_cvt_pk_bf16_f32 v47, v62, v63
  ds_write_b128 v211, v[44:47] offset:3072
  s_mov_b32 s26, 0
  s_mov_b64 exec, 0x3f01ff
  buffer_load_dword v181, v195, s[8:11], 0 offen sc1
  s_nop 15
  buffer_load_dword v182, v195, s[8:11], 0 offen sc1
  s_nop 15
w_mk:
  buffer_load_dword v183, v195, s[8:11], 0 offen sc1
  s_add_u32 s26, s26, 1
  s_cmp_gt_u32 s26, 65536
  s_cbranch_scc1 chain_abort
  s_waitcnt vmcnt(3)
  v_cmp_gt_u32 vcc, v219, v180
  s_cbranch_vccz w_mk_ok
  buffer_load_dword v180, v195, s[8:11], 0 offen sc1
  s_waitcnt vmcnt(3)
  v_cmp_gt_u32 vcc, v219, v181
  s_cbranch_vccz w_mk_ok
  buffer_load_dword v181, v195, s[8:11], 0 offen sc1
  s_waitcnt vmcnt(3)
  v_cmp_gt_u32 vcc, v219, v182
  s_cbranch_vccz w_mk_ok
  buffer_load_dword v182, v195, s[8:11], 0 offen sc1
  s_waitcnt vmcnt(3)
  v_cmp_gt_u32 vcc, v219, v183
  s_cbranch_vccz w_mk_ok
  s_branch w_mk
w_mk_ok:
  s_mov_b64 exec, -1
  s_mov_b32 s26, 0
  s_nop 15
  s_nop 14
  buffer_load_dwordx4 v[4:7], v184, s[8:11], s35 offen offset:0 sc1
  buffer_load_dwordx4 v[8:11], v184, s[8:11], s35 offen offset:1024 sc1
  buffer_load_dwordx4 v[12:15], v184, s[8:11], s35 offen offset:2048 sc1
  s_nop 15
  s_nop 15
  s_nop 15
  s_nop 5
  buffer_load_dwordx4 v[20:23], v184, s[8:11], s34 offen offset:0 sc1
  buffer_load_dwordx4 v[24:27], v184, s[8:11], s34 offen offset:1024 sc1
  buffer_load_dwordx4 v[28:31], v184, s[8:11], s34 offen offset:2048 sc1
  buffer_load_dword v16, v185, s[8:11], s34 offen offset:3072 sc1
  buffer_load_dword v17, v185, s[8:11], s34 offen offset:3328 sc1
  buffer_load_dword v18, v185, s[8:11], s34 offen offset:3584 sc1
  s_waitcnt vmcnt(6)
w_gv:
  v_max3_u32 v203, v4, v8, v12
  v_cmp_eq_u32 vcc, -1, v203
  s_cbranch_vccnz w_gv_r
  v_smfmac_f32_16x16x64_bf16 v[84:87], v[4:7], a[0:7], v190
  v_smfmac_f32_16x16x64_bf16 v[88:91], v[4:7], a[24:31], v190
  v_smfmac_f32_16x16x64_bf16 v[92:95], v[4:7], a[48:55], v190
  buffer_load_dwordx4 a[96:99], v184, s[8:11], s45 offen offset:0 sc1
  v_smfmac_f32_16x16x64_bf16 v[96:99], v[4:7], a[72:79], v190
  v_smfmac_f32_16x16x64_bf16 v[84:87], v[8:11], a[8:15], v190
  v_smfmac_f32_16x16x64_bf16 v[88:91], v[8:11], a[32:39], v190
  v_smfmac_f32_16x16x64_bf16 v[92:95], v[8:11], a[56:63], v190
  buffer_load_dwordx4 a[100:103], v184, s[8:11], s45 offen offset:1024 sc1
  v_smfmac_f32_16x16x64_bf16 v[96:99], v[8:11], a[80:87], v190
  v_smfmac_f32_16x16x64_bf16 v[84:87], v[12:15], a[16:23], v190
  v_smfmac_f32_16x16x64_bf16 v[88:91], v[12:15], a[40:47], v190
  v_smfmac_f32_16x16x64_bf16 v[92:95], v[12:15], a[64:71], v190
  buffer_load_dwordx4 a[104:107], v184, s[8:11], s45 offen offset:2048 sc1
  v_smfmac_f32_16x16x64_bf16 v[96:99], v[12:15], a[88:95], v190
  s_cmp_eq_u32 s25, 63
  s_cbranch_scc1 w_last
  s_nop 1
  v_cvt_pk_bf16_f32 v100, v84, v85
  v_cvt_pk_bf16_f32 v101, v86, v87
  v_cvt_pk_bf16_f32 v104, v92, v93
  v_cvt_pk_bf16_f32 v105, v94, v95
  v_cvt_pk_bf16_f32 v102, v88, v89
  v_cvt_pk_bf16_f32 v103, v90, v91
  v_cvt_pk_bf16_f32 v106, v96, v97
  v_cvt_pk_bf16_f32 v107, v98, v99
  buffer_load_dwordx4 a[108:111], v184, s[8:11], s45 offen offset:3072 sc1
  s_waitcnt vmcnt(7)
w_gx:
  v_pk_add_f32 v[64:65], v[20:21], v[24:25]
  v_pk_add_f32 v[66:67], v[22:23], v[26:27]
  v_pk_add_f32 v[64:65], v[64:65], v[28:29]
  v_pk_add_f32 v[66:67], v[66:67], v[30:31]
  v_cmp_u_f32 vcc, v64, v64
  v_pk_mul_f32 v[64:65], v[64:65], s[60:61]
  v_pk_mul_f32 v[66:67], v[66:67], s[60:61]
  v_exp_f32 v64, v64
  s_cbranch_vccnz w_gx_r
  v_exp_f32 v65, v65
  v_exp_f32 v66, v66
  v_exp_f32 v67, v67
  s_waitcnt vmcnt(4)
w_gm:
  v_add_f32 v68, v16, v17
  v_cvt_pk_bf16_f32 v140, v64, v65
  v_cvt_pk_bf16_f32 v141, v66, v67
  v_add_f32 v68, v68, v18
  v_cmp_u_f32 vcc, v68, v68
  v_mov_b32_dpp v108, v140 quad_perm:[0,1,2,3] row_mask:0xf bank_mask:0x3
  v_mov_b32_dpp v109, v141 quad_perm:[0,1,2,3] row_mask:0xf bank_mask:0x3
  v_mul_f32 v68, s60, v68
  v_mov_b32_dpp v110, v140 row_ror:8 row_mask:0xf bank_mask:0x3
  v_mov_b32_dpp v111, v141 row_ror:8 row_mask:0xf bank_mask:0x3
  v_exp_f32 v68, v68
  s_cbranch_vccnz w_gm_r
  v_mfma_f32_16x16x32_bf16 v[72:75], v[80:83], v[108:111], 0
  buffer_load_dwordx4 a[112:115], v184, s[8:11], s46 offen offset:0 sc1
  v_mov_b32_dpp v112, v140 row_ror:8 row_mask:0xf bank_mask:0xc
  v_mov_b32_dpp v113, v141 row_ror:8 row_mask:0xf bank_mask:0xc
  v_mov_b32_dpp v114, v140 quad_perm:[0,1,2,3] row_mask:0xf bank_mask:0xc
  v_mov_b32_dpp v115, v141 quad_perm:[0,1,2,3] row_mask:0xf bank_mask:0xc
  v_mfma_f32_16x16x32_bf16 v[132:135], v[32:35], v[108:111], 0
  v_mov_b32_dpp v69, v68 row_ror:8 row_mask:0xf bank_mask:0xf
  v_cvt_pk_bf16_f32 v142, v68, v69
  v_mfma_f32_16x16x32_bf16 v[136:139], v[40:43], v[108:111], 0
  s_nop 0
  v_mov_b32_dpp v116, v142 quad_perm:[0,1,2,3] row_mask:0xf bank_mask:0x3
  v_mov_b32_dpp v117, v142 quad_perm:[0,1,2,3] row_mask:0xf bank_mask:0x3
  v_mfma_f32_16x16x32_bf16 v[132:135], v[36:39], v[112:115], v[132:135]
  v_mov_b32_dpp v118, v142 row_ror:8 row_mask:0xf bank_mask:0xc
  v_mov_b32_dpp v119, v142 row_ror:8 row_mask:0xf bank_mask:0xc
  v_mfma_f32_16x16x32_bf16 v[136:139], v[44:47], v[112:115], v[136:139]
  v_mfma_f32_16x16x16_bf16 v[72:75], v[122:123], v[116:117], v[72:75]
  buffer_load_dwordx4 a[116:119], v184, s[8:11], s46 offen offset:1024 sc1
  buffer_store_dwordx4 v[176:179], v197, s[8:11], s41 offen sc1
  v_mfma_f32_16x16x16_bf16 v[132:135], v[100:101], v[116:117], v[132:135]
  s_nop 1
  v_mfma_f32_16x16x16_bf16 v[136:139], v[104:105], v[116:117], v[136:139]
  v_mfma_f32_16x16x16_bf16 v[132:135], v[102:103], v[118:119], v[132:135]
  s_nop 0
  v_subrev_u32 v203, 0x21800000, v72
  v_rcp_f32 v120, v72
  v_mfma_f32_16x16x16_bf16 v[136:139], v[106:107], v[118:119], v[136:139]
  v_cmp_lt_u32 vcc, 0x50000000, v203
  ds_write_b32 v192, v120
  s_and_b64 vcc, vcc, s[58:59]
  s_cbranch_vccnz w_gz_r
w_gz:
  s_nop 0
  ds_write_b128 v186, v[132:135] offset:0
  s_nop 2
  ds_write_b128 v186, v[136:139] offset:1024
  s_waitcnt lgkmcnt(0)
  s_barrier
  ds_read_b128 v[100:103], v193
  ds_read_b64 v[124:125], v187 offset:0
  ds_read_b64 v[126:127], v187 offset:2048
  ds_read_b64 v[128:129], v187 offset:4096
  ds_read_b64 v[130:131], v187 offset:6144
  s_waitcnt lgkmcnt(3)
  v_pk_mul_f32 v[120:121], v[124:125], v[100:101] op_sel_hi:[1,0]
  s_waitcnt lgkmcnt(2)
  v_pk_fma_f32 v[120:121], v[126:127], v[100:101], v[120:121] op_sel:[0,1,0]
  s_waitcnt lgkmcnt(1)
  v_pk_fma_f32 v[120:121], v[128:129], v[102:103], v[120:121] op_sel_hi:[1,0,1]
  s_waitcnt lgkmcnt(0)
  v_pk_fma_f32 v[120:121], v[130:131], v[102:103], v[120:121] op_sel:[0,1,0]
  v_cvt_pk_bf16_f32 v120, v120, v121
  buffer_store_dword v120, v185, s[8:11], s53 offen sc1
  buffer_store_dword v120, v185, s[8:11], s52 offen sc1
  v_mfma_f32_16x16x32_bf16 v[168:171], a[144:147], a[176:179], 0
  v_pk_add_f32 v[84:85], v[84:85], v[86:87]
  v_pk_add_f32 v[88:89], v[88:89], v[90:91]
  v_pk_add_f32 v[92:93], v[92:93], v[94:95]
  v_mfma_f32_16x16x32_bf16 v[172:175], a[148:151], a[176:179], 0
  v_pk_add_f32 v[96:97], v[96:97], v[98:99]
  v_cvt_pk_bf16_f32 v72, v84, v85
  v_cvt_pk_bf16_f32 v73, v88, v89
  buffer_load_dwordx4 a[120:123], v184, s[8:11], s47 offen offset:0 sc1
  v_mfma_f32_16x16x32_bf16 v[168:171], a[152:155], a[180:183], v[168:171]
  v_cvt_pk_bf16_f32 v74, v92, v93
  v_cvt_pk_bf16_f32 v75, v96, v97
  v_mfma_f32_16x16x32_bf16 v[172:175], a[156:159], a[180:183], v[172:175]
  ds_write_b128 v201, v[72:75]
  v_mov_b32 v84, 0
  v_mov_b32 v85, 0
  v_mfma_f32_16x16x32_bf16 v[168:171], a[160:163], a[184:187], v[168:171]
  v_mov_b32 v86, 0
  v_mov_b32 v87, 0
  v_mov_b32 v88, 0
  v_mfma_f32_16x16x32_bf16 v[172:175], a[164:167], a[184:187], v[172:175]
  v_mov_b32 v89, 0
  v_mov_b32 v90, 0
  v_mov_b32 v91, 0
  buffer_load_dwordx4 a[124:127], v184, s[8:11], s47 offen offset:1024 sc1
  v_mfma_f32_16x16x32_bf16 v[168:171], a[168:171], a[188:191], v[168:171]
  v_mov_b32 v92, 0
  v_mov_b32 v93, 0
  v_mfma_f32_16x16x32_bf16 v[172:175], a[172:175], a[188:191], v[172:175]
  v_mov_b32 v94, 0
  v_mov_b32 v95, 0
  v_mov_b32 v96, 0
  v_mfma_f32_16x16x32_bf16 v[168:171], v[160:163], a[192:195], v[168:171]
  v_mov_b32 v97, 0
  v_mov_b32 v98, 0
  v_mov_b32 v99, 0
  v_mfma_f32_16x16x32_bf16 v[172:175], v[164:167], a[192:195], v[172:175]
  s_waitcnt vmcnt(5)
  buffer_load_dwordx4 a[128:131], v184, s[8:11], s47 offen offset:2048 sc1
  v_mfma_f32_16x16x32_bf16 v[48:51], a[96:99], a[0:3], 0
  v_mfma_f32_16x16x32_bf16 v[52:55], a[96:99], a[24:27], 0
  v_cvt_pk_bf16_f32 v176, v168, v169
  v_cvt_pk_bf16_f32 v177, v170, v171
  v_mfma_f32_16x16x32_bf16 v[56:59], a[96:99], a[48:51], 0
  s_nop 0
  v_cvt_pk_bf16_f32 v178, v172, v173
  v_cvt_pk_bf16_f32 v179, v174, v175
  v_mfma_f32_16x16x32_bf16 v[60:63], a[96:99], a[72:75], 0
  buffer_load_dwordx4 a[132:135], v184, s[8:11], s47 offen offset:3072 sc1
  v_mfma_f32_16x16x32_bf16 v[48:51], a[100:103], a[4:7], v[48:51]
  v_mfma_f32_16x16x32_bf16 v[52:55], a[100:103], a[28:31], v[52:55]
  v_mfma_f32_16x16x32_bf16 v[56:59], a[100:103], a[52:55], v[56:59]
  v_mfma_f32_16x16x32_bf16 v[60:63], a[100:103], a[76:79], v[60:63]
  buffer_load_dwordx4 a[136:139], v184, s[8:11], s48 offen offset:0 sc1
  v_mfma_f32_16x16x32_bf16 v[48:51], a[104:107], a[8:11], v[48:51]
  v_mfma_f32_16x16x32_bf16 v[52:55], a[104:107], a[32:35], v[52:55]
  v_mfma_f32_16x16x32_bf16 v[56:59], a[104:107], a[56:59], v[56:59]
  v_mfma_f32_16x16x32_bf16 v[60:63], a[104:107], a[80:83], v[60:63]
  buffer_load_dwordx4 a[140:143], v184, s[8:11], s48 offen offset:1024 sc1
  v_mfma_f32_16x16x32_bf16 v[48:51], a[108:111], a[12:15], v[48:51]
  v_mfma_f32_16x16x32_bf16 v[52:55], a[108:111], a[36:39], v[52:55]
  v_mfma_f32_16x16x32_bf16 v[56:59], a[108:111], a[60:63], v[56:59]
  v_mfma_f32_16x16x32_bf16 v[60:63], a[108:111], a[84:87], v[60:63]
  buffer_load_dword v191, v189, s[8:11], 0 offen sc1
  v_mfma_f32_16x16x32_bf16 v[48:51], a[112:115], a[16:19], v[48:51]
  v_mfma_f32_16x16x32_bf16 v[52:55], a[112:115], a[40:43], v[52:55]
  v_mfma_f32_16x16x32_bf16 v[56:59], a[112:115], a[64:67], v[56:59]
  v_mfma_f32_16x16x32_bf16 v[60:63], a[112:115], a[88:91], v[60:63]
  v_mfma_f32_16x16x32_bf16 v[48:51], a[116:119], a[20:23], v[48:51]
  v_mfma_f32_16x16x32_bf16 v[52:55], a[116:119], a[44:47], v[52:55]
  v_mfma_f32_16x16x32_bf16 v[56:59], a[116:119], a[68:71], v[56:59]
  v_mfma_f32_16x16x32_bf16 v[60:63], a[116:119], a[92:95], v[60:63]
  s_nop 2
  s_nop 3
  v_cvt_pk_bf16_f32 v32, v48, v49
  v_cvt_pk_bf16_f32 v33, v50, v51
  s_nop 1
  v_cvt_pk_bf16_f32 v36, v52, v53
  v_cvt_pk_bf16_f32 v37, v54, v55
  s_nop 1
  v_cvt_pk_bf16_f32 v40, v56, v57
  v_cvt_pk_bf16_f32 v41, v58, v59
  s_nop 1
  v_cvt_pk_bf16_f32 v44, v60, v61
  v_cvt_pk_bf16_f32 v45, v62, v63
  s_waitcnt vmcnt(0)
we_71:
  v_cmp_gt_u32 vcc, s25, v191
  s_nop 0
  s_and_b32 vcc_lo, vcc_lo, 0x3c0
  s_cbranch_scc1 we_71_r
  s_add_u32 s25, s25, 1
  s_sub_u32 s27, s25, 9
  s_cmp_lt_u32 s27, 10
  s_cbranch_scc1 w_sent
  s_cmp_lg_u32 s25, 63
  s_cbranch_scc1 w_loop
  s_add_u32 s27, s41, 327680
  s_nop 15
  buffer_store_dwordx4 v[176:179], v197, s[8:11], s27 offen sc1
  s_branch w_loop
w_last:
  s_add_u32 s41, s41, 327680
  buffer_load_dword v191, v189, s[8:11], 0 offen sc1
  v_pk_add_f32 v[84:85], v[84:85], v[86:87]
  v_pk_add_f32 v[88:89], v[88:89], v[90:91]
  v_pk_add_f32 v[92:93], v[92:93], v[94:95]
  s_nop 0
  v_pk_add_f32 v[96:97], v[96:97], v[98:99]
  v_cvt_pk_bf16_f32 v72, v84, v85
  v_cvt_pk_bf16_f32 v73, v88, v89
  v_cvt_pk_bf16_f32 v74, v92, v93
  v_cvt_pk_bf16_f32 v75, v96, v97
  ds_write_b128 v201, v[72:75]
  v_mfma_f32_16x16x32_bf16 v[168:171], a[144:147], a[176:179], 0
  v_mfma_f32_16x16x32_bf16 v[172:175], a[148:151], a[176:179], 0
  v_mfma_f32_16x16x32_bf16 v[168:171], a[152:155], a[180:183], v[168:171]
  v_mfma_f32_16x16x32_bf16 v[172:175], a[156:159], a[180:183], v[172:175]
  v_mfma_f32_16x16x32_bf16 v[168:171], a[160:163], a[184:187], v[168:171]
  v_mfma_f32_16x16x32_bf16 v[172:175], a[164:167], a[184:187], v[172:175]
  v_mfma_f32_16x16x32_bf16 v[168:171], a[168:171], a[188:191], v[168:171]
  v_mfma_f32_16x16x32_bf16 v[172:175], a[172:175], a[188:191], v[172:175]
  v_mfma_f32_16x16x32_bf16 v[168:171], v[160:163], a[192:195], v[168:171]
  v_mfma_f32_16x16x32_bf16 v[172:175], v[164:167], a[192:195], v[172:175]
  s_add_u32 s27, s25, 3
  s_and_b32 s27, s27, 3
  s_mul_i32 s28, s27, 24576
  s_add_u32 s49, s39, s28
  s_add_u32 s50, s49, 4096
  s_add_u32 s51, s40, s28
  s_lshl_b32 s28, s27, 14
  v_add_u32 v208, s28, v212
  v_add_u32 v209, s28, v213
  s_lshl_b32 s28, s27, 12
  v_add_u32 v199, s28, v198
  v_add_u32 v216, s28, v217
  s_mov_b32 s26, 0
  s_waitcnt vmcnt(0) lgkmcnt(0)
  s_barrier
we_72:
  v_cmp_gt_u32 vcc, 63, v191
  s_nop 0
  s_and_b32 vcc_lo, vcc_lo, 0x3c0
  s_cbranch_scc1 we_72_r
  buffer_load_dwordx4 a[176:179], v184, s[8:11], s49 offen offset:0 sc1
  buffer_load_dwordx4 a[180:183], v184, s[8:11], s49 offen offset:2048 sc1
  buffer_load_dwordx4 a[184:187], v184, s[8:11], s50 offen offset:0 sc1
  buffer_load_dwordx4 a[188:191], v184, s[8:11], s50 offen offset:2048 sc1
  buffer_load_dwordx4 a[192:195], v184, s[8:11], s51 offen sc1
  ds_read_b128 a[144:147], v208 offset:0
  ds_read_b128 a[148:151], v209 offset:0
  ds_read_b128 a[152:155], v208 offset:4096
  ds_read_b128 a[156:159], v209 offset:4096
  ds_read_b128 a[160:163], v208 offset:8192
  ds_read_b128 a[164:167], v209 offset:8192
  ds_read_b128 a[168:171], v208 offset:12288
  ds_read_b128 a[172:175], v209 offset:12288
  ds_read2st64_b32 v[160:161], v199 offset0:0 offset1:4
  ds_read2st64_b32 v[162:163], v199 offset0:8 offset1:12
  ds_read2st64_b32 v[164:165], v216 offset0:0 offset1:4
  ds_read2st64_b32 v[166:167], v216 offset0:8 offset1:12
  v_cvt_pk_bf16_f32 v152, v168, v169
  v_cvt_pk_bf16_f32 v153, v170, v171
  v_cvt_pk_bf16_f32 v154, v172, v173
  v_cvt_pk_bf16_f32 v155, v174, v175
  s_mov_b32 s29, s41
  s_waitcnt lgkmcnt(0)
  s_waitcnt vmcnt(4)
  v_mfma_f32_16x16x32_bf16 v[168:171], a[144:147], a[176:179], 0
  v_mfma_f32_16x16x32_bf16 v[172:175], a[148:151], a[176:179], 0
  s_waitcnt vmcnt(3)
  v_mfma_f32_16x16x32_bf16 v[168:171], a[152:155], a[180:183], v[168:171]
  v_mfma_f32_16x16x32_bf16 v[172:175], a[156:159], a[180:183], v[172:175]
  s_waitcnt vmcnt(2)
  v_mfma_f32_16x16x32_bf16 v[168:171], a[160:163], a[184:187], v[168:171]
  v_mfma_f32_16x16x32_bf16 v[172:175], a[164:167], a[184:187], v[172:175]
  s_waitcnt vmcnt(1)
  v_mfma_f32_16x16x32_bf16 v[168:171], a[168:171], a[188:191], v[168:171]
  v_mfma_f32_16x16x32_bf16 v[172:175], a[172:175], a[188:191], v[172:175]
  s_waitcnt vmcnt(0)
  v_mfma_f32_16x16x32_bf16 v[168:171], v[160:163], a[192:195], v[168:171]
  v_mfma_f32_16x16x32_bf16 v[172:175], v[164:167], a[192:195], v[172:175]
  s_nop 6
  v_cvt_pk_bf16_f32 v176, v168, v169
  v_cvt_pk_bf16_f32 v177, v170, v171
  v_cvt_pk_bf16_f32 v178, v172, v173
  v_cvt_pk_bf16_f32 v179, v174, v175
  s_add_u32 s41, s41, 327680
  buffer_store_dwordx4 v[176:179], v197, s[8:11], s41 offen sc1
  buffer_store_dwordx4 v[152:155], v197, s[8:11], s29 offen sc1
  s_add_u32 s27, s25, 4
  s_and_b32 s27, s27, 3
  s_mul_i32 s28, s27, 24576
  s_add_u32 s49, s39, s28
  s_add_u32 s50, s49, 4096
  s_add_u32 s51, s40, s28
  s_lshl_b32 s28, s27, 14
  v_add_u32 v208, s28, v212
  v_add_u32 v209, s28, v213
  s_lshl_b32 s28, s27, 12
  v_add_u32 v199, s28, v198
  v_add_u32 v216, s28, v217
  ds_read_b128 a[144:147], v208 offset:0
  ds_read_b128 a[148:151], v209 offset:0
  ds_read_b128 a[152:155], v208 offset:4096
  ds_read_b128 a[156:159], v209 offset:4096
  ds_read_b128 a[160:163], v208 offset:8192
  ds_read_b128 a[164:167], v209 offset:8192
  ds_read_b128 a[168:171], v208 offset:12288
  ds_read_b128 a[172:175], v209 offset:12288
  ds_read2st64_b32 v[160:161], v199 offset0:0 offset1:4
  ds_read2st64_b32 v[162:163], v199 offset0:8 offset1:12
  ds_read2st64_b32 v[164:165], v216 offset0:0 offset1:4
  ds_read2st64_b32 v[166:167], v216 offset0:8 offset1:12
  s_mov_b32 s26, 0
pw_73:
  buffer_load_dword v191, v189, s[8:11], 0 offen sc1
  s_add_u32 s26, s26, 1
  s_cmp_gt_u32 s26, 65536
  s_cbranch_scc1 role_abort
  s_waitcnt vmcnt(0)
pc_75:
  v_cmp_gt_u32 vcc, 64, v191
  s_nop 0
  s_and_b32 vcc_lo, vcc_lo, 0x3c0
  s_and_b32 vcc_hi, vcc_hi, 0x0
  s_cmp_eq_u64 vcc, 0
  s_cbranch_scc1 po_74
  s_sleep 1
  s_branch pw_73
po_74:
  buffer_load_dwordx4 a[176:179], v184, s[8:11], s49 offen offset:0 sc1
  buffer_load_dwordx4 a[180:183], v184, s[8:11], s49 offen offset:2048 sc1
  buffer_load_dwordx4 a[184:187], v184, s[8:11], s50 offen offset:0 sc1
  buffer_load_dwordx4 a[188:191], v184, s[8:11], s50 offen offset:2048 sc1
  buffer_load_dwordx4 a[192:195], v184, s[8:11], s51 offen sc1
  s_waitcnt lgkmcnt(0)
  s_waitcnt vmcnt(4)
  v_mfma_f32_16x16x32_bf16 v[168:171], a[144:147], a[176:179], 0
  v_mfma_f32_16x16x32_bf16 v[172:175], a[148:151], a[176:179], 0
  s_waitcnt vmcnt(3)
  v_mfma_f32_16x16x32_bf16 v[168:171], a[152:155], a[180:183], v[168:171]
  v_mfma_f32_16x16x32_bf16 v[172:175], a[156:159], a[180:183], v[172:175]
  s_waitcnt vmcnt(2)
  v_mfma_f32_16x16x32_bf16 v[168:171], a[160:163], a[184:187], v[168:171]
  v_mfma_f32_16x16x32_bf16 v[172:175], a[164:167], a[184:187], v[172:175]
  s_waitcnt vmcnt(1)
  v_mfma_f32_16x16x32_bf16 v[168:171], a[168:171], a[188:191], v[168:171]
  v_mfma_f32_16x16x32_bf16 v[172:175], a[172:175], a[188:191], v[172:175]
  s_waitcnt vmcnt(0)
  v_mfma_f32_16x16x32_bf16 v[168:171], v[160:163], a[192:195], v[168:171]
  v_mfma_f32_16x16x32_bf16 v[172:175], v[164:167], a[192:195], v[172:175]
  s_nop 6
  v_cvt_pk_bf16_f32 v176, v168, v169
  v_cvt_pk_bf16_f32 v177, v170, v171
  v_cvt_pk_bf16_f32 v178, v172, v173
  v_cvt_pk_bf16_f32 v179, v174, v175
  s_add_u32 s41, s41, 327680
  buffer_store_dwordx4 v[176:179], v197, s[8:11], s41 offen sc1
  s_endpgm
we_70_r:
  s_sleep 1
  buffer_load_dword v191, v189, s[8:11], 0 offen sc1
  s_add_u32 s26, s26, 1
  s_cmp_gt_u32 s26, 65536
  s_cbranch_scc1 chain_abort
  s_waitcnt vmcnt(0)
  s_branch we_70
w_gx_r:
  v_max3_u32 v205, v20, v21, v22
  v_max_u32 v205, v205, v23
  v_cmp_eq_u32 vcc, -1, v205
  s_cbranch_vccz w_gx_s0
  s_mov_b64 exec, vcc
  buffer_load_dwordx4 v[20:23], v184, s[8:11], s34 offen offset:0 sc1
  s_mov_b64 exec, -1
w_gx_s0:
  v_max3_u32 v205, v24, v25, v26
  v_max_u32 v205, v205, v27
  v_cmp_eq_u32 vcc, -1, v205
  s_cbranch_vccz w_gx_s1
  s_mov_b64 exec, vcc
  buffer_load_dwordx4 v[24:27], v184, s[8:11], s34 offen offset:1024 sc1
  s_mov_b64 exec, -1
w_gx_s1:
  v_max3_u32 v205, v28, v29, v30
  v_max_u32 v205, v205, v31
  v_cmp_eq_u32 vcc, -1, v205
  s_cbranch_vccz w_gx_s2
  s_mov_b64 exec, vcc
  buffer_load_dwordx4 v[28:31], v184, s[8:11], s34 offen offset:2048 sc1
  s_mov_b64 exec, -1
w_gx_s2:
  buffer_load_dword v16, v185, s[8:11], s34 offen offset:3072 sc1
  buffer_load_dword v17, v185, s[8:11], s34 offen offset:3328 sc1
  buffer_load_dword v18, v185, s[8:11], s34 offen offset:3584 sc1
  s_add_u32 s26, s26, 1
  s_cmp_gt_u32 s26, 65536
  s_cbranch_scc1 chain_abort
  s_waitcnt vmcnt(0)
  s_branch w_gx
w_gm_r:
  v_max3_u32 v205, v16, v17, v18
  v_cmp_eq_u32 vcc, -1, v205
  s_cbranch_vccz w_gm_s0
  s_mov_b64 exec, vcc
  buffer_load_dword v16, v185, s[8:11], s34 offen offset:3072 sc1
  buffer_load_dword v17, v185, s[8:11], s34 offen offset:3328 sc1
  buffer_load_dword v18, v185, s[8:11], s34 offen offset:3584 sc1
  s_mov_b64 exec, -1
w_gm_s0:
  s_add_u32 s26, s26, 1
  s_cmp_gt_u32 s26, 65536
  s_cbranch_scc1 chain_abort
  s_waitcnt vmcnt(0)
  s_branch w_gm
w_gv_r:
  v_max3_u32 v205, v4, v5, v6
  v_max_u32 v205, v205, v7
  v_cmp_eq_u32 vcc, -1, v205
  s_cbranch_vccz w_gv_s0
  s_mov_b64 exec, vcc
  buffer_load_dwordx4 v[4:7], v184, s[8:11], s35 offen offset:0 sc1
  s_mov_b64 exec, -1
w_gv_s0:
  v_max3_u32 v205, v8, v9, v10
  v_max_u32 v205, v205, v11
  v_cmp_eq_u32 vcc, -1, v205
  s_cbranch_vccz w_gv_s1
  s_mov_b64 exec, vcc
  buffer_load_dwordx4 v[8:11], v184, s[8:11], s35 offen offset:1024 sc1
  s_mov_b64 exec, -1
w_gv_s1:
  v_max3_u32 v205, v12, v13, v14
  v_max_u32 v205, v205, v15
  v_cmp_eq_u32 vcc, -1, v205
  s_cbranch_vccz w_gv_s2
  s_mov_b64 exec, vcc
  buffer_load_dwordx4 v[12:15], v184, s[8:11], s35 offen offset:2048 sc1
  s_mov_b64 exec, -1
w_gv_s2:
  buffer_load_dwordx4 v[20:23], v184, s[8:11], s34 offen offset:0 sc1
  buffer_load_dwordx4 v[24:27], v184, s[8:11], s34 offen offset:1024 sc1
  buffer_load_dwordx4 v[28:31], v184, s[8:11], s34 offen offset:2048 sc1
  buffer_load_dword v16, v185, s[8:11], s34 offen offset:3072 sc1
  buffer_load_dword v17, v185, s[8:11], s34 offen offset:3328 sc1
  buffer_load_dword v18, v185, s[8:11], s34 offen offset:3584 sc1
  s_add_u32 s26, s26, 1
  s_cmp_gt_u32 s26, 65536
  s_cbranch_scc1 chain_abort
  s_waitcnt vmcnt(0)
  s_branch w_gv
w_gz_r:
  v_pk_add_f32 v[64:65], v[20:21], v[24:25]
  v_pk_add_f32 v[66:67], v[22:23], v[26:27]
  v_pk_add_f32 v[64:65], v[64:65], v[28:29]
  v_pk_add_f32 v[66:67], v[66:67], v[30:31]
  v_add_f32 v68, v16, v17
  v_add_f32 v68, v68, v18
  v_max3_f32 v203, v64, v65, v66
  v_max3_f32 v203, v203, v67, v68
  s_nop 1
  v_max_f32_dpp v203, v203, v203 row_ror:8 row_mask:0xf bank_mask:0xf
  v_mov_b32 v204, v203
  s_nop 1
  v_permlane16_swap_b32 v203, v204
  v_max_f32 v203, v203, v204
  v_mov_b32 v204, v203
  s_nop 1
  v_permlane32_swap_b32 v203, v204
  v_max_f32 v203, v203, v204
  v_sub_f32 v64, v64, v203
  v_mul_f32 v64, s60, v64
  v_exp_f32 v64, v64
  v_sub_f32 v65, v65, v203
  v_mul_f32 v65, s60, v65
  v_exp_f32 v65, v65
  v_sub_f32 v66, v66, v203
  v_mul_f32 v66, s60, v66
  v_exp_f32 v66, v66
  v_sub_f32 v67, v67, v203
  v_mul_f32 v67, s60, v67
  v_exp_f32 v67, v67
  v_sub_f32 v68, v68, v203
  v_mul_f32 v68, s60, v68
  v_exp_f32 v68, v68
  v_cvt_pk_bf16_f32 v140, v64, v65
  v_cvt_pk_bf16_f32 v141, v66, v67
  s_nop 0
  v_mov_b32_dpp v108, v140 quad_perm:[0,1,2,3] row_mask:0xf bank_mask:0x3
  v_mov_b32_dpp v109, v141 quad_perm:[0,1,2,3] row_mask:0xf bank_mask:0x3
  v_mov_b32_dpp v110, v140 row_ror:8 row_mask:0xf bank_mask:0x3
  v_mov_b32_dpp v111, v141 row_ror:8 row_mask:0xf bank_mask:0x3
  v_mov_b32_dpp v112, v140 row_ror:8 row_mask:0xf bank_mask:0xc
  v_mov_b32_dpp v113, v141 row_ror:8 row_mask:0xf bank_mask:0xc
  v_mov_b32_dpp v114, v140 quad_perm:[0,1,2,3] row_mask:0xf bank_mask:0xc
  v_mov_b32_dpp v115, v141 quad_perm:[0,1,2,3] row_mask:0xf bank_mask:0xc
  v_mov_b32_dpp v69, v68 row_ror:8 row_mask:0xf bank_mask:0xf
  v_cvt_pk_bf16_f32 v142, v68, v69
  s_nop 1
  v_mov_b32_dpp v116, v142 quad_perm:[0,1,2,3] row_mask:0xf bank_mask:0x3
  v_mov_b32_dpp v117, v142 quad_perm:[0,1,2,3] row_mask:0xf bank_mask:0x3
  v_mov_b32_dpp v118, v142 row_ror:8 row_mask:0xf bank_mask:0xc
  v_mov_b32_dpp v119, v142 row_ror:8 row_mask:0xf bank_mask:0xc
  v_mfma_f32_16x16x32_bf16 v[72:75], v[80:83], v[108:111], 0
  v_mfma_f32_16x16x32_bf16 v[132:135], v[32:35], v[108:111], 0
  v_mfma_f32_16x16x32_bf16 v[136:139], v[40:43], v[108:111], 0
  v_mfma_f32_16x16x32_bf16 v[132:135], v[36:39], v[112:115], v[132:135]
  v_mfma_f32_16x16x32_bf16 v[136:139], v[44:47], v[112:115], v[136:139]
  s_nop 1
  v_mfma_f32_16x16x16_bf16 v[72:75], v[122:123], v[116:117], v[72:75]
  s_nop 1
  v_mfma_f32_16x16x16_bf16 v[132:135], v[100:101], v[116:117], v[132:135]
  v_mfma_f32_16x16x16_bf16 v[136:139], v[104:105], v[116:117], v[136:139]
  v_mfma_f32_16x16x16_bf16 v[132:135], v[102:103], v[118:119], v[132:135]
  v_mfma_f32_16x16x16_bf16 v[136:139], v[106:107], v[118:119], v[136:139]
  s_nop 1
  v_rcp_f32 v120, v72
  s_nop 0
  ds_write_b32 v192, v120
  s_branch w_gz
we_71_r:
  s_sleep 1
  buffer_load_dword v191, v189, s[8:11], 0 offen sc1
  s_add_u32 s26, s26, 1
  s_cmp_gt_u32 s26, 65536
  s_cbranch_scc1 chain_abort
  s_waitcnt vmcnt(0)
  s_branch we_71
w_sent:
  s_add_u32 s27, s41, 16056320
  buffer_store_dwordx4 v[152:155], v197, s[8:11], s27 offen sc1
  s_branch w_loop
we_72_r:
  s_sleep 1
  buffer_load_dword v191, v189, s[8:11], 0 offen sc1
  s_add_u32 s26, s26, 1
  s_cmp_gt_u32 s26, 65536
  s_cbranch_scc1 chain_abort
  s_waitcnt vmcnt(0)
  s_branch we_72
.section .rodata,"a"
.p2align 6
.amdhsa_kernel adaLN_cond__memory_aug_recurrent_mem_tr__moe_arch_mod__prompt_kernel
  .amdhsa_next_free_vgpr 512
  .amdhsa_next_free_sgpr 102
  .amdhsa_accum_offset 256
  .amdhsa_group_segment_fixed_size 0
  .amdhsa_kernarg_size 136
  .amdhsa_user_sgpr_count 2
  .amdhsa_user_sgpr_kernarg_segment_ptr 1
  .amdhsa_system_sgpr_workgroup_id_x 1
.end_amdhsa_kernel
```
